```python
import torch

def _softmax(x, axis=-1):
    return torch.softmax(x, dim=axis)

def _gelu(x):
    return torch.nn.functional.gelu(x, approximate='tanh')

def _silu(x):
    return torch.nn.functional.silu(x)

def _sigmoid(x):
    return torch.sigmoid(x)

def _layernorm(x, axis=-1, eps=1e-05):
    m = x.mean(dim=axis, keepdim=True)
    v = x.var(dim=axis, keepdim=True, unbiased=False)
    return (x - m) / torch.sqrt(v + eps)

def _scatter_add(tgt, idx, src, axis=0):
    return tgt.clone().index_add_(axis, idx, src)

def _segment_sum(src, seg, n):
    out = torch.zeros((n,) + src.shape[1:], dtype=src.dtype)
    return out.index_add_(0, seg, src)

def _pad(x, pw):
    flat = tuple((v for pair in reversed(pw) for v in pair))
    return torch.nn.functional.pad(x, flat)
kernel_name = 'adaLN_cond__compressed_kv_cla__dense_activation_relu__decode'

def setup_inputs():

    _w = lambda a: (lambda t: t.to(torch.bfloat16) if t.is_floating_point() else t)(torch.as_tensor(a))

    def _A_setup():
        B, H, Sq, Sk, D, M = (8, 32, 1, 4096, 128, 512)
        Dc = 4 * D
        return {'x': _w((lambda *s: torch.randn(*s, dtype=torch.bfloat16) * 0.05)(B, Sq, M)), 'c_kv': _w((lambda *s: torch.randn(*s, dtype=torch.bfloat16) * 1.6)(B, Sk, Dc)), 'w_q': _w((lambda *s: torch.randn(*s, dtype=torch.bfloat16) * 1.6)(M, H, D) * M ** (-0.5)), 'w_uk': _w((lambda *s: torch.randn(*s, dtype=torch.bfloat16) * 1.6)(Dc, H, D) * Dc ** (-0.5)), 'w_uv': _w((lambda *s: torch.randn(*s, dtype=torch.bfloat16) * 1.6)(Dc, H, D) * Dc ** (-0.5)), 'w_o': _w((lambda *s: torch.randn(*s, dtype=torch.bfloat16) * 1.6)(H, D, M) * (H * D) ** (-0.5))}
    _A_in = _A_setup()

    def _B_setup():
        B, S, D, Dff = (8, 1, 512, 1792)
        return {'x': _w((lambda *s: torch.randn(*s, dtype=torch.bfloat16) * 0.05)(B, S, D)), 'w1': _w((lambda *s: torch.randn(*s, dtype=torch.bfloat16) * 0.05)(D, Dff)), 'w2': _w((lambda *s: torch.randn(*s, dtype=torch.bfloat16) * 0.05)(Dff, D))}
    _B_in = _B_setup()
    return {'A_x': _A_in['x'], 'A_c_kv': _A_in['c_kv'], 'A_w_q': _A_in['w_q'], 'A_w_uk': _A_in['w_uk'], 'A_w_uv': _A_in['w_uv'], 'A_w_o': _A_in['w_o'], 'B_x': _B_in['x'], 'B_w1': _B_in['w1'], 'B_w2': _B_in['w2'], 'c': _w((lambda *s: torch.randn(*s, dtype=torch.bfloat16) * 0.2)(8, 512) * 8.0), 'w_mod': _w((lambda *s: torch.randn(*s, dtype=torch.bfloat16) * 0.2)(512, 6 * 512) * 512 ** (-0.5) * 8.0)}

def reference(A_x, A_c_kv, A_w_q, A_w_uk, A_w_uv, A_w_o, B_x, B_w1, B_w2, c, w_mod):

    def _A_ref(x, c_kv, w_q, w_uk, w_uv, w_o):
        B, Sq, M = (x.shape[0], x.shape[1], x.shape[2])
        Sk = c_kv.shape[1]
        H, D = (w_q.shape[1], w_q.shape[2])
        q = torch.einsum('bqm,mhd->bhqd', x, w_q)
        k = torch.einsum('bkc,chd->bhkd', c_kv, w_uk)
        v = torch.einsum('bkc,chd->bhkd', c_kv, w_uv)
        scores = torch.einsum('bhqd,bhkd->bhqk', q, k) * D ** (-0.5)
        off = Sk - Sq
        qi = torch.arange(Sq)[:, None]
        kj = torch.arange(Sk)[None, :]
        cmask = kj <= qi + off
        scores = torch.where(cmask[None, None], scores, -1000000000.0)
        p = _softmax(scores, axis=-1)
        ctx = torch.einsum('bhqk,bhkd->bhqd', p, v)
        return torch.einsum('bhqd,hdm->bqm', ctx, w_o)

    def _B_ref(x, w1, w2):
        h = torch.einsum('bsd,df->bsf', x, w1)
        zero = torch.zeros_like(h)
        h = torch.maximum(h, zero)
        return torch.einsum('bsf,fd->bsd', h, w2)
    x = A_x
    mod = (_silu(c) @ w_mod).reshape(c.shape[0], 6, 1, -1)
    sa, ca, ga, sb, cb, gb = (mod[:, 0].clone(), mod[:, 1].clone(), mod[:, 2].clone(), mod[:, 3].clone(), mod[:, 4].clone(), mod[:, 5].clone())
    h = _layernorm(x, axis=-1) * (1 + ca) + sa
    x = x + ga * _A_ref(h, A_c_kv, A_w_q, A_w_uk, A_w_uv, A_w_o)
    h = _layernorm(x, axis=-1) * (1 + cb) + sb
    x = x + gb * _B_ref(h, B_w1, B_w2)
    return x
```

```asm
; @launch grid=(256,1,1) block=(512,1,1) lds=163840
.amdgcn_target "amdgcn-amd-amdhsa--gfx950"
.text
.globl adaLN_cond__compressed_kv_cla__dense_activation_relu__decode_kernel
.p2align 8
.type adaLN_cond__compressed_kv_cla__dense_activation_relu__decode_kernel,@function
adaLN_cond__compressed_kv_cla__dense_activation_relu__decode_kernel:
    s_cmp_ge_u32 s2, 256
    s_cbranch_scc1 L_end
    s_load_dwordx2 s[36:37], s[0:1], 72
    s_load_dwordx2 s[40:41], s[0:1], 80
    s_load_dwordx2 s[48:49], s[0:1], 104
    s_load_dwordx2 s[8:9], s[0:1], 8
    s_load_dwordx2 s[4:5], s[0:1], 0
    s_load_dwordx2 s[12:13], s[0:1], 16
    s_load_dwordx2 s[16:17], s[0:1], 24
    v_mov_b32 v3, v0
    v_lshrrev_b32 v4, 6, v0
    v_and_b32 v0, 63, v0
    v_readfirstlane_b32 s56, v4
    v_and_b32 v1, 15, v0
    v_lshrrev_b32 v2, 4, v0
    s_and_b32 s52, s2, 7
    s_lshr_b32 s53, s2, 3
    s_and_b32 s54, s53, 15
    s_lshl_b32 s55, s52, 4
    s_add_u32 s55, s55, s54
    v_lshlrev_b32 v16, 4, v3
    s_mov_b32 s38, 8192
    s_mov_b32 s39, 0x00020000
    s_mov_b32 s42, 3145728
    s_mov_b32 s43, 0x00020000
    s_mov_b32 s50, 15728640
    s_mov_b32 s51, 0x00020000
    s_mov_b32 s6, 8192
    s_mov_b32 s7, 0x00020000
    v_and_b32 v4, 7, v1
    v_lshlrev_b32 v4, 10, v4
    v_lshrrev_b32 v5, 3, v1
    v_lshl_add_u32 v4, v5, 6, v4
    v_lshl_add_u32 v4, v2, 4, v4
    s_cmp_ge_u32 s53, 16
    s_cbranch_scc1 L_att0
    s_cmp_lg_u32 s56, 0
    s_cbranch_scc1 L_svc0
    s_and_b32 s61, s54, 3
    s_lshl_b32 s64, s61, 8
    v_lshrrev_b32 v5, 2, v0
    v_mul_u32_u24 v5, 6144, v5
    v_and_b32 v18, 3, v0
    v_lshrrev_b32 v17, 5, v0
    v_lshlrev_b32 v17, 1, v17
    v_xor_b32 v18, v18, v17
    v_lshl_add_u32 v5, v18, 4, v5
    s_lshr_b32 s66, s55, 2
    s_lshl_b32 s66, s66, 6
    s_mul_i32 s65, s61, 786432
    s_add_u32 s65, s65, s66
    s_mov_b32 m0, 131072
    v_mov_b32 v20, -1
    v_mov_b32 v21, -1
    v_mov_b32 v22, -1
    v_mov_b32 v23, -1
    s_mul_i32 s67, s55, 2688
    s_add_u32 s67, s67, 196608
    s_lshl_b32 s35, s55, 12
    s_add_u32 s35, s35, 7061504
    s_add_u32 s68, s67, 2048
    v_add_u32 v17, s68, v16
    s_add_u32 s68, s35, 384
    v_min_u32 v18, 47, v0
    v_lshl_add_u32 v18, v18, 4, s68
    v_cmp_lt_u32 vcc, 39, v0
    s_nop 1
    v_cndmask_b32 v17, v17, v18, vcc
    s_waitcnt lgkmcnt(0)
    s_load_dword s57, s[48:49], 0
    buffer_load_dwordx4 v[40:43], v4, s[36:39], s64 offen
    buffer_load_dwordx4 v[44:47], v4, s[36:39], s64 offen offset:128
    buffer_load_dwordx4 v5, s[40:43], s65 offen  lds
    s_add_u32 s65, s65, 98304
    s_add_u32 m0, m0, 1024
    s_nop 0
    buffer_load_dwordx4 v5, s[40:43], s65 offen  lds
    s_add_u32 s65, s65, 98304
    s_add_u32 m0, m0, 1024
    s_nop 0
    buffer_load_dwordx4 v5, s[40:43], s65 offen  lds
    s_add_u32 s65, s65, 98304
    s_add_u32 m0, m0, 1024
    s_nop 0
    buffer_load_dwordx4 v5, s[40:43], s65 offen  lds
    s_add_u32 s65, s65, 98304
    s_add_u32 m0, m0, 1024
    s_nop 0
    buffer_load_dwordx4 v5, s[40:43], s65 offen  lds
    s_add_u32 s65, s65, 98304
    s_add_u32 m0, m0, 1024
    s_nop 0
    buffer_load_dwordx4 v5, s[40:43], s65 offen  lds
    s_add_u32 s65, s65, 98304
    s_add_u32 m0, m0, 1024
    s_nop 0
    buffer_load_dwordx4 v5, s[40:43], s65 offen  lds
    s_add_u32 s65, s65, 98304
    s_add_u32 m0, m0, 1024
    s_nop 0
    buffer_load_dwordx4 v5, s[40:43], s65 offen  lds
    buffer_store_dwordx4 v[20:23], v16, s[48:51], s67 offen sc1
    buffer_store_dwordx4 v[20:23], v16, s[48:51], s67 offen offset:1024 sc1
    buffer_store_dwordx4 v[20:23], v17, s[48:51], 0 offen sc1
    s_branch L_p1
L_svc0:
    v_lshlrev_b32 v17, 4, v0
    s_waitcnt lgkmcnt(0)
    s_load_dword s57, s[48:49], 0
    buffer_load_dwordx4 v[8:11], v16, s[4:7], 0 offen
    s_cmp_lg_u32 s56, 3
    s_cbranch_scc1 wi_1
    buffer_load_dwordx4 v[40:43], v17, s[4:7], 0 offen
wi_1:
    s_branch L_svc
L_att0:
    s_cmp_ge_u32 s56, 4
    s_cbranch_scc0 L_atq
    s_barrier
    s_barrier
    s_branch L_pv
L_atq:
    s_getpc_b64 s[64:65]
pc_3:
    s_sub_u32 s64, s64, pc_3-adaLN_cond__compressed_kv_cla__dense_activation_relu__decode_kernel
    s_subb_u32 s65, s65, 0
    s_lshl_b32 s66, s56, 4
    s_add_u32 s66, s66, s54
    s_lshl_b32 s66, s66, 10
    s_cmp_ge_u32 s66, L_code_end-adaLN_cond__compressed_kv_cla__dense_activation_relu__decode_kernel
    s_cbranch_scc1 cpf_4
    s_min_u32 s66, s66, L_code_end-adaLN_cond__compressed_kv_cla__dense_activation_relu__decode_kernel-1024
    v_lshl_add_u32 v32, v0, 4, s66
    global_load_dwordx4 v[64:67], v32, s[64:65]
cpf_4:
    s_mov_b32 s18, 4194304
    s_mov_b32 s19, 0x00020000
    s_lshr_b32 s60, s55, 2
    s_and_b32 s61, s54, 3
    v_lshlrev_b32 v29, 13, v2
    s_and_b32 s69, s56, 3
    s_lshl_b32 s67, s61, 20
    s_lshl_b32 s68, s69, 18
    s_add_u32 s67, s67, s68
    s_lshl_b32 s68, s60, 8
    s_add_u32 s67, s67, s68
    s_lshl_b32 s68, s69, 13
    v_lshrrev_b32 v33, 1, v0
    v_lshlrev_b32 v33, 13, v33
    v_and_b32 v34, 1, v0
    v_lshl_add_u32 v33, v34, 7, v33
    s_mov_b32 s14, 4194304
    s_mov_b32 s15, 0x00020000
    s_mov_b32 exec_lo, 0xffffffff
    s_mov_b32 exec_hi, 0xffffffff
    s_waitcnt lgkmcnt(0)
    buffer_load_dword v69, v33, s[12:15], s67 offen
    s_mov_b64 exec, -1
    s_barrier
    s_mov_b32 exec_lo, 0xffffffff
    s_mov_b32 exec_hi, 0xffffffff
    buffer_load_dword v68, v33, s[16:19], s67 offen
    s_mov_b64 exec, -1
    s_lshl_b32 s66, s55, 12
    s_add_u32 s66, s66, 1818624
    buffer_load_dword v70, v16, s[48:51], s66 offen sc1
    s_barrier
    s_branch L_qk
L_p1:
    v_lshrrev_b32 v48, 2, v1
    v_lshl_add_u32 v48, v2, 3, v48
    v_lshlrev_b32 v48, 6, v48
    v_and_b32 v50, 3, v1
    v_lshl_add_u32 v48, v50, 3, v48
    v_and_b32 v50, 1, v2
    v_lshl_add_u32 v48, v50, 5, v48
    v_add_u32 v48, 131072, v48
    v_xor_b32 v49, 32, v48
    v_lshlrev_b32 v50, 6, v1
    v_lshl_add_u32 v50, v2, 4, v50
    s_waitcnt vmcnt(11)
    v_lshlrev_b32 v64, 16, v40
    v_and_b32 v65, 0xffff0000, v40
    v_lshlrev_b32 v66, 16, v41
    v_and_b32 v67, 0xffff0000, v41
    v_lshlrev_b32 v68, 16, v42
    v_and_b32 v69, 0xffff0000, v42
    v_lshlrev_b32 v70, 16, v43
    v_and_b32 v71, 0xffff0000, v43
    v_lshlrev_b32 v72, 16, v44
    v_and_b32 v73, 0xffff0000, v44
    v_lshlrev_b32 v74, 16, v45
    v_and_b32 v75, 0xffff0000, v45
    v_lshlrev_b32 v76, 16, v46
    v_and_b32 v77, 0xffff0000, v46
    v_lshlrev_b32 v78, 16, v47
    v_and_b32 v79, 0xffff0000, v47
    v_mul_f32 v80, 0xbfb8aa3b, v64
    v_mul_f32 v81, 0xbfb8aa3b, v65
    v_mul_f32 v82, 0xbfb8aa3b, v66
    v_mul_f32 v83, 0xbfb8aa3b, v67
    v_mul_f32 v84, 0xbfb8aa3b, v68
    v_mul_f32 v85, 0xbfb8aa3b, v69
    v_mul_f32 v86, 0xbfb8aa3b, v70
    v_mul_f32 v87, 0xbfb8aa3b, v71
    v_mul_f32 v88, 0xbfb8aa3b, v72
    v_mul_f32 v89, 0xbfb8aa3b, v73
    v_mul_f32 v90, 0xbfb8aa3b, v74
    v_mul_f32 v91, 0xbfb8aa3b, v75
    v_mul_f32 v92, 0xbfb8aa3b, v76
    v_mul_f32 v93, 0xbfb8aa3b, v77
    v_mul_f32 v94, 0xbfb8aa3b, v78
    v_mul_f32 v95, 0xbfb8aa3b, v79
    v_exp_f32 v80, v80
    v_exp_f32 v81, v81
    v_exp_f32 v82, v82
    v_exp_f32 v83, v83
    v_exp_f32 v84, v84
    v_exp_f32 v85, v85
    v_exp_f32 v86, v86
    v_exp_f32 v87, v87
    v_exp_f32 v88, v88
    v_exp_f32 v89, v89
    v_exp_f32 v90, v90
    v_exp_f32 v91, v91
    v_exp_f32 v92, v92
    v_exp_f32 v93, v93
    v_exp_f32 v94, v94
    v_exp_f32 v95, v95
    v_add_f32 v80, 1.0, v80
    v_add_f32 v81, 1.0, v81
    v_add_f32 v82, 1.0, v82
    v_add_f32 v83, 1.0, v83
    v_add_f32 v84, 1.0, v84
    v_add_f32 v85, 1.0, v85
    v_add_f32 v86, 1.0, v86
    v_add_f32 v87, 1.0, v87
    v_add_f32 v88, 1.0, v88
    v_add_f32 v89, 1.0, v89
    v_add_f32 v90, 1.0, v90
    v_add_f32 v91, 1.0, v91
    v_add_f32 v92, 1.0, v92
    v_add_f32 v93, 1.0, v93
    v_add_f32 v94, 1.0, v94
    v_add_f32 v95, 1.0, v95
    v_rcp_f32 v80, v80
    v_rcp_f32 v81, v81
    v_rcp_f32 v82, v82
    v_rcp_f32 v83, v83
    v_rcp_f32 v84, v84
    v_rcp_f32 v85, v85
    v_rcp_f32 v86, v86
    v_rcp_f32 v87, v87
    v_rcp_f32 v88, v88
    v_rcp_f32 v89, v89
    v_rcp_f32 v90, v90
    v_rcp_f32 v91, v91
    v_rcp_f32 v92, v92
    v_rcp_f32 v93, v93
    v_rcp_f32 v94, v94
    v_rcp_f32 v95, v95
    v_mul_f32 v64, v64, v80
    v_mul_f32 v65, v65, v81
    v_mul_f32 v66, v66, v82
    v_mul_f32 v67, v67, v83
    v_mul_f32 v68, v68, v84
    v_mul_f32 v69, v69, v85
    v_mul_f32 v70, v70, v86
    v_mul_f32 v71, v71, v87
    v_mul_f32 v72, v72, v88
    v_mul_f32 v73, v73, v89
    v_mul_f32 v74, v74, v90
    v_mul_f32 v75, v75, v91
    v_mul_f32 v76, v76, v92
    v_mul_f32 v77, v77, v93
    v_mul_f32 v78, v78, v94
    v_mul_f32 v79, v79, v95
    v_cvt_pk_bf16_f32 v52, v64, v65
    v_cvt_pk_bf16_f32 v53, v66, v67
    v_cvt_pk_bf16_f32 v54, v68, v69
    v_cvt_pk_bf16_f32 v55, v70, v71
    v_cvt_pk_bf16_f32 v56, v72, v73
    v_cvt_pk_bf16_f32 v57, v74, v75
    v_cvt_pk_bf16_f32 v58, v76, v77
    v_cvt_pk_bf16_f32 v59, v78, v79
    s_waitcnt lgkmcnt(0)
    ds_write_b128 v16, v[52:55] offset:45056
    ds_write_b128 v16, v[56:59] offset:46080
    s_mul_i32 s57, s57, 0x9e3779b1
    s_add_u32 s57, s57, 0x7f4a7c15
    s_and_b32 s58, s57, 0xffff
    s_lshr_b32 s59, s57, 16
    s_getreg_b32 s28, hwreg(HW_REG_XCC_ID)
    s_not_b32 s67, s57
    s_xor_b32 s28, s67, s28
    v_bfe_u32 v12, s57, 0, 8
    v_bfe_u32 v13, s57, 8, 8
    v_bfe_u32 v14, s57, 16, 8
    v_bfe_u32 v15, s57, 24, 8
    s_mov_b32 s67, 0xff
    s_waitcnt lgkmcnt(0)
    s_waitcnt vmcnt(9)
    ds_read_b64_tr_b16 v[64:65], v48 offset:0
    ds_read_b64_tr_b16 v[66:67], v48 offset:256
    ds_read_b64_tr_b16 v[68:69], v49 offset:0
    ds_read_b64_tr_b16 v[70:71], v49 offset:256
    s_waitcnt vmcnt(7)
    ds_read_b64_tr_b16 v[72:73], v48 offset:2048
    ds_read_b64_tr_b16 v[74:75], v48 offset:2304
    ds_read_b64_tr_b16 v[76:77], v49 offset:2048
    ds_read_b64_tr_b16 v[78:79], v49 offset:2304
    s_waitcnt vmcnt(5)
    ds_read_b64_tr_b16 v[80:81], v48 offset:4096
    ds_read_b64_tr_b16 v[82:83], v48 offset:4352
    ds_read_b64_tr_b16 v[84:85], v49 offset:4096
    ds_read_b64_tr_b16 v[86:87], v49 offset:4352
    s_waitcnt vmcnt(3)
    ds_read_b64_tr_b16 v[88:89], v48 offset:6144
    ds_read_b64_tr_b16 v[90:91], v48 offset:6400
    ds_read_b64_tr_b16 v[92:93], v49 offset:6144
    ds_read_b64_tr_b16 v[94:95], v49 offset:6400
    s_waitcnt lgkmcnt(14)
    v_mfma_f32_16x16x32_bf16 v[96:99], v[64:67], v[52:55], 0
    s_waitcnt lgkmcnt(12)
    v_mfma_f32_16x16x32_bf16 v[104:107], v[68:71], v[52:55], 0
    s_waitcnt lgkmcnt(10)
    v_mfma_f32_16x16x32_bf16 v[100:103], v[72:75], v[52:55], 0
    s_waitcnt lgkmcnt(8)
    v_mfma_f32_16x16x32_bf16 v[108:111], v[76:79], v[52:55], 0
    s_waitcnt lgkmcnt(6)
    v_mfma_f32_16x16x32_bf16 v[96:99], v[80:83], v[56:59], v[96:99]
    s_waitcnt lgkmcnt(4)
    v_mfma_f32_16x16x32_bf16 v[104:107], v[84:87], v[56:59], v[104:107]
    s_waitcnt lgkmcnt(2)
    v_mfma_f32_16x16x32_bf16 v[100:103], v[88:91], v[56:59], v[100:103]
    s_waitcnt lgkmcnt(0)
    v_mfma_f32_16x16x32_bf16 v[108:111], v[92:95], v[56:59], v[108:111]
    s_nop 5
    v_add_f32_dpp v112, v100, v96 row_ror:8 row_mask:0xf bank_mask:0x3
    v_add_f32_dpp v113, v101, v97 row_ror:8 row_mask:0xf bank_mask:0x3
    v_add_f32_dpp v114, v102, v98 row_ror:8 row_mask:0xf bank_mask:0x3
    v_add_f32_dpp v115, v103, v99 row_ror:8 row_mask:0xf bank_mask:0x3
    v_add_f32_dpp v112, v104, v108 row_ror:8 row_mask:0xf bank_mask:0xc
    v_add_f32_dpp v113, v105, v109 row_ror:8 row_mask:0xf bank_mask:0xc
    v_add_f32_dpp v114, v106, v110 row_ror:8 row_mask:0xf bank_mask:0xc
    v_add_f32_dpp v115, v107, v111 row_ror:8 row_mask:0xf bank_mask:0xc
    v_bfi_b32 v112, s67, v12, v112
    v_bfi_b32 v113, s67, v13, v113
    v_bfi_b32 v114, s67, v14, v114
    v_bfi_b32 v115, s67, v15, v115
    s_waitcnt vmcnt(0)
    buffer_store_dwordx4 v[112:115], v50, s[48:51], s35 offen sc1
    v_mov_b32 v60, s57
    s_mov_b32 exec_lo, 0x1
    s_mov_b32 exec_hi, 0x0
    buffer_store_dword v60, v16, s[48:51], s35 offen offset:1024 sc1
    s_mov_b64 exec, -1
    s_barrier
L_svc:
    s_load_dwordx2 s[20:21], s[0:1], 32
    s_load_dwordx2 s[24:25], s[0:1], 40
    s_load_dwordx2 s[44:45], s[0:1], 88
    s_mov_b32 s22, 4194304
    s_mov_b32 s23, 0x00020000
    s_mov_b32 s26, 4194304
    s_mov_b32 s27, 0x00020000
    s_mov_b32 s46, 8192
    s_mov_b32 s47, 0x00020000
    s_mov_b32 s18, 4194304
    s_mov_b32 s19, 0x00020000
    s_mov_b32 s10, 33554432
    s_mov_b32 s11, 0x00020000
    s_lshr_b32 s60, s55, 2
    s_and_b32 s61, s54, 3
    v_lshlrev_b32 v29, 13, v2
    s_and_b32 s69, s56, 3
    s_lshl_b32 s67, s61, 20
    s_lshl_b32 s68, s69, 18
    s_add_u32 s67, s67, s68
    s_lshl_b32 s68, s60, 8
    s_add_u32 s67, s67, s68
    s_lshl_b32 s68, s69, 13
    s_mov_b32 s76, 0x05040100
    s_mov_b32 s77, 0x07060302
    v_lshrrev_b32 v17, 2, v1
    v_and_b32 v38, 3, v1
    v_lshl_add_u32 v28, v2, 3, v17
    v_lshlrev_b32 v36, 8, v28
    v_lshl_add_u32 v36, v38, 3, v36
    v_lshlrev_b32 v5, 7, v28
    v_lshl_add_u32 v5, v38, 3, v5
    v_bfe_u32 v28, v1, 3, 1
    v_lshl_add_u32 v5, v28, 5, v5
    v_and_b32 v37, 1, v2
    v_lshl_add_u32 v5, v37, 6, v5
    v_and_b32 v19, 7, v1
    v_lshlrev_b32 v95, 1, v37
    v_xor_b32 v95, v95, v19
    v_lshlrev_b32 v95, 4, v95
    v_lshl_add_u32 v37, v37, 2, v17
    v_xor_b32 v37, s56, v37
    v_lshl_add_u32 v36, v37, 5, v36
    s_lshl_b32 s66, s56, 5
    v_bfe_u32 v28, v0, 2, 3
    v_and_b32 v21, 3, v0
    v_lshrrev_b32 v22, 5, v0
    v_lshl_add_u32 v22, v21, 1, v22
    v_mul_u32_u24 v20, 272, v28
    v_lshl_add_u32 v20, v22, 2, v20
    v_add_u32 v20, s66, v20
    v_lshlrev_b32 v24, 10, v28
    v_lshl_add_u32 v24, v22, 2, v24
    s_lshl_b32 s64, s61, 8
    s_add_u32 s64, s64, s66
    v_add_u32 v21, s64, v24
    v_mul_u32_u24 v22, 272, v19
    v_lshrrev_b32 v28, 3, v1
    v_lshl_add_u32 v22, v28, 6, v22
    v_lshl_add_u32 v22, v2, 4, v22
    v_lshlrev_b32 v17, 3, v0
    v_lshlrev_b32 v23, 6, v19
    v_lshl_add_u32 v23, v2, 4, v23
    v_and_b32 v26, 31, v0
    v_lshlrev_b32 v26, 4, v26
    v_lshrrev_b32 v28, 5, v0
    v_lshl_add_u32 v39, v28, 12, v26
    v_lshl_add_u32 v26, v28, 12, v26
    v_add_u32 v27, 8192, v26
    v_lshrrev_b32 v32, 3, v0
    v_mul_u32_u24 v32, 6144, v32
    v_add_u32 v32, v32, v95
    v_xor_b32 v33, 64, v32
    s_lshl_b32 s64, s61, 2
    s_add_u32 s64, s64, s69
    s_mul_i32 s33, s64, 196608
    s_lshl_b32 s64, s60, 7
    s_add_u32 s33, s33, s64
    s_add_u32 s33, s33, 2048
    s_lshl_b32 s34, s69, 12
    s_add_u32 s34, s34, 139264
    s_lshl_b32 s64, s61, 16
    s_lshr_b32 s65, s56, 1
    s_lshl_b32 s65, s65, 14
    s_add_u32 s64, s64, s65
    s_and_b32 s65, s56, 1
    s_lshl_b32 s65, s65, 9
    s_add_u32 s64, s64, s65
    s_add_u32 s30, s64, 7061504
    s_add_u32 s31, s30, 262144
    v_lshlrev_b32 v34, 7, v2
    s_lshl_b32 s29, s60, 9
    s_add_u32 s29, s29, 102400
    s_cmp_eq_u32 s56, 0
    s_cbranch_scc1 L_svc4
    s_cmp_lt_u32 s56, 4
    s_cbranch_scc1 wi_5
    s_add_u32 s64, s33, 0
    s_add_u32 m0, s34, 0
    s_nop 0
    buffer_load_dwordx4 v32, s[40:43], s64 offen nt lds
    s_add_u32 s64, s33, 49152
    s_add_u32 m0, s34, 1024
    s_nop 0
    buffer_load_dwordx4 v33, s[40:43], s64 offen nt lds
    s_add_u32 s64, s33, 98304
    s_add_u32 m0, s34, 2048
    s_nop 0
    buffer_load_dwordx4 v32, s[40:43], s64 offen nt lds
    s_add_u32 s64, s33, 147456
    s_add_u32 m0, s34, 3072
    s_nop 0
    buffer_load_dwordx4 v33, s[40:43], s64 offen nt lds
    s_waitcnt vmcnt(4)
    s_branch wd_6
wi_5:
    s_waitcnt vmcnt(0)
wd_6:
    v_mov_b32 v44, v16
    s_cmp_eq_u32 s56, 3
    s_cselect_b32 s68, 1, 0
L_ln:
    v_lshlrev_b32 v96, 16, v8
    v_and_b32 v97, 0xffff0000, v8
    v_lshlrev_b32 v98, 16, v9
    v_and_b32 v99, 0xffff0000, v9
    v_lshlrev_b32 v100, 16, v10
    v_and_b32 v101, 0xffff0000, v10
    v_lshlrev_b32 v102, 16, v11
    v_and_b32 v103, 0xffff0000, v11
    v_readfirstlane_b32 s64, v96
    s_nop 1
    v_subrev_f32 v72, s64, v96
    v_subrev_f32 v73, s64, v97
    v_subrev_f32 v74, s64, v98
    v_subrev_f32 v75, s64, v99
    v_subrev_f32 v76, s64, v100
    v_subrev_f32 v77, s64, v101
    v_subrev_f32 v78, s64, v102
    v_subrev_f32 v79, s64, v103
    v_add_f32 v80, v72, v73
    v_mul_f32 v81, v72, v72
    v_fmac_f32 v81, v73, v73
    v_add_f32 v80, v80, v74
    v_fmac_f32 v81, v74, v74
    v_add_f32 v80, v80, v75
    v_fmac_f32 v81, v75, v75
    v_add_f32 v80, v80, v76
    v_fmac_f32 v81, v76, v76
    v_add_f32 v80, v80, v77
    v_fmac_f32 v81, v77, v77
    v_add_f32 v80, v80, v78
    v_fmac_f32 v81, v78, v78
    v_add_f32 v80, v80, v79
    v_fmac_f32 v81, v79, v79
    s_nop 0
    v_add_f32_dpp v80, v80, v80 row_ror:8 row_mask:0xf bank_mask:0xf
    v_add_f32_dpp v81, v81, v81 row_ror:8 row_mask:0xf bank_mask:0xf
    s_nop 0
    v_add_f32_dpp v80, v80, v80 row_ror:4 row_mask:0xf bank_mask:0xf
    v_add_f32_dpp v81, v81, v81 row_ror:4 row_mask:0xf bank_mask:0xf
    s_nop 0
    v_add_f32_dpp v80, v80, v80 row_ror:2 row_mask:0xf bank_mask:0xf
    v_add_f32_dpp v81, v81, v81 row_ror:2 row_mask:0xf bank_mask:0xf
    s_nop 0
    v_add_f32_dpp v80, v80, v80 row_ror:1 row_mask:0xf bank_mask:0xf
    v_add_f32_dpp v81, v81, v81 row_ror:1 row_mask:0xf bank_mask:0xf
    s_nop 0
    v_add_f32_dpp v80, v80, v80 row_bcast:15 row_mask:0xa bank_mask:0xf
    v_add_f32_dpp v81, v81, v81 row_bcast:15 row_mask:0xa bank_mask:0xf
    s_nop 0
    v_add_f32_dpp v80, v80, v80 row_bcast:31 row_mask:0xc bank_mask:0xf
    v_add_f32_dpp v81, v81, v81 row_bcast:31 row_mask:0xc bank_mask:0xf
    v_readlane_b32 s65, v80, 63
    v_readlane_b32 s66, v81, 63
    v_mov_b32 v72, 0x3b000000
    v_mul_f32 v73, s65, v72
    v_mul_f32 v74, s66, v72
    v_fma_f32 v74, -v73, v73, v74
    v_max_f32 v74, 0, v74
    v_add_f32 v73, s64, v73
    v_cvt_pk_bf16_f32 v73, 0, v73
    v_cvt_pk_bf16_f32 v74, 0, v74
    v_add_f32 v74, 0x3727c5ac, v74
    v_cvt_pk_bf16_f32 v74, 0, v74
    v_sqrt_f32 v74, v74
    v_sub_f32 v96, v96, v73
    v_sub_f32 v97, v97, v73
    v_sub_f32 v98, v98, v73
    v_sub_f32 v99, v99, v73
    v_sub_f32 v100, v100, v73
    v_sub_f32 v101, v101, v73
    v_sub_f32 v102, v102, v73
    v_sub_f32 v103, v103, v73
    v_cvt_pk_bf16_f32 v74, 0, v74
    v_rcp_f32 v74, v74
    v_cvt_pk_bf16_f32 v96, 0, v96
    v_cvt_pk_bf16_f32 v97, 0, v97
    v_cvt_pk_bf16_f32 v98, 0, v98
    v_cvt_pk_bf16_f32 v99, 0, v99
    v_cvt_pk_bf16_f32 v100, 0, v100
    v_cvt_pk_bf16_f32 v101, 0, v101
    v_cvt_pk_bf16_f32 v102, 0, v102
    v_cvt_pk_bf16_f32 v103, 0, v103
    v_mul_f32 v96, v96, v74
    v_mul_f32 v97, v97, v74
    v_mul_f32 v98, v98, v74
    v_mul_f32 v99, v99, v74
    v_mul_f32 v100, v100, v74
    v_mul_f32 v101, v101, v74
    v_mul_f32 v102, v102, v74
    v_mul_f32 v103, v103, v74
    v_cvt_pk_bf16_f32 v84, v96, v97
    v_cvt_pk_bf16_f32 v85, v98, v99
    v_cvt_pk_bf16_f32 v86, v100, v101
    v_cvt_pk_bf16_f32 v87, v102, v103
    ds_write_b128 v44, v[84:87] offset:32768
    v_mov_b32 v8, v40
    v_mov_b32 v9, v41
    v_mov_b32 v10, v42
    v_mov_b32 v11, v43
    v_lshlrev_b32 v44, 4, v0
    s_sub_u32 s68, s68, 1
    s_cbranch_scc0 L_ln
    s_waitcnt lgkmcnt(0)
    s_mul_i32 s57, s57, 0x9e3779b1
    s_add_u32 s57, s57, 0x7f4a7c15
    s_and_b32 s58, s57, 0xffff
    s_lshr_b32 s59, s57, 16
    s_getreg_b32 s28, hwreg(HW_REG_XCC_ID)
    s_not_b32 s67, s57
    s_xor_b32 s28, s67, s28
    v_bfe_u32 v12, s57, 0, 8
    v_bfe_u32 v13, s57, 8, 8
    v_bfe_u32 v14, s57, 16, 8
    v_bfe_u32 v15, s57, 24, 8
    s_cmp_lt_u32 s56, 4
    s_cbranch_scc1 L_svc3
    s_mov_b32 s14, 4194304
    s_mov_b32 s15, 0x00020000
    s_lshr_b32 s60, s55, 2
    s_and_b32 s61, s54, 3
    v_lshlrev_b32 v29, 13, v2
    s_and_b32 s69, s56, 3
    s_lshl_b32 s67, s61, 20
    s_lshl_b32 s68, s69, 18
    s_add_u32 s67, s67, s68
    s_lshl_b32 s68, s60, 8
    s_add_u32 s67, s67, s68
    s_lshl_b32 s68, s69, 13
    v_lshlrev_b32 v30, 1, v2
    v_xor_b32 v30, v30, v1
    v_lshl_add_u32 v30, v30, 4, v29
    v_xor_b32 v31, 128, v30
    s_barrier
    s_add_u32 s64, s67, 0
    s_add_u32 m0, s68, 98304
    s_nop 0
    buffer_load_dwordx4 v30, s[12:15], s64 offen nt lds
    s_add_u32 s64, s67, 32768
    s_add_u32 m0, s68, 99328
    s_nop 0
    buffer_load_dwordx4 v30, s[12:15], s64 offen nt lds
    s_add_u32 s64, s67, 65536
    s_add_u32 m0, s68, 100352
    s_nop 0
    buffer_load_dwordx4 v31, s[12:15], s64 offen nt lds
    s_add_u32 s64, s67, 98304
    s_add_u32 m0, s68, 101376
    s_nop 0
    buffer_load_dwordx4 v31, s[12:15], s64 offen nt lds
    s_add_u32 s64, s67, 131072
    s_add_u32 m0, s68, 102400
    s_nop 0
    buffer_load_dwordx4 v30, s[12:15], s64 offen nt lds
    s_add_u32 s64, s67, 163840
    s_add_u32 m0, s68, 103424
    s_nop 0
    buffer_load_dwordx4 v30, s[12:15], s64 offen nt lds
    s_add_u32 s64, s67, 196608
    s_add_u32 m0, s68, 104448
    s_nop 0
    buffer_load_dwordx4 v31, s[12:15], s64 offen nt lds
    s_add_u32 s64, s67, 229376
    s_add_u32 m0, s68, 105472
    s_nop 0
    buffer_load_dwordx4 v31, s[12:15], s64 offen nt lds
    v_xor_b32 v30, v1, v2
    v_lshl_add_u32 v30, v30, 4, v29
    v_xor_b32 v31, 0, v30
    s_add_u32 s64, s67, 0
    s_add_u32 m0, s68, 0
    s_nop 0
    buffer_load_dwordx4 v31, s[16:19], s64 offen nt lds
    s_add_u32 s64, s67, 32768
    s_add_u32 m0, s68, 1024
    s_nop 0
    buffer_load_dwordx4 v31, s[16:19], s64 offen nt lds
    v_xor_b32 v31, 64, v30
    s_add_u32 s64, s67, 65536
    s_add_u32 m0, s68, 2048
    s_nop 0
    buffer_load_dwordx4 v31, s[16:19], s64 offen nt lds
    s_add_u32 s64, s67, 98304
    s_add_u32 m0, s68, 3072
    s_nop 0
    buffer_load_dwordx4 v31, s[16:19], s64 offen nt lds
    v_xor_b32 v31, 128, v30
    s_add_u32 s64, s67, 131072
    s_add_u32 m0, s68, 4096
    s_nop 0
    buffer_load_dwordx4 v31, s[16:19], s64 offen nt lds
    s_add_u32 s64, s67, 163840
    s_add_u32 m0, s68, 5120
    s_nop 0
    buffer_load_dwordx4 v31, s[16:19], s64 offen nt lds
    v_xor_b32 v31, 192, v30
    s_add_u32 s64, s67, 196608
    s_add_u32 m0, s68, 6144
    s_nop 0
    buffer_load_dwordx4 v31, s[16:19], s64 offen nt lds
    s_add_u32 s64, s67, 229376
    s_add_u32 m0, s68, 7168
    s_nop 0
    buffer_load_dwordx4 v31, s[16:19], s64 offen nt lds
    s_branch L_svc4
L_svc3:
    v_mov_b32 v68, -1
    v_mov_b32 v69, -1
    v_mov_b32 v70, -1
    v_mov_b32 v71, -1
    s_mul_i32 s67, s55, 2816
    s_add_u32 s67, s67, 539648
    v_min_u32 v30, 3824, v16
    buffer_store_dwordx4 v[68:71], v30, s[48:51], s67 offen sc1
    s_cmp_lg_u32 s56, 1
    s_cbranch_scc1 wi_7
    v_mov_b32 v66, s57
    v_mov_b32 v67, s28
    s_lshl_b32 s68, s55, 7
    s_add_u32 s68, s68, 102400
    s_mov_b32 exec_lo, 0xffff
    s_mov_b32 exec_hi, 0x0
    buffer_store_dwordx2 v[66:67], v17, s[48:51], s68 offen sc1
    s_mov_b64 exec, -1
wi_7:
    s_and_b32 s66, s56, 1
    s_lshl_b32 s66, s66, 2
    s_add_u32 s66, s66, s61
    s_lshl_b32 s66, s66, 4
    s_and_b32 s67, s60, 15
    s_add_u32 s66, s66, s67
    s_lshl_b32 s66, s66, 12
    s_add_u32 s66, s66, 7062528
    s_barrier
    s_cmp_eq_u32 s56, 3
    s_cbranch_scc1 L_svc4
    s_mov_b32 s63, 60000
hw_9:
    s_load_dword s67, s[48:49], s66 glc
    s_waitcnt lgkmcnt(0)
    s_cmp_eq_u32 s67, s57
    s_cbranch_scc1 hd_10
    s_sub_u32 s63, s63, 1
    s_cbranch_scc0 hw_9
hd_10:
L_svc4:
    s_waitcnt lgkmcnt(0)
    s_barrier
    buffer_load_dwordx4 v[68:71], v26, s[48:51], s31 offen sc1
    buffer_load_dwordx4 v[76:79], v27, s[48:51], s31 offen sc1
    buffer_load_dwordx4 v[64:67], v26, s[48:51], s30 offen sc1
    buffer_load_dwordx4 v[72:75], v27, s[48:51], s30 offen sc1
    buffer_load_dwordx2 v[90:91], v34, s[48:51], s29 offen sc1
    s_cmp_lt_u32 s56, 4
    s_cbranch_scc1 wi_11
    s_waitcnt vmcnt(13)
wi_11:
    s_barrier
    ds_read_b32 v84, v21 offset:32768
    v_add_u32 v30, 98304, v36
    ds_read_b64_tr_b16 v[96:97], v30 offset:0
    ds_read_b64_tr_b16 v[98:99], v30 offset:1024
    ds_read_b64_tr_b16 v[100:101], v30 offset:8192
    ds_read_b64_tr_b16 v[102:103], v30 offset:9216
    ds_read_b64_tr_b16 v[104:105], v30 offset:16384
    ds_read_b64_tr_b16 v[106:107], v30 offset:17408
    ds_read_b64_tr_b16 v[108:109], v30 offset:24576
    ds_read_b64_tr_b16 v[110:111], v30 offset:25600
    s_lshl_b32 s66, s55, 12
    s_lshl_b32 s67, s56, 9
    s_add_u32 s66, s66, s67
    s_add_u32 s66, s66, 1818624
    s_mov_b32 s68, 0xff
    s_waitcnt lgkmcnt(8)
    v_lshlrev_b32 v88, 16, v84
    v_and_b32 v89, 0xffff0000, v84
    s_mov_b32 s63, 60000
    s_waitcnt vmcnt(0)
poll_13:
    v_xor_b32 v64, v64, v12
    v_xor_b32 v65, v65, v13
    v_xor_b32 v66, v66, v14
    v_xor_b32 v67, v67, v15
    v_xor_b32 v68, v68, v12
    v_xor_b32 v69, v69, v13
    v_xor_b32 v70, v70, v14
    v_xor_b32 v71, v71, v15
    v_xor_b32 v72, v72, v12
    v_xor_b32 v73, v73, v13
    v_xor_b32 v74, v74, v14
    v_xor_b32 v75, v75, v15
    v_xor_b32 v76, v76, v12
    v_xor_b32 v77, v77, v13
    v_xor_b32 v78, v78, v14
    v_xor_b32 v79, v79, v15
    v_or3_b32 v80, v64, v65, v66
    v_or3_b32 v81, v67, v68, v69
    v_or3_b32 v80, v80, v70, v71
    v_or3_b32 v81, v81, v72, v73
    v_or3_b32 v80, v80, v74, v75
    v_or3_b32 v81, v81, v76, v77
    v_or3_b32 v80, v80, v78, v79
    v_or_b32 v80, v80, v81
    v_and_b32 v80, 0xff, v80
    v_cmp_ne_u32 vcc, 0, v80
    s_cbranch_vccz pdone_14
    s_sleep 1
    buffer_load_dwordx4 v[68:71], v26, s[48:51], s31 offen sc1
    buffer_load_dwordx4 v[76:79], v27, s[48:51], s31 offen sc1
    buffer_load_dwordx4 v[64:67], v26, s[48:51], s30 offen sc1
    buffer_load_dwordx4 v[72:75], v27, s[48:51], s30 offen sc1
    s_sub_u32 s63, s63, 1
    s_waitcnt vmcnt(0)
    s_cbranch_scc0 poll_13
pdone_14:
    v_add_f32 v68, v68, v76
    v_add_f32 v69, v69, v77
    v_add_f32 v70, v70, v78
    v_add_f32 v71, v71, v79
    v_add_f32 v64, v64, v72
    v_add_f32 v65, v65, v73
    v_add_f32 v66, v66, v74
    v_add_f32 v67, v67, v75
    v_permlane32_swap_b32 v68, v70
    v_permlane32_swap_b32 v69, v71
    v_permlane32_swap_b32 v64, v66
    v_permlane32_swap_b32 v65, v67
    v_add_f32 v68, v68, v70
    v_add_f32 v69, v69, v71
    v_add_f32 v64, v64, v66
    v_add_f32 v65, v65, v67
    v_cvt_pk_bf16_f32 v68, 0, v68
    v_cvt_pk_bf16_f32 v69, 0, v69
    v_cvt_pk_bf16_f32 v64, 0, v64
    v_cvt_pk_bf16_f32 v65, 0, v65
    v_add_f32 v68, 1.0, v68
    v_add_f32 v69, 1.0, v69
    v_cvt_pk_bf16_f32 v68, 0, v68
    v_cvt_pk_bf16_f32 v69, 0, v69
    v_mul_f32 v68, v68, v88
    v_mul_f32 v69, v69, v89
    v_cvt_pk_bf16_f32 v68, 0, v68
    v_cvt_pk_bf16_f32 v69, 0, v69
    v_add_f32 v68, v68, v64
    v_add_f32 v69, v69, v65
    v_cvt_pk_bf16_f32 v68, v68, v69
    ds_write_b32 v20, v68 offset:49152
    s_waitcnt lgkmcnt(0)
    s_barrier
    ds_read_b128 v[64:67], v22 offset:49152
    ds_read_b128 v[68:71], v22 offset:49280
    v_xor_b32 v90, s57, v90
    v_xor_b32 v91, s28, v91
    v_or_b32 v90, v90, v91
    v_cmp_ne_u32 vcc, 0, v90
    s_lshl_b32 s64, s60, 14
    s_add_u32 s64, s64, s67
    s_add_u32 s64, s64, 1818624
    s_add_u32 s65, s64, 8192
    s_waitcnt lgkmcnt(1)
    v_mfma_f32_16x16x32_bf16 v[112:115], v[96:99], v[64:67], 0
    v_mfma_f32_16x16x32_bf16 v[116:119], v[100:103], v[64:67], 0
    s_waitcnt lgkmcnt(0)
    v_mfma_f32_16x16x32_bf16 v[112:115], v[104:107], v[68:71], v[112:115]
    v_mfma_f32_16x16x32_bf16 v[116:119], v[108:111], v[68:71], v[116:119]
    s_nop 7
    v_add_f32_dpp v112, v116, v112 row_ror:8 row_mask:0xf bank_mask:0xf
    v_add_f32_dpp v113, v117, v113 row_ror:8 row_mask:0xf bank_mask:0xf
    v_add_f32_dpp v114, v118, v114 row_ror:8 row_mask:0xf bank_mask:0xf
    v_add_f32_dpp v115, v119, v115 row_ror:8 row_mask:0xf bank_mask:0xf
    v_bfi_b32 v112, s68, v12, v112
    v_bfi_b32 v113, s68, v13, v113
    v_bfi_b32 v114, s68, v14, v114
    v_bfi_b32 v115, s68, v15, v115
    s_mov_b32 exec_lo, 0xff00ff
    s_mov_b32 exec_hi, 0xff00ff
    s_cbranch_vccnz far_15
    buffer_store_dwordx4 v[112:115], v23, s[48:51], s66 offen
    s_branch dn_16
far_15:
    buffer_store_dwordx4 v[112:115], v23, s[48:51], s66 offen sc1
dn_16:
    s_mov_b64 exec, -1
    s_cmp_ge_u32 s56, 4
    s_cbranch_scc1 wi_17
    v_lshrrev_b32 v40, 2, v1
    v_lshl_add_u32 v40, v40, 3, v38
    v_lshlrev_b32 v40, 8, v40
    s_lshl_b32 s69, s56, 13
    v_add_u32 v40, s69, v40
    v_xor_b32 v41, v1, v2
    v_lshlrev_b32 v30, 15, v19
    v_lshl_add_u32 v30, v2, 4, v30
    s_lshr_b32 s69, s60, 4
    s_lshl_b32 s69, s69, 14
    s_lshl_b32 s66, s61, 12
    s_add_u32 s69, s69, s66
    s_lshl_b32 s66, s56, 10
    s_add_u32 s69, s69, s66
    s_and_b32 s66, s60, 15
    s_lshl_b32 s66, s66, 6
    s_add_u32 s69, s69, s66
    s_add_u32 s69, s69, 196608
    v_xor_b32 v42, 0, v41
    v_lshl_add_u32 v42, v42, 4, v40
    ds_read_b128 v[128:131], v42 offset:0
    ds_read_b128 v[144:147], v42 offset:1024
    v_xor_b32 v42, 4, v41
    v_lshl_add_u32 v42, v42, 4, v40
    ds_read_b128 v[132:135], v42 offset:0
    ds_read_b128 v[148:151], v42 offset:1024
    v_xor_b32 v42, 8, v41
    v_lshl_add_u32 v42, v42, 4, v40
    ds_read_b128 v[136:139], v42 offset:0
    ds_read_b128 v[152:155], v42 offset:1024
    v_xor_b32 v42, 12, v41
    v_lshl_add_u32 v42, v42, 4, v40
    ds_read_b128 v[140:143], v42 offset:0
    ds_read_b128 v[156:159], v42 offset:1024
    s_branch wd_18
wi_17:
    v_lshlrev_b32 v40, 4, v0
    ds_read_b128 v[128:131], v40 offset:45056
    ds_read_b128 v[132:135], v40 offset:46080
    s_and_b32 s69, s56, 3
    s_lshl_b32 s66, s69, 5
    v_xor_b32 v41, s66, v5
    v_add_u32 v41, 139264, v41
    s_lshl_b32 s69, s69, 9
    s_lshl_b32 s66, s55, 12
    s_add_u32 s69, s69, s66
    s_add_u32 s69, s69, 2342912
wd_18:
    s_mov_b32 s63, 60000
    buffer_load_dwordx4 v[64:67], v39, s[48:51], s64 offen sc1
    buffer_load_dwordx4 v[68:71], v39, s[48:51], s65 offen sc1
    s_waitcnt vmcnt(0)
poll_19:
    v_xor_b32 v64, v64, v12
    v_xor_b32 v65, v65, v13
    v_xor_b32 v66, v66, v14
    v_xor_b32 v67, v67, v15
    v_xor_b32 v68, v68, v12
    v_xor_b32 v69, v69, v13
    v_xor_b32 v70, v70, v14
    v_xor_b32 v71, v71, v15
    v_or3_b32 v72, v64, v65, v66
    v_or3_b32 v73, v67, v68, v69
    v_or3_b32 v72, v72, v70, v71
    v_or_b32 v72, v72, v73
    v_and_b32 v72, 0xff, v72
    v_cmp_ne_u32 vcc, 0, v72
    s_cbranch_vccz pdone_20
    buffer_load_dwordx4 v[64:67], v39, s[48:51], s64 offen sc1
    buffer_load_dwordx4 v[68:71], v39, s[48:51], s65 offen sc1
    s_sub_u32 s63, s63, 1
    s_waitcnt vmcnt(0)
    s_cbranch_scc0 poll_19
pdone_20:
    v_add_f32 v64, v64, v68
    v_add_f32 v65, v65, v69
    v_add_f32 v66, v66, v70
    v_add_f32 v67, v67, v71
    s_nop 0
    v_permlane32_swap_b32 v64, v66
    v_permlane32_swap_b32 v65, v67
    v_add_f32 v64, v64, v66
    v_add_f32 v65, v65, v67
    v_cvt_pk_bf16_f32 v64, v64, v65
    ds_write_b32 v20, v64 offset:53248
    s_waitcnt lgkmcnt(0)
    s_barrier
    s_cmp_ge_u32 s56, 4
    s_cbranch_scc1 wi_21
    ds_read_b128 v[64:67], v22 offset:53248
    ds_read_b128 v[68:71], v22 offset:53376
    s_waitcnt lgkmcnt(0)
    v_mfma_f32_16x16x32_bf16 v[96:99], v[128:131], v[64:67], 0
    v_mfma_f32_16x16x32_bf16 v[100:103], v[132:135], v[64:67], 0
    v_mfma_f32_16x16x32_bf16 v[104:107], v[144:147], v[64:67], 0
    v_mfma_f32_16x16x32_bf16 v[108:111], v[148:151], v[64:67], 0
    v_mfma_f32_16x16x32_bf16 v[96:99], v[136:139], v[68:71], v[96:99]
    v_mfma_f32_16x16x32_bf16 v[100:103], v[140:143], v[68:71], v[100:103]
    v_mfma_f32_16x16x32_bf16 v[104:107], v[152:155], v[68:71], v[104:107]
    v_mfma_f32_16x16x32_bf16 v[108:111], v[156:159], v[68:71], v[108:111]
    s_nop 5
    v_add_f32_dpp v96, v100, v96 row_ror:8 row_mask:0xf bank_mask:0xf
    v_add_f32_dpp v97, v101, v97 row_ror:8 row_mask:0xf bank_mask:0xf
    v_add_f32_dpp v98, v102, v98 row_ror:8 row_mask:0xf bank_mask:0xf
    v_add_f32_dpp v99, v103, v99 row_ror:8 row_mask:0xf bank_mask:0xf
    v_add_f32_dpp v104, v108, v104 row_ror:8 row_mask:0xf bank_mask:0xf
    v_add_f32_dpp v105, v109, v105 row_ror:8 row_mask:0xf bank_mask:0xf
    v_add_f32_dpp v106, v110, v106 row_ror:8 row_mask:0xf bank_mask:0xf
    v_add_f32_dpp v107, v111, v107 row_ror:8 row_mask:0xf bank_mask:0xf
    v_cvt_pk_bf16_f32 v72, v96, v97
    v_cvt_pk_bf16_f32 v73, v98, v99
    v_cvt_pk_bf16_f32 v74, v104, v105
    v_cvt_pk_bf16_f32 v75, v106, v107
    s_mov_b32 exec_lo, 0xff00ff
    s_mov_b32 exec_hi, 0xff00ff
    buffer_store_dwordx4 v[72:75], v30, s[48:51], s69 offen sc1
    s_mov_b64 exec, -1
    s_waitcnt vmcnt(0)
    s_cmp_lg_u32 s56, 3
    s_cbranch_scc1 noflg_23
    v_mov_b32 v76, s57
    v_not_b32 v77, v76
    s_lshl_b32 s67, s55, 7
    s_add_u32 s67, s67, 524288
    v_lshlrev_b32 v78, 3, v0
    s_mov_b32 exec_lo, 0xffff
    s_mov_b32 exec_hi, 0x0
    buffer_store_dwordx2 v[76:77], v78, s[48:51], s67 offen sc1
    s_mov_b64 exec, -1
noflg_23:
    s_branch wd_22
wi_21:
    ds_read_b64_tr_b16 v[64:65], v41 offset:0
    ds_read_b64_tr_b16 v[66:67], v41 offset:512
    ds_read_b64_tr_b16 v[68:69], v41 offset:4096
    ds_read_b64_tr_b16 v[70:71], v41 offset:4608
    ds_read_b64_tr_b16 v[72:73], v41 offset:8192
    ds_read_b64_tr_b16 v[74:75], v41 offset:8704
    ds_read_b64_tr_b16 v[76:77], v41 offset:12288
    ds_read_b64_tr_b16 v[78:79], v41 offset:12800
    s_waitcnt lgkmcnt(6)
    v_mfma_f32_16x16x32_bf16 v[96:99], v[64:67], v[128:131], 0
    s_waitcnt lgkmcnt(4)
    v_mfma_f32_16x16x32_bf16 v[100:103], v[68:71], v[128:131], 0
    s_waitcnt lgkmcnt(2)
    v_mfma_f32_16x16x32_bf16 v[96:99], v[72:75], v[132:135], v[96:99]
    s_waitcnt lgkmcnt(0)
    v_mfma_f32_16x16x32_bf16 v[100:103], v[76:79], v[132:135], v[100:103]
    s_nop 7
    v_add_f32_dpp v96, v100, v96 row_ror:8 row_mask:0xf bank_mask:0xf
    v_add_f32_dpp v97, v101, v97 row_ror:8 row_mask:0xf bank_mask:0xf
    v_add_f32_dpp v98, v102, v98 row_ror:8 row_mask:0xf bank_mask:0xf
    v_add_f32_dpp v99, v103, v99 row_ror:8 row_mask:0xf bank_mask:0xf
    v_bfi_b32 v96, s68, v12, v96
    v_bfi_b32 v97, s68, v13, v97
    v_bfi_b32 v98, s68, v14, v98
    v_bfi_b32 v99, s68, v15, v99
    s_mov_b32 exec_lo, 0xff00ff
    s_mov_b32 exec_hi, 0xff00ff
    buffer_store_dwordx4 v[96:99], v23, s[48:51], s69 offen sc1
    s_mov_b64 exec, -1
wd_22:
    v_and_b32 v30, 1, v0
    v_lshlrev_b32 v30, 7, v30
    s_lshl_b32 s69, s52, 11
    s_lshl_b32 s66, s56, 8
    s_add_u32 s69, s69, s66
    s_add_u32 s69, s69, 102400
    v_bfe_u32 v37, v1, 2, 1
    v_lshlrev_b32 v37, 12, v37
    v_lshl_add_u32 v37, v38, 5, v37
    v_lshl_add_u32 v37, v2, 3, v37
    s_lshl_b32 s32, s60, 13
    s_lshl_b32 s66, s61, 10
    s_add_u32 s32, s32, s66
    s_lshl_b32 s66, s56, 7
    s_add_u32 s32, s32, s66
    s_add_u32 s32, s32, 540672
    s_lshl_b32 s64, s60, 14
    s_lshl_b32 s65, s61, 9
    s_add_u32 s64, s64, s65
    s_add_u32 s64, s64, 2342912
    s_add_u32 s65, s64, 8192
    v_lshlrev_b32 v119, 7, v0
    s_lshl_b32 s67, s55, 18
    s_mul_i32 s66, s56, 8192
    s_add_u32 s67, s67, s66
    s_add_u32 s67, s67, 131072
    s_barrier
    s_cmp_lg_u32 s56, 5
    s_cbranch_scc1 wi_24
    buffer_load_dwordx4 v[64:67], v39, s[48:51], s64 offen sc1
    buffer_load_dwordx4 v[68:71], v39, s[48:51], s65 offen sc1
wi_24:
    buffer_load_dwordx2 v[90:91], v30, s[48:51], s69 offen sc1
    buffer_load_dwordx2 v[92:93], v37, s[48:51], s32 offen sc1
    buffer_load_dword v118, v119, s[8:11], s67 offen
    s_add_u32 s67, s67, 65536
    s_barrier
    buffer_load_dword v117, v119, s[8:11], s67 offen
    s_add_u32 s67, s67, 65536
    s_barrier
    s_waitcnt vmcnt(3)
    v_xor_b32 v90, s57, v90
    v_xor_b32 v91, s28, v91
    v_or_b32 v90, v90, v91
    v_and_b32 v91, 1, v0
    s_lshl_b32 s66, s56, 3
    s_add_u32 s66, s66, 160000
    v_lshl_add_u32 v91, v91, 2, s66
    ds_write_b32 v91, v90
    s_cmp_lg_u32 s56, 5
    s_cbranch_scc1 wi_26
    s_mov_b32 s63, 60000
poll_28:
    v_xor_b32 v64, v64, v12
    v_xor_b32 v65, v65, v13
    v_xor_b32 v66, v66, v14
    v_xor_b32 v67, v67, v15
    v_xor_b32 v68, v68, v12
    v_xor_b32 v69, v69, v13
    v_xor_b32 v70, v70, v14
    v_xor_b32 v71, v71, v15
    v_or3_b32 v72, v64, v65, v66
    v_or3_b32 v73, v67, v68, v69
    v_or3_b32 v72, v72, v70, v71
    v_or_b32 v72, v72, v73
    v_and_b32 v72, 0xff, v72
    v_cmp_ne_u32 vcc, 0, v72
    s_cbranch_vccz pdone_29
    s_sleep 2
    buffer_load_dwordx4 v[64:67], v39, s[48:51], s64 offen sc1
    buffer_load_dwordx4 v[68:71], v39, s[48:51], s65 offen sc1
    s_sub_u32 s63, s63, 1
    s_waitcnt vmcnt(0)
    s_cbranch_scc0 poll_28
pdone_29:
    v_add_f32 v64, v64, v68
    v_add_f32 v65, v65, v69
    v_add_f32 v66, v66, v70
    v_add_f32 v67, v67, v71
    s_nop 0
    v_permlane32_swap_b32 v64, v66
    v_permlane32_swap_b32 v65, v67
    v_add_f32 v64, v64, v66
    v_add_f32 v65, v65, v67
    s_lshr_b32 s66, s55, 5
    s_lshl_b32 s65, s66, 13
    s_and_b32 s67, s55, 31
    s_lshl_b32 s67, s67, 5
    s_add_u32 s65, s65, s67
    s_add_u32 s65, s65, 458752
    s_cmp_eq_u32 s66, 2
    s_cselect_b32 s66, 1.0, 0
    v_cvt_pk_bf16_f32 v64, 0, v64
    v_cvt_pk_bf16_f32 v65, 0, v65
    v_add_f32 v64, s66, v64
    v_add_f32 v65, s66, v65
    v_cvt_pk_bf16_f32 v64, v64, v65
    buffer_store_dword v64, v24, s[48:51], s65 offen sc1
wi_26:
    v_and_b32 v28, 1, v2
    v_lshlrev_b32 v28, 18, v28
    v_lshrrev_b32 v29, 1, v2
    v_lshl_add_u32 v28, v29, 17, v28
    v_lshlrev_b32 v29, 1, v2
    v_xor_b32 v29, v29, v1
    v_lshl_add_u32 v28, v29, 4, v28
    v_xor_b32 v29, 128, v28
    s_lshl_b32 s65, s61, 20
    s_mul_i32 s66, s56, 16384
    s_add_u32 s65, s65, s66
    s_lshl_b32 s66, s60, 8
    s_add_u32 s65, s65, s66
    s_mul_i32 s66, s56, 4096
    s_add_u32 s67, s65, 0
    s_add_u32 s68, s66, 0
    s_mov_b32 m0, s68
    s_nop 0
    buffer_load_dwordx4 v28, s[20:23], s67 offen nt lds
    s_add_u32 s67, s65, 524288
    s_add_u32 s68, s66, 1024
    s_mov_b32 m0, s68
    s_nop 0
    buffer_load_dwordx4 v28, s[20:23], s67 offen nt lds
    s_add_u32 s67, s65, 8192
    s_add_u32 s68, s66, 2048
    s_mov_b32 m0, s68
    s_nop 0
    buffer_load_dwordx4 v29, s[20:23], s67 offen nt lds
    s_add_u32 s67, s65, 532480
    s_add_u32 s68, s66, 3072
    s_mov_b32 m0, s68
    s_nop 0
    buffer_load_dwordx4 v29, s[20:23], s67 offen nt lds
    s_barrier
    s_lshl_b32 s62, s54, 2
    s_add_u32 s62, s62, s56
    s_and_b32 s62, s62, 7
    v_lshrrev_b32 v17, 3, v0
    v_lshlrev_b32 v17, 10, v17
    v_add_u32 v17, v17, v95
    v_xor_b32 v18, 64, v17
    s_lshl_b32 s65, s52, 19
    s_lshl_b32 s66, s62, 16
    s_add_u32 s65, s65, s66
    s_lshr_b32 s66, s54, 1
    s_xor_b32 s66, s66, 4
    s_lshl_b32 s66, s66, 7
    s_add_u32 s65, s65, s66
    s_lshl_b32 s66, s56, 13
    s_add_u32 s66, s66, 32768
    v_add_u32 v5, s66, v5
    s_mov_b32 m0, s66
    s_nop 0
    buffer_load_dwordx4 v17, s[24:27], s65 offen  lds
    s_add_u32 s65, s65, 8192
    s_add_u32 s66, s66, 1024
    s_mov_b32 m0, s66
    s_nop 0
    buffer_load_dwordx4 v18, s[24:27], s65 offen  lds
    s_add_u32 s65, s65, 8192
    s_add_u32 s66, s66, 1024
    s_mov_b32 m0, s66
    s_nop 0
    buffer_load_dwordx4 v17, s[24:27], s65 offen  lds
    s_add_u32 s65, s65, 8192
    s_add_u32 s66, s66, 1024
    s_mov_b32 m0, s66
    s_nop 0
    buffer_load_dwordx4 v18, s[24:27], s65 offen  lds
    s_add_u32 s65, s65, 8192
    s_add_u32 s66, s66, 1024
    s_mov_b32 m0, s66
    s_nop 0
    buffer_load_dwordx4 v17, s[24:27], s65 offen  lds
    s_add_u32 s65, s65, 8192
    s_add_u32 s66, s66, 1024
    s_mov_b32 m0, s66
    s_nop 0
    buffer_load_dwordx4 v18, s[24:27], s65 offen  lds
    s_add_u32 s65, s65, 8192
    s_add_u32 s66, s66, 1024
    s_mov_b32 m0, s66
    s_nop 0
    buffer_load_dwordx4 v17, s[24:27], s65 offen  lds
    s_add_u32 s65, s65, 8192
    s_add_u32 s66, s66, 1024
    s_mov_b32 m0, s66
    s_nop 0
    buffer_load_dwordx4 v18, s[24:27], s65 offen  lds
    v_and_b32 v38, 3, v1
    v_lshlrev_b32 v32, 10, v2
    v_lshl_add_u32 v32, v1, 4, v32
    s_lshl_b32 s64, s55, 15
    s_lshl_b32 s65, s56, 12
    s_add_u32 s64, s64, s65
    s_add_u32 s64, s64, 2867200
    s_lshl_b32 s66, s56, 8
    s_add_u32 s66, s66, 155648
    v_and_b32 v33, 1, v1
    v_lshlrev_b32 v33, 5, v33
    v_lshl_add_u32 v33, v2, 3, v33
    v_add_u32 v33, s66, v33
    v_lshlrev_b32 v44, 5, v2
    v_lshl_add_u32 v44, v1, 1, v44
    v_add_u32 v44, s66, v44
    s_mul_i32 s66, s56, 272
    s_add_u32 s66, s66, 157696
    v_lshlrev_b32 v34, 4, v1
    v_add_u32 v34, s66, v34
    v_mul_u32_u24 v35, 272, v19
    v_lshl_add_u32 v35, v2, 4, v35
    v_add_u32 v35, 157696, v35
    v_lshlrev_b32 v49, 3, v38
    v_lshrrev_b32 v49, v49, s57
    v_bfe_u32 v8, v49, 0, 1
    v_bfe_u32 v48, v49, 1, 1
    v_lshl_or_b32 v8, v48, 16, v8
    v_bfe_u32 v9, v49, 2, 1
    v_bfe_u32 v48, v49, 3, 1
    v_lshl_or_b32 v9, v48, 16, v9
    v_bfe_u32 v10, v49, 4, 1
    v_bfe_u32 v48, v49, 5, 1
    v_lshl_or_b32 v10, v48, 16, v10
    v_bfe_u32 v11, v49, 6, 1
    v_bfe_u32 v48, v49, 7, 1
    v_lshl_or_b32 v11, v48, 16, v11
    v_lshlrev_b32 v39, 8, v1
    s_lshl_b32 s66, s56, 12
    s_lshl_b32 s67, s60, 3
    s_add_u32 s66, s66, s67
    s_add_u32 s66, s66, 491520
    v_lshrrev_b32 v56, 2, v1
    v_lshlrev_b32 v57, 6, v56
    v_lshlrev_b32 v56, 10, v56
    v_lshl_add_u32 v56, v38, 5, v56
    v_lshrrev_b32 v58, 1, v2
    v_lshl_add_u32 v56, v58, 7, v56
    v_and_b32 v58, 1, v2
    v_lshl_add_u32 v56, v58, 4, v56
    s_and_b32 s69, s54, 1
    s_lshl_b32 s33, s52, 15
    s_lshr_b32 s68, s62, 1
    s_lshl_b32 s68, s68, 13
    s_add_u32 s33, s33, s68
    s_lshl_b32 s68, s69, 12
    s_add_u32 s33, s33, s68
    s_and_b32 s68, s62, 1
    s_lshl_b32 s68, s68, 9
    s_add_u32 s33, s33, s68
    s_add_u32 s33, s33, 540672
    v_mul_u32_u24 v58, 272, v38
    v_add_u32 v57, v57, v58
    v_lshl_add_u32 v57, v2, 4, v57
    s_mul_i32 s68, s56, 1088
    s_add_u32 s68, s68, 98304
    v_add_u32 v57, s68, v57
    v_lshlrev_b32 v58, 3, v3
    v_lshrrev_b32 v59, 5, v3
    v_lshl_add_u32 v58, v59, 4, v58
    v_add_u32 v58, 98304, v58
    v_lshrrev_b32 v59, 5, v3
    v_lshlrev_b32 v59, 13, v59
    v_and_b32 v60, 31, v3
    v_lshl_add_u32 v59, v60, 2, v59
    s_lshl_b32 s34, s69, 15
    s_lshl_b32 s68, s52, 10
    s_add_u32 s34, s34, s68
    s_lshr_b32 s68, s54, 1
    s_xor_b32 s68, s68, 4
    s_lshl_b32 s68, s68, 7
    s_add_u32 s34, s34, s68
    s_add_u32 s34, s34, 802816
    v_lshlrev_b32 v91, 2, v1
    v_add_u32 v91, 160000, v91
    s_waitcnt vmcnt(8) lgkmcnt(0)
    s_barrier
    ds_read_b32 v90, v91
    ds_read_b64_tr_b16 v[112:113], v36 offset:0
    ds_read_b64_tr_b16 v[114:115], v36 offset:1024
    ds_read_b64_tr_b16 v[116:117], v36 offset:8192
    ds_read_b64_tr_b16 v[118:119], v36 offset:9216
    ds_read_b64_tr_b16 v[120:121], v36 offset:16384
    ds_read_b64_tr_b16 v[122:123], v36 offset:17408
    ds_read_b64_tr_b16 v[124:125], v36 offset:24576
    ds_read_b64_tr_b16 v[126:127], v36 offset:25600
    s_waitcnt lgkmcnt(8)
    v_cmp_ne_u32 vcc, 0, v90
    s_or_b32 s29, vcc_lo, vcc_hi
    s_waitcnt vmcnt(4)
    buffer_load_dwordx2 v[40:41], v39, s[48:51], s66 offen sc1
    s_waitcnt vmcnt(0)
    v_xor_b32 v47, 0, v5
    ds_read_b64_tr_b16 v[192:193], v47 offset:0
    ds_read_b64_tr_b16 v[194:195], v47 offset:512
    ds_read_b64_tr_b16 v[208:209], v47 offset:4096
    ds_read_b64_tr_b16 v[210:211], v47 offset:4608
    v_xor_b32 v47, 32, v5
    ds_read_b64_tr_b16 v[196:197], v47 offset:0
    ds_read_b64_tr_b16 v[198:199], v47 offset:512
    ds_read_b64_tr_b16 v[212:213], v47 offset:4096
    ds_read_b64_tr_b16 v[214:215], v47 offset:4608
    v_xor_b32 v47, 64, v5
    ds_read_b64_tr_b16 v[200:201], v47 offset:0
    ds_read_b64_tr_b16 v[202:203], v47 offset:512
    ds_read_b64_tr_b16 v[216:217], v47 offset:4096
    ds_read_b64_tr_b16 v[218:219], v47 offset:4608
    v_xor_b32 v47, 96, v5
    ds_read_b64_tr_b16 v[204:205], v47 offset:0
    ds_read_b64_tr_b16 v[206:207], v47 offset:512
    ds_read_b64_tr_b16 v[220:221], v47 offset:4096
    ds_read_b64_tr_b16 v[222:223], v47 offset:4608
    v_max_u32 v47, v40, v41
    v_cmp_eq_u32 vcc, -1, v47
    s_cbranch_vccz gotst_30
    v_cmp_ne_u32 vcc, -1, v47
    s_cbranch_vccnz full_31
    v_mov_b32 v41, s54
    v_lshlrev_b32 v41, 8, v41
    s_mov_b32 s63, 60000
poll_32:
    buffer_load_dword v40, v41, s[48:51], s66 offen sc1
    s_waitcnt vmcnt(0)
    v_mov_b32 v47, v40
    v_cmp_eq_u32 vcc, -1, v47
    s_cbranch_vccz pdone_33
    s_sleep 4
    s_sub_u32 s63, s63, 1
    s_cbranch_scc0 poll_32
pdone_33:
    v_mov_b32 v40, -1
full_31:
    s_mov_b32 s63, 60000
poll_34:
    v_max_u32 v47, v40, v41
    v_cmp_eq_u32 vcc, -1, v47
    s_cbranch_vccz pdone_35
    s_mov_b64 exec, vcc
    buffer_load_dwordx2 v[40:41], v39, s[48:51], s66 offen sc1
    s_mov_b64 exec, -1
    s_waitcnt vmcnt(0)
    s_sub_u32 s63, s63, 1
    s_cbranch_scc0 poll_34
pdone_35:
gotst_30:
    buffer_load_dwordx4 v[64:67], v32, s[48:51], s64 offen offset:0 sc1
    buffer_load_dwordx4 v[68:71], v32, s[48:51], s64 offen offset:256 sc1
    buffer_load_dwordx4 v[72:75], v32, s[48:51], s64 offen offset:512 sc1
    buffer_load_dwordx4 v[76:79], v32, s[48:51], s64 offen offset:768 sc1
    v_mov_b32 v42, v40
    s_nop 1
    v_max_f32_dpp v42, v42, v42 row_ror:8 row_mask:0xf bank_mask:0xf
    s_nop 1
    v_max_f32_dpp v42, v42, v42 row_ror:4 row_mask:0xf bank_mask:0xf
    s_nop 1
    v_max_f32_dpp v42, v42, v42 row_ror:2 row_mask:0xf bank_mask:0xf
    s_nop 1
    v_max_f32_dpp v42, v42, v42 row_ror:1 row_mask:0xf bank_mask:0xf
    v_sub_f32 v40, v40, v42
    v_exp_f32 v40, v40
    s_nop 0
    v_mul_f32 v41, v41, v40
    s_nop 1
    v_add_f32_dpp v41, v41, v41 row_ror:8 row_mask:0xf bank_mask:0xf
    s_nop 1
    v_add_f32_dpp v41, v41, v41 row_ror:4 row_mask:0xf bank_mask:0xf
    s_nop 1
    v_add_f32_dpp v41, v41, v41 row_ror:2 row_mask:0xf bank_mask:0xf
    s_nop 1
    v_add_f32_dpp v41, v41, v41 row_ror:1 row_mask:0xf bank_mask:0xf
    v_rcp_f32 v41, v41
    v_and_b32 v47, 1, v2
    v_cmp_eq_u32 vcc, 1, v47
    v_mul_f32 v40, v40, v41
    v_cvt_pk_bf16_f32 v42, v40, v40
    v_and_b32 v43, 0xffff0000, v42
    v_sub_f32 v40, v40, v43
    v_cvt_pk_bf16_f32 v43, v40, v40
    v_cndmask_b32 v42, v42, v43, vcc
    ds_write_b16 v44, v42
    s_waitcnt lgkmcnt(0)
    ds_read_b64 v[52:53], v33
    s_mov_b32 s63, 60000
poll_36:
    s_waitcnt vmcnt(0)
    v_xor_b32 v80, v64, v8
    v_xor_b32 v81, v65, v9
    v_xor_b32 v82, v66, v10
    v_xor_b32 v83, v67, v11
    v_xor_b32 v84, v68, v8
    v_xor_b32 v85, v69, v9
    v_xor_b32 v86, v70, v10
    v_xor_b32 v87, v71, v11
    v_xor_b32 v88, v72, v8
    v_xor_b32 v89, v73, v9
    v_xor_b32 v90, v74, v10
    v_xor_b32 v91, v75, v11
    v_xor_b32 v92, v76, v8
    v_xor_b32 v93, v77, v9
    v_xor_b32 v94, v78, v10
    v_xor_b32 v95, v79, v11
    v_or3_b32 v47, v80, v81, v82
    v_or3_b32 v48, v83, v84, v85
    v_or3_b32 v47, v47, v86, v87
    v_or3_b32 v48, v48, v88, v89
    v_or3_b32 v47, v47, v90, v91
    v_or3_b32 v48, v48, v92, v93
    v_or3_b32 v47, v47, v94, v95
    v_or_b32 v47, v47, v48
    v_and_b32 v47, 0x00010001, v47
    v_cmp_ne_u32 vcc, 0, v47
    s_cbranch_vccz pdone_37
    buffer_load_dwordx4 v[64:67], v32, s[48:51], s64 offen offset:0 sc1
    buffer_load_dwordx4 v[68:71], v32, s[48:51], s64 offen offset:256 sc1
    buffer_load_dwordx4 v[72:75], v32, s[48:51], s64 offen offset:512 sc1
    buffer_load_dwordx4 v[76:79], v32, s[48:51], s64 offen offset:768 sc1
    s_sub_u32 s63, s63, 1
    s_cbranch_scc0 poll_36
    s_waitcnt vmcnt(0)
pdone_37:
    v_perm_b32 v64, v84, v80, s76
    v_perm_b32 v65, v92, v88, s76
    v_perm_b32 v66, v84, v80, s77
    v_perm_b32 v67, v92, v88, s77
    v_or_b32 v66, 0x00010001, v66
    v_or_b32 v67, 0x00010001, v67
    s_waitcnt lgkmcnt(0)
    v_mfma_f32_16x16x16_bf16 v[128:131], v[52:53], v[64:65], 0
    v_perm_b32 v68, v85, v81, s76
    v_perm_b32 v69, v93, v89, s76
    v_mfma_f32_16x16x16_bf16 v[132:135], v[52:53], v[66:67], 0
    v_perm_b32 v70, v85, v81, s77
    v_perm_b32 v71, v93, v89, s77
    v_or_b32 v70, 0x00010001, v70
    v_or_b32 v71, 0x00010001, v71
    v_mfma_f32_16x16x16_bf16 v[136:139], v[52:53], v[68:69], 0
    v_perm_b32 v72, v86, v82, s76
    v_perm_b32 v73, v94, v90, s76
    v_mfma_f32_16x16x16_bf16 v[140:143], v[52:53], v[70:71], 0
    v_perm_b32 v74, v86, v82, s77
    v_perm_b32 v75, v94, v90, s77
    v_or_b32 v74, 0x00010001, v74
    v_or_b32 v75, 0x00010001, v75
    v_mfma_f32_16x16x16_bf16 v[144:147], v[52:53], v[72:73], 0
    v_perm_b32 v76, v87, v83, s76
    v_perm_b32 v77, v95, v91, s76
    v_mfma_f32_16x16x16_bf16 v[148:151], v[52:53], v[74:75], 0
    v_perm_b32 v78, v87, v83, s77
    v_perm_b32 v79, v95, v91, s77
    v_or_b32 v78, 0x00010001, v78
    v_or_b32 v79, 0x00010001, v79
    v_mfma_f32_16x16x16_bf16 v[152:155], v[52:53], v[76:77], 0
    s_nop 0
    v_mfma_f32_16x16x16_bf16 v[156:159], v[52:53], v[78:79], 0
    v_add_f32 v128, v128, v129
    v_add_f32 v132, v132, v133
    v_add_f32 v136, v136, v137
    v_add_f32 v140, v140, v141
    v_add_f32 v144, v144, v145
    v_add_f32 v148, v148, v149
    v_add_f32 v152, v152, v153
    s_nop 0
    v_add_f32 v156, v156, v157
    v_cvt_pk_bf16_f32 v80, v128, v132
    v_cvt_pk_bf16_f32 v81, v136, v140
    v_cvt_pk_bf16_f32 v82, v144, v148
    v_cvt_pk_bf16_f32 v83, v152, v156
    s_mov_b32 exec_lo, 0xffff
    s_mov_b32 exec_hi, 0x0
    ds_write_b128 v34, v[80:83]
    s_mov_b64 exec, -1
    s_waitcnt lgkmcnt(0)
    s_barrier
    ds_read_b128 v[64:67], v35 offset:0
    ds_read_b128 v[68:71], v35 offset:64
    ds_read_b128 v[72:75], v35 offset:128
    ds_read_b128 v[76:79], v35 offset:192
    s_waitcnt lgkmcnt(3)
    v_mfma_f32_16x16x32_bf16 v[84:87], v[112:115], v[64:67], 0
    s_waitcnt lgkmcnt(2)
    v_mfma_f32_16x16x32_bf16 v[84:87], v[116:119], v[68:71], v[84:87]
    s_waitcnt lgkmcnt(1)
    v_mfma_f32_16x16x32_bf16 v[84:87], v[120:123], v[72:75], v[84:87]
    s_waitcnt lgkmcnt(0)
    v_mfma_f32_16x16x32_bf16 v[84:87], v[124:127], v[76:79], v[84:87]
    s_nop 7
    v_cvt_pk_bf16_f32 v88, v84, v85
    v_cvt_pk_bf16_f32 v89, v86, v87
    s_mov_b32 exec_lo, 0xff00ff
    s_mov_b32 exec_hi, 0xff00ff
    s_cmp_lg_u32 s29, 0
    s_cbranch_scc1 far_38
    buffer_store_dwordx2 v[88:89], v37, s[48:51], s32 offen
    s_branch dn_39
far_38:
    buffer_store_dwordx2 v[88:89], v37, s[48:51], s32 offen sc1
dn_39:
    s_mov_b64 exec, -1
    s_mov_b32 s63, 60000
poll_40:
    buffer_load_dwordx4 v[64:67], v56, s[48:51], s33 offen offset:0 sc1
    buffer_load_dwordx4 v[68:71], v56, s[48:51], s33 offen offset:256 sc1
    s_waitcnt vmcnt(0)
    v_max3_u32 v47, v64, v66, v68
    v_max_u32 v47, v47, v70
    v_cmp_eq_u32 vcc, -1, v47
    s_cbranch_vccz pdone_41
    s_sub_u32 s63, s63, 1
    s_cbranch_scc0 poll_40
pdone_41:
    v_mfma_f32_16x16x32_bf16 v[80:83], v[192:195], v[64:67], 0
    v_mfma_f32_16x16x32_bf16 v[84:87], v[196:199], v[64:67], 0
    v_mfma_f32_16x16x32_bf16 v[88:91], v[200:203], v[64:67], 0
    v_mfma_f32_16x16x32_bf16 v[92:95], v[204:207], v[64:67], 0
    v_mfma_f32_16x16x32_bf16 v[80:83], v[208:211], v[68:71], v[80:83]
    v_mfma_f32_16x16x32_bf16 v[84:87], v[212:215], v[68:71], v[84:87]
    v_mfma_f32_16x16x32_bf16 v[88:91], v[216:219], v[68:71], v[88:91]
    v_mfma_f32_16x16x32_bf16 v[92:95], v[220:223], v[68:71], v[92:95]
    s_nop 4
    v_add_f32_dpp v96, v80, v80 row_ror:8 row_mask:0xf bank_mask:0x3
    v_add_f32_dpp v97, v81, v81 row_ror:8 row_mask:0xf bank_mask:0x3
    v_add_f32_dpp v98, v82, v82 row_ror:8 row_mask:0xf bank_mask:0x3
    v_add_f32_dpp v99, v83, v83 row_ror:8 row_mask:0xf bank_mask:0x3
    v_add_f32_dpp v100, v84, v84 row_ror:8 row_mask:0xf bank_mask:0x3
    v_add_f32_dpp v101, v85, v85 row_ror:8 row_mask:0xf bank_mask:0x3
    v_add_f32_dpp v102, v86, v86 row_ror:8 row_mask:0xf bank_mask:0x3
    v_add_f32_dpp v103, v87, v87 row_ror:8 row_mask:0xf bank_mask:0x3
    v_add_f32_dpp v96, v88, v88 row_ror:8 row_mask:0xf bank_mask:0xc
    v_add_f32_dpp v97, v89, v89 row_ror:8 row_mask:0xf bank_mask:0xc
    v_add_f32_dpp v98, v90, v90 row_ror:8 row_mask:0xf bank_mask:0xc
    v_add_f32_dpp v99, v91, v91 row_ror:8 row_mask:0xf bank_mask:0xc
    v_add_f32_dpp v100, v92, v92 row_ror:8 row_mask:0xf bank_mask:0xc
    v_add_f32_dpp v101, v93, v93 row_ror:8 row_mask:0xf bank_mask:0xc
    v_add_f32_dpp v102, v94, v94 row_ror:8 row_mask:0xf bank_mask:0xc
    v_add_f32_dpp v103, v95, v95 row_ror:8 row_mask:0xf bank_mask:0xc
    v_add_f32_dpp v104, v96, v96 row_shl:4 row_mask:0xf bank_mask:0x5
    v_add_f32_dpp v105, v97, v97 row_shl:4 row_mask:0xf bank_mask:0x5
    v_add_f32_dpp v106, v98, v98 row_shl:4 row_mask:0xf bank_mask:0x5
    v_add_f32_dpp v107, v99, v99 row_shl:4 row_mask:0xf bank_mask:0x5
    v_add_f32_dpp v104, v100, v100 row_shr:4 row_mask:0xf bank_mask:0xa
    v_add_f32_dpp v105, v101, v101 row_shr:4 row_mask:0xf bank_mask:0xa
    v_add_f32_dpp v106, v102, v102 row_shr:4 row_mask:0xf bank_mask:0xa
    v_add_f32_dpp v107, v103, v103 row_shr:4 row_mask:0xf bank_mask:0xa
    ds_write_b128 v57, v[104:107]
    s_waitcnt lgkmcnt(0)
    s_barrier
    s_cmp_lg_u32 s56, 7
    s_cbranch_scc1 nohint_42
    s_lshl_b32 s64, s55, 7
    s_add_u32 s64, s64, 868352
    v_mov_b32 v108, s57
    v_mov_b32 v109, 0
    s_mov_b32 exec_lo, 0x1
    s_mov_b32 exec_hi, 0x0
    buffer_store_dword v108, v109, s[48:51], s64 offen sc1
    s_mov_b64 exec, -1
nohint_42:
    s_cmp_ge_u32 s56, 3
    s_cbranch_scc1 L_fin
    s_cmp_eq_u32 s56, 2
    s_cbranch_scc1 L_final
    ds_read_b64 v[64:65], v58 offset:0
    ds_read_b64 v[66:67], v58 offset:1088
    ds_read_b64 v[68:69], v58 offset:2176
    ds_read_b64 v[70:71], v58 offset:3264
    ds_read_b64 v[72:73], v58 offset:4352
    ds_read_b64 v[74:75], v58 offset:5440
    ds_read_b64 v[76:77], v58 offset:6528
    ds_read_b64 v[78:79], v58 offset:7616
    s_waitcnt lgkmcnt(0)
    v_add_f32 v64, v64, v72
    v_add_f32 v65, v65, v73
    v_add_f32 v66, v66, v74
    v_add_f32 v67, v67, v75
    v_add_f32 v68, v68, v76
    v_add_f32 v69, v69, v77
    v_add_f32 v70, v70, v78
    v_add_f32 v71, v71, v79
    v_add_f32 v64, v64, v68
    v_add_f32 v65, v65, v69
    v_add_f32 v66, v66, v70
    v_add_f32 v67, v67, v71
    v_add_f32 v64, v64, v66
    v_add_f32 v65, v65, v67
    v_cvt_pk_bf16_f32 v64, v64, v65
    buffer_store_dword v64, v59, s[48:51], s34 offen sc1
    s_cmp_lg_u32 s2, 0
    s_cbranch_scc1 L_fin
    v_mov_b32 v40, s57
    v_mov_b32 v39, 0
    s_mov_b32 exec_lo, 0x1
    s_mov_b32 exec_hi, 0x0
    buffer_store_dword v40, v39, s[48:51], 0 offen offset:0 sc1
    s_mov_b64 exec, -1
    s_branch L_fin
L_final:
    s_lshr_b32 s68, s55, 2
    s_and_b32 s69, s55, 3
    v_bfe_u32 v32, v0, 2, 1
    v_and_b32 v33, 3, v0
    v_lshlrev_b32 v34, 10, v32
    v_lshl_add_u32 v34, v33, 3, v34
    s_lshl_b32 s64, s69, 11
    s_lshl_b32 s65, s68, 5
    s_add_u32 s64, s64, s65
    buffer_load_dwordx2 v[40:41], v34, s[4:7], s64 offen
    s_add_u32 s65, s64, 458752
    s_add_u32 s66, s65, 24576
    s_mov_b32 s63, 60000
poll_43:
    buffer_load_dwordx2 v[42:43], v34, s[48:51], s65 offen sc1
    buffer_load_dwordx2 v[44:45], v34, s[48:51], s66 offen sc1
    s_waitcnt vmcnt(0)
    v_max3_u32 v47, v42, v43, v44
    v_max_u32 v47, v47, v45
    v_cmp_eq_u32 vcc, -1, v47
    s_cbranch_vccz pdone_44
    s_sleep 1
    s_sub_u32 s63, s63, 1
    s_cbranch_scc0 poll_43
pdone_44:
    v_lshlrev_b32 v48, 16, v40
    v_and_b32 v49, 0xffff0000, v40
    v_lshlrev_b32 v50, 16, v41
    v_and_b32 v51, 0xffff0000, v41
    v_lshlrev_b32 v52, 16, v42
    v_and_b32 v53, 0xffff0000, v42
    v_lshlrev_b32 v54, 16, v43
    v_and_b32 v55, 0xffff0000, v43
    v_lshlrev_b32 v56, 16, v44
    v_and_b32 v57, 0xffff0000, v44
    v_lshlrev_b32 v58, 16, v45
    v_and_b32 v59, 0xffff0000, v45
    v_lshlrev_b32 v35, 13, v32
    v_lshl_add_u32 v35, v33, 3, v35
    s_lshl_b32 s65, s69, 14
    s_lshl_b32 s66, s68, 5
    s_add_u32 s65, s65, s66
    s_add_u32 s65, s65, 802816
    s_add_u32 s66, s65, 4096
    s_min_u32 s67, s54, 13
    s_lshl_b32 s33, s52, 4
    s_add_u32 s67, s67, s33
    s_lshl_b32 s67, s67, 7
    s_add_u32 s67, s67, 884800
    s_mov_b32 s63, 60000
hw_45:
    s_load_dword s33, s[48:49], s67 glc
    s_waitcnt lgkmcnt(0)
    s_cmp_eq_u32 s33, s57
    s_cbranch_scc1 hd_46
    s_sub_u32 s63, s63, 1
    s_cbranch_scc0 hw_45
hd_46:
    s_mov_b32 s63, 60000
poll_47:
    buffer_load_dwordx2 v[128:129], v35, s[48:51], s65 offen offset:0 sc1
    buffer_load_dwordx2 v[130:131], v35, s[48:51], s65 offen offset:1024 sc1
    buffer_load_dwordx2 v[132:133], v35, s[48:51], s65 offen offset:2048 sc1
    buffer_load_dwordx2 v[134:135], v35, s[48:51], s65 offen offset:3072 sc1
    buffer_load_dwordx2 v[136:137], v35, s[48:51], s66 offen offset:0 sc1
    buffer_load_dwordx2 v[138:139], v35, s[48:51], s66 offen offset:1024 sc1
    buffer_load_dwordx2 v[140:141], v35, s[48:51], s66 offen offset:2048 sc1
    buffer_load_dwordx2 v[142:143], v35, s[48:51], s66 offen offset:3072 sc1
    s_waitcnt vmcnt(0)
    v_max3_u32 v47, v128, v129, v130
    v_max3_u32 v47, v47, v131, v132
    v_max3_u32 v47, v47, v133, v134
    v_max3_u32 v47, v47, v135, v136
    v_max3_u32 v47, v47, v137, v138
    v_max3_u32 v47, v47, v139, v140
    v_max3_u32 v47, v47, v141, v142
    v_max_u32 v47, v47, v143
    v_cmp_eq_u32 vcc, -1, v47
    s_cbranch_vccz pdone_48
    s_sleep 1
    s_sub_u32 s63, s63, 1
    s_cbranch_scc0 poll_47
pdone_48:
    v_lshlrev_b32 v144, 16, v128
    v_and_b32 v145, 0xffff0000, v128
    v_lshlrev_b32 v146, 16, v129
    v_and_b32 v147, 0xffff0000, v129
    v_lshlrev_b32 v148, 16, v130
    v_and_b32 v149, 0xffff0000, v130
    v_lshlrev_b32 v150, 16, v131
    v_and_b32 v151, 0xffff0000, v131
    v_lshlrev_b32 v152, 16, v132
    v_and_b32 v153, 0xffff0000, v132
    v_lshlrev_b32 v154, 16, v133
    v_and_b32 v155, 0xffff0000, v133
    v_lshlrev_b32 v156, 16, v134
    v_and_b32 v157, 0xffff0000, v134
    v_lshlrev_b32 v158, 16, v135
    v_and_b32 v159, 0xffff0000, v135
    v_lshlrev_b32 v160, 16, v136
    v_and_b32 v161, 0xffff0000, v136
    v_lshlrev_b32 v162, 16, v137
    v_and_b32 v163, 0xffff0000, v137
    v_lshlrev_b32 v164, 16, v138
    v_and_b32 v165, 0xffff0000, v138
    v_lshlrev_b32 v166, 16, v139
    v_and_b32 v167, 0xffff0000, v139
    v_lshlrev_b32 v168, 16, v140
    v_and_b32 v169, 0xffff0000, v140
    v_lshlrev_b32 v170, 16, v141
    v_and_b32 v171, 0xffff0000, v141
    v_lshlrev_b32 v172, 16, v142
    v_and_b32 v173, 0xffff0000, v142
    v_lshlrev_b32 v174, 16, v143
    v_and_b32 v175, 0xffff0000, v143
    v_add_f32 v144, v144, v160
    v_add_f32 v145, v145, v161
    v_add_f32 v146, v146, v162
    v_add_f32 v147, v147, v163
    v_add_f32 v148, v148, v164
    v_add_f32 v149, v149, v165
    v_add_f32 v150, v150, v166
    v_add_f32 v151, v151, v167
    v_add_f32 v152, v152, v168
    v_add_f32 v153, v153, v169
    v_add_f32 v154, v154, v170
    v_add_f32 v155, v155, v171
    v_add_f32 v156, v156, v172
    v_add_f32 v157, v157, v173
    v_add_f32 v158, v158, v174
    v_add_f32 v159, v159, v175
    v_add_f32 v144, v144, v152
    v_add_f32 v145, v145, v153
    v_add_f32 v146, v146, v154
    v_add_f32 v147, v147, v155
    v_add_f32 v148, v148, v156
    v_add_f32 v149, v149, v157
    v_add_f32 v150, v150, v158
    v_add_f32 v151, v151, v159
    v_add_f32 v144, v144, v148
    v_add_f32 v145, v145, v149
    v_add_f32 v146, v146, v150
    v_add_f32 v147, v147, v151
    v_mov_b32 v72, v144
    v_mov_b32 v73, v145
    v_mov_b32 v74, v146
    v_mov_b32 v75, v147
    v_cvt_pk_bf16_f32 v72, 0, v72
    v_cvt_pk_bf16_f32 v73, 0, v73
    v_cvt_pk_bf16_f32 v74, 0, v74
    v_cvt_pk_bf16_f32 v75, 0, v75
    v_mul_f32 v72, v72, v52
    v_mul_f32 v73, v73, v53
    v_mul_f32 v74, v74, v54
    v_mul_f32 v75, v75, v55
    v_cvt_pk_bf16_f32 v72, 0, v72
    v_cvt_pk_bf16_f32 v73, 0, v73
    v_cvt_pk_bf16_f32 v74, 0, v74
    v_cvt_pk_bf16_f32 v75, 0, v75
    v_add_f32 v72, v72, v48
    v_add_f32 v73, v73, v49
    v_add_f32 v74, v74, v50
    v_add_f32 v75, v75, v51
    v_cvt_pk_bf16_f32 v72, 0, v72
    v_cvt_pk_bf16_f32 v73, 0, v73
    v_cvt_pk_bf16_f32 v74, 0, v74
    v_cvt_pk_bf16_f32 v75, 0, v75
    v_lshlrev_b32 v35, 4, v0
    s_mul_i32 s65, s55, 7168
    s_add_u32 s65, s65, 901120
    s_add_u32 s66, s65, 4096
    v_bfe_u32 v40, s57, 0, 8
    v_bfe_u32 v41, s57, 8, 8
    v_bfe_u32 v42, s57, 16, 8
    v_bfe_u32 v43, s57, 24, 8
    s_min_u32 s67, s54, 13
    s_lshl_b32 s68, s52, 4
    s_add_u32 s67, s67, s68
    s_lshl_b32 s67, s67, 7
    s_add_u32 s67, s67, 884736
    s_mov_b32 s63, 60000
hw_49:
    s_load_dword s68, s[48:49], s67 glc
    s_waitcnt lgkmcnt(0)
    s_cmp_eq_u32 s68, s57
    s_cbranch_scc1 hd_50
    s_sub_u32 s63, s63, 1
    s_cbranch_scc0 hw_49
hd_50:
    s_mov_b32 s63, 60000
poll_51:
    buffer_load_dwordx4 v[96:99], v35, s[48:51], s65 offen offset:0 sc1
    buffer_load_dwordx4 v[100:103], v35, s[48:51], s65 offen offset:1024 sc1
    buffer_load_dwordx4 v[104:107], v35, s[48:51], s65 offen offset:2048 sc1
    buffer_load_dwordx4 v[108:111], v35, s[48:51], s65 offen offset:3072 sc1
    buffer_load_dwordx4 v[112:115], v35, s[48:51], s66 offen offset:0 sc1
    buffer_load_dwordx4 v[116:119], v35, s[48:51], s66 offen offset:1024 sc1
    buffer_load_dwordx4 v[120:123], v35, s[48:51], s66 offen offset:2048 sc1
    s_waitcnt vmcnt(0)
    v_xor_b32 v96, v96, v40
    v_xor_b32 v97, v97, v41
    v_xor_b32 v98, v98, v42
    v_xor_b32 v99, v99, v43
    v_xor_b32 v100, v100, v40
    v_xor_b32 v101, v101, v41
    v_xor_b32 v102, v102, v42
    v_xor_b32 v103, v103, v43
    v_xor_b32 v104, v104, v40
    v_xor_b32 v105, v105, v41
    v_xor_b32 v106, v106, v42
    v_xor_b32 v107, v107, v43
    v_xor_b32 v108, v108, v40
    v_xor_b32 v109, v109, v41
    v_xor_b32 v110, v110, v42
    v_xor_b32 v111, v111, v43
    v_xor_b32 v112, v112, v40
    v_xor_b32 v113, v113, v41
    v_xor_b32 v114, v114, v42
    v_xor_b32 v115, v115, v43
    v_xor_b32 v116, v116, v40
    v_xor_b32 v117, v117, v41
    v_xor_b32 v118, v118, v42
    v_xor_b32 v119, v119, v43
    v_xor_b32 v120, v120, v40
    v_xor_b32 v121, v121, v41
    v_xor_b32 v122, v122, v42
    v_xor_b32 v123, v123, v43
    v_or3_b32 v47, v96, v97, v98
    v_or3_b32 v46, v99, v100, v101
    v_or3_b32 v47, v47, v102, v103
    v_or3_b32 v46, v46, v104, v105
    v_or3_b32 v47, v47, v106, v107
    v_or3_b32 v46, v46, v108, v109
    v_or3_b32 v47, v47, v110, v111
    v_or3_b32 v46, v46, v112, v113
    v_or3_b32 v47, v47, v114, v115
    v_or3_b32 v46, v46, v116, v117
    v_or3_b32 v47, v47, v118, v119
    v_or3_b32 v46, v46, v120, v121
    v_or3_b32 v47, v47, v122, v123
    v_or_b32 v47, v47, v46
    v_and_b32 v47, 0xff, v47
    v_cmp_ne_u32 vcc, 0, v47
    s_cbranch_vccz pdone_52
    s_sub_u32 s63, s63, 1
    s_cbranch_scc0 poll_51
pdone_52:
    v_add_f32 v96, v96, v100
    v_add_f32 v104, v104, v108
    v_add_f32 v112, v112, v116
    v_add_f32 v97, v97, v101
    v_add_f32 v105, v105, v109
    v_add_f32 v113, v113, v117
    v_add_f32 v98, v98, v102
    v_add_f32 v106, v106, v110
    v_add_f32 v114, v114, v118
    v_add_f32 v99, v99, v103
    v_add_f32 v107, v107, v111
    v_add_f32 v115, v115, v119
    v_add_f32 v96, v96, v104
    v_add_f32 v112, v112, v120
    v_add_f32 v97, v97, v105
    v_add_f32 v113, v113, v121
    v_add_f32 v98, v98, v106
    v_add_f32 v114, v114, v122
    v_add_f32 v99, v99, v107
    v_add_f32 v115, v115, v123
    v_add_f32 v96, v96, v112
    v_add_f32 v97, v97, v113
    v_add_f32 v98, v98, v114
    v_add_f32 v99, v99, v115
    v_add_f32_dpp v96, v96, v96 row_ror:8 row_mask:0xf bank_mask:0xf
    v_add_f32_dpp v97, v97, v97 row_ror:8 row_mask:0xf bank_mask:0xf
    v_add_f32_dpp v98, v98, v98 row_ror:8 row_mask:0xf bank_mask:0xf
    v_add_f32_dpp v99, v99, v99 row_ror:8 row_mask:0xf bank_mask:0xf
    v_mov_b32 v100, v96
    v_mov_b32 v101, v97
    v_mov_b32 v102, v98
    v_mov_b32 v103, v99
    v_permlane16_swap_b32 v100, v96
    v_permlane16_swap_b32 v101, v97
    v_permlane16_swap_b32 v102, v98
    v_permlane16_swap_b32 v103, v99
    v_add_f32 v96, v96, v100
    v_add_f32 v97, v97, v101
    v_add_f32 v98, v98, v102
    v_add_f32 v99, v99, v103
    v_mov_b32 v100, v96
    v_mov_b32 v101, v97
    v_mov_b32 v102, v98
    v_mov_b32 v103, v99
    v_permlane32_swap_b32 v100, v96
    v_permlane32_swap_b32 v101, v97
    v_permlane32_swap_b32 v102, v98
    v_permlane32_swap_b32 v103, v99
    v_add_f32 v96, v96, v100
    v_add_f32 v97, v97, v101
    v_add_f32 v98, v98, v102
    v_add_f32 v99, v99, v103
    v_cvt_pk_bf16_f32 v96, 0, v96
    v_cvt_pk_bf16_f32 v97, 0, v97
    v_cvt_pk_bf16_f32 v98, 0, v98
    v_cvt_pk_bf16_f32 v99, 0, v99
    v_mul_f32 v96, v96, v56
    v_mul_f32 v97, v97, v57
    v_mul_f32 v98, v98, v58
    v_mul_f32 v99, v99, v59
    v_cvt_pk_bf16_f32 v96, 0, v96
    v_cvt_pk_bf16_f32 v97, 0, v97
    v_cvt_pk_bf16_f32 v98, 0, v98
    v_cvt_pk_bf16_f32 v99, 0, v99
    v_add_f32 v96, v96, v72
    v_add_f32 v97, v97, v73
    v_add_f32 v98, v98, v74
    v_add_f32 v99, v99, v75
    v_cvt_pk_bf16_f32 v100, v96, v97
    v_cvt_pk_bf16_f32 v101, v98, v99
    s_mov_b32 exec_lo, 0xff
    s_mov_b32 exec_hi, 0x0
    buffer_store_dwordx2 v[100:101], v34, s[44:47], s64 offen
    s_mov_b64 exec, -1
    s_branch L_fin
L_pv:
    s_mov_b32 s10, 33554432
    s_mov_b32 s11, 0x00020000
    s_lshl_b32 s78, s55, 18
    s_and_b32 s79, s56, 3
    s_lshl_b32 s69, s79, 13
    s_and_b32 s64, s79, 1
    s_cmp_eq_u32 s64, 1
    s_cselect_b32 s65, 3, 0
    v_xor_b32 v48, s65, v0
    v_lshlrev_b32 v48, 4, v48
    v_add_u32 v48, s69, v48
    s_cselect_b32 s65, 7, 4
    v_xor_b32 v49, s65, v0
    v_lshlrev_b32 v49, 4, v49
    v_add_u32 v49, s69, v49
    s_cselect_b32 s65, 11, 8
    v_xor_b32 v50, s65, v0
    v_lshlrev_b32 v50, 4, v50
    v_add_u32 v50, s69, v50
    s_cselect_b32 s65, 15, 12
    v_xor_b32 v51, s65, v0
    v_lshlrev_b32 v51, 4, v51
    v_add_u32 v51, s69, v51
    s_cselect_b32 s65, 1, 2
    v_xor_b32 v52, s65, v0
    v_lshlrev_b32 v52, 4, v52
    v_add_u32 v52, s69, v52
    v_add_u32 v52, 4096, v52
    s_cselect_b32 s65, 5, 6
    v_xor_b32 v53, s65, v0
    v_lshlrev_b32 v53, 4, v53
    v_add_u32 v53, s69, v53
    v_add_u32 v53, 4096, v53
    s_cselect_b32 s65, 9, 10
    v_xor_b32 v54, s65, v0
    v_lshlrev_b32 v54, 4, v54
    v_add_u32 v54, s69, v54
    v_add_u32 v54, 4096, v54
    s_cselect_b32 s65, 13, 14
    v_xor_b32 v55, s65, v0
    v_lshlrev_b32 v55, 4, v55
    v_add_u32 v55, s69, v55
    v_add_u32 v55, 4096, v55
    s_waitcnt lgkmcnt(0)
    s_load_dword s57, s[48:49], 0
    s_load_dwordx2 s[28:29], s[0:1], 56
    s_load_dwordx2 s[32:33], s[0:1], 64
    s_mov_b32 s30, 1835008
    s_mov_b32 s31, 0x00020000
    s_mov_b32 s34, 1835008
    s_mov_b32 s35, 0x00020000
    s_mov_b32 s72, 0
L_pv_start:
    s_add_u32 s67, s78, 0
    s_add_u32 m0, s69, 0
    s_nop 0
    buffer_load_dwordx4 v48, s[8:11], s67 offen nt lds
    buffer_load_dwordx4 v49, s[8:11], s67 offen offset:1024 nt lds
    buffer_load_dwordx4 v50, s[8:11], s67 offen offset:2048 nt lds
    buffer_load_dwordx4 v51, s[8:11], s67 offen offset:3072 nt lds
    s_add_u32 s67, s78, 0
    s_add_u32 m0, s69, 4096
    s_nop 0
    buffer_load_dwordx4 v52, s[8:11], s67 offen nt lds
    buffer_load_dwordx4 v53, s[8:11], s67 offen offset:1024 nt lds
    buffer_load_dwordx4 v54, s[8:11], s67 offen offset:2048 nt lds
    buffer_load_dwordx4 v55, s[8:11], s67 offen offset:3072 nt lds
    v_mov_b32 v64, 0
    v_mov_b32 v65, 0
    v_mov_b32 v66, 0
    v_mov_b32 v67, 0
    v_mov_b32 v68, 0
    v_mov_b32 v69, 0
    v_mov_b32 v70, 0
    v_mov_b32 v71, 0
    v_mov_b32 v72, 0
    v_mov_b32 v73, 0
    v_mov_b32 v74, 0
    v_mov_b32 v75, 0
    v_mov_b32 v76, 0
    v_mov_b32 v77, 0
    v_mov_b32 v78, 0
    v_mov_b32 v79, 0
    v_mov_b32 v80, 0
    v_mov_b32 v81, 0
    v_mov_b32 v82, 0
    v_mov_b32 v83, 0
    v_mov_b32 v84, 0
    v_mov_b32 v85, 0
    v_mov_b32 v86, 0
    v_mov_b32 v87, 0
    v_mov_b32 v88, 0
    v_mov_b32 v89, 0
    v_mov_b32 v90, 0
    v_mov_b32 v91, 0
    v_mov_b32 v92, 0
    v_mov_b32 v93, 0
    v_mov_b32 v94, 0
    v_mov_b32 v95, 0
    v_mov_b32 v96, 0
    v_mov_b32 v97, 0
    v_mov_b32 v98, 0
    v_mov_b32 v99, 0
    v_mov_b32 v100, 0
    v_mov_b32 v101, 0
    v_mov_b32 v102, 0
    v_mov_b32 v103, 0
    v_mov_b32 v104, 0
    v_mov_b32 v105, 0
    v_mov_b32 v106, 0
    v_mov_b32 v107, 0
    v_mov_b32 v108, 0
    v_mov_b32 v109, 0
    v_mov_b32 v110, 0
    v_mov_b32 v111, 0
    v_mov_b32 v112, 0
    v_mov_b32 v113, 0
    v_mov_b32 v114, 0
    v_mov_b32 v115, 0
    v_mov_b32 v116, 0
    v_mov_b32 v117, 0
    v_mov_b32 v118, 0
    v_mov_b32 v119, 0
    v_mov_b32 v120, 0
    v_mov_b32 v121, 0
    v_mov_b32 v122, 0
    v_mov_b32 v123, 0
    v_mov_b32 v124, 0
    v_mov_b32 v125, 0
    v_mov_b32 v126, 0
    v_mov_b32 v127, 0
    s_cmp_lg_u32 s72, 0
    s_cbranch_scc1 L_pv_again
    v_lshrrev_b32 v42, 2, v1
    v_and_b32 v43, 3, v1
    v_and_b32 v44, 1, v2
    v_lshrrev_b32 v45, 1, v2
    v_lshl_add_u32 v46, v45, 3, v42
    v_lshlrev_b32 v46, 10, v46
    v_and_b32 v47, 1, v43
    v_lshl_add_u32 v46, v47, 3, v46
    s_lshl_b32 s64, s79, 8
    v_add_u32 v46, s64, v46
    v_lshrrev_b32 v47, 1, v43
    v_lshl_add_u32 v47, v44, 1, v47
    v_lshl_add_u32 v47, v42, 2, v47
    v_cmp_eq_u32 vcc, 1, v45
    v_mov_b32 v56, 0
    v_mov_b32 v57, 3
    v_cndmask_b32 v56, v56, v57, vcc
    v_xor_b32 v56, v56, v47
    v_xor_b32 v24, 0, v56
    v_lshl_add_u32 v24, v24, 4, v46
    v_add_u32 v32, 0x10000, v24
    v_xor_b32 v26, 4, v56
    v_lshl_add_u32 v26, v26, 4, v46
    v_add_u32 v34, 0x10000, v26
    v_xor_b32 v28, 8, v56
    v_lshl_add_u32 v28, v28, 4, v46
    v_add_u32 v36, 0x10000, v28
    v_xor_b32 v30, 12, v56
    v_lshl_add_u32 v30, v30, 4, v46
    v_add_u32 v38, 0x10000, v30
    v_mov_b32 v56, 2
    v_mov_b32 v57, 1
    v_cndmask_b32 v56, v56, v57, vcc
    v_xor_b32 v56, v56, v47
    v_xor_b32 v25, 0, v56
    v_lshl_add_u32 v25, v25, 4, v46
    v_add_u32 v25, 4096, v25
    v_add_u32 v33, 0x10000, v25
    v_xor_b32 v27, 4, v56
    v_lshl_add_u32 v27, v27, 4, v46
    v_add_u32 v27, 4096, v27
    v_add_u32 v35, 0x10000, v27
    v_xor_b32 v29, 8, v56
    v_lshl_add_u32 v29, v29, 4, v46
    v_add_u32 v29, 4096, v29
    v_add_u32 v37, 0x10000, v29
    v_xor_b32 v31, 12, v56
    v_lshl_add_u32 v31, v31, 4, v46
    v_add_u32 v31, 4096, v31
    v_add_u32 v39, 0x10000, v31
    v_and_b32 v42, 31, v0
    v_mul_u32_u24 v40, 80, v42
    v_lshrrev_b32 v42, 5, v0
    v_lshl_add_u32 v40, v42, 4, v40
    v_add_u32 v40, 131072, v40
    v_mov_b32 v41, 137344
    s_waitcnt lgkmcnt(0)
    s_mul_i32 s57, s57, 0x9e3779b1
    s_add_u32 s57, s57, 0x7f4a7c15
    s_and_b32 s58, s57, 0xffff
    s_lshr_b32 s59, s57, 16
    v_and_b32 v42, 3, v1
    v_lshlrev_b32 v42, 3, v42
    v_lshrrev_b32 v42, v42, s57
    v_bfe_u32 v4, v42, 0, 1
    v_bfe_u32 v43, v42, 1, 1
    v_lshl_or_b32 v4, v43, 16, v4
    v_bfe_u32 v5, v42, 2, 1
    v_bfe_u32 v43, v42, 3, 1
    v_lshl_or_b32 v5, v43, 16, v5
    v_bfe_u32 v6, v42, 4, 1
    v_bfe_u32 v43, v42, 5, 1
    v_lshl_or_b32 v6, v43, 16, v6
    v_bfe_u32 v7, v42, 6, 1
    v_bfe_u32 v43, v42, 7, 1
    v_lshl_or_b32 v7, v43, 16, v7
L_pv_again:
    s_waitcnt vmcnt(8)
    s_add_u32 s67, s78, 32768
    s_add_u32 m0, s69, 32768
    s_nop 0
    buffer_load_dwordx4 v48, s[8:11], s67 offen nt lds
    buffer_load_dwordx4 v49, s[8:11], s67 offen offset:1024 nt lds
    s_waitcnt vmcnt(8)
    s_add_u32 s67, s78, 32768
    s_add_u32 m0, s69, 32768
    s_nop 0
    buffer_load_dwordx4 v50, s[8:11], s67 offen offset:2048 nt lds
    buffer_load_dwordx4 v51, s[8:11], s67 offen offset:3072 nt lds
    s_waitcnt vmcnt(8)
    s_add_u32 s67, s78, 32768
    s_add_u32 m0, s69, 36864
    s_nop 0
    buffer_load_dwordx4 v52, s[8:11], s67 offen nt lds
    buffer_load_dwordx4 v53, s[8:11], s67 offen offset:1024 nt lds
    s_waitcnt vmcnt(8)
    s_add_u32 s67, s78, 32768
    s_add_u32 m0, s69, 36864
    s_nop 0
    buffer_load_dwordx4 v54, s[8:11], s67 offen offset:2048 nt lds
    buffer_load_dwordx4 v55, s[8:11], s67 offen offset:3072 nt lds
    s_waitcnt vmcnt(8)
    s_barrier
    ds_read_b64_tr_b16 v[128:129], v24 offset:0
    ds_read_b64_tr_b16 v[130:131], v25 offset:0
    ds_read_b64_tr_b16 v[136:137], v26 offset:0
    ds_read_b64_tr_b16 v[138:139], v27 offset:0
    ds_read_b64_tr_b16 v[144:145], v28 offset:0
    ds_read_b64_tr_b16 v[146:147], v29 offset:0
    ds_read_b64_tr_b16 v[152:153], v30 offset:0
    ds_read_b64_tr_b16 v[154:155], v31 offset:0
    ds_read_b64_tr_b16 v[132:133], v24 offset:16384
    ds_read_b64_tr_b16 v[134:135], v25 offset:16384
    ds_read_b64_tr_b16 v[140:141], v26 offset:16384
    ds_read_b64_tr_b16 v[142:143], v27 offset:16384
    ds_read_b64_tr_b16 v[148:149], v28 offset:16384
    ds_read_b64_tr_b16 v[150:151], v29 offset:16384
    ds_read_b64_tr_b16 v[156:157], v30 offset:16384
    ds_read_b64_tr_b16 v[158:159], v31 offset:16384
    s_waitcnt vmcnt(8)
    s_add_u32 s67, s78, 65536
    s_add_u32 m0, s69, 65536
    s_nop 0
    buffer_load_dwordx4 v48, s[8:11], s67 offen nt lds
    buffer_load_dwordx4 v49, s[8:11], s67 offen offset:1024 nt lds
    s_waitcnt vmcnt(8)
    s_add_u32 s67, s78, 65536
    s_add_u32 m0, s69, 65536
    s_nop 0
    buffer_load_dwordx4 v50, s[8:11], s67 offen offset:2048 nt lds
    buffer_load_dwordx4 v51, s[8:11], s67 offen offset:3072 nt lds
    s_waitcnt vmcnt(8)
    s_add_u32 s67, s78, 65536
    s_add_u32 m0, s69, 69632
    s_nop 0
    buffer_load_dwordx4 v52, s[8:11], s67 offen nt lds
    buffer_load_dwordx4 v53, s[8:11], s67 offen offset:1024 nt lds
    s_waitcnt vmcnt(8)
    s_add_u32 s67, s78, 65536
    s_add_u32 m0, s69, 69632
    s_nop 0
    buffer_load_dwordx4 v54, s[8:11], s67 offen offset:2048 nt lds
    buffer_load_dwordx4 v55, s[8:11], s67 offen offset:3072 nt lds
    s_waitcnt vmcnt(8) lgkmcnt(0)
    s_barrier
    ds_read_b64_tr_b16 v[160:161], v24 offset:32768
    ds_read_b64_tr_b16 v[162:163], v25 offset:32768
    ds_read_b64_tr_b16 v[168:169], v26 offset:32768
    ds_read_b64_tr_b16 v[170:171], v27 offset:32768
    ds_read_b64_tr_b16 v[176:177], v28 offset:32768
    ds_read_b64_tr_b16 v[178:179], v29 offset:32768
    ds_read_b64_tr_b16 v[184:185], v30 offset:32768
    ds_read_b64_tr_b16 v[186:187], v31 offset:32768
    ds_read_b64_tr_b16 v[164:165], v24 offset:49152
    ds_read_b64_tr_b16 v[166:167], v25 offset:49152
    ds_read_b64_tr_b16 v[172:173], v26 offset:49152
    ds_read_b64_tr_b16 v[174:175], v27 offset:49152
    ds_read_b64_tr_b16 v[180:181], v28 offset:49152
    ds_read_b64_tr_b16 v[182:183], v29 offset:49152
    ds_read_b64_tr_b16 v[188:189], v30 offset:49152
    ds_read_b64_tr_b16 v[190:191], v31 offset:49152
    s_waitcnt vmcnt(8) lgkmcnt(0)
    s_barrier
    s_waitcnt vmcnt(8)
    s_add_u32 s67, s78, 98304
    s_add_u32 m0, s69, 98304
    s_nop 0
    buffer_load_dwordx4 v48, s[8:11], s67 offen nt lds
    buffer_load_dwordx4 v49, s[8:11], s67 offen offset:1024 nt lds
    s_waitcnt vmcnt(8)
    s_add_u32 s67, s78, 98304
    s_add_u32 m0, s69, 98304
    s_nop 0
    buffer_load_dwordx4 v50, s[8:11], s67 offen offset:2048 nt lds
    buffer_load_dwordx4 v51, s[8:11], s67 offen offset:3072 nt lds
    s_waitcnt vmcnt(8)
    s_add_u32 s67, s78, 98304
    s_add_u32 m0, s69, 102400
    s_nop 0
    buffer_load_dwordx4 v52, s[8:11], s67 offen nt lds
    buffer_load_dwordx4 v53, s[8:11], s67 offen offset:1024 nt lds
    s_waitcnt vmcnt(8)
    s_add_u32 s67, s78, 98304
    s_add_u32 m0, s69, 102400
    s_nop 0
    buffer_load_dwordx4 v54, s[8:11], s67 offen offset:2048 nt lds
    buffer_load_dwordx4 v55, s[8:11], s67 offen offset:3072 nt lds
    s_waitcnt vmcnt(8)
    s_barrier
    ds_read_b64_tr_b16 v[192:193], v32 offset:0
    ds_read_b64_tr_b16 v[194:195], v33 offset:0
    ds_read_b64_tr_b16 v[200:201], v34 offset:0
    ds_read_b64_tr_b16 v[202:203], v35 offset:0
    ds_read_b64_tr_b16 v[208:209], v36 offset:0
    ds_read_b64_tr_b16 v[210:211], v37 offset:0
    ds_read_b64_tr_b16 v[216:217], v38 offset:0
    ds_read_b64_tr_b16 v[218:219], v39 offset:0
    ds_read_b64_tr_b16 v[196:197], v32 offset:16384
    ds_read_b64_tr_b16 v[198:199], v33 offset:16384
    ds_read_b64_tr_b16 v[204:205], v34 offset:16384
    ds_read_b64_tr_b16 v[206:207], v35 offset:16384
    ds_read_b64_tr_b16 v[212:213], v36 offset:16384
    ds_read_b64_tr_b16 v[214:215], v37 offset:16384
    ds_read_b64_tr_b16 v[220:221], v38 offset:16384
    ds_read_b64_tr_b16 v[222:223], v39 offset:16384
    s_barrier
    s_add_u32 s67, s78, 131072
    s_add_u32 m0, s69, 0
    s_nop 0
    buffer_load_dwordx4 v48, s[8:11], s67 offen nt lds
    buffer_load_dwordx4 v49, s[8:11], s67 offen offset:1024 nt lds
    s_waitcnt vmcnt(2) lgkmcnt(0)
    s_barrier
    ds_read_b64_tr_b16 v[224:225], v32 offset:32768
    ds_read_b64_tr_b16 v[226:227], v33 offset:32768
    ds_read_b64_tr_b16 v[232:233], v34 offset:32768
    ds_read_b64_tr_b16 v[234:235], v35 offset:32768
    ds_read_b64_tr_b16 v[240:241], v36 offset:32768
    ds_read_b64_tr_b16 v[242:243], v37 offset:32768
    ds_read_b64_tr_b16 v[248:249], v38 offset:32768
    ds_read_b64_tr_b16 v[250:251], v39 offset:32768
    ds_read_b64_tr_b16 v[228:229], v32 offset:49152
    ds_read_b64_tr_b16 v[230:231], v33 offset:49152
    ds_read_b64_tr_b16 v[236:237], v34 offset:49152
    ds_read_b64_tr_b16 v[238:239], v35 offset:49152
    ds_read_b64_tr_b16 v[244:245], v36 offset:49152
    ds_read_b64_tr_b16 v[246:247], v37 offset:49152
    ds_read_b64_tr_b16 v[252:253], v38 offset:49152
    ds_read_b64_tr_b16 v[254:255], v39 offset:49152
    s_add_u32 s67, s78, 131072
    s_add_u32 m0, s69, 0
    s_nop 0
    buffer_load_dwordx4 v50, s[8:11], s67 offen offset:2048 nt lds
    s_add_u32 s67, s78, 131072
    s_add_u32 m0, s69, 0
    s_nop 0
    buffer_load_dwordx4 v51, s[8:11], s67 offen offset:3072 nt lds
    s_add_u32 s67, s78, 131072
    s_add_u32 m0, s69, 4096
    s_nop 0
    buffer_load_dwordx4 v52, s[8:11], s67 offen nt lds
    s_add_u32 s67, s78, 131072
    s_add_u32 m0, s69, 4096
    s_nop 0
    buffer_load_dwordx4 v53, s[8:11], s67 offen offset:1024 nt lds
    s_add_u32 s67, s78, 131072
    s_add_u32 m0, s69, 4096
    s_nop 0
    buffer_load_dwordx4 v54, s[8:11], s67 offen offset:2048 nt lds
    s_add_u32 s67, s78, 131072
    s_add_u32 m0, s69, 4096
    s_nop 0
    buffer_load_dwordx4 v55, s[8:11], s67 offen offset:3072 nt lds
    s_add_u32 s67, s78, 163840
    s_add_u32 m0, s69, 32768
    s_nop 0
    buffer_load_dwordx4 v48, s[8:11], s67 offen nt lds
    s_add_u32 s67, s78, 163840
    s_add_u32 m0, s69, 32768
    s_nop 0
    buffer_load_dwordx4 v49, s[8:11], s67 offen offset:1024 nt lds
    s_add_u32 s67, s78, 163840
    s_add_u32 m0, s69, 32768
    s_nop 0
    buffer_load_dwordx4 v50, s[8:11], s67 offen offset:2048 nt lds
    s_add_u32 s67, s78, 163840
    s_add_u32 m0, s69, 32768
    s_nop 0
    buffer_load_dwordx4 v51, s[8:11], s67 offen offset:3072 nt lds
    s_waitcnt lgkmcnt(0)
    s_barrier
    ds_read_b128 v[8:11], v40 offset:0
    ds_read_b128 v[12:15], v40 offset:32
    s_waitcnt lgkmcnt(0)
    v_mfma_f32_32x32x16_bf16 v[64:79], v[8:11], v[128:131], v[64:79]
    s_add_u32 s67, s78, 163840
    s_add_u32 m0, s69, 36864
    s_nop 0
    buffer_load_dwordx4 v52, s[8:11], s67 offen nt lds
    s_add_u32 s67, s78, 163840
    s_add_u32 m0, s69, 36864
    s_nop 0
    buffer_load_dwordx4 v53, s[8:11], s67 offen offset:1024 nt lds
    v_mfma_f32_32x32x16_bf16 v[80:95], v[8:11], v[136:139], v[80:95]
    s_add_u32 s67, s78, 163840
    s_add_u32 m0, s69, 36864
    s_nop 0
    buffer_load_dwordx4 v54, s[8:11], s67 offen offset:2048 nt lds
    s_add_u32 s67, s78, 163840
    s_add_u32 m0, s69, 36864
    s_nop 0
    buffer_load_dwordx4 v55, s[8:11], s67 offen offset:3072 nt lds
    v_mfma_f32_32x32x16_bf16 v[96:111], v[8:11], v[144:147], v[96:111]
    s_add_u32 s67, s78, 196608
    s_add_u32 m0, s69, 65536
    s_nop 0
    buffer_load_dwordx4 v48, s[8:11], s67 offen nt lds
    v_mfma_f32_32x32x16_bf16 v[112:127], v[8:11], v[152:155], v[112:127]
    s_add_u32 s67, s78, 196608
    s_add_u32 m0, s69, 65536
    s_nop 0
    buffer_load_dwordx4 v49, s[8:11], s67 offen offset:1024 nt lds
    s_add_u32 s67, s78, 196608
    s_add_u32 m0, s69, 65536
    s_nop 0
    buffer_load_dwordx4 v50, s[8:11], s67 offen offset:2048 nt lds
    v_mfma_f32_32x32x16_bf16 v[64:79], v[12:15], v[132:135], v[64:79]
    s_add_u32 s67, s78, 196608
    s_add_u32 m0, s69, 65536
    s_nop 0
    buffer_load_dwordx4 v51, s[8:11], s67 offen offset:3072 nt lds
    s_waitcnt vmcnt(12)
    s_barrier
    ds_read_b128 v[16:19], v40 offset:2560
    ds_read_b128 v[20:23], v40 offset:2592
    v_mfma_f32_32x32x16_bf16 v[80:95], v[12:15], v[140:143], v[80:95]
    v_mfma_f32_32x32x16_bf16 v[96:111], v[12:15], v[148:151], v[96:111]
    v_mfma_f32_32x32x16_bf16 v[112:127], v[12:15], v[156:159], v[112:127]
    s_waitcnt lgkmcnt(0)
    v_mfma_f32_32x32x16_bf16 v[64:79], v[16:19], v[160:163], v[64:79]
    s_add_u32 s67, s78, 196608
    s_add_u32 m0, s69, 69632
    s_nop 0
    buffer_load_dwordx4 v52, s[8:11], s67 offen nt lds
    s_add_u32 s67, s78, 196608
    s_add_u32 m0, s69, 69632
    s_nop 0
    buffer_load_dwordx4 v53, s[8:11], s67 offen offset:1024 nt lds
    s_add_u32 s67, s78, 196608
    s_add_u32 m0, s69, 69632
    s_nop 0
    buffer_load_dwordx4 v54, s[8:11], s67 offen offset:2048 nt lds
    s_add_u32 s67, s78, 196608
    s_add_u32 m0, s69, 69632
    s_nop 0
    buffer_load_dwordx4 v55, s[8:11], s67 offen offset:3072 nt lds
    s_add_u32 s67, s78, 229376
    s_add_u32 m0, s69, 98304
    s_nop 0
    buffer_load_dwordx4 v48, s[8:11], s67 offen nt lds
    v_mfma_f32_32x32x16_bf16 v[80:95], v[16:19], v[168:171], v[80:95]
    s_add_u32 s67, s78, 229376
    s_add_u32 m0, s69, 98304
    s_nop 0
    buffer_load_dwordx4 v49, s[8:11], s67 offen offset:1024 nt lds
    ds_read_b64_tr_b16 v[128:129], v24 offset:0
    ds_read_b64_tr_b16 v[130:131], v25 offset:0
    ds_read_b64_tr_b16 v[136:137], v26 offset:0
    v_mfma_f32_32x32x16_bf16 v[96:111], v[16:19], v[176:179], v[96:111]
    ds_read_b64_tr_b16 v[138:139], v27 offset:0
    ds_read_b64_tr_b16 v[144:145], v28 offset:0
    ds_read_b64_tr_b16 v[146:147], v29 offset:0
    ds_read_b64_tr_b16 v[152:153], v30 offset:0
    ds_read_b64_tr_b16 v[154:155], v31 offset:0
    v_mfma_f32_32x32x16_bf16 v[112:127], v[16:19], v[184:187], v[112:127]
    ds_read_b64_tr_b16 v[132:133], v24 offset:16384
    ds_read_b64_tr_b16 v[134:135], v25 offset:16384
    ds_read_b64_tr_b16 v[140:141], v26 offset:16384
    ds_read_b64_tr_b16 v[142:143], v27 offset:16384
    v_mfma_f32_32x32x16_bf16 v[64:79], v[20:23], v[164:167], v[64:79]
    ds_read_b64_tr_b16 v[148:149], v28 offset:16384
    ds_read_b64_tr_b16 v[150:151], v29 offset:16384
    ds_read_b64_tr_b16 v[156:157], v30 offset:16384
    ds_read_b64_tr_b16 v[158:159], v31 offset:16384
    s_waitcnt vmcnt(10)
    s_barrier
    ds_read_b128 v[8:11], v40 offset:0
    ds_read_b128 v[12:15], v40 offset:32
    v_mfma_f32_32x32x16_bf16 v[80:95], v[20:23], v[172:175], v[80:95]
    v_mfma_f32_32x32x16_bf16 v[96:111], v[20:23], v[180:183], v[96:111]
    v_mfma_f32_32x32x16_bf16 v[112:127], v[20:23], v[188:191], v[112:127]
    s_waitcnt lgkmcnt(0)
    v_mfma_f32_32x32x16_bf16 v[64:79], v[8:11], v[192:195], v[64:79]
    s_add_u32 s67, s78, 229376
    s_add_u32 m0, s69, 98304
    s_nop 0
    buffer_load_dwordx4 v50, s[8:11], s67 offen offset:2048 nt lds
    s_add_u32 s67, s78, 229376
    s_add_u32 m0, s69, 98304
    s_nop 0
    buffer_load_dwordx4 v51, s[8:11], s67 offen offset:3072 nt lds
    s_add_u32 s67, s78, 229376
    s_add_u32 m0, s69, 102400
    s_nop 0
    buffer_load_dwordx4 v52, s[8:11], s67 offen nt lds
    s_add_u32 s67, s78, 229376
    s_add_u32 m0, s69, 102400
    s_nop 0
    buffer_load_dwordx4 v53, s[8:11], s67 offen offset:1024 nt lds
    s_add_u32 s67, s78, 229376
    s_add_u32 m0, s69, 102400
    s_nop 0
    buffer_load_dwordx4 v54, s[8:11], s67 offen offset:2048 nt lds
    v_mfma_f32_32x32x16_bf16 v[80:95], v[8:11], v[200:203], v[80:95]
    s_add_u32 s67, s78, 229376
    s_add_u32 m0, s69, 102400
    s_nop 0
    buffer_load_dwordx4 v55, s[8:11], s67 offen offset:3072 nt lds
    ds_read_b64_tr_b16 v[160:161], v24 offset:32768
    ds_read_b64_tr_b16 v[162:163], v25 offset:32768
    ds_read_b64_tr_b16 v[168:169], v26 offset:32768
    v_mfma_f32_32x32x16_bf16 v[96:111], v[8:11], v[208:211], v[96:111]
    ds_read_b64_tr_b16 v[170:171], v27 offset:32768
    ds_read_b64_tr_b16 v[176:177], v28 offset:32768
    ds_read_b64_tr_b16 v[178:179], v29 offset:32768
    ds_read_b64_tr_b16 v[184:185], v30 offset:32768
    ds_read_b64_tr_b16 v[186:187], v31 offset:32768
    v_mfma_f32_32x32x16_bf16 v[112:127], v[8:11], v[216:219], v[112:127]
    ds_read_b64_tr_b16 v[164:165], v24 offset:49152
    ds_read_b64_tr_b16 v[166:167], v25 offset:49152
    ds_read_b64_tr_b16 v[172:173], v26 offset:49152
    ds_read_b64_tr_b16 v[174:175], v27 offset:49152
    v_mfma_f32_32x32x16_bf16 v[64:79], v[12:15], v[196:199], v[64:79]
    ds_read_b64_tr_b16 v[180:181], v28 offset:49152
    ds_read_b64_tr_b16 v[182:183], v29 offset:49152
    ds_read_b64_tr_b16 v[188:189], v30 offset:49152
    ds_read_b64_tr_b16 v[190:191], v31 offset:49152
    s_waitcnt vmcnt(8)
    s_barrier
    ds_read_b128 v[16:19], v40 offset:2560
    ds_read_b128 v[20:23], v40 offset:2592
    v_mfma_f32_32x32x16_bf16 v[80:95], v[12:15], v[204:207], v[80:95]
    v_mfma_f32_32x32x16_bf16 v[96:111], v[12:15], v[212:215], v[96:111]
    v_mfma_f32_32x32x16_bf16 v[112:127], v[12:15], v[220:223], v[112:127]
    s_waitcnt lgkmcnt(0)
    v_mfma_f32_32x32x16_bf16 v[64:79], v[16:19], v[224:227], v[64:79]
    ds_read_b64_tr_b16 v[192:193], v32 offset:0
    ds_read_b64_tr_b16 v[194:195], v33 offset:0
    ds_read_b64_tr_b16 v[200:201], v34 offset:0
    ds_read_b64_tr_b16 v[202:203], v35 offset:0
    v_mfma_f32_32x32x16_bf16 v[80:95], v[16:19], v[232:235], v[80:95]
    ds_read_b64_tr_b16 v[208:209], v36 offset:0
    ds_read_b64_tr_b16 v[210:211], v37 offset:0
    ds_read_b64_tr_b16 v[216:217], v38 offset:0
    v_mfma_f32_32x32x16_bf16 v[96:111], v[16:19], v[240:243], v[96:111]
    ds_read_b64_tr_b16 v[218:219], v39 offset:0
    ds_read_b64_tr_b16 v[196:197], v32 offset:16384
    ds_read_b64_tr_b16 v[198:199], v33 offset:16384
    v_mfma_f32_32x32x16_bf16 v[112:127], v[16:19], v[248:251], v[112:127]
    ds_read_b64_tr_b16 v[204:205], v34 offset:16384
    ds_read_b64_tr_b16 v[206:207], v35 offset:16384
    ds_read_b64_tr_b16 v[212:213], v36 offset:16384
    v_mfma_f32_32x32x16_bf16 v[64:79], v[20:23], v[228:231], v[64:79]
    ds_read_b64_tr_b16 v[214:215], v37 offset:16384
    ds_read_b64_tr_b16 v[220:221], v38 offset:16384
    ds_read_b64_tr_b16 v[222:223], v39 offset:16384
    s_waitcnt vmcnt(0)
    s_barrier
    ds_read_b128 v[8:11], v40 offset:0
    ds_read_b128 v[12:15], v40 offset:32
    v_mfma_f32_32x32x16_bf16 v[80:95], v[20:23], v[236:239], v[80:95]
    v_mfma_f32_32x32x16_bf16 v[96:111], v[20:23], v[244:247], v[96:111]
    v_mfma_f32_32x32x16_bf16 v[112:127], v[20:23], v[252:255], v[112:127]
    s_waitcnt lgkmcnt(0)
    v_mfma_f32_32x32x16_bf16 v[64:79], v[8:11], v[128:131], v[64:79]
    s_min_u32 s64, s54, 13
    s_lshr_b32 s64, s64, 1
    s_mul_i32 s65, s52, 7
    s_add_u32 s64, s64, s65
    s_lshl_b32 s64, s64, 15
    s_add_u32 s64, s64, s69
    s_add_u32 s64, s64, 0
    s_add_u32 m0, s69, 0
    v_lshlrev_b32 v43, 4, v0
    s_and_b32 s65, s56, 1
    s_lshl_b32 s65, s65, 7
    v_xor_b32 v43, s65, v43
    v_mfma_f32_32x32x16_bf16 v[80:95], v[8:11], v[136:139], v[80:95]
    v_xor_b32 v46, 0, v43
    buffer_load_dwordx4 v46, s[32:35], s64 offen offset:0  lds
    v_mfma_f32_32x32x16_bf16 v[96:111], v[8:11], v[144:147], v[96:111]
    v_xor_b32 v46, 32, v43
    buffer_load_dwordx4 v46, s[32:35], s64 offen offset:1024  lds
    v_mfma_f32_32x32x16_bf16 v[112:127], v[8:11], v[152:155], v[112:127]
    v_xor_b32 v46, 64, v43
    buffer_load_dwordx4 v46, s[32:35], s64 offen offset:2048  lds
    v_mfma_f32_32x32x16_bf16 v[64:79], v[12:15], v[132:135], v[64:79]
    v_xor_b32 v46, 96, v43
    buffer_load_dwordx4 v46, s[32:35], s64 offen offset:3072  lds
    s_barrier
    ds_read_b128 v[16:19], v40 offset:2560
    ds_read_b128 v[20:23], v40 offset:2592
    v_mfma_f32_32x32x16_bf16 v[80:95], v[12:15], v[140:143], v[80:95]
    v_mfma_f32_32x32x16_bf16 v[96:111], v[12:15], v[148:151], v[96:111]
    v_mfma_f32_32x32x16_bf16 v[112:127], v[12:15], v[156:159], v[112:127]
    s_waitcnt lgkmcnt(0)
    v_mfma_f32_32x32x16_bf16 v[64:79], v[16:19], v[160:163], v[64:79]
    s_min_u32 s64, s54, 13
    s_lshr_b32 s64, s64, 1
    s_mul_i32 s65, s52, 7
    s_add_u32 s64, s64, s65
    s_lshl_b32 s64, s64, 15
    s_add_u32 s64, s64, s69
    s_add_u32 s64, s64, 4096
    s_add_u32 m0, s69, 4096
    v_lshlrev_b32 v43, 4, v0
    s_and_b32 s65, s56, 1
    s_lshl_b32 s65, s65, 7
    v_xor_b32 v43, s65, v43
    v_xor_b32 v46, 0, v43
    buffer_load_dwordx4 v46, s[32:35], s64 offen offset:0  lds
    v_xor_b32 v46, 32, v43
    buffer_load_dwordx4 v46, s[32:35], s64 offen offset:1024  lds
    v_xor_b32 v46, 64, v43
    buffer_load_dwordx4 v46, s[32:35], s64 offen offset:2048  lds
    v_xor_b32 v46, 96, v43
    buffer_load_dwordx4 v46, s[32:35], s64 offen offset:3072  lds
    v_mfma_f32_32x32x16_bf16 v[80:95], v[16:19], v[168:171], v[80:95]
    ds_read_b64_tr_b16 v[224:225], v32 offset:32768
    ds_read_b64_tr_b16 v[226:227], v33 offset:32768
    ds_read_b64_tr_b16 v[232:233], v34 offset:32768
    ds_read_b64_tr_b16 v[234:235], v35 offset:32768
    v_mfma_f32_32x32x16_bf16 v[96:111], v[16:19], v[176:179], v[96:111]
    ds_read_b64_tr_b16 v[240:241], v36 offset:32768
    ds_read_b64_tr_b16 v[242:243], v37 offset:32768
    ds_read_b64_tr_b16 v[248:249], v38 offset:32768
    ds_read_b64_tr_b16 v[250:251], v39 offset:32768
    v_mfma_f32_32x32x16_bf16 v[112:127], v[16:19], v[184:187], v[112:127]
    ds_read_b64_tr_b16 v[228:229], v32 offset:49152
    ds_read_b64_tr_b16 v[230:231], v33 offset:49152
    ds_read_b64_tr_b16 v[236:237], v34 offset:49152
    ds_read_b64_tr_b16 v[238:239], v35 offset:49152
    v_mfma_f32_32x32x16_bf16 v[64:79], v[20:23], v[164:167], v[64:79]
    ds_read_b64_tr_b16 v[244:245], v36 offset:49152
    ds_read_b64_tr_b16 v[246:247], v37 offset:49152
    ds_read_b64_tr_b16 v[252:253], v38 offset:49152
    ds_read_b64_tr_b16 v[254:255], v39 offset:49152
    s_barrier
    v_lshrrev_b32 v44, 1, v2
    v_and_b32 v45, 1, v2
    v_lshl_add_u32 v44, v44, 2, v45
    v_lshlrev_b32 v44, 17, v44
    v_lshl_add_u32 v44, v1, 4, v44
    s_lshl_b32 s65, s79, 15
    s_lshl_b32 s66, s55, 8
    s_add_u32 s65, s65, s66
    s_add_u32 s65, s65, 2867200
    s_mov_b32 s67, 0x00010001
    ds_read_b128 v[8:11], v40 offset:0
    ds_read_b128 v[12:15], v40 offset:32
    v_mfma_f32_32x32x16_bf16 v[80:95], v[20:23], v[172:175], v[80:95]
    v_mfma_f32_32x32x16_bf16 v[96:111], v[20:23], v[180:183], v[96:111]
    v_mfma_f32_32x32x16_bf16 v[112:127], v[20:23], v[188:191], v[112:127]
    s_waitcnt lgkmcnt(0)
    v_mfma_f32_32x32x16_bf16 v[64:79], v[8:11], v[192:195], v[64:79]
    v_mfma_f32_32x32x16_bf16 v[80:95], v[8:11], v[200:203], v[80:95]
    v_mfma_f32_32x32x16_bf16 v[96:111], v[8:11], v[208:211], v[96:111]
    v_mfma_f32_32x32x16_bf16 v[112:127], v[8:11], v[216:219], v[112:127]
    v_mfma_f32_32x32x16_bf16 v[64:79], v[12:15], v[196:199], v[64:79]
    v_mfma_f32_32x32x16_bf16 v[80:95], v[12:15], v[204:207], v[80:95]
    s_barrier
    ds_read_b32 v42, v41
    ds_read_b128 v[16:19], v40 offset:2560
    ds_read_b128 v[20:23], v40 offset:2592
    v_mfma_f32_32x32x16_bf16 v[96:111], v[12:15], v[212:215], v[96:111]
    v_mfma_f32_32x32x16_bf16 v[112:127], v[12:15], v[220:223], v[112:127]
    s_waitcnt lgkmcnt(0)
    v_readfirstlane_b32 s64, v42
    s_cmp_lg_u32 s64, 0
    s_cbranch_scc1 L_pv_redo
    v_mfma_f32_32x32x16_bf16 v[64:79], v[16:19], v[224:227], v[64:79]
    v_mfma_f32_32x32x16_bf16 v[80:95], v[16:19], v[232:235], v[80:95]
    v_mfma_f32_32x32x16_bf16 v[96:111], v[16:19], v[240:243], v[96:111]
    v_mfma_f32_32x32x16_bf16 v[112:127], v[16:19], v[248:251], v[112:127]
    v_mfma_f32_32x32x16_bf16 v[64:79], v[20:23], v[228:231], v[64:79]
    v_mfma_f32_32x32x16_bf16 v[80:95], v[20:23], v[236:239], v[80:95]
    v_mfma_f32_32x32x16_bf16 v[96:111], v[20:23], v[244:247], v[96:111]
    v_mfma_f32_32x32x16_bf16 v[112:127], v[20:23], v[252:255], v[112:127]
    s_nop 9
    v_cvt_pk_bf16_f32 v160, v64, v80
    v_cvt_pk_bf16_f32 v161, v65, v81
    v_cvt_pk_bf16_f32 v162, v96, v112
    v_cvt_pk_bf16_f32 v163, v97, v113
    v_cvt_pk_bf16_f32 v164, v66, v82
    v_cvt_pk_bf16_f32 v165, v67, v83
    v_cvt_pk_bf16_f32 v166, v98, v114
    v_cvt_pk_bf16_f32 v167, v99, v115
    v_permlane16_swap_b32 v160, v161
    v_permlane16_swap_b32 v162, v163
    v_bfi_b32 v160, s67, v4, v160
    v_bfi_b32 v161, s67, v5, v161
    v_bfi_b32 v162, s67, v6, v162
    v_bfi_b32 v163, s67, v7, v163
    s_add_u32 s66, s65, 0
    buffer_store_dwordx4 v[160:163], v44, s[48:51], s66 offen sc1
    v_cvt_pk_bf16_f32 v168, v68, v84
    v_cvt_pk_bf16_f32 v169, v69, v85
    v_cvt_pk_bf16_f32 v170, v100, v116
    v_cvt_pk_bf16_f32 v171, v101, v117
    v_permlane16_swap_b32 v164, v165
    v_permlane16_swap_b32 v166, v167
    v_bfi_b32 v164, s67, v4, v164
    v_bfi_b32 v165, s67, v5, v165
    v_bfi_b32 v166, s67, v6, v166
    v_bfi_b32 v167, s67, v7, v167
    s_add_u32 s66, s65, 262144
    buffer_store_dwordx4 v[164:167], v44, s[48:51], s66 offen sc1
    v_cvt_pk_bf16_f32 v172, v70, v86
    v_cvt_pk_bf16_f32 v173, v71, v87
    v_cvt_pk_bf16_f32 v174, v102, v118
    v_cvt_pk_bf16_f32 v175, v103, v119
    v_permlane16_swap_b32 v168, v169
    v_permlane16_swap_b32 v170, v171
    v_bfi_b32 v168, s67, v4, v168
    v_bfi_b32 v169, s67, v5, v169
    v_bfi_b32 v170, s67, v6, v170
    v_bfi_b32 v171, s67, v7, v171
    s_add_u32 s66, s65, 1048576
    buffer_store_dwordx4 v[168:171], v44, s[48:51], s66 offen sc1
    v_cvt_pk_bf16_f32 v176, v72, v88
    v_cvt_pk_bf16_f32 v177, v73, v89
    v_cvt_pk_bf16_f32 v178, v104, v120
    v_cvt_pk_bf16_f32 v179, v105, v121
    v_permlane16_swap_b32 v172, v173
    v_permlane16_swap_b32 v174, v175
    v_bfi_b32 v172, s67, v4, v172
    v_bfi_b32 v173, s67, v5, v173
    v_bfi_b32 v174, s67, v6, v174
    v_bfi_b32 v175, s67, v7, v175
    s_add_u32 s66, s65, 1310720
    buffer_store_dwordx4 v[172:175], v44, s[48:51], s66 offen sc1
    v_cvt_pk_bf16_f32 v180, v74, v90
    v_cvt_pk_bf16_f32 v181, v75, v91
    v_cvt_pk_bf16_f32 v182, v106, v122
    v_cvt_pk_bf16_f32 v183, v107, v123
    v_permlane16_swap_b32 v176, v177
    v_permlane16_swap_b32 v178, v179
    v_bfi_b32 v176, s67, v4, v176
    v_bfi_b32 v177, s67, v5, v177
    v_bfi_b32 v178, s67, v6, v178
    v_bfi_b32 v179, s67, v7, v179
    s_add_u32 s66, s65, 2097152
    buffer_store_dwordx4 v[176:179], v44, s[48:51], s66 offen sc1
    v_cvt_pk_bf16_f32 v184, v76, v92
    v_cvt_pk_bf16_f32 v185, v77, v93
    v_cvt_pk_bf16_f32 v186, v108, v124
    v_cvt_pk_bf16_f32 v187, v109, v125
    v_permlane16_swap_b32 v180, v181
    v_permlane16_swap_b32 v182, v183
    v_bfi_b32 v180, s67, v4, v180
    v_bfi_b32 v181, s67, v5, v181
    v_bfi_b32 v182, s67, v6, v182
    v_bfi_b32 v183, s67, v7, v183
    s_add_u32 s66, s65, 2359296
    buffer_store_dwordx4 v[180:183], v44, s[48:51], s66 offen sc1
    v_cvt_pk_bf16_f32 v188, v78, v94
    v_cvt_pk_bf16_f32 v189, v79, v95
    v_cvt_pk_bf16_f32 v190, v110, v126
    v_cvt_pk_bf16_f32 v191, v111, v127
    v_permlane16_swap_b32 v184, v185
    v_permlane16_swap_b32 v186, v187
    v_bfi_b32 v184, s67, v4, v184
    v_bfi_b32 v185, s67, v5, v185
    v_bfi_b32 v186, s67, v6, v186
    v_bfi_b32 v187, s67, v7, v187
    s_add_u32 s66, s65, 3145728
    buffer_store_dwordx4 v[184:187], v44, s[48:51], s66 offen sc1
    v_permlane16_swap_b32 v188, v189
    v_permlane16_swap_b32 v190, v191
    v_bfi_b32 v188, s67, v4, v188
    v_bfi_b32 v189, s67, v5, v189
    v_bfi_b32 v190, s67, v6, v190
    v_bfi_b32 v191, s67, v7, v191
    s_add_u32 s66, s65, 3407872
    buffer_store_dwordx4 v[188:191], v44, s[48:51], s66 offen sc1
    s_branch L_att_post
L_pv_redo:
    s_waitcnt vmcnt(0) lgkmcnt(0)
    s_barrier
    s_mov_b32 s72, 1
    s_nop 7
    s_branch L_pv_start
L_qk:
    s_load_dword s57, s[48:49], 0
    s_load_dwordx2 s[28:29], s[0:1], 56
    s_load_dwordx2 s[32:33], s[0:1], 64
    s_mov_b32 s30, 1835008
    s_mov_b32 s31, 0x00020000
    s_mov_b32 s34, 1835008
    s_mov_b32 s35, 0x00020000
    s_and_b32 s68, s56, 1
    s_lshr_b32 s69, s56, 1
    v_and_b32 v32, 3, v1
    v_lshlrev_b32 v32, 2, v32
    v_lshrrev_b32 v33, 2, v1
    v_lshlrev_b32 v33, 1, v33
    v_mov_b32 v34, 120
    v_lshrrev_b32 v33, v33, v34
    v_and_b32 v33, 3, v33
    v_or_b32 v32, v32, v33
    v_xor_b32 v32, v32, v2
    v_lshlrev_b32 v33, 10, v1
    s_mul_i32 s64, s68, 16896
    v_add_u32 v33, s64, v33
    v_xor_b32 v100, 0, v32
    v_lshl_add_u32 v100, v100, 4, v33
    v_xor_b32 v96, 0x4000, v100
    v_add_u32 v104, 0x10000, v96
    v_add_u32 v108, 0x10000, v100
    v_xor_b32 v101, 4, v32
    v_lshl_add_u32 v101, v101, 4, v33
    v_xor_b32 v97, 0x4000, v101
    v_add_u32 v105, 0x10000, v97
    v_add_u32 v109, 0x10000, v101
    v_xor_b32 v102, 8, v32
    v_lshl_add_u32 v102, v102, 4, v33
    v_xor_b32 v98, 0x4000, v102
    v_add_u32 v106, 0x10000, v98
    v_add_u32 v110, 0x10000, v102
    v_xor_b32 v103, 12, v32
    v_lshl_add_u32 v103, v103, 4, v33
    v_xor_b32 v99, 0x4000, v103
    v_add_u32 v107, 0x10000, v99
    v_add_u32 v111, 0x10000, v103
    v_lshlrev_b32 v112, 4, v0
    s_lshl_b32 s64, s56, 10
    s_add_u32 s64, s64, 139264
    v_add_u32 v112, s64, v112
    v_xor_b32 v113, 1024, v112
    s_lshl_b32 s64, s69, 4
    v_add_u32 v32, s64, v1
    v_mul_u32_u24 v27, 80, v32
    v_lshl_add_u32 v27, v2, 3, v27
    s_lshl_b32 s64, s68, 5
    s_add_u32 s64, s64, 131072
    v_add_u32 v27, s64, v27
    v_lshlrev_b32 v29, 5, v32
    v_add_u32 v29, 136192, v29
    v_lshl_add_u32 v28, v2, 2, v29
    s_lshl_b32 s64, s68, 4
    v_add_u32 v28, s64, v28
    v_lshlrev_b32 v30, 2, v32
    s_lshl_b32 s64, s68, 7
    s_add_u32 s64, s64, 137472
    v_add_u32 v62, s64, v30
    v_add_u32 v30, 137216, v30
    v_mov_b32 v31, 137344
    s_waitcnt lgkmcnt(0)
    s_mul_i32 s57, s57, 0x9e3779b1
    s_add_u32 s57, s57, 0x7f4a7c15
    s_and_b32 s58, s57, 0xffff
    s_lshr_b32 s59, s57, 16
    s_mov_b32 s72, 0
L_qk_start:
    v_mov_b32 v25, 0
    v_mov_b32 v26, 0
    v_mov_b32 v40, 0
    v_mov_b32 v41, 0
    v_mov_b32 v42, 1
    ds_write_b64 v31, v[40:41]
    v_lshlrev_b32 v43, 6, v1
    v_lshl_add_u32 v43, v2, 4, v43
    v_add_u32 v46, 2560, v27
    v_xor_b32 v46, v46, v27
    s_barrier
    ds_read_b128 v[128:131], v96 offset:0
    ds_read_b128 v[132:135], v97 offset:0
    ds_read_b128 v[136:139], v98 offset:0
    ds_read_b128 v[140:143], v99 offset:0
    ds_read_b128 v[144:147], v96 offset:256
    ds_read_b128 v[148:151], v97 offset:256
    ds_read_b128 v[152:155], v98 offset:256
    ds_read_b128 v[156:159], v99 offset:256
    ds_read_b128 v[160:163], v100 offset:0
    ds_read_b128 v[164:167], v101 offset:0
    ds_read_b128 v[168:171], v102 offset:0
    ds_read_b128 v[172:175], v103 offset:0
    ds_read_b128 v[176:179], v100 offset:256
    ds_read_b128 v[180:183], v101 offset:256
    ds_read_b128 v[184:187], v102 offset:256
    ds_read_b128 v[188:191], v103 offset:256
    s_waitcnt lgkmcnt(0)
    s_barrier
    ds_read_b128 v[192:195], v96 offset:32768
    ds_read_b128 v[196:199], v97 offset:32768
    ds_read_b128 v[200:203], v98 offset:32768
    ds_read_b128 v[204:207], v99 offset:32768
    ds_read_b128 v[208:211], v96 offset:33024
    ds_read_b128 v[212:215], v97 offset:33024
    ds_read_b128 v[216:219], v98 offset:33024
    ds_read_b128 v[220:223], v99 offset:33024
    ds_read_b128 v[224:227], v100 offset:32768
    ds_read_b128 v[228:231], v101 offset:32768
    ds_read_b128 v[232:235], v102 offset:32768
    ds_read_b128 v[236:239], v103 offset:32768
    ds_read_b128 v[240:243], v100 offset:33024
    ds_read_b128 v[244:247], v101 offset:33024
    ds_read_b128 v[248:251], v102 offset:33024
    ds_read_b128 v[252:255], v103 offset:33024
    s_waitcnt lgkmcnt(0)
    s_barrier
    s_cmp_lg_u32 s72, 0
    s_cbranch_scc1 L_noq
    v_mov_b32 v44, 0
    s_and_b32 s64, s55, 0x73
    s_or_b32 s64, s64, 4
    s_lshl_b32 s64, s64, 7
    s_add_u32 s64, s64, 524288
    s_not_b32 s65, s57
    s_mov_b32 s63, 60000
    s_cmp_lg_u32 s56, 0
    s_cbranch_scc1 foll_55
poll_53:
    s_load_dwordx2 s[66:67], s[48:49], s64 glc
    s_waitcnt lgkmcnt(0)
    s_xor_b32 s66, s66, s57
    s_xor_b32 s67, s67, s65
    s_or_b32 s66, s66, s67
    s_cbranch_scc0 seen_56
    s_sub_u32 s63, s63, 1
    s_cbranch_scc0 poll_53
seen_56:
    ds_write_b32 v31, v42 offset:4
foll_55:
    s_lshl_b32 s64, s52, 15
    s_lshl_b32 s65, s56, 13
    s_add_u32 s64, s64, s65
    s_add_u32 s64, s64, 196608
    s_add_u32 s65, s64, 4096
    s_add_u32 s66, s64, 8192
    s_add_u32 s67, s64, 12288
    s_barrier
    buffer_load_dwordx4 v[64:67], v43, s[48:51], s64 offen offset:0 sc1
    buffer_load_dwordx4 v[68:71], v43, s[48:51], s64 offen offset:1024 sc1
    buffer_load_dwordx4 v[72:75], v43, s[48:51], s64 offen offset:2048 sc1
    buffer_load_dwordx4 v[76:79], v43, s[48:51], s64 offen offset:3072 sc1
    buffer_load_dwordx4 v[80:83], v43, s[48:51], s65 offen offset:0 sc1
    buffer_load_dwordx4 v[84:87], v43, s[48:51], s65 offen offset:1024 sc1
    buffer_load_dwordx4 v[88:91], v43, s[48:51], s65 offen offset:2048 sc1
    buffer_load_dwordx4 v[92:95], v43, s[48:51], s65 offen offset:3072 sc1
    s_barrier
    s_mov_b32 s63, 60000
poll_57:
    s_waitcnt vmcnt(0)
    v_max3_u32 v48, v64, v68, v72
    v_max3_u32 v48, v48, v76, v80
    v_max3_u32 v48, v48, v84, v88
    v_max_u32 v48, v48, v92
    v_cmp_eq_u32 vcc, -1, v48
    s_cbranch_vccz pdone_58
    v_cmp_eq_u32 vcc, -1, v64
    s_cbranch_vccz qn_59
    buffer_load_dwordx4 v[64:67], v43, s[48:51], s64 offen offset:0 sc1
qn_59:
    v_cmp_eq_u32 vcc, -1, v68
    s_cbranch_vccz qn_60
    buffer_load_dwordx4 v[68:71], v43, s[48:51], s64 offen offset:1024 sc1
qn_60:
    v_cmp_eq_u32 vcc, -1, v72
    s_cbranch_vccz qn_61
    buffer_load_dwordx4 v[72:75], v43, s[48:51], s64 offen offset:2048 sc1
qn_61:
    v_cmp_eq_u32 vcc, -1, v76
    s_cbranch_vccz qn_62
    buffer_load_dwordx4 v[76:79], v43, s[48:51], s64 offen offset:3072 sc1
qn_62:
    v_cmp_eq_u32 vcc, -1, v80
    s_cbranch_vccz qn_63
    buffer_load_dwordx4 v[80:83], v43, s[48:51], s65 offen offset:0 sc1
qn_63:
    v_cmp_eq_u32 vcc, -1, v84
    s_cbranch_vccz qn_64
    buffer_load_dwordx4 v[84:87], v43, s[48:51], s65 offen offset:1024 sc1
qn_64:
    v_cmp_eq_u32 vcc, -1, v88
    s_cbranch_vccz qn_65
    buffer_load_dwordx4 v[88:91], v43, s[48:51], s65 offen offset:2048 sc1
qn_65:
    v_cmp_eq_u32 vcc, -1, v92
    s_cbranch_vccz qn_66
    buffer_load_dwordx4 v[92:95], v43, s[48:51], s65 offen offset:3072 sc1
qn_66:
    s_sub_u32 s63, s63, 1
    s_cbranch_scc0 poll_57
    s_waitcnt vmcnt(0)
pdone_58:
    s_branch L_go
L_noq:
    s_barrier
    s_barrier
L_go:
    s_mov_b32 s66, 0x3db504f3
    s_mov_b32 s67, 0x3fb8aa3b
    s_mov_b32 s65, 0x42800000
    s_setprio 1
    v_mfma_f32_16x16x32_bf16 v[16:19], v[128:131], v[64:67], 0
    ds_read_b128 v[128:131], v104 offset:0
    v_mfma_f32_16x16x32_bf16 v[16:19], v[132:135], v[68:71], v[16:19]
    ds_read_b128 v[132:135], v105 offset:0
    v_mfma_f32_16x16x32_bf16 v[16:19], v[136:139], v[72:75], v[16:19]
    ds_read_b128 v[136:139], v106 offset:0
    v_mfma_f32_16x16x32_bf16 v[16:19], v[140:143], v[76:79], v[16:19]
    ds_read_b128 v[140:143], v107 offset:0
    v_mfma_f32_16x16x32_bf16 v[16:19], v[144:147], v[80:83], v[16:19]
    ds_read_b128 v[144:147], v104 offset:256
    v_mfma_f32_16x16x32_bf16 v[16:19], v[148:151], v[84:87], v[16:19]
    ds_read_b128 v[148:151], v105 offset:256
    v_mfma_f32_16x16x32_bf16 v[16:19], v[152:155], v[88:91], v[16:19]
    ds_read_b128 v[152:155], v106 offset:256
    v_mfma_f32_16x16x32_bf16 v[16:19], v[156:159], v[92:95], v[16:19]
    ds_read_b128 v[156:159], v107 offset:256
    v_mfma_f32_16x16x32_bf16 v[8:11], v[160:163], v[64:67], 0
    ds_read_b128 v[160:163], v108 offset:0
    v_mfma_f32_16x16x32_bf16 v[8:11], v[164:167], v[68:71], v[8:11]
    ds_read_b128 v[164:167], v109 offset:0
    v_mfma_f32_16x16x32_bf16 v[8:11], v[168:171], v[72:75], v[8:11]
    ds_read_b128 v[168:171], v110 offset:0
    v_mfma_f32_16x16x32_bf16 v[8:11], v[172:175], v[76:79], v[8:11]
    ds_write_b128 v112, v[16:19] offset:0
    ds_read_b128 v[172:175], v111 offset:0
    v_mfma_f32_16x16x32_bf16 v[8:11], v[176:179], v[80:83], v[8:11]
    ds_read_b128 v[176:179], v108 offset:256
    v_mfma_f32_16x16x32_bf16 v[8:11], v[180:183], v[84:87], v[8:11]
    ds_read_b128 v[180:183], v109 offset:256
    v_mfma_f32_16x16x32_bf16 v[8:11], v[184:187], v[88:91], v[8:11]
    ds_read_b128 v[184:187], v110 offset:256
    v_mfma_f32_16x16x32_bf16 v[8:11], v[188:191], v[92:95], v[8:11]
    ds_read_b128 v[188:191], v111 offset:256
    v_mov_b32 v48, v16
    v_mov_b32 v49, v17
    v_mov_b32 v50, v18
    v_mov_b32 v51, v19
    s_nop 2
    ds_write_b128 v112, v[8:11] offset:8192
    s_waitcnt lgkmcnt(0)
    s_barrier
    ds_read_b128 v[20:23], v113 offset:0
    ds_read_b128 v[52:55], v113 offset:8192
    v_mfma_f32_16x16x32_bf16 v[16:19], v[192:195], v[64:67], 0
    v_mfma_f32_16x16x32_bf16 v[16:19], v[196:199], v[68:71], v[16:19]
    ds_read_b128 v[192:195], v104 offset:32768
    ds_read_b128 v[196:199], v105 offset:32768
    v_mfma_f32_16x16x32_bf16 v[16:19], v[200:203], v[72:75], v[16:19]
    v_mfma_f32_16x16x32_bf16 v[16:19], v[204:207], v[76:79], v[16:19]
    ds_read_b128 v[200:203], v106 offset:32768
    ds_read_b128 v[204:207], v107 offset:32768
    s_waitcnt lgkmcnt(4)
    v_add_f32 v8, v8, v20
    v_add_f32 v9, v9, v21
    v_add_f32 v48, v48, v52
    v_add_f32 v10, v10, v22
    v_add_f32 v11, v11, v23
    v_add_f32 v49, v49, v53
    v_cvt_pk_bf16_f32 v32, 0, v8
    v_cvt_pk_bf16_f32 v33, 0, v9
    v_mfma_f32_16x16x32_bf16 v[16:19], v[208:211], v[80:83], v[16:19]
    v_mfma_f32_16x16x32_bf16 v[16:19], v[212:215], v[84:87], v[16:19]
    ds_read_b128 v[208:211], v104 offset:33024
    ds_read_b128 v[212:215], v105 offset:33024
    v_add_f32 v50, v50, v54
    v_cvt_pk_bf16_f32 v34, 0, v10
    v_cvt_pk_bf16_f32 v35, 0, v11
    v_add_f32 v51, v51, v55
    v_mul_f32 v32, s66, v32
    v_mul_f32 v33, s66, v33
    v_max3_f32 v48, v48, v49, v50
    v_mul_f32 v34, s66, v34
    v_mul_f32 v35, s66, v35
    v_mfma_f32_16x16x32_bf16 v[16:19], v[216:219], v[88:91], v[16:19]
    v_mfma_f32_16x16x32_bf16 v[16:19], v[220:223], v[92:95], v[16:19]
    ds_read_b128 v[216:219], v106 offset:33024
    ds_read_b128 v[220:223], v107 offset:33024
    v_max_f32 v48, v48, v51
    v_cvt_pk_bf16_f32 v56, 0, v32
    v_cvt_pk_bf16_f32 v57, 0, v33
    v_cvt_pk_bf16_f32 v48, 0, v48
    v_cvt_pk_bf16_f32 v58, 0, v34
    v_cvt_pk_bf16_f32 v59, 0, v35
    v_mul_f32 v48, s66, v48
    v_cvt_pk_bf16_f32 v48, 0, v48
    v_mfma_f32_16x16x32_bf16 v[12:15], v[224:227], v[64:67], 0
    v_mfma_f32_16x16x32_bf16 v[12:15], v[228:231], v[68:71], v[12:15]
    ds_read_b128 v[224:227], v108 offset:32768
    ds_read_b128 v[228:231], v109 offset:32768
    v_max3_f32 v48, v48, v56, v57
    v_max3_f32 v48, v48, v58, v59
    v_mov_b32 v49, v48
    s_nop 1
    v_permlane16_swap_b32 v49, v48
    v_max_f32 v48, v48, v49
    v_mov_b32 v49, v48
    s_nop 1
    v_permlane32_swap_b32 v49, v48
    v_max_f32 v48, v48, v49
    s_cmp_lg_u32 s72, 0
    s_cbranch_scc1 p2_67
    v_mul_f32 v24, s67, v48
p2_67:
    v_mfma_f32_16x16x32_bf16 v[12:15], v[232:235], v[72:75], v[12:15]
    v_mfma_f32_16x16x32_bf16 v[12:15], v[236:239], v[76:79], v[12:15]
    ds_write_b128 v112, v[16:19] offset:4096
    ds_read_b128 v[232:235], v110 offset:32768
    ds_read_b128 v[236:239], v111 offset:32768
    v_fma_f32 v32, v56, s67, -v24
    v_fma_f32 v33, v57, s67, -v24
    v_fma_f32 v34, v58, s67, -v24
    v_fma_f32 v35, v59, s67, -v24
    v_max3_f32 v26, v26, v32, v33
    v_max3_f32 v26, v26, v34, v35
    v_exp_f32 v32, v32
    v_exp_f32 v33, v33
    v_exp_f32 v34, v34
    v_mfma_f32_16x16x32_bf16 v[12:15], v[240:243], v[80:83], v[12:15]
    v_mfma_f32_16x16x32_bf16 v[12:15], v[244:247], v[84:87], v[12:15]
    ds_read_b128 v[240:243], v108 offset:33024
    ds_read_b128 v[244:247], v109 offset:33024
    v_exp_f32 v35, v35
    v_cvt_pk_bf16_f32 v36, v32, v33
    v_cvt_pk_bf16_f32 v37, v34, v35
    ds_write_b64 v27, v[36:37] offset:0
    v_add_f32 v32, v32, v33
    v_add_f32 v34, v34, v35
    v_add_f32 v25, v25, v32
    v_add_f32 v25, v25, v34
    v_mfma_f32_16x16x32_bf16 v[12:15], v[248:251], v[88:91], v[12:15]
    v_mfma_f32_16x16x32_bf16 v[12:15], v[252:255], v[92:95], v[12:15]
    ds_read_b128 v[248:251], v110 offset:33024
    ds_read_b128 v[252:255], v111 offset:33024
    s_waitcnt lgkmcnt(0)
    s_barrier
    ds_read_b128 v[20:23], v113 offset:4096
    v_mfma_f32_16x16x32_bf16 v[16:19], v[128:131], v[64:67], 0
    v_mfma_f32_16x16x32_bf16 v[16:19], v[132:135], v[68:71], v[16:19]
    v_mfma_f32_16x16x32_bf16 v[16:19], v[136:139], v[72:75], v[16:19]
    v_mfma_f32_16x16x32_bf16 v[16:19], v[140:143], v[76:79], v[16:19]
    v_mfma_f32_16x16x32_bf16 v[16:19], v[144:147], v[80:83], v[16:19]
    v_mfma_f32_16x16x32_bf16 v[16:19], v[148:151], v[84:87], v[16:19]
    s_waitcnt lgkmcnt(0)
    v_add_f32 v12, v12, v20
    v_add_f32 v13, v13, v21
    v_add_f32 v14, v14, v22
    v_add_f32 v15, v15, v23
    v_cvt_pk_bf16_f32 v32, 0, v12
    v_cvt_pk_bf16_f32 v33, 0, v13
    v_mfma_f32_16x16x32_bf16 v[16:19], v[152:155], v[88:91], v[16:19]
    v_mfma_f32_16x16x32_bf16 v[16:19], v[156:159], v[92:95], v[16:19]
    v_cvt_pk_bf16_f32 v34, 0, v14
    v_cvt_pk_bf16_f32 v35, 0, v15
    v_mul_f32 v32, s66, v32
    v_mul_f32 v33, s66, v33
    v_mul_f32 v34, s66, v34
    v_mul_f32 v35, s66, v35
    v_cvt_pk_bf16_f32 v56, 0, v32
    v_mfma_f32_16x16x32_bf16 v[8:11], v[160:163], v[64:67], 0
    v_mfma_f32_16x16x32_bf16 v[8:11], v[164:167], v[68:71], v[8:11]
    v_cvt_pk_bf16_f32 v57, 0, v33
    v_cvt_pk_bf16_f32 v58, 0, v34
    v_cvt_pk_bf16_f32 v59, 0, v35
    v_fma_f32 v32, v56, s67, -v24
    v_fma_f32 v33, v57, s67, -v24
    v_fma_f32 v34, v58, s67, -v24
    v_fma_f32 v35, v59, s67, -v24
    v_mfma_f32_16x16x32_bf16 v[8:11], v[168:171], v[72:75], v[8:11]
    v_mfma_f32_16x16x32_bf16 v[8:11], v[172:175], v[76:79], v[8:11]
    ds_write_b128 v112, v[16:19] offset:0
    v_max3_f32 v26, v26, v32, v33
    v_max3_f32 v26, v26, v34, v35
    v_exp_f32 v32, v32
    v_exp_f32 v33, v33
    v_exp_f32 v34, v34
    v_exp_f32 v35, v35
    v_cvt_pk_bf16_f32 v36, v32, v33
    v_mfma_f32_16x16x32_bf16 v[8:11], v[176:179], v[80:83], v[8:11]
    v_mfma_f32_16x16x32_bf16 v[8:11], v[180:183], v[84:87], v[8:11]
    v_cvt_pk_bf16_f32 v37, v34, v35
    ds_write_b64 v27, v[36:37] offset:2560
    v_add_f32 v32, v32, v33
    v_add_f32 v34, v34, v35
    v_add_f32 v25, v25, v32
    v_add_f32 v25, v25, v34
    v_mfma_f32_16x16x32_bf16 v[8:11], v[184:187], v[88:91], v[8:11]
    v_mfma_f32_16x16x32_bf16 v[8:11], v[188:191], v[92:95], v[8:11]
    s_waitcnt lgkmcnt(0)
    s_barrier
    ds_read_b128 v[20:23], v113 offset:0
    v_mfma_f32_16x16x32_bf16 v[16:19], v[192:195], v[64:67], 0
    v_mfma_f32_16x16x32_bf16 v[16:19], v[196:199], v[68:71], v[16:19]
    ds_read_b128 v[128:131], v96 offset:0
    ds_read_b128 v[132:135], v97 offset:0
    ds_read_b128 v[136:139], v98 offset:0
    v_mfma_f32_16x16x32_bf16 v[16:19], v[200:203], v[72:75], v[16:19]
    v_mfma_f32_16x16x32_bf16 v[16:19], v[204:207], v[76:79], v[16:19]
    ds_read_b128 v[140:143], v99 offset:0
    ds_read_b128 v[144:147], v96 offset:256
    ds_read_b128 v[148:151], v97 offset:256
    v_mfma_f32_16x16x32_bf16 v[16:19], v[208:211], v[80:83], v[16:19]
    v_mfma_f32_16x16x32_bf16 v[16:19], v[212:215], v[84:87], v[16:19]
    ds_read_b128 v[152:155], v98 offset:256
    ds_read_b128 v[156:159], v99 offset:256
    s_waitcnt lgkmcnt(8)
    v_add_f32 v8, v8, v20
    v_add_f32 v9, v9, v21
    v_add_f32 v10, v10, v22
    v_add_f32 v11, v11, v23
    v_cvt_pk_bf16_f32 v32, 0, v8
    v_cvt_pk_bf16_f32 v33, 0, v9
    v_mfma_f32_16x16x32_bf16 v[16:19], v[216:219], v[88:91], v[16:19]
    v_mfma_f32_16x16x32_bf16 v[16:19], v[220:223], v[92:95], v[16:19]
    ds_read_b128 v[160:163], v100 offset:0
    ds_read_b128 v[164:167], v101 offset:0
    ds_read_b128 v[168:171], v102 offset:0
    v_cvt_pk_bf16_f32 v34, 0, v10
    v_cvt_pk_bf16_f32 v35, 0, v11
    v_mul_f32 v32, s66, v32
    v_mul_f32 v33, s66, v33
    v_mul_f32 v34, s66, v34
    v_mul_f32 v35, s66, v35
    v_cvt_pk_bf16_f32 v56, 0, v32
    v_mfma_f32_16x16x32_bf16 v[12:15], v[224:227], v[64:67], 0
    v_mfma_f32_16x16x32_bf16 v[12:15], v[228:231], v[68:71], v[12:15]
    ds_read_b128 v[172:175], v103 offset:0
    ds_read_b128 v[176:179], v100 offset:256
    ds_read_b128 v[180:183], v101 offset:256
    v_cvt_pk_bf16_f32 v57, 0, v33
    v_cvt_pk_bf16_f32 v58, 0, v34
    v_cvt_pk_bf16_f32 v59, 0, v35
    v_fma_f32 v32, v56, s67, -v24
    v_fma_f32 v33, v57, s67, -v24
    v_fma_f32 v34, v58, s67, -v24
    v_fma_f32 v35, v59, s67, -v24
    v_mfma_f32_16x16x32_bf16 v[12:15], v[232:235], v[72:75], v[12:15]
    v_mfma_f32_16x16x32_bf16 v[12:15], v[236:239], v[76:79], v[12:15]
    ds_write_b128 v112, v[16:19] offset:4096
    ds_read_b128 v[184:187], v102 offset:256
    ds_read_b128 v[188:191], v103 offset:256
    v_max3_f32 v26, v26, v32, v33
    v_max3_f32 v26, v26, v34, v35
    v_exp_f32 v32, v32
    v_exp_f32 v33, v33
    v_exp_f32 v34, v34
    v_exp_f32 v35, v35
    v_cvt_pk_bf16_f32 v36, v32, v33
    v_mfma_f32_16x16x32_bf16 v[12:15], v[240:243], v[80:83], v[12:15]
    v_mfma_f32_16x16x32_bf16 v[12:15], v[244:247], v[84:87], v[12:15]
    v_cvt_pk_bf16_f32 v37, v34, v35
    ds_write_b64 v27, v[36:37] offset:0
    v_add_f32 v32, v32, v33
    v_add_f32 v34, v34, v35
    v_add_f32 v25, v25, v32
    v_add_f32 v25, v25, v34
    v_mfma_f32_16x16x32_bf16 v[12:15], v[248:251], v[88:91], v[12:15]
    v_mfma_f32_16x16x32_bf16 v[12:15], v[252:255], v[92:95], v[12:15]
    s_waitcnt lgkmcnt(0)
    s_barrier
    ds_read_b128 v[20:23], v113 offset:4096
    v_mfma_f32_16x16x32_bf16 v[16:19], v[128:131], v[64:67], 0
    v_mfma_f32_16x16x32_bf16 v[16:19], v[132:135], v[68:71], v[16:19]
    ds_read_b128 v[192:195], v96 offset:32768
    ds_read_b128 v[196:199], v97 offset:32768
    ds_read_b128 v[200:203], v98 offset:32768
    v_mfma_f32_16x16x32_bf16 v[16:19], v[136:139], v[72:75], v[16:19]
    v_mfma_f32_16x16x32_bf16 v[16:19], v[140:143], v[76:79], v[16:19]
    ds_read_b128 v[204:207], v99 offset:32768
    ds_read_b128 v[208:211], v96 offset:33024
    ds_read_b128 v[212:215], v97 offset:33024
    v_mfma_f32_16x16x32_bf16 v[16:19], v[144:147], v[80:83], v[16:19]
    v_mfma_f32_16x16x32_bf16 v[16:19], v[148:151], v[84:87], v[16:19]
    ds_read_b128 v[216:219], v98 offset:33024
    ds_read_b128 v[220:223], v99 offset:33024
    s_waitcnt lgkmcnt(8)
    v_add_f32 v12, v12, v20
    v_add_f32 v13, v13, v21
    v_add_f32 v14, v14, v22
    v_add_f32 v15, v15, v23
    v_cvt_pk_bf16_f32 v32, 0, v12
    v_cvt_pk_bf16_f32 v33, 0, v13
    v_mfma_f32_16x16x32_bf16 v[16:19], v[152:155], v[88:91], v[16:19]
    v_mfma_f32_16x16x32_bf16 v[16:19], v[156:159], v[92:95], v[16:19]
    ds_read_b128 v[224:227], v100 offset:32768
    ds_read_b128 v[228:231], v101 offset:32768
    ds_read_b128 v[232:235], v102 offset:32768
    v_cvt_pk_bf16_f32 v34, 0, v14
    v_cvt_pk_bf16_f32 v35, 0, v15
    v_mul_f32 v32, s66, v32
    v_mul_f32 v33, s66, v33
    v_mul_f32 v34, s66, v34
    v_mul_f32 v35, s66, v35
    v_cvt_pk_bf16_f32 v56, 0, v32
    v_mfma_f32_16x16x32_bf16 v[8:11], v[160:163], v[64:67], 0
    v_mfma_f32_16x16x32_bf16 v[8:11], v[164:167], v[68:71], v[8:11]
    ds_read_b128 v[236:239], v103 offset:32768
    ds_read_b128 v[240:243], v100 offset:33024
    ds_read_b128 v[244:247], v101 offset:33024
    v_cvt_pk_bf16_f32 v57, 0, v33
    v_cvt_pk_bf16_f32 v58, 0, v34
    v_cvt_pk_bf16_f32 v59, 0, v35
    v_fma_f32 v32, v56, s67, -v24
    v_fma_f32 v33, v57, s67, -v24
    v_fma_f32 v34, v58, s67, -v24
    v_fma_f32 v35, v59, s67, -v24
    v_mfma_f32_16x16x32_bf16 v[8:11], v[168:171], v[72:75], v[8:11]
    v_mfma_f32_16x16x32_bf16 v[8:11], v[172:175], v[76:79], v[8:11]
    ds_write_b128 v112, v[16:19] offset:0
    ds_read_b128 v[248:251], v102 offset:33024
    ds_read_b128 v[252:255], v103 offset:33024
    v_max3_f32 v26, v26, v32, v33
    v_max3_f32 v26, v26, v34, v35
    v_exp_f32 v32, v32
    v_exp_f32 v33, v33
    v_exp_f32 v34, v34
    v_exp_f32 v35, v35
    v_cvt_pk_bf16_f32 v36, v32, v33
    v_mfma_f32_16x16x32_bf16 v[8:11], v[176:179], v[80:83], v[8:11]
    v_mfma_f32_16x16x32_bf16 v[8:11], v[180:183], v[84:87], v[8:11]
    v_cvt_pk_bf16_f32 v37, v34, v35
    ds_write_b64 v27, v[36:37] offset:2560
    v_add_f32 v32, v32, v33
    v_add_f32 v34, v34, v35
    v_add_f32 v25, v25, v32
    v_add_f32 v25, v25, v34
    v_mfma_f32_16x16x32_bf16 v[8:11], v[184:187], v[88:91], v[8:11]
    v_mfma_f32_16x16x32_bf16 v[8:11], v[188:191], v[92:95], v[8:11]
    s_waitcnt lgkmcnt(0)
    s_barrier
    ds_read_b128 v[20:23], v113 offset:0
    v_mfma_f32_16x16x32_bf16 v[16:19], v[192:195], v[64:67], 0
    v_mfma_f32_16x16x32_bf16 v[16:19], v[196:199], v[68:71], v[16:19]
    ds_read_b128 v[128:131], v104 offset:0
    ds_read_b128 v[132:135], v105 offset:0
    ds_read_b128 v[136:139], v106 offset:0
    v_mfma_f32_16x16x32_bf16 v[16:19], v[200:203], v[72:75], v[16:19]
    v_mfma_f32_16x16x32_bf16 v[16:19], v[204:207], v[76:79], v[16:19]
    ds_read_b128 v[140:143], v107 offset:0
    ds_read_b128 v[144:147], v104 offset:256
    ds_read_b128 v[148:151], v105 offset:256
    v_mfma_f32_16x16x32_bf16 v[16:19], v[208:211], v[80:83], v[16:19]
    v_mfma_f32_16x16x32_bf16 v[16:19], v[212:215], v[84:87], v[16:19]
    ds_read_b128 v[152:155], v106 offset:256
    ds_read_b128 v[156:159], v107 offset:256
    s_waitcnt lgkmcnt(8)
    v_add_f32 v8, v8, v20
    v_add_f32 v9, v9, v21
    v_add_f32 v10, v10, v22
    v_add_f32 v11, v11, v23
    v_cvt_pk_bf16_f32 v32, 0, v8
    v_cvt_pk_bf16_f32 v33, 0, v9
    v_mfma_f32_16x16x32_bf16 v[16:19], v[216:219], v[88:91], v[16:19]
    v_mfma_f32_16x16x32_bf16 v[16:19], v[220:223], v[92:95], v[16:19]
    ds_read_b128 v[160:163], v108 offset:0
    ds_read_b128 v[164:167], v109 offset:0
    ds_read_b128 v[168:171], v110 offset:0
    v_cvt_pk_bf16_f32 v34, 0, v10
    v_cvt_pk_bf16_f32 v35, 0, v11
    v_mul_f32 v32, s66, v32
    v_mul_f32 v33, s66, v33
    v_mul_f32 v34, s66, v34
    v_mul_f32 v35, s66, v35
    v_cvt_pk_bf16_f32 v56, 0, v32
    v_mfma_f32_16x16x32_bf16 v[12:15], v[224:227], v[64:67], 0
    v_mfma_f32_16x16x32_bf16 v[12:15], v[228:231], v[68:71], v[12:15]
    ds_read_b128 v[172:175], v111 offset:0
    ds_read_b128 v[176:179], v108 offset:256
    ds_read_b128 v[180:183], v109 offset:256
    v_cvt_pk_bf16_f32 v57, 0, v33
    v_cvt_pk_bf16_f32 v58, 0, v34
    v_cvt_pk_bf16_f32 v59, 0, v35
    v_fma_f32 v32, v56, s67, -v24
    v_fma_f32 v33, v57, s67, -v24
    v_fma_f32 v34, v58, s67, -v24
    v_fma_f32 v35, v59, s67, -v24
    v_mfma_f32_16x16x32_bf16 v[12:15], v[232:235], v[72:75], v[12:15]
    v_mfma_f32_16x16x32_bf16 v[12:15], v[236:239], v[76:79], v[12:15]
    ds_write_b128 v112, v[16:19] offset:4096
    ds_read_b128 v[184:187], v110 offset:256
    ds_read_b128 v[188:191], v111 offset:256
    v_max3_f32 v26, v26, v32, v33
    v_max3_f32 v26, v26, v34, v35
    v_exp_f32 v32, v32
    v_exp_f32 v33, v33
    v_exp_f32 v34, v34
    v_exp_f32 v35, v35
    v_cvt_pk_bf16_f32 v36, v32, v33
    v_mfma_f32_16x16x32_bf16 v[12:15], v[240:243], v[80:83], v[12:15]
    v_mfma_f32_16x16x32_bf16 v[12:15], v[244:247], v[84:87], v[12:15]
    v_cvt_pk_bf16_f32 v37, v34, v35
    ds_write_b64 v27, v[36:37] offset:0
    v_add_f32 v32, v32, v33
    v_add_f32 v34, v34, v35
    v_add_f32 v25, v25, v32
    v_add_f32 v25, v25, v34
    v_mfma_f32_16x16x32_bf16 v[12:15], v[248:251], v[88:91], v[12:15]
    v_mfma_f32_16x16x32_bf16 v[12:15], v[252:255], v[92:95], v[12:15]
    s_waitcnt lgkmcnt(0)
    s_barrier
    ds_read_b128 v[20:23], v113 offset:4096
    v_mfma_f32_16x16x32_bf16 v[16:19], v[128:131], v[64:67], 0
    v_mfma_f32_16x16x32_bf16 v[16:19], v[132:135], v[68:71], v[16:19]
    ds_read_b128 v[192:195], v104 offset:32768
    ds_read_b128 v[196:199], v105 offset:32768
    ds_read_b128 v[200:203], v106 offset:32768
    v_mfma_f32_16x16x32_bf16 v[16:19], v[136:139], v[72:75], v[16:19]
    v_mfma_f32_16x16x32_bf16 v[16:19], v[140:143], v[76:79], v[16:19]
    ds_read_b128 v[204:207], v107 offset:32768
    ds_read_b128 v[208:211], v104 offset:33024
    ds_read_b128 v[212:215], v105 offset:33024
    v_mfma_f32_16x16x32_bf16 v[16:19], v[144:147], v[80:83], v[16:19]
    v_mfma_f32_16x16x32_bf16 v[16:19], v[148:151], v[84:87], v[16:19]
    ds_read_b128 v[216:219], v106 offset:33024
    ds_read_b128 v[220:223], v107 offset:33024
    s_waitcnt lgkmcnt(8)
    v_add_f32 v12, v12, v20
    v_add_f32 v13, v13, v21
    v_add_f32 v14, v14, v22
    v_add_f32 v15, v15, v23
    v_cvt_pk_bf16_f32 v32, 0, v12
    v_cvt_pk_bf16_f32 v33, 0, v13
    v_mfma_f32_16x16x32_bf16 v[16:19], v[152:155], v[88:91], v[16:19]
    v_mfma_f32_16x16x32_bf16 v[16:19], v[156:159], v[92:95], v[16:19]
    ds_read_b128 v[224:227], v108 offset:32768
    ds_read_b128 v[228:231], v109 offset:32768
    ds_read_b128 v[232:235], v110 offset:32768
    v_cvt_pk_bf16_f32 v34, 0, v14
    v_cvt_pk_bf16_f32 v35, 0, v15
    v_mul_f32 v32, s66, v32
    v_mul_f32 v33, s66, v33
    v_mul_f32 v34, s66, v34
    v_mul_f32 v35, s66, v35
    v_cvt_pk_bf16_f32 v56, 0, v32
    v_mfma_f32_16x16x32_bf16 v[8:11], v[160:163], v[64:67], 0
    v_mfma_f32_16x16x32_bf16 v[8:11], v[164:167], v[68:71], v[8:11]
    ds_read_b128 v[236:239], v111 offset:32768
    ds_read_b128 v[240:243], v108 offset:33024
    ds_read_b128 v[244:247], v109 offset:33024
    v_cvt_pk_bf16_f32 v57, 0, v33
    v_cvt_pk_bf16_f32 v58, 0, v34
    v_cvt_pk_bf16_f32 v59, 0, v35
    v_fma_f32 v32, v56, s67, -v24
    v_fma_f32 v33, v57, s67, -v24
    v_fma_f32 v34, v58, s67, -v24
    v_fma_f32 v35, v59, s67, -v24
    v_mfma_f32_16x16x32_bf16 v[8:11], v[168:171], v[72:75], v[8:11]
    v_mfma_f32_16x16x32_bf16 v[8:11], v[172:175], v[76:79], v[8:11]
    ds_write_b128 v112, v[16:19] offset:0
    ds_read_b128 v[248:251], v110 offset:33024
    ds_read_b128 v[252:255], v111 offset:33024
    v_max3_f32 v26, v26, v32, v33
    v_max3_f32 v26, v26, v34, v35
    v_exp_f32 v32, v32
    v_exp_f32 v33, v33
    v_exp_f32 v34, v34
    v_exp_f32 v35, v35
    v_cvt_pk_bf16_f32 v36, v32, v33
    v_mfma_f32_16x16x32_bf16 v[8:11], v[176:179], v[80:83], v[8:11]
    v_mfma_f32_16x16x32_bf16 v[8:11], v[180:183], v[84:87], v[8:11]
    v_cvt_pk_bf16_f32 v37, v34, v35
    ds_write_b64 v27, v[36:37] offset:2560
    v_add_f32 v32, v32, v33
    v_add_f32 v34, v34, v35
    v_add_f32 v25, v25, v32
    v_add_f32 v25, v25, v34
    v_mfma_f32_16x16x32_bf16 v[8:11], v[184:187], v[88:91], v[8:11]
    v_mfma_f32_16x16x32_bf16 v[8:11], v[188:191], v[92:95], v[8:11]
    s_waitcnt lgkmcnt(0)
    s_barrier
    ds_read_b128 v[20:23], v113 offset:0
    v_mfma_f32_16x16x32_bf16 v[16:19], v[192:195], v[64:67], 0
    v_mfma_f32_16x16x32_bf16 v[16:19], v[196:199], v[68:71], v[16:19]
    v_mfma_f32_16x16x32_bf16 v[16:19], v[200:203], v[72:75], v[16:19]
    v_mfma_f32_16x16x32_bf16 v[16:19], v[204:207], v[76:79], v[16:19]
    v_mfma_f32_16x16x32_bf16 v[16:19], v[208:211], v[80:83], v[16:19]
    v_mfma_f32_16x16x32_bf16 v[16:19], v[212:215], v[84:87], v[16:19]
    s_waitcnt lgkmcnt(0)
    v_add_f32 v8, v8, v20
    v_add_f32 v9, v9, v21
    v_add_f32 v10, v10, v22
    v_add_f32 v11, v11, v23
    v_cvt_pk_bf16_f32 v32, 0, v8
    v_cvt_pk_bf16_f32 v33, 0, v9
    v_mfma_f32_16x16x32_bf16 v[16:19], v[216:219], v[88:91], v[16:19]
    v_mfma_f32_16x16x32_bf16 v[16:19], v[220:223], v[92:95], v[16:19]
    v_cvt_pk_bf16_f32 v34, 0, v10
    v_cvt_pk_bf16_f32 v35, 0, v11
    v_mul_f32 v32, s66, v32
    v_mul_f32 v33, s66, v33
    v_mul_f32 v34, s66, v34
    v_mul_f32 v35, s66, v35
    v_cvt_pk_bf16_f32 v56, 0, v32
    v_mfma_f32_16x16x32_bf16 v[12:15], v[224:227], v[64:67], 0
    v_mfma_f32_16x16x32_bf16 v[12:15], v[228:231], v[68:71], v[12:15]
    v_cvt_pk_bf16_f32 v57, 0, v33
    v_cvt_pk_bf16_f32 v58, 0, v34
    v_cvt_pk_bf16_f32 v59, 0, v35
    v_fma_f32 v32, v56, s67, -v24
    v_fma_f32 v33, v57, s67, -v24
    v_fma_f32 v34, v58, s67, -v24
    v_fma_f32 v35, v59, s67, -v24
    v_mfma_f32_16x16x32_bf16 v[12:15], v[232:235], v[72:75], v[12:15]
    v_mfma_f32_16x16x32_bf16 v[12:15], v[236:239], v[76:79], v[12:15]
    ds_write_b128 v112, v[16:19] offset:4096
    v_max3_f32 v26, v26, v32, v33
    v_max3_f32 v26, v26, v34, v35
    v_exp_f32 v32, v32
    v_exp_f32 v33, v33
    v_exp_f32 v34, v34
    v_exp_f32 v35, v35
    v_cvt_pk_bf16_f32 v36, v32, v33
    v_mfma_f32_16x16x32_bf16 v[12:15], v[240:243], v[80:83], v[12:15]
    v_mfma_f32_16x16x32_bf16 v[12:15], v[244:247], v[84:87], v[12:15]
    v_cvt_pk_bf16_f32 v37, v34, v35
    ds_write_b64 v27, v[36:37] offset:0
    v_add_f32 v32, v32, v33
    v_add_f32 v34, v34, v35
    v_add_f32 v25, v25, v32
    v_add_f32 v25, v25, v34
    v_mfma_f32_16x16x32_bf16 v[12:15], v[248:251], v[88:91], v[12:15]
    v_mfma_f32_16x16x32_bf16 v[12:15], v[252:255], v[92:95], v[12:15]
    s_waitcnt lgkmcnt(0)
    s_barrier
    ds_read_b128 v[20:23], v113 offset:4096
    s_waitcnt lgkmcnt(0)
    s_nop 3
    v_add_f32 v12, v12, v20
    v_add_f32 v13, v13, v21
    v_add_f32 v14, v14, v22
    v_add_f32 v15, v15, v23
    v_cvt_pk_bf16_f32 v32, 0, v12
    v_cvt_pk_bf16_f32 v33, 0, v13
    v_cvt_pk_bf16_f32 v34, 0, v14
    v_cvt_pk_bf16_f32 v35, 0, v15
    v_mul_f32 v32, s66, v32
    v_mul_f32 v33, s66, v33
    v_mul_f32 v34, s66, v34
    v_mul_f32 v35, s66, v35
    v_cvt_pk_bf16_f32 v56, 0, v32
    v_cvt_pk_bf16_f32 v57, 0, v33
    v_cvt_pk_bf16_f32 v58, 0, v34
    v_cvt_pk_bf16_f32 v59, 0, v35
    v_fma_f32 v32, v56, s67, -v24
    v_fma_f32 v33, v57, s67, -v24
    v_fma_f32 v34, v58, s67, -v24
    v_fma_f32 v35, v59, s67, -v24
    v_max3_f32 v26, v26, v32, v33
    v_max3_f32 v26, v26, v34, v35
    v_exp_f32 v32, v32
    v_exp_f32 v33, v33
    v_exp_f32 v34, v34
    v_exp_f32 v35, v35
    v_cvt_pk_bf16_f32 v36, v32, v33
    v_cvt_pk_bf16_f32 v37, v34, v35
    ds_write_b64 v27, v[36:37] offset:2560
    v_add_f32 v32, v32, v33
    v_add_f32 v34, v34, v35
    v_add_f32 v25, v25, v32
    v_add_f32 v25, v25, v34
    v_cmp_lt_f32 vcc, s65, v26
    v_mov_b32 v61, v25
    s_nop 1
    v_permlane16_swap_b32 v61, v25
    v_add_f32 v25, v25, v61
    v_mov_b32 v61, v25
    s_nop 1
    v_permlane32_swap_b32 v61, v25
    v_add_f32 v25, v25, v61
    ds_write_b32 v62, v25
    s_cbranch_vccz noflag_68
    s_cmp_lg_u32 s72, 0
    s_cbranch_scc1 noflag_68
    ds_write_b32 v31, v42
noflag_68:
    s_waitcnt lgkmcnt(0)
    s_barrier
    ds_read_b32 v39, v31
    ds_read_b32 v33, v62 offset:128
    s_lshl_b32 s65, s55, 8
    s_lshl_b32 s66, s69, 7
    s_add_u32 s65, s65, s66
    s_add_u32 s65, s65, 491520
    v_lshlrev_b32 v63, 3, v1
    v_mov_b32 v32, v24
    s_setprio 0
    s_waitcnt lgkmcnt(0)
    v_readfirstlane_b32 s64, v39
    v_add_f32 v33, v33, v25
    s_cmp_lg_u32 s64, 0
    s_cbranch_scc1 L_qk_redo
    s_cmp_lg_u32 s68, 0
    s_cbranch_scc1 L_att_post
    s_mov_b32 exec_lo, 0xffff
    s_mov_b32 exec_hi, 0x0
    buffer_store_dwordx2 v[32:33], v63, s[48:51], s65 offen sc1
    s_mov_b64 exec, -1
    s_branch L_att_post
L_qk_redo:
    ds_write_b32 v28, v26
    s_waitcnt lgkmcnt(0)
    s_barrier
    ds_read_b128 v[48:51], v29
    ds_read_b128 v[52:55], v29 offset:16
    s_waitcnt lgkmcnt(0)
    v_max3_f32 v48, v48, v49, v50
    v_max3_f32 v52, v52, v53, v54
    v_max3_f32 v48, v48, v51, v55
    v_max_f32 v48, v48, v52
    v_add_f32 v24, v24, v48
    s_mov_b32 s72, 1
    s_branch L_qk_start
L_att_post:
    s_cmp_ge_u32 s54, 14
    s_cbranch_scc1 L_fin
    s_lshr_b32 s68, s54, 1
    s_mul_i32 s65, s52, 7
    s_add_u32 s68, s68, s65
    s_and_b32 s69, s54, 1
    v_lshrrev_b32 v44, 2, v0
    v_mul_u32_u24 v44, 3584, v44
    v_and_b32 v45, 3, v0
    v_lshrrev_b32 v32, 5, v0
    v_lshlrev_b32 v32, 1, v32
    v_xor_b32 v45, v45, v32
    v_lshl_add_u32 v44, v45, 4, v44
    v_lshlrev_b32 v32, 4, v0
    s_lshl_b32 s64, s68, 6
    s_mul_i32 s65, s56, 229376
    s_add_u32 s64, s64, s65
    s_lshl_b32 s65, s56, 12
    s_add_u32 s66, s65, 32768
    s_barrier
    s_mov_b32 m0, s66
    s_nop 0
    buffer_load_dwordx4 v44, s[28:31], s64 offen  lds
    s_add_u32 s64, s64, 57344
    s_add_u32 s66, s66, 1024
    s_mov_b32 m0, s66
    s_nop 0
    buffer_load_dwordx4 v44, s[28:31], s64 offen  lds
    s_add_u32 s64, s64, 57344
    s_add_u32 s66, s66, 1024
    s_mov_b32 m0, s66
    s_nop 0
    buffer_load_dwordx4 v44, s[28:31], s64 offen  lds
    s_add_u32 s64, s64, 57344
    s_add_u32 s66, s66, 1024
    s_mov_b32 m0, s66
    s_nop 0
    buffer_load_dwordx4 v44, s[28:31], s64 offen  lds
    v_and_b32 v38, 3, v1
    s_lshl_b32 s64, s69, 12
    s_lshl_b32 s65, s56, 9
    s_add_u32 s65, s65, s64
    v_and_b32 v33, 31, v0
    v_lshlrev_b32 v33, 4, v33
    v_lshrrev_b32 v34, 5, v0
    v_lshl_add_u32 v33, v34, 3, v33
    buffer_load_dwordx2 v[40:41], v33, s[4:7], s65 offen
    s_add_u32 s65, s65, 458752
    s_add_u32 s66, s65, 8192
    s_add_u32 s67, s65, 16384
    s_mov_b32 s63, 60000
poll_69:
    buffer_load_dwordx2 v[44:45], v33, s[48:51], s65 offen sc1
    buffer_load_dwordx2 v[46:47], v33, s[48:51], s66 offen sc1
    buffer_load_dwordx2 v[48:49], v33, s[48:51], s67 offen sc1
    s_waitcnt vmcnt(0)
    v_max3_u32 v56, v44, v45, v46
    v_max3_u32 v56, v56, v47, v48
    v_max_u32 v56, v56, v49
    v_cmp_eq_u32 vcc, -1, v56
    s_cbranch_vccz pdone_70
    s_sleep 1
    s_sub_u32 s63, s63, 1
    s_cbranch_scc0 poll_69
pdone_70:
    s_lshr_b32 s64, s56, 1
    s_and_b32 s65, s56, 1
    s_mul_i32 s66, s64, 1040
    s_lshl_b32 s67, s65, 9
    s_add_u32 s66, s66, s67
    s_add_u32 s66, s66, 139264
    v_add_u32 v39, s66, v33
    ds_write_b64 v39, v[48:49] offset:4160
    ds_write_b64 v39, v[46:47] offset:8320
    v_lshlrev_b32 v160, 16, v40
    v_and_b32 v161, 0xffff0000, v40
    v_lshlrev_b32 v162, 16, v41
    v_and_b32 v163, 0xffff0000, v41
    v_lshlrev_b32 v164, 16, v44
    v_and_b32 v165, 0xffff0000, v44
    v_lshlrev_b32 v166, 16, v45
    v_and_b32 v167, 0xffff0000, v45
    v_lshlrev_b32 v168, 16, v48
    v_and_b32 v169, 0xffff0000, v48
    v_lshlrev_b32 v170, 16, v49
    v_and_b32 v171, 0xffff0000, v49
    s_waitcnt lgkmcnt(0)
    s_barrier
    v_lshrrev_b32 v34, 2, v1
    v_lshl_add_u32 v34, v2, 3, v34
    v_lshlrev_b32 v35, 6, v34
    v_lshl_add_u32 v35, v38, 3, v35
    v_and_b32 v36, 1, v2
    v_xor_b32 v36, s65, v36
    v_lshl_add_u32 v35, v36, 5, v35
    s_lshl_b32 s66, s64, 13
    v_add_u32 v35, s66, v35
    ds_read_b64_tr_b16 v[128:129], v35 offset:32768
    ds_read_b64_tr_b16 v[130:131], v35 offset:33024
    ds_read_b64_tr_b16 v[132:133], v35 offset:34816
    ds_read_b64_tr_b16 v[134:135], v35 offset:35072
    ds_read_b64_tr_b16 v[136:137], v35 offset:36864
    ds_read_b64_tr_b16 v[138:139], v35 offset:37120
    ds_read_b64_tr_b16 v[140:141], v35 offset:38912
    ds_read_b64_tr_b16 v[142:143], v35 offset:39168
    v_lshlrev_b32 v35, 10, v34
    v_lshl_add_u32 v35, v38, 3, v35
    v_lshrrev_b32 v36, 2, v1
    v_and_b32 v37, 1, v2
    v_lshl_add_u32 v36, v37, 2, v36
    s_lshl_b32 s66, s56, 2
    v_xor_b32 v36, s66, v36
    v_lshl_add_u32 v35, v36, 5, v35
    v_xor_b32 v36, 0, v35
    ds_read_b64_tr_b16 v[144:145], v36 offset:0
    ds_read_b64_tr_b16 v[146:147], v36 offset:4096
    v_xor_b32 v36, 32, v35
    ds_read_b64_tr_b16 v[148:149], v36 offset:0
    ds_read_b64_tr_b16 v[150:151], v36 offset:4096
    v_xor_b32 v36, 64, v35
    ds_read_b64_tr_b16 v[152:153], v36 offset:0
    ds_read_b64_tr_b16 v[154:155], v36 offset:4096
    v_xor_b32 v36, 96, v35
    ds_read_b64_tr_b16 v[156:157], v36 offset:0
    ds_read_b64_tr_b16 v[158:159], v36 offset:4096
    v_and_b32 v42, 7, v1
    v_mul_u32_u24 v34, 1040, v42
    v_lshl_add_u32 v34, v2, 4, v34
    s_lshl_b32 s66, s64, 8
    s_add_u32 s66, s66, 139264
    v_add_u32 v34, s66, v34
    v_mul_u32_u24 v35, 144, v42
    v_lshl_add_u32 v35, v2, 4, v35
    s_mul_i32 s66, s64, 1216
    s_lshl_b32 s67, s65, 6
    s_add_u32 s66, s66, s67
    s_add_u32 s66, s66, 152576
    v_add_u32 v35, s66, v35
    v_lshrrev_b32 v36, 2, v1
    v_mul_u32_u24 v36, 1216, v36
    v_mul_u32_u24 v43, 144, v38
    v_add_u32 v36, v36, v43
    v_lshl_add_u32 v36, v2, 5, v36
    v_add_u32 v36, 152576, v36
    v_lshrrev_b32 v37, 1, v38
    v_mul_u32_u24 v37, 7168, v37
    v_and_b32 v43, 1, v38
    v_lshl_add_u32 v37, v43, 6, v37
    v_lshl_add_u32 v37, v2, 4, v37
    v_lshrrev_b32 v43, 2, v1
    v_mul_u32_u24 v43, 28672, v43
    v_add_u32 v37, v37, v43
    v_lshlrev_b32 v50, 4, v38
    v_add_u32 v50, 157696, v50
    s_lshl_b32 s66, s56, 3
    s_add_u32 s66, s66, 157696
    v_mov_b32 v51, s66
    ds_read_b128 v[64:67], v34 offset:4160
    ds_read_b128 v[68:71], v34 offset:4224
    ds_read_b128 v[72:75], v34 offset:4288
    ds_read_b128 v[76:79], v34 offset:4352
    s_waitcnt lgkmcnt(0)
    v_mfma_f32_16x16x32_bf16 v[80:83], v[128:131], v[64:67], 0
    v_mfma_f32_16x16x32_bf16 v[80:83], v[132:135], v[68:71], v[80:83]
    v_mfma_f32_16x16x32_bf16 v[80:83], v[136:139], v[72:75], v[80:83]
    v_mfma_f32_16x16x32_bf16 v[80:83], v[140:143], v[76:79], v[80:83]
    s_mov_b32 exec_lo, 0xff00ff
    s_mov_b32 exec_hi, 0xff00ff
    s_nop 5
    ds_write_b128 v35, v[80:83]
    s_mov_b64 exec, -1
    s_waitcnt lgkmcnt(0)
    s_barrier
    ds_read_b128 v[176:179], v36
    ds_read_b128 v[180:183], v36 offset:16
    ds_read_b128 v[184:187], v36 offset:576
    ds_read_b128 v[188:191], v36 offset:592
    s_lshl_b32 s66, s69, 15
    s_lshl_b32 s67, s64, 13
    s_add_u32 s66, s66, s67
    s_lshl_b32 s67, s65, 9
    s_add_u32 s66, s66, s67
    s_add_u32 s66, s66, 802816
    s_add_u32 s67, s66, 4096
    s_lshl_b32 s64, s56, 4
    s_lshl_b32 s65, s69, 1
    s_add_u32 s64, s64, s65
    s_mul_i32 s64, s64, 7168
    s_lshl_b32 s65, s68, 7
    s_add_u32 s64, s64, s65
    s_add_u32 s64, s64, 901120
    s_mov_b32 s65, 0xff
    v_lshrrev_b32 v40, 0, s57
    v_lshrrev_b32 v41, 8, s57
    v_lshrrev_b32 v42, 16, s57
    v_lshrrev_b32 v43, 24, s57
    s_waitcnt lgkmcnt(0)
    v_add_f32_dpp v176, v176, v176 row_ror:8 row_mask:0xf bank_mask:0xf
    v_add_f32_dpp v177, v177, v177 row_ror:8 row_mask:0xf bank_mask:0xf
    v_add_f32_dpp v178, v178, v178 row_ror:8 row_mask:0xf bank_mask:0xf
    v_add_f32_dpp v179, v179, v179 row_ror:8 row_mask:0xf bank_mask:0xf
    v_add_f32_dpp v180, v180, v180 row_ror:8 row_mask:0xf bank_mask:0xf
    v_add_f32_dpp v181, v181, v181 row_ror:8 row_mask:0xf bank_mask:0xf
    v_add_f32_dpp v182, v182, v182 row_ror:8 row_mask:0xf bank_mask:0xf
    v_add_f32_dpp v183, v183, v183 row_ror:8 row_mask:0xf bank_mask:0xf
    v_add_f32_dpp v184, v184, v184 row_ror:8 row_mask:0xf bank_mask:0xf
    v_add_f32_dpp v185, v185, v185 row_ror:8 row_mask:0xf bank_mask:0xf
    v_add_f32_dpp v186, v186, v186 row_ror:8 row_mask:0xf bank_mask:0xf
    v_add_f32_dpp v187, v187, v187 row_ror:8 row_mask:0xf bank_mask:0xf
    v_add_f32_dpp v188, v188, v188 row_ror:8 row_mask:0xf bank_mask:0xf
    v_add_f32_dpp v189, v189, v189 row_ror:8 row_mask:0xf bank_mask:0xf
    v_add_f32_dpp v190, v190, v190 row_ror:8 row_mask:0xf bank_mask:0xf
    v_add_f32_dpp v191, v191, v191 row_ror:8 row_mask:0xf bank_mask:0xf
    v_add_f32_dpp v176, v176, v176 row_ror:4 row_mask:0xf bank_mask:0xf
    v_add_f32_dpp v177, v177, v177 row_ror:4 row_mask:0xf bank_mask:0xf
    v_add_f32_dpp v178, v178, v178 row_ror:4 row_mask:0xf bank_mask:0xf
    v_add_f32_dpp v179, v179, v179 row_ror:4 row_mask:0xf bank_mask:0xf
    v_add_f32_dpp v180, v180, v180 row_ror:4 row_mask:0xf bank_mask:0xf
    v_add_f32_dpp v181, v181, v181 row_ror:4 row_mask:0xf bank_mask:0xf
    v_add_f32_dpp v182, v182, v182 row_ror:4 row_mask:0xf bank_mask:0xf
    v_add_f32_dpp v183, v183, v183 row_ror:4 row_mask:0xf bank_mask:0xf
    v_add_f32_dpp v184, v184, v184 row_ror:4 row_mask:0xf bank_mask:0xf
    v_add_f32_dpp v185, v185, v185 row_ror:4 row_mask:0xf bank_mask:0xf
    v_add_f32_dpp v186, v186, v186 row_ror:4 row_mask:0xf bank_mask:0xf
    v_add_f32_dpp v187, v187, v187 row_ror:4 row_mask:0xf bank_mask:0xf
    v_add_f32_dpp v188, v188, v188 row_ror:4 row_mask:0xf bank_mask:0xf
    v_add_f32_dpp v189, v189, v189 row_ror:4 row_mask:0xf bank_mask:0xf
    v_add_f32_dpp v190, v190, v190 row_ror:4 row_mask:0xf bank_mask:0xf
    v_add_f32_dpp v191, v191, v191 row_ror:4 row_mask:0xf bank_mask:0xf
    v_and_b32 v57, 31, v0
    v_lshlrev_b32 v57, 4, v57
    v_lshrrev_b32 v58, 5, v0
    v_lshl_add_u32 v57, v58, 12, v57
    s_cmp_lg_u32 s56, 0
    s_cbranch_scc1 nohw_71
    s_lshl_b32 s78, s55, 7
    s_add_u32 s78, s78, 868352
    s_mov_b32 s63, 60000
hw_72:
    s_load_dword s79, s[48:49], s78 glc
    s_waitcnt lgkmcnt(0)
    s_cmp_eq_u32 s79, s57
    s_cbranch_scc1 hd_73
    s_sub_u32 s63, s63, 1
    s_cbranch_scc0 hw_72
hd_73:
nohw_71:
    s_barrier
    s_mov_b32 s63, 60000
poll_74:
    buffer_load_dwordx4 v[64:67], v57, s[48:51], s66 offen offset:0 sc1
    buffer_load_dwordx4 v[68:71], v57, s[48:51], s66 offen offset:1024 sc1
    buffer_load_dwordx4 v[72:75], v57, s[48:51], s66 offen offset:2048 sc1
    buffer_load_dwordx4 v[76:79], v57, s[48:51], s66 offen offset:3072 sc1
    s_waitcnt vmcnt(0)
    v_max3_u32 v56, v64, v66, v68
    v_max3_u32 v56, v56, v70, v72
    v_max3_u32 v56, v56, v74, v76
    v_max_u32 v56, v56, v78
    v_cmp_eq_u32 vcc, -1, v56
    s_cbranch_vccz pdone_75
    s_sub_u32 s63, s63, 1
    s_cbranch_scc0 poll_74
pdone_75:
    s_cmp_lg_u32 s56, 6
    s_cbranch_scc1 nohint_76
    s_lshl_b32 s78, s55, 7
    s_add_u32 s78, s78, 884800
    v_mov_b32 v112, s57
    v_mov_b32 v113, 0
    s_mov_b32 exec_lo, 0x1
    s_mov_b32 exec_hi, 0x0
    buffer_store_dword v112, v113, s[48:51], s78 offen sc1
    s_mov_b64 exec, -1
nohint_76:
    v_lshlrev_b32 v80, 16, v64
    v_and_b32 v81, 0xffff0000, v64
    v_lshlrev_b32 v82, 16, v65
    v_and_b32 v83, 0xffff0000, v65
    v_lshlrev_b32 v84, 16, v66
    v_and_b32 v85, 0xffff0000, v66
    v_lshlrev_b32 v86, 16, v67
    v_and_b32 v87, 0xffff0000, v67
    v_lshlrev_b32 v88, 16, v68
    v_and_b32 v89, 0xffff0000, v68
    v_lshlrev_b32 v90, 16, v69
    v_and_b32 v91, 0xffff0000, v69
    v_lshlrev_b32 v92, 16, v70
    v_and_b32 v93, 0xffff0000, v70
    v_lshlrev_b32 v94, 16, v71
    v_and_b32 v95, 0xffff0000, v71
    v_lshlrev_b32 v96, 16, v72
    v_and_b32 v97, 0xffff0000, v72
    v_lshlrev_b32 v98, 16, v73
    v_and_b32 v99, 0xffff0000, v73
    v_lshlrev_b32 v100, 16, v74
    v_and_b32 v101, 0xffff0000, v74
    v_lshlrev_b32 v102, 16, v75
    v_and_b32 v103, 0xffff0000, v75
    v_lshlrev_b32 v104, 16, v76
    v_and_b32 v105, 0xffff0000, v76
    v_lshlrev_b32 v106, 16, v77
    v_and_b32 v107, 0xffff0000, v77
    v_lshlrev_b32 v108, 16, v78
    v_and_b32 v109, 0xffff0000, v78
    v_lshlrev_b32 v110, 16, v79
    v_and_b32 v111, 0xffff0000, v79
    v_pk_add_f32 v[80:81], v[80:81], v[96:97]
    v_pk_add_f32 v[82:83], v[82:83], v[98:99]
    v_pk_add_f32 v[84:85], v[84:85], v[100:101]
    v_pk_add_f32 v[86:87], v[86:87], v[102:103]
    v_pk_add_f32 v[88:89], v[88:89], v[104:105]
    v_pk_add_f32 v[90:91], v[90:91], v[106:107]
    v_pk_add_f32 v[92:93], v[92:93], v[108:109]
    v_pk_add_f32 v[94:95], v[94:95], v[110:111]
    v_pk_add_f32 v[80:81], v[80:81], v[88:89]
    v_pk_add_f32 v[82:83], v[82:83], v[90:91]
    v_pk_add_f32 v[84:85], v[84:85], v[92:93]
    v_pk_add_f32 v[86:87], v[86:87], v[94:95]
    s_nop 0
    v_permlane32_swap_b32 v80, v84
    v_permlane32_swap_b32 v81, v85
    v_permlane32_swap_b32 v82, v86
    v_permlane32_swap_b32 v83, v87
    v_pk_add_f32 v[80:81], v[80:81], v[84:85]
    v_pk_add_f32 v[82:83], v[82:83], v[86:87]
    v_fma_f32 v80, v80, v164, v160
    v_fma_f32 v81, v81, v165, v161
    v_fma_f32 v82, v82, v166, v162
    v_fma_f32 v83, v83, v167, v163
    v_mul_f32 v84, v80, v168
    v_mul_f32 v85, v81, v169
    v_mul_f32 v86, v82, v170
    v_mul_f32 v87, v83, v171
    v_cvt_pk_bf16_f32 v88, v84, v85
    v_cvt_pk_bf16_f32 v89, v86, v87
    ds_write_b64 v39, v[88:89]
    v_add_f32 v52, v80, v81
    v_mul_f32 v53, v80, v80
    v_add_f32 v54, v82, v83
    v_fmac_f32 v53, v81, v81
    v_add_f32 v52, v52, v54
    v_fmac_f32 v53, v82, v82
    v_fmac_f32 v53, v83, v83
    s_waitcnt lgkmcnt(0)
    s_barrier
    ds_read_b128 v[64:67], v34 offset:0
    ds_read_b128 v[68:71], v34 offset:64
    ds_read_b128 v[72:75], v34 offset:128
    ds_read_b128 v[76:79], v34 offset:192
    v_add_f32_dpp v52, v52, v52 row_ror:8 row_mask:0xf bank_mask:0xf
    v_add_f32_dpp v53, v53, v53 row_ror:8 row_mask:0xf bank_mask:0xf
    s_nop 0
    v_add_f32_dpp v52, v52, v52 row_ror:4 row_mask:0xf bank_mask:0xf
    v_add_f32_dpp v53, v53, v53 row_ror:4 row_mask:0xf bank_mask:0xf
    s_nop 0
    v_add_f32_dpp v52, v52, v52 row_ror:2 row_mask:0xf bank_mask:0xf
    v_add_f32_dpp v53, v53, v53 row_ror:2 row_mask:0xf bank_mask:0xf
    s_nop 0
    v_add_f32_dpp v52, v52, v52 row_ror:1 row_mask:0xf bank_mask:0xf
    v_add_f32_dpp v53, v53, v53 row_ror:1 row_mask:0xf bank_mask:0xf
    s_waitcnt lgkmcnt(3)
    v_mfma_f32_16x16x32_bf16 v[80:83], v[128:131], v[64:67], 0
    s_waitcnt lgkmcnt(2)
    v_mfma_f32_16x16x32_bf16 v[80:83], v[132:135], v[68:71], v[80:83]
    s_waitcnt lgkmcnt(1)
    v_mfma_f32_16x16x32_bf16 v[80:83], v[136:139], v[72:75], v[80:83]
    s_waitcnt lgkmcnt(0)
    v_mfma_f32_16x16x32_bf16 v[80:83], v[140:143], v[76:79], v[80:83]
    v_add_f32_dpp v52, v52, v52 row_bcast:15 row_mask:0xa bank_mask:0xf
    v_add_f32_dpp v53, v53, v53 row_bcast:15 row_mask:0xa bank_mask:0xf
    s_nop 0
    v_add_f32_dpp v52, v52, v52 row_bcast:31 row_mask:0xc bank_mask:0xf
    v_add_f32_dpp v53, v53, v53 row_bcast:31 row_mask:0xc bank_mask:0xf
    s_mov_b32 exec_lo, 0x0
    s_mov_b32 exec_hi, 0x80000000
    ds_write_b64 v51, v[52:53]
    s_mov_b32 exec_lo, 0xf000f
    s_mov_b32 exec_hi, 0xf000f
    ds_write_b128 v35, v[80:83]
    s_mov_b64 exec, -1
    s_waitcnt lgkmcnt(0)
    s_barrier
    ds_read_b128 v[52:55], v50
    ds_read_b128 v[64:67], v36
    ds_read_b128 v[68:71], v36 offset:16
    s_waitcnt lgkmcnt(2)
    v_add_f32 v52, v52, v54
    v_add_f32 v53, v53, v55
    v_mul_f32 v52, 0x3b000000, v52
    v_mul_f32 v53, 0x3b000000, v53
    v_fma_f32 v53, -v52, v52, v53
    v_max_f32 v53, 0, v53
    v_add_f32 v53, 0x3727c5ac, v53
    v_rsq_f32 v53, v53
    s_waitcnt lgkmcnt(0)
    v_add_f32_dpp v64, v64, v64 row_ror:8 row_mask:0xf bank_mask:0xf
    v_add_f32_dpp v65, v65, v65 row_ror:8 row_mask:0xf bank_mask:0xf
    v_add_f32_dpp v66, v66, v66 row_ror:8 row_mask:0xf bank_mask:0xf
    v_add_f32_dpp v67, v67, v67 row_ror:8 row_mask:0xf bank_mask:0xf
    v_add_f32_dpp v68, v68, v68 row_ror:8 row_mask:0xf bank_mask:0xf
    v_add_f32_dpp v69, v69, v69 row_ror:8 row_mask:0xf bank_mask:0xf
    v_add_f32_dpp v70, v70, v70 row_ror:8 row_mask:0xf bank_mask:0xf
    v_add_f32_dpp v71, v71, v71 row_ror:8 row_mask:0xf bank_mask:0xf
    v_add_f32_dpp v64, v64, v64 row_ror:4 row_mask:0xf bank_mask:0xf
    v_add_f32_dpp v65, v65, v65 row_ror:4 row_mask:0xf bank_mask:0xf
    v_add_f32_dpp v66, v66, v66 row_ror:4 row_mask:0xf bank_mask:0xf
    v_add_f32_dpp v67, v67, v67 row_ror:4 row_mask:0xf bank_mask:0xf
    v_add_f32_dpp v68, v68, v68 row_ror:4 row_mask:0xf bank_mask:0xf
    v_add_f32_dpp v69, v69, v69 row_ror:4 row_mask:0xf bank_mask:0xf
    v_add_f32_dpp v70, v70, v70 row_ror:4 row_mask:0xf bank_mask:0xf
    v_add_f32_dpp v71, v71, v71 row_ror:4 row_mask:0xf bank_mask:0xf
    v_mov_b32 v54, v53
    v_mov_b32 v55, v53
    v_sub_f32 v52, 0, v52
    v_mov_b32 v53, v52
    v_pk_fma_f32 v[64:65], v[52:53], v[176:177], v[64:65]
    v_pk_fma_f32 v[66:67], v[52:53], v[178:179], v[66:67]
    v_pk_fma_f32 v[68:69], v[52:53], v[180:181], v[68:69]
    v_pk_fma_f32 v[70:71], v[52:53], v[182:183], v[70:71]
    v_pk_fma_f32 v[64:65], v[54:55], v[64:65], v[184:185]
    v_pk_fma_f32 v[66:67], v[54:55], v[66:67], v[186:187]
    v_pk_fma_f32 v[68:69], v[54:55], v[68:69], v[188:189]
    v_pk_fma_f32 v[70:71], v[54:55], v[70:71], v[190:191]
    v_cvt_pk_bf16_f32 v72, v64, v65
    v_cvt_pk_bf16_f32 v73, v66, v67
    v_cvt_pk_bf16_f32 v74, v68, v69
    v_cvt_pk_bf16_f32 v75, v70, v71
    v_pk_max_i16 v72, v72, 0
    v_pk_max_i16 v73, v73, 0
    v_pk_max_i16 v74, v74, 0
    v_pk_max_i16 v75, v75, 0
    s_nop 1
    v_mfma_f32_16x16x32_bf16 v[80:83], v[144:147], v[72:75], 0
    v_mfma_f32_16x16x32_bf16 v[84:87], v[148:151], v[72:75], 0
    v_mfma_f32_16x16x32_bf16 v[88:91], v[152:155], v[72:75], 0
    v_mfma_f32_16x16x32_bf16 v[92:95], v[156:159], v[72:75], 0
    s_nop 5
    v_mov_b32_dpp v80, v84 quad_perm:[0,1,2,3] row_mask:0xf bank_mask:0x2
    v_mov_b32_dpp v81, v85 quad_perm:[0,1,2,3] row_mask:0xf bank_mask:0x2
    v_mov_b32_dpp v82, v86 quad_perm:[0,1,2,3] row_mask:0xf bank_mask:0x2
    v_mov_b32_dpp v83, v87 quad_perm:[0,1,2,3] row_mask:0xf bank_mask:0x2
    v_mov_b32_dpp v80, v88 quad_perm:[0,1,2,3] row_mask:0xf bank_mask:0x4
    v_mov_b32_dpp v81, v89 quad_perm:[0,1,2,3] row_mask:0xf bank_mask:0x4
    v_mov_b32_dpp v82, v90 quad_perm:[0,1,2,3] row_mask:0xf bank_mask:0x4
    v_mov_b32_dpp v83, v91 quad_perm:[0,1,2,3] row_mask:0xf bank_mask:0x4
    v_mov_b32_dpp v80, v92 quad_perm:[0,1,2,3] row_mask:0xf bank_mask:0x8
    v_mov_b32_dpp v81, v93 quad_perm:[0,1,2,3] row_mask:0xf bank_mask:0x8
    v_mov_b32_dpp v82, v94 quad_perm:[0,1,2,3] row_mask:0xf bank_mask:0x8
    v_mov_b32_dpp v83, v95 quad_perm:[0,1,2,3] row_mask:0xf bank_mask:0x8
    v_bfi_b32 v80, s65, v40, v80
    v_bfi_b32 v81, s65, v41, v81
    v_bfi_b32 v82, s65, v42, v82
    v_bfi_b32 v83, s65, v43, v83
    buffer_store_dwordx4 v[80:83], v37, s[48:51], s64 offen sc1
    s_cmp_lg_u32 s56, 0
    s_cbranch_scc1 nohint_77
    s_lshl_b32 s78, s55, 7
    s_add_u32 s78, s78, 884736
    v_mov_b32 v112, s57
    v_mov_b32 v113, 0
    s_mov_b32 exec_lo, 0x1
    s_mov_b32 exec_hi, 0x0
    buffer_store_dword v112, v113, s[48:51], s78 offen sc1
    s_mov_b64 exec, -1
nohint_77:
L_fin:
L_end:
    s_endpgm
L_code_end:
.section .rodata,"a"
.p2align 6
.amdhsa_kernel adaLN_cond__compressed_kv_cla__dense_activation_relu__decode_kernel
  .amdhsa_next_free_vgpr 256
  .amdhsa_next_free_sgpr 102
  .amdhsa_accum_offset 256
  .amdhsa_group_segment_fixed_size 0
  .amdhsa_kernarg_size 112
  .amdhsa_user_sgpr_count 2
  .amdhsa_user_sgpr_kernarg_segment_ptr 1
  .amdhsa_system_sgpr_workgroup_id_x 1
.end_amdhsa_kernel
```

```asm
; @launch grid=(256,1,1) block=(512,1,1) lds=163840
.amdgcn_target "amdgcn-amd-amdhsa--gfx950"
.text
.globl adaLN_cond__compressed_kv_cla__dense_activation_relu__decode_kernel
.p2align 8
.type adaLN_cond__compressed_kv_cla__dense_activation_relu__decode_kernel,@function
adaLN_cond__compressed_kv_cla__dense_activation_relu__decode_kernel:
    s_cmp_ge_u32 s2, 256
    s_cbranch_scc1 L_end
    s_load_dwordx2 s[36:37], s[0:1], 72
    s_load_dwordx2 s[40:41], s[0:1], 80
    s_load_dwordx2 s[48:49], s[0:1], 104
    s_load_dwordx2 s[8:9], s[0:1], 8
    s_load_dwordx2 s[4:5], s[0:1], 0
    s_load_dwordx2 s[12:13], s[0:1], 16
    s_load_dwordx2 s[16:17], s[0:1], 24
    v_mov_b32 v3, v0
    v_lshrrev_b32 v4, 6, v0
    v_and_b32 v0, 63, v0
    v_readfirstlane_b32 s56, v4
    v_and_b32 v1, 15, v0
    v_lshrrev_b32 v2, 4, v0
    s_and_b32 s52, s2, 7
    s_lshr_b32 s53, s2, 3
    s_and_b32 s54, s53, 15
    s_lshl_b32 s55, s52, 4
    s_add_u32 s55, s55, s54
    v_lshlrev_b32 v16, 4, v3
    s_mov_b32 s38, 8192
    s_mov_b32 s39, 0x00020000
    s_mov_b32 s42, 3145728
    s_mov_b32 s43, 0x00020000
    s_mov_b32 s50, 15728640
    s_mov_b32 s51, 0x00020000
    s_mov_b32 s6, 8192
    s_mov_b32 s7, 0x00020000
    v_and_b32 v4, 7, v1
    v_lshlrev_b32 v4, 10, v4
    v_lshrrev_b32 v5, 3, v1
    v_lshl_add_u32 v4, v5, 6, v4
    v_lshl_add_u32 v4, v2, 4, v4
    s_cmp_ge_u32 s53, 16
    s_cbranch_scc1 L_att0
    s_cmp_lg_u32 s56, 0
    s_cbranch_scc1 L_svc0
    s_and_b32 s61, s54, 3
    s_lshl_b32 s64, s61, 8
    v_lshrrev_b32 v5, 2, v0
    v_mul_u32_u24 v5, 6144, v5
    v_and_b32 v18, 3, v0
    v_lshrrev_b32 v17, 5, v0
    v_lshlrev_b32 v17, 1, v17
    v_xor_b32 v18, v18, v17
    v_lshl_add_u32 v5, v18, 4, v5
    s_lshr_b32 s66, s55, 2
    s_lshl_b32 s66, s66, 6
    s_mul_i32 s65, s61, 786432
    s_add_u32 s65, s65, s66
    s_mov_b32 m0, 131072
    v_mov_b32 v20, -1
    v_mov_b32 v21, -1
    v_mov_b32 v22, -1
    v_mov_b32 v23, -1
    s_lshl_b32 s68, s52, 18
    s_lshl_b32 s67, s54, 11
    s_add_u32 s68, s68, s67
    s_add_u32 s35, s68, s67
    s_add_u32 s35, s35, 2293760
    s_add_u32 s67, s68, 2097152
    s_mul_i32 s68, s55, 656
    s_add_u32 s68, s68, 32768
    v_add_u32 v17, s68, v16
    s_add_u32 s68, s35, 368
    v_min_u32 v18, 48, v0
    v_lshl_add_u32 v18, v18, 4, s68
    v_cmp_lt_u32 vcc, 40, v0
    s_nop 1
    v_cndmask_b32 v17, v17, v18, vcc
    s_waitcnt lgkmcnt(0)
    s_load_dword s57, s[48:49], 0
    buffer_load_dwordx4 v[40:43], v4, s[36:39], s64 offen
    buffer_load_dwordx4 v[44:47], v4, s[36:39], s64 offen offset:128
    buffer_load_dwordx4 v5, s[40:43], s65 offen  lds
    s_add_u32 s65, s65, 98304
    s_add_u32 m0, m0, 1024
    s_nop 0
    buffer_load_dwordx4 v5, s[40:43], s65 offen  lds
    s_add_u32 s65, s65, 98304
    s_add_u32 m0, m0, 1024
    s_nop 0
    buffer_load_dwordx4 v5, s[40:43], s65 offen  lds
    s_add_u32 s65, s65, 98304
    s_add_u32 m0, m0, 1024
    s_nop 0
    buffer_load_dwordx4 v5, s[40:43], s65 offen  lds
    s_add_u32 s65, s65, 98304
    s_add_u32 m0, m0, 1024
    s_nop 0
    buffer_load_dwordx4 v5, s[40:43], s65 offen  lds
    s_add_u32 s65, s65, 98304
    s_add_u32 m0, m0, 1024
    s_nop 0
    buffer_load_dwordx4 v5, s[40:43], s65 offen  lds
    s_add_u32 s65, s65, 98304
    s_add_u32 m0, m0, 1024
    s_nop 0
    buffer_load_dwordx4 v5, s[40:43], s65 offen  lds
    s_add_u32 s65, s65, 98304
    s_add_u32 m0, m0, 1024
    s_nop 0
    buffer_load_dwordx4 v5, s[40:43], s65 offen  lds
    buffer_store_dwordx4 v[20:23], v16, s[48:51], s67 offen sc1
    buffer_store_dwordx4 v[20:23], v16, s[48:51], s67 offen offset:1024 sc1
    buffer_store_dwordx4 v[20:23], v17, s[48:51], 0 offen sc1
    s_branch L_p1
L_svc0:
    v_lshlrev_b32 v17, 4, v0
    s_waitcnt lgkmcnt(0)
    s_load_dword s57, s[48:49], 0
    buffer_load_dwordx4 v[8:11], v16, s[4:7], 0 offen
    s_cmp_lg_u32 s56, 3
    s_cbranch_scc1 wi_1
    buffer_load_dwordx4 v[40:43], v17, s[4:7], 0 offen
wi_1:
    s_branch L_svc
L_att0:
    s_cmp_ge_u32 s56, 4
    s_cbranch_scc0 L_atq
    s_barrier
    s_barrier
    s_branch L_pv
L_atq:
    s_getpc_b64 s[64:65]
pc_3:
    s_sub_u32 s64, s64, pc_3-adaLN_cond__compressed_kv_cla__dense_activation_relu__decode_kernel
    s_subb_u32 s65, s65, 0
    s_lshl_b32 s66, s56, 4
    s_add_u32 s66, s66, s54
    s_lshl_b32 s66, s66, 10
    s_cmp_ge_u32 s66, L_code_end-adaLN_cond__compressed_kv_cla__dense_activation_relu__decode_kernel
    s_cbranch_scc1 cpf_4
    s_min_u32 s66, s66, L_code_end-adaLN_cond__compressed_kv_cla__dense_activation_relu__decode_kernel-1024
    v_lshl_add_u32 v32, v0, 4, s66
    global_load_dword v64, v32, s[64:65]
cpf_4:
    s_mov_b32 s18, 4194304
    s_mov_b32 s19, 0x00020000
    v_lshrrev_b32 v33, 3, v3
    v_lshlrev_b32 v33, 13, v33
    v_and_b32 v34, 7, v0
    v_lshl_add_u32 v33, v34, 7, v33
    s_lshl_b32 s67, s54, 18
    s_lshl_b32 s68, s52, 10
    s_add_u32 s67, s67, s68
    s_mov_b32 s14, 4194304
    s_mov_b32 s15, 0x00020000
    s_mov_b32 exec_lo, 0xffffffff
    s_mov_b32 exec_hi, 0xffffffff
    s_waitcnt lgkmcnt(0)
    buffer_load_dword v69, v33, s[12:15], s67 offen
    s_mov_b64 exec, -1
    s_barrier
    s_mov_b32 exec_lo, 0xffffffff
    s_mov_b32 exec_hi, 0xffffffff
    buffer_load_dword v68, v33, s[16:19], s67 offen
    s_mov_b64 exec, -1
    s_lshl_b32 s66, s54, 12
    s_lshl_b32 s65, s52, 18
    s_add_u32 s66, s66, s65
    s_add_u32 s66, s66, 2162688
    buffer_load_dword v70, v16, s[48:51], s66 offen sc1
    s_barrier
    s_branch L_qk
L_p1:
    v_lshrrev_b32 v48, 2, v1
    v_lshl_add_u32 v48, v2, 3, v48
    v_lshlrev_b32 v48, 6, v48
    v_and_b32 v50, 3, v1
    v_lshl_add_u32 v48, v50, 3, v48
    v_and_b32 v50, 1, v2
    v_lshl_add_u32 v48, v50, 5, v48
    v_add_u32 v48, 131072, v48
    v_xor_b32 v49, 32, v48
    v_lshlrev_b32 v50, 6, v1
    v_lshl_add_u32 v50, v2, 4, v50
    s_waitcnt vmcnt(11)
    v_lshlrev_b32 v64, 16, v40
    v_and_b32 v65, 0xffff0000, v40
    v_lshlrev_b32 v66, 16, v41
    v_and_b32 v67, 0xffff0000, v41
    v_lshlrev_b32 v68, 16, v42
    v_and_b32 v69, 0xffff0000, v42
    v_lshlrev_b32 v70, 16, v43
    v_and_b32 v71, 0xffff0000, v43
    v_lshlrev_b32 v72, 16, v44
    v_and_b32 v73, 0xffff0000, v44
    v_lshlrev_b32 v74, 16, v45
    v_and_b32 v75, 0xffff0000, v45
    v_lshlrev_b32 v76, 16, v46
    v_and_b32 v77, 0xffff0000, v46
    v_lshlrev_b32 v78, 16, v47
    v_and_b32 v79, 0xffff0000, v47
    v_mul_f32 v80, 0xbfb8aa3b, v64
    v_mul_f32 v81, 0xbfb8aa3b, v65
    v_mul_f32 v82, 0xbfb8aa3b, v66
    v_mul_f32 v83, 0xbfb8aa3b, v67
    v_mul_f32 v84, 0xbfb8aa3b, v68
    v_mul_f32 v85, 0xbfb8aa3b, v69
    v_mul_f32 v86, 0xbfb8aa3b, v70
    v_mul_f32 v87, 0xbfb8aa3b, v71
    v_mul_f32 v88, 0xbfb8aa3b, v72
    v_mul_f32 v89, 0xbfb8aa3b, v73
    v_mul_f32 v90, 0xbfb8aa3b, v74
    v_mul_f32 v91, 0xbfb8aa3b, v75
    v_mul_f32 v92, 0xbfb8aa3b, v76
    v_mul_f32 v93, 0xbfb8aa3b, v77
    v_mul_f32 v94, 0xbfb8aa3b, v78
    v_mul_f32 v95, 0xbfb8aa3b, v79
    v_exp_f32 v80, v80
    v_exp_f32 v81, v81
    v_exp_f32 v82, v82
    v_exp_f32 v83, v83
    v_exp_f32 v84, v84
    v_exp_f32 v85, v85
    v_exp_f32 v86, v86
    v_exp_f32 v87, v87
    v_exp_f32 v88, v88
    v_exp_f32 v89, v89
    v_exp_f32 v90, v90
    v_exp_f32 v91, v91
    v_exp_f32 v92, v92
    v_exp_f32 v93, v93
    v_exp_f32 v94, v94
    v_exp_f32 v95, v95
    v_add_f32 v80, 1.0, v80
    v_add_f32 v81, 1.0, v81
    v_add_f32 v82, 1.0, v82
    v_add_f32 v83, 1.0, v83
    v_add_f32 v84, 1.0, v84
    v_add_f32 v85, 1.0, v85
    v_add_f32 v86, 1.0, v86
    v_add_f32 v87, 1.0, v87
    v_add_f32 v88, 1.0, v88
    v_add_f32 v89, 1.0, v89
    v_add_f32 v90, 1.0, v90
    v_add_f32 v91, 1.0, v91
    v_add_f32 v92, 1.0, v92
    v_add_f32 v93, 1.0, v93
    v_add_f32 v94, 1.0, v94
    v_add_f32 v95, 1.0, v95
    v_rcp_f32 v80, v80
    v_rcp_f32 v81, v81
    v_rcp_f32 v82, v82
    v_rcp_f32 v83, v83
    v_rcp_f32 v84, v84
    v_rcp_f32 v85, v85
    v_rcp_f32 v86, v86
    v_rcp_f32 v87, v87
    v_rcp_f32 v88, v88
    v_rcp_f32 v89, v89
    v_rcp_f32 v90, v90
    v_rcp_f32 v91, v91
    v_rcp_f32 v92, v92
    v_rcp_f32 v93, v93
    v_rcp_f32 v94, v94
    v_rcp_f32 v95, v95
    v_mul_f32 v64, v64, v80
    v_mul_f32 v65, v65, v81
    v_mul_f32 v66, v66, v82
    v_mul_f32 v67, v67, v83
    v_mul_f32 v68, v68, v84
    v_mul_f32 v69, v69, v85
    v_mul_f32 v70, v70, v86
    v_mul_f32 v71, v71, v87
    v_mul_f32 v72, v72, v88
    v_mul_f32 v73, v73, v89
    v_mul_f32 v74, v74, v90
    v_mul_f32 v75, v75, v91
    v_mul_f32 v76, v76, v92
    v_mul_f32 v77, v77, v93
    v_mul_f32 v78, v78, v94
    v_mul_f32 v79, v79, v95
    v_cvt_pk_bf16_f32 v52, v64, v65
    v_cvt_pk_bf16_f32 v53, v66, v67
    v_cvt_pk_bf16_f32 v54, v68, v69
    v_cvt_pk_bf16_f32 v55, v70, v71
    v_cvt_pk_bf16_f32 v56, v72, v73
    v_cvt_pk_bf16_f32 v57, v74, v75
    v_cvt_pk_bf16_f32 v58, v76, v77
    v_cvt_pk_bf16_f32 v59, v78, v79
    s_waitcnt lgkmcnt(0)
    ds_write_b128 v16, v[52:55] offset:45056
    ds_write_b128 v16, v[56:59] offset:46080
    s_mul_i32 s57, s57, 0x9e3779b1
    s_add_u32 s57, s57, 0x7f4a7c15
    s_and_b32 s58, s57, 0xffff
    s_lshr_b32 s59, s57, 16
    s_getreg_b32 s28, hwreg(HW_REG_XCC_ID)
    s_not_b32 s67, s57
    s_xor_b32 s28, s67, s28
    v_bfe_u32 v12, s57, 0, 8
    v_bfe_u32 v13, s57, 8, 8
    v_bfe_u32 v14, s57, 16, 8
    v_bfe_u32 v15, s57, 24, 8
    s_mov_b32 s67, 0xff
    s_waitcnt lgkmcnt(0)
    s_waitcnt vmcnt(9)
    ds_read_b64_tr_b16 v[64:65], v48 offset:0
    ds_read_b64_tr_b16 v[66:67], v48 offset:256
    ds_read_b64_tr_b16 v[68:69], v49 offset:0
    ds_read_b64_tr_b16 v[70:71], v49 offset:256
    s_waitcnt vmcnt(7)
    ds_read_b64_tr_b16 v[72:73], v48 offset:2048
    ds_read_b64_tr_b16 v[74:75], v48 offset:2304
    ds_read_b64_tr_b16 v[76:77], v49 offset:2048
    ds_read_b64_tr_b16 v[78:79], v49 offset:2304
    s_waitcnt vmcnt(5)
    ds_read_b64_tr_b16 v[80:81], v48 offset:4096
    ds_read_b64_tr_b16 v[82:83], v48 offset:4352
    ds_read_b64_tr_b16 v[84:85], v49 offset:4096
    ds_read_b64_tr_b16 v[86:87], v49 offset:4352
    s_waitcnt vmcnt(3)
    ds_read_b64_tr_b16 v[88:89], v48 offset:6144
    ds_read_b64_tr_b16 v[90:91], v48 offset:6400
    ds_read_b64_tr_b16 v[92:93], v49 offset:6144
    ds_read_b64_tr_b16 v[94:95], v49 offset:6400
    s_waitcnt lgkmcnt(14)
    v_mfma_f32_16x16x32_bf16 v[96:99], v[64:67], v[52:55], 0
    s_waitcnt lgkmcnt(12)
    v_mfma_f32_16x16x32_bf16 v[104:107], v[68:71], v[52:55], 0
    s_waitcnt lgkmcnt(10)
    v_mfma_f32_16x16x32_bf16 v[100:103], v[72:75], v[52:55], 0
    s_waitcnt lgkmcnt(8)
    v_mfma_f32_16x16x32_bf16 v[108:111], v[76:79], v[52:55], 0
    s_waitcnt lgkmcnt(6)
    v_mfma_f32_16x16x32_bf16 v[96:99], v[80:83], v[56:59], v[96:99]
    s_waitcnt lgkmcnt(4)
    v_mfma_f32_16x16x32_bf16 v[104:107], v[84:87], v[56:59], v[104:107]
    s_waitcnt lgkmcnt(2)
    v_mfma_f32_16x16x32_bf16 v[100:103], v[88:91], v[56:59], v[100:103]
    s_waitcnt lgkmcnt(0)
    v_mfma_f32_16x16x32_bf16 v[108:111], v[92:95], v[56:59], v[108:111]
    s_nop 5
    v_add_f32_dpp v112, v100, v96 row_ror:8 row_mask:0xf bank_mask:0x3
    v_add_f32_dpp v113, v101, v97 row_ror:8 row_mask:0xf bank_mask:0x3
    v_add_f32_dpp v114, v102, v98 row_ror:8 row_mask:0xf bank_mask:0x3
    v_add_f32_dpp v115, v103, v99 row_ror:8 row_mask:0xf bank_mask:0x3
    v_add_f32_dpp v112, v104, v108 row_ror:8 row_mask:0xf bank_mask:0xc
    v_add_f32_dpp v113, v105, v109 row_ror:8 row_mask:0xf bank_mask:0xc
    v_add_f32_dpp v114, v106, v110 row_ror:8 row_mask:0xf bank_mask:0xc
    v_add_f32_dpp v115, v107, v111 row_ror:8 row_mask:0xf bank_mask:0xc
    v_bfi_b32 v112, s67, v12, v112
    v_bfi_b32 v113, s67, v13, v113
    v_bfi_b32 v114, s67, v14, v114
    v_bfi_b32 v115, s67, v15, v115
    s_waitcnt vmcnt(0)
    buffer_store_dwordx4 v[112:115], v50, s[48:51], s35 offen sc1
    v_mov_b32 v60, s57
    s_mov_b32 exec_lo, 0x1
    s_mov_b32 exec_hi, 0x0
    buffer_store_dword v60, v16, s[48:51], s35 offen offset:1024 sc1
    s_mov_b64 exec, -1
    s_barrier
L_svc:
    s_load_dwordx2 s[20:21], s[0:1], 32
    s_load_dwordx2 s[24:25], s[0:1], 40
    s_load_dwordx2 s[44:45], s[0:1], 88
    s_mov_b32 s22, 4194304
    s_mov_b32 s23, 0x00020000
    s_mov_b32 s26, 4194304
    s_mov_b32 s27, 0x00020000
    s_mov_b32 s46, 8192
    s_mov_b32 s47, 0x00020000
    s_mov_b32 s18, 4194304
    s_mov_b32 s19, 0x00020000
    s_mov_b32 s10, 33554432
    s_mov_b32 s11, 0x00020000
    s_lshr_b32 s60, s55, 2
    s_and_b32 s61, s54, 3
    v_lshlrev_b32 v29, 13, v2
    s_and_b32 s69, s56, 3
    s_lshl_b32 s67, s61, 20
    s_lshl_b32 s68, s69, 18
    s_add_u32 s67, s67, s68
    s_lshl_b32 s68, s60, 8
    s_add_u32 s67, s67, s68
    s_lshl_b32 s68, s69, 13
    s_mul_i32 s72, s52, 196608
    s_mul_i32 s73, s52, 229376
    s_mov_b32 s76, 0x05040100
    s_mov_b32 s77, 0x07060302
    v_lshrrev_b32 v17, 2, v1
    v_and_b32 v38, 3, v1
    v_lshl_add_u32 v28, v2, 3, v17
    v_lshlrev_b32 v36, 8, v28
    v_lshl_add_u32 v36, v38, 3, v36
    v_lshlrev_b32 v5, 7, v28
    v_lshl_add_u32 v5, v38, 3, v5
    v_bfe_u32 v28, v1, 3, 1
    v_lshl_add_u32 v5, v28, 5, v5
    v_and_b32 v37, 1, v2
    v_lshl_add_u32 v5, v37, 6, v5
    v_and_b32 v19, 7, v1
    v_lshlrev_b32 v95, 1, v37
    v_xor_b32 v95, v95, v19
    v_lshlrev_b32 v95, 4, v95
    v_lshl_add_u32 v37, v37, 2, v17
    v_xor_b32 v37, s56, v37
    v_lshl_add_u32 v36, v37, 5, v36
    s_lshl_b32 s66, s56, 5
    v_bfe_u32 v28, v0, 2, 3
    v_and_b32 v21, 3, v0
    v_lshrrev_b32 v22, 5, v0
    v_lshl_add_u32 v22, v21, 1, v22
    v_mul_u32_u24 v20, 272, v28
    v_lshl_add_u32 v20, v22, 2, v20
    v_add_u32 v20, s66, v20
    v_lshlrev_b32 v24, 10, v28
    v_lshl_add_u32 v24, v22, 2, v24
    s_lshl_b32 s64, s61, 8
    s_add_u32 s64, s64, s66
    v_add_u32 v21, s64, v24
    v_mul_u32_u24 v22, 272, v19
    v_lshrrev_b32 v28, 3, v1
    v_lshl_add_u32 v22, v28, 6, v22
    v_lshl_add_u32 v22, v2, 4, v22
    v_lshlrev_b32 v17, 3, v0
    v_lshlrev_b32 v23, 6, v19
    v_lshl_add_u32 v23, v2, 4, v23
    v_and_b32 v26, 31, v0
    v_lshlrev_b32 v26, 4, v26
    v_lshrrev_b32 v28, 5, v0
    v_lshl_add_u32 v39, v28, 12, v26
    v_lshl_add_u32 v26, v28, 12, v26
    v_add_u32 v27, 8192, v26
    v_lshrrev_b32 v32, 3, v0
    v_mul_u32_u24 v32, 6144, v32
    v_add_u32 v32, v32, v95
    v_xor_b32 v33, 64, v32
    s_lshl_b32 s64, s61, 2
    s_add_u32 s64, s64, s69
    s_mul_i32 s33, s64, 196608
    s_lshl_b32 s64, s60, 7
    s_add_u32 s33, s33, s64
    s_add_u32 s33, s33, 2048
    s_lshl_b32 s34, s69, 12
    s_add_u32 s34, s34, 139264
    s_lshl_b32 s64, s61, 18
    s_lshr_b32 s65, s56, 1
    s_lshl_b32 s65, s65, 14
    s_add_u32 s64, s64, s65
    s_and_b32 s65, s56, 1
    s_lshl_b32 s65, s65, 9
    s_add_u32 s64, s64, s65
    s_add_u32 s30, s64, 2293760
    s_add_u32 s31, s30, 1048576
    v_lshlrev_b32 v34, 7, v2
    s_lshl_b32 s29, s60, 9
    s_add_u32 s29, s29, 4096
    s_cmp_eq_u32 s56, 0
    s_cbranch_scc1 L_svc4
    s_waitcnt vmcnt(0)
    v_mov_b32 v44, v16
    s_cmp_eq_u32 s56, 3
    s_cselect_b32 s68, 1, 0
L_ln:
    v_lshlrev_b32 v96, 16, v8
    v_and_b32 v97, 0xffff0000, v8
    v_lshlrev_b32 v98, 16, v9
    v_and_b32 v99, 0xffff0000, v9
    v_lshlrev_b32 v100, 16, v10
    v_and_b32 v101, 0xffff0000, v10
    v_lshlrev_b32 v102, 16, v11
    v_and_b32 v103, 0xffff0000, v11
    v_readfirstlane_b32 s64, v96
    s_nop 1
    v_subrev_f32 v72, s64, v96
    v_subrev_f32 v73, s64, v97
    v_subrev_f32 v74, s64, v98
    v_subrev_f32 v75, s64, v99
    v_subrev_f32 v76, s64, v100
    v_subrev_f32 v77, s64, v101
    v_subrev_f32 v78, s64, v102
    v_subrev_f32 v79, s64, v103
    v_add_f32 v80, v72, v73
    v_mul_f32 v81, v72, v72
    v_fmac_f32 v81, v73, v73
    v_add_f32 v80, v80, v74
    v_fmac_f32 v81, v74, v74
    v_add_f32 v80, v80, v75
    v_fmac_f32 v81, v75, v75
    v_add_f32 v80, v80, v76
    v_fmac_f32 v81, v76, v76
    v_add_f32 v80, v80, v77
    v_fmac_f32 v81, v77, v77
    v_add_f32 v80, v80, v78
    v_fmac_f32 v81, v78, v78
    v_add_f32 v80, v80, v79
    v_fmac_f32 v81, v79, v79
    s_nop 0
    v_add_f32_dpp v80, v80, v80 row_ror:8 row_mask:0xf bank_mask:0xf
    v_add_f32_dpp v81, v81, v81 row_ror:8 row_mask:0xf bank_mask:0xf
    s_nop 0
    v_add_f32_dpp v80, v80, v80 row_ror:4 row_mask:0xf bank_mask:0xf
    v_add_f32_dpp v81, v81, v81 row_ror:4 row_mask:0xf bank_mask:0xf
    s_nop 0
    v_add_f32_dpp v80, v80, v80 row_ror:2 row_mask:0xf bank_mask:0xf
    v_add_f32_dpp v81, v81, v81 row_ror:2 row_mask:0xf bank_mask:0xf
    s_nop 0
    v_add_f32_dpp v80, v80, v80 row_ror:1 row_mask:0xf bank_mask:0xf
    v_add_f32_dpp v81, v81, v81 row_ror:1 row_mask:0xf bank_mask:0xf
    s_nop 0
    v_add_f32_dpp v80, v80, v80 row_bcast:15 row_mask:0xa bank_mask:0xf
    v_add_f32_dpp v81, v81, v81 row_bcast:15 row_mask:0xa bank_mask:0xf
    s_nop 0
    v_add_f32_dpp v80, v80, v80 row_bcast:31 row_mask:0xc bank_mask:0xf
    v_add_f32_dpp v81, v81, v81 row_bcast:31 row_mask:0xc bank_mask:0xf
    v_readlane_b32 s65, v80, 63
    v_readlane_b32 s66, v81, 63
    v_mov_b32 v72, 0x3b000000
    v_mul_f32 v73, s65, v72
    v_mul_f32 v74, s66, v72
    v_fma_f32 v74, -v73, v73, v74
    v_max_f32 v74, 0, v74
    v_add_f32 v73, s64, v73
    v_cvt_pk_bf16_f32 v73, 0, v73
    v_cvt_pk_bf16_f32 v74, 0, v74
    v_add_f32 v74, 0x3727c5ac, v74
    v_cvt_pk_bf16_f32 v74, 0, v74
    v_sqrt_f32 v74, v74
    v_sub_f32 v96, v96, v73
    v_sub_f32 v97, v97, v73
    v_sub_f32 v98, v98, v73
    v_sub_f32 v99, v99, v73
    v_sub_f32 v100, v100, v73
    v_sub_f32 v101, v101, v73
    v_sub_f32 v102, v102, v73
    v_sub_f32 v103, v103, v73
    v_cvt_pk_bf16_f32 v74, 0, v74
    v_rcp_f32 v74, v74
    v_cvt_pk_bf16_f32 v96, 0, v96
    v_cvt_pk_bf16_f32 v97, 0, v97
    v_cvt_pk_bf16_f32 v98, 0, v98
    v_cvt_pk_bf16_f32 v99, 0, v99
    v_cvt_pk_bf16_f32 v100, 0, v100
    v_cvt_pk_bf16_f32 v101, 0, v101
    v_cvt_pk_bf16_f32 v102, 0, v102
    v_cvt_pk_bf16_f32 v103, 0, v103
    v_mul_f32 v96, v96, v74
    v_mul_f32 v97, v97, v74
    v_mul_f32 v98, v98, v74
    v_mul_f32 v99, v99, v74
    v_mul_f32 v100, v100, v74
    v_mul_f32 v101, v101, v74
    v_mul_f32 v102, v102, v74
    v_mul_f32 v103, v103, v74
    v_cvt_pk_bf16_f32 v84, v96, v97
    v_cvt_pk_bf16_f32 v85, v98, v99
    v_cvt_pk_bf16_f32 v86, v100, v101
    v_cvt_pk_bf16_f32 v87, v102, v103
    ds_write_b128 v44, v[84:87] offset:32768
    v_mov_b32 v8, v40
    v_mov_b32 v9, v41
    v_mov_b32 v10, v42
    v_mov_b32 v11, v43
    v_lshlrev_b32 v44, 4, v0
    s_sub_u32 s68, s68, 1
    s_cbranch_scc0 L_ln
    s_waitcnt lgkmcnt(0)
    s_mul_i32 s57, s57, 0x9e3779b1
    s_add_u32 s57, s57, 0x7f4a7c15
    s_and_b32 s58, s57, 0xffff
    s_lshr_b32 s59, s57, 16
    s_getreg_b32 s28, hwreg(HW_REG_XCC_ID)
    s_not_b32 s67, s57
    s_xor_b32 s28, s67, s28
    v_bfe_u32 v12, s57, 0, 8
    v_bfe_u32 v13, s57, 8, 8
    v_bfe_u32 v14, s57, 16, 8
    v_bfe_u32 v15, s57, 24, 8
    s_cmp_lt_u32 s56, 4
    s_cbranch_scc1 L_svc3
    s_mov_b32 s14, 4194304
    s_mov_b32 s15, 0x00020000
    s_lshr_b32 s60, s55, 2
    s_and_b32 s61, s54, 3
    v_lshlrev_b32 v29, 13, v2
    s_and_b32 s69, s56, 3
    s_lshl_b32 s67, s61, 20
    s_lshl_b32 s68, s69, 18
    s_add_u32 s67, s67, s68
    s_lshl_b32 s68, s60, 8
    s_add_u32 s67, s67, s68
    s_lshl_b32 s68, s69, 13
    v_lshlrev_b32 v30, 1, v2
    v_xor_b32 v30, v30, v1
    v_lshl_add_u32 v30, v30, 4, v29
    v_xor_b32 v31, 128, v30
    s_barrier
    s_add_u32 s64, s67, 0
    s_add_u32 m0, s68, 98304
    s_nop 0
    buffer_load_dwordx4 v30, s[12:15], s64 offen nt lds
    s_add_u32 s64, s67, 32768
    s_add_u32 m0, s68, 99328
    s_nop 0
    buffer_load_dwordx4 v30, s[12:15], s64 offen nt lds
    s_add_u32 s64, s67, 65536
    s_add_u32 m0, s68, 100352
    s_nop 0
    buffer_load_dwordx4 v31, s[12:15], s64 offen nt lds
    s_add_u32 s64, s67, 98304
    s_add_u32 m0, s68, 101376
    s_nop 0
    buffer_load_dwordx4 v31, s[12:15], s64 offen nt lds
    s_add_u32 s64, s67, 131072
    s_add_u32 m0, s68, 102400
    s_nop 0
    buffer_load_dwordx4 v30, s[12:15], s64 offen nt lds
    s_add_u32 s64, s67, 163840
    s_add_u32 m0, s68, 103424
    s_nop 0
    buffer_load_dwordx4 v30, s[12:15], s64 offen nt lds
    s_add_u32 s64, s67, 196608
    s_add_u32 m0, s68, 104448
    s_nop 0
    buffer_load_dwordx4 v31, s[12:15], s64 offen nt lds
    s_add_u32 s64, s67, 229376
    s_add_u32 m0, s68, 105472
    s_nop 0
    buffer_load_dwordx4 v31, s[12:15], s64 offen nt lds
    v_xor_b32 v30, v1, v2
    v_lshl_add_u32 v30, v30, 4, v29
    v_xor_b32 v31, 0, v30
    s_add_u32 s64, s67, 0
    s_add_u32 m0, s68, 0
    s_nop 0
    buffer_load_dwordx4 v31, s[16:19], s64 offen nt lds
    s_add_u32 s64, s67, 32768
    s_add_u32 m0, s68, 1024
    s_nop 0
    buffer_load_dwordx4 v31, s[16:19], s64 offen nt lds
    v_xor_b32 v31, 64, v30
    s_add_u32 s64, s67, 65536
    s_add_u32 m0, s68, 2048
    s_nop 0
    buffer_load_dwordx4 v31, s[16:19], s64 offen nt lds
    s_add_u32 s64, s67, 98304
    s_add_u32 m0, s68, 3072
    s_nop 0
    buffer_load_dwordx4 v31, s[16:19], s64 offen nt lds
    v_xor_b32 v31, 128, v30
    s_add_u32 s64, s67, 131072
    s_add_u32 m0, s68, 4096
    s_nop 0
    buffer_load_dwordx4 v31, s[16:19], s64 offen nt lds
    s_add_u32 s64, s67, 163840
    s_add_u32 m0, s68, 5120
    s_nop 0
    buffer_load_dwordx4 v31, s[16:19], s64 offen nt lds
    v_xor_b32 v31, 192, v30
    s_add_u32 s64, s67, 196608
    s_add_u32 m0, s68, 6144
    s_nop 0
    buffer_load_dwordx4 v31, s[16:19], s64 offen nt lds
    s_add_u32 s64, s67, 229376
    s_add_u32 m0, s68, 7168
    s_nop 0
    buffer_load_dwordx4 v31, s[16:19], s64 offen nt lds
    s_branch L_svc4
L_svc3:
    v_mov_b32 v68, -1
    v_mov_b32 v69, -1
    v_mov_b32 v70, -1
    v_mov_b32 v71, -1
    s_mul_i32 s66, s55, 768
    s_add_u32 s66, s66, 113664
    s_lshl_b32 s67, s55, 11
    s_add_u32 s67, s67, s73
    s_add_u32 s67, s67, 2128896
    s_cmp_eq_u32 s56, 3
    s_cselect_b32 s67, s66, s67
    v_min_u32 v30, 3824, v16
    buffer_store_dwordx4 v[68:71], v30, s[48:51], s67 offen sc1
    s_cmp_lg_u32 s56, 1
    s_cbranch_scc1 wi_5
    v_mov_b32 v66, s57
    v_mov_b32 v67, s28
    s_lshl_b32 s68, s55, 7
    s_add_u32 s68, s68, 4096
    s_mov_b32 exec_lo, 0xffff
    s_mov_b32 exec_hi, 0x0
    buffer_store_dwordx2 v[66:67], v17, s[48:51], s68 offen sc1
    s_mov_b64 exec, -1
wi_5:
    s_and_b32 s66, s56, 1
    s_lshl_b32 s66, s66, 2
    s_add_u32 s66, s66, s61
    s_lshl_b32 s66, s66, 6
    s_and_b32 s67, s60, 15
    s_add_u32 s66, s66, s67
    s_lshl_b32 s66, s66, 12
    s_add_u32 s66, s66, 2294784
    s_barrier
    s_cmp_eq_u32 s56, 3
    s_cbranch_scc1 L_svc4
    s_mov_b32 s63, 60000
hw_7:
    s_load_dword s67, s[48:49], s66 glc
    s_waitcnt lgkmcnt(0)
    s_cmp_eq_u32 s67, s57
    s_cbranch_scc1 hd_8
    s_sub_u32 s63, s63, 1
    s_cbranch_scc0 hw_7
hd_8:
L_svc4:
    s_waitcnt lgkmcnt(0)
    s_barrier
    buffer_load_dwordx4 v[68:71], v26, s[48:51], s31 offen sc1
    buffer_load_dwordx4 v[76:79], v27, s[48:51], s31 offen sc1
    buffer_load_dwordx4 v[64:67], v26, s[48:51], s30 offen sc1
    buffer_load_dwordx4 v[72:75], v27, s[48:51], s30 offen sc1
    buffer_load_dwordx2 v[90:91], v34, s[48:51], s29 offen sc1
    s_cmp_lt_u32 s56, 4
    s_cbranch_scc1 wi_9
    s_waitcnt vmcnt(13)
wi_9:
    s_barrier
    ds_read_b32 v84, v21 offset:32768
    v_add_u32 v30, 98304, v36
    ds_read_b64_tr_b16 v[96:97], v30 offset:0
    ds_read_b64_tr_b16 v[98:99], v30 offset:1024
    ds_read_b64_tr_b16 v[100:101], v30 offset:8192
    ds_read_b64_tr_b16 v[102:103], v30 offset:9216
    ds_read_b64_tr_b16 v[104:105], v30 offset:16384
    ds_read_b64_tr_b16 v[106:107], v30 offset:17408
    ds_read_b64_tr_b16 v[108:109], v30 offset:24576
    ds_read_b64_tr_b16 v[110:111], v30 offset:25600
    s_lshl_b32 s66, s55, 12
    s_lshl_b32 s67, s56, 9
    s_add_u32 s66, s66, s67
    s_add_u32 s66, s66, s72
    s_add_u32 s66, s66, 2162688
    s_mov_b32 s68, 0xff
    s_waitcnt lgkmcnt(8)
    v_lshlrev_b32 v88, 16, v84
    v_and_b32 v89, 0xffff0000, v84
    s_mov_b32 s63, 60000
    s_waitcnt vmcnt(0)
poll_11:
    v_xor_b32 v64, v64, v12
    v_xor_b32 v65, v65, v13
    v_xor_b32 v66, v66, v14
    v_xor_b32 v67, v67, v15
    v_xor_b32 v68, v68, v12
    v_xor_b32 v69, v69, v13
    v_xor_b32 v70, v70, v14
    v_xor_b32 v71, v71, v15
    v_xor_b32 v72, v72, v12
    v_xor_b32 v73, v73, v13
    v_xor_b32 v74, v74, v14
    v_xor_b32 v75, v75, v15
    v_xor_b32 v76, v76, v12
    v_xor_b32 v77, v77, v13
    v_xor_b32 v78, v78, v14
    v_xor_b32 v79, v79, v15
    v_or3_b32 v80, v64, v65, v66
    v_or3_b32 v81, v67, v68, v69
    v_or3_b32 v80, v80, v70, v71
    v_or3_b32 v81, v81, v72, v73
    v_or3_b32 v80, v80, v74, v75
    v_or3_b32 v81, v81, v76, v77
    v_or3_b32 v80, v80, v78, v79
    v_or_b32 v80, v80, v81
    v_and_b32 v80, 0xff, v80
    v_cmp_ne_u32 vcc, 0, v80
    s_cbranch_vccz pdone_12
    s_sleep 1
    buffer_load_dwordx4 v[68:71], v26, s[48:51], s31 offen sc1
    buffer_load_dwordx4 v[76:79], v27, s[48:51], s31 offen sc1
    buffer_load_dwordx4 v[64:67], v26, s[48:51], s30 offen sc1
    buffer_load_dwordx4 v[72:75], v27, s[48:51], s30 offen sc1
    s_sub_u32 s63, s63, 1
    s_waitcnt vmcnt(0)
    s_cbranch_scc0 poll_11
pdone_12:
    v_add_f32 v68, v68, v76
    v_add_f32 v69, v69, v77
    v_add_f32 v70, v70, v78
    v_add_f32 v71, v71, v79
    v_add_f32 v64, v64, v72
    v_add_f32 v65, v65, v73
    v_add_f32 v66, v66, v74
    v_add_f32 v67, v67, v75
    v_permlane32_swap_b32 v68, v70
    v_permlane32_swap_b32 v69, v71
    v_permlane32_swap_b32 v64, v66
    v_permlane32_swap_b32 v65, v67
    v_add_f32 v68, v68, v70
    v_add_f32 v69, v69, v71
    v_add_f32 v64, v64, v66
    v_add_f32 v65, v65, v67
    v_cvt_pk_bf16_f32 v68, 0, v68
    v_cvt_pk_bf16_f32 v69, 0, v69
    v_cvt_pk_bf16_f32 v64, 0, v64
    v_cvt_pk_bf16_f32 v65, 0, v65
    v_add_f32 v68, 1.0, v68
    v_add_f32 v69, 1.0, v69
    v_cvt_pk_bf16_f32 v68, 0, v68
    v_cvt_pk_bf16_f32 v69, 0, v69
    v_mul_f32 v68, v68, v88
    v_mul_f32 v69, v69, v89
    v_cvt_pk_bf16_f32 v68, 0, v68
    v_cvt_pk_bf16_f32 v69, 0, v69
    v_add_f32 v68, v68, v64
    v_add_f32 v69, v69, v65
    v_cvt_pk_bf16_f32 v68, v68, v69
    ds_write_b32 v20, v68 offset:49152
    s_waitcnt lgkmcnt(0)
    s_barrier
    ds_read_b128 v[64:67], v22 offset:49152
    ds_read_b128 v[68:71], v22 offset:49280
    v_xor_b32 v90, s57, v90
    v_xor_b32 v91, s28, v91
    v_or_b32 v90, v90, v91
    v_cmp_ne_u32 vcc, 0, v90
    s_lshl_b32 s64, s60, 14
    s_add_u32 s64, s64, s67
    s_add_u32 s64, s64, s72
    s_add_u32 s64, s64, 2162688
    s_add_u32 s65, s64, 8192
    s_waitcnt lgkmcnt(1)
    v_mfma_f32_16x16x32_bf16 v[112:115], v[96:99], v[64:67], 0
    v_mfma_f32_16x16x32_bf16 v[116:119], v[100:103], v[64:67], 0
    s_waitcnt lgkmcnt(0)
    v_mfma_f32_16x16x32_bf16 v[112:115], v[104:107], v[68:71], v[112:115]
    v_mfma_f32_16x16x32_bf16 v[116:119], v[108:111], v[68:71], v[116:119]
    s_nop 7
    v_add_f32_dpp v112, v116, v112 row_ror:8 row_mask:0xf bank_mask:0xf
    v_add_f32_dpp v113, v117, v113 row_ror:8 row_mask:0xf bank_mask:0xf
    v_add_f32_dpp v114, v118, v114 row_ror:8 row_mask:0xf bank_mask:0xf
    v_add_f32_dpp v115, v119, v115 row_ror:8 row_mask:0xf bank_mask:0xf
    v_bfi_b32 v112, s68, v12, v112
    v_bfi_b32 v113, s68, v13, v113
    v_bfi_b32 v114, s68, v14, v114
    v_bfi_b32 v115, s68, v15, v115
    s_mov_b32 exec_lo, 0xff00ff
    s_mov_b32 exec_hi, 0xff00ff
    s_cbranch_vccnz far_13
    buffer_store_dwordx4 v[112:115], v23, s[48:51], s66 offen
    s_branch dn_14
far_13:
    buffer_store_dwordx4 v[112:115], v23, s[48:51], s66 offen sc1
dn_14:
    s_mov_b64 exec, -1
    s_cmp_ge_u32 s56, 4
    s_cbranch_scc1 wi_15
    v_lshrrev_b32 v40, 2, v1
    v_lshl_add_u32 v40, v40, 3, v38
    v_lshlrev_b32 v40, 8, v40
    s_lshl_b32 s69, s56, 13
    v_add_u32 v40, s69, v40
    v_xor_b32 v41, v1, v2
    v_lshlrev_b32 v30, 18, v19
    v_lshl_add_u32 v30, v2, 4, v30
    s_lshr_b32 s69, s60, 4
    s_lshl_b32 s69, s69, 14
    s_lshl_b32 s66, s61, 12
    s_add_u32 s69, s69, s66
    s_lshl_b32 s66, s56, 10
    s_add_u32 s69, s69, s66
    s_and_b32 s66, s60, 15
    s_lshl_b32 s66, s66, 6
    s_add_u32 s69, s69, s66
    s_add_u32 s69, s69, 2097152
    v_xor_b32 v42, 0, v41
    v_lshl_add_u32 v42, v42, 4, v40
    ds_read_b128 v[128:131], v42 offset:0
    ds_read_b128 v[144:147], v42 offset:1024
    v_xor_b32 v42, 4, v41
    v_lshl_add_u32 v42, v42, 4, v40
    ds_read_b128 v[132:135], v42 offset:0
    ds_read_b128 v[148:151], v42 offset:1024
    v_xor_b32 v42, 8, v41
    v_lshl_add_u32 v42, v42, 4, v40
    ds_read_b128 v[136:139], v42 offset:0
    ds_read_b128 v[152:155], v42 offset:1024
    v_xor_b32 v42, 12, v41
    v_lshl_add_u32 v42, v42, 4, v40
    ds_read_b128 v[140:143], v42 offset:0
    ds_read_b128 v[156:159], v42 offset:1024
    s_branch wd_16
wi_15:
    v_lshlrev_b32 v40, 4, v0
    ds_read_b128 v[128:131], v40 offset:45056
    ds_read_b128 v[132:135], v40 offset:46080
    s_and_b32 s69, s56, 3
    s_lshl_b32 s66, s69, 5
    v_xor_b32 v41, s66, v5
    v_add_u32 v41, 139264, v41
    s_lshl_b32 s69, s69, 9
    s_lshl_b32 s66, s55, 12
    s_add_u32 s69, s69, s66
    s_add_u32 s69, s69, s72
    s_add_u32 s69, s69, 2228224
wd_16:
    s_mov_b32 s63, 60000
    buffer_load_dwordx4 v[64:67], v39, s[48:51], s64 offen sc1
    buffer_load_dwordx4 v[68:71], v39, s[48:51], s65 offen sc1
    s_waitcnt vmcnt(0)
poll_17:
    v_xor_b32 v64, v64, v12
    v_xor_b32 v65, v65, v13
    v_xor_b32 v66, v66, v14
    v_xor_b32 v67, v67, v15
    v_xor_b32 v68, v68, v12
    v_xor_b32 v69, v69, v13
    v_xor_b32 v70, v70, v14
    v_xor_b32 v71, v71, v15
    v_or3_b32 v72, v64, v65, v66
    v_or3_b32 v73, v67, v68, v69
    v_or3_b32 v72, v72, v70, v71
    v_or_b32 v72, v72, v73
    v_and_b32 v72, 0xff, v72
    v_cmp_ne_u32 vcc, 0, v72
    s_cbranch_vccz pdone_18
    buffer_load_dwordx4 v[64:67], v39, s[48:51], s64 offen sc1
    buffer_load_dwordx4 v[68:71], v39, s[48:51], s65 offen sc1
    s_sub_u32 s63, s63, 1
    s_waitcnt vmcnt(0)
    s_cbranch_scc0 poll_17
pdone_18:
    v_add_f32 v64, v64, v68
    v_add_f32 v65, v65, v69
    v_add_f32 v66, v66, v70
    v_add_f32 v67, v67, v71
    s_nop 0
    v_permlane32_swap_b32 v64, v66
    v_permlane32_swap_b32 v65, v67
    v_add_f32 v64, v64, v66
    v_add_f32 v65, v65, v67
    v_cvt_pk_bf16_f32 v64, v64, v65
    ds_write_b32 v20, v64 offset:53248
    s_waitcnt lgkmcnt(0)
    s_barrier
    s_cmp_ge_u32 s56, 4
    s_cbranch_scc1 wi_19
    ds_read_b128 v[64:67], v22 offset:53248
    ds_read_b128 v[68:71], v22 offset:53376
    s_waitcnt lgkmcnt(0)
    v_mfma_f32_16x16x32_bf16 v[96:99], v[128:131], v[64:67], 0
    v_mfma_f32_16x16x32_bf16 v[100:103], v[132:135], v[64:67], 0
    v_mfma_f32_16x16x32_bf16 v[104:107], v[144:147], v[64:67], 0
    v_mfma_f32_16x16x32_bf16 v[108:111], v[148:151], v[64:67], 0
    v_mfma_f32_16x16x32_bf16 v[96:99], v[136:139], v[68:71], v[96:99]
    v_mfma_f32_16x16x32_bf16 v[100:103], v[140:143], v[68:71], v[100:103]
    v_mfma_f32_16x16x32_bf16 v[104:107], v[152:155], v[68:71], v[104:107]
    v_mfma_f32_16x16x32_bf16 v[108:111], v[156:159], v[68:71], v[108:111]
    s_nop 5
    v_add_f32_dpp v96, v100, v96 row_ror:8 row_mask:0xf bank_mask:0xf
    v_add_f32_dpp v97, v101, v97 row_ror:8 row_mask:0xf bank_mask:0xf
    v_add_f32_dpp v98, v102, v98 row_ror:8 row_mask:0xf bank_mask:0xf
    v_add_f32_dpp v99, v103, v99 row_ror:8 row_mask:0xf bank_mask:0xf
    v_add_f32_dpp v104, v108, v104 row_ror:8 row_mask:0xf bank_mask:0xf
    v_add_f32_dpp v105, v109, v105 row_ror:8 row_mask:0xf bank_mask:0xf
    v_add_f32_dpp v106, v110, v106 row_ror:8 row_mask:0xf bank_mask:0xf
    v_add_f32_dpp v107, v111, v107 row_ror:8 row_mask:0xf bank_mask:0xf
    v_cvt_pk_bf16_f32 v72, v96, v97
    v_cvt_pk_bf16_f32 v73, v98, v99
    v_cvt_pk_bf16_f32 v74, v104, v105
    v_cvt_pk_bf16_f32 v75, v106, v107
    s_mov_b32 exec_lo, 0xff00ff
    s_mov_b32 exec_hi, 0xff00ff
    buffer_store_dwordx4 v[72:75], v30, s[48:51], s69 offen sc1
    s_mov_b64 exec, -1
    s_barrier
    s_cmp_lg_u32 s56, 3
    s_cbranch_scc1 noflg_21
    v_mov_b32 v76, s57
    v_not_b32 v77, v76
    s_lshl_b32 s67, s54, 7
    s_lshl_b32 s66, s52, 3
    s_add_u32 s67, s67, s66
    v_lshlrev_b32 v78, 11, v0
    s_mov_b32 exec_lo, 0xff
    s_mov_b32 exec_hi, 0x0
    s_add_u32 s67, s67, 98304
    buffer_store_dwordx2 v[76:77], v78, s[48:51], s67 offen sc1
    s_mov_b64 exec, -1
noflg_21:
    s_branch wd_20
wi_19:
    s_barrier
    s_add_u32 s64, s33, 0
    s_add_u32 m0, s34, 0
    s_nop 0
    buffer_load_dwordx4 v32, s[40:43], s64 offen nt lds
    s_add_u32 s64, s33, 49152
    s_add_u32 m0, s34, 1024
    s_nop 0
    buffer_load_dwordx4 v33, s[40:43], s64 offen nt lds
    s_add_u32 s64, s33, 98304
    s_add_u32 m0, s34, 2048
    s_nop 0
    buffer_load_dwordx4 v32, s[40:43], s64 offen nt lds
    s_add_u32 s64, s33, 147456
    s_add_u32 m0, s34, 3072
    s_nop 0
    buffer_load_dwordx4 v33, s[40:43], s64 offen nt lds
    s_mov_b32 s35, s69
wd_20:
    v_and_b32 v30, 1, v0
    v_lshlrev_b32 v30, 7, v30
    s_lshl_b32 s69, s52, 11
    s_lshl_b32 s66, s56, 8
    s_add_u32 s69, s69, s66
    s_add_u32 s69, s69, 4096
    v_bfe_u32 v37, v1, 2, 1
    v_lshlrev_b32 v37, 12, v37
    v_lshl_add_u32 v37, v38, 5, v37
    v_lshl_add_u32 v37, v2, 3, v37
    s_lshl_b32 s32, s60, 13
    s_lshl_b32 s66, s61, 10
    s_add_u32 s32, s32, s66
    s_lshl_b32 s66, s56, 7
    s_add_u32 s32, s32, s66
    s_add_u32 s32, s32, s73
    s_add_u32 s32, s32, 2129920
    s_lshl_b32 s64, s60, 14
    s_lshl_b32 s65, s61, 9
    s_add_u32 s64, s64, s65
    s_add_u32 s64, s64, s72
    s_add_u32 s64, s64, 2228224
    s_add_u32 s65, s64, 8192
    s_mul_i32 s66, s56, 56
    s_lshl_b32 s67, s52, 22
    s_add_u32 s33, s66, 1152
    v_add_u32 v119, s33, v0
    v_lshrrev_b32 v115, 8, v119
    v_mul_u32_u24 v115, 1, v115
    v_add_u32 v115, s54, v115
    v_and_b32 v115, 15, v115
    v_lshlrev_b32 v115, 18, v115
    v_lshl_add_u32 v118, v119, 7, v115
    s_add_u32 s33, s66, 1600
    v_add_u32 v119, s33, v0
    v_lshrrev_b32 v115, 8, v119
    v_mul_u32_u24 v115, 1, v115
    v_add_u32 v115, s54, v115
    v_and_b32 v115, 15, v115
    v_lshlrev_b32 v115, 18, v115
    v_lshl_add_u32 v117, v119, 7, v115
    buffer_load_dwordx2 v[90:91], v30, s[48:51], s69 offen sc1
    buffer_load_dwordx2 v[92:93], v37, s[48:51], s32 offen sc1
    s_cmp_ge_u32 s56, 4
    s_cbranch_scc1 wi_22
    s_mov_b32 exec_lo, 0xffffffff
    s_mov_b32 exec_hi, 0xffffff
    buffer_load_dword v118, v118, s[8:11], s67 offen
    s_mov_b64 exec, -1
    s_barrier
    s_branch wd_23
wi_22:
    s_waitcnt vmcnt(2)
    s_barrier
    s_mov_b32 s69, s35
    ds_read_b64_tr_b16 v[64:65], v41 offset:0
    ds_read_b64_tr_b16 v[66:67], v41 offset:512
    ds_read_b64_tr_b16 v[68:69], v41 offset:4096
    ds_read_b64_tr_b16 v[70:71], v41 offset:4608
    ds_read_b64_tr_b16 v[72:73], v41 offset:8192
    ds_read_b64_tr_b16 v[74:75], v41 offset:8704
    ds_read_b64_tr_b16 v[76:77], v41 offset:12288
    ds_read_b64_tr_b16 v[78:79], v41 offset:12800
    s_waitcnt lgkmcnt(6)
    v_mfma_f32_16x16x32_bf16 v[96:99], v[64:67], v[128:131], 0
    s_waitcnt lgkmcnt(4)
    v_mfma_f32_16x16x32_bf16 v[100:103], v[68:71], v[128:131], 0
    s_waitcnt lgkmcnt(2)
    v_mfma_f32_16x16x32_bf16 v[96:99], v[72:75], v[132:135], v[96:99]
    s_waitcnt lgkmcnt(0)
    v_mfma_f32_16x16x32_bf16 v[100:103], v[76:79], v[132:135], v[100:103]
    s_nop 7
    v_add_f32_dpp v96, v100, v96 row_ror:8 row_mask:0xf bank_mask:0xf
    v_add_f32_dpp v97, v101, v97 row_ror:8 row_mask:0xf bank_mask:0xf
    v_add_f32_dpp v98, v102, v98 row_ror:8 row_mask:0xf bank_mask:0xf
    v_add_f32_dpp v99, v103, v99 row_ror:8 row_mask:0xf bank_mask:0xf
    v_bfi_b32 v96, s68, v12, v96
    v_bfi_b32 v97, s68, v13, v97
    v_bfi_b32 v98, s68, v14, v98
    v_bfi_b32 v99, s68, v15, v99
    s_mov_b32 exec_lo, 0xff00ff
    s_mov_b32 exec_hi, 0xff00ff
    buffer_store_dwordx4 v[96:99], v23, s[48:51], s69 offen sc1
    s_mov_b64 exec, -1
    s_mov_b32 exec_lo, 0xffffffff
    s_mov_b32 exec_hi, 0xffffff
    buffer_load_dword v118, v118, s[8:11], s67 offen
    s_mov_b64 exec, -1
wd_23:
    s_barrier
    s_cmp_lg_u32 s56, 5
    s_cbranch_scc1 wi_24
    buffer_load_dwordx4 v[64:67], v39, s[48:51], s64 offen sc1
    buffer_load_dwordx4 v[68:71], v39, s[48:51], s65 offen sc1
wi_24:
    s_mov_b32 exec_lo, 0xffffffff
    s_mov_b32 exec_hi, 0xffffff
    buffer_load_dword v117, v117, s[8:11], s67 offen
    s_mov_b64 exec, -1
    s_barrier
    s_waitcnt vmcnt(3)
    v_xor_b32 v90, s57, v90
    v_xor_b32 v91, s28, v91
    v_or_b32 v90, v90, v91
    v_and_b32 v91, 1, v0
    s_lshl_b32 s66, s56, 3
    s_add_u32 s66, s66, 160000
    v_lshl_add_u32 v91, v91, 2, s66
    ds_write_b32 v91, v90
    s_cmp_lg_u32 s56, 5
    s_cbranch_scc1 wi_26
    s_mov_b32 s63, 60000
    s_waitcnt vmcnt(1)
poll_28:
    v_xor_b32 v64, v64, v12
    v_xor_b32 v65, v65, v13
    v_xor_b32 v66, v66, v14
    v_xor_b32 v67, v67, v15
    v_xor_b32 v68, v68, v12
    v_xor_b32 v69, v69, v13
    v_xor_b32 v70, v70, v14
    v_xor_b32 v71, v71, v15
    v_or3_b32 v72, v64, v65, v66
    v_or3_b32 v73, v67, v68, v69
    v_or3_b32 v72, v72, v70, v71
    v_or_b32 v72, v72, v73
    v_and_b32 v72, 0xff, v72
    v_cmp_ne_u32 vcc, 0, v72
    s_cbranch_vccz pdone_29
    s_sleep 2
    buffer_load_dwordx4 v[64:67], v39, s[48:51], s64 offen sc1
    buffer_load_dwordx4 v[68:71], v39, s[48:51], s65 offen sc1
    s_sub_u32 s63, s63, 1
    s_waitcnt vmcnt(0)
    s_cbranch_scc0 poll_28
pdone_29:
    v_add_f32 v64, v64, v68
    v_add_f32 v65, v65, v69
    v_add_f32 v66, v66, v70
    v_add_f32 v67, v67, v71
    s_nop 0
    v_permlane32_swap_b32 v64, v66
    v_permlane32_swap_b32 v65, v67
    v_add_f32 v64, v64, v66
    v_add_f32 v65, v65, v67
    s_lshr_b32 s66, s55, 5
    s_lshl_b32 s65, s66, 13
    s_and_b32 s67, s55, 31
    s_lshl_b32 s67, s67, 5
    s_add_u32 s65, s65, s67
    s_add_u32 s65, s65, 32768
    s_cmp_eq_u32 s66, 2
    s_cselect_b32 s66, 1.0, 0
    v_cvt_pk_bf16_f32 v64, 0, v64
    v_cvt_pk_bf16_f32 v65, 0, v65
    v_add_f32 v64, s66, v64
    v_add_f32 v65, s66, v65
    v_cvt_pk_bf16_f32 v64, v64, v65
    buffer_store_dword v64, v24, s[48:51], s65 offen sc1
wi_26:
    s_cmp_ge_u32 s56, 4
    s_cbranch_scc1 wi_30
    v_lshrrev_b32 v114, 3, v3
    v_lshlrev_b32 v114, 13, v114
    v_lshl_add_u32 v114, v19, 7, v114
    s_lshl_b32 s67, s54, 18
    s_lshl_b32 s68, s52, 10
    s_add_u32 s67, s67, s68
    buffer_load_dword v114, v114, s[20:23], s67 offen
    s_barrier
    s_branch wd_31
wi_30:
    s_barrier
wd_31:
    s_lshl_b32 s62, s54, 2
    s_add_u32 s62, s62, s56
    s_and_b32 s62, s62, 7
    v_lshrrev_b32 v17, 3, v0
    v_lshlrev_b32 v17, 10, v17
    v_add_u32 v17, v17, v95
    v_xor_b32 v18, 64, v17
    s_lshl_b32 s74, s52, 19
    s_lshl_b32 s66, s62, 16
    s_add_u32 s74, s74, s66
    s_lshr_b32 s66, s54, 1
    s_xor_b32 s66, s66, 4
    s_lshl_b32 s66, s66, 7
    s_add_u32 s74, s74, s66
    s_lshl_b32 s75, s56, 13
    s_add_u32 s75, s75, 32768
    v_add_u32 v5, s75, v5
    v_and_b32 v38, 3, v1
    v_lshlrev_b32 v32, 10, v2
    v_lshl_add_u32 v32, v1, 4, v32
    s_lshl_b32 s64, s55, 15
    s_lshl_b32 s65, s56, 12
    s_add_u32 s64, s64, s65
    s_add_u32 s64, s64, 4194304
    s_lshl_b32 s66, s56, 8
    s_add_u32 s66, s66, 155648
    v_and_b32 v33, 1, v1
    v_lshlrev_b32 v33, 5, v33
    v_lshl_add_u32 v33, v2, 3, v33
    v_add_u32 v33, s66, v33
    v_lshlrev_b32 v44, 5, v2
    v_lshl_add_u32 v44, v1, 1, v44
    v_add_u32 v44, s66, v44
    s_mul_i32 s66, s56, 272
    s_add_u32 s66, s66, 157696
    v_lshlrev_b32 v34, 4, v1
    v_add_u32 v34, s66, v34
    v_mul_u32_u24 v35, 272, v19
    v_lshl_add_u32 v35, v2, 4, v35
    v_add_u32 v35, 157696, v35
    v_lshlrev_b32 v49, 3, v38
    v_lshrrev_b32 v49, v49, s57
    v_bfe_u32 v8, v49, 0, 1
    v_bfe_u32 v48, v49, 1, 1
    v_lshl_or_b32 v8, v48, 16, v8
    v_bfe_u32 v9, v49, 2, 1
    v_bfe_u32 v48, v49, 3, 1
    v_lshl_or_b32 v9, v48, 16, v9
    v_bfe_u32 v10, v49, 4, 1
    v_bfe_u32 v48, v49, 5, 1
    v_lshl_or_b32 v10, v48, 16, v10
    v_bfe_u32 v11, v49, 6, 1
    v_bfe_u32 v48, v49, 7, 1
    v_lshl_or_b32 v11, v48, 16, v11
    v_lshlrev_b32 v39, 8, v1
    s_lshl_b32 s66, s56, 12
    s_lshl_b32 s67, s60, 3
    s_add_u32 s66, s66, s67
    s_add_u32 s66, s66, 65536
    s_mov_b32 s31, s66
    v_lshrrev_b32 v56, 2, v1
    v_lshlrev_b32 v57, 6, v56
    v_lshlrev_b32 v56, 10, v56
    v_lshl_add_u32 v56, v38, 5, v56
    v_lshrrev_b32 v58, 1, v2
    v_lshl_add_u32 v56, v58, 7, v56
    v_and_b32 v58, 1, v2
    v_lshl_add_u32 v56, v58, 4, v56
    s_and_b32 s69, s54, 1
    s_lshl_b32 s33, s52, 15
    s_lshr_b32 s68, s62, 1
    s_lshl_b32 s68, s68, 13
    s_add_u32 s33, s33, s68
    s_lshl_b32 s68, s69, 12
    s_add_u32 s33, s33, s68
    s_and_b32 s68, s62, 1
    s_lshl_b32 s68, s68, 9
    s_add_u32 s33, s33, s68
    s_add_u32 s33, s33, s73
    s_add_u32 s33, s33, 2129920
    v_mul_u32_u24 v58, 272, v38
    v_add_u32 v57, v57, v58
    v_lshl_add_u32 v57, v2, 4, v57
    s_mul_i32 s68, s56, 1088
    s_add_u32 s68, s68, 98304
    v_add_u32 v57, s68, v57
    v_lshlrev_b32 v58, 3, v3
    v_lshrrev_b32 v59, 5, v3
    v_lshl_add_u32 v58, v59, 4, v58
    v_add_u32 v58, 98304, v58
    v_lshrrev_b32 v59, 5, v3
    v_lshlrev_b32 v59, 13, v59
    v_and_b32 v60, 31, v3
    v_lshl_add_u32 v59, v60, 2, v59
    s_lshl_b32 s34, s69, 15
    s_lshl_b32 s68, s52, 10
    s_add_u32 s34, s34, s68
    s_lshr_b32 s68, s54, 1
    s_xor_b32 s68, s68, 4
    s_lshl_b32 s68, s68, 7
    s_add_u32 s34, s34, s68
    s_add_u32 s34, s34, 116736
    v_lshlrev_b32 v110, 2, v1
    v_add_u32 v110, 160000, v110
    s_lshl_b32 s30, s60, 10
    s_lshl_b32 s65, s56, 7
    s_add_u32 s30, s30, s65
    s_add_u32 s30, s30, 1572864
    v_and_b32 v28, 1, v2
    v_lshlrev_b32 v28, 18, v28
    v_lshrrev_b32 v29, 1, v2
    v_lshl_add_u32 v28, v29, 17, v28
    v_lshlrev_b32 v29, 1, v2
    v_xor_b32 v29, v29, v1
    v_lshl_add_u32 v28, v29, 4, v28
    v_xor_b32 v29, 128, v28
    s_lshl_b32 s65, s61, 20
    s_mul_i32 s66, s56, 16384
    s_add_u32 s65, s65, s66
    s_lshl_b32 s66, s60, 8
    s_add_u32 s65, s65, s66
    s_mul_i32 s66, s56, 4096
    s_add_u32 s67, s65, 0
    s_add_u32 s68, s66, 0
    s_mov_b32 m0, s68
    s_nop 0
    buffer_load_dwordx4 v28, s[20:23], s67 offen nt lds
    s_add_u32 s67, s65, 524288
    s_add_u32 s68, s66, 1024
    s_mov_b32 m0, s68
    s_nop 0
    buffer_load_dwordx4 v28, s[20:23], s67 offen nt lds
    s_add_u32 s67, s65, 8192
    s_add_u32 s68, s66, 2048
    s_mov_b32 m0, s68
    s_nop 0
    buffer_load_dwordx4 v29, s[20:23], s67 offen nt lds
    s_add_u32 s67, s65, 532480
    s_add_u32 s68, s66, 3072
    s_mov_b32 m0, s68
    s_nop 0
    buffer_load_dwordx4 v29, s[20:23], s67 offen nt lds
    s_load_dword s65, s[48:49], s30 glc
    s_waitcnt lgkmcnt(0)
    s_mov_b32 s78, 1
    s_cmp_eq_u32 s65, s57
    s_cbranch_scc1 gotst_32
    s_mov_b32 s78, 0
    s_add_u32 s65, s74, 0
    s_add_u32 m0, s75, 0
    s_nop 0
    buffer_load_dwordx4 v17, s[24:27], s65 offen  lds
    s_add_u32 s65, s74, 8192
    s_add_u32 m0, s75, 1024
    s_nop 0
    buffer_load_dwordx4 v18, s[24:27], s65 offen  lds
    s_add_u32 s65, s74, 16384
    s_add_u32 m0, s75, 2048
    s_nop 0
    buffer_load_dwordx4 v17, s[24:27], s65 offen  lds
    s_add_u32 s65, s74, 24576
    s_add_u32 m0, s75, 3072
    s_nop 0
    buffer_load_dwordx4 v18, s[24:27], s65 offen  lds
    s_add_u32 s65, s74, 32768
    s_add_u32 m0, s75, 4096
    s_nop 0
    buffer_load_dwordx4 v17, s[24:27], s65 offen  lds
    s_add_u32 s65, s74, 40960
    s_add_u32 m0, s75, 5120
    s_nop 0
    buffer_load_dwordx4 v18, s[24:27], s65 offen  lds
    s_add_u32 s65, s74, 49152
    s_add_u32 m0, s75, 6144
    s_nop 0
    buffer_load_dwordx4 v17, s[24:27], s65 offen  lds
    s_add_u32 s65, s74, 57344
    s_add_u32 m0, s75, 7168
    s_nop 0
    buffer_load_dwordx4 v18, s[24:27], s65 offen  lds
    s_mov_b32 s63, 60000
hw_33:
    s_load_dword s65, s[48:49], s30 glc
    s_waitcnt lgkmcnt(0)
    s_cmp_eq_u32 s65, s57
    s_cbranch_scc1 hd_34
    s_sub_u32 s63, s63, 1
    s_cbranch_scc0 hw_33
hd_34:
gotst_32:
    buffer_load_dwordx2 v[40:41], v39, s[48:51], s31 offen sc1
    buffer_load_dwordx4 v[64:67], v32, s[48:51], s64 offen offset:0 sc1
    buffer_load_dwordx4 v[68:71], v32, s[48:51], s64 offen offset:256 sc1
    buffer_load_dwordx4 v[72:75], v32, s[48:51], s64 offen offset:512 sc1
    buffer_load_dwordx4 v[76:79], v32, s[48:51], s64 offen offset:768 sc1
    s_waitcnt vmcnt(4)
    v_max_u32 v47, v40, v41
    v_cmp_eq_u32 vcc, -1, v47
    s_cbranch_vccz okst_35
    s_mov_b32 s63, 60000
poll_36:
    buffer_load_dwordx2 v[40:41], v39, s[48:51], s31 offen sc1
    s_waitcnt vmcnt(0)
    v_max_u32 v47, v40, v41
    v_cmp_eq_u32 vcc, -1, v47
    s_cbranch_vccz pdone_37
    s_sub_u32 s63, s63, 1
    s_cbranch_scc0 poll_36
pdone_37:
okst_35:
    s_cmp_eq_u32 s78, 0
    s_cbranch_scc1 nr_38
    s_add_u32 s65, s74, 0
    s_add_u32 m0, s75, 0
    s_nop 0
    buffer_load_dwordx4 v17, s[24:27], s65 offen  lds
    s_add_u32 s65, s74, 8192
    s_add_u32 m0, s75, 1024
    s_nop 0
    buffer_load_dwordx4 v18, s[24:27], s65 offen  lds
    s_add_u32 s65, s74, 16384
    s_add_u32 m0, s75, 2048
    s_nop 0
    buffer_load_dwordx4 v17, s[24:27], s65 offen  lds
    s_add_u32 s65, s74, 24576
    s_add_u32 m0, s75, 3072
    s_nop 0
    buffer_load_dwordx4 v18, s[24:27], s65 offen  lds
    s_add_u32 s65, s74, 32768
    s_add_u32 m0, s75, 4096
    s_nop 0
    buffer_load_dwordx4 v17, s[24:27], s65 offen  lds
    s_add_u32 s65, s74, 40960
    s_add_u32 m0, s75, 5120
    s_nop 0
    buffer_load_dwordx4 v18, s[24:27], s65 offen  lds
    s_add_u32 s65, s74, 49152
    s_add_u32 m0, s75, 6144
    s_nop 0
    buffer_load_dwordx4 v17, s[24:27], s65 offen  lds
    s_add_u32 s65, s74, 57344
    s_add_u32 m0, s75, 7168
    s_nop 0
    buffer_load_dwordx4 v18, s[24:27], s65 offen  lds
nr_38:
    v_mov_b32 v42, v40
    s_nop 1
    v_max_f32_dpp v42, v42, v42 row_ror:8 row_mask:0xf bank_mask:0xf
    s_nop 1
    v_max_f32_dpp v42, v42, v42 row_ror:4 row_mask:0xf bank_mask:0xf
    s_nop 1
    v_max_f32_dpp v42, v42, v42 row_ror:2 row_mask:0xf bank_mask:0xf
    s_nop 1
    v_max_f32_dpp v42, v42, v42 row_ror:1 row_mask:0xf bank_mask:0xf
    v_sub_f32 v40, v40, v42
    v_exp_f32 v40, v40
    s_nop 0
    v_mul_f32 v41, v41, v40
    s_nop 1
    v_add_f32_dpp v41, v41, v41 row_ror:8 row_mask:0xf bank_mask:0xf
    s_nop 1
    v_add_f32_dpp v41, v41, v41 row_ror:4 row_mask:0xf bank_mask:0xf
    s_nop 1
    v_add_f32_dpp v41, v41, v41 row_ror:2 row_mask:0xf bank_mask:0xf
    s_nop 1
    v_add_f32_dpp v41, v41, v41 row_ror:1 row_mask:0xf bank_mask:0xf
    v_rcp_f32 v41, v41
    v_and_b32 v47, 1, v2
    v_cmp_eq_u32 vcc, 1, v47
    v_mul_f32 v40, v40, v41
    v_cvt_pk_bf16_f32 v42, v40, v40
    v_and_b32 v43, 0xffff0000, v42
    v_sub_f32 v40, v40, v43
    v_cvt_pk_bf16_f32 v43, v40, v40
    v_cndmask_b32 v42, v42, v43, vcc
    ds_write_b16 v44, v42
    s_waitcnt lgkmcnt(0)
    ds_read_b64 v[52:53], v33
    s_mov_b32 s63, 60000
    s_waitcnt vmcnt(8)
    s_cmp_lg_u32 s78, 0
    s_cbranch_scc1 chk_41
poll_39:
    s_waitcnt vmcnt(0)
chk_41:
    v_xor_b32 v80, v64, v8
    v_xor_b32 v81, v65, v9
    v_xor_b32 v82, v66, v10
    v_xor_b32 v83, v67, v11
    v_xor_b32 v84, v68, v8
    v_xor_b32 v85, v69, v9
    v_xor_b32 v86, v70, v10
    v_xor_b32 v87, v71, v11
    v_xor_b32 v88, v72, v8
    v_xor_b32 v89, v73, v9
    v_xor_b32 v90, v74, v10
    v_xor_b32 v91, v75, v11
    v_xor_b32 v92, v76, v8
    v_xor_b32 v93, v77, v9
    v_xor_b32 v94, v78, v10
    v_xor_b32 v95, v79, v11
    v_or3_b32 v47, v80, v81, v82
    v_or3_b32 v48, v83, v84, v85
    v_or3_b32 v47, v47, v86, v87
    v_or3_b32 v48, v48, v88, v89
    v_or3_b32 v47, v47, v90, v91
    v_or3_b32 v48, v48, v92, v93
    v_or3_b32 v47, v47, v94, v95
    v_or_b32 v47, v47, v48
    v_and_b32 v47, 0x00010001, v47
    v_cmp_ne_u32 vcc, 0, v47
    s_cbranch_vccz pdone_40
    buffer_load_dwordx4 v[64:67], v32, s[48:51], s64 offen offset:0 sc1
    buffer_load_dwordx4 v[68:71], v32, s[48:51], s64 offen offset:256 sc1
    buffer_load_dwordx4 v[72:75], v32, s[48:51], s64 offen offset:512 sc1
    buffer_load_dwordx4 v[76:79], v32, s[48:51], s64 offen offset:768 sc1
    s_sub_u32 s63, s63, 1
    s_cbranch_scc0 poll_39
    s_waitcnt vmcnt(0)
pdone_40:
    v_perm_b32 v64, v84, v80, s76
    v_perm_b32 v65, v92, v88, s76
    v_perm_b32 v66, v84, v80, s77
    v_perm_b32 v67, v92, v88, s77
    v_or_b32 v66, 0x00010001, v66
    v_or_b32 v67, 0x00010001, v67
    s_waitcnt lgkmcnt(0)
    v_mfma_f32_16x16x16_bf16 v[128:131], v[52:53], v[64:65], 0
    v_perm_b32 v68, v85, v81, s76
    v_perm_b32 v69, v93, v89, s76
    v_mfma_f32_16x16x16_bf16 v[132:135], v[52:53], v[66:67], 0
    v_perm_b32 v70, v85, v81, s77
    v_perm_b32 v71, v93, v89, s77
    v_or_b32 v70, 0x00010001, v70
    v_or_b32 v71, 0x00010001, v71
    v_mfma_f32_16x16x16_bf16 v[136:139], v[52:53], v[68:69], 0
    v_perm_b32 v72, v86, v82, s76
    v_perm_b32 v73, v94, v90, s76
    v_mfma_f32_16x16x16_bf16 v[140:143], v[52:53], v[70:71], 0
    v_perm_b32 v74, v86, v82, s77
    v_perm_b32 v75, v94, v90, s77
    v_or_b32 v74, 0x00010001, v74
    v_or_b32 v75, 0x00010001, v75
    v_mfma_f32_16x16x16_bf16 v[144:147], v[52:53], v[72:73], 0
    v_perm_b32 v76, v87, v83, s76
    v_perm_b32 v77, v95, v91, s76
    v_mfma_f32_16x16x16_bf16 v[148:151], v[52:53], v[74:75], 0
    v_perm_b32 v78, v87, v83, s77
    v_perm_b32 v79, v95, v91, s77
    v_or_b32 v78, 0x00010001, v78
    v_or_b32 v79, 0x00010001, v79
    v_mfma_f32_16x16x16_bf16 v[152:155], v[52:53], v[76:77], 0
    s_nop 0
    v_mfma_f32_16x16x16_bf16 v[156:159], v[52:53], v[78:79], 0
    v_add_f32 v128, v128, v129
    v_add_f32 v132, v132, v133
    v_add_f32 v136, v136, v137
    v_add_f32 v140, v140, v141
    v_add_f32 v144, v144, v145
    v_add_f32 v148, v148, v149
    v_add_f32 v152, v152, v153
    s_nop 0
    v_add_f32 v156, v156, v157
    v_cvt_pk_bf16_f32 v80, v128, v132
    v_cvt_pk_bf16_f32 v81, v136, v140
    v_cvt_pk_bf16_f32 v82, v144, v148
    v_cvt_pk_bf16_f32 v83, v152, v156
    s_mov_b32 exec_lo, 0xffff
    s_mov_b32 exec_hi, 0x0
    ds_write_b128 v34, v[80:83]
    s_mov_b64 exec, -1
    s_waitcnt lgkmcnt(0)
    s_barrier
    ds_read_b32 v110, v110
    ds_read_b128 v[64:67], v35 offset:0
    ds_read_b64_tr_b16 v[112:113], v36 offset:0
    ds_read_b64_tr_b16 v[114:115], v36 offset:1024
    ds_read_b128 v[68:71], v35 offset:64
    ds_read_b64_tr_b16 v[116:117], v36 offset:8192
    ds_read_b64_tr_b16 v[118:119], v36 offset:9216
    ds_read_b128 v[72:75], v35 offset:128
    ds_read_b64_tr_b16 v[120:121], v36 offset:16384
    ds_read_b64_tr_b16 v[122:123], v36 offset:17408
    ds_read_b128 v[76:79], v35 offset:192
    ds_read_b64_tr_b16 v[124:125], v36 offset:24576
    ds_read_b64_tr_b16 v[126:127], v36 offset:25600
    s_waitcnt lgkmcnt(9)
    v_mfma_f32_16x16x32_bf16 v[84:87], v[112:115], v[64:67], 0
    s_waitcnt lgkmcnt(6)
    v_mfma_f32_16x16x32_bf16 v[84:87], v[116:119], v[68:71], v[84:87]
    s_waitcnt lgkmcnt(3)
    v_mfma_f32_16x16x32_bf16 v[84:87], v[120:123], v[72:75], v[84:87]
    s_waitcnt lgkmcnt(0)
    v_mfma_f32_16x16x32_bf16 v[84:87], v[124:127], v[76:79], v[84:87]
    v_cmp_ne_u32 vcc, 0, v110
    s_or_b32 s29, vcc_lo, vcc_hi
    s_nop 5
    v_cvt_pk_bf16_f32 v88, v84, v85
    v_cvt_pk_bf16_f32 v89, v86, v87
    s_mov_b32 exec_lo, 0xff00ff
    s_mov_b32 exec_hi, 0xff00ff
    s_cmp_lg_u32 s29, 0
    s_cbranch_scc1 far_42
    buffer_store_dwordx2 v[88:89], v37, s[48:51], s32 offen
    s_branch dn_43
far_42:
    buffer_store_dwordx2 v[88:89], v37, s[48:51], s32 offen sc1
dn_43:
    s_mov_b64 exec, -1
    s_waitcnt vmcnt(1)
    v_xor_b32 v47, 0, v5
    ds_read_b64_tr_b16 v[192:193], v47 offset:0
    ds_read_b64_tr_b16 v[194:195], v47 offset:512
    ds_read_b64_tr_b16 v[208:209], v47 offset:4096
    ds_read_b64_tr_b16 v[210:211], v47 offset:4608
    v_xor_b32 v47, 32, v5
    ds_read_b64_tr_b16 v[196:197], v47 offset:0
    ds_read_b64_tr_b16 v[198:199], v47 offset:512
    ds_read_b64_tr_b16 v[212:213], v47 offset:4096
    ds_read_b64_tr_b16 v[214:215], v47 offset:4608
    v_xor_b32 v47, 64, v5
    ds_read_b64_tr_b16 v[200:201], v47 offset:0
    ds_read_b64_tr_b16 v[202:203], v47 offset:512
    ds_read_b64_tr_b16 v[216:217], v47 offset:4096
    ds_read_b64_tr_b16 v[218:219], v47 offset:4608
    v_xor_b32 v47, 96, v5
    ds_read_b64_tr_b16 v[204:205], v47 offset:0
    ds_read_b64_tr_b16 v[206:207], v47 offset:512
    ds_read_b64_tr_b16 v[220:221], v47 offset:4096
    ds_read_b64_tr_b16 v[222:223], v47 offset:4608
    s_mov_b32 s63, 60000
poll_44:
    buffer_load_dwordx4 v[64:67], v56, s[48:51], s33 offen offset:0 sc1
    buffer_load_dwordx4 v[68:71], v56, s[48:51], s33 offen offset:256 sc1
    s_waitcnt vmcnt(0)
    v_max3_u32 v47, v64, v66, v68
    v_max_u32 v47, v47, v70
    v_cmp_eq_u32 vcc, -1, v47
    s_cbranch_vccz pdone_45
    s_sub_u32 s63, s63, 1
    s_cbranch_scc0 poll_44
pdone_45:
    s_waitcnt lgkmcnt(0)
    v_mfma_f32_16x16x32_bf16 v[80:83], v[192:195], v[64:67], 0
    v_mfma_f32_16x16x32_bf16 v[84:87], v[196:199], v[64:67], 0
    v_mfma_f32_16x16x32_bf16 v[88:91], v[200:203], v[64:67], 0
    v_mfma_f32_16x16x32_bf16 v[92:95], v[204:207], v[64:67], 0
    v_mfma_f32_16x16x32_bf16 v[80:83], v[208:211], v[68:71], v[80:83]
    v_mfma_f32_16x16x32_bf16 v[84:87], v[212:215], v[68:71], v[84:87]
    v_mfma_f32_16x16x32_bf16 v[88:91], v[216:219], v[68:71], v[88:91]
    v_mfma_f32_16x16x32_bf16 v[92:95], v[220:223], v[68:71], v[92:95]
    s_nop 4
    v_add_f32_dpp v96, v80, v80 row_ror:8 row_mask:0xf bank_mask:0x3
    v_add_f32_dpp v97, v81, v81 row_ror:8 row_mask:0xf bank_mask:0x3
    v_add_f32_dpp v98, v82, v82 row_ror:8 row_mask:0xf bank_mask:0x3
    v_add_f32_dpp v99, v83, v83 row_ror:8 row_mask:0xf bank_mask:0x3
    v_add_f32_dpp v100, v84, v84 row_ror:8 row_mask:0xf bank_mask:0x3
    v_add_f32_dpp v101, v85, v85 row_ror:8 row_mask:0xf bank_mask:0x3
    v_add_f32_dpp v102, v86, v86 row_ror:8 row_mask:0xf bank_mask:0x3
    v_add_f32_dpp v103, v87, v87 row_ror:8 row_mask:0xf bank_mask:0x3
    v_add_f32_dpp v96, v88, v88 row_ror:8 row_mask:0xf bank_mask:0xc
    v_add_f32_dpp v97, v89, v89 row_ror:8 row_mask:0xf bank_mask:0xc
    v_add_f32_dpp v98, v90, v90 row_ror:8 row_mask:0xf bank_mask:0xc
    v_add_f32_dpp v99, v91, v91 row_ror:8 row_mask:0xf bank_mask:0xc
    v_add_f32_dpp v100, v92, v92 row_ror:8 row_mask:0xf bank_mask:0xc
    v_add_f32_dpp v101, v93, v93 row_ror:8 row_mask:0xf bank_mask:0xc
    v_add_f32_dpp v102, v94, v94 row_ror:8 row_mask:0xf bank_mask:0xc
    v_add_f32_dpp v103, v95, v95 row_ror:8 row_mask:0xf bank_mask:0xc
    v_add_f32_dpp v104, v96, v96 row_shl:4 row_mask:0xf bank_mask:0x5
    v_add_f32_dpp v105, v97, v97 row_shl:4 row_mask:0xf bank_mask:0x5
    v_add_f32_dpp v106, v98, v98 row_shl:4 row_mask:0xf bank_mask:0x5
    v_add_f32_dpp v107, v99, v99 row_shl:4 row_mask:0xf bank_mask:0x5
    v_add_f32_dpp v104, v100, v100 row_shr:4 row_mask:0xf bank_mask:0xa
    v_add_f32_dpp v105, v101, v101 row_shr:4 row_mask:0xf bank_mask:0xa
    v_add_f32_dpp v106, v102, v102 row_shr:4 row_mask:0xf bank_mask:0xa
    v_add_f32_dpp v107, v103, v103 row_shr:4 row_mask:0xf bank_mask:0xa
    ds_write_b128 v57, v[104:107]
    s_waitcnt lgkmcnt(0)
    s_barrier
    s_cmp_lg_u32 s56, 7
    s_cbranch_scc1 nohint_46
    s_lshl_b32 s64, s55, 7
    s_add_u32 s64, s64, 182272
    v_mov_b32 v108, s57
    v_mov_b32 v109, 0
    s_mov_b32 exec_lo, 0x1
    s_mov_b32 exec_hi, 0x0
    buffer_store_dword v108, v109, s[48:51], s64 offen sc1
    s_mov_b64 exec, -1
nohint_46:
    s_cmp_ge_u32 s56, 3
    s_cbranch_scc1 L_fin
    s_cmp_eq_u32 s56, 2
    s_cbranch_scc1 L_final
    ds_read_b64 v[64:65], v58 offset:0
    ds_read_b64 v[66:67], v58 offset:1088
    ds_read_b64 v[68:69], v58 offset:2176
    ds_read_b64 v[70:71], v58 offset:3264
    ds_read_b64 v[72:73], v58 offset:4352
    ds_read_b64 v[74:75], v58 offset:5440
    ds_read_b64 v[76:77], v58 offset:6528
    ds_read_b64 v[78:79], v58 offset:7616
    s_waitcnt lgkmcnt(0)
    v_add_f32 v64, v64, v72
    v_add_f32 v65, v65, v73
    v_add_f32 v66, v66, v74
    v_add_f32 v67, v67, v75
    v_add_f32 v68, v68, v76
    v_add_f32 v69, v69, v77
    v_add_f32 v70, v70, v78
    v_add_f32 v71, v71, v79
    v_add_f32 v64, v64, v68
    v_add_f32 v65, v65, v69
    v_add_f32 v66, v66, v70
    v_add_f32 v67, v67, v71
    v_add_f32 v64, v64, v66
    v_add_f32 v65, v65, v67
    v_cvt_pk_bf16_f32 v64, v64, v65
    buffer_store_dword v64, v59, s[48:51], s34 offen sc1
    s_cmp_lg_u32 s2, 0
    s_cbranch_scc1 L_fin
    v_mov_b32 v40, s57
    v_mov_b32 v39, 0
    s_mov_b32 exec_lo, 0x1
    s_mov_b32 exec_hi, 0x0
    buffer_store_dword v40, v39, s[48:51], 0 offen offset:0 sc1
    s_mov_b64 exec, -1
    s_branch L_fin
L_final:
    s_lshr_b32 s68, s55, 2
    s_and_b32 s69, s55, 3
    v_bfe_u32 v32, v0, 2, 1
    v_and_b32 v33, 3, v0
    v_lshlrev_b32 v34, 10, v32
    v_lshl_add_u32 v34, v33, 3, v34
    s_lshl_b32 s64, s69, 11
    s_lshl_b32 s65, s68, 5
    s_add_u32 s64, s64, s65
    buffer_load_dwordx2 v[40:41], v34, s[4:7], s64 offen
    s_add_u32 s65, s64, 32768
    s_add_u32 s66, s65, 24576
    s_mov_b32 s63, 60000
poll_47:
    buffer_load_dwordx2 v[42:43], v34, s[48:51], s65 offen sc1
    buffer_load_dwordx2 v[44:45], v34, s[48:51], s66 offen sc1
    s_waitcnt vmcnt(0)
    v_max3_u32 v47, v42, v43, v44
    v_max_u32 v47, v47, v45
    v_cmp_eq_u32 vcc, -1, v47
    s_cbranch_vccz pdone_48
    s_sleep 1
    s_sub_u32 s63, s63, 1
    s_cbranch_scc0 poll_47
pdone_48:
    v_lshlrev_b32 v48, 16, v40
    v_and_b32 v49, 0xffff0000, v40
    v_lshlrev_b32 v50, 16, v41
    v_and_b32 v51, 0xffff0000, v41
    v_lshlrev_b32 v52, 16, v42
    v_and_b32 v53, 0xffff0000, v42
    v_lshlrev_b32 v54, 16, v43
    v_and_b32 v55, 0xffff0000, v43
    v_lshlrev_b32 v56, 16, v44
    v_and_b32 v57, 0xffff0000, v44
    v_lshlrev_b32 v58, 16, v45
    v_and_b32 v59, 0xffff0000, v45
    v_lshlrev_b32 v35, 13, v32
    v_lshl_add_u32 v35, v33, 3, v35
    s_lshl_b32 s65, s69, 14
    s_lshl_b32 s66, s68, 5
    s_add_u32 s65, s65, s66
    s_add_u32 s65, s65, 116736
    s_add_u32 s66, s65, 4096
    s_min_u32 s67, s54, 13
    s_lshl_b32 s33, s52, 4
    s_add_u32 s67, s67, s33
    s_lshl_b32 s67, s67, 7
    s_add_u32 s67, s67, 198720
    s_mov_b32 s63, 60000
hw_49:
    s_load_dword s33, s[48:49], s67 glc
    s_waitcnt lgkmcnt(0)
    s_cmp_eq_u32 s33, s57
    s_cbranch_scc1 hd_50
    s_sub_u32 s63, s63, 1
    s_cbranch_scc0 hw_49
hd_50:
    s_mov_b32 s63, 60000
poll_51:
    buffer_load_dwordx2 v[128:129], v35, s[48:51], s65 offen offset:0 sc1
    buffer_load_dwordx2 v[130:131], v35, s[48:51], s65 offen offset:1024 sc1
    buffer_load_dwordx2 v[132:133], v35, s[48:51], s65 offen offset:2048 sc1
    buffer_load_dwordx2 v[134:135], v35, s[48:51], s65 offen offset:3072 sc1
    buffer_load_dwordx2 v[136:137], v35, s[48:51], s66 offen offset:0 sc1
    buffer_load_dwordx2 v[138:139], v35, s[48:51], s66 offen offset:1024 sc1
    buffer_load_dwordx2 v[140:141], v35, s[48:51], s66 offen offset:2048 sc1
    buffer_load_dwordx2 v[142:143], v35, s[48:51], s66 offen offset:3072 sc1
    s_waitcnt vmcnt(0)
    v_max3_u32 v47, v128, v129, v130
    v_max3_u32 v47, v47, v131, v132
    v_max3_u32 v47, v47, v133, v134
    v_max3_u32 v47, v47, v135, v136
    v_max3_u32 v47, v47, v137, v138
    v_max3_u32 v47, v47, v139, v140
    v_max3_u32 v47, v47, v141, v142
    v_max_u32 v47, v47, v143
    v_cmp_eq_u32 vcc, -1, v47
    s_cbranch_vccz pdone_52
    s_sleep 1
    s_sub_u32 s63, s63, 1
    s_cbranch_scc0 poll_51
pdone_52:
    v_lshlrev_b32 v144, 16, v128
    v_and_b32 v145, 0xffff0000, v128
    v_lshlrev_b32 v146, 16, v129
    v_and_b32 v147, 0xffff0000, v129
    v_lshlrev_b32 v148, 16, v130
    v_and_b32 v149, 0xffff0000, v130
    v_lshlrev_b32 v150, 16, v131
    v_and_b32 v151, 0xffff0000, v131
    v_lshlrev_b32 v152, 16, v132
    v_and_b32 v153, 0xffff0000, v132
    v_lshlrev_b32 v154, 16, v133
    v_and_b32 v155, 0xffff0000, v133
    v_lshlrev_b32 v156, 16, v134
    v_and_b32 v157, 0xffff0000, v134
    v_lshlrev_b32 v158, 16, v135
    v_and_b32 v159, 0xffff0000, v135
    v_lshlrev_b32 v160, 16, v136
    v_and_b32 v161, 0xffff0000, v136
    v_lshlrev_b32 v162, 16, v137
    v_and_b32 v163, 0xffff0000, v137
    v_lshlrev_b32 v164, 16, v138
    v_and_b32 v165, 0xffff0000, v138
    v_lshlrev_b32 v166, 16, v139
    v_and_b32 v167, 0xffff0000, v139
    v_lshlrev_b32 v168, 16, v140
    v_and_b32 v169, 0xffff0000, v140
    v_lshlrev_b32 v170, 16, v141
    v_and_b32 v171, 0xffff0000, v141
    v_lshlrev_b32 v172, 16, v142
    v_and_b32 v173, 0xffff0000, v142
    v_lshlrev_b32 v174, 16, v143
    v_and_b32 v175, 0xffff0000, v143
    v_add_f32 v144, v144, v160
    v_add_f32 v145, v145, v161
    v_add_f32 v146, v146, v162
    v_add_f32 v147, v147, v163
    v_add_f32 v148, v148, v164
    v_add_f32 v149, v149, v165
    v_add_f32 v150, v150, v166
    v_add_f32 v151, v151, v167
    v_add_f32 v152, v152, v168
    v_add_f32 v153, v153, v169
    v_add_f32 v154, v154, v170
    v_add_f32 v155, v155, v171
    v_add_f32 v156, v156, v172
    v_add_f32 v157, v157, v173
    v_add_f32 v158, v158, v174
    v_add_f32 v159, v159, v175
    v_add_f32 v144, v144, v152
    v_add_f32 v145, v145, v153
    v_add_f32 v146, v146, v154
    v_add_f32 v147, v147, v155
    v_add_f32 v148, v148, v156
    v_add_f32 v149, v149, v157
    v_add_f32 v150, v150, v158
    v_add_f32 v151, v151, v159
    v_add_f32 v144, v144, v148
    v_add_f32 v145, v145, v149
    v_add_f32 v146, v146, v150
    v_add_f32 v147, v147, v151
    v_mov_b32 v72, v144
    v_mov_b32 v73, v145
    v_mov_b32 v74, v146
    v_mov_b32 v75, v147
    v_cvt_pk_bf16_f32 v72, 0, v72
    v_cvt_pk_bf16_f32 v73, 0, v73
    v_cvt_pk_bf16_f32 v74, 0, v74
    v_cvt_pk_bf16_f32 v75, 0, v75
    v_mul_f32 v72, v72, v52
    v_mul_f32 v73, v73, v53
    v_mul_f32 v74, v74, v54
    v_mul_f32 v75, v75, v55
    v_cvt_pk_bf16_f32 v72, 0, v72
    v_cvt_pk_bf16_f32 v73, 0, v73
    v_cvt_pk_bf16_f32 v74, 0, v74
    v_cvt_pk_bf16_f32 v75, 0, v75
    v_add_f32 v72, v72, v48
    v_add_f32 v73, v73, v49
    v_add_f32 v74, v74, v50
    v_add_f32 v75, v75, v51
    v_cvt_pk_bf16_f32 v72, 0, v72
    v_cvt_pk_bf16_f32 v73, 0, v73
    v_cvt_pk_bf16_f32 v74, 0, v74
    v_cvt_pk_bf16_f32 v75, 0, v75
    v_lshlrev_b32 v35, 4, v0
    s_mul_i32 s65, s55, 7168
    s_add_u32 s65, s65, 215040
    s_add_u32 s66, s65, 4096
    v_bfe_u32 v40, s57, 0, 8
    v_bfe_u32 v41, s57, 8, 8
    v_bfe_u32 v42, s57, 16, 8
    v_bfe_u32 v43, s57, 24, 8
    s_min_u32 s67, s54, 13
    s_lshl_b32 s68, s52, 4
    s_add_u32 s67, s67, s68
    s_lshl_b32 s67, s67, 7
    s_add_u32 s67, s67, 198656
    s_mov_b32 s63, 60000
hw_53:
    s_load_dword s68, s[48:49], s67 glc
    s_waitcnt lgkmcnt(0)
    s_cmp_eq_u32 s68, s57
    s_cbranch_scc1 hd_54
    s_sub_u32 s63, s63, 1
    s_cbranch_scc0 hw_53
hd_54:
    s_mov_b32 s63, 60000
poll_55:
    buffer_load_dwordx4 v[96:99], v35, s[48:51], s65 offen offset:0 sc1
    buffer_load_dwordx4 v[100:103], v35, s[48:51], s65 offen offset:1024 sc1
    buffer_load_dwordx4 v[104:107], v35, s[48:51], s65 offen offset:2048 sc1
    buffer_load_dwordx4 v[108:111], v35, s[48:51], s65 offen offset:3072 sc1
    buffer_load_dwordx4 v[112:115], v35, s[48:51], s66 offen offset:0 sc1
    buffer_load_dwordx4 v[116:119], v35, s[48:51], s66 offen offset:1024 sc1
    buffer_load_dwordx4 v[120:123], v35, s[48:51], s66 offen offset:2048 sc1
    s_waitcnt vmcnt(0)
    v_xor_b32 v96, v96, v40
    v_xor_b32 v97, v97, v41
    v_xor_b32 v98, v98, v42
    v_xor_b32 v99, v99, v43
    v_xor_b32 v100, v100, v40
    v_xor_b32 v101, v101, v41
    v_xor_b32 v102, v102, v42
    v_xor_b32 v103, v103, v43
    v_xor_b32 v104, v104, v40
    v_xor_b32 v105, v105, v41
    v_xor_b32 v106, v106, v42
    v_xor_b32 v107, v107, v43
    v_xor_b32 v108, v108, v40
    v_xor_b32 v109, v109, v41
    v_xor_b32 v110, v110, v42
    v_xor_b32 v111, v111, v43
    v_xor_b32 v112, v112, v40
    v_xor_b32 v113, v113, v41
    v_xor_b32 v114, v114, v42
    v_xor_b32 v115, v115, v43
    v_xor_b32 v116, v116, v40
    v_xor_b32 v117, v117, v41
    v_xor_b32 v118, v118, v42
    v_xor_b32 v119, v119, v43
    v_xor_b32 v120, v120, v40
    v_xor_b32 v121, v121, v41
    v_xor_b32 v122, v122, v42
    v_xor_b32 v123, v123, v43
    v_or3_b32 v47, v96, v97, v98
    v_or3_b32 v46, v99, v100, v101
    v_or3_b32 v47, v47, v102, v103
    v_or3_b32 v46, v46, v104, v105
    v_or3_b32 v47, v47, v106, v107
    v_or3_b32 v46, v46, v108, v109
    v_or3_b32 v47, v47, v110, v111
    v_or3_b32 v46, v46, v112, v113
    v_or3_b32 v47, v47, v114, v115
    v_or3_b32 v46, v46, v116, v117
    v_or3_b32 v47, v47, v118, v119
    v_or3_b32 v46, v46, v120, v121
    v_or3_b32 v47, v47, v122, v123
    v_or_b32 v47, v47, v46
    v_and_b32 v47, 0xff, v47
    v_cmp_ne_u32 vcc, 0, v47
    s_cbranch_vccz pdone_56
    s_sub_u32 s63, s63, 1
    s_cbranch_scc0 poll_55
pdone_56:
    v_add_f32 v96, v96, v100
    v_add_f32 v104, v104, v108
    v_add_f32 v112, v112, v116
    v_add_f32 v97, v97, v101
    v_add_f32 v105, v105, v109
    v_add_f32 v113, v113, v117
    v_add_f32 v98, v98, v102
    v_add_f32 v106, v106, v110
    v_add_f32 v114, v114, v118
    v_add_f32 v99, v99, v103
    v_add_f32 v107, v107, v111
    v_add_f32 v115, v115, v119
    v_add_f32 v96, v96, v104
    v_add_f32 v112, v112, v120
    v_add_f32 v97, v97, v105
    v_add_f32 v113, v113, v121
    v_add_f32 v98, v98, v106
    v_add_f32 v114, v114, v122
    v_add_f32 v99, v99, v107
    v_add_f32 v115, v115, v123
    v_add_f32 v96, v96, v112
    v_add_f32 v97, v97, v113
    v_add_f32 v98, v98, v114
    v_add_f32 v99, v99, v115
    v_add_f32_dpp v96, v96, v96 row_ror:8 row_mask:0xf bank_mask:0xf
    v_add_f32_dpp v97, v97, v97 row_ror:8 row_mask:0xf bank_mask:0xf
    v_add_f32_dpp v98, v98, v98 row_ror:8 row_mask:0xf bank_mask:0xf
    v_add_f32_dpp v99, v99, v99 row_ror:8 row_mask:0xf bank_mask:0xf
    v_mov_b32 v100, v96
    v_mov_b32 v101, v97
    v_mov_b32 v102, v98
    v_mov_b32 v103, v99
    v_permlane16_swap_b32 v100, v96
    v_permlane16_swap_b32 v101, v97
    v_permlane16_swap_b32 v102, v98
    v_permlane16_swap_b32 v103, v99
    v_add_f32 v96, v96, v100
    v_add_f32 v97, v97, v101
    v_add_f32 v98, v98, v102
    v_add_f32 v99, v99, v103
    v_mov_b32 v100, v96
    v_mov_b32 v101, v97
    v_mov_b32 v102, v98
    v_mov_b32 v103, v99
    v_permlane32_swap_b32 v100, v96
    v_permlane32_swap_b32 v101, v97
    v_permlane32_swap_b32 v102, v98
    v_permlane32_swap_b32 v103, v99
    v_add_f32 v96, v96, v100
    v_add_f32 v97, v97, v101
    v_add_f32 v98, v98, v102
    v_add_f32 v99, v99, v103
    v_cvt_pk_bf16_f32 v96, 0, v96
    v_cvt_pk_bf16_f32 v97, 0, v97
    v_cvt_pk_bf16_f32 v98, 0, v98
    v_cvt_pk_bf16_f32 v99, 0, v99
    v_mul_f32 v96, v96, v56
    v_mul_f32 v97, v97, v57
    v_mul_f32 v98, v98, v58
    v_mul_f32 v99, v99, v59
    v_cvt_pk_bf16_f32 v96, 0, v96
    v_cvt_pk_bf16_f32 v97, 0, v97
    v_cvt_pk_bf16_f32 v98, 0, v98
    v_cvt_pk_bf16_f32 v99, 0, v99
    v_add_f32 v96, v96, v72
    v_add_f32 v97, v97, v73
    v_add_f32 v98, v98, v74
    v_add_f32 v99, v99, v75
    v_cvt_pk_bf16_f32 v100, v96, v97
    v_cvt_pk_bf16_f32 v101, v98, v99
    s_mov_b32 exec_lo, 0xff
    s_mov_b32 exec_hi, 0x0
    buffer_store_dwordx2 v[100:101], v34, s[44:47], s64 offen
    s_mov_b64 exec, -1
    s_branch L_fin
L_pv:
    s_mov_b32 s10, 33554432
    s_mov_b32 s11, 0x00020000
    s_lshl_b32 s78, s54, 18
    s_lshl_b32 s64, s52, 22
    s_add_u32 s12, s78, 0
    s_and_b32 s12, s12, 0x3fffff
    s_or_b32 s12, s12, s64
    s_add_u32 s13, s78, 294912
    s_and_b32 s13, s13, 0x3fffff
    s_or_b32 s13, s13, s64
    s_add_u32 s14, s78, 589824
    s_and_b32 s14, s14, 0x3fffff
    s_or_b32 s14, s14, s64
    s_add_u32 s15, s78, 884736
    s_and_b32 s15, s15, 0x3fffff
    s_or_b32 s15, s15, s64
    s_add_u32 s16, s78, 1179648
    s_and_b32 s16, s16, 0x3fffff
    s_or_b32 s16, s16, s64
    s_add_u32 s17, s78, 1474560
    s_and_b32 s17, s17, 0x3fffff
    s_or_b32 s17, s17, s64
    s_add_u32 s18, s78, 1769472
    s_and_b32 s18, s18, 0x3fffff
    s_or_b32 s18, s18, s64
    s_add_u32 s19, s78, 2064384
    s_and_b32 s19, s19, 0x3fffff
    s_or_b32 s19, s19, s64
    s_and_b32 s79, s56, 3
    s_lshl_b32 s69, s79, 13
    s_and_b32 s64, s79, 1
    s_cmp_eq_u32 s64, 1
    s_cselect_b32 s65, 3, 0
    v_xor_b32 v48, s65, v0
    v_lshlrev_b32 v48, 4, v48
    v_add_u32 v48, s69, v48
    s_cselect_b32 s65, 7, 4
    v_xor_b32 v49, s65, v0
    v_lshlrev_b32 v49, 4, v49
    v_add_u32 v49, s69, v49
    s_cselect_b32 s65, 11, 8
    v_xor_b32 v50, s65, v0
    v_lshlrev_b32 v50, 4, v50
    v_add_u32 v50, s69, v50
    s_cselect_b32 s65, 15, 12
    v_xor_b32 v51, s65, v0
    v_lshlrev_b32 v51, 4, v51
    v_add_u32 v51, s69, v51
    s_cselect_b32 s65, 1, 2
    v_xor_b32 v52, s65, v0
    v_lshlrev_b32 v52, 4, v52
    v_add_u32 v52, s69, v52
    v_add_u32 v52, 4096, v52
    s_cselect_b32 s65, 5, 6
    v_xor_b32 v53, s65, v0
    v_lshlrev_b32 v53, 4, v53
    v_add_u32 v53, s69, v53
    v_add_u32 v53, 4096, v53
    s_cselect_b32 s65, 9, 10
    v_xor_b32 v54, s65, v0
    v_lshlrev_b32 v54, 4, v54
    v_add_u32 v54, s69, v54
    v_add_u32 v54, 4096, v54
    s_cselect_b32 s65, 13, 14
    v_xor_b32 v55, s65, v0
    v_lshlrev_b32 v55, 4, v55
    v_add_u32 v55, s69, v55
    v_add_u32 v55, 4096, v55
    s_waitcnt lgkmcnt(0)
    s_load_dword s57, s[48:49], 0
    s_load_dwordx2 s[28:29], s[0:1], 56
    s_load_dwordx2 s[32:33], s[0:1], 64
    s_mov_b32 s30, 1835008
    s_mov_b32 s31, 0x00020000
    s_mov_b32 s34, 1835008
    s_mov_b32 s35, 0x00020000
    s_mov_b32 s72, 0
L_pv_start:
    s_add_u32 m0, s69, 0
    s_nop 0
    buffer_load_dwordx4 v48, s[8:11], s12 offen nt lds
    buffer_load_dwordx4 v49, s[8:11], s12 offen offset:1024 nt lds
    buffer_load_dwordx4 v50, s[8:11], s12 offen offset:2048 nt lds
    buffer_load_dwordx4 v51, s[8:11], s12 offen offset:3072 nt lds
    s_add_u32 m0, s69, 4096
    s_nop 0
    buffer_load_dwordx4 v52, s[8:11], s12 offen nt lds
    buffer_load_dwordx4 v53, s[8:11], s12 offen offset:1024 nt lds
    buffer_load_dwordx4 v54, s[8:11], s12 offen offset:2048 nt lds
    buffer_load_dwordx4 v55, s[8:11], s12 offen offset:3072 nt lds
    v_mov_b32 v64, 0
    v_mov_b32 v65, 0
    v_mov_b32 v66, 0
    v_mov_b32 v67, 0
    v_mov_b32 v68, 0
    v_mov_b32 v69, 0
    v_mov_b32 v70, 0
    v_mov_b32 v71, 0
    v_mov_b32 v72, 0
    v_mov_b32 v73, 0
    v_mov_b32 v74, 0
    v_mov_b32 v75, 0
    v_mov_b32 v76, 0
    v_mov_b32 v77, 0
    v_mov_b32 v78, 0
    v_mov_b32 v79, 0
    v_mov_b32 v80, 0
    v_mov_b32 v81, 0
    v_mov_b32 v82, 0
    v_mov_b32 v83, 0
    v_mov_b32 v84, 0
    v_mov_b32 v85, 0
    v_mov_b32 v86, 0
    v_mov_b32 v87, 0
    v_mov_b32 v88, 0
    v_mov_b32 v89, 0
    v_mov_b32 v90, 0
    v_mov_b32 v91, 0
    v_mov_b32 v92, 0
    v_mov_b32 v93, 0
    v_mov_b32 v94, 0
    v_mov_b32 v95, 0
    v_mov_b32 v96, 0
    v_mov_b32 v97, 0
    v_mov_b32 v98, 0
    v_mov_b32 v99, 0
    v_mov_b32 v100, 0
    v_mov_b32 v101, 0
    v_mov_b32 v102, 0
    v_mov_b32 v103, 0
    v_mov_b32 v104, 0
    v_mov_b32 v105, 0
    v_mov_b32 v106, 0
    v_mov_b32 v107, 0
    v_mov_b32 v108, 0
    v_mov_b32 v109, 0
    v_mov_b32 v110, 0
    v_mov_b32 v111, 0
    v_mov_b32 v112, 0
    v_mov_b32 v113, 0
    v_mov_b32 v114, 0
    v_mov_b32 v115, 0
    v_mov_b32 v116, 0
    v_mov_b32 v117, 0
    v_mov_b32 v118, 0
    v_mov_b32 v119, 0
    v_mov_b32 v120, 0
    v_mov_b32 v121, 0
    v_mov_b32 v122, 0
    v_mov_b32 v123, 0
    v_mov_b32 v124, 0
    v_mov_b32 v125, 0
    v_mov_b32 v126, 0
    v_mov_b32 v127, 0
    s_cmp_lg_u32 s72, 0
    s_cbranch_scc1 L_pv_again
    v_lshrrev_b32 v42, 2, v1
    v_and_b32 v43, 3, v1
    v_and_b32 v44, 1, v2
    v_lshrrev_b32 v45, 1, v2
    v_lshl_add_u32 v46, v45, 3, v42
    v_lshlrev_b32 v46, 10, v46
    v_and_b32 v47, 1, v43
    v_lshl_add_u32 v46, v47, 3, v46
    s_lshl_b32 s64, s79, 8
    v_add_u32 v46, s64, v46
    v_lshrrev_b32 v47, 1, v43
    v_lshl_add_u32 v47, v44, 1, v47
    v_lshl_add_u32 v47, v42, 2, v47
    v_cmp_eq_u32 vcc, 1, v45
    v_mov_b32 v56, 0
    v_mov_b32 v57, 3
    v_cndmask_b32 v56, v56, v57, vcc
    v_xor_b32 v56, v56, v47
    v_xor_b32 v24, 0, v56
    v_lshl_add_u32 v24, v24, 4, v46
    v_add_u32 v32, 0x10000, v24
    v_xor_b32 v26, 4, v56
    v_lshl_add_u32 v26, v26, 4, v46
    v_add_u32 v34, 0x10000, v26
    v_xor_b32 v28, 8, v56
    v_lshl_add_u32 v28, v28, 4, v46
    v_add_u32 v36, 0x10000, v28
    v_xor_b32 v30, 12, v56
    v_lshl_add_u32 v30, v30, 4, v46
    v_add_u32 v38, 0x10000, v30
    v_mov_b32 v56, 2
    v_mov_b32 v57, 1
    v_cndmask_b32 v56, v56, v57, vcc
    v_xor_b32 v56, v56, v47
    v_xor_b32 v25, 0, v56
    v_lshl_add_u32 v25, v25, 4, v46
    v_add_u32 v25, 4096, v25
    v_add_u32 v33, 0x10000, v25
    v_xor_b32 v27, 4, v56
    v_lshl_add_u32 v27, v27, 4, v46
    v_add_u32 v27, 4096, v27
    v_add_u32 v35, 0x10000, v27
    v_xor_b32 v29, 8, v56
    v_lshl_add_u32 v29, v29, 4, v46
    v_add_u32 v29, 4096, v29
    v_add_u32 v37, 0x10000, v29
    v_xor_b32 v31, 12, v56
    v_lshl_add_u32 v31, v31, 4, v46
    v_add_u32 v31, 4096, v31
    v_add_u32 v39, 0x10000, v31
    v_lshlrev_b32 v40, 4, v0
    v_add_u32 v40, 131072, v40
    v_mov_b32 v41, 163328
    s_waitcnt lgkmcnt(0)
    s_mul_i32 s57, s57, 0x9e3779b1
    s_add_u32 s57, s57, 0x7f4a7c15
    s_and_b32 s58, s57, 0xffff
    s_lshr_b32 s59, s57, 16
    v_and_b32 v42, 3, v1
    v_lshlrev_b32 v42, 3, v42
    v_lshrrev_b32 v42, v42, s57
    v_bfe_u32 v4, v42, 0, 1
    v_bfe_u32 v43, v42, 1, 1
    v_lshl_or_b32 v4, v43, 16, v4
    v_bfe_u32 v5, v42, 2, 1
    v_bfe_u32 v43, v42, 3, 1
    v_lshl_or_b32 v5, v43, 16, v5
    v_bfe_u32 v6, v42, 4, 1
    v_bfe_u32 v43, v42, 5, 1
    v_lshl_or_b32 v6, v43, 16, v6
    v_bfe_u32 v7, v42, 6, 1
    v_bfe_u32 v43, v42, 7, 1
    v_lshl_or_b32 v7, v43, 16, v7
L_pv_again:
    s_waitcnt vmcnt(8)
    s_add_u32 m0, s69, 65536
    s_nop 0
    buffer_load_dwordx4 v48, s[8:11], s13 offen nt lds
    buffer_load_dwordx4 v49, s[8:11], s13 offen offset:1024 nt lds
    s_waitcnt vmcnt(8)
    s_add_u32 m0, s69, 65536
    s_nop 0
    buffer_load_dwordx4 v50, s[8:11], s13 offen offset:2048 nt lds
    buffer_load_dwordx4 v51, s[8:11], s13 offen offset:3072 nt lds
    s_waitcnt vmcnt(8)
    s_add_u32 m0, s69, 69632
    s_nop 0
    buffer_load_dwordx4 v52, s[8:11], s13 offen nt lds
    buffer_load_dwordx4 v53, s[8:11], s13 offen offset:1024 nt lds
    s_waitcnt vmcnt(8)
    s_add_u32 m0, s69, 69632
    s_nop 0
    buffer_load_dwordx4 v54, s[8:11], s13 offen offset:2048 nt lds
    buffer_load_dwordx4 v55, s[8:11], s13 offen offset:3072 nt lds
    s_waitcnt vmcnt(8)
    s_add_u32 m0, s69, 32768
    s_nop 0
    buffer_load_dwordx4 v48, s[8:11], s14 offen nt lds
    buffer_load_dwordx4 v49, s[8:11], s14 offen offset:1024 nt lds
    s_waitcnt vmcnt(8)
    s_add_u32 m0, s69, 32768
    s_nop 0
    buffer_load_dwordx4 v50, s[8:11], s14 offen offset:2048 nt lds
    buffer_load_dwordx4 v51, s[8:11], s14 offen offset:3072 nt lds
    s_waitcnt vmcnt(8)
    s_add_u32 m0, s69, 36864
    s_nop 0
    buffer_load_dwordx4 v52, s[8:11], s14 offen nt lds
    buffer_load_dwordx4 v53, s[8:11], s14 offen offset:1024 nt lds
    s_waitcnt vmcnt(8)
    s_add_u32 m0, s69, 36864
    s_nop 0
    buffer_load_dwordx4 v54, s[8:11], s14 offen offset:2048 nt lds
    buffer_load_dwordx4 v55, s[8:11], s14 offen offset:3072 nt lds
    s_waitcnt vmcnt(8)
    s_barrier
    ds_read_b64_tr_b16 v[128:129], v24 offset:0
    ds_read_b64_tr_b16 v[130:131], v25 offset:0
    ds_read_b64_tr_b16 v[136:137], v26 offset:0
    ds_read_b64_tr_b16 v[138:139], v27 offset:0
    ds_read_b64_tr_b16 v[144:145], v28 offset:0
    ds_read_b64_tr_b16 v[146:147], v29 offset:0
    ds_read_b64_tr_b16 v[152:153], v30 offset:0
    ds_read_b64_tr_b16 v[154:155], v31 offset:0
    s_waitcnt vmcnt(8)
    s_add_u32 m0, s69, 98304
    s_nop 0
    buffer_load_dwordx4 v48, s[8:11], s15 offen nt lds
    buffer_load_dwordx4 v49, s[8:11], s15 offen offset:1024 nt lds
    ds_read_b64_tr_b16 v[132:133], v24 offset:16384
    ds_read_b64_tr_b16 v[134:135], v25 offset:16384
    ds_read_b64_tr_b16 v[140:141], v26 offset:16384
    ds_read_b64_tr_b16 v[142:143], v27 offset:16384
    ds_read_b64_tr_b16 v[148:149], v28 offset:16384
    ds_read_b64_tr_b16 v[150:151], v29 offset:16384
    ds_read_b64_tr_b16 v[156:157], v30 offset:16384
    ds_read_b64_tr_b16 v[158:159], v31 offset:16384
    s_waitcnt vmcnt(8)
    s_add_u32 m0, s69, 98304
    s_nop 0
    buffer_load_dwordx4 v50, s[8:11], s15 offen offset:2048 nt lds
    buffer_load_dwordx4 v51, s[8:11], s15 offen offset:3072 nt lds
    ds_read_b64_tr_b16 v[160:161], v32 offset:0
    ds_read_b64_tr_b16 v[162:163], v33 offset:0
    ds_read_b64_tr_b16 v[168:169], v34 offset:0
    ds_read_b64_tr_b16 v[170:171], v35 offset:0
    ds_read_b64_tr_b16 v[176:177], v36 offset:0
    ds_read_b64_tr_b16 v[178:179], v37 offset:0
    ds_read_b64_tr_b16 v[184:185], v38 offset:0
    ds_read_b64_tr_b16 v[186:187], v39 offset:0
    s_waitcnt vmcnt(8)
    s_add_u32 m0, s69, 102400
    s_nop 0
    buffer_load_dwordx4 v52, s[8:11], s15 offen nt lds
    buffer_load_dwordx4 v53, s[8:11], s15 offen offset:1024 nt lds
    ds_read_b64_tr_b16 v[164:165], v32 offset:16384
    ds_read_b64_tr_b16 v[166:167], v33 offset:16384
    ds_read_b64_tr_b16 v[172:173], v34 offset:16384
    ds_read_b64_tr_b16 v[174:175], v35 offset:16384
    ds_read_b64_tr_b16 v[180:181], v36 offset:16384
    ds_read_b64_tr_b16 v[182:183], v37 offset:16384
    ds_read_b64_tr_b16 v[188:189], v38 offset:16384
    ds_read_b64_tr_b16 v[190:191], v39 offset:16384
    s_waitcnt lgkmcnt(0)
    s_barrier
    s_waitcnt vmcnt(8)
    s_add_u32 m0, s69, 102400
    s_nop 0
    buffer_load_dwordx4 v54, s[8:11], s15 offen offset:2048 nt lds
    buffer_load_dwordx4 v55, s[8:11], s15 offen offset:3072 nt lds
    s_waitcnt vmcnt(8)
    s_barrier
    ds_read_b64_tr_b16 v[192:193], v24 offset:32768
    ds_read_b64_tr_b16 v[194:195], v25 offset:32768
    ds_read_b64_tr_b16 v[200:201], v26 offset:32768
    ds_read_b64_tr_b16 v[202:203], v27 offset:32768
    ds_read_b64_tr_b16 v[208:209], v28 offset:32768
    ds_read_b64_tr_b16 v[210:211], v29 offset:32768
    ds_read_b64_tr_b16 v[216:217], v30 offset:32768
    ds_read_b64_tr_b16 v[218:219], v31 offset:32768
    ds_read_b64_tr_b16 v[196:197], v24 offset:49152
    ds_read_b64_tr_b16 v[198:199], v25 offset:49152
    ds_read_b64_tr_b16 v[204:205], v26 offset:49152
    ds_read_b64_tr_b16 v[206:207], v27 offset:49152
    ds_read_b64_tr_b16 v[212:213], v28 offset:49152
    ds_read_b64_tr_b16 v[214:215], v29 offset:49152
    ds_read_b64_tr_b16 v[220:221], v30 offset:49152
    ds_read_b64_tr_b16 v[222:223], v31 offset:49152
    s_waitcnt vmcnt(0)
    s_barrier
    ds_read_b64_tr_b16 v[224:225], v32 offset:32768
    ds_read_b64_tr_b16 v[226:227], v33 offset:32768
    ds_read_b64_tr_b16 v[232:233], v34 offset:32768
    ds_read_b64_tr_b16 v[234:235], v35 offset:32768
    ds_read_b64_tr_b16 v[240:241], v36 offset:32768
    ds_read_b64_tr_b16 v[242:243], v37 offset:32768
    ds_read_b64_tr_b16 v[248:249], v38 offset:32768
    ds_read_b64_tr_b16 v[250:251], v39 offset:32768
    ds_read_b64_tr_b16 v[228:229], v32 offset:49152
    ds_read_b64_tr_b16 v[230:231], v33 offset:49152
    ds_read_b64_tr_b16 v[236:237], v34 offset:49152
    ds_read_b64_tr_b16 v[238:239], v35 offset:49152
    ds_read_b64_tr_b16 v[244:245], v36 offset:49152
    ds_read_b64_tr_b16 v[246:247], v37 offset:49152
    ds_read_b64_tr_b16 v[252:253], v38 offset:49152
    ds_read_b64_tr_b16 v[254:255], v39 offset:49152
    s_add_u32 m0, s69, 0
    s_nop 0
    buffer_load_dwordx4 v48, s[8:11], s16 offen nt lds
    s_add_u32 m0, s69, 0
    s_nop 0
    buffer_load_dwordx4 v49, s[8:11], s16 offen offset:1024 nt lds
    s_add_u32 m0, s69, 0
    s_nop 0
    buffer_load_dwordx4 v50, s[8:11], s16 offen offset:2048 nt lds
    s_add_u32 m0, s69, 0
    s_nop 0
    buffer_load_dwordx4 v51, s[8:11], s16 offen offset:3072 nt lds
    s_add_u32 m0, s69, 4096
    s_nop 0
    buffer_load_dwordx4 v52, s[8:11], s16 offen nt lds
    s_add_u32 m0, s69, 4096
    s_nop 0
    buffer_load_dwordx4 v53, s[8:11], s16 offen offset:1024 nt lds
    s_barrier
    s_add_u32 m0, s69, 4096
    s_nop 0
    buffer_load_dwordx4 v54, s[8:11], s16 offen offset:2048 nt lds
    s_add_u32 m0, s69, 4096
    s_nop 0
    buffer_load_dwordx4 v55, s[8:11], s16 offen offset:3072 nt lds
    s_add_u32 m0, s69, 65536
    s_nop 0
    buffer_load_dwordx4 v48, s[8:11], s17 offen nt lds
    s_add_u32 m0, s69, 65536
    s_nop 0
    buffer_load_dwordx4 v49, s[8:11], s17 offen offset:1024 nt lds
    s_add_u32 m0, s69, 65536
    s_nop 0
    buffer_load_dwordx4 v50, s[8:11], s17 offen offset:2048 nt lds
    s_add_u32 m0, s69, 65536
    s_nop 0
    buffer_load_dwordx4 v51, s[8:11], s17 offen offset:3072 nt lds
    s_add_u32 m0, s69, 69632
    s_nop 0
    buffer_load_dwordx4 v52, s[8:11], s17 offen nt lds
    s_add_u32 m0, s69, 69632
    s_nop 0
    buffer_load_dwordx4 v53, s[8:11], s17 offen offset:1024 nt lds
    s_add_u32 m0, s69, 69632
    s_nop 0
    buffer_load_dwordx4 v54, s[8:11], s17 offen offset:2048 nt lds
    s_add_u32 m0, s69, 69632
    s_nop 0
    buffer_load_dwordx4 v55, s[8:11], s17 offen offset:3072 nt lds
    s_waitcnt lgkmcnt(0)
    s_barrier
    s_add_u32 m0, s69, 32768
    s_nop 0
    buffer_load_dwordx4 v48, s[8:11], s18 offen nt lds
    s_add_u32 m0, s69, 32768
    s_nop 0
    buffer_load_dwordx4 v49, s[8:11], s18 offen offset:1024 nt lds
    s_add_u32 m0, s69, 32768
    s_nop 0
    buffer_load_dwordx4 v50, s[8:11], s18 offen offset:2048 nt lds
    s_add_u32 m0, s69, 32768
    s_nop 0
    buffer_load_dwordx4 v51, s[8:11], s18 offen offset:3072 nt lds
    s_waitcnt vmcnt(4)
    s_barrier
    ds_read_b128 v[8:11], v40 offset:0
    ds_read_b128 v[12:15], v40 offset:1024
    ds_read_b128 v[16:19], v40 offset:2048
    ds_read_b128 v[20:23], v40 offset:3072
    s_waitcnt lgkmcnt(0)
    v_mfma_f32_32x32x16_bf16 v[64:79], v[8:11], v[128:131], v[64:79]
    s_add_u32 m0, s69, 36864
    s_nop 0
    buffer_load_dwordx4 v52, s[8:11], s18 offen nt lds
    v_mfma_f32_32x32x16_bf16 v[80:95], v[8:11], v[136:139], v[80:95]
    s_add_u32 m0, s69, 36864
    s_nop 0
    buffer_load_dwordx4 v53, s[8:11], s18 offen offset:1024 nt lds
    v_mfma_f32_32x32x16_bf16 v[96:111], v[8:11], v[144:147], v[96:111]
    s_add_u32 m0, s69, 36864
    s_nop 0
    buffer_load_dwordx4 v54, s[8:11], s18 offen offset:2048 nt lds
    v_mfma_f32_32x32x16_bf16 v[112:127], v[8:11], v[152:155], v[112:127]
    s_add_u32 m0, s69, 36864
    s_nop 0
    buffer_load_dwordx4 v55, s[8:11], s18 offen offset:3072 nt lds
    v_mfma_f32_32x32x16_bf16 v[64:79], v[12:15], v[132:135], v[64:79]
    s_add_u32 m0, s69, 98304
    s_nop 0
    buffer_load_dwordx4 v48, s[8:11], s19 offen nt lds
    v_mfma_f32_32x32x16_bf16 v[80:95], v[12:15], v[140:143], v[80:95]
    s_add_u32 m0, s69, 98304
    s_nop 0
    buffer_load_dwordx4 v49, s[8:11], s19 offen offset:1024 nt lds
    v_mfma_f32_32x32x16_bf16 v[96:111], v[12:15], v[148:151], v[96:111]
    s_add_u32 m0, s69, 98304
    s_nop 0
    buffer_load_dwordx4 v50, s[8:11], s19 offen offset:2048 nt lds
    v_mfma_f32_32x32x16_bf16 v[112:127], v[12:15], v[156:159], v[112:127]
    s_add_u32 m0, s69, 98304
    s_nop 0
    buffer_load_dwordx4 v51, s[8:11], s19 offen offset:3072 nt lds
    v_mfma_f32_32x32x16_bf16 v[64:79], v[16:19], v[160:163], v[64:79]
    v_mfma_f32_32x32x16_bf16 v[80:95], v[16:19], v[168:171], v[80:95]
    v_mfma_f32_32x32x16_bf16 v[96:111], v[16:19], v[176:179], v[96:111]
    v_mfma_f32_32x32x16_bf16 v[112:127], v[16:19], v[184:187], v[112:127]
    v_mfma_f32_32x32x16_bf16 v[64:79], v[20:23], v[164:167], v[64:79]
    s_waitcnt vmcnt(12)
    s_barrier
    ds_read_b128 v[8:11], v40 offset:4096
    ds_read_b128 v[12:15], v40 offset:5120
    ds_read_b128 v[16:19], v40 offset:6144
    ds_read_b128 v[60:63], v40 offset:7168
    v_mfma_f32_32x32x16_bf16 v[80:95], v[20:23], v[172:175], v[80:95]
    v_mfma_f32_32x32x16_bf16 v[96:111], v[20:23], v[180:183], v[96:111]
    v_mfma_f32_32x32x16_bf16 v[112:127], v[20:23], v[188:191], v[112:127]
    s_waitcnt lgkmcnt(0)
    v_mfma_f32_32x32x16_bf16 v[64:79], v[8:11], v[192:195], v[64:79]
    s_add_u32 m0, s69, 102400
    s_nop 0
    buffer_load_dwordx4 v52, s[8:11], s19 offen nt lds
    s_add_u32 m0, s69, 102400
    s_nop 0
    buffer_load_dwordx4 v53, s[8:11], s19 offen offset:1024 nt lds
    s_add_u32 m0, s69, 102400
    s_nop 0
    buffer_load_dwordx4 v54, s[8:11], s19 offen offset:2048 nt lds
    v_mfma_f32_32x32x16_bf16 v[80:95], v[8:11], v[200:203], v[80:95]
    s_add_u32 m0, s69, 102400
    s_nop 0
    buffer_load_dwordx4 v55, s[8:11], s19 offen offset:3072 nt lds
    ds_read_b64_tr_b16 v[128:129], v24 offset:0
    ds_read_b64_tr_b16 v[130:131], v25 offset:0
    v_mfma_f32_32x32x16_bf16 v[96:111], v[8:11], v[208:211], v[96:111]
    ds_read_b64_tr_b16 v[136:137], v26 offset:0
    ds_read_b64_tr_b16 v[138:139], v27 offset:0
    ds_read_b64_tr_b16 v[144:145], v28 offset:0
    v_mfma_f32_32x32x16_bf16 v[112:127], v[8:11], v[216:219], v[112:127]
    ds_read_b64_tr_b16 v[146:147], v29 offset:0
    ds_read_b64_tr_b16 v[152:153], v30 offset:0
    ds_read_b64_tr_b16 v[154:155], v31 offset:0
    v_mfma_f32_32x32x16_bf16 v[64:79], v[12:15], v[196:199], v[64:79]
    ds_read_b64_tr_b16 v[132:133], v24 offset:16384
    ds_read_b64_tr_b16 v[134:135], v25 offset:16384
    v_mfma_f32_32x32x16_bf16 v[80:95], v[12:15], v[204:207], v[80:95]
    ds_read_b64_tr_b16 v[140:141], v26 offset:16384
    ds_read_b64_tr_b16 v[142:143], v27 offset:16384
    ds_read_b64_tr_b16 v[148:149], v28 offset:16384
    v_mfma_f32_32x32x16_bf16 v[96:111], v[12:15], v[212:215], v[96:111]
    ds_read_b64_tr_b16 v[150:151], v29 offset:16384
    ds_read_b64_tr_b16 v[156:157], v30 offset:16384
    ds_read_b64_tr_b16 v[158:159], v31 offset:16384
    v_mfma_f32_32x32x16_bf16 v[112:127], v[12:15], v[220:223], v[112:127]
    ds_read_b64_tr_b16 v[160:161], v32 offset:0
    ds_read_b64_tr_b16 v[162:163], v33 offset:0
    ds_read_b64_tr_b16 v[168:169], v34 offset:0
    v_mfma_f32_32x32x16_bf16 v[64:79], v[16:19], v[224:227], v[64:79]
    ds_read_b64_tr_b16 v[170:171], v35 offset:0
    ds_read_b64_tr_b16 v[176:177], v36 offset:0
    v_mfma_f32_32x32x16_bf16 v[80:95], v[16:19], v[232:235], v[80:95]
    ds_read_b64_tr_b16 v[178:179], v37 offset:0
    ds_read_b64_tr_b16 v[184:185], v38 offset:0
    ds_read_b64_tr_b16 v[186:187], v39 offset:0
    v_mfma_f32_32x32x16_bf16 v[96:111], v[16:19], v[240:243], v[96:111]
    ds_read_b64_tr_b16 v[164:165], v32 offset:16384
    ds_read_b64_tr_b16 v[166:167], v33 offset:16384
    ds_read_b64_tr_b16 v[172:173], v34 offset:16384
    v_mfma_f32_32x32x16_bf16 v[112:127], v[16:19], v[248:251], v[112:127]
    ds_read_b64_tr_b16 v[174:175], v35 offset:16384
    ds_read_b64_tr_b16 v[180:181], v36 offset:16384
    ds_read_b64_tr_b16 v[182:183], v37 offset:16384
    v_mfma_f32_32x32x16_bf16 v[64:79], v[60:63], v[228:231], v[64:79]
    ds_read_b64_tr_b16 v[188:189], v38 offset:16384
    ds_read_b64_tr_b16 v[190:191], v39 offset:16384
    s_waitcnt vmcnt(8)
    s_waitcnt lgkmcnt(0)
    s_barrier
    ds_read_b128 v[8:11], v40 offset:0
    ds_read_b128 v[12:15], v40 offset:1024
    ds_read_b128 v[16:19], v40 offset:2048
    ds_read_b128 v[20:23], v40 offset:3072
    v_mfma_f32_32x32x16_bf16 v[80:95], v[60:63], v[236:239], v[80:95]
    v_mfma_f32_32x32x16_bf16 v[96:111], v[60:63], v[244:247], v[96:111]
    v_mfma_f32_32x32x16_bf16 v[112:127], v[60:63], v[252:255], v[112:127]
    s_waitcnt lgkmcnt(0)
    v_mfma_f32_32x32x16_bf16 v[64:79], v[8:11], v[128:131], v[64:79]
    ds_read_b64_tr_b16 v[192:193], v24 offset:32768
    ds_read_b64_tr_b16 v[194:195], v25 offset:32768
    v_mfma_f32_32x32x16_bf16 v[80:95], v[8:11], v[136:139], v[80:95]
    ds_read_b64_tr_b16 v[200:201], v26 offset:32768
    ds_read_b64_tr_b16 v[202:203], v27 offset:32768
    v_mfma_f32_32x32x16_bf16 v[96:111], v[8:11], v[144:147], v[96:111]
    ds_read_b64_tr_b16 v[208:209], v28 offset:32768
    v_mfma_f32_32x32x16_bf16 v[112:127], v[8:11], v[152:155], v[112:127]
    ds_read_b64_tr_b16 v[210:211], v29 offset:32768
    ds_read_b64_tr_b16 v[216:217], v30 offset:32768
    v_mfma_f32_32x32x16_bf16 v[64:79], v[12:15], v[132:135], v[64:79]
    ds_read_b64_tr_b16 v[218:219], v31 offset:32768
    v_mfma_f32_32x32x16_bf16 v[80:95], v[12:15], v[140:143], v[80:95]
    ds_read_b64_tr_b16 v[196:197], v24 offset:49152
    ds_read_b64_tr_b16 v[198:199], v25 offset:49152
    v_mfma_f32_32x32x16_bf16 v[96:111], v[12:15], v[148:151], v[96:111]
    ds_read_b64_tr_b16 v[204:205], v26 offset:49152
    ds_read_b64_tr_b16 v[206:207], v27 offset:49152
    v_mfma_f32_32x32x16_bf16 v[112:127], v[12:15], v[156:159], v[112:127]
    ds_read_b64_tr_b16 v[212:213], v28 offset:49152
    v_mfma_f32_32x32x16_bf16 v[64:79], v[16:19], v[160:163], v[64:79]
    ds_read_b64_tr_b16 v[214:215], v29 offset:49152
    ds_read_b64_tr_b16 v[220:221], v30 offset:49152
    v_mfma_f32_32x32x16_bf16 v[80:95], v[16:19], v[168:171], v[80:95]
    ds_read_b64_tr_b16 v[222:223], v31 offset:49152
    s_waitcnt vmcnt(0)
    s_barrier
    ds_read_b128 v[8:11], v40 offset:4096
    ds_read_b128 v[12:15], v40 offset:5120
    v_mfma_f32_32x32x16_bf16 v[96:111], v[16:19], v[176:179], v[96:111]
    v_mfma_f32_32x32x16_bf16 v[112:127], v[16:19], v[184:187], v[112:127]
    v_mfma_f32_32x32x16_bf16 v[64:79], v[20:23], v[164:167], v[64:79]
    v_mfma_f32_32x32x16_bf16 v[80:95], v[20:23], v[172:175], v[80:95]
    v_mfma_f32_32x32x16_bf16 v[96:111], v[20:23], v[180:183], v[96:111]
    v_mfma_f32_32x32x16_bf16 v[112:127], v[20:23], v[188:191], v[112:127]
    s_waitcnt lgkmcnt(0)
    v_mfma_f32_32x32x16_bf16 v[64:79], v[8:11], v[192:195], v[64:79]
    ds_read_b64_tr_b16 v[224:225], v32 offset:32768
    ds_read_b64_tr_b16 v[226:227], v33 offset:32768
    ds_read_b64_tr_b16 v[232:233], v34 offset:32768
    v_mfma_f32_32x32x16_bf16 v[80:95], v[8:11], v[200:203], v[80:95]
    ds_read_b64_tr_b16 v[234:235], v35 offset:32768
    ds_read_b64_tr_b16 v[240:241], v36 offset:32768
    ds_read_b64_tr_b16 v[242:243], v37 offset:32768
    v_mfma_f32_32x32x16_bf16 v[96:111], v[8:11], v[208:211], v[96:111]
    ds_read_b64_tr_b16 v[248:249], v38 offset:32768
    ds_read_b64_tr_b16 v[250:251], v39 offset:32768
    v_mfma_f32_32x32x16_bf16 v[112:127], v[8:11], v[216:219], v[112:127]
    ds_read_b64_tr_b16 v[228:229], v32 offset:49152
    ds_read_b64_tr_b16 v[230:231], v33 offset:49152
    ds_read_b64_tr_b16 v[236:237], v34 offset:49152
    v_mfma_f32_32x32x16_bf16 v[64:79], v[12:15], v[196:199], v[64:79]
    ds_read_b64_tr_b16 v[238:239], v35 offset:49152
    ds_read_b64_tr_b16 v[244:245], v36 offset:49152
    ds_read_b64_tr_b16 v[246:247], v37 offset:49152
    v_mfma_f32_32x32x16_bf16 v[80:95], v[12:15], v[204:207], v[80:95]
    ds_read_b64_tr_b16 v[252:253], v38 offset:49152
    ds_read_b64_tr_b16 v[254:255], v39 offset:49152
    v_lshrrev_b32 v44, 1, v2
    v_and_b32 v45, 1, v2
    v_lshl_add_u32 v44, v44, 2, v45
    v_lshlrev_b32 v44, 17, v44
    v_lshl_add_u32 v44, v1, 4, v44
    s_lshl_b32 s65, s79, 15
    s_lshl_b32 s66, s55, 8
    s_add_u32 s65, s65, s66
    s_add_u32 s65, s65, 4194304
    s_mov_b32 s67, 0x00010001
    s_barrier
    ds_read_b32 v42, v41
    ds_read_b128 v[16:19], v40 offset:6144
    ds_read_b128 v[60:63], v40 offset:7168
    v_mfma_f32_32x32x16_bf16 v[96:111], v[12:15], v[212:215], v[96:111]
    v_mfma_f32_32x32x16_bf16 v[112:127], v[12:15], v[220:223], v[112:127]
    s_waitcnt lgkmcnt(0)
    v_readfirstlane_b32 s64, v42
    s_cmp_lg_u32 s64, 0
    s_cbranch_scc1 L_pv_redo
    v_mfma_f32_32x32x16_bf16 v[64:79], v[16:19], v[224:227], v[64:79]
    v_mfma_f32_32x32x16_bf16 v[80:95], v[16:19], v[232:235], v[80:95]
    v_mfma_f32_32x32x16_bf16 v[96:111], v[16:19], v[240:243], v[96:111]
    v_mfma_f32_32x32x16_bf16 v[112:127], v[16:19], v[248:251], v[112:127]
    v_mfma_f32_32x32x16_bf16 v[64:79], v[60:63], v[228:231], v[64:79]
    v_mfma_f32_32x32x16_bf16 v[80:95], v[60:63], v[236:239], v[80:95]
    v_mfma_f32_32x32x16_bf16 v[96:111], v[60:63], v[244:247], v[96:111]
    v_mfma_f32_32x32x16_bf16 v[112:127], v[60:63], v[252:255], v[112:127]
    s_nop 9
    v_cvt_pk_bf16_f32 v160, v64, v80
    v_cvt_pk_bf16_f32 v161, v65, v81
    v_cvt_pk_bf16_f32 v162, v96, v112
    v_cvt_pk_bf16_f32 v163, v97, v113
    s_barrier
    v_cvt_pk_bf16_f32 v164, v66, v82
    v_cvt_pk_bf16_f32 v165, v67, v83
    v_cvt_pk_bf16_f32 v166, v98, v114
    v_cvt_pk_bf16_f32 v167, v99, v115
    v_permlane16_swap_b32 v160, v161
    v_permlane16_swap_b32 v162, v163
    v_bfi_b32 v160, s67, v4, v160
    v_bfi_b32 v161, s67, v5, v161
    v_bfi_b32 v162, s67, v6, v162
    v_bfi_b32 v163, s67, v7, v163
    s_add_u32 s66, s65, 0
    buffer_store_dwordx4 v[160:163], v44, s[48:51], s66 offen sc1
    v_cvt_pk_bf16_f32 v168, v68, v84
    v_cvt_pk_bf16_f32 v169, v69, v85
    v_cvt_pk_bf16_f32 v170, v100, v116
    v_cvt_pk_bf16_f32 v171, v101, v117
    v_permlane16_swap_b32 v164, v165
    v_permlane16_swap_b32 v166, v167
    v_bfi_b32 v164, s67, v4, v164
    v_bfi_b32 v165, s67, v5, v165
    v_bfi_b32 v166, s67, v6, v166
    v_bfi_b32 v167, s67, v7, v167
    s_add_u32 s66, s65, 262144
    buffer_store_dwordx4 v[164:167], v44, s[48:51], s66 offen sc1
    v_cvt_pk_bf16_f32 v172, v70, v86
    v_cvt_pk_bf16_f32 v173, v71, v87
    v_cvt_pk_bf16_f32 v174, v102, v118
    v_cvt_pk_bf16_f32 v175, v103, v119
    v_permlane16_swap_b32 v168, v169
    v_permlane16_swap_b32 v170, v171
    v_bfi_b32 v168, s67, v4, v168
    v_bfi_b32 v169, s67, v5, v169
    v_bfi_b32 v170, s67, v6, v170
    v_bfi_b32 v171, s67, v7, v171
    s_add_u32 s66, s65, 1048576
    buffer_store_dwordx4 v[168:171], v44, s[48:51], s66 offen sc1
    v_cvt_pk_bf16_f32 v176, v72, v88
    v_cvt_pk_bf16_f32 v177, v73, v89
    v_cvt_pk_bf16_f32 v178, v104, v120
    v_cvt_pk_bf16_f32 v179, v105, v121
    v_permlane16_swap_b32 v172, v173
    v_permlane16_swap_b32 v174, v175
    v_bfi_b32 v172, s67, v4, v172
    v_bfi_b32 v173, s67, v5, v173
    v_bfi_b32 v174, s67, v6, v174
    v_bfi_b32 v175, s67, v7, v175
    s_add_u32 s66, s65, 1310720
    buffer_store_dwordx4 v[172:175], v44, s[48:51], s66 offen sc1
    v_cvt_pk_bf16_f32 v180, v74, v90
    v_cvt_pk_bf16_f32 v181, v75, v91
    v_cvt_pk_bf16_f32 v182, v106, v122
    v_cvt_pk_bf16_f32 v183, v107, v123
    v_permlane16_swap_b32 v176, v177
    v_permlane16_swap_b32 v178, v179
    v_bfi_b32 v176, s67, v4, v176
    v_bfi_b32 v177, s67, v5, v177
    v_bfi_b32 v178, s67, v6, v178
    v_bfi_b32 v179, s67, v7, v179
    s_add_u32 s66, s65, 2097152
    buffer_store_dwordx4 v[176:179], v44, s[48:51], s66 offen sc1
    v_cvt_pk_bf16_f32 v184, v76, v92
    v_cvt_pk_bf16_f32 v185, v77, v93
    v_cvt_pk_bf16_f32 v186, v108, v124
    v_cvt_pk_bf16_f32 v187, v109, v125
    v_permlane16_swap_b32 v180, v181
    v_permlane16_swap_b32 v182, v183
    v_bfi_b32 v180, s67, v4, v180
    v_bfi_b32 v181, s67, v5, v181
    v_bfi_b32 v182, s67, v6, v182
    v_bfi_b32 v183, s67, v7, v183
    s_add_u32 s66, s65, 2359296
    buffer_store_dwordx4 v[180:183], v44, s[48:51], s66 offen sc1
    v_cvt_pk_bf16_f32 v188, v78, v94
    v_cvt_pk_bf16_f32 v189, v79, v95
    v_cvt_pk_bf16_f32 v190, v110, v126
    v_cvt_pk_bf16_f32 v191, v111, v127
    v_permlane16_swap_b32 v184, v185
    v_permlane16_swap_b32 v186, v187
    v_bfi_b32 v184, s67, v4, v184
    v_bfi_b32 v185, s67, v5, v185
    v_bfi_b32 v186, s67, v6, v186
    v_bfi_b32 v187, s67, v7, v187
    s_add_u32 s66, s65, 3145728
    buffer_store_dwordx4 v[184:187], v44, s[48:51], s66 offen sc1
    v_permlane16_swap_b32 v188, v189
    v_permlane16_swap_b32 v190, v191
    v_bfi_b32 v188, s67, v4, v188
    v_bfi_b32 v189, s67, v5, v189
    v_bfi_b32 v190, s67, v6, v190
    v_bfi_b32 v191, s67, v7, v191
    s_add_u32 s66, s65, 3407872
    buffer_store_dwordx4 v[188:191], v44, s[48:51], s66 offen sc1
    s_branch L_att_post
L_pv_redo:
    s_waitcnt vmcnt(0) lgkmcnt(0)
    s_barrier
    s_mov_b32 s72, 1
    s_nop 7
    s_branch L_pv_start
L_qk:
    s_load_dword s57, s[48:49], 0
    s_load_dwordx2 s[28:29], s[0:1], 56
    s_load_dwordx2 s[32:33], s[0:1], 64
    s_load_dwordx2 s[24:25], s[0:1], 40
    s_mov_b32 s30, 1835008
    s_mov_b32 s31, 0x00020000
    s_mov_b32 s34, 1835008
    s_mov_b32 s35, 0x00020000
    s_mov_b32 s26, 4194304
    s_mov_b32 s27, 0x00020000
    v_and_b32 v32, 3, v1
    v_lshlrev_b32 v32, 2, v32
    v_lshrrev_b32 v33, 2, v1
    v_lshlrev_b32 v33, 1, v33
    v_mov_b32 v34, 120
    v_lshrrev_b32 v33, v33, v34
    v_and_b32 v33, 3, v33
    v_or_b32 v32, v32, v33
    v_xor_b32 v32, v32, v2
    v_lshlrev_b32 v33, 10, v1
    s_and_b32 s64, s56, 1
    s_lshl_b32 s64, s64, 14
    s_lshr_b32 s65, s56, 1
    s_lshl_b32 s65, s65, 16
    s_add_u32 s64, s64, s65
    v_add_u32 v33, s64, v33
    v_xor_b32 v48, 0, v32
    v_lshl_add_u32 v48, v48, 4, v33
    v_xor_b32 v49, 4, v32
    v_lshl_add_u32 v49, v49, 4, v33
    v_xor_b32 v50, 8, v32
    v_lshl_add_u32 v50, v50, 4, v33
    v_xor_b32 v51, 12, v32
    v_lshl_add_u32 v51, v51, 4, v33
    v_add_u32 v30, 131072, v16
    v_lshlrev_b32 v53, 4, v0
    v_add_u32 v53, 131072, v53
    v_lshlrev_b32 v55, 4, v1
    v_add_u32 v55, 162816, v55
    v_and_b32 v54, 31, v0
    v_lshlrev_b32 v54, 4, v54
    s_lshl_b32 s64, s56, 2
    s_add_u32 s64, s64, 162816
    v_add_u32 v54, s64, v54
    v_mov_b32 v31, 163328
    v_lshlrev_b32 v52, 6, v1
    v_lshl_add_u32 v52, v2, 4, v52
    s_lshl_b32 s64, s56, 12
    v_add_u32 v57, s64, v53
    s_waitcnt lgkmcnt(0)
    s_mul_i32 s57, s57, 0x9e3779b1
    s_add_u32 s57, s57, 0x7f4a7c15
    s_and_b32 s58, s57, 0xffff
    s_lshr_b32 s59, s57, 16
    s_mov_b32 s72, 0
L_qk_start:
    v_mov_b32 v26, 0
    v_mov_b32 v27, 0
    v_mov_b32 v28, 0
    v_mov_b32 v29, 0
    v_mov_b32 v40, 0
    v_mov_b32 v41, 0
    ds_write_b64 v31, v[40:41]
    s_barrier
    ds_read_b128 v[192:195], v48 offset:0
    ds_read_b128 v[196:199], v49 offset:0
    ds_read_b128 v[200:203], v50 offset:0
    ds_read_b128 v[204:207], v51 offset:0
    ds_read_b128 v[208:211], v48 offset:256
    ds_read_b128 v[212:215], v49 offset:256
    ds_read_b128 v[216:219], v50 offset:256
    ds_read_b128 v[220:223], v51 offset:256
    ds_read_b128 v[224:227], v48 offset:512
    ds_read_b128 v[228:231], v49 offset:512
    ds_read_b128 v[232:235], v50 offset:512
    ds_read_b128 v[236:239], v51 offset:512
    ds_read_b128 v[240:243], v48 offset:768
    ds_read_b128 v[244:247], v49 offset:768
    ds_read_b128 v[248:251], v50 offset:768
    ds_read_b128 v[252:255], v51 offset:768
    s_waitcnt lgkmcnt(0)
    s_barrier
    s_cmp_lg_u32 s72, 0
    s_cbranch_scc1 L_noq
    s_lshl_b32 s64, s55, 7
    s_add_u32 s64, s64, 98304
    s_not_b32 s65, s57
    s_lshl_b32 s68, s52, 18
    s_add_u32 s68, s68, 2097152
    s_add_u32 s78, s68, 31744
    s_lshl_b32 s69, s56, 12
    s_add_u32 s68, s68, s69
    s_add_u32 s69, s68, 16384
    s_mov_b32 s63, 60000
    s_cmp_lg_u32 s56, 0
    s_cbranch_scc1 foll_58
poll_57:
    s_load_dwordx16 s[8:23], s[48:49], s64 glc
    s_waitcnt lgkmcnt(0)
    s_mov_b32 s66, s57
    s_mov_b32 s67, s65
    s_xor_b64 s[8:9], s[8:9], s[66:67]
    s_xor_b64 s[10:11], s[10:11], s[66:67]
    s_xor_b64 s[12:13], s[12:13], s[66:67]
    s_xor_b64 s[14:15], s[14:15], s[66:67]
    s_xor_b64 s[16:17], s[16:17], s[66:67]
    s_xor_b64 s[18:19], s[18:19], s[66:67]
    s_xor_b64 s[20:21], s[20:21], s[66:67]
    s_xor_b64 s[22:23], s[22:23], s[66:67]
    s_or_b64 s[8:9], s[8:9], s[16:17]
    s_or_b64 s[10:11], s[10:11], s[18:19]
    s_or_b64 s[12:13], s[12:13], s[20:21]
    s_or_b64 s[14:15], s[14:15], s[22:23]
    s_or_b64 s[8:9], s[8:9], s[12:13]
    s_or_b64 s[10:11], s[10:11], s[14:15]
    s_or_b64 s[8:9], s[8:9], s[10:11]
    s_cbranch_scc0 seen_59
    s_sub_u32 s63, s63, 1
    s_cbranch_scc0 poll_57
seen_59:
    ds_write_b32 v31, v31 offset:4
foll_58:
    s_barrier
    buffer_load_dwordx4 v[156:159], v52, s[48:51], s68 offen offset:0 sc1
    buffer_load_dwordx4 v[160:163], v52, s[48:51], s68 offen offset:1024 sc1
    buffer_load_dwordx4 v[164:167], v52, s[48:51], s68 offen offset:2048 sc1
    buffer_load_dwordx4 v[168:171], v52, s[48:51], s68 offen offset:3072 sc1
    buffer_load_dwordx4 v[172:175], v52, s[48:51], s69 offen offset:0 sc1
    buffer_load_dwordx4 v[176:179], v52, s[48:51], s69 offen offset:1024 sc1
    buffer_load_dwordx4 v[180:183], v52, s[48:51], s69 offen offset:2048 sc1
    buffer_load_dwordx4 v[184:187], v52, s[48:51], s69 offen offset:3072 sc1
    buffer_load_dwordx4 v[188:191], v52, s[48:51], s78 offen sc1
    s_barrier
    s_waitcnt vmcnt(8)
    ds_write_b128 v57, v[156:159] offset:0
    s_waitcnt vmcnt(7)
    ds_write_b128 v57, v[160:163] offset:1024
    s_waitcnt vmcnt(6)
    ds_write_b128 v57, v[164:167] offset:2048
    s_waitcnt vmcnt(5)
    ds_write_b128 v57, v[168:171] offset:3072
    s_waitcnt vmcnt(4)
    ds_write_b128 v57, v[172:175] offset:16384
    s_waitcnt vmcnt(3)
    ds_write_b128 v57, v[176:179] offset:17408
    s_waitcnt vmcnt(2)
    ds_write_b128 v57, v[180:183] offset:18432
    s_waitcnt vmcnt(1)
    s_cmp_eq_u32 s56, 3
    s_cbranch_scc1 wi_60
    ds_write_b128 v57, v[184:187] offset:19456
wi_60:
    s_mov_b32 s63, 60000
    s_waitcnt vmcnt(0)
poll_62:
    v_max3_u32 v40, v156, v160, v164
    v_max3_u32 v40, v40, v168, v172
    v_max3_u32 v40, v40, v176, v180
    v_max3_u32 v40, v40, v184, v188
    v_cmp_eq_u32 vcc, -1, v40
    s_cbranch_vccz pdone_63
    v_cmp_eq_u32 vcc, -1, v156
    s_cbranch_vccz qn_64
    buffer_load_dwordx4 v[156:159], v52, s[48:51], s68 offen offset:0 sc1
qn_64:
    v_cmp_eq_u32 vcc, -1, v160
    s_cbranch_vccz qn_65
    buffer_load_dwordx4 v[160:163], v52, s[48:51], s68 offen offset:1024 sc1
qn_65:
    v_cmp_eq_u32 vcc, -1, v164
    s_cbranch_vccz qn_66
    buffer_load_dwordx4 v[164:167], v52, s[48:51], s68 offen offset:2048 sc1
qn_66:
    v_cmp_eq_u32 vcc, -1, v168
    s_cbranch_vccz qn_67
    buffer_load_dwordx4 v[168:171], v52, s[48:51], s68 offen offset:3072 sc1
qn_67:
    v_cmp_eq_u32 vcc, -1, v172
    s_cbranch_vccz qn_68
    buffer_load_dwordx4 v[172:175], v52, s[48:51], s69 offen offset:0 sc1
qn_68:
    v_cmp_eq_u32 vcc, -1, v176
    s_cbranch_vccz qn_69
    buffer_load_dwordx4 v[176:179], v52, s[48:51], s69 offen offset:1024 sc1
qn_69:
    v_cmp_eq_u32 vcc, -1, v180
    s_cbranch_vccz qn_70
    buffer_load_dwordx4 v[180:183], v52, s[48:51], s69 offen offset:2048 sc1
qn_70:
    v_cmp_eq_u32 vcc, -1, v184
    s_cbranch_vccz qn_71
    buffer_load_dwordx4 v[184:187], v52, s[48:51], s69 offen offset:3072 sc1
qn_71:
    v_cmp_eq_u32 vcc, -1, v188
    s_cbranch_vccz qn_72
    buffer_load_dwordx4 v[188:191], v52, s[48:51], s78 offen sc1
qn_72:
    s_waitcnt vmcnt(0)
    ds_write_b128 v57, v[156:159] offset:0
    ds_write_b128 v57, v[160:163] offset:1024
    ds_write_b128 v57, v[164:167] offset:2048
    ds_write_b128 v57, v[168:171] offset:3072
    ds_write_b128 v57, v[172:175] offset:16384
    ds_write_b128 v57, v[176:179] offset:17408
    ds_write_b128 v57, v[180:183] offset:18432
    s_cmp_eq_u32 s56, 3
    s_cbranch_scc1 wi_73
    ds_write_b128 v57, v[184:187] offset:19456
wi_73:
    s_sub_u32 s63, s63, 1
    s_cbranch_scc0 poll_62
pdone_63:
    s_branch L_go
L_noq:
    s_barrier
    s_barrier
    ds_write_b128 v53, v[64:67] offset:0
    ds_write_b128 v53, v[68:71] offset:1024
    ds_write_b128 v53, v[72:75] offset:2048
    ds_write_b128 v53, v[76:79] offset:3072
    ds_write_b128 v53, v[80:83] offset:4096
    ds_write_b128 v53, v[84:87] offset:5120
    ds_write_b128 v53, v[88:91] offset:6144
    ds_write_b128 v53, v[92:95] offset:7168
    ds_write_b128 v53, v[96:99] offset:8192
    ds_write_b128 v53, v[100:103] offset:9216
    ds_write_b128 v53, v[104:107] offset:10240
    ds_write_b128 v53, v[108:111] offset:11264
    ds_write_b128 v53, v[112:115] offset:12288
    ds_write_b128 v53, v[116:119] offset:13312
    ds_write_b128 v53, v[120:123] offset:14336
    ds_write_b128 v53, v[124:127] offset:15360
    ds_write_b128 v53, v[128:131] offset:16384
    ds_write_b128 v53, v[132:135] offset:17408
    ds_write_b128 v53, v[136:139] offset:18432
    ds_write_b128 v53, v[140:143] offset:19456
    ds_write_b128 v53, v[144:147] offset:20480
    ds_write_b128 v53, v[148:151] offset:21504
    ds_write_b128 v53, v[152:155] offset:22528
    ds_write_b128 v53, v[156:159] offset:23552
    ds_write_b128 v53, v[160:163] offset:24576
    ds_write_b128 v53, v[164:167] offset:25600
    ds_write_b128 v53, v[168:171] offset:26624
    ds_write_b128 v53, v[172:175] offset:27648
    ds_write_b128 v53, v[176:179] offset:28672
    ds_write_b128 v53, v[180:183] offset:29696
    ds_write_b128 v53, v[184:187] offset:30720
L_go:
    s_mov_b32 s66, 0x3db504f3
    s_mov_b32 s67, 0x3fb8aa3b
    s_mov_b32 s65, 0x42800000
    s_setprio 1
    s_waitcnt lgkmcnt(0)
    s_barrier
    ds_read_b128 v[64:67], v53 offset:0
    ds_read_b128 v[128:131], v53 offset:16384
    ds_read_b128 v[68:71], v53 offset:1024
    ds_read_b128 v[132:135], v53 offset:17408
    ds_read_b128 v[72:75], v53 offset:2048
    ds_read_b128 v[136:139], v53 offset:18432
    ds_read_b128 v[76:79], v53 offset:3072
    ds_read_b128 v[140:143], v53 offset:19456
    s_waitcnt lgkmcnt(7)
    v_mfma_f32_16x16x32_bf16 v[8:11], v[192:195], v[64:67], 0
    ds_read_b128 v[80:83], v53 offset:4096
    s_waitcnt lgkmcnt(7)
    v_mfma_f32_16x16x32_bf16 v[12:15], v[192:195], v[128:131], 0
    ds_read_b128 v[144:147], v53 offset:20480
    s_waitcnt lgkmcnt(7)
    v_mfma_f32_16x16x32_bf16 v[8:11], v[196:199], v[68:71], v[8:11]
    ds_read_b128 v[84:87], v53 offset:5120
    s_waitcnt lgkmcnt(7)
    v_mfma_f32_16x16x32_bf16 v[12:15], v[196:199], v[132:135], v[12:15]
    ds_read_b128 v[148:151], v53 offset:21504
    s_waitcnt lgkmcnt(7)
    v_mfma_f32_16x16x32_bf16 v[8:11], v[200:203], v[72:75], v[8:11]
    ds_read_b128 v[88:91], v53 offset:6144
    s_waitcnt lgkmcnt(7)
    v_mfma_f32_16x16x32_bf16 v[12:15], v[200:203], v[136:139], v[12:15]
    ds_read_b128 v[152:155], v53 offset:22528
    s_waitcnt lgkmcnt(7)
    v_mfma_f32_16x16x32_bf16 v[8:11], v[204:207], v[76:79], v[8:11]
    ds_read_b128 v[92:95], v53 offset:7168
    s_waitcnt lgkmcnt(7)
    v_mfma_f32_16x16x32_bf16 v[12:15], v[204:207], v[140:143], v[12:15]
    ds_read_b128 v[156:159], v53 offset:23552
    s_waitcnt lgkmcnt(7)
    v_mfma_f32_16x16x32_bf16 v[8:11], v[208:211], v[80:83], v[8:11]
    ds_read_b128 v[96:99], v53 offset:8192
    s_waitcnt lgkmcnt(7)
    v_mfma_f32_16x16x32_bf16 v[12:15], v[208:211], v[144:147], v[12:15]
    ds_read_b128 v[160:163], v53 offset:24576
    s_waitcnt lgkmcnt(7)
    v_mfma_f32_16x16x32_bf16 v[8:11], v[212:215], v[84:87], v[8:11]
    ds_read_b128 v[100:103], v53 offset:9216
    s_waitcnt lgkmcnt(7)
    v_mfma_f32_16x16x32_bf16 v[12:15], v[212:215], v[148:151], v[12:15]
    ds_read_b128 v[164:167], v53 offset:25600
    s_waitcnt lgkmcnt(7)
    v_mfma_f32_16x16x32_bf16 v[8:11], v[216:219], v[88:91], v[8:11]
    ds_read_b128 v[104:107], v53 offset:10240
    s_waitcnt lgkmcnt(7)
    v_mfma_f32_16x16x32_bf16 v[12:15], v[216:219], v[152:155], v[12:15]
    ds_read_b128 v[168:171], v53 offset:26624
    s_waitcnt lgkmcnt(7)
    v_mfma_f32_16x16x32_bf16 v[8:11], v[220:223], v[92:95], v[8:11]
    ds_read_b128 v[108:111], v53 offset:11264
    s_waitcnt lgkmcnt(7)
    v_mfma_f32_16x16x32_bf16 v[12:15], v[220:223], v[156:159], v[12:15]
    ds_read_b128 v[172:175], v53 offset:27648
    s_waitcnt lgkmcnt(7)
    v_mfma_f32_16x16x32_bf16 v[8:11], v[224:227], v[96:99], v[8:11]
    ds_read_b128 v[112:115], v53 offset:12288
    s_waitcnt lgkmcnt(7)
    v_mfma_f32_16x16x32_bf16 v[12:15], v[224:227], v[160:163], v[12:15]
    ds_read_b128 v[176:179], v53 offset:28672
    s_waitcnt lgkmcnt(7)
    v_mfma_f32_16x16x32_bf16 v[8:11], v[228:231], v[100:103], v[8:11]
    ds_read_b128 v[116:119], v53 offset:13312
    s_waitcnt lgkmcnt(7)
    v_mfma_f32_16x16x32_bf16 v[12:15], v[228:231], v[164:167], v[12:15]
    ds_read_b128 v[180:183], v53 offset:29696
    s_waitcnt lgkmcnt(7)
    v_mfma_f32_16x16x32_bf16 v[8:11], v[232:235], v[104:107], v[8:11]
    ds_read_b128 v[120:123], v53 offset:14336
    s_waitcnt lgkmcnt(7)
    v_mfma_f32_16x16x32_bf16 v[12:15], v[232:235], v[168:171], v[12:15]
    ds_read_b128 v[184:187], v53 offset:30720
    s_waitcnt lgkmcnt(7)
    v_mfma_f32_16x16x32_bf16 v[8:11], v[236:239], v[108:111], v[8:11]
    ds_read_b128 v[124:127], v53 offset:15360
    s_waitcnt lgkmcnt(7)
    v_mfma_f32_16x16x32_bf16 v[12:15], v[236:239], v[172:175], v[12:15]
    ds_read_b128 v[192:195], v48 offset:32768
    s_waitcnt lgkmcnt(7)
    v_mfma_f32_16x16x32_bf16 v[8:11], v[240:243], v[112:115], v[8:11]
    ds_read_b128 v[196:199], v49 offset:32768
    s_waitcnt lgkmcnt(7)
    v_mfma_f32_16x16x32_bf16 v[12:15], v[240:243], v[176:179], v[12:15]
    ds_read_b128 v[200:203], v50 offset:32768
    s_waitcnt lgkmcnt(7)
    v_mfma_f32_16x16x32_bf16 v[8:11], v[244:247], v[116:119], v[8:11]
    ds_read_b128 v[204:207], v51 offset:32768
    s_waitcnt lgkmcnt(7)
    v_mfma_f32_16x16x32_bf16 v[12:15], v[244:247], v[180:183], v[12:15]
    ds_read_b128 v[208:211], v48 offset:33024
    s_waitcnt lgkmcnt(7)
    v_mfma_f32_16x16x32_bf16 v[8:11], v[248:251], v[120:123], v[8:11]
    ds_read_b128 v[212:215], v49 offset:33024
    s_waitcnt lgkmcnt(7)
    v_mfma_f32_16x16x32_bf16 v[12:15], v[248:251], v[184:187], v[12:15]
    ds_read_b128 v[216:219], v50 offset:33024
    s_waitcnt lgkmcnt(7)
    v_mfma_f32_16x16x32_bf16 v[8:11], v[252:255], v[124:127], v[8:11]
    ds_read_b128 v[220:223], v51 offset:33024
    v_mfma_f32_16x16x32_bf16 v[12:15], v[252:255], v[188:191], v[12:15]
    ds_read_b128 v[224:227], v48 offset:33280
    s_waitcnt lgkmcnt(8)
    v_mfma_f32_16x16x32_bf16 v[4:7], v[192:195], v[64:67], 0
    ds_read_b128 v[228:231], v49 offset:33280
    v_mfma_f32_16x16x32_bf16 v[56:59], v[192:195], v[128:131], 0
    ds_read_b128 v[232:235], v50 offset:33280
    s_waitcnt lgkmcnt(9)
    v_mfma_f32_16x16x32_bf16 v[4:7], v[196:199], v[68:71], v[4:7]
    ds_read_b128 v[236:239], v51 offset:33280
    v_mfma_f32_16x16x32_bf16 v[56:59], v[196:199], v[132:135], v[56:59]
    ds_read_b128 v[240:243], v48 offset:33536
    s_waitcnt lgkmcnt(10)
    v_mfma_f32_16x16x32_bf16 v[4:7], v[200:203], v[72:75], v[4:7]
    ds_read_b128 v[244:247], v49 offset:33536
    v_max3_f32 v44, v8, v9, v10
    v_max3_f32 v45, v12, v13, v14
    v_max_f32 v44, v44, v11
    v_max_f32 v45, v45, v15
    v_mfma_f32_16x16x32_bf16 v[56:59], v[200:203], v[136:139], v[56:59]
    ds_read_b128 v[248:251], v50 offset:33536
    v_cvt_pk_bf16_f32 v32, 0, v8
    v_cvt_pk_bf16_f32 v36, 0, v12
    v_permlane16_swap_b32 v44, v45
    s_waitcnt lgkmcnt(11)
    v_mfma_f32_16x16x32_bf16 v[4:7], v[204:207], v[76:79], v[4:7]
    ds_read_b128 v[252:255], v51 offset:33536
    v_cvt_pk_bf16_f32 v33, 0, v9
    v_cvt_pk_bf16_f32 v37, 0, v13
    v_max_f32 v44, v44, v45
    v_mfma_f32_16x16x32_bf16 v[56:59], v[204:207], v[140:143], v[56:59]
    v_cvt_pk_bf16_f32 v34, 0, v10
    v_cvt_pk_bf16_f32 v38, 0, v14
    v_mov_b32 v46, v44
    s_waitcnt lgkmcnt(11)
    v_mfma_f32_16x16x32_bf16 v[4:7], v[208:211], v[80:83], v[4:7]
    v_cvt_pk_bf16_f32 v35, 0, v11
    v_cvt_pk_bf16_f32 v39, 0, v15
    v_permlane32_swap_b32 v46, v44
    v_mul_f32 v32, s66, v32
    v_mfma_f32_16x16x32_bf16 v[56:59], v[208:211], v[144:147], v[56:59]
    v_mul_f32 v36, s66, v36
    v_max_f32 v44, v44, v46
    ds_write_b32 v54, v44
    s_waitcnt lgkmcnt(11)
    v_mfma_f32_16x16x32_bf16 v[4:7], v[212:215], v[84:87], v[4:7]
    v_mul_f32 v33, s66, v33
    v_mul_f32 v37, s66, v37
    v_mul_f32 v34, s66, v34
    v_mfma_f32_16x16x32_bf16 v[56:59], v[212:215], v[148:151], v[56:59]
    v_mul_f32 v38, s66, v38
    v_mul_f32 v35, s66, v35
    v_mul_f32 v39, s66, v39
    s_waitcnt lgkmcnt(10)
    v_mfma_f32_16x16x32_bf16 v[4:7], v[216:219], v[88:91], v[4:7]
    v_cvt_pk_bf16_f32 v16, 0, v32
    v_cvt_pk_bf16_f32 v20, 0, v36
    s_waitcnt lgkmcnt(0)
    s_barrier
    v_mfma_f32_16x16x32_bf16 v[56:59], v[216:219], v[152:155], v[56:59]
    ds_read_b128 v[40:43], v55
    ds_read_b128 v[44:47], v55 offset:256
    v_cvt_pk_bf16_f32 v17, 0, v33
    v_cvt_pk_bf16_f32 v21, 0, v37
    v_mfma_f32_16x16x32_bf16 v[4:7], v[220:223], v[92:95], v[4:7]
    v_cvt_pk_bf16_f32 v18, 0, v34
    v_cvt_pk_bf16_f32 v22, 0, v38
    v_cvt_pk_bf16_f32 v19, 0, v35
    v_mfma_f32_16x16x32_bf16 v[56:59], v[220:223], v[156:159], v[56:59]
    v_cvt_pk_bf16_f32 v23, 0, v39
    v_mfma_f32_16x16x32_bf16 v[4:7], v[224:227], v[96:99], v[4:7]
    v_mfma_f32_16x16x32_bf16 v[56:59], v[224:227], v[160:163], v[56:59]
    s_waitcnt lgkmcnt(0)
    v_max3_f32 v40, v40, v41, v42
    v_mfma_f32_16x16x32_bf16 v[4:7], v[228:231], v[100:103], v[4:7]
    v_max3_f32 v44, v44, v45, v46
    v_max_f32 v40, v40, v43
    v_max_f32 v44, v44, v47
    v_cvt_pk_bf16_f32 v40, 0, v40
    v_mfma_f32_16x16x32_bf16 v[56:59], v[228:231], v[164:167], v[56:59]
    v_cvt_pk_bf16_f32 v44, 0, v44
    v_mul_f32 v40, s66, v40
    v_mul_f32 v44, s66, v44
    v_mfma_f32_16x16x32_bf16 v[4:7], v[232:235], v[104:107], v[4:7]
    v_cvt_pk_bf16_f32 v40, 0, v40
    v_cvt_pk_bf16_f32 v44, 0, v44
    s_cmp_lg_u32 s72, 0
    s_cbranch_scc1 p2_75
    v_mul_f32 v24, s67, v40
    v_mul_f32 v25, s67, v44
p2_75:
    v_mfma_f32_16x16x32_bf16 v[56:59], v[232:235], v[168:171], v[56:59]
    v_fma_f32 v32, v16, s67, -v24
    v_fma_f32 v36, v20, s67, -v25
    v_fma_f32 v33, v17, s67, -v24
    v_mfma_f32_16x16x32_bf16 v[4:7], v[236:239], v[108:111], v[4:7]
    v_fma_f32 v37, v21, s67, -v25
    v_fma_f32 v34, v18, s67, -v24
    v_fma_f32 v38, v22, s67, -v25
    v_fma_f32 v35, v19, s67, -v24
    v_mfma_f32_16x16x32_bf16 v[56:59], v[236:239], v[172:175], v[56:59]
    v_fma_f32 v39, v23, s67, -v25
    v_max3_f32 v28, v28, v32, v33
    v_max3_f32 v29, v29, v36, v37
    v_mfma_f32_16x16x32_bf16 v[4:7], v[240:243], v[112:115], v[4:7]
    v_max3_f32 v28, v28, v34, v35
    v_max3_f32 v29, v29, v38, v39
    v_exp_f32 v32, v32
    v_mfma_f32_16x16x32_bf16 v[56:59], v[240:243], v[176:179], v[56:59]
    v_exp_f32 v36, v36
    v_exp_f32 v33, v33
    v_exp_f32 v37, v37
    v_mfma_f32_16x16x32_bf16 v[4:7], v[244:247], v[116:119], v[4:7]
    v_exp_f32 v34, v34
    v_exp_f32 v38, v38
    v_exp_f32 v35, v35
    v_mfma_f32_16x16x32_bf16 v[56:59], v[244:247], v[180:183], v[56:59]
    v_exp_f32 v39, v39
    v_cvt_pk_bf16_f32 v60, v32, v33
    v_cvt_pk_bf16_f32 v62, v36, v37
    v_cvt_pk_bf16_f32 v61, v34, v35
    v_mfma_f32_16x16x32_bf16 v[4:7], v[248:251], v[120:123], v[4:7]
    v_cvt_pk_bf16_f32 v63, v38, v39
    v_permlane16_swap_b32 v60, v62
    s_nop 0
    v_permlane16_swap_b32 v61, v63
    v_mfma_f32_16x16x32_bf16 v[56:59], v[248:251], v[184:187], v[56:59]
    ds_write_b128 v30, v[60:63] offset:0
    v_add_f32 v32, v32, v33
    v_add_f32 v36, v36, v37
    v_mfma_f32_16x16x32_bf16 v[4:7], v[252:255], v[124:127], v[4:7]
    v_add_f32 v34, v34, v35
    v_add_f32 v38, v38, v39
    v_add_f32 v26, v26, v32
    v_mfma_f32_16x16x32_bf16 v[56:59], v[252:255], v[188:191], v[56:59]
    v_add_f32 v27, v27, v36
    v_add_f32 v26, v26, v34
    v_add_f32 v27, v27, v38
    s_waitcnt lgkmcnt(0)
    s_barrier
    ds_read_b128 v[192:195], v48 offset:0
    ds_read_b128 v[196:199], v49 offset:0
    ds_read_b128 v[200:203], v50 offset:0
    ds_read_b128 v[204:207], v51 offset:0
    ds_read_b128 v[208:211], v48 offset:256
    ds_read_b128 v[212:215], v49 offset:256
    s_waitcnt lgkmcnt(5)
    v_mfma_f32_16x16x32_bf16 v[8:11], v[192:195], v[64:67], 0
    v_cvt_pk_bf16_f32 v32, 0, v4
    v_cvt_pk_bf16_f32 v36, 0, v56
    v_cvt_pk_bf16_f32 v33, 0, v5
    v_mfma_f32_16x16x32_bf16 v[12:15], v[192:195], v[128:131], 0
    ds_read_b128 v[216:219], v50 offset:256
    v_cvt_pk_bf16_f32 v37, 0, v57
    v_cvt_pk_bf16_f32 v34, 0, v6
    s_waitcnt lgkmcnt(5)
    v_mfma_f32_16x16x32_bf16 v[8:11], v[196:199], v[68:71], v[8:11]
    v_cvt_pk_bf16_f32 v38, 0, v58
    v_cvt_pk_bf16_f32 v35, 0, v7
    v_mfma_f32_16x16x32_bf16 v[12:15], v[196:199], v[132:135], v[12:15]
    ds_read_b128 v[220:223], v51 offset:256
    v_cvt_pk_bf16_f32 v39, 0, v59
    v_mul_f32 v32, s66, v32
    s_waitcnt lgkmcnt(5)
    v_mfma_f32_16x16x32_bf16 v[8:11], v[200:203], v[72:75], v[8:11]
    v_mul_f32 v36, s66, v36
    v_mul_f32 v33, s66, v33
    v_mfma_f32_16x16x32_bf16 v[12:15], v[200:203], v[136:139], v[12:15]
    ds_read_b128 v[224:227], v48 offset:512
    v_mul_f32 v37, s66, v37
    v_mul_f32 v34, s66, v34
    s_waitcnt lgkmcnt(5)
    v_mfma_f32_16x16x32_bf16 v[8:11], v[204:207], v[76:79], v[8:11]
    v_mul_f32 v38, s66, v38
    v_mul_f32 v35, s66, v35
    v_mfma_f32_16x16x32_bf16 v[12:15], v[204:207], v[140:143], v[12:15]
    ds_read_b128 v[228:231], v49 offset:512
    v_mul_f32 v39, s66, v39
    v_cvt_pk_bf16_f32 v16, 0, v32
    s_waitcnt lgkmcnt(5)
    v_mfma_f32_16x16x32_bf16 v[8:11], v[208:211], v[80:83], v[8:11]
    v_cvt_pk_bf16_f32 v20, 0, v36
    v_cvt_pk_bf16_f32 v17, 0, v33
    v_mfma_f32_16x16x32_bf16 v[12:15], v[208:211], v[144:147], v[12:15]
    ds_read_b128 v[232:235], v50 offset:512
    v_cvt_pk_bf16_f32 v21, 0, v37
    v_cvt_pk_bf16_f32 v18, 0, v34
    v_cvt_pk_bf16_f32 v22, 0, v38
    s_waitcnt lgkmcnt(5)
    v_mfma_f32_16x16x32_bf16 v[8:11], v[212:215], v[84:87], v[8:11]
    v_cvt_pk_bf16_f32 v19, 0, v35
    v_cvt_pk_bf16_f32 v23, 0, v39
    v_mfma_f32_16x16x32_bf16 v[12:15], v[212:215], v[148:151], v[12:15]
    ds_read_b128 v[236:239], v51 offset:512
    v_fma_f32 v32, v16, s67, -v24
    v_fma_f32 v36, v20, s67, -v25
    s_waitcnt lgkmcnt(5)
    v_mfma_f32_16x16x32_bf16 v[8:11], v[216:219], v[88:91], v[8:11]
    v_fma_f32 v33, v17, s67, -v24
    v_fma_f32 v37, v21, s67, -v25
    v_mfma_f32_16x16x32_bf16 v[12:15], v[216:219], v[152:155], v[12:15]
    ds_read_b128 v[240:243], v48 offset:768
    v_fma_f32 v34, v18, s67, -v24
    v_fma_f32 v38, v22, s67, -v25
    s_waitcnt lgkmcnt(5)
    v_mfma_f32_16x16x32_bf16 v[8:11], v[220:223], v[92:95], v[8:11]
    v_fma_f32 v35, v19, s67, -v24
    v_fma_f32 v39, v23, s67, -v25
    v_mfma_f32_16x16x32_bf16 v[12:15], v[220:223], v[156:159], v[12:15]
    ds_read_b128 v[244:247], v49 offset:768
    v_max3_f32 v28, v28, v32, v33
    v_max3_f32 v29, v29, v36, v37
    s_waitcnt lgkmcnt(5)
    v_mfma_f32_16x16x32_bf16 v[8:11], v[224:227], v[96:99], v[8:11]
    v_max3_f32 v28, v28, v34, v35
    v_max3_f32 v29, v29, v38, v39
    v_mfma_f32_16x16x32_bf16 v[12:15], v[224:227], v[160:163], v[12:15]
    ds_read_b128 v[248:251], v50 offset:768
    v_exp_f32 v32, v32
    v_exp_f32 v36, v36
    s_waitcnt lgkmcnt(5)
    v_mfma_f32_16x16x32_bf16 v[8:11], v[228:231], v[100:103], v[8:11]
    v_exp_f32 v33, v33
    v_exp_f32 v37, v37
    v_exp_f32 v34, v34
    v_mfma_f32_16x16x32_bf16 v[12:15], v[228:231], v[164:167], v[12:15]
    ds_read_b128 v[252:255], v51 offset:768
    v_exp_f32 v38, v38
    v_exp_f32 v35, v35
    s_waitcnt lgkmcnt(5)
    v_mfma_f32_16x16x32_bf16 v[8:11], v[232:235], v[104:107], v[8:11]
    v_exp_f32 v39, v39
    v_cvt_pk_bf16_f32 v60, v32, v33
    v_mfma_f32_16x16x32_bf16 v[12:15], v[232:235], v[168:171], v[12:15]
    v_cvt_pk_bf16_f32 v62, v36, v37
    v_cvt_pk_bf16_f32 v61, v34, v35
    s_waitcnt lgkmcnt(4)
    v_mfma_f32_16x16x32_bf16 v[8:11], v[236:239], v[108:111], v[8:11]
    v_cvt_pk_bf16_f32 v63, v38, v39
    v_permlane16_swap_b32 v60, v62
    v_mfma_f32_16x16x32_bf16 v[12:15], v[236:239], v[172:175], v[12:15]
    v_permlane16_swap_b32 v61, v63
    ds_write_b128 v30, v[60:63] offset:4096
    s_waitcnt lgkmcnt(4)
    v_mfma_f32_16x16x32_bf16 v[8:11], v[240:243], v[112:115], v[8:11]
    v_add_f32 v32, v32, v33
    v_add_f32 v36, v36, v37
    v_mfma_f32_16x16x32_bf16 v[12:15], v[240:243], v[176:179], v[12:15]
    v_add_f32 v34, v34, v35
    v_add_f32 v38, v38, v39
    s_waitcnt lgkmcnt(3)
    v_mfma_f32_16x16x32_bf16 v[8:11], v[244:247], v[116:119], v[8:11]
    v_add_f32 v26, v26, v32
    v_add_f32 v27, v27, v36
    v_mfma_f32_16x16x32_bf16 v[12:15], v[244:247], v[180:183], v[12:15]
    v_add_f32 v26, v26, v34
    v_add_f32 v27, v27, v38
    s_waitcnt lgkmcnt(2)
    v_mfma_f32_16x16x32_bf16 v[8:11], v[248:251], v[120:123], v[8:11]
    v_mfma_f32_16x16x32_bf16 v[12:15], v[248:251], v[184:187], v[12:15]
    s_waitcnt lgkmcnt(1)
    v_mfma_f32_16x16x32_bf16 v[8:11], v[252:255], v[124:127], v[8:11]
    v_mfma_f32_16x16x32_bf16 v[12:15], v[252:255], v[188:191], v[12:15]
    s_waitcnt lgkmcnt(0)
    s_barrier
    s_getpc_b64 s[68:69]
pc_76:
    s_sub_u32 s68, s68, pc_76-adaLN_cond__compressed_kv_cla__dense_activation_relu__decode_kernel
    s_subb_u32 s69, s69, 0
    s_lshl_b32 s64, s56, 4
    s_add_u32 s64, s64, s54
    s_lshl_b32 s64, s64, 10
    s_cmp_ge_u32 s64, L_code_end-adaLN_cond__compressed_kv_cla__dense_activation_relu__decode_kernel
    s_cbranch_scc1 cpf_77
    s_min_u32 s64, s64, L_code_end-adaLN_cond__compressed_kv_cla__dense_activation_relu__decode_kernel-1024
    v_lshl_add_u32 v40, v0, 4, s64
    global_load_dword v52, v40, s[68:69]
cpf_77:
    v_cvt_pk_bf16_f32 v32, 0, v8
    v_cvt_pk_bf16_f32 v36, 0, v12
    v_cvt_pk_bf16_f32 v33, 0, v9
    v_cvt_pk_bf16_f32 v37, 0, v13
    v_cvt_pk_bf16_f32 v34, 0, v10
    v_cvt_pk_bf16_f32 v38, 0, v14
    v_cvt_pk_bf16_f32 v35, 0, v11
    v_cvt_pk_bf16_f32 v39, 0, v15
    v_mul_f32 v32, s66, v32
    v_mul_f32 v36, s66, v36
    v_mul_f32 v33, s66, v33
    v_mul_f32 v37, s66, v37
    v_mul_f32 v34, s66, v34
    v_mul_f32 v38, s66, v38
    v_mul_f32 v35, s66, v35
    v_mul_f32 v39, s66, v39
    v_cvt_pk_bf16_f32 v16, 0, v32
    v_cvt_pk_bf16_f32 v20, 0, v36
    v_cvt_pk_bf16_f32 v17, 0, v33
    v_cvt_pk_bf16_f32 v21, 0, v37
    v_cvt_pk_bf16_f32 v18, 0, v34
    v_cvt_pk_bf16_f32 v22, 0, v38
    v_cvt_pk_bf16_f32 v19, 0, v35
    v_cvt_pk_bf16_f32 v23, 0, v39
    v_fma_f32 v32, v16, s67, -v24
    v_fma_f32 v36, v20, s67, -v25
    v_fma_f32 v33, v17, s67, -v24
    v_fma_f32 v37, v21, s67, -v25
    v_fma_f32 v34, v18, s67, -v24
    v_fma_f32 v38, v22, s67, -v25
    v_fma_f32 v35, v19, s67, -v24
    v_fma_f32 v39, v23, s67, -v25
    v_max3_f32 v28, v28, v32, v33
    v_max3_f32 v29, v29, v36, v37
    v_max3_f32 v28, v28, v34, v35
    v_max3_f32 v29, v29, v38, v39
    v_exp_f32 v32, v32
    v_exp_f32 v36, v36
    v_exp_f32 v33, v33
    v_exp_f32 v37, v37
    v_exp_f32 v34, v34
    v_exp_f32 v38, v38
    v_exp_f32 v35, v35
    v_exp_f32 v39, v39
    v_cvt_pk_bf16_f32 v60, v32, v33
    v_cvt_pk_bf16_f32 v62, v36, v37
    v_cvt_pk_bf16_f32 v61, v34, v35
    v_cvt_pk_bf16_f32 v63, v38, v39
    v_permlane16_swap_b32 v60, v62
    s_nop 0
    v_permlane16_swap_b32 v61, v63
    ds_write_b128 v30, v[60:63] offset:0
    v_add_f32 v32, v32, v33
    v_add_f32 v36, v36, v37
    v_add_f32 v34, v34, v35
    v_add_f32 v38, v38, v39
    v_add_f32 v26, v26, v32
    v_add_f32 v27, v27, v36
    v_add_f32 v26, v26, v34
    v_add_f32 v27, v27, v38
    v_lshrrev_b32 v44, 1, v2
    v_lshlrev_b32 v44, 9, v44
    v_lshl_add_u32 v44, v1, 4, v44
    v_and_b32 v45, 1, v2
    v_lshl_add_u32 v44, v45, 3, v44
    s_and_b32 s64, s56, 1
    s_lshl_b32 s64, s64, 10
    s_lshr_b32 s68, s56, 1
    s_lshl_b32 s68, s68, 8
    s_add_u32 s64, s64, s68
    s_add_u32 s64, s64, 135168
    v_add_u32 v44, s64, v44
    v_and_b32 v48, 0xffff, v48
    v_and_b32 v49, 0xffff, v49
    v_and_b32 v50, 0xffff, v50
    v_and_b32 v51, 0xffff, v51
    s_waitcnt lgkmcnt(0)
    s_barrier
    v_lshlrev_b32 v40, 7, v3
    s_lshl_b32 s64, s55, 15
    buffer_load_dword v53, v40, s[24:27], s64 offen
    s_cmp_ge_u32 s56, 2
    s_cbranch_scc1 wi_78
    ds_read_b128 v[192:195], v48 offset:32768
    ds_read_b128 v[196:199], v49 offset:32768
    ds_read_b128 v[200:203], v50 offset:32768
    ds_read_b128 v[204:207], v51 offset:32768
    ds_read_b128 v[208:211], v48 offset:33024
    ds_read_b128 v[212:215], v49 offset:33024
    ds_read_b128 v[216:219], v50 offset:33024
    ds_read_b128 v[220:223], v51 offset:33024
    ds_read_b128 v[224:227], v48 offset:33280
    ds_read_b128 v[228:231], v49 offset:33280
    ds_read_b128 v[232:235], v50 offset:33280
    ds_read_b128 v[236:239], v51 offset:33280
    ds_read_b128 v[240:243], v48 offset:33536
    ds_read_b128 v[244:247], v49 offset:33536
    ds_read_b128 v[248:251], v50 offset:33536
    ds_read_b128 v[252:255], v51 offset:33536
    s_waitcnt lgkmcnt(15)
    v_mfma_f32_16x16x32_bf16 v[4:7], v[192:195], v[64:67], 0
    s_waitcnt lgkmcnt(14)
    v_mfma_f32_16x16x32_bf16 v[4:7], v[196:199], v[68:71], v[4:7]
    s_waitcnt lgkmcnt(13)
    v_mfma_f32_16x16x32_bf16 v[4:7], v[200:203], v[72:75], v[4:7]
    s_waitcnt lgkmcnt(12)
    v_mfma_f32_16x16x32_bf16 v[4:7], v[204:207], v[76:79], v[4:7]
    s_waitcnt lgkmcnt(11)
    v_mfma_f32_16x16x32_bf16 v[4:7], v[208:211], v[80:83], v[4:7]
    s_waitcnt lgkmcnt(10)
    v_mfma_f32_16x16x32_bf16 v[4:7], v[212:215], v[84:87], v[4:7]
    s_waitcnt lgkmcnt(9)
    v_mfma_f32_16x16x32_bf16 v[4:7], v[216:219], v[88:91], v[4:7]
    s_waitcnt lgkmcnt(8)
    v_mfma_f32_16x16x32_bf16 v[4:7], v[220:223], v[92:95], v[4:7]
    s_waitcnt lgkmcnt(7)
    v_mfma_f32_16x16x32_bf16 v[4:7], v[224:227], v[96:99], v[4:7]
    s_waitcnt lgkmcnt(6)
    v_mfma_f32_16x16x32_bf16 v[4:7], v[228:231], v[100:103], v[4:7]
    s_waitcnt lgkmcnt(5)
    v_mfma_f32_16x16x32_bf16 v[4:7], v[232:235], v[104:107], v[4:7]
    s_waitcnt lgkmcnt(4)
    v_mfma_f32_16x16x32_bf16 v[4:7], v[236:239], v[108:111], v[4:7]
    s_waitcnt lgkmcnt(3)
    v_mfma_f32_16x16x32_bf16 v[4:7], v[240:243], v[112:115], v[4:7]
    s_waitcnt lgkmcnt(2)
    v_mfma_f32_16x16x32_bf16 v[4:7], v[244:247], v[116:119], v[4:7]
    s_waitcnt lgkmcnt(1)
    v_mfma_f32_16x16x32_bf16 v[4:7], v[248:251], v[120:123], v[4:7]
    s_waitcnt lgkmcnt(0)
    v_mfma_f32_16x16x32_bf16 v[4:7], v[252:255], v[124:127], v[4:7]
    v_or_b32 v48, 0x10000, v48
    v_or_b32 v49, 0x10000, v49
    v_or_b32 v50, 0x10000, v50
    v_or_b32 v51, 0x10000, v51
    s_nop 3
    v_cvt_pk_bf16_f32 v32, 0, v4
    v_cvt_pk_bf16_f32 v33, 0, v5
    v_cvt_pk_bf16_f32 v34, 0, v6
    v_cvt_pk_bf16_f32 v35, 0, v7
    v_mul_f32 v32, s66, v32
    v_mul_f32 v33, s66, v33
    v_mul_f32 v34, s66, v34
    v_mul_f32 v35, s66, v35
    v_cvt_pk_bf16_f32 v16, 0, v32
    v_cvt_pk_bf16_f32 v17, 0, v33
    v_cvt_pk_bf16_f32 v18, 0, v34
    v_cvt_pk_bf16_f32 v19, 0, v35
    v_fma_f32 v32, v16, s67, -v24
    v_fma_f32 v33, v17, s67, -v24
    v_fma_f32 v34, v18, s67, -v24
    v_fma_f32 v35, v19, s67, -v24
    v_max3_f32 v28, v28, v32, v33
    v_max3_f32 v28, v28, v34, v35
    v_exp_f32 v32, v32
    v_exp_f32 v33, v33
    v_exp_f32 v34, v34
    v_exp_f32 v35, v35
    v_cvt_pk_bf16_f32 v60, v32, v33
    v_cvt_pk_bf16_f32 v61, v34, v35
    ds_write_b64 v44, v[60:61] offset:0
    v_add_f32 v32, v32, v33
    v_add_f32 v34, v34, v35
    v_add_f32 v26, v26, v32
    v_add_f32 v26, v26, v34
    s_waitcnt lgkmcnt(0)
    s_barrier
    s_or_b32 s64, s56, s72
    s_cbranch_scc1 noarr_80
    v_mov_b32 v43, 1
    v_mov_b32 v40, 0
    s_lshl_b32 s64, s52, 7
    s_add_u32 s64, s64, 114688
    s_mov_b32 exec_lo, 0x1
    s_mov_b32 exec_hi, 0x0
    buffer_atomic_add v43, v40, s[48:51], s64 offen sc0 sc1
    s_mov_b64 exec, -1
noarr_80:
    ds_read_b128 v[192:195], v48 offset:32768
    ds_read_b128 v[196:199], v49 offset:32768
    ds_read_b128 v[200:203], v50 offset:32768
    ds_read_b128 v[204:207], v51 offset:32768
    ds_read_b128 v[208:211], v48 offset:33024
    ds_read_b128 v[212:215], v49 offset:33024
    ds_read_b128 v[216:219], v50 offset:33024
    ds_read_b128 v[220:223], v51 offset:33024
    ds_read_b128 v[224:227], v48 offset:33280
    ds_read_b128 v[228:231], v49 offset:33280
    ds_read_b128 v[232:235], v50 offset:33280
    ds_read_b128 v[236:239], v51 offset:33280
    ds_read_b128 v[240:243], v48 offset:33536
    ds_read_b128 v[244:247], v49 offset:33536
    ds_read_b128 v[248:251], v50 offset:33536
    ds_read_b128 v[252:255], v51 offset:33536
    s_waitcnt lgkmcnt(15)
    v_mfma_f32_16x16x32_bf16 v[4:7], v[192:195], v[64:67], 0
    s_waitcnt lgkmcnt(14)
    v_mfma_f32_16x16x32_bf16 v[4:7], v[196:199], v[68:71], v[4:7]
    s_waitcnt lgkmcnt(13)
    v_mfma_f32_16x16x32_bf16 v[4:7], v[200:203], v[72:75], v[4:7]
    s_waitcnt lgkmcnt(12)
    v_mfma_f32_16x16x32_bf16 v[4:7], v[204:207], v[76:79], v[4:7]
    s_waitcnt lgkmcnt(11)
    v_mfma_f32_16x16x32_bf16 v[4:7], v[208:211], v[80:83], v[4:7]
    s_waitcnt lgkmcnt(10)
    v_mfma_f32_16x16x32_bf16 v[4:7], v[212:215], v[84:87], v[4:7]
    s_waitcnt lgkmcnt(9)
    v_mfma_f32_16x16x32_bf16 v[4:7], v[216:219], v[88:91], v[4:7]
    s_waitcnt lgkmcnt(8)
    v_mfma_f32_16x16x32_bf16 v[4:7], v[220:223], v[92:95], v[4:7]
    s_waitcnt lgkmcnt(7)
    v_mfma_f32_16x16x32_bf16 v[4:7], v[224:227], v[96:99], v[4:7]
    s_waitcnt lgkmcnt(6)
    v_mfma_f32_16x16x32_bf16 v[4:7], v[228:231], v[100:103], v[4:7]
    s_waitcnt lgkmcnt(5)
    v_mfma_f32_16x16x32_bf16 v[4:7], v[232:235], v[104:107], v[4:7]
    s_waitcnt lgkmcnt(4)
    v_mfma_f32_16x16x32_bf16 v[4:7], v[236:239], v[108:111], v[4:7]
    s_waitcnt lgkmcnt(3)
    v_mfma_f32_16x16x32_bf16 v[4:7], v[240:243], v[112:115], v[4:7]
    s_waitcnt lgkmcnt(2)
    v_mfma_f32_16x16x32_bf16 v[4:7], v[244:247], v[116:119], v[4:7]
    s_waitcnt lgkmcnt(1)
    v_mfma_f32_16x16x32_bf16 v[4:7], v[248:251], v[120:123], v[4:7]
    s_waitcnt lgkmcnt(0)
    v_mfma_f32_16x16x32_bf16 v[4:7], v[252:255], v[124:127], v[4:7]
    v_and_b32 v48, 0xffff, v48
    v_and_b32 v49, 0xffff, v49
    v_and_b32 v50, 0xffff, v50
    v_and_b32 v51, 0xffff, v51
    s_nop 3
    v_cvt_pk_bf16_f32 v32, 0, v4
    v_cvt_pk_bf16_f32 v33, 0, v5
    v_cvt_pk_bf16_f32 v34, 0, v6
    v_cvt_pk_bf16_f32 v35, 0, v7
    v_mul_f32 v32, s66, v32
    v_mul_f32 v33, s66, v33
    v_mul_f32 v34, s66, v34
    v_mul_f32 v35, s66, v35
    v_cvt_pk_bf16_f32 v16, 0, v32
    v_cvt_pk_bf16_f32 v17, 0, v33
    v_cvt_pk_bf16_f32 v18, 0, v34
    v_cvt_pk_bf16_f32 v19, 0, v35
    v_fma_f32 v32, v16, s67, -v24
    v_fma_f32 v33, v17, s67, -v24
    v_fma_f32 v34, v18, s67, -v24
    v_fma_f32 v35, v19, s67, -v24
    v_max3_f32 v28, v28, v32, v33
    v_max3_f32 v28, v28, v34, v35
    v_exp_f32 v32, v32
    v_exp_f32 v33, v33
    v_exp_f32 v34, v34
    v_exp_f32 v35, v35
    v_cvt_pk_bf16_f32 v60, v32, v33
    v_cvt_pk_bf16_f32 v61, v34, v35
    ds_write_b64 v44, v[60:61] offset:2048
    v_add_f32 v32, v32, v33
    v_add_f32 v34, v34, v35
    v_add_f32 v26, v26, v32
    v_add_f32 v26, v26, v34
    s_branch wd_79
wi_78:
    ds_read_b128 v[192:195], v48 offset:32768
    ds_read_b128 v[196:199], v49 offset:32768
    ds_read_b128 v[200:203], v50 offset:32768
    ds_read_b128 v[204:207], v51 offset:32768
    ds_read_b128 v[208:211], v48 offset:33024
    ds_read_b128 v[212:215], v49 offset:33024
    ds_read_b128 v[216:219], v50 offset:33024
    ds_read_b128 v[220:223], v51 offset:33024
    ds_read_b128 v[224:227], v48 offset:33280
    ds_read_b128 v[228:231], v49 offset:33280
    ds_read_b128 v[232:235], v50 offset:33280
    ds_read_b128 v[236:239], v51 offset:33280
    ds_read_b128 v[240:243], v48 offset:33536
    ds_read_b128 v[244:247], v49 offset:33536
    ds_read_b128 v[248:251], v50 offset:33536
    ds_read_b128 v[252:255], v51 offset:33536
    s_waitcnt lgkmcnt(15)
    v_mfma_f32_16x16x32_bf16 v[56:59], v[192:195], v[128:131], 0
    s_waitcnt lgkmcnt(14)
    v_mfma_f32_16x16x32_bf16 v[56:59], v[196:199], v[132:135], v[56:59]
    s_waitcnt lgkmcnt(13)
    v_mfma_f32_16x16x32_bf16 v[56:59], v[200:203], v[136:139], v[56:59]
    s_waitcnt lgkmcnt(12)
    v_mfma_f32_16x16x32_bf16 v[56:59], v[204:207], v[140:143], v[56:59]
    s_waitcnt lgkmcnt(11)
    v_mfma_f32_16x16x32_bf16 v[56:59], v[208:211], v[144:147], v[56:59]
    s_waitcnt lgkmcnt(10)
    v_mfma_f32_16x16x32_bf16 v[56:59], v[212:215], v[148:151], v[56:59]
    s_waitcnt lgkmcnt(9)
    v_mfma_f32_16x16x32_bf16 v[56:59], v[216:219], v[152:155], v[56:59]
    s_waitcnt lgkmcnt(8)
    v_mfma_f32_16x16x32_bf16 v[56:59], v[220:223], v[156:159], v[56:59]
    s_waitcnt lgkmcnt(7)
    v_mfma_f32_16x16x32_bf16 v[56:59], v[224:227], v[160:163], v[56:59]
    s_waitcnt lgkmcnt(6)
    v_mfma_f32_16x16x32_bf16 v[56:59], v[228:231], v[164:167], v[56:59]
    s_waitcnt lgkmcnt(5)
    v_mfma_f32_16x16x32_bf16 v[56:59], v[232:235], v[168:171], v[56:59]
    s_waitcnt lgkmcnt(4)
    v_mfma_f32_16x16x32_bf16 v[56:59], v[236:239], v[172:175], v[56:59]
    s_waitcnt lgkmcnt(3)
    v_mfma_f32_16x16x32_bf16 v[56:59], v[240:243], v[176:179], v[56:59]
    s_waitcnt lgkmcnt(2)
    v_mfma_f32_16x16x32_bf16 v[56:59], v[244:247], v[180:183], v[56:59]
    s_waitcnt lgkmcnt(1)
    v_mfma_f32_16x16x32_bf16 v[56:59], v[248:251], v[184:187], v[56:59]
    s_waitcnt lgkmcnt(0)
    v_mfma_f32_16x16x32_bf16 v[56:59], v[252:255], v[188:191], v[56:59]
    v_or_b32 v48, 0x10000, v48
    v_or_b32 v49, 0x10000, v49
    v_or_b32 v50, 0x10000, v50
    v_or_b32 v51, 0x10000, v51
    s_nop 3
    v_cvt_pk_bf16_f32 v36, 0, v56
    v_cvt_pk_bf16_f32 v37, 0, v57
    v_cvt_pk_bf16_f32 v38, 0, v58
    v_cvt_pk_bf16_f32 v39, 0, v59
    v_mul_f32 v36, s66, v36
    v_mul_f32 v37, s66, v37
    v_mul_f32 v38, s66, v38
    v_mul_f32 v39, s66, v39
    v_cvt_pk_bf16_f32 v20, 0, v36
    v_cvt_pk_bf16_f32 v21, 0, v37
    v_cvt_pk_bf16_f32 v22, 0, v38
    v_cvt_pk_bf16_f32 v23, 0, v39
    v_fma_f32 v36, v20, s67, -v25
    v_fma_f32 v37, v21, s67, -v25
    v_fma_f32 v38, v22, s67, -v25
    v_fma_f32 v39, v23, s67, -v25
    v_max3_f32 v29, v29, v36, v37
    v_max3_f32 v29, v29, v38, v39
    v_exp_f32 v36, v36
    v_exp_f32 v37, v37
    v_exp_f32 v38, v38
    v_exp_f32 v39, v39
    v_cvt_pk_bf16_f32 v62, v36, v37
    v_cvt_pk_bf16_f32 v63, v38, v39
    ds_write_b64 v44, v[62:63] offset:0
    v_add_f32 v36, v36, v37
    v_add_f32 v38, v38, v39
    v_add_f32 v27, v27, v36
    v_add_f32 v27, v27, v38
    s_waitcnt lgkmcnt(0)
    s_barrier
    ds_read_b128 v[192:195], v48 offset:32768
    ds_read_b128 v[196:199], v49 offset:32768
    ds_read_b128 v[200:203], v50 offset:32768
    ds_read_b128 v[204:207], v51 offset:32768
    ds_read_b128 v[208:211], v48 offset:33024
    ds_read_b128 v[212:215], v49 offset:33024
    ds_read_b128 v[216:219], v50 offset:33024
    ds_read_b128 v[220:223], v51 offset:33024
    ds_read_b128 v[224:227], v48 offset:33280
    ds_read_b128 v[228:231], v49 offset:33280
    ds_read_b128 v[232:235], v50 offset:33280
    ds_read_b128 v[236:239], v51 offset:33280
    ds_read_b128 v[240:243], v48 offset:33536
    ds_read_b128 v[244:247], v49 offset:33536
    ds_read_b128 v[248:251], v50 offset:33536
    ds_read_b128 v[252:255], v51 offset:33536
    s_waitcnt lgkmcnt(15)
    v_mfma_f32_16x16x32_bf16 v[56:59], v[192:195], v[128:131], 0
    s_waitcnt lgkmcnt(14)
    v_mfma_f32_16x16x32_bf16 v[56:59], v[196:199], v[132:135], v[56:59]
    s_waitcnt lgkmcnt(13)
    v_mfma_f32_16x16x32_bf16 v[56:59], v[200:203], v[136:139], v[56:59]
    s_waitcnt lgkmcnt(12)
    v_mfma_f32_16x16x32_bf16 v[56:59], v[204:207], v[140:143], v[56:59]
    s_waitcnt lgkmcnt(11)
    v_mfma_f32_16x16x32_bf16 v[56:59], v[208:211], v[144:147], v[56:59]
    s_waitcnt lgkmcnt(10)
    v_mfma_f32_16x16x32_bf16 v[56:59], v[212:215], v[148:151], v[56:59]
    s_waitcnt lgkmcnt(9)
    v_mfma_f32_16x16x32_bf16 v[56:59], v[216:219], v[152:155], v[56:59]
    s_waitcnt lgkmcnt(8)
    v_mfma_f32_16x16x32_bf16 v[56:59], v[220:223], v[156:159], v[56:59]
    s_waitcnt lgkmcnt(7)
    v_mfma_f32_16x16x32_bf16 v[56:59], v[224:227], v[160:163], v[56:59]
    s_waitcnt lgkmcnt(6)
    v_mfma_f32_16x16x32_bf16 v[56:59], v[228:231], v[164:167], v[56:59]
    s_waitcnt lgkmcnt(5)
    v_mfma_f32_16x16x32_bf16 v[56:59], v[232:235], v[168:171], v[56:59]
    s_waitcnt lgkmcnt(4)
    v_mfma_f32_16x16x32_bf16 v[56:59], v[236:239], v[172:175], v[56:59]
    s_waitcnt lgkmcnt(3)
    v_mfma_f32_16x16x32_bf16 v[56:59], v[240:243], v[176:179], v[56:59]
    s_waitcnt lgkmcnt(2)
    v_mfma_f32_16x16x32_bf16 v[56:59], v[244:247], v[180:183], v[56:59]
    s_waitcnt lgkmcnt(1)
    v_mfma_f32_16x16x32_bf16 v[56:59], v[248:251], v[184:187], v[56:59]
    s_waitcnt lgkmcnt(0)
    v_mfma_f32_16x16x32_bf16 v[56:59], v[252:255], v[188:191], v[56:59]
    s_nop 7
    v_cvt_pk_bf16_f32 v36, 0, v56
    v_cvt_pk_bf16_f32 v37, 0, v57
    v_cvt_pk_bf16_f32 v38, 0, v58
    v_cvt_pk_bf16_f32 v39, 0, v59
    v_mul_f32 v36, s66, v36
    v_mul_f32 v37, s66, v37
    v_mul_f32 v38, s66, v38
    v_mul_f32 v39, s66, v39
    v_cvt_pk_bf16_f32 v20, 0, v36
    v_cvt_pk_bf16_f32 v21, 0, v37
    v_cvt_pk_bf16_f32 v22, 0, v38
    v_cvt_pk_bf16_f32 v23, 0, v39
    v_fma_f32 v36, v20, s67, -v25
    v_fma_f32 v37, v21, s67, -v25
    v_fma_f32 v38, v22, s67, -v25
    v_fma_f32 v39, v23, s67, -v25
    v_max3_f32 v29, v29, v36, v37
    v_max3_f32 v29, v29, v38, v39
    v_exp_f32 v36, v36
    v_exp_f32 v37, v37
    v_exp_f32 v38, v38
    v_exp_f32 v39, v39
    v_cvt_pk_bf16_f32 v62, v36, v37
    v_cvt_pk_bf16_f32 v63, v38, v39
    ds_write_b64 v44, v[62:63] offset:2048
    v_add_f32 v36, v36, v37
    v_add_f32 v38, v38, v39
    v_add_f32 v27, v27, v36
    v_add_f32 v27, v27, v38
wd_79:
    v_max_f32 v40, v28, v29
    v_cmp_lt_f32 vcc, s65, v40
    v_permlane16_swap_b32 v26, v27
    v_add_f32 v26, v26, v27
    v_mov_b32 v41, v26
    s_nop 1
    v_permlane32_swap_b32 v41, v26
    v_add_f32 v26, v26, v41
    v_subrev_u32 v42, 23552, v54
    ds_write_b32 v42, v26
    s_cbranch_vccz noflag_81
    s_cmp_lg_u32 s72, 0
    s_cbranch_scc1 noflag_81
    ds_write_b32 v31, v31
noflag_81:
    s_waitcnt lgkmcnt(0)
    s_barrier
    ds_read_b32 v39, v31
    v_and_b32 v42, -16, v42
    ds_read_b128 v[44:47], v42
    s_lshl_b32 s65, s55, 8
    s_add_u32 s65, s65, 65536
    v_lshlrev_b32 v40, 3, v0
    v_and_b32 v41, 1, v2
    v_cmp_eq_u32 vcc, 1, v41
    s_nop 1
    v_cndmask_b32 v32, v24, v25, vcc
    s_setprio 0
    s_waitcnt lgkmcnt(0)
    v_readfirstlane_b32 s64, v39
    v_add_f32 v44, v44, v45
    v_add_f32 v46, v46, v47
    v_add_f32 v33, v44, v46
    s_cmp_lg_u32 s64, 0
    s_cbranch_scc1 L_qk_redo
    s_cmp_lg_u32 s56, 0
    s_cbranch_scc1 wi_82
    s_mov_b32 exec_lo, 0xffffffff
    s_mov_b32 exec_hi, 0x0
    buffer_store_dwordx2 v[32:33], v40, s[48:51], s65 offen sc1
    s_mov_b64 exec, -1
wi_82:
    s_barrier
    s_or_b32 s68, s56, s72
    s_cbranch_scc1 noring_84
    v_lshlrev_b32 v35, 10, v0
    v_mov_b32 v36, s57
    s_lshl_b32 s69, s52, 7
    s_add_u32 s69, s69, 1572864
    s_waitcnt vmcnt(1)
    v_readfirstlane_b32 s68, v43
    s_cmp_lg_u32 s68, 14
    s_cbranch_scc1 noring_84
    s_mov_b32 exec_lo, 0xffffffff
    s_mov_b32 exec_hi, 0x0
    buffer_store_dword v36, v35, s[48:51], s69 offen sc1
    s_mov_b64 exec, -1
noring_84:
    s_branch L_att_post
L_qk_redo:
    s_or_b32 s68, s56, s72
    s_cbranch_scc1 noring_85
    v_lshlrev_b32 v35, 10, v0
    v_mov_b32 v36, s57
    s_lshl_b32 s69, s52, 7
    s_add_u32 s69, s69, 1572864
    s_waitcnt vmcnt(0)
    v_readfirstlane_b32 s68, v43
    s_cmp_lg_u32 s68, 14
    s_cbranch_scc1 noring_85
    s_mov_b32 exec_lo, 0xffffffff
    s_mov_b32 exec_hi, 0x0
    buffer_store_dword v36, v35, s[48:51], s69 offen sc1
    s_mov_b64 exec, -1
noring_85:
    s_waitcnt vmcnt(0)
    v_lshlrev_b32 v53, 4, v0
    v_add_u32 v53, 131072, v53
    v_permlane16_swap_b32 v28, v29
    v_max_f32 v28, v28, v29
    v_mov_b32 v41, v28
    s_nop 1
    v_permlane32_swap_b32 v41, v28
    v_max_f32 v28, v28, v41
    ds_write_b32 v54, v28
    s_waitcnt lgkmcnt(0)
    s_barrier
    ds_read_b128 v[40:43], v55
    ds_read_b128 v[44:47], v55 offset:256
    s_waitcnt lgkmcnt(0)
    v_max3_f32 v40, v40, v41, v42
    v_max_f32 v40, v40, v43
    v_add_f32 v24, v24, v40
    v_max3_f32 v44, v44, v45, v46
    v_max_f32 v44, v44, v47
    v_add_f32 v25, v25, v44
    s_mov_b32 s72, 1
    s_branch L_qk_start
L_att_post:
    s_barrier
    s_cmp_ge_u32 s56, 4
    s_cbranch_scc1 wi_86
    s_cmp_ge_u32 s56, 2
    s_cbranch_scc1 wi_88
    v_and_b32 v40, 31, v3
    v_mul_u32_u24 v40, 3584, v40
    v_lshrrev_b32 v41, 5, v3
    v_lshl_add_u32 v40, v41, 7, v40
    s_mul_i32 s64, s54, 114688
    s_mul_i32 s68, s52, 448
    s_add_u32 s64, s64, s68
    buffer_load_dword v52, v40, s[28:31], s64 offen offset:60
    s_branch wd_89
wi_88:
    v_subrev_u32 v40, 128, v3
    v_min_u32 v40, 111, v40
    v_lshlrev_b32 v40, 7, v40
    s_mul_i32 s64, s55, 14336
    buffer_load_dword v52, v40, s[32:35], s64 offen
wd_89:
wi_86:
    s_cmp_ge_u32 s54, 14
    s_cbranch_scc1 L_fin
    s_lshr_b32 s68, s54, 1
    s_mul_i32 s65, s52, 7
    s_add_u32 s68, s68, s65
    s_and_b32 s69, s54, 1
    v_lshrrev_b32 v44, 2, v0
    v_mul_u32_u24 v44, 3584, v44
    v_and_b32 v45, 3, v0
    v_lshrrev_b32 v32, 5, v0
    v_lshlrev_b32 v32, 1, v32
    v_xor_b32 v45, v45, v32
    v_lshl_add_u32 v44, v45, 4, v44
    v_lshlrev_b32 v32, 4, v0
    s_lshl_b32 s64, s68, 6
    s_mul_i32 s65, s56, 229376
    s_add_u32 s64, s64, s65
    s_lshl_b32 s65, s56, 12
    s_add_u32 s66, s65, 32768
    s_barrier
    s_mov_b32 m0, s66
    s_nop 0
    buffer_load_dwordx4 v44, s[28:31], s64 offen  lds
    s_add_u32 s64, s64, 57344
    s_add_u32 s66, s66, 1024
    s_mov_b32 m0, s66
    s_nop 0
    buffer_load_dwordx4 v44, s[28:31], s64 offen  lds
    s_add_u32 s64, s64, 57344
    s_add_u32 s66, s66, 1024
    s_mov_b32 m0, s66
    s_nop 0
    buffer_load_dwordx4 v44, s[28:31], s64 offen  lds
    s_add_u32 s64, s64, 57344
    s_add_u32 s66, s66, 1024
    s_mov_b32 m0, s66
    s_nop 0
    buffer_load_dwordx4 v44, s[28:31], s64 offen  lds
    s_cmp_lt_u32 s56, 4
    s_cbranch_scc1 wi_90
    s_mov_b32 s78, s69
    s_lshl_b32 s69, s79, 13
    s_min_u32 s64, s54, 13
    s_lshr_b32 s64, s64, 1
    s_mul_i32 s65, s52, 7
    s_add_u32 s64, s64, s65
    s_lshl_b32 s64, s64, 15
    s_add_u32 s64, s64, s69
    s_add_u32 s64, s64, 0
    s_add_u32 m0, s69, 0
    v_lshlrev_b32 v43, 4, v0
    s_and_b32 s65, s56, 1
    s_lshl_b32 s65, s65, 7
    v_xor_b32 v43, s65, v43
    v_xor_b32 v46, 0, v43
    buffer_load_dwordx4 v46, s[32:35], s64 offen offset:0  lds
    v_xor_b32 v46, 32, v43
    buffer_load_dwordx4 v46, s[32:35], s64 offen offset:1024  lds
    v_xor_b32 v46, 64, v43
    buffer_load_dwordx4 v46, s[32:35], s64 offen offset:2048  lds
    v_xor_b32 v46, 96, v43
    buffer_load_dwordx4 v46, s[32:35], s64 offen offset:3072  lds
    s_min_u32 s64, s54, 13
    s_lshr_b32 s64, s64, 1
    s_mul_i32 s65, s52, 7
    s_add_u32 s64, s64, s65
    s_lshl_b32 s64, s64, 15
    s_add_u32 s64, s64, s69
    s_add_u32 s64, s64, 4096
    s_add_u32 m0, s69, 4096
    v_lshlrev_b32 v43, 4, v0
    s_and_b32 s65, s56, 1
    s_lshl_b32 s65, s65, 7
    v_xor_b32 v43, s65, v43
    v_xor_b32 v46, 0, v43
    buffer_load_dwordx4 v46, s[32:35], s64 offen offset:0  lds
    v_xor_b32 v46, 32, v43
    buffer_load_dwordx4 v46, s[32:35], s64 offen offset:1024  lds
    v_xor_b32 v46, 64, v43
    buffer_load_dwordx4 v46, s[32:35], s64 offen offset:2048  lds
    v_xor_b32 v46, 96, v43
    buffer_load_dwordx4 v46, s[32:35], s64 offen offset:3072  lds
    s_mov_b32 s69, s78
wi_90:
    v_and_b32 v38, 3, v1
    s_lshl_b32 s64, s69, 12
    s_lshl_b32 s65, s56, 9
    s_add_u32 s65, s65, s64
    v_and_b32 v33, 31, v0
    v_lshlrev_b32 v33, 4, v33
    v_lshrrev_b32 v34, 5, v0
    v_lshl_add_u32 v33, v34, 3, v33
    buffer_load_dwordx2 v[40:41], v33, s[4:7], s65 offen
    s_add_u32 s65, s65, 32768
    s_add_u32 s66, s65, 8192
    s_add_u32 s67, s65, 16384
    s_mov_b32 s63, 60000
poll_92:
    buffer_load_dwordx2 v[44:45], v33, s[48:51], s65 offen sc1
    buffer_load_dwordx2 v[46:47], v33, s[48:51], s66 offen sc1
    buffer_load_dwordx2 v[48:49], v33, s[48:51], s67 offen sc1
    s_waitcnt vmcnt(0)
    v_max3_u32 v56, v44, v45, v46
    v_max3_u32 v56, v56, v47, v48
    v_max_u32 v56, v56, v49
    v_cmp_eq_u32 vcc, -1, v56
    s_cbranch_vccz pdone_93
    s_sleep 1
    s_sub_u32 s63, s63, 1
    s_cbranch_scc0 poll_92
pdone_93:
    s_lshr_b32 s64, s56, 1
    s_and_b32 s65, s56, 1
    s_mul_i32 s66, s64, 1040
    s_lshl_b32 s67, s65, 9
    s_add_u32 s66, s66, s67
    s_add_u32 s66, s66, 139264
    v_add_u32 v39, s66, v33
    ds_write_b64 v39, v[48:49] offset:4160
    ds_write_b64 v39, v[46:47] offset:8320
    v_lshlrev_b32 v160, 16, v40
    v_and_b32 v161, 0xffff0000, v40
    v_lshlrev_b32 v162, 16, v41
    v_and_b32 v163, 0xffff0000, v41
    v_lshlrev_b32 v164, 16, v44
    v_and_b32 v165, 0xffff0000, v44
    v_lshlrev_b32 v166, 16, v45
    v_and_b32 v167, 0xffff0000, v45
    v_lshlrev_b32 v168, 16, v48
    v_and_b32 v169, 0xffff0000, v48
    v_lshlrev_b32 v170, 16, v49
    v_and_b32 v171, 0xffff0000, v49
    s_waitcnt lgkmcnt(0)
    s_barrier
    v_lshrrev_b32 v34, 2, v1
    v_lshl_add_u32 v34, v2, 3, v34
    v_lshlrev_b32 v35, 6, v34
    v_lshl_add_u32 v35, v38, 3, v35
    v_and_b32 v36, 1, v2
    v_xor_b32 v36, s65, v36
    v_lshl_add_u32 v35, v36, 5, v35
    s_lshl_b32 s66, s64, 13
    v_add_u32 v35, s66, v35
    ds_read_b64_tr_b16 v[128:129], v35 offset:32768
    ds_read_b64_tr_b16 v[130:131], v35 offset:33024
    ds_read_b64_tr_b16 v[132:133], v35 offset:34816
    ds_read_b64_tr_b16 v[134:135], v35 offset:35072
    ds_read_b64_tr_b16 v[136:137], v35 offset:36864
    ds_read_b64_tr_b16 v[138:139], v35 offset:37120
    ds_read_b64_tr_b16 v[140:141], v35 offset:38912
    ds_read_b64_tr_b16 v[142:143], v35 offset:39168
    v_lshlrev_b32 v35, 10, v34
    v_lshl_add_u32 v35, v38, 3, v35
    v_lshrrev_b32 v36, 2, v1
    v_and_b32 v37, 1, v2
    v_lshl_add_u32 v36, v37, 2, v36
    s_lshl_b32 s66, s56, 2
    v_xor_b32 v36, s66, v36
    v_lshl_add_u32 v35, v36, 5, v35
    v_xor_b32 v36, 0, v35
    ds_read_b64_tr_b16 v[144:145], v36 offset:0
    ds_read_b64_tr_b16 v[146:147], v36 offset:4096
    v_xor_b32 v36, 32, v35
    ds_read_b64_tr_b16 v[148:149], v36 offset:0
    ds_read_b64_tr_b16 v[150:151], v36 offset:4096
    v_xor_b32 v36, 64, v35
    ds_read_b64_tr_b16 v[152:153], v36 offset:0
    ds_read_b64_tr_b16 v[154:155], v36 offset:4096
    v_xor_b32 v36, 96, v35
    ds_read_b64_tr_b16 v[156:157], v36 offset:0
    ds_read_b64_tr_b16 v[158:159], v36 offset:4096
    v_and_b32 v42, 7, v1
    v_mul_u32_u24 v34, 1040, v42
    v_lshl_add_u32 v34, v2, 4, v34
    s_lshl_b32 s66, s64, 8
    s_add_u32 s66, s66, 139264
    v_add_u32 v34, s66, v34
    v_mul_u32_u24 v35, 144, v42
    v_lshl_add_u32 v35, v2, 4, v35
    s_mul_i32 s66, s64, 1216
    s_lshl_b32 s67, s65, 6
    s_add_u32 s66, s66, s67
    s_add_u32 s66, s66, 152576
    v_add_u32 v35, s66, v35
    v_lshrrev_b32 v36, 2, v1
    v_mul_u32_u24 v36, 1216, v36
    v_mul_u32_u24 v43, 144, v38
    v_add_u32 v36, v36, v43
    v_lshl_add_u32 v36, v2, 5, v36
    v_add_u32 v36, 152576, v36
    v_lshrrev_b32 v37, 1, v38
    v_mul_u32_u24 v37, 7168, v37
    v_and_b32 v43, 1, v38
    v_lshl_add_u32 v37, v43, 6, v37
    v_lshl_add_u32 v37, v2, 4, v37
    v_lshrrev_b32 v43, 2, v1
    v_mul_u32_u24 v43, 28672, v43
    v_add_u32 v37, v37, v43
    v_lshlrev_b32 v50, 4, v38
    v_add_u32 v50, 157696, v50
    s_lshl_b32 s66, s56, 3
    s_add_u32 s66, s66, 157696
    v_mov_b32 v51, s66
    ds_read_b128 v[64:67], v34 offset:4160
    ds_read_b128 v[68:71], v34 offset:4224
    ds_read_b128 v[72:75], v34 offset:4288
    ds_read_b128 v[76:79], v34 offset:4352
    s_waitcnt lgkmcnt(0)
    v_mfma_f32_16x16x32_bf16 v[80:83], v[128:131], v[64:67], 0
    v_mfma_f32_16x16x32_bf16 v[80:83], v[132:135], v[68:71], v[80:83]
    v_mfma_f32_16x16x32_bf16 v[80:83], v[136:139], v[72:75], v[80:83]
    v_mfma_f32_16x16x32_bf16 v[80:83], v[140:143], v[76:79], v[80:83]
    s_mov_b32 exec_lo, 0xff00ff
    s_mov_b32 exec_hi, 0xff00ff
    s_nop 5
    ds_write_b128 v35, v[80:83]
    s_mov_b64 exec, -1
    s_waitcnt lgkmcnt(0)
    s_barrier
    ds_read_b128 v[176:179], v36
    ds_read_b128 v[180:183], v36 offset:16
    ds_read_b128 v[184:187], v36 offset:576
    ds_read_b128 v[188:191], v36 offset:592
    s_lshl_b32 s66, s69, 15
    s_lshl_b32 s67, s64, 13
    s_add_u32 s66, s66, s67
    s_lshl_b32 s67, s65, 9
    s_add_u32 s66, s66, s67
    s_add_u32 s66, s66, 116736
    s_add_u32 s67, s66, 4096
    s_lshl_b32 s64, s56, 4
    s_lshl_b32 s65, s69, 1
    s_add_u32 s64, s64, s65
    s_mul_i32 s64, s64, 7168
    s_lshl_b32 s65, s68, 7
    s_add_u32 s64, s64, s65
    s_add_u32 s64, s64, 215040
    s_mov_b32 s65, 0xff
    v_lshrrev_b32 v40, 0, s57
    v_lshrrev_b32 v41, 8, s57
    v_lshrrev_b32 v42, 16, s57
    v_lshrrev_b32 v43, 24, s57
    s_waitcnt lgkmcnt(0)
    v_add_f32_dpp v176, v176, v176 row_ror:8 row_mask:0xf bank_mask:0xf
    v_add_f32_dpp v177, v177, v177 row_ror:8 row_mask:0xf bank_mask:0xf
    v_add_f32_dpp v178, v178, v178 row_ror:8 row_mask:0xf bank_mask:0xf
    v_add_f32_dpp v179, v179, v179 row_ror:8 row_mask:0xf bank_mask:0xf
    v_add_f32_dpp v180, v180, v180 row_ror:8 row_mask:0xf bank_mask:0xf
    v_add_f32_dpp v181, v181, v181 row_ror:8 row_mask:0xf bank_mask:0xf
    v_add_f32_dpp v182, v182, v182 row_ror:8 row_mask:0xf bank_mask:0xf
    v_add_f32_dpp v183, v183, v183 row_ror:8 row_mask:0xf bank_mask:0xf
    v_add_f32_dpp v184, v184, v184 row_ror:8 row_mask:0xf bank_mask:0xf
    v_add_f32_dpp v185, v185, v185 row_ror:8 row_mask:0xf bank_mask:0xf
    v_add_f32_dpp v186, v186, v186 row_ror:8 row_mask:0xf bank_mask:0xf
    v_add_f32_dpp v187, v187, v187 row_ror:8 row_mask:0xf bank_mask:0xf
    v_add_f32_dpp v188, v188, v188 row_ror:8 row_mask:0xf bank_mask:0xf
    v_add_f32_dpp v189, v189, v189 row_ror:8 row_mask:0xf bank_mask:0xf
    v_add_f32_dpp v190, v190, v190 row_ror:8 row_mask:0xf bank_mask:0xf
    v_add_f32_dpp v191, v191, v191 row_ror:8 row_mask:0xf bank_mask:0xf
    v_add_f32_dpp v176, v176, v176 row_ror:4 row_mask:0xf bank_mask:0xf
    v_add_f32_dpp v177, v177, v177 row_ror:4 row_mask:0xf bank_mask:0xf
    v_add_f32_dpp v178, v178, v178 row_ror:4 row_mask:0xf bank_mask:0xf
    v_add_f32_dpp v179, v179, v179 row_ror:4 row_mask:0xf bank_mask:0xf
    v_add_f32_dpp v180, v180, v180 row_ror:4 row_mask:0xf bank_mask:0xf
    v_add_f32_dpp v181, v181, v181 row_ror:4 row_mask:0xf bank_mask:0xf
    v_add_f32_dpp v182, v182, v182 row_ror:4 row_mask:0xf bank_mask:0xf
    v_add_f32_dpp v183, v183, v183 row_ror:4 row_mask:0xf bank_mask:0xf
    v_add_f32_dpp v184, v184, v184 row_ror:4 row_mask:0xf bank_mask:0xf
    v_add_f32_dpp v185, v185, v185 row_ror:4 row_mask:0xf bank_mask:0xf
    v_add_f32_dpp v186, v186, v186 row_ror:4 row_mask:0xf bank_mask:0xf
    v_add_f32_dpp v187, v187, v187 row_ror:4 row_mask:0xf bank_mask:0xf
    v_add_f32_dpp v188, v188, v188 row_ror:4 row_mask:0xf bank_mask:0xf
    v_add_f32_dpp v189, v189, v189 row_ror:4 row_mask:0xf bank_mask:0xf
    v_add_f32_dpp v190, v190, v190 row_ror:4 row_mask:0xf bank_mask:0xf
    v_add_f32_dpp v191, v191, v191 row_ror:4 row_mask:0xf bank_mask:0xf
    v_and_b32 v57, 31, v0
    v_lshlrev_b32 v57, 4, v57
    v_lshrrev_b32 v58, 5, v0
    v_lshl_add_u32 v57, v58, 12, v57
    s_cmp_lg_u32 s56, 0
    s_cbranch_scc1 nohw_94
    s_lshl_b32 s78, s55, 7
    s_add_u32 s78, s78, 182272
    s_mov_b32 s63, 60000
hw_95:
    s_load_dword s79, s[48:49], s78 glc
    s_waitcnt lgkmcnt(0)
    s_cmp_eq_u32 s79, s57
    s_cbranch_scc1 hd_96
    s_sub_u32 s63, s63, 1
    s_cbranch_scc0 hw_95
hd_96:
nohw_94:
    s_barrier
    s_mov_b32 s63, 60000
poll_97:
    buffer_load_dwordx4 v[64:67], v57, s[48:51], s66 offen offset:0 sc1
    buffer_load_dwordx4 v[68:71], v57, s[48:51], s66 offen offset:1024 sc1
    buffer_load_dwordx4 v[72:75], v57, s[48:51], s66 offen offset:2048 sc1
    buffer_load_dwordx4 v[76:79], v57, s[48:51], s66 offen offset:3072 sc1
    s_waitcnt vmcnt(0)
    v_max3_u32 v56, v64, v66, v68
    v_max3_u32 v56, v56, v70, v72
    v_max3_u32 v56, v56, v74, v76
    v_max_u32 v56, v56, v78
    v_cmp_eq_u32 vcc, -1, v56
    s_cbranch_vccz pdone_98
    s_sub_u32 s63, s63, 1
    s_cbranch_scc0 poll_97
pdone_98:
    s_cmp_lg_u32 s56, 6
    s_cbranch_scc1 nohint_99
    s_lshl_b32 s78, s55, 7
    s_add_u32 s78, s78, 198720
    v_mov_b32 v112, s57
    v_mov_b32 v113, 0
    s_mov_b32 exec_lo, 0x1
    s_mov_b32 exec_hi, 0x0
    buffer_store_dword v112, v113, s[48:51], s78 offen sc1
    s_mov_b64 exec, -1
nohint_99:
    v_lshlrev_b32 v80, 16, v64
    v_and_b32 v81, 0xffff0000, v64
    v_lshlrev_b32 v82, 16, v65
    v_and_b32 v83, 0xffff0000, v65
    v_lshlrev_b32 v84, 16, v66
    v_and_b32 v85, 0xffff0000, v66
    v_lshlrev_b32 v86, 16, v67
    v_and_b32 v87, 0xffff0000, v67
    v_lshlrev_b32 v88, 16, v68
    v_and_b32 v89, 0xffff0000, v68
    v_lshlrev_b32 v90, 16, v69
    v_and_b32 v91, 0xffff0000, v69
    v_lshlrev_b32 v92, 16, v70
    v_and_b32 v93, 0xffff0000, v70
    v_lshlrev_b32 v94, 16, v71
    v_and_b32 v95, 0xffff0000, v71
    v_lshlrev_b32 v96, 16, v72
    v_and_b32 v97, 0xffff0000, v72
    v_lshlrev_b32 v98, 16, v73
    v_and_b32 v99, 0xffff0000, v73
    v_lshlrev_b32 v100, 16, v74
    v_and_b32 v101, 0xffff0000, v74
    v_lshlrev_b32 v102, 16, v75
    v_and_b32 v103, 0xffff0000, v75
    v_lshlrev_b32 v104, 16, v76
    v_and_b32 v105, 0xffff0000, v76
    v_lshlrev_b32 v106, 16, v77
    v_and_b32 v107, 0xffff0000, v77
    v_lshlrev_b32 v108, 16, v78
    v_and_b32 v109, 0xffff0000, v78
    v_lshlrev_b32 v110, 16, v79
    v_and_b32 v111, 0xffff0000, v79
    v_pk_add_f32 v[80:81], v[80:81], v[96:97]
    v_pk_add_f32 v[82:83], v[82:83], v[98:99]
    v_pk_add_f32 v[84:85], v[84:85], v[100:101]
    v_pk_add_f32 v[86:87], v[86:87], v[102:103]
    v_pk_add_f32 v[88:89], v[88:89], v[104:105]
    v_pk_add_f32 v[90:91], v[90:91], v[106:107]
    v_pk_add_f32 v[92:93], v[92:93], v[108:109]
    v_pk_add_f32 v[94:95], v[94:95], v[110:111]
    v_pk_add_f32 v[80:81], v[80:81], v[88:89]
    v_pk_add_f32 v[82:83], v[82:83], v[90:91]
    v_pk_add_f32 v[84:85], v[84:85], v[92:93]
    v_pk_add_f32 v[86:87], v[86:87], v[94:95]
    s_nop 0
    v_permlane32_swap_b32 v80, v84
    v_permlane32_swap_b32 v81, v85
    v_permlane32_swap_b32 v82, v86
    v_permlane32_swap_b32 v83, v87
    v_pk_add_f32 v[80:81], v[80:81], v[84:85]
    v_pk_add_f32 v[82:83], v[82:83], v[86:87]
    v_fma_f32 v80, v80, v164, v160
    v_fma_f32 v81, v81, v165, v161
    v_fma_f32 v82, v82, v166, v162
    v_fma_f32 v83, v83, v167, v163
    v_mul_f32 v84, v80, v168
    v_mul_f32 v85, v81, v169
    v_mul_f32 v86, v82, v170
    v_mul_f32 v87, v83, v171
    v_cvt_pk_bf16_f32 v88, v84, v85
    v_cvt_pk_bf16_f32 v89, v86, v87
    ds_write_b64 v39, v[88:89]
    v_add_f32 v52, v80, v81
    v_mul_f32 v53, v80, v80
    v_add_f32 v54, v82, v83
    v_fmac_f32 v53, v81, v81
    v_add_f32 v52, v52, v54
    v_fmac_f32 v53, v82, v82
    v_fmac_f32 v53, v83, v83
    s_waitcnt lgkmcnt(0)
    s_barrier
    ds_read_b128 v[64:67], v34 offset:0
    ds_read_b128 v[68:71], v34 offset:64
    ds_read_b128 v[72:75], v34 offset:128
    ds_read_b128 v[76:79], v34 offset:192
    v_add_f32_dpp v52, v52, v52 row_ror:8 row_mask:0xf bank_mask:0xf
    v_add_f32_dpp v53, v53, v53 row_ror:8 row_mask:0xf bank_mask:0xf
    s_nop 0
    v_add_f32_dpp v52, v52, v52 row_ror:4 row_mask:0xf bank_mask:0xf
    v_add_f32_dpp v53, v53, v53 row_ror:4 row_mask:0xf bank_mask:0xf
    s_nop 0
    v_add_f32_dpp v52, v52, v52 row_ror:2 row_mask:0xf bank_mask:0xf
    v_add_f32_dpp v53, v53, v53 row_ror:2 row_mask:0xf bank_mask:0xf
    s_nop 0
    v_add_f32_dpp v52, v52, v52 row_ror:1 row_mask:0xf bank_mask:0xf
    v_add_f32_dpp v53, v53, v53 row_ror:1 row_mask:0xf bank_mask:0xf
    s_waitcnt lgkmcnt(3)
    v_mfma_f32_16x16x32_bf16 v[80:83], v[128:131], v[64:67], 0
    s_waitcnt lgkmcnt(2)
    v_mfma_f32_16x16x32_bf16 v[80:83], v[132:135], v[68:71], v[80:83]
    s_waitcnt lgkmcnt(1)
    v_mfma_f32_16x16x32_bf16 v[80:83], v[136:139], v[72:75], v[80:83]
    s_waitcnt lgkmcnt(0)
    v_mfma_f32_16x16x32_bf16 v[80:83], v[140:143], v[76:79], v[80:83]
    v_add_f32_dpp v52, v52, v52 row_bcast:15 row_mask:0xa bank_mask:0xf
    v_add_f32_dpp v53, v53, v53 row_bcast:15 row_mask:0xa bank_mask:0xf
    s_nop 0
    v_add_f32_dpp v52, v52, v52 row_bcast:31 row_mask:0xc bank_mask:0xf
    v_add_f32_dpp v53, v53, v53 row_bcast:31 row_mask:0xc bank_mask:0xf
    s_mov_b32 exec_lo, 0x0
    s_mov_b32 exec_hi, 0x80000000
    ds_write_b64 v51, v[52:53]
    s_mov_b32 exec_lo, 0xf000f
    s_mov_b32 exec_hi, 0xf000f
    ds_write_b128 v35, v[80:83]
    s_mov_b64 exec, -1
    s_waitcnt lgkmcnt(0)
    s_barrier
    ds_read_b128 v[52:55], v50
    ds_read_b128 v[64:67], v36
    ds_read_b128 v[68:71], v36 offset:16
    s_waitcnt lgkmcnt(2)
    v_add_f32 v52, v52, v54
    v_add_f32 v53, v53, v55
    v_mul_f32 v52, 0x3b000000, v52
    v_mul_f32 v53, 0x3b000000, v53
    v_fma_f32 v53, -v52, v52, v53
    v_max_f32 v53, 0, v53
    v_add_f32 v53, 0x3727c5ac, v53
    v_rsq_f32 v53, v53
    s_waitcnt lgkmcnt(0)
    v_add_f32_dpp v64, v64, v64 row_ror:8 row_mask:0xf bank_mask:0xf
    v_add_f32_dpp v65, v65, v65 row_ror:8 row_mask:0xf bank_mask:0xf
    v_add_f32_dpp v66, v66, v66 row_ror:8 row_mask:0xf bank_mask:0xf
    v_add_f32_dpp v67, v67, v67 row_ror:8 row_mask:0xf bank_mask:0xf
    v_add_f32_dpp v68, v68, v68 row_ror:8 row_mask:0xf bank_mask:0xf
    v_add_f32_dpp v69, v69, v69 row_ror:8 row_mask:0xf bank_mask:0xf
    v_add_f32_dpp v70, v70, v70 row_ror:8 row_mask:0xf bank_mask:0xf
    v_add_f32_dpp v71, v71, v71 row_ror:8 row_mask:0xf bank_mask:0xf
    v_add_f32_dpp v64, v64, v64 row_ror:4 row_mask:0xf bank_mask:0xf
    v_add_f32_dpp v65, v65, v65 row_ror:4 row_mask:0xf bank_mask:0xf
    v_add_f32_dpp v66, v66, v66 row_ror:4 row_mask:0xf bank_mask:0xf
    v_add_f32_dpp v67, v67, v67 row_ror:4 row_mask:0xf bank_mask:0xf
    v_add_f32_dpp v68, v68, v68 row_ror:4 row_mask:0xf bank_mask:0xf
    v_add_f32_dpp v69, v69, v69 row_ror:4 row_mask:0xf bank_mask:0xf
    v_add_f32_dpp v70, v70, v70 row_ror:4 row_mask:0xf bank_mask:0xf
    v_add_f32_dpp v71, v71, v71 row_ror:4 row_mask:0xf bank_mask:0xf
    v_mov_b32 v54, v53
    v_mov_b32 v55, v53
    v_sub_f32 v52, 0, v52
    v_mov_b32 v53, v52
    v_pk_fma_f32 v[64:65], v[52:53], v[176:177], v[64:65]
    v_pk_fma_f32 v[66:67], v[52:53], v[178:179], v[66:67]
    v_pk_fma_f32 v[68:69], v[52:53], v[180:181], v[68:69]
    v_pk_fma_f32 v[70:71], v[52:53], v[182:183], v[70:71]
    v_pk_fma_f32 v[64:65], v[54:55], v[64:65], v[184:185]
    v_pk_fma_f32 v[66:67], v[54:55], v[66:67], v[186:187]
    v_pk_fma_f32 v[68:69], v[54:55], v[68:69], v[188:189]
    v_pk_fma_f32 v[70:71], v[54:55], v[70:71], v[190:191]
    v_cvt_pk_bf16_f32 v72, v64, v65
    v_cvt_pk_bf16_f32 v73, v66, v67
    v_cvt_pk_bf16_f32 v74, v68, v69
    v_cvt_pk_bf16_f32 v75, v70, v71
    v_pk_max_i16 v72, v72, 0
    v_pk_max_i16 v73, v73, 0
    v_pk_max_i16 v74, v74, 0
    v_pk_max_i16 v75, v75, 0
    s_nop 1
    v_mfma_f32_16x16x32_bf16 v[80:83], v[144:147], v[72:75], 0
    v_mfma_f32_16x16x32_bf16 v[84:87], v[148:151], v[72:75], 0
    v_mfma_f32_16x16x32_bf16 v[88:91], v[152:155], v[72:75], 0
    v_mfma_f32_16x16x32_bf16 v[92:95], v[156:159], v[72:75], 0
    s_nop 5
    v_mov_b32_dpp v80, v84 quad_perm:[0,1,2,3] row_mask:0xf bank_mask:0x2
    v_mov_b32_dpp v81, v85 quad_perm:[0,1,2,3] row_mask:0xf bank_mask:0x2
    v_mov_b32_dpp v82, v86 quad_perm:[0,1,2,3] row_mask:0xf bank_mask:0x2
    v_mov_b32_dpp v83, v87 quad_perm:[0,1,2,3] row_mask:0xf bank_mask:0x2
    v_mov_b32_dpp v80, v88 quad_perm:[0,1,2,3] row_mask:0xf bank_mask:0x4
    v_mov_b32_dpp v81, v89 quad_perm:[0,1,2,3] row_mask:0xf bank_mask:0x4
    v_mov_b32_dpp v82, v90 quad_perm:[0,1,2,3] row_mask:0xf bank_mask:0x4
    v_mov_b32_dpp v83, v91 quad_perm:[0,1,2,3] row_mask:0xf bank_mask:0x4
    v_mov_b32_dpp v80, v92 quad_perm:[0,1,2,3] row_mask:0xf bank_mask:0x8
    v_mov_b32_dpp v81, v93 quad_perm:[0,1,2,3] row_mask:0xf bank_mask:0x8
    v_mov_b32_dpp v82, v94 quad_perm:[0,1,2,3] row_mask:0xf bank_mask:0x8
    v_mov_b32_dpp v83, v95 quad_perm:[0,1,2,3] row_mask:0xf bank_mask:0x8
    v_bfi_b32 v80, s65, v40, v80
    v_bfi_b32 v81, s65, v41, v81
    v_bfi_b32 v82, s65, v42, v82
    v_bfi_b32 v83, s65, v43, v83
    buffer_store_dwordx4 v[80:83], v37, s[48:51], s64 offen sc1
    s_cmp_lg_u32 s56, 0
    s_cbranch_scc1 nohint_100
    s_lshl_b32 s78, s55, 7
    s_add_u32 s78, s78, 198656
    v_mov_b32 v112, s57
    v_mov_b32 v113, 0
    s_mov_b32 exec_lo, 0x1
    s_mov_b32 exec_hi, 0x0
    buffer_store_dword v112, v113, s[48:51], s78 offen sc1
    s_mov_b64 exec, -1
nohint_100:
L_fin:
L_end:
    s_endpgm
L_code_end:
.section .rodata,"a"
.p2align 6
.amdhsa_kernel adaLN_cond__compressed_kv_cla__dense_activation_relu__decode_kernel
  .amdhsa_next_free_vgpr 256
  .amdhsa_next_free_sgpr 102
  .amdhsa_accum_offset 256
  .amdhsa_group_segment_fixed_size 0
  .amdhsa_kernarg_size 112
  .amdhsa_user_sgpr_count 2
  .amdhsa_user_sgpr_kernarg_segment_ptr 1
  .amdhsa_system_sgpr_workgroup_id_x 1
.end_amdhsa_kernel
```

```asm
; @launch grid=(256,1,1) block=(512,1,1) lds=163840
.amdgcn_target "amdgcn-amd-amdhsa--gfx950"
.text
.globl adaLN_cond__compressed_kv_cla__dense_activation_relu__decode_kernel
.p2align 8
.type adaLN_cond__compressed_kv_cla__dense_activation_relu__decode_kernel,@function
adaLN_cond__compressed_kv_cla__dense_activation_relu__decode_kernel:
    s_cmp_ge_u32 s2, 256
    s_cbranch_scc1 L_end
    s_load_dwordx2 s[36:37], s[0:1], 72
    s_load_dwordx2 s[40:41], s[0:1], 80
    s_load_dwordx2 s[48:49], s[0:1], 104
    s_load_dwordx2 s[8:9], s[0:1], 8
    s_load_dwordx2 s[4:5], s[0:1], 0
    s_load_dwordx2 s[12:13], s[0:1], 16
    s_load_dwordx2 s[16:17], s[0:1], 24
    v_mov_b32 v3, v0
    v_lshrrev_b32 v4, 6, v0
    v_and_b32 v0, 63, v0
    v_readfirstlane_b32 s56, v4
    v_and_b32 v1, 15, v0
    v_lshrrev_b32 v2, 4, v0
    s_and_b32 s52, s2, 7
    s_lshr_b32 s53, s2, 3
    s_and_b32 s54, s53, 15
    s_lshl_b32 s55, s52, 4
    s_add_u32 s55, s55, s54
    v_lshlrev_b32 v16, 4, v3
    s_mov_b32 s38, 8192
    s_mov_b32 s39, 0x00020000
    s_mov_b32 s42, 3145728
    s_mov_b32 s43, 0x00020000
    s_mov_b32 s50, 15728640
    s_mov_b32 s51, 0x00020000
    s_mov_b32 s6, 8192
    s_mov_b32 s7, 0x00020000
    v_and_b32 v4, 7, v1
    v_lshlrev_b32 v4, 10, v4
    v_lshrrev_b32 v5, 3, v1
    v_lshl_add_u32 v4, v5, 6, v4
    v_lshl_add_u32 v4, v2, 4, v4
    s_cmp_ge_u32 s53, 16
    s_cbranch_scc1 L_att0
    s_cmp_lg_u32 s56, 0
    s_cbranch_scc1 L_svc0
    s_and_b32 s61, s54, 3
    s_lshl_b32 s64, s61, 8
    v_lshrrev_b32 v5, 2, v0
    v_mul_u32_u24 v5, 6144, v5
    v_and_b32 v18, 3, v0
    v_lshrrev_b32 v17, 5, v0
    v_lshlrev_b32 v17, 1, v17
    v_xor_b32 v18, v18, v17
    v_lshl_add_u32 v5, v18, 4, v5
    s_lshr_b32 s66, s55, 2
    s_lshl_b32 s66, s66, 6
    s_mul_i32 s65, s61, 786432
    s_add_u32 s65, s65, s66
    s_mov_b32 m0, 131072
    v_mov_b32 v20, -1
    v_mov_b32 v21, -1
    v_mov_b32 v22, -1
    v_mov_b32 v23, -1
    s_lshl_b32 s68, s52, 18
    s_lshl_b32 s67, s54, 11
    s_add_u32 s68, s68, s67
    s_add_u32 s35, s68, s67
    s_add_u32 s35, s35, 2293760
    s_add_u32 s67, s68, 2097152
    s_mul_i32 s68, s55, 656
    s_add_u32 s68, s68, 32768
    v_add_u32 v17, s68, v16
    s_add_u32 s68, s35, 368
    v_min_u32 v18, 48, v0
    v_lshl_add_u32 v18, v18, 4, s68
    v_cmp_lt_u32 vcc, 40, v0
    s_nop 1
    v_cndmask_b32 v17, v17, v18, vcc
    s_waitcnt lgkmcnt(0)
    s_load_dword s57, s[48:49], 0
    buffer_load_dwordx4 v[40:43], v4, s[36:39], s64 offen
    buffer_load_dwordx4 v[44:47], v4, s[36:39], s64 offen offset:128
    buffer_load_dwordx4 v5, s[40:43], s65 offen  lds
    s_add_u32 s65, s65, 98304
    s_add_u32 m0, m0, 1024
    s_nop 0
    buffer_load_dwordx4 v5, s[40:43], s65 offen  lds
    s_add_u32 s65, s65, 98304
    s_add_u32 m0, m0, 1024
    s_nop 0
    buffer_load_dwordx4 v5, s[40:43], s65 offen  lds
    s_add_u32 s65, s65, 98304
    s_add_u32 m0, m0, 1024
    s_nop 0
    buffer_load_dwordx4 v5, s[40:43], s65 offen  lds
    s_add_u32 s65, s65, 98304
    s_add_u32 m0, m0, 1024
    s_nop 0
    buffer_load_dwordx4 v5, s[40:43], s65 offen  lds
    s_add_u32 s65, s65, 98304
    s_add_u32 m0, m0, 1024
    s_nop 0
    buffer_load_dwordx4 v5, s[40:43], s65 offen  lds
    s_add_u32 s65, s65, 98304
    s_add_u32 m0, m0, 1024
    s_nop 0
    buffer_load_dwordx4 v5, s[40:43], s65 offen  lds
    s_add_u32 s65, s65, 98304
    s_add_u32 m0, m0, 1024
    s_nop 0
    buffer_load_dwordx4 v5, s[40:43], s65 offen  lds
    buffer_store_dwordx4 v[20:23], v16, s[48:51], s67 offen sc1
    buffer_store_dwordx4 v[20:23], v16, s[48:51], s67 offen offset:1024 sc1
    buffer_store_dwordx4 v[20:23], v17, s[48:51], 0 offen sc1
    s_branch L_p1
L_svc0:
    v_lshlrev_b32 v17, 4, v0
    s_waitcnt lgkmcnt(0)
    s_load_dword s57, s[48:49], 0
    buffer_load_dwordx4 v[8:11], v16, s[4:7], 0 offen
    s_cmp_lg_u32 s56, 3
    s_cbranch_scc1 wi_1
    buffer_load_dwordx4 v[40:43], v17, s[4:7], 0 offen
wi_1:
    s_branch L_svc
L_att0:
    s_cmp_ge_u32 s56, 4
    s_cbranch_scc0 L_atq
    s_barrier
    s_barrier
    s_branch L_pv
L_atq:
    s_getpc_b64 s[64:65]
pc_3:
    s_sub_u32 s64, s64, pc_3-adaLN_cond__compressed_kv_cla__dense_activation_relu__decode_kernel
    s_subb_u32 s65, s65, 0
    s_lshl_b32 s66, s56, 4
    s_add_u32 s66, s66, s54
    s_lshl_b32 s66, s66, 10
    s_cmp_ge_u32 s66, L_code_end-adaLN_cond__compressed_kv_cla__dense_activation_relu__decode_kernel
    s_cbranch_scc1 cpf_4
    s_min_u32 s66, s66, L_code_end-adaLN_cond__compressed_kv_cla__dense_activation_relu__decode_kernel-1024
    v_lshl_add_u32 v32, v0, 4, s66
    global_load_dword v64, v32, s[64:65]
cpf_4:
    s_mov_b32 s18, 4194304
    s_mov_b32 s19, 0x00020000
    v_lshrrev_b32 v33, 3, v3
    v_lshlrev_b32 v33, 13, v33
    v_and_b32 v34, 7, v0
    v_lshl_add_u32 v33, v34, 7, v33
    s_lshl_b32 s67, s54, 18
    s_lshl_b32 s68, s52, 10
    s_add_u32 s67, s67, s68
    s_mov_b32 s14, 4194304
    s_mov_b32 s15, 0x00020000
    s_mov_b32 exec_lo, 0xffffffff
    s_mov_b32 exec_hi, 0xffffffff
    s_waitcnt lgkmcnt(0)
    buffer_load_dword v69, v33, s[12:15], s67 offen
    s_mov_b64 exec, -1
    s_barrier
    s_mov_b32 exec_lo, 0xffffffff
    s_mov_b32 exec_hi, 0xffffffff
    buffer_load_dword v68, v33, s[16:19], s67 offen
    s_mov_b64 exec, -1
    s_lshl_b32 s66, s54, 12
    s_lshl_b32 s65, s52, 18
    s_add_u32 s66, s66, s65
    s_add_u32 s66, s66, 2162688
    buffer_load_dword v70, v16, s[48:51], s66 offen sc1
    s_barrier
    s_branch L_qk
L_p1:
    v_lshrrev_b32 v48, 2, v1
    v_lshl_add_u32 v48, v2, 3, v48
    v_lshlrev_b32 v48, 6, v48
    v_and_b32 v50, 3, v1
    v_lshl_add_u32 v48, v50, 3, v48
    v_and_b32 v50, 1, v2
    v_lshl_add_u32 v48, v50, 5, v48
    v_add_u32 v48, 131072, v48
    v_xor_b32 v49, 32, v48
    v_lshlrev_b32 v50, 6, v1
    v_lshl_add_u32 v50, v2, 4, v50
    s_waitcnt vmcnt(11)
    v_lshlrev_b32 v64, 16, v40
    v_and_b32 v65, 0xffff0000, v40
    v_lshlrev_b32 v66, 16, v41
    v_and_b32 v67, 0xffff0000, v41
    v_lshlrev_b32 v68, 16, v42
    v_and_b32 v69, 0xffff0000, v42
    v_lshlrev_b32 v70, 16, v43
    v_and_b32 v71, 0xffff0000, v43
    v_lshlrev_b32 v72, 16, v44
    v_and_b32 v73, 0xffff0000, v44
    v_lshlrev_b32 v74, 16, v45
    v_and_b32 v75, 0xffff0000, v45
    v_lshlrev_b32 v76, 16, v46
    v_and_b32 v77, 0xffff0000, v46
    v_lshlrev_b32 v78, 16, v47
    v_and_b32 v79, 0xffff0000, v47
    v_mul_f32 v80, 0xbfb8aa3b, v64
    v_mul_f32 v81, 0xbfb8aa3b, v65
    v_mul_f32 v82, 0xbfb8aa3b, v66
    v_mul_f32 v83, 0xbfb8aa3b, v67
    v_mul_f32 v84, 0xbfb8aa3b, v68
    v_mul_f32 v85, 0xbfb8aa3b, v69
    v_mul_f32 v86, 0xbfb8aa3b, v70
    v_mul_f32 v87, 0xbfb8aa3b, v71
    v_mul_f32 v88, 0xbfb8aa3b, v72
    v_mul_f32 v89, 0xbfb8aa3b, v73
    v_mul_f32 v90, 0xbfb8aa3b, v74
    v_mul_f32 v91, 0xbfb8aa3b, v75
    v_mul_f32 v92, 0xbfb8aa3b, v76
    v_mul_f32 v93, 0xbfb8aa3b, v77
    v_mul_f32 v94, 0xbfb8aa3b, v78
    v_mul_f32 v95, 0xbfb8aa3b, v79
    v_exp_f32 v80, v80
    v_exp_f32 v81, v81
    v_exp_f32 v82, v82
    v_exp_f32 v83, v83
    v_exp_f32 v84, v84
    v_exp_f32 v85, v85
    v_exp_f32 v86, v86
    v_exp_f32 v87, v87
    v_exp_f32 v88, v88
    v_exp_f32 v89, v89
    v_exp_f32 v90, v90
    v_exp_f32 v91, v91
    v_exp_f32 v92, v92
    v_exp_f32 v93, v93
    v_exp_f32 v94, v94
    v_exp_f32 v95, v95
    v_add_f32 v80, 1.0, v80
    v_add_f32 v81, 1.0, v81
    v_add_f32 v82, 1.0, v82
    v_add_f32 v83, 1.0, v83
    v_add_f32 v84, 1.0, v84
    v_add_f32 v85, 1.0, v85
    v_add_f32 v86, 1.0, v86
    v_add_f32 v87, 1.0, v87
    v_add_f32 v88, 1.0, v88
    v_add_f32 v89, 1.0, v89
    v_add_f32 v90, 1.0, v90
    v_add_f32 v91, 1.0, v91
    v_add_f32 v92, 1.0, v92
    v_add_f32 v93, 1.0, v93
    v_add_f32 v94, 1.0, v94
    v_add_f32 v95, 1.0, v95
    v_rcp_f32 v80, v80
    v_rcp_f32 v81, v81
    v_rcp_f32 v82, v82
    v_rcp_f32 v83, v83
    v_rcp_f32 v84, v84
    v_rcp_f32 v85, v85
    v_rcp_f32 v86, v86
    v_rcp_f32 v87, v87
    v_rcp_f32 v88, v88
    v_rcp_f32 v89, v89
    v_rcp_f32 v90, v90
    v_rcp_f32 v91, v91
    v_rcp_f32 v92, v92
    v_rcp_f32 v93, v93
    v_rcp_f32 v94, v94
    v_rcp_f32 v95, v95
    v_mul_f32 v64, v64, v80
    v_mul_f32 v65, v65, v81
    v_mul_f32 v66, v66, v82
    v_mul_f32 v67, v67, v83
    v_mul_f32 v68, v68, v84
    v_mul_f32 v69, v69, v85
    v_mul_f32 v70, v70, v86
    v_mul_f32 v71, v71, v87
    v_mul_f32 v72, v72, v88
    v_mul_f32 v73, v73, v89
    v_mul_f32 v74, v74, v90
    v_mul_f32 v75, v75, v91
    v_mul_f32 v76, v76, v92
    v_mul_f32 v77, v77, v93
    v_mul_f32 v78, v78, v94
    v_mul_f32 v79, v79, v95
    v_cvt_pk_bf16_f32 v52, v64, v65
    v_cvt_pk_bf16_f32 v53, v66, v67
    v_cvt_pk_bf16_f32 v54, v68, v69
    v_cvt_pk_bf16_f32 v55, v70, v71
    v_cvt_pk_bf16_f32 v56, v72, v73
    v_cvt_pk_bf16_f32 v57, v74, v75
    v_cvt_pk_bf16_f32 v58, v76, v77
    v_cvt_pk_bf16_f32 v59, v78, v79
    s_waitcnt lgkmcnt(0)
    ds_write_b128 v16, v[52:55] offset:45056
    ds_write_b128 v16, v[56:59] offset:46080
    s_mul_i32 s57, s57, 0x9e3779b1
    s_add_u32 s57, s57, 0x7f4a7c15
    s_and_b32 s58, s57, 0xffff
    s_lshr_b32 s59, s57, 16
    s_getreg_b32 s28, hwreg(HW_REG_XCC_ID)
    s_not_b32 s67, s57
    s_xor_b32 s28, s67, s28
    v_bfe_u32 v12, s57, 0, 8
    v_bfe_u32 v13, s57, 8, 8
    v_bfe_u32 v14, s57, 16, 8
    v_bfe_u32 v15, s57, 24, 8
    s_mov_b32 s67, 0xff
    s_waitcnt lgkmcnt(0)
    s_waitcnt vmcnt(9)
    ds_read_b64_tr_b16 v[64:65], v48 offset:0
    ds_read_b64_tr_b16 v[66:67], v48 offset:256
    ds_read_b64_tr_b16 v[68:69], v49 offset:0
    ds_read_b64_tr_b16 v[70:71], v49 offset:256
    s_waitcnt vmcnt(7)
    ds_read_b64_tr_b16 v[72:73], v48 offset:2048
    ds_read_b64_tr_b16 v[74:75], v48 offset:2304
    ds_read_b64_tr_b16 v[76:77], v49 offset:2048
    ds_read_b64_tr_b16 v[78:79], v49 offset:2304
    s_waitcnt vmcnt(5)
    ds_read_b64_tr_b16 v[80:81], v48 offset:4096
    ds_read_b64_tr_b16 v[82:83], v48 offset:4352
    ds_read_b64_tr_b16 v[84:85], v49 offset:4096
    ds_read_b64_tr_b16 v[86:87], v49 offset:4352
    s_waitcnt vmcnt(3)
    ds_read_b64_tr_b16 v[88:89], v48 offset:6144
    ds_read_b64_tr_b16 v[90:91], v48 offset:6400
    ds_read_b64_tr_b16 v[92:93], v49 offset:6144
    ds_read_b64_tr_b16 v[94:95], v49 offset:6400
    s_waitcnt lgkmcnt(14)
    v_mfma_f32_16x16x32_bf16 v[96:99], v[64:67], v[52:55], 0
    s_waitcnt lgkmcnt(12)
    v_mfma_f32_16x16x32_bf16 v[104:107], v[68:71], v[52:55], 0
    s_waitcnt lgkmcnt(10)
    v_mfma_f32_16x16x32_bf16 v[100:103], v[72:75], v[52:55], 0
    s_waitcnt lgkmcnt(8)
    v_mfma_f32_16x16x32_bf16 v[108:111], v[76:79], v[52:55], 0
    s_waitcnt lgkmcnt(6)
    v_mfma_f32_16x16x32_bf16 v[96:99], v[80:83], v[56:59], v[96:99]
    s_waitcnt lgkmcnt(4)
    v_mfma_f32_16x16x32_bf16 v[104:107], v[84:87], v[56:59], v[104:107]
    s_waitcnt lgkmcnt(2)
    v_mfma_f32_16x16x32_bf16 v[100:103], v[88:91], v[56:59], v[100:103]
    s_waitcnt lgkmcnt(0)
    v_mfma_f32_16x16x32_bf16 v[108:111], v[92:95], v[56:59], v[108:111]
    s_nop 5
    v_add_f32_dpp v112, v100, v96 row_ror:8 row_mask:0xf bank_mask:0x3
    v_add_f32_dpp v113, v101, v97 row_ror:8 row_mask:0xf bank_mask:0x3
    v_add_f32_dpp v114, v102, v98 row_ror:8 row_mask:0xf bank_mask:0x3
    v_add_f32_dpp v115, v103, v99 row_ror:8 row_mask:0xf bank_mask:0x3
    v_add_f32_dpp v112, v104, v108 row_ror:8 row_mask:0xf bank_mask:0xc
    v_add_f32_dpp v113, v105, v109 row_ror:8 row_mask:0xf bank_mask:0xc
    v_add_f32_dpp v114, v106, v110 row_ror:8 row_mask:0xf bank_mask:0xc
    v_add_f32_dpp v115, v107, v111 row_ror:8 row_mask:0xf bank_mask:0xc
    v_bfi_b32 v112, s67, v12, v112
    v_bfi_b32 v113, s67, v13, v113
    v_bfi_b32 v114, s67, v14, v114
    v_bfi_b32 v115, s67, v15, v115
    s_waitcnt vmcnt(0)
    buffer_store_dwordx4 v[112:115], v50, s[48:51], s35 offen sc1
    v_mov_b32 v60, s57
    s_mov_b32 exec_lo, 0x1
    s_mov_b32 exec_hi, 0x0
    buffer_store_dword v60, v16, s[48:51], s35 offen offset:1024 sc1
    s_mov_b64 exec, -1
    s_barrier
L_svc:
    s_load_dwordx2 s[20:21], s[0:1], 32
    s_load_dwordx2 s[24:25], s[0:1], 40
    s_load_dwordx2 s[44:45], s[0:1], 88
    s_mov_b32 s22, 4194304
    s_mov_b32 s23, 0x00020000
    s_mov_b32 s26, 4194304
    s_mov_b32 s27, 0x00020000
    s_mov_b32 s46, 8192
    s_mov_b32 s47, 0x00020000
    s_mov_b32 s18, 4194304
    s_mov_b32 s19, 0x00020000
    s_mov_b32 s10, 33554432
    s_mov_b32 s11, 0x00020000
    s_lshr_b32 s60, s55, 2
    s_and_b32 s61, s54, 3
    v_lshlrev_b32 v29, 13, v2
    s_and_b32 s69, s56, 3
    s_lshl_b32 s67, s61, 20
    s_lshl_b32 s68, s69, 18
    s_add_u32 s67, s67, s68
    s_lshl_b32 s68, s60, 8
    s_add_u32 s67, s67, s68
    s_lshl_b32 s68, s69, 13
    s_mul_i32 s72, s52, 196608
    s_mul_i32 s73, s52, 229376
    s_mov_b32 s76, 0x05040100
    s_mov_b32 s77, 0x07060302
    v_lshrrev_b32 v17, 2, v1
    v_and_b32 v38, 3, v1
    v_lshl_add_u32 v28, v2, 3, v17
    v_lshlrev_b32 v36, 8, v28
    v_lshl_add_u32 v36, v38, 3, v36
    v_lshlrev_b32 v5, 7, v28
    v_lshl_add_u32 v5, v38, 3, v5
    v_bfe_u32 v28, v1, 3, 1
    v_lshl_add_u32 v5, v28, 5, v5
    v_and_b32 v37, 1, v2
    v_lshl_add_u32 v5, v37, 6, v5
    v_and_b32 v19, 7, v1
    v_lshlrev_b32 v95, 1, v37
    v_xor_b32 v95, v95, v19
    v_lshlrev_b32 v95, 4, v95
    v_lshl_add_u32 v37, v37, 2, v17
    v_xor_b32 v37, s56, v37
    v_lshl_add_u32 v36, v37, 5, v36
    s_lshl_b32 s66, s56, 5
    v_bfe_u32 v28, v0, 2, 3
    v_and_b32 v21, 3, v0
    v_lshrrev_b32 v22, 5, v0
    v_lshl_add_u32 v22, v21, 1, v22
    v_mul_u32_u24 v20, 272, v28
    v_lshl_add_u32 v20, v22, 2, v20
    v_add_u32 v20, s66, v20
    v_lshlrev_b32 v24, 10, v28
    v_lshl_add_u32 v24, v22, 2, v24
    s_lshl_b32 s64, s61, 8
    s_add_u32 s64, s64, s66
    v_add_u32 v21, s64, v24
    v_mul_u32_u24 v22, 272, v19
    v_lshrrev_b32 v28, 3, v1
    v_lshl_add_u32 v22, v28, 6, v22
    v_lshl_add_u32 v22, v2, 4, v22
    v_lshlrev_b32 v17, 3, v0
    v_lshlrev_b32 v23, 6, v19
    v_lshl_add_u32 v23, v2, 4, v23
    v_and_b32 v26, 31, v0
    v_lshlrev_b32 v26, 4, v26
    v_lshrrev_b32 v28, 5, v0
    v_lshl_add_u32 v39, v28, 12, v26
    v_lshl_add_u32 v26, v28, 12, v26
    v_add_u32 v27, 8192, v26
    v_lshrrev_b32 v32, 3, v0
    v_mul_u32_u24 v32, 6144, v32
    v_add_u32 v32, v32, v95
    v_xor_b32 v33, 64, v32
    s_lshl_b32 s64, s61, 2
    s_add_u32 s64, s64, s69
    s_mul_i32 s33, s64, 196608
    s_lshl_b32 s64, s60, 7
    s_add_u32 s33, s33, s64
    s_add_u32 s33, s33, 2048
    s_lshl_b32 s34, s69, 12
    s_add_u32 s34, s34, 139264
    s_lshl_b32 s64, s61, 18
    s_lshr_b32 s65, s56, 1
    s_lshl_b32 s65, s65, 14
    s_add_u32 s64, s64, s65
    s_and_b32 s65, s56, 1
    s_lshl_b32 s65, s65, 9
    s_add_u32 s64, s64, s65
    s_add_u32 s30, s64, 2293760
    s_add_u32 s31, s30, 1048576
    v_lshlrev_b32 v34, 7, v2
    s_lshl_b32 s29, s60, 9
    s_add_u32 s29, s29, 4096
    s_cmp_eq_u32 s56, 0
    s_cbranch_scc1 L_svc4
    s_waitcnt vmcnt(0)
    v_mov_b32 v44, v16
    s_cmp_eq_u32 s56, 3
    s_cselect_b32 s68, 1, 0
L_ln:
    v_lshlrev_b32 v96, 16, v8
    v_and_b32 v97, 0xffff0000, v8
    v_lshlrev_b32 v98, 16, v9
    v_and_b32 v99, 0xffff0000, v9
    v_lshlrev_b32 v100, 16, v10
    v_and_b32 v101, 0xffff0000, v10
    v_lshlrev_b32 v102, 16, v11
    v_and_b32 v103, 0xffff0000, v11
    v_readfirstlane_b32 s64, v96
    s_nop 1
    v_subrev_f32 v72, s64, v96
    v_subrev_f32 v73, s64, v97
    v_subrev_f32 v74, s64, v98
    v_subrev_f32 v75, s64, v99
    v_subrev_f32 v76, s64, v100
    v_subrev_f32 v77, s64, v101
    v_subrev_f32 v78, s64, v102
    v_subrev_f32 v79, s64, v103
    v_add_f32 v80, v72, v73
    v_mul_f32 v81, v72, v72
    v_fmac_f32 v81, v73, v73
    v_add_f32 v80, v80, v74
    v_fmac_f32 v81, v74, v74
    v_add_f32 v80, v80, v75
    v_fmac_f32 v81, v75, v75
    v_add_f32 v80, v80, v76
    v_fmac_f32 v81, v76, v76
    v_add_f32 v80, v80, v77
    v_fmac_f32 v81, v77, v77
    v_add_f32 v80, v80, v78
    v_fmac_f32 v81, v78, v78
    v_add_f32 v80, v80, v79
    v_fmac_f32 v81, v79, v79
    s_nop 0
    v_add_f32_dpp v80, v80, v80 row_ror:8 row_mask:0xf bank_mask:0xf
    v_add_f32_dpp v81, v81, v81 row_ror:8 row_mask:0xf bank_mask:0xf
    s_nop 0
    v_add_f32_dpp v80, v80, v80 row_ror:4 row_mask:0xf bank_mask:0xf
    v_add_f32_dpp v81, v81, v81 row_ror:4 row_mask:0xf bank_mask:0xf
    s_nop 0
    v_add_f32_dpp v80, v80, v80 row_ror:2 row_mask:0xf bank_mask:0xf
    v_add_f32_dpp v81, v81, v81 row_ror:2 row_mask:0xf bank_mask:0xf
    s_nop 0
    v_add_f32_dpp v80, v80, v80 row_ror:1 row_mask:0xf bank_mask:0xf
    v_add_f32_dpp v81, v81, v81 row_ror:1 row_mask:0xf bank_mask:0xf
    s_nop 0
    v_add_f32_dpp v80, v80, v80 row_bcast:15 row_mask:0xa bank_mask:0xf
    v_add_f32_dpp v81, v81, v81 row_bcast:15 row_mask:0xa bank_mask:0xf
    s_nop 0
    v_add_f32_dpp v80, v80, v80 row_bcast:31 row_mask:0xc bank_mask:0xf
    v_add_f32_dpp v81, v81, v81 row_bcast:31 row_mask:0xc bank_mask:0xf
    v_readlane_b32 s65, v80, 63
    v_readlane_b32 s66, v81, 63
    v_mov_b32 v72, 0x3b000000
    v_mul_f32 v73, s65, v72
    v_mul_f32 v74, s66, v72
    v_fma_f32 v74, -v73, v73, v74
    v_max_f32 v74, 0, v74
    v_add_f32 v73, s64, v73
    v_cvt_pk_bf16_f32 v73, 0, v73
    v_cvt_pk_bf16_f32 v74, 0, v74
    v_add_f32 v74, 0x3727c5ac, v74
    v_cvt_pk_bf16_f32 v74, 0, v74
    v_sqrt_f32 v74, v74
    v_sub_f32 v96, v96, v73
    v_sub_f32 v97, v97, v73
    v_sub_f32 v98, v98, v73
    v_sub_f32 v99, v99, v73
    v_sub_f32 v100, v100, v73
    v_sub_f32 v101, v101, v73
    v_sub_f32 v102, v102, v73
    v_sub_f32 v103, v103, v73
    v_cvt_pk_bf16_f32 v74, 0, v74
    v_rcp_f32 v74, v74
    v_cvt_pk_bf16_f32 v96, 0, v96
    v_cvt_pk_bf16_f32 v97, 0, v97
    v_cvt_pk_bf16_f32 v98, 0, v98
    v_cvt_pk_bf16_f32 v99, 0, v99
    v_cvt_pk_bf16_f32 v100, 0, v100
    v_cvt_pk_bf16_f32 v101, 0, v101
    v_cvt_pk_bf16_f32 v102, 0, v102
    v_cvt_pk_bf16_f32 v103, 0, v103
    v_mul_f32 v96, v96, v74
    v_mul_f32 v97, v97, v74
    v_mul_f32 v98, v98, v74
    v_mul_f32 v99, v99, v74
    v_mul_f32 v100, v100, v74
    v_mul_f32 v101, v101, v74
    v_mul_f32 v102, v102, v74
    v_mul_f32 v103, v103, v74
    v_cvt_pk_bf16_f32 v84, v96, v97
    v_cvt_pk_bf16_f32 v85, v98, v99
    v_cvt_pk_bf16_f32 v86, v100, v101
    v_cvt_pk_bf16_f32 v87, v102, v103
    ds_write_b128 v44, v[84:87] offset:32768
    v_mov_b32 v8, v40
    v_mov_b32 v9, v41
    v_mov_b32 v10, v42
    v_mov_b32 v11, v43
    v_lshlrev_b32 v44, 4, v0
    s_sub_u32 s68, s68, 1
    s_cbranch_scc0 L_ln
    s_waitcnt lgkmcnt(0)
    s_mul_i32 s57, s57, 0x9e3779b1
    s_add_u32 s57, s57, 0x7f4a7c15
    s_and_b32 s58, s57, 0xffff
    s_lshr_b32 s59, s57, 16
    s_getreg_b32 s28, hwreg(HW_REG_XCC_ID)
    s_not_b32 s67, s57
    s_xor_b32 s28, s67, s28
    v_bfe_u32 v12, s57, 0, 8
    v_bfe_u32 v13, s57, 8, 8
    v_bfe_u32 v14, s57, 16, 8
    v_bfe_u32 v15, s57, 24, 8
    s_cmp_lt_u32 s56, 4
    s_cbranch_scc1 L_svc3
    s_mov_b32 s14, 4194304
    s_mov_b32 s15, 0x00020000
    s_lshr_b32 s60, s55, 2
    s_and_b32 s61, s54, 3
    v_lshlrev_b32 v29, 13, v2
    s_and_b32 s69, s56, 3
    s_lshl_b32 s67, s61, 20
    s_lshl_b32 s68, s69, 18
    s_add_u32 s67, s67, s68
    s_lshl_b32 s68, s60, 8
    s_add_u32 s67, s67, s68
    s_lshl_b32 s68, s69, 13
    v_lshlrev_b32 v30, 1, v2
    v_xor_b32 v30, v30, v1
    v_lshl_add_u32 v30, v30, 4, v29
    v_xor_b32 v31, 128, v30
    s_barrier
    s_add_u32 s64, s67, 0
    s_add_u32 m0, s68, 98304
    s_nop 0
    buffer_load_dwordx4 v30, s[12:15], s64 offen nt lds
    s_add_u32 s64, s67, 32768
    s_add_u32 m0, s68, 99328
    s_nop 0
    buffer_load_dwordx4 v30, s[12:15], s64 offen nt lds
    s_add_u32 s64, s67, 65536
    s_add_u32 m0, s68, 100352
    s_nop 0
    buffer_load_dwordx4 v31, s[12:15], s64 offen nt lds
    s_add_u32 s64, s67, 98304
    s_add_u32 m0, s68, 101376
    s_nop 0
    buffer_load_dwordx4 v31, s[12:15], s64 offen nt lds
    s_add_u32 s64, s67, 131072
    s_add_u32 m0, s68, 102400
    s_nop 0
    buffer_load_dwordx4 v30, s[12:15], s64 offen nt lds
    s_add_u32 s64, s67, 163840
    s_add_u32 m0, s68, 103424
    s_nop 0
    buffer_load_dwordx4 v30, s[12:15], s64 offen nt lds
    s_add_u32 s64, s67, 196608
    s_add_u32 m0, s68, 104448
    s_nop 0
    buffer_load_dwordx4 v31, s[12:15], s64 offen nt lds
    s_add_u32 s64, s67, 229376
    s_add_u32 m0, s68, 105472
    s_nop 0
    buffer_load_dwordx4 v31, s[12:15], s64 offen nt lds
    v_xor_b32 v30, v1, v2
    v_lshl_add_u32 v30, v30, 4, v29
    v_xor_b32 v31, 0, v30
    s_add_u32 s64, s67, 0
    s_add_u32 m0, s68, 0
    s_nop 0
    buffer_load_dwordx4 v31, s[16:19], s64 offen nt lds
    s_add_u32 s64, s67, 32768
    s_add_u32 m0, s68, 1024
    s_nop 0
    buffer_load_dwordx4 v31, s[16:19], s64 offen nt lds
    v_xor_b32 v31, 64, v30
    s_add_u32 s64, s67, 65536
    s_add_u32 m0, s68, 2048
    s_nop 0
    buffer_load_dwordx4 v31, s[16:19], s64 offen nt lds
    s_add_u32 s64, s67, 98304
    s_add_u32 m0, s68, 3072
    s_nop 0
    buffer_load_dwordx4 v31, s[16:19], s64 offen nt lds
    v_xor_b32 v31, 128, v30
    s_add_u32 s64, s67, 131072
    s_add_u32 m0, s68, 4096
    s_nop 0
    buffer_load_dwordx4 v31, s[16:19], s64 offen nt lds
    s_add_u32 s64, s67, 163840
    s_add_u32 m0, s68, 5120
    s_nop 0
    buffer_load_dwordx4 v31, s[16:19], s64 offen nt lds
    v_xor_b32 v31, 192, v30
    s_add_u32 s64, s67, 196608
    s_add_u32 m0, s68, 6144
    s_nop 0
    buffer_load_dwordx4 v31, s[16:19], s64 offen nt lds
    s_add_u32 s64, s67, 229376
    s_add_u32 m0, s68, 7168
    s_nop 0
    buffer_load_dwordx4 v31, s[16:19], s64 offen nt lds
    s_branch L_svc4
L_svc3:
    v_mov_b32 v68, -1
    v_mov_b32 v69, -1
    v_mov_b32 v70, -1
    v_mov_b32 v71, -1
    s_mul_i32 s66, s55, 768
    s_add_u32 s66, s66, 113664
    s_lshl_b32 s67, s55, 11
    s_add_u32 s67, s67, s73
    s_add_u32 s67, s67, 2128896
    s_cmp_eq_u32 s56, 3
    s_cselect_b32 s67, s66, s67
    v_min_u32 v30, 3824, v16
    buffer_store_dwordx4 v[68:71], v30, s[48:51], s67 offen sc1
    s_cmp_lg_u32 s56, 1
    s_cbranch_scc1 wi_5
    v_mov_b32 v66, s57
    v_mov_b32 v67, s28
    s_lshl_b32 s68, s55, 7
    s_add_u32 s68, s68, 4096
    s_mov_b32 exec_lo, 0xffff
    s_mov_b32 exec_hi, 0x0
    buffer_store_dwordx2 v[66:67], v17, s[48:51], s68 offen sc1
    s_mov_b64 exec, -1
wi_5:
    s_and_b32 s66, s56, 1
    s_lshl_b32 s66, s66, 2
    s_add_u32 s66, s66, s61
    s_lshl_b32 s66, s66, 6
    s_and_b32 s67, s60, 15
    s_add_u32 s66, s66, s67
    s_lshl_b32 s66, s66, 12
    s_add_u32 s66, s66, 2294784
    s_barrier
    s_cmp_eq_u32 s56, 3
    s_cbranch_scc1 L_svc4
    s_mov_b32 s63, 60000
hw_7:
    s_load_dword s67, s[48:49], s66 glc
    s_waitcnt lgkmcnt(0)
    s_cmp_eq_u32 s67, s57
    s_cbranch_scc1 hd_8
    s_sub_u32 s63, s63, 1
    s_cbranch_scc0 hw_7
hd_8:
L_svc4:
    s_waitcnt lgkmcnt(0)
    s_barrier
    buffer_load_dwordx4 v[68:71], v26, s[48:51], s31 offen sc1
    buffer_load_dwordx4 v[76:79], v27, s[48:51], s31 offen sc1
    buffer_load_dwordx4 v[64:67], v26, s[48:51], s30 offen sc1
    buffer_load_dwordx4 v[72:75], v27, s[48:51], s30 offen sc1
    buffer_load_dwordx2 v[90:91], v34, s[48:51], s29 offen sc1
    s_cmp_lt_u32 s56, 4
    s_cbranch_scc1 wi_9
    s_waitcnt vmcnt(13)
wi_9:
    s_barrier
    ds_read_b32 v84, v21 offset:32768
    v_add_u32 v30, 98304, v36
    ds_read_b64_tr_b16 v[96:97], v30 offset:0
    ds_read_b64_tr_b16 v[98:99], v30 offset:1024
    ds_read_b64_tr_b16 v[100:101], v30 offset:8192
    ds_read_b64_tr_b16 v[102:103], v30 offset:9216
    ds_read_b64_tr_b16 v[104:105], v30 offset:16384
    ds_read_b64_tr_b16 v[106:107], v30 offset:17408
    ds_read_b64_tr_b16 v[108:109], v30 offset:24576
    ds_read_b64_tr_b16 v[110:111], v30 offset:25600
    s_lshl_b32 s66, s55, 12
    s_lshl_b32 s67, s56, 9
    s_add_u32 s66, s66, s67
    s_add_u32 s66, s66, s72
    s_add_u32 s66, s66, 2162688
    s_mov_b32 s68, 0xff
    s_waitcnt lgkmcnt(8)
    v_lshlrev_b32 v88, 16, v84
    v_and_b32 v89, 0xffff0000, v84
    s_mov_b32 s63, 60000
    s_waitcnt vmcnt(0)
poll_11:
    v_xor_b32 v64, v64, v12
    v_xor_b32 v65, v65, v13
    v_xor_b32 v66, v66, v14
    v_xor_b32 v67, v67, v15
    v_xor_b32 v68, v68, v12
    v_xor_b32 v69, v69, v13
    v_xor_b32 v70, v70, v14
    v_xor_b32 v71, v71, v15
    v_xor_b32 v72, v72, v12
    v_xor_b32 v73, v73, v13
    v_xor_b32 v74, v74, v14
    v_xor_b32 v75, v75, v15
    v_xor_b32 v76, v76, v12
    v_xor_b32 v77, v77, v13
    v_xor_b32 v78, v78, v14
    v_xor_b32 v79, v79, v15
    v_or3_b32 v80, v64, v65, v66
    v_or3_b32 v81, v67, v68, v69
    v_or3_b32 v80, v80, v70, v71
    v_or3_b32 v81, v81, v72, v73
    v_or3_b32 v80, v80, v74, v75
    v_or3_b32 v81, v81, v76, v77
    v_or3_b32 v80, v80, v78, v79
    v_or_b32 v80, v80, v81
    v_and_b32 v80, 0xff, v80
    v_cmp_ne_u32 vcc, 0, v80
    s_cbranch_vccz pdone_12
    s_sleep 1
    buffer_load_dwordx4 v[68:71], v26, s[48:51], s31 offen sc1
    buffer_load_dwordx4 v[76:79], v27, s[48:51], s31 offen sc1
    buffer_load_dwordx4 v[64:67], v26, s[48:51], s30 offen sc1
    buffer_load_dwordx4 v[72:75], v27, s[48:51], s30 offen sc1
    s_sub_u32 s63, s63, 1
    s_waitcnt vmcnt(0)
    s_cbranch_scc0 poll_11
pdone_12:
    v_add_f32 v68, v68, v76
    v_add_f32 v69, v69, v77
    v_add_f32 v70, v70, v78
    v_add_f32 v71, v71, v79
    v_add_f32 v64, v64, v72
    v_add_f32 v65, v65, v73
    v_add_f32 v66, v66, v74
    v_add_f32 v67, v67, v75
    v_permlane32_swap_b32 v68, v70
    v_permlane32_swap_b32 v69, v71
    v_permlane32_swap_b32 v64, v66
    v_permlane32_swap_b32 v65, v67
    v_add_f32 v68, v68, v70
    v_add_f32 v69, v69, v71
    v_add_f32 v64, v64, v66
    v_add_f32 v65, v65, v67
    v_cvt_pk_bf16_f32 v68, 0, v68
    v_cvt_pk_bf16_f32 v69, 0, v69
    v_cvt_pk_bf16_f32 v64, 0, v64
    v_cvt_pk_bf16_f32 v65, 0, v65
    v_add_f32 v68, 1.0, v68
    v_add_f32 v69, 1.0, v69
    v_cvt_pk_bf16_f32 v68, 0, v68
    v_cvt_pk_bf16_f32 v69, 0, v69
    v_mul_f32 v68, v68, v88
    v_mul_f32 v69, v69, v89
    v_cvt_pk_bf16_f32 v68, 0, v68
    v_cvt_pk_bf16_f32 v69, 0, v69
    v_add_f32 v68, v68, v64
    v_add_f32 v69, v69, v65
    v_cvt_pk_bf16_f32 v68, v68, v69
    ds_write_b32 v20, v68 offset:49152
    s_waitcnt lgkmcnt(0)
    s_barrier
    ds_read_b128 v[64:67], v22 offset:49152
    ds_read_b128 v[68:71], v22 offset:49280
    v_xor_b32 v90, s57, v90
    v_xor_b32 v91, s28, v91
    v_or_b32 v90, v90, v91
    v_cmp_ne_u32 vcc, 0, v90
    s_lshl_b32 s64, s60, 14
    s_add_u32 s64, s64, s67
    s_add_u32 s64, s64, s72
    s_add_u32 s64, s64, 2162688
    s_add_u32 s65, s64, 8192
    s_waitcnt lgkmcnt(1)
    v_mfma_f32_16x16x32_bf16 v[112:115], v[96:99], v[64:67], 0
    v_mfma_f32_16x16x32_bf16 v[116:119], v[100:103], v[64:67], 0
    s_waitcnt lgkmcnt(0)
    v_mfma_f32_16x16x32_bf16 v[112:115], v[104:107], v[68:71], v[112:115]
    v_mfma_f32_16x16x32_bf16 v[116:119], v[108:111], v[68:71], v[116:119]
    s_nop 7
    v_add_f32_dpp v112, v116, v112 row_ror:8 row_mask:0xf bank_mask:0xf
    v_add_f32_dpp v113, v117, v113 row_ror:8 row_mask:0xf bank_mask:0xf
    v_add_f32_dpp v114, v118, v114 row_ror:8 row_mask:0xf bank_mask:0xf
    v_add_f32_dpp v115, v119, v115 row_ror:8 row_mask:0xf bank_mask:0xf
    v_bfi_b32 v112, s68, v12, v112
    v_bfi_b32 v113, s68, v13, v113
    v_bfi_b32 v114, s68, v14, v114
    v_bfi_b32 v115, s68, v15, v115
    s_mov_b32 exec_lo, 0xff00ff
    s_mov_b32 exec_hi, 0xff00ff
    s_cbranch_vccnz far_13
    buffer_store_dwordx4 v[112:115], v23, s[48:51], s66 offen
    s_branch dn_14
far_13:
    buffer_store_dwordx4 v[112:115], v23, s[48:51], s66 offen sc1
dn_14:
    s_mov_b64 exec, -1
    s_cmp_ge_u32 s56, 4
    s_cbranch_scc1 wi_15
    v_lshrrev_b32 v40, 2, v1
    v_lshl_add_u32 v40, v40, 3, v38
    v_lshlrev_b32 v40, 8, v40
    s_lshl_b32 s69, s56, 13
    v_add_u32 v40, s69, v40
    v_xor_b32 v41, v1, v2
    v_lshlrev_b32 v30, 18, v19
    v_lshl_add_u32 v30, v2, 4, v30
    s_lshr_b32 s69, s60, 4
    s_lshl_b32 s69, s69, 14
    s_lshl_b32 s66, s61, 12
    s_add_u32 s69, s69, s66
    s_lshl_b32 s66, s56, 10
    s_add_u32 s69, s69, s66
    s_and_b32 s66, s60, 15
    s_lshl_b32 s66, s66, 6
    s_add_u32 s69, s69, s66
    s_add_u32 s69, s69, 2097152
    v_xor_b32 v42, 0, v41
    v_lshl_add_u32 v42, v42, 4, v40
    ds_read_b128 v[128:131], v42 offset:0
    ds_read_b128 v[144:147], v42 offset:1024
    v_xor_b32 v42, 4, v41
    v_lshl_add_u32 v42, v42, 4, v40
    ds_read_b128 v[132:135], v42 offset:0
    ds_read_b128 v[148:151], v42 offset:1024
    v_xor_b32 v42, 8, v41
    v_lshl_add_u32 v42, v42, 4, v40
    ds_read_b128 v[136:139], v42 offset:0
    ds_read_b128 v[152:155], v42 offset:1024
    v_xor_b32 v42, 12, v41
    v_lshl_add_u32 v42, v42, 4, v40
    ds_read_b128 v[140:143], v42 offset:0
    ds_read_b128 v[156:159], v42 offset:1024
    s_branch wd_16
wi_15:
    v_lshlrev_b32 v40, 4, v0
    ds_read_b128 v[128:131], v40 offset:45056
    ds_read_b128 v[132:135], v40 offset:46080
    s_and_b32 s69, s56, 3
    s_lshl_b32 s66, s69, 5
    v_xor_b32 v41, s66, v5
    v_add_u32 v41, 139264, v41
    s_lshl_b32 s69, s69, 9
    s_lshl_b32 s66, s55, 12
    s_add_u32 s69, s69, s66
    s_add_u32 s69, s69, s72
    s_add_u32 s69, s69, 2228224
wd_16:
    s_mov_b32 s63, 60000
    buffer_load_dwordx4 v[64:67], v39, s[48:51], s64 offen sc1
    buffer_load_dwordx4 v[68:71], v39, s[48:51], s65 offen sc1
    s_waitcnt vmcnt(0)
poll_17:
    v_xor_b32 v64, v64, v12
    v_xor_b32 v65, v65, v13
    v_xor_b32 v66, v66, v14
    v_xor_b32 v67, v67, v15
    v_xor_b32 v68, v68, v12
    v_xor_b32 v69, v69, v13
    v_xor_b32 v70, v70, v14
    v_xor_b32 v71, v71, v15
    v_or3_b32 v72, v64, v65, v66
    v_or3_b32 v73, v67, v68, v69
    v_or3_b32 v72, v72, v70, v71
    v_or_b32 v72, v72, v73
    v_and_b32 v72, 0xff, v72
    v_cmp_ne_u32 vcc, 0, v72
    s_cbranch_vccz pdone_18
    buffer_load_dwordx4 v[64:67], v39, s[48:51], s64 offen sc1
    buffer_load_dwordx4 v[68:71], v39, s[48:51], s65 offen sc1
    s_sub_u32 s63, s63, 1
    s_waitcnt vmcnt(0)
    s_cbranch_scc0 poll_17
pdone_18:
    v_add_f32 v64, v64, v68
    v_add_f32 v65, v65, v69
    v_add_f32 v66, v66, v70
    v_add_f32 v67, v67, v71
    s_nop 0
    v_permlane32_swap_b32 v64, v66
    v_permlane32_swap_b32 v65, v67
    v_add_f32 v64, v64, v66
    v_add_f32 v65, v65, v67
    v_cvt_pk_bf16_f32 v64, v64, v65
    ds_write_b32 v20, v64 offset:53248
    s_waitcnt lgkmcnt(0)
    s_barrier
    s_cmp_ge_u32 s56, 4
    s_cbranch_scc1 wi_19
    ds_read_b128 v[64:67], v22 offset:53248
    ds_read_b128 v[68:71], v22 offset:53376
    s_waitcnt lgkmcnt(0)
    v_mfma_f32_16x16x32_bf16 v[96:99], v[128:131], v[64:67], 0
    v_mfma_f32_16x16x32_bf16 v[100:103], v[132:135], v[64:67], 0
    v_mfma_f32_16x16x32_bf16 v[104:107], v[144:147], v[64:67], 0
    v_mfma_f32_16x16x32_bf16 v[108:111], v[148:151], v[64:67], 0
    v_mfma_f32_16x16x32_bf16 v[96:99], v[136:139], v[68:71], v[96:99]
    v_mfma_f32_16x16x32_bf16 v[100:103], v[140:143], v[68:71], v[100:103]
    v_mfma_f32_16x16x32_bf16 v[104:107], v[152:155], v[68:71], v[104:107]
    v_mfma_f32_16x16x32_bf16 v[108:111], v[156:159], v[68:71], v[108:111]
    s_nop 5
    v_add_f32_dpp v96, v100, v96 row_ror:8 row_mask:0xf bank_mask:0xf
    v_add_f32_dpp v97, v101, v97 row_ror:8 row_mask:0xf bank_mask:0xf
    v_add_f32_dpp v98, v102, v98 row_ror:8 row_mask:0xf bank_mask:0xf
    v_add_f32_dpp v99, v103, v99 row_ror:8 row_mask:0xf bank_mask:0xf
    v_add_f32_dpp v104, v108, v104 row_ror:8 row_mask:0xf bank_mask:0xf
    v_add_f32_dpp v105, v109, v105 row_ror:8 row_mask:0xf bank_mask:0xf
    v_add_f32_dpp v106, v110, v106 row_ror:8 row_mask:0xf bank_mask:0xf
    v_add_f32_dpp v107, v111, v107 row_ror:8 row_mask:0xf bank_mask:0xf
    v_cvt_pk_bf16_f32 v72, v96, v97
    v_cvt_pk_bf16_f32 v73, v98, v99
    v_cvt_pk_bf16_f32 v74, v104, v105
    v_cvt_pk_bf16_f32 v75, v106, v107
    s_mov_b32 exec_lo, 0xff00ff
    s_mov_b32 exec_hi, 0xff00ff
    buffer_store_dwordx4 v[72:75], v30, s[48:51], s69 offen sc1
    s_mov_b64 exec, -1
    s_barrier
    s_cmp_lg_u32 s56, 3
    s_cbranch_scc1 noflg_21
    v_mov_b32 v76, s57
    v_not_b32 v77, v76
    s_lshl_b32 s67, s54, 7
    s_lshl_b32 s66, s52, 3
    s_add_u32 s67, s67, s66
    v_lshlrev_b32 v78, 11, v0
    s_mov_b32 exec_lo, 0xff
    s_mov_b32 exec_hi, 0x0
    s_add_u32 s67, s67, 98304
    buffer_store_dwordx2 v[76:77], v78, s[48:51], s67 offen sc1
    s_mov_b64 exec, -1
noflg_21:
    s_branch wd_20
wi_19:
    s_barrier
    s_add_u32 s64, s33, 0
    s_add_u32 m0, s34, 0
    s_nop 0
    buffer_load_dwordx4 v32, s[40:43], s64 offen nt lds
    s_add_u32 s64, s33, 49152
    s_add_u32 m0, s34, 1024
    s_nop 0
    buffer_load_dwordx4 v33, s[40:43], s64 offen nt lds
    s_add_u32 s64, s33, 98304
    s_add_u32 m0, s34, 2048
    s_nop 0
    buffer_load_dwordx4 v32, s[40:43], s64 offen nt lds
    s_add_u32 s64, s33, 147456
    s_add_u32 m0, s34, 3072
    s_nop 0
    buffer_load_dwordx4 v33, s[40:43], s64 offen nt lds
    s_mov_b32 s35, s69
wd_20:
    v_and_b32 v30, 1, v0
    v_lshlrev_b32 v30, 7, v30
    s_lshl_b32 s69, s52, 11
    s_lshl_b32 s66, s56, 8
    s_add_u32 s69, s69, s66
    s_add_u32 s69, s69, 4096
    v_bfe_u32 v37, v1, 2, 1
    v_lshlrev_b32 v37, 12, v37
    v_lshl_add_u32 v37, v38, 5, v37
    v_lshl_add_u32 v37, v2, 3, v37
    s_lshl_b32 s32, s60, 13
    s_lshl_b32 s66, s61, 10
    s_add_u32 s32, s32, s66
    s_lshl_b32 s66, s56, 7
    s_add_u32 s32, s32, s66
    s_add_u32 s32, s32, s73
    s_add_u32 s32, s32, 2129920
    s_lshl_b32 s64, s60, 14
    s_lshl_b32 s65, s61, 9
    s_add_u32 s64, s64, s65
    s_add_u32 s64, s64, s72
    s_add_u32 s64, s64, 2228224
    s_add_u32 s65, s64, 8192
    s_mul_i32 s66, s56, 56
    s_lshl_b32 s67, s52, 22
    s_add_u32 s33, s66, 1152
    v_add_u32 v119, s33, v0
    v_lshrrev_b32 v115, 8, v119
    v_mul_u32_u24 v115, 1, v115
    v_add_u32 v115, s54, v115
    v_and_b32 v115, 15, v115
    v_lshlrev_b32 v115, 18, v115
    v_lshl_add_u32 v118, v119, 7, v115
    s_add_u32 s33, s66, 1600
    v_add_u32 v119, s33, v0
    v_lshrrev_b32 v115, 8, v119
    v_mul_u32_u24 v115, 1, v115
    v_add_u32 v115, s54, v115
    v_and_b32 v115, 15, v115
    v_lshlrev_b32 v115, 18, v115
    v_lshl_add_u32 v117, v119, 7, v115
    buffer_load_dwordx2 v[90:91], v30, s[48:51], s69 offen sc1
    buffer_load_dwordx2 v[92:93], v37, s[48:51], s32 offen sc1
    s_cmp_ge_u32 s56, 4
    s_cbranch_scc1 wi_22
    s_mov_b32 exec_lo, 0xffffffff
    s_mov_b32 exec_hi, 0xffffff
    buffer_load_dword v118, v118, s[8:11], s67 offen
    s_mov_b64 exec, -1
    s_barrier
    s_branch wd_23
wi_22:
    s_waitcnt vmcnt(2)
    s_barrier
    s_mov_b32 s69, s35
    ds_read_b64_tr_b16 v[64:65], v41 offset:0
    ds_read_b64_tr_b16 v[66:67], v41 offset:512
    ds_read_b64_tr_b16 v[68:69], v41 offset:4096
    ds_read_b64_tr_b16 v[70:71], v41 offset:4608
    ds_read_b64_tr_b16 v[72:73], v41 offset:8192
    ds_read_b64_tr_b16 v[74:75], v41 offset:8704
    ds_read_b64_tr_b16 v[76:77], v41 offset:12288
    ds_read_b64_tr_b16 v[78:79], v41 offset:12800
    s_waitcnt lgkmcnt(6)
    v_mfma_f32_16x16x32_bf16 v[96:99], v[64:67], v[128:131], 0
    s_waitcnt lgkmcnt(4)
    v_mfma_f32_16x16x32_bf16 v[100:103], v[68:71], v[128:131], 0
    s_waitcnt lgkmcnt(2)
    v_mfma_f32_16x16x32_bf16 v[96:99], v[72:75], v[132:135], v[96:99]
    s_waitcnt lgkmcnt(0)
    v_mfma_f32_16x16x32_bf16 v[100:103], v[76:79], v[132:135], v[100:103]
    s_nop 7
    v_add_f32_dpp v96, v100, v96 row_ror:8 row_mask:0xf bank_mask:0xf
    v_add_f32_dpp v97, v101, v97 row_ror:8 row_mask:0xf bank_mask:0xf
    v_add_f32_dpp v98, v102, v98 row_ror:8 row_mask:0xf bank_mask:0xf
    v_add_f32_dpp v99, v103, v99 row_ror:8 row_mask:0xf bank_mask:0xf
    v_bfi_b32 v96, s68, v12, v96
    v_bfi_b32 v97, s68, v13, v97
    v_bfi_b32 v98, s68, v14, v98
    v_bfi_b32 v99, s68, v15, v99
    s_mov_b32 exec_lo, 0xff00ff
    s_mov_b32 exec_hi, 0xff00ff
    buffer_store_dwordx4 v[96:99], v23, s[48:51], s69 offen sc1
    s_mov_b64 exec, -1
    s_mov_b32 exec_lo, 0xffffffff
    s_mov_b32 exec_hi, 0xffffff
    buffer_load_dword v118, v118, s[8:11], s67 offen
    s_mov_b64 exec, -1
wd_23:
    s_barrier
    s_cmp_lg_u32 s56, 5
    s_cbranch_scc1 wi_24
    buffer_load_dwordx4 v[64:67], v39, s[48:51], s64 offen sc1
    buffer_load_dwordx4 v[68:71], v39, s[48:51], s65 offen sc1
wi_24:
    s_mov_b32 exec_lo, 0xffffffff
    s_mov_b32 exec_hi, 0xffffff
    buffer_load_dword v117, v117, s[8:11], s67 offen
    s_mov_b64 exec, -1
    s_barrier
    s_waitcnt vmcnt(3)
    v_xor_b32 v90, s57, v90
    v_xor_b32 v91, s28, v91
    v_or_b32 v90, v90, v91
    v_and_b32 v91, 1, v0
    s_lshl_b32 s66, s56, 3
    s_add_u32 s66, s66, 160000
    v_lshl_add_u32 v91, v91, 2, s66
    ds_write_b32 v91, v90
    s_cmp_lg_u32 s56, 5
    s_cbranch_scc1 wi_26
    s_mov_b32 s63, 60000
    s_waitcnt vmcnt(1)
poll_28:
    v_xor_b32 v64, v64, v12
    v_xor_b32 v65, v65, v13
    v_xor_b32 v66, v66, v14
    v_xor_b32 v67, v67, v15
    v_xor_b32 v68, v68, v12
    v_xor_b32 v69, v69, v13
    v_xor_b32 v70, v70, v14
    v_xor_b32 v71, v71, v15
    v_or3_b32 v72, v64, v65, v66
    v_or3_b32 v73, v67, v68, v69
    v_or3_b32 v72, v72, v70, v71
    v_or_b32 v72, v72, v73
    v_and_b32 v72, 0xff, v72
    v_cmp_ne_u32 vcc, 0, v72
    s_cbranch_vccz pdone_29
    s_sleep 2
    buffer_load_dwordx4 v[64:67], v39, s[48:51], s64 offen sc1
    buffer_load_dwordx4 v[68:71], v39, s[48:51], s65 offen sc1
    s_sub_u32 s63, s63, 1
    s_waitcnt vmcnt(0)
    s_cbranch_scc0 poll_28
pdone_29:
    v_add_f32 v64, v64, v68
    v_add_f32 v65, v65, v69
    v_add_f32 v66, v66, v70
    v_add_f32 v67, v67, v71
    s_nop 0
    v_permlane32_swap_b32 v64, v66
    v_permlane32_swap_b32 v65, v67
    v_add_f32 v64, v64, v66
    v_add_f32 v65, v65, v67
    s_lshr_b32 s66, s55, 5
    s_lshl_b32 s65, s66, 13
    s_and_b32 s67, s55, 31
    s_lshl_b32 s67, s67, 5
    s_add_u32 s65, s65, s67
    s_add_u32 s65, s65, 32768
    s_cmp_eq_u32 s66, 2
    s_cselect_b32 s66, 1.0, 0
    v_cvt_pk_bf16_f32 v64, 0, v64
    v_cvt_pk_bf16_f32 v65, 0, v65
    v_add_f32 v64, s66, v64
    v_add_f32 v65, s66, v65
    v_cvt_pk_bf16_f32 v64, v64, v65
    buffer_store_dword v64, v24, s[48:51], s65 offen sc1
wi_26:
    s_cmp_ge_u32 s56, 4
    s_cbranch_scc1 wi_30
    v_lshrrev_b32 v114, 3, v3
    v_lshlrev_b32 v114, 13, v114
    v_lshl_add_u32 v114, v19, 7, v114
    s_lshl_b32 s67, s54, 18
    s_lshl_b32 s68, s52, 10
    s_add_u32 s67, s67, s68
    buffer_load_dword v114, v114, s[20:23], s67 offen
    s_barrier
    s_branch wd_31
wi_30:
    s_barrier
wd_31:
    s_lshl_b32 s62, s54, 2
    s_add_u32 s62, s62, s56
    s_and_b32 s62, s62, 7
    v_lshrrev_b32 v17, 3, v0
    v_lshlrev_b32 v17, 10, v17
    v_add_u32 v17, v17, v95
    v_xor_b32 v18, 64, v17
    s_lshl_b32 s74, s52, 19
    s_lshl_b32 s66, s62, 16
    s_add_u32 s74, s74, s66
    s_lshr_b32 s66, s54, 1
    s_xor_b32 s66, s66, 4
    s_lshl_b32 s66, s66, 7
    s_add_u32 s74, s74, s66
    s_lshl_b32 s75, s56, 13
    s_add_u32 s75, s75, 32768
    v_add_u32 v5, s75, v5
    v_and_b32 v38, 3, v1
    v_lshlrev_b32 v32, 10, v2
    v_lshl_add_u32 v32, v1, 4, v32
    s_lshl_b32 s64, s55, 15
    s_lshl_b32 s65, s56, 12
    s_add_u32 s64, s64, s65
    s_add_u32 s64, s64, 4194304
    s_lshl_b32 s66, s56, 8
    s_add_u32 s66, s66, 155648
    v_and_b32 v33, 1, v1
    v_lshlrev_b32 v33, 5, v33
    v_lshl_add_u32 v33, v2, 3, v33
    v_add_u32 v33, s66, v33
    v_lshlrev_b32 v44, 5, v2
    v_lshl_add_u32 v44, v1, 1, v44
    v_add_u32 v44, s66, v44
    s_mul_i32 s66, s56, 272
    s_add_u32 s66, s66, 157696
    v_lshlrev_b32 v34, 4, v1
    v_add_u32 v34, s66, v34
    v_mul_u32_u24 v35, 272, v19
    v_lshl_add_u32 v35, v2, 4, v35
    v_add_u32 v35, 157696, v35
    v_lshlrev_b32 v49, 3, v38
    v_lshrrev_b32 v49, v49, s57
    v_bfe_u32 v8, v49, 0, 1
    v_bfe_u32 v48, v49, 1, 1
    v_lshl_or_b32 v8, v48, 16, v8
    v_bfe_u32 v9, v49, 2, 1
    v_bfe_u32 v48, v49, 3, 1
    v_lshl_or_b32 v9, v48, 16, v9
    v_bfe_u32 v10, v49, 4, 1
    v_bfe_u32 v48, v49, 5, 1
    v_lshl_or_b32 v10, v48, 16, v10
    v_bfe_u32 v11, v49, 6, 1
    v_bfe_u32 v48, v49, 7, 1
    v_lshl_or_b32 v11, v48, 16, v11
    v_lshlrev_b32 v39, 8, v1
    s_lshl_b32 s66, s56, 12
    s_lshl_b32 s67, s60, 3
    s_add_u32 s66, s66, s67
    s_add_u32 s66, s66, 65536
    s_mov_b32 s31, s66
    v_lshrrev_b32 v56, 2, v1
    v_lshlrev_b32 v57, 6, v56
    v_lshlrev_b32 v56, 10, v56
    v_lshl_add_u32 v56, v38, 5, v56
    v_lshrrev_b32 v58, 1, v2
    v_lshl_add_u32 v56, v58, 7, v56
    v_and_b32 v58, 1, v2
    v_lshl_add_u32 v56, v58, 4, v56
    s_and_b32 s69, s54, 1
    s_lshl_b32 s33, s52, 15
    s_lshr_b32 s68, s62, 1
    s_lshl_b32 s68, s68, 13
    s_add_u32 s33, s33, s68
    s_lshl_b32 s68, s69, 12
    s_add_u32 s33, s33, s68
    s_and_b32 s68, s62, 1
    s_lshl_b32 s68, s68, 9
    s_add_u32 s33, s33, s68
    s_add_u32 s33, s33, s73
    s_add_u32 s33, s33, 2129920
    v_mul_u32_u24 v58, 272, v38
    v_add_u32 v57, v57, v58
    v_lshl_add_u32 v57, v2, 4, v57
    s_mul_i32 s68, s56, 1088
    s_add_u32 s68, s68, 98304
    v_add_u32 v57, s68, v57
    v_lshlrev_b32 v58, 3, v3
    v_lshrrev_b32 v59, 5, v3
    v_lshl_add_u32 v58, v59, 4, v58
    v_add_u32 v58, 98304, v58
    v_lshrrev_b32 v59, 5, v3
    v_lshlrev_b32 v59, 13, v59
    v_and_b32 v60, 31, v3
    v_lshl_add_u32 v59, v60, 2, v59
    s_lshl_b32 s34, s69, 15
    s_lshl_b32 s68, s52, 10
    s_add_u32 s34, s34, s68
    s_lshr_b32 s68, s54, 1
    s_xor_b32 s68, s68, 4
    s_lshl_b32 s68, s68, 7
    s_add_u32 s34, s34, s68
    s_add_u32 s34, s34, 116736
    v_lshlrev_b32 v110, 2, v1
    v_add_u32 v110, 160000, v110
    s_lshl_b32 s30, s60, 10
    s_lshl_b32 s65, s56, 7
    s_add_u32 s30, s30, s65
    s_add_u32 s30, s30, 1572864
    v_and_b32 v28, 1, v2
    v_lshlrev_b32 v28, 18, v28
    v_lshrrev_b32 v29, 1, v2
    v_lshl_add_u32 v28, v29, 17, v28
    v_lshlrev_b32 v29, 1, v2
    v_xor_b32 v29, v29, v1
    v_lshl_add_u32 v28, v29, 4, v28
    v_xor_b32 v29, 128, v28
    s_lshl_b32 s65, s61, 20
    s_mul_i32 s66, s56, 16384
    s_add_u32 s65, s65, s66
    s_lshl_b32 s66, s60, 8
    s_add_u32 s65, s65, s66
    s_mul_i32 s66, s56, 4096
    s_add_u32 s67, s65, 0
    s_add_u32 s68, s66, 0
    s_mov_b32 m0, s68
    s_nop 0
    buffer_load_dwordx4 v28, s[20:23], s67 offen nt lds
    s_add_u32 s67, s65, 524288
    s_add_u32 s68, s66, 1024
    s_mov_b32 m0, s68
    s_nop 0
    buffer_load_dwordx4 v28, s[20:23], s67 offen nt lds
    s_add_u32 s67, s65, 8192
    s_add_u32 s68, s66, 2048
    s_mov_b32 m0, s68
    s_nop 0
    buffer_load_dwordx4 v29, s[20:23], s67 offen nt lds
    s_add_u32 s67, s65, 532480
    s_add_u32 s68, s66, 3072
    s_mov_b32 m0, s68
    s_nop 0
    buffer_load_dwordx4 v29, s[20:23], s67 offen nt lds
    s_load_dword s65, s[48:49], s30 glc
    s_waitcnt lgkmcnt(0)
    s_mov_b32 s78, 1
    s_cmp_eq_u32 s65, s57
    s_cbranch_scc1 gotst_32
    s_mov_b32 s78, 0
    s_add_u32 s65, s74, 0
    s_add_u32 m0, s75, 0
    s_nop 0
    buffer_load_dwordx4 v17, s[24:27], s65 offen  lds
    s_add_u32 s65, s74, 8192
    s_add_u32 m0, s75, 1024
    s_nop 0
    buffer_load_dwordx4 v18, s[24:27], s65 offen  lds
    s_add_u32 s65, s74, 16384
    s_add_u32 m0, s75, 2048
    s_nop 0
    buffer_load_dwordx4 v17, s[24:27], s65 offen  lds
    s_add_u32 s65, s74, 24576
    s_add_u32 m0, s75, 3072
    s_nop 0
    buffer_load_dwordx4 v18, s[24:27], s65 offen  lds
    s_add_u32 s65, s74, 32768
    s_add_u32 m0, s75, 4096
    s_nop 0
    buffer_load_dwordx4 v17, s[24:27], s65 offen  lds
    s_add_u32 s65, s74, 40960
    s_add_u32 m0, s75, 5120
    s_nop 0
    buffer_load_dwordx4 v18, s[24:27], s65 offen  lds
    s_add_u32 s65, s74, 49152
    s_add_u32 m0, s75, 6144
    s_nop 0
    buffer_load_dwordx4 v17, s[24:27], s65 offen  lds
    s_add_u32 s65, s74, 57344
    s_add_u32 m0, s75, 7168
    s_nop 0
    buffer_load_dwordx4 v18, s[24:27], s65 offen  lds
    s_waitcnt vmcnt(8)
    s_barrier
    ds_read_b32 v110, v110
    ds_read_b64_tr_b16 v[112:113], v36 offset:0
    ds_read_b64_tr_b16 v[114:115], v36 offset:1024
    ds_read_b64_tr_b16 v[116:117], v36 offset:8192
    ds_read_b64_tr_b16 v[118:119], v36 offset:9216
    ds_read_b64_tr_b16 v[120:121], v36 offset:16384
    ds_read_b64_tr_b16 v[122:123], v36 offset:17408
    ds_read_b64_tr_b16 v[124:125], v36 offset:24576
    ds_read_b64_tr_b16 v[126:127], v36 offset:25600
    s_mov_b32 s63, 60000
hw_33:
    s_load_dword s65, s[48:49], s30 glc
    s_waitcnt lgkmcnt(0)
    s_cmp_eq_u32 s65, s57
    s_cbranch_scc1 hd_34
    s_sub_u32 s63, s63, 1
    s_cbranch_scc0 hw_33
hd_34:
gotst_32:
    buffer_load_dwordx2 v[40:41], v39, s[48:51], s31 offen sc1
    buffer_load_dwordx4 v[64:67], v32, s[48:51], s64 offen offset:0 sc1
    buffer_load_dwordx4 v[68:71], v32, s[48:51], s64 offen offset:256 sc1
    buffer_load_dwordx4 v[72:75], v32, s[48:51], s64 offen offset:512 sc1
    buffer_load_dwordx4 v[76:79], v32, s[48:51], s64 offen offset:768 sc1
    s_waitcnt vmcnt(4)
    v_max_u32 v47, v40, v41
    v_cmp_eq_u32 vcc, -1, v47
    s_cbranch_vccz okst_35
    s_mov_b32 s63, 60000
poll_36:
    buffer_load_dwordx2 v[40:41], v39, s[48:51], s31 offen sc1
    s_waitcnt vmcnt(0)
    v_max_u32 v47, v40, v41
    v_cmp_eq_u32 vcc, -1, v47
    s_cbranch_vccz pdone_37
    s_sub_u32 s63, s63, 1
    s_cbranch_scc0 poll_36
pdone_37:
okst_35:
    s_cmp_eq_u32 s78, 0
    s_cbranch_scc1 nr_38
    s_add_u32 s65, s74, 0
    s_add_u32 m0, s75, 0
    s_nop 0
    buffer_load_dwordx4 v17, s[24:27], s65 offen  lds
    s_add_u32 s65, s74, 8192
    s_add_u32 m0, s75, 1024
    s_nop 0
    buffer_load_dwordx4 v18, s[24:27], s65 offen  lds
    s_add_u32 s65, s74, 16384
    s_add_u32 m0, s75, 2048
    s_nop 0
    buffer_load_dwordx4 v17, s[24:27], s65 offen  lds
    s_add_u32 s65, s74, 24576
    s_add_u32 m0, s75, 3072
    s_nop 0
    buffer_load_dwordx4 v18, s[24:27], s65 offen  lds
    s_add_u32 s65, s74, 32768
    s_add_u32 m0, s75, 4096
    s_nop 0
    buffer_load_dwordx4 v17, s[24:27], s65 offen  lds
    s_add_u32 s65, s74, 40960
    s_add_u32 m0, s75, 5120
    s_nop 0
    buffer_load_dwordx4 v18, s[24:27], s65 offen  lds
    s_add_u32 s65, s74, 49152
    s_add_u32 m0, s75, 6144
    s_nop 0
    buffer_load_dwordx4 v17, s[24:27], s65 offen  lds
    s_add_u32 s65, s74, 57344
    s_add_u32 m0, s75, 7168
    s_nop 0
    buffer_load_dwordx4 v18, s[24:27], s65 offen  lds
    s_barrier
    ds_read_b32 v110, v110
    ds_read_b64_tr_b16 v[112:113], v36 offset:0
    ds_read_b64_tr_b16 v[114:115], v36 offset:1024
    ds_read_b64_tr_b16 v[116:117], v36 offset:8192
    ds_read_b64_tr_b16 v[118:119], v36 offset:9216
    ds_read_b64_tr_b16 v[120:121], v36 offset:16384
    ds_read_b64_tr_b16 v[122:123], v36 offset:17408
    ds_read_b64_tr_b16 v[124:125], v36 offset:24576
    ds_read_b64_tr_b16 v[126:127], v36 offset:25600
nr_38:
    v_mov_b32 v42, v40
    s_nop 1
    v_max_f32_dpp v42, v42, v42 row_ror:8 row_mask:0xf bank_mask:0xf
    s_nop 1
    v_max_f32_dpp v42, v42, v42 row_ror:4 row_mask:0xf bank_mask:0xf
    s_nop 1
    v_max_f32_dpp v42, v42, v42 row_ror:2 row_mask:0xf bank_mask:0xf
    s_nop 1
    v_max_f32_dpp v42, v42, v42 row_ror:1 row_mask:0xf bank_mask:0xf
    v_sub_f32 v40, v40, v42
    v_exp_f32 v40, v40
    s_nop 0
    v_mul_f32 v41, v41, v40
    s_nop 1
    v_add_f32_dpp v41, v41, v41 row_ror:8 row_mask:0xf bank_mask:0xf
    s_nop 1
    v_add_f32_dpp v41, v41, v41 row_ror:4 row_mask:0xf bank_mask:0xf
    s_nop 1
    v_add_f32_dpp v41, v41, v41 row_ror:2 row_mask:0xf bank_mask:0xf
    s_nop 1
    v_add_f32_dpp v41, v41, v41 row_ror:1 row_mask:0xf bank_mask:0xf
    v_rcp_f32 v41, v41
    v_and_b32 v47, 1, v2
    v_cmp_eq_u32 vcc, 1, v47
    v_mul_f32 v40, v40, v41
    v_cvt_pk_bf16_f32 v42, v40, v40
    v_and_b32 v43, 0xffff0000, v42
    v_sub_f32 v40, v40, v43
    v_cvt_pk_bf16_f32 v43, v40, v40
    v_cndmask_b32 v42, v42, v43, vcc
    ds_write_b16 v44, v42
    s_waitcnt lgkmcnt(0)
    ds_read_b64 v[52:53], v33
    s_mov_b32 s63, 60000
    s_waitcnt vmcnt(8)
    s_cmp_lg_u32 s78, 0
    s_cbranch_scc1 chk_41
poll_39:
    s_waitcnt vmcnt(0)
chk_41:
    v_xor_b32 v80, v64, v8
    v_xor_b32 v81, v65, v9
    v_xor_b32 v82, v66, v10
    v_xor_b32 v83, v67, v11
    v_xor_b32 v84, v68, v8
    v_xor_b32 v85, v69, v9
    v_xor_b32 v86, v70, v10
    v_xor_b32 v87, v71, v11
    v_xor_b32 v88, v72, v8
    v_xor_b32 v89, v73, v9
    v_xor_b32 v90, v74, v10
    v_xor_b32 v91, v75, v11
    v_xor_b32 v92, v76, v8
    v_xor_b32 v93, v77, v9
    v_xor_b32 v94, v78, v10
    v_xor_b32 v95, v79, v11
    v_or3_b32 v47, v80, v81, v82
    v_or3_b32 v48, v83, v84, v85
    v_or3_b32 v47, v47, v86, v87
    v_or3_b32 v48, v48, v88, v89
    v_or3_b32 v47, v47, v90, v91
    v_or3_b32 v48, v48, v92, v93
    v_or3_b32 v47, v47, v94, v95
    v_or_b32 v47, v47, v48
    v_and_b32 v47, 0x00010001, v47
    v_cmp_ne_u32 vcc, 0, v47
    s_cbranch_vccz pdone_40
    buffer_load_dwordx4 v[64:67], v32, s[48:51], s64 offen offset:0 sc1
    buffer_load_dwordx4 v[68:71], v32, s[48:51], s64 offen offset:256 sc1
    buffer_load_dwordx4 v[72:75], v32, s[48:51], s64 offen offset:512 sc1
    buffer_load_dwordx4 v[76:79], v32, s[48:51], s64 offen offset:768 sc1
    s_sub_u32 s63, s63, 1
    s_cbranch_scc0 poll_39
    s_waitcnt vmcnt(0)
pdone_40:
    v_perm_b32 v64, v84, v80, s76
    v_perm_b32 v65, v92, v88, s76
    v_perm_b32 v66, v84, v80, s77
    v_perm_b32 v67, v92, v88, s77
    v_or_b32 v66, 0x00010001, v66
    v_or_b32 v67, 0x00010001, v67
    s_waitcnt lgkmcnt(0)
    v_mfma_f32_16x16x16_bf16 v[128:131], v[52:53], v[64:65], 0
    v_perm_b32 v68, v85, v81, s76
    v_perm_b32 v69, v93, v89, s76
    v_mfma_f32_16x16x16_bf16 v[132:135], v[52:53], v[66:67], 0
    v_perm_b32 v70, v85, v81, s77
    v_perm_b32 v71, v93, v89, s77
    v_or_b32 v70, 0x00010001, v70
    v_or_b32 v71, 0x00010001, v71
    v_mfma_f32_16x16x16_bf16 v[136:139], v[52:53], v[68:69], 0
    v_perm_b32 v72, v86, v82, s76
    v_perm_b32 v73, v94, v90, s76
    v_mfma_f32_16x16x16_bf16 v[140:143], v[52:53], v[70:71], 0
    v_perm_b32 v74, v86, v82, s77
    v_perm_b32 v75, v94, v90, s77
    v_or_b32 v74, 0x00010001, v74
    v_or_b32 v75, 0x00010001, v75
    v_mfma_f32_16x16x16_bf16 v[144:147], v[52:53], v[72:73], 0
    v_perm_b32 v76, v87, v83, s76
    v_perm_b32 v77, v95, v91, s76
    v_mfma_f32_16x16x16_bf16 v[148:151], v[52:53], v[74:75], 0
    v_perm_b32 v78, v87, v83, s77
    v_perm_b32 v79, v95, v91, s77
    v_or_b32 v78, 0x00010001, v78
    v_or_b32 v79, 0x00010001, v79
    v_mfma_f32_16x16x16_bf16 v[152:155], v[52:53], v[76:77], 0
    s_nop 0
    v_mfma_f32_16x16x16_bf16 v[156:159], v[52:53], v[78:79], 0
    v_add_f32 v128, v128, v129
    v_add_f32 v132, v132, v133
    v_add_f32 v136, v136, v137
    v_add_f32 v140, v140, v141
    v_add_f32 v144, v144, v145
    v_add_f32 v148, v148, v149
    v_add_f32 v152, v152, v153
    s_nop 0
    v_add_f32 v156, v156, v157
    v_cvt_pk_bf16_f32 v80, v128, v132
    v_cvt_pk_bf16_f32 v81, v136, v140
    v_cvt_pk_bf16_f32 v82, v144, v148
    v_cvt_pk_bf16_f32 v83, v152, v156
    s_mov_b32 exec_lo, 0xffff
    s_mov_b32 exec_hi, 0x0
    ds_write_b128 v34, v[80:83]
    s_mov_b64 exec, -1
    s_waitcnt lgkmcnt(0)
    s_barrier
    ds_read_b128 v[64:67], v35 offset:0
    ds_read_b128 v[68:71], v35 offset:64
    ds_read_b128 v[72:75], v35 offset:128
    ds_read_b128 v[76:79], v35 offset:192
    s_waitcnt lgkmcnt(3)
    v_mfma_f32_16x16x32_bf16 v[84:87], v[112:115], v[64:67], 0
    s_waitcnt lgkmcnt(2)
    v_mfma_f32_16x16x32_bf16 v[84:87], v[116:119], v[68:71], v[84:87]
    s_waitcnt lgkmcnt(1)
    v_mfma_f32_16x16x32_bf16 v[84:87], v[120:123], v[72:75], v[84:87]
    s_waitcnt lgkmcnt(0)
    v_mfma_f32_16x16x32_bf16 v[84:87], v[124:127], v[76:79], v[84:87]
    v_cmp_ne_u32 vcc, 0, v110
    s_or_b32 s29, vcc_lo, vcc_hi
    s_nop 5
    v_cvt_pk_bf16_f32 v88, v84, v85
    v_cvt_pk_bf16_f32 v89, v86, v87
    s_mov_b32 exec_lo, 0xff00ff
    s_mov_b32 exec_hi, 0xff00ff
    s_cmp_lg_u32 s29, 0
    s_cbranch_scc1 far_42
    buffer_store_dwordx2 v[88:89], v37, s[48:51], s32 offen
    s_branch dn_43
far_42:
    buffer_store_dwordx2 v[88:89], v37, s[48:51], s32 offen sc1
dn_43:
    s_mov_b64 exec, -1
    s_waitcnt vmcnt(1)
    v_xor_b32 v47, 0, v5
    ds_read_b64_tr_b16 v[192:193], v47 offset:0
    ds_read_b64_tr_b16 v[194:195], v47 offset:512
    ds_read_b64_tr_b16 v[208:209], v47 offset:4096
    ds_read_b64_tr_b16 v[210:211], v47 offset:4608
    v_xor_b32 v47, 32, v5
    ds_read_b64_tr_b16 v[196:197], v47 offset:0
    ds_read_b64_tr_b16 v[198:199], v47 offset:512
    ds_read_b64_tr_b16 v[212:213], v47 offset:4096
    ds_read_b64_tr_b16 v[214:215], v47 offset:4608
    v_xor_b32 v47, 64, v5
    ds_read_b64_tr_b16 v[200:201], v47 offset:0
    ds_read_b64_tr_b16 v[202:203], v47 offset:512
    ds_read_b64_tr_b16 v[216:217], v47 offset:4096
    ds_read_b64_tr_b16 v[218:219], v47 offset:4608
    v_xor_b32 v47, 96, v5
    ds_read_b64_tr_b16 v[204:205], v47 offset:0
    ds_read_b64_tr_b16 v[206:207], v47 offset:512
    ds_read_b64_tr_b16 v[220:221], v47 offset:4096
    ds_read_b64_tr_b16 v[222:223], v47 offset:4608
    s_mov_b32 s63, 60000
poll_44:
    buffer_load_dwordx4 v[64:67], v56, s[48:51], s33 offen offset:0 sc1
    buffer_load_dwordx4 v[68:71], v56, s[48:51], s33 offen offset:256 sc1
    s_waitcnt vmcnt(0)
    v_max3_u32 v47, v64, v66, v68
    v_max_u32 v47, v47, v70
    v_cmp_eq_u32 vcc, -1, v47
    s_cbranch_vccz pdone_45
    s_sub_u32 s63, s63, 1
    s_cbranch_scc0 poll_44
pdone_45:
    s_waitcnt lgkmcnt(0)
    v_mfma_f32_16x16x32_bf16 v[80:83], v[192:195], v[64:67], 0
    v_mfma_f32_16x16x32_bf16 v[84:87], v[196:199], v[64:67], 0
    v_mfma_f32_16x16x32_bf16 v[88:91], v[200:203], v[64:67], 0
    v_mfma_f32_16x16x32_bf16 v[92:95], v[204:207], v[64:67], 0
    v_mfma_f32_16x16x32_bf16 v[80:83], v[208:211], v[68:71], v[80:83]
    v_mfma_f32_16x16x32_bf16 v[84:87], v[212:215], v[68:71], v[84:87]
    v_mfma_f32_16x16x32_bf16 v[88:91], v[216:219], v[68:71], v[88:91]
    v_mfma_f32_16x16x32_bf16 v[92:95], v[220:223], v[68:71], v[92:95]
    s_nop 4
    v_add_f32_dpp v96, v80, v80 row_ror:8 row_mask:0xf bank_mask:0x3
    v_add_f32_dpp v97, v81, v81 row_ror:8 row_mask:0xf bank_mask:0x3
    v_add_f32_dpp v98, v82, v82 row_ror:8 row_mask:0xf bank_mask:0x3
    v_add_f32_dpp v99, v83, v83 row_ror:8 row_mask:0xf bank_mask:0x3
    v_add_f32_dpp v100, v84, v84 row_ror:8 row_mask:0xf bank_mask:0x3
    v_add_f32_dpp v101, v85, v85 row_ror:8 row_mask:0xf bank_mask:0x3
    v_add_f32_dpp v102, v86, v86 row_ror:8 row_mask:0xf bank_mask:0x3
    v_add_f32_dpp v103, v87, v87 row_ror:8 row_mask:0xf bank_mask:0x3
    v_add_f32_dpp v96, v88, v88 row_ror:8 row_mask:0xf bank_mask:0xc
    v_add_f32_dpp v97, v89, v89 row_ror:8 row_mask:0xf bank_mask:0xc
    v_add_f32_dpp v98, v90, v90 row_ror:8 row_mask:0xf bank_mask:0xc
    v_add_f32_dpp v99, v91, v91 row_ror:8 row_mask:0xf bank_mask:0xc
    v_add_f32_dpp v100, v92, v92 row_ror:8 row_mask:0xf bank_mask:0xc
    v_add_f32_dpp v101, v93, v93 row_ror:8 row_mask:0xf bank_mask:0xc
    v_add_f32_dpp v102, v94, v94 row_ror:8 row_mask:0xf bank_mask:0xc
    v_add_f32_dpp v103, v95, v95 row_ror:8 row_mask:0xf bank_mask:0xc
    v_add_f32_dpp v104, v96, v96 row_shl:4 row_mask:0xf bank_mask:0x5
    v_add_f32_dpp v105, v97, v97 row_shl:4 row_mask:0xf bank_mask:0x5
    v_add_f32_dpp v106, v98, v98 row_shl:4 row_mask:0xf bank_mask:0x5
    v_add_f32_dpp v107, v99, v99 row_shl:4 row_mask:0xf bank_mask:0x5
    v_add_f32_dpp v104, v100, v100 row_shr:4 row_mask:0xf bank_mask:0xa
    v_add_f32_dpp v105, v101, v101 row_shr:4 row_mask:0xf bank_mask:0xa
    v_add_f32_dpp v106, v102, v102 row_shr:4 row_mask:0xf bank_mask:0xa
    v_add_f32_dpp v107, v103, v103 row_shr:4 row_mask:0xf bank_mask:0xa
    ds_write_b128 v57, v[104:107]
    s_waitcnt lgkmcnt(0)
    s_barrier
    s_cmp_lg_u32 s56, 7
    s_cbranch_scc1 nohint_46
    s_lshl_b32 s64, s55, 7
    s_add_u32 s64, s64, 182272
    v_mov_b32 v108, s57
    v_mov_b32 v109, 0
    s_mov_b32 exec_lo, 0x1
    s_mov_b32 exec_hi, 0x0
    buffer_store_dword v108, v109, s[48:51], s64 offen sc1
    s_mov_b64 exec, -1
nohint_46:
    s_cmp_ge_u32 s56, 3
    s_cbranch_scc1 L_fin
    s_cmp_eq_u32 s56, 2
    s_cbranch_scc1 L_final
    ds_read_b64 v[64:65], v58 offset:0
    ds_read_b64 v[66:67], v58 offset:1088
    ds_read_b64 v[68:69], v58 offset:2176
    ds_read_b64 v[70:71], v58 offset:3264
    ds_read_b64 v[72:73], v58 offset:4352
    ds_read_b64 v[74:75], v58 offset:5440
    ds_read_b64 v[76:77], v58 offset:6528
    ds_read_b64 v[78:79], v58 offset:7616
    s_waitcnt lgkmcnt(0)
    v_add_f32 v64, v64, v72
    v_add_f32 v65, v65, v73
    v_add_f32 v66, v66, v74
    v_add_f32 v67, v67, v75
    v_add_f32 v68, v68, v76
    v_add_f32 v69, v69, v77
    v_add_f32 v70, v70, v78
    v_add_f32 v71, v71, v79
    v_add_f32 v64, v64, v68
    v_add_f32 v65, v65, v69
    v_add_f32 v66, v66, v70
    v_add_f32 v67, v67, v71
    v_add_f32 v64, v64, v66
    v_add_f32 v65, v65, v67
    v_cvt_pk_bf16_f32 v64, v64, 0
    v_and_b32 v66, 0x7fffffff, v65
    v_add_u32 v66, 0x8000, v66
    s_mov_b32 s64, 0xffff
    s_brev_b32 s65, 1
    v_sub_u32 v66, v66, v64 clamp
    v_bfi_b32 v64, s64, v64, v66
    v_bfi_b32 v64, s65, v65, v64
    buffer_store_dword v64, v59, s[48:51], s34 offen sc1
    s_cmp_lg_u32 s2, 0
    s_cbranch_scc1 L_fin
    v_mov_b32 v40, s57
    v_mov_b32 v39, 0
    s_mov_b32 exec_lo, 0x1
    s_mov_b32 exec_hi, 0x0
    buffer_store_dword v40, v39, s[48:51], 0 offen offset:0 sc1
    s_mov_b64 exec, -1
    s_branch L_fin
L_final:
    s_lshr_b32 s68, s55, 2
    s_and_b32 s69, s55, 3
    v_bfe_u32 v32, v0, 2, 1
    v_and_b32 v33, 3, v0
    v_lshlrev_b32 v34, 10, v32
    v_lshl_add_u32 v34, v33, 3, v34
    s_lshl_b32 s64, s69, 11
    s_lshl_b32 s65, s68, 5
    s_add_u32 s64, s64, s65
    buffer_load_dwordx2 v[40:41], v34, s[4:7], s64 offen
    s_add_u32 s65, s64, 32768
    s_add_u32 s66, s65, 24576
    s_mov_b32 s63, 60000
poll_47:
    buffer_load_dwordx2 v[42:43], v34, s[48:51], s65 offen sc1
    buffer_load_dwordx2 v[44:45], v34, s[48:51], s66 offen sc1
    s_waitcnt vmcnt(0)
    v_max3_u32 v47, v42, v43, v44
    v_max_u32 v47, v47, v45
    v_cmp_eq_u32 vcc, -1, v47
    s_cbranch_vccz pdone_48
    s_sleep 1
    s_sub_u32 s63, s63, 1
    s_cbranch_scc0 poll_47
pdone_48:
    v_lshlrev_b32 v48, 16, v40
    v_and_b32 v49, 0xffff0000, v40
    v_lshlrev_b32 v50, 16, v41
    v_and_b32 v51, 0xffff0000, v41
    v_lshlrev_b32 v52, 16, v42
    v_and_b32 v53, 0xffff0000, v42
    v_lshlrev_b32 v54, 16, v43
    v_and_b32 v55, 0xffff0000, v43
    v_lshlrev_b32 v56, 16, v44
    v_and_b32 v57, 0xffff0000, v44
    v_lshlrev_b32 v58, 16, v45
    v_and_b32 v59, 0xffff0000, v45
    v_lshlrev_b32 v35, 13, v32
    v_lshl_add_u32 v35, v33, 3, v35
    s_lshl_b32 s65, s69, 14
    s_lshl_b32 s66, s68, 5
    s_add_u32 s65, s65, s66
    s_add_u32 s65, s65, 116736
    s_add_u32 s66, s65, 4096
    s_min_u32 s67, s54, 13
    s_lshl_b32 s33, s52, 4
    s_add_u32 s67, s67, s33
    s_lshl_b32 s67, s67, 7
    s_add_u32 s67, s67, 198720
    s_mov_b32 s63, 60000
hw_49:
    s_load_dword s33, s[48:49], s67 glc
    s_waitcnt lgkmcnt(0)
    s_cmp_eq_u32 s33, s57
    s_cbranch_scc1 hd_50
    s_sub_u32 s63, s63, 1
    s_cbranch_scc0 hw_49
hd_50:
    s_mov_b32 s63, 60000
poll_51:
    buffer_load_dwordx2 v[128:129], v35, s[48:51], s65 offen offset:0 sc1
    buffer_load_dwordx2 v[130:131], v35, s[48:51], s65 offen offset:1024 sc1
    buffer_load_dwordx2 v[132:133], v35, s[48:51], s65 offen offset:2048 sc1
    buffer_load_dwordx2 v[134:135], v35, s[48:51], s65 offen offset:3072 sc1
    buffer_load_dwordx2 v[136:137], v35, s[48:51], s66 offen offset:0 sc1
    buffer_load_dwordx2 v[138:139], v35, s[48:51], s66 offen offset:1024 sc1
    buffer_load_dwordx2 v[140:141], v35, s[48:51], s66 offen offset:2048 sc1
    buffer_load_dwordx2 v[142:143], v35, s[48:51], s66 offen offset:3072 sc1
    s_waitcnt vmcnt(0)
    v_max3_u32 v47, v128, v129, v130
    v_max3_u32 v47, v47, v131, v132
    v_max3_u32 v47, v47, v133, v134
    v_max3_u32 v47, v47, v135, v136
    v_max3_u32 v47, v47, v137, v138
    v_max3_u32 v47, v47, v139, v140
    v_max3_u32 v47, v47, v141, v142
    v_max_u32 v47, v47, v143
    v_cmp_eq_u32 vcc, -1, v47
    s_cbranch_vccz pdone_52
    s_sleep 1
    s_sub_u32 s63, s63, 1
    s_cbranch_scc0 poll_51
pdone_52:
    v_lshlrev_b32 v144, 16, v128
    v_mov_b32 v145, v128
    v_lshlrev_b32 v146, 16, v129
    v_mov_b32 v147, v129
    v_lshlrev_b32 v148, 16, v130
    v_mov_b32 v149, v130
    v_lshlrev_b32 v150, 16, v131
    v_mov_b32 v151, v131
    v_lshlrev_b32 v152, 16, v132
    v_mov_b32 v153, v132
    v_lshlrev_b32 v154, 16, v133
    v_mov_b32 v155, v133
    v_lshlrev_b32 v156, 16, v134
    v_mov_b32 v157, v134
    v_lshlrev_b32 v158, 16, v135
    v_mov_b32 v159, v135
    v_lshlrev_b32 v160, 16, v136
    v_mov_b32 v161, v136
    v_lshlrev_b32 v162, 16, v137
    v_mov_b32 v163, v137
    v_lshlrev_b32 v164, 16, v138
    v_mov_b32 v165, v138
    v_lshlrev_b32 v166, 16, v139
    v_mov_b32 v167, v139
    v_lshlrev_b32 v168, 16, v140
    v_mov_b32 v169, v140
    v_lshlrev_b32 v170, 16, v141
    v_mov_b32 v171, v141
    v_lshlrev_b32 v172, 16, v142
    v_mov_b32 v173, v142
    v_lshlrev_b32 v174, 16, v143
    v_mov_b32 v175, v143
    v_add_f32 v144, v144, v160
    v_add_f32 v145, v145, v161
    v_add_f32 v146, v146, v162
    v_add_f32 v147, v147, v163
    v_add_f32 v148, v148, v164
    v_add_f32 v149, v149, v165
    v_add_f32 v150, v150, v166
    v_add_f32 v151, v151, v167
    v_add_f32 v152, v152, v168
    v_add_f32 v153, v153, v169
    v_add_f32 v154, v154, v170
    v_add_f32 v155, v155, v171
    v_add_f32 v156, v156, v172
    v_add_f32 v157, v157, v173
    v_add_f32 v158, v158, v174
    v_add_f32 v159, v159, v175
    v_add_f32 v144, v144, v152
    v_add_f32 v145, v145, v153
    v_add_f32 v146, v146, v154
    v_add_f32 v147, v147, v155
    v_add_f32 v148, v148, v156
    v_add_f32 v149, v149, v157
    v_add_f32 v150, v150, v158
    v_add_f32 v151, v151, v159
    v_add_f32 v144, v144, v148
    v_add_f32 v145, v145, v149
    v_add_f32 v146, v146, v150
    v_add_f32 v147, v147, v151
    v_mov_b32 v72, v144
    v_mov_b32 v73, v145
    v_mov_b32 v74, v146
    v_mov_b32 v75, v147
    v_cvt_pk_bf16_f32 v72, 0, v72
    v_cvt_pk_bf16_f32 v73, 0, v73
    v_cvt_pk_bf16_f32 v74, 0, v74
    v_cvt_pk_bf16_f32 v75, 0, v75
    v_mul_f32 v72, v72, v52
    v_mul_f32 v73, v73, v53
    v_mul_f32 v74, v74, v54
    v_mul_f32 v75, v75, v55
    v_cvt_pk_bf16_f32 v72, 0, v72
    v_cvt_pk_bf16_f32 v73, 0, v73
    v_cvt_pk_bf16_f32 v74, 0, v74
    v_cvt_pk_bf16_f32 v75, 0, v75
    v_add_f32 v72, v72, v48
    v_add_f32 v73, v73, v49
    v_add_f32 v74, v74, v50
    v_add_f32 v75, v75, v51
    v_cvt_pk_bf16_f32 v72, 0, v72
    v_cvt_pk_bf16_f32 v73, 0, v73
    v_cvt_pk_bf16_f32 v74, 0, v74
    v_cvt_pk_bf16_f32 v75, 0, v75
    v_lshlrev_b32 v35, 4, v0
    s_mul_i32 s65, s55, 7168
    s_add_u32 s65, s65, 215040
    s_add_u32 s66, s65, 4096
    v_bfe_u32 v40, s57, 0, 8
    v_bfe_u32 v41, s57, 8, 8
    v_bfe_u32 v42, s57, 16, 8
    v_bfe_u32 v43, s57, 24, 8
    s_min_u32 s67, s54, 13
    s_lshl_b32 s68, s52, 4
    s_add_u32 s67, s67, s68
    s_lshl_b32 s67, s67, 7
    s_add_u32 s67, s67, 198656
    s_mov_b32 s63, 60000
hw_53:
    s_load_dword s68, s[48:49], s67 glc
    s_waitcnt lgkmcnt(0)
    s_cmp_eq_u32 s68, s57
    s_cbranch_scc1 hd_54
    s_sub_u32 s63, s63, 1
    s_cbranch_scc0 hw_53
hd_54:
    s_mov_b32 s63, 60000
poll_55:
    buffer_load_dwordx4 v[96:99], v35, s[48:51], s65 offen offset:0 sc1
    buffer_load_dwordx4 v[100:103], v35, s[48:51], s65 offen offset:1024 sc1
    buffer_load_dwordx4 v[104:107], v35, s[48:51], s65 offen offset:2048 sc1
    buffer_load_dwordx4 v[108:111], v35, s[48:51], s65 offen offset:3072 sc1
    buffer_load_dwordx4 v[112:115], v35, s[48:51], s66 offen offset:0 sc1
    buffer_load_dwordx4 v[116:119], v35, s[48:51], s66 offen offset:1024 sc1
    buffer_load_dwordx4 v[120:123], v35, s[48:51], s66 offen offset:2048 sc1
    s_waitcnt vmcnt(0)
    v_xor_b32 v96, v96, v40
    v_xor_b32 v97, v97, v41
    v_xor_b32 v98, v98, v42
    v_xor_b32 v99, v99, v43
    v_xor_b32 v100, v100, v40
    v_xor_b32 v101, v101, v41
    v_xor_b32 v102, v102, v42
    v_xor_b32 v103, v103, v43
    v_xor_b32 v104, v104, v40
    v_xor_b32 v105, v105, v41
    v_xor_b32 v106, v106, v42
    v_xor_b32 v107, v107, v43
    v_xor_b32 v108, v108, v40
    v_xor_b32 v109, v109, v41
    v_xor_b32 v110, v110, v42
    v_xor_b32 v111, v111, v43
    v_xor_b32 v112, v112, v40
    v_xor_b32 v113, v113, v41
    v_xor_b32 v114, v114, v42
    v_xor_b32 v115, v115, v43
    v_xor_b32 v116, v116, v40
    v_xor_b32 v117, v117, v41
    v_xor_b32 v118, v118, v42
    v_xor_b32 v119, v119, v43
    v_xor_b32 v120, v120, v40
    v_xor_b32 v121, v121, v41
    v_xor_b32 v122, v122, v42
    v_xor_b32 v123, v123, v43
    v_or3_b32 v47, v96, v97, v98
    v_or3_b32 v46, v99, v100, v101
    v_or3_b32 v47, v47, v102, v103
    v_or3_b32 v46, v46, v104, v105
    v_or3_b32 v47, v47, v106, v107
    v_or3_b32 v46, v46, v108, v109
    v_or3_b32 v47, v47, v110, v111
    v_or3_b32 v46, v46, v112, v113
    v_or3_b32 v47, v47, v114, v115
    v_or3_b32 v46, v46, v116, v117
    v_or3_b32 v47, v47, v118, v119
    v_or3_b32 v46, v46, v120, v121
    v_or3_b32 v47, v47, v122, v123
    v_or_b32 v47, v47, v46
    v_and_b32 v47, 0xff, v47
    v_cmp_ne_u32 vcc, 0, v47
    s_cbranch_vccz pdone_56
    s_sub_u32 s63, s63, 1
    s_cbranch_scc0 poll_55
pdone_56:
    v_add_f32 v96, v96, v100
    v_add_f32 v104, v104, v108
    v_add_f32 v112, v112, v116
    v_add_f32 v97, v97, v101
    v_add_f32 v105, v105, v109
    v_add_f32 v113, v113, v117
    v_add_f32 v98, v98, v102
    v_add_f32 v106, v106, v110
    v_add_f32 v114, v114, v118
    v_add_f32 v99, v99, v103
    v_add_f32 v107, v107, v111
    v_add_f32 v115, v115, v119
    v_add_f32 v96, v96, v104
    v_add_f32 v112, v112, v120
    v_add_f32 v97, v97, v105
    v_add_f32 v113, v113, v121
    v_add_f32 v98, v98, v106
    v_add_f32 v114, v114, v122
    v_add_f32 v99, v99, v107
    v_add_f32 v115, v115, v123
    v_add_f32 v96, v96, v112
    v_add_f32 v97, v97, v113
    v_add_f32 v98, v98, v114
    v_add_f32 v99, v99, v115
    v_add_f32_dpp v96, v96, v96 row_ror:8 row_mask:0xf bank_mask:0xf
    v_add_f32_dpp v97, v97, v97 row_ror:8 row_mask:0xf bank_mask:0xf
    v_add_f32_dpp v98, v98, v98 row_ror:8 row_mask:0xf bank_mask:0xf
    v_add_f32_dpp v99, v99, v99 row_ror:8 row_mask:0xf bank_mask:0xf
    v_mov_b32 v100, v96
    v_mov_b32 v101, v97
    v_mov_b32 v102, v98
    v_mov_b32 v103, v99
    v_permlane16_swap_b32 v100, v96
    v_permlane16_swap_b32 v101, v97
    v_permlane16_swap_b32 v102, v98
    v_permlane16_swap_b32 v103, v99
    v_add_f32 v96, v96, v100
    v_add_f32 v97, v97, v101
    v_add_f32 v98, v98, v102
    v_add_f32 v99, v99, v103
    v_mov_b32 v100, v96
    v_mov_b32 v101, v97
    v_mov_b32 v102, v98
    v_mov_b32 v103, v99
    v_permlane32_swap_b32 v100, v96
    v_permlane32_swap_b32 v101, v97
    v_permlane32_swap_b32 v102, v98
    v_permlane32_swap_b32 v103, v99
    v_add_f32 v96, v96, v100
    v_add_f32 v97, v97, v101
    v_add_f32 v98, v98, v102
    v_add_f32 v99, v99, v103
    v_cvt_pk_bf16_f32 v96, 0, v96
    v_cvt_pk_bf16_f32 v97, 0, v97
    v_cvt_pk_bf16_f32 v98, 0, v98
    v_cvt_pk_bf16_f32 v99, 0, v99
    v_mul_f32 v96, v96, v56
    v_mul_f32 v97, v97, v57
    v_mul_f32 v98, v98, v58
    v_mul_f32 v99, v99, v59
    v_cvt_pk_bf16_f32 v96, 0, v96
    v_cvt_pk_bf16_f32 v97, 0, v97
    v_cvt_pk_bf16_f32 v98, 0, v98
    v_cvt_pk_bf16_f32 v99, 0, v99
    v_add_f32 v96, v96, v72
    v_add_f32 v97, v97, v73
    v_add_f32 v98, v98, v74
    v_add_f32 v99, v99, v75
    v_cvt_pk_bf16_f32 v100, v96, v97
    v_cvt_pk_bf16_f32 v101, v98, v99
    s_mov_b32 exec_lo, 0xff
    s_mov_b32 exec_hi, 0x0
    buffer_store_dwordx2 v[100:101], v34, s[44:47], s64 offen
    s_mov_b64 exec, -1
    s_branch L_fin
L_pv:
    s_mov_b32 s10, 33554432
    s_mov_b32 s11, 0x00020000
    s_lshl_b32 s78, s54, 18
    s_lshl_b32 s64, s52, 22
    s_add_u32 s12, s78, 0
    s_and_b32 s12, s12, 0x3fffff
    s_or_b32 s12, s12, s64
    s_add_u32 s13, s78, 294912
    s_and_b32 s13, s13, 0x3fffff
    s_or_b32 s13, s13, s64
    s_add_u32 s14, s78, 589824
    s_and_b32 s14, s14, 0x3fffff
    s_or_b32 s14, s14, s64
    s_add_u32 s15, s78, 884736
    s_and_b32 s15, s15, 0x3fffff
    s_or_b32 s15, s15, s64
    s_add_u32 s16, s78, 1179648
    s_and_b32 s16, s16, 0x3fffff
    s_or_b32 s16, s16, s64
    s_add_u32 s17, s78, 1474560
    s_and_b32 s17, s17, 0x3fffff
    s_or_b32 s17, s17, s64
    s_add_u32 s18, s78, 1769472
    s_and_b32 s18, s18, 0x3fffff
    s_or_b32 s18, s18, s64
    s_add_u32 s19, s78, 2064384
    s_and_b32 s19, s19, 0x3fffff
    s_or_b32 s19, s19, s64
    s_and_b32 s79, s56, 3
    s_lshl_b32 s69, s79, 13
    s_and_b32 s64, s79, 1
    s_cmp_eq_u32 s64, 1
    s_cselect_b32 s65, 3, 0
    v_xor_b32 v48, s65, v0
    v_lshlrev_b32 v48, 4, v48
    v_add_u32 v48, s69, v48
    s_cselect_b32 s65, 7, 4
    v_xor_b32 v49, s65, v0
    v_lshlrev_b32 v49, 4, v49
    v_add_u32 v49, s69, v49
    s_cselect_b32 s65, 11, 8
    v_xor_b32 v50, s65, v0
    v_lshlrev_b32 v50, 4, v50
    v_add_u32 v50, s69, v50
    s_cselect_b32 s65, 15, 12
    v_xor_b32 v51, s65, v0
    v_lshlrev_b32 v51, 4, v51
    v_add_u32 v51, s69, v51
    s_cselect_b32 s65, 1, 2
    v_xor_b32 v52, s65, v0
    v_lshlrev_b32 v52, 4, v52
    v_add_u32 v52, s69, v52
    v_add_u32 v52, 4096, v52
    s_cselect_b32 s65, 5, 6
    v_xor_b32 v53, s65, v0
    v_lshlrev_b32 v53, 4, v53
    v_add_u32 v53, s69, v53
    v_add_u32 v53, 4096, v53
    s_cselect_b32 s65, 9, 10
    v_xor_b32 v54, s65, v0
    v_lshlrev_b32 v54, 4, v54
    v_add_u32 v54, s69, v54
    v_add_u32 v54, 4096, v54
    s_cselect_b32 s65, 13, 14
    v_xor_b32 v55, s65, v0
    v_lshlrev_b32 v55, 4, v55
    v_add_u32 v55, s69, v55
    v_add_u32 v55, 4096, v55
    s_waitcnt lgkmcnt(0)
    s_load_dword s57, s[48:49], 0
    s_load_dwordx2 s[28:29], s[0:1], 56
    s_load_dwordx2 s[32:33], s[0:1], 64
    s_mov_b32 s30, 1835008
    s_mov_b32 s31, 0x00020000
    s_mov_b32 s34, 1835008
    s_mov_b32 s35, 0x00020000
    s_mov_b32 s72, 0
L_pv_start:
    s_add_u32 m0, s69, 0
    s_nop 0
    buffer_load_dwordx4 v48, s[8:11], s12 offen nt lds
    buffer_load_dwordx4 v49, s[8:11], s12 offen offset:1024 nt lds
    buffer_load_dwordx4 v50, s[8:11], s12 offen offset:2048 nt lds
    buffer_load_dwordx4 v51, s[8:11], s12 offen offset:3072 nt lds
    s_add_u32 m0, s69, 4096
    s_nop 0
    buffer_load_dwordx4 v52, s[8:11], s12 offen nt lds
    buffer_load_dwordx4 v53, s[8:11], s12 offen offset:1024 nt lds
    buffer_load_dwordx4 v54, s[8:11], s12 offen offset:2048 nt lds
    buffer_load_dwordx4 v55, s[8:11], s12 offen offset:3072 nt lds
    v_mov_b32 v64, 0
    v_mov_b32 v65, 0
    v_mov_b32 v66, 0
    v_mov_b32 v67, 0
    v_mov_b32 v68, 0
    v_mov_b32 v69, 0
    v_mov_b32 v70, 0
    v_mov_b32 v71, 0
    v_mov_b32 v72, 0
    v_mov_b32 v73, 0
    v_mov_b32 v74, 0
    v_mov_b32 v75, 0
    v_mov_b32 v76, 0
    v_mov_b32 v77, 0
    v_mov_b32 v78, 0
    v_mov_b32 v79, 0
    v_mov_b32 v80, 0
    v_mov_b32 v81, 0
    v_mov_b32 v82, 0
    v_mov_b32 v83, 0
    v_mov_b32 v84, 0
    v_mov_b32 v85, 0
    v_mov_b32 v86, 0
    v_mov_b32 v87, 0
    v_mov_b32 v88, 0
    v_mov_b32 v89, 0
    v_mov_b32 v90, 0
    v_mov_b32 v91, 0
    v_mov_b32 v92, 0
    v_mov_b32 v93, 0
    v_mov_b32 v94, 0
    v_mov_b32 v95, 0
    v_mov_b32 v96, 0
    v_mov_b32 v97, 0
    v_mov_b32 v98, 0
    v_mov_b32 v99, 0
    v_mov_b32 v100, 0
    v_mov_b32 v101, 0
    v_mov_b32 v102, 0
    v_mov_b32 v103, 0
    v_mov_b32 v104, 0
    v_mov_b32 v105, 0
    v_mov_b32 v106, 0
    v_mov_b32 v107, 0
    v_mov_b32 v108, 0
    v_mov_b32 v109, 0
    v_mov_b32 v110, 0
    v_mov_b32 v111, 0
    v_mov_b32 v112, 0
    v_mov_b32 v113, 0
    v_mov_b32 v114, 0
    v_mov_b32 v115, 0
    v_mov_b32 v116, 0
    v_mov_b32 v117, 0
    v_mov_b32 v118, 0
    v_mov_b32 v119, 0
    v_mov_b32 v120, 0
    v_mov_b32 v121, 0
    v_mov_b32 v122, 0
    v_mov_b32 v123, 0
    v_mov_b32 v124, 0
    v_mov_b32 v125, 0
    v_mov_b32 v126, 0
    v_mov_b32 v127, 0
    s_cmp_lg_u32 s72, 0
    s_cbranch_scc1 L_pv_again
    v_lshrrev_b32 v42, 2, v1
    v_and_b32 v43, 3, v1
    v_and_b32 v44, 1, v2
    v_lshrrev_b32 v45, 1, v2
    v_lshl_add_u32 v46, v45, 3, v42
    v_lshlrev_b32 v46, 10, v46
    v_and_b32 v47, 1, v43
    v_lshl_add_u32 v46, v47, 3, v46
    s_lshl_b32 s64, s79, 8
    v_add_u32 v46, s64, v46
    v_lshrrev_b32 v47, 1, v43
    v_lshl_add_u32 v47, v44, 1, v47
    v_lshl_add_u32 v47, v42, 2, v47
    v_cmp_eq_u32 vcc, 1, v45
    v_mov_b32 v56, 0
    v_mov_b32 v57, 3
    v_cndmask_b32 v56, v56, v57, vcc
    v_xor_b32 v56, v56, v47
    v_xor_b32 v24, 0, v56
    v_lshl_add_u32 v24, v24, 4, v46
    v_add_u32 v32, 0x10000, v24
    v_xor_b32 v26, 4, v56
    v_lshl_add_u32 v26, v26, 4, v46
    v_add_u32 v34, 0x10000, v26
    v_xor_b32 v28, 8, v56
    v_lshl_add_u32 v28, v28, 4, v46
    v_add_u32 v36, 0x10000, v28
    v_xor_b32 v30, 12, v56
    v_lshl_add_u32 v30, v30, 4, v46
    v_add_u32 v38, 0x10000, v30
    v_mov_b32 v56, 2
    v_mov_b32 v57, 1
    v_cndmask_b32 v56, v56, v57, vcc
    v_xor_b32 v56, v56, v47
    v_xor_b32 v25, 0, v56
    v_lshl_add_u32 v25, v25, 4, v46
    v_add_u32 v25, 4096, v25
    v_add_u32 v33, 0x10000, v25
    v_xor_b32 v27, 4, v56
    v_lshl_add_u32 v27, v27, 4, v46
    v_add_u32 v27, 4096, v27
    v_add_u32 v35, 0x10000, v27
    v_xor_b32 v29, 8, v56
    v_lshl_add_u32 v29, v29, 4, v46
    v_add_u32 v29, 4096, v29
    v_add_u32 v37, 0x10000, v29
    v_xor_b32 v31, 12, v56
    v_lshl_add_u32 v31, v31, 4, v46
    v_add_u32 v31, 4096, v31
    v_add_u32 v39, 0x10000, v31
    v_lshlrev_b32 v40, 4, v0
    v_add_u32 v40, 131072, v40
    v_mov_b32 v41, 163328
    s_waitcnt lgkmcnt(0)
    s_mul_i32 s57, s57, 0x9e3779b1
    s_add_u32 s57, s57, 0x7f4a7c15
    s_and_b32 s58, s57, 0xffff
    s_lshr_b32 s59, s57, 16
    v_and_b32 v42, 3, v1
    v_lshlrev_b32 v42, 3, v42
    v_lshrrev_b32 v42, v42, s57
    v_bfe_u32 v4, v42, 0, 1
    v_bfe_u32 v43, v42, 1, 1
    v_lshl_or_b32 v4, v43, 16, v4
    v_bfe_u32 v5, v42, 2, 1
    v_bfe_u32 v43, v42, 3, 1
    v_lshl_or_b32 v5, v43, 16, v5
    v_bfe_u32 v6, v42, 4, 1
    v_bfe_u32 v43, v42, 5, 1
    v_lshl_or_b32 v6, v43, 16, v6
    v_bfe_u32 v7, v42, 6, 1
    v_bfe_u32 v43, v42, 7, 1
    v_lshl_or_b32 v7, v43, 16, v7
L_pv_again:
    s_waitcnt vmcnt(8)
    s_add_u32 m0, s69, 65536
    s_nop 0
    buffer_load_dwordx4 v48, s[8:11], s13 offen nt lds
    buffer_load_dwordx4 v49, s[8:11], s13 offen offset:1024 nt lds
    s_waitcnt vmcnt(8)
    s_add_u32 m0, s69, 65536
    s_nop 0
    buffer_load_dwordx4 v50, s[8:11], s13 offen offset:2048 nt lds
    buffer_load_dwordx4 v51, s[8:11], s13 offen offset:3072 nt lds
    s_waitcnt vmcnt(8)
    s_add_u32 m0, s69, 69632
    s_nop 0
    buffer_load_dwordx4 v52, s[8:11], s13 offen nt lds
    buffer_load_dwordx4 v53, s[8:11], s13 offen offset:1024 nt lds
    s_waitcnt vmcnt(8)
    s_add_u32 m0, s69, 69632
    s_nop 0
    buffer_load_dwordx4 v54, s[8:11], s13 offen offset:2048 nt lds
    buffer_load_dwordx4 v55, s[8:11], s13 offen offset:3072 nt lds
    s_waitcnt vmcnt(8)
    s_add_u32 m0, s69, 32768
    s_nop 0
    buffer_load_dwordx4 v48, s[8:11], s14 offen nt lds
    buffer_load_dwordx4 v49, s[8:11], s14 offen offset:1024 nt lds
    s_waitcnt vmcnt(8)
    s_add_u32 m0, s69, 32768
    s_nop 0
    buffer_load_dwordx4 v50, s[8:11], s14 offen offset:2048 nt lds
    buffer_load_dwordx4 v51, s[8:11], s14 offen offset:3072 nt lds
    s_waitcnt vmcnt(8)
    s_add_u32 m0, s69, 36864
    s_nop 0
    buffer_load_dwordx4 v52, s[8:11], s14 offen nt lds
    buffer_load_dwordx4 v53, s[8:11], s14 offen offset:1024 nt lds
    s_waitcnt vmcnt(8)
    s_add_u32 m0, s69, 36864
    s_nop 0
    buffer_load_dwordx4 v54, s[8:11], s14 offen offset:2048 nt lds
    buffer_load_dwordx4 v55, s[8:11], s14 offen offset:3072 nt lds
    s_waitcnt vmcnt(8)
    s_barrier
    ds_read_b64_tr_b16 v[128:129], v24 offset:0
    ds_read_b64_tr_b16 v[130:131], v25 offset:0
    ds_read_b64_tr_b16 v[136:137], v26 offset:0
    ds_read_b64_tr_b16 v[138:139], v27 offset:0
    ds_read_b64_tr_b16 v[144:145], v28 offset:0
    ds_read_b64_tr_b16 v[146:147], v29 offset:0
    ds_read_b64_tr_b16 v[152:153], v30 offset:0
    ds_read_b64_tr_b16 v[154:155], v31 offset:0
    s_waitcnt vmcnt(8)
    s_add_u32 m0, s69, 98304
    s_nop 0
    buffer_load_dwordx4 v48, s[8:11], s15 offen nt lds
    buffer_load_dwordx4 v49, s[8:11], s15 offen offset:1024 nt lds
    ds_read_b64_tr_b16 v[132:133], v24 offset:16384
    ds_read_b64_tr_b16 v[134:135], v25 offset:16384
    ds_read_b64_tr_b16 v[140:141], v26 offset:16384
    ds_read_b64_tr_b16 v[142:143], v27 offset:16384
    ds_read_b64_tr_b16 v[148:149], v28 offset:16384
    ds_read_b64_tr_b16 v[150:151], v29 offset:16384
    ds_read_b64_tr_b16 v[156:157], v30 offset:16384
    ds_read_b64_tr_b16 v[158:159], v31 offset:16384
    s_waitcnt vmcnt(8)
    s_add_u32 m0, s69, 98304
    s_nop 0
    buffer_load_dwordx4 v50, s[8:11], s15 offen offset:2048 nt lds
    buffer_load_dwordx4 v51, s[8:11], s15 offen offset:3072 nt lds
    ds_read_b64_tr_b16 v[160:161], v32 offset:0
    ds_read_b64_tr_b16 v[162:163], v33 offset:0
    ds_read_b64_tr_b16 v[168:169], v34 offset:0
    ds_read_b64_tr_b16 v[170:171], v35 offset:0
    ds_read_b64_tr_b16 v[176:177], v36 offset:0
    ds_read_b64_tr_b16 v[178:179], v37 offset:0
    ds_read_b64_tr_b16 v[184:185], v38 offset:0
    ds_read_b64_tr_b16 v[186:187], v39 offset:0
    s_waitcnt vmcnt(8)
    s_add_u32 m0, s69, 102400
    s_nop 0
    buffer_load_dwordx4 v52, s[8:11], s15 offen nt lds
    buffer_load_dwordx4 v53, s[8:11], s15 offen offset:1024 nt lds
    ds_read_b64_tr_b16 v[164:165], v32 offset:16384
    ds_read_b64_tr_b16 v[166:167], v33 offset:16384
    ds_read_b64_tr_b16 v[172:173], v34 offset:16384
    ds_read_b64_tr_b16 v[174:175], v35 offset:16384
    ds_read_b64_tr_b16 v[180:181], v36 offset:16384
    ds_read_b64_tr_b16 v[182:183], v37 offset:16384
    ds_read_b64_tr_b16 v[188:189], v38 offset:16384
    ds_read_b64_tr_b16 v[190:191], v39 offset:16384
    s_waitcnt lgkmcnt(0)
    s_barrier
    s_waitcnt vmcnt(8)
    s_add_u32 m0, s69, 102400
    s_nop 0
    buffer_load_dwordx4 v54, s[8:11], s15 offen offset:2048 nt lds
    buffer_load_dwordx4 v55, s[8:11], s15 offen offset:3072 nt lds
    s_waitcnt vmcnt(8)
    s_barrier
    ds_read_b64_tr_b16 v[192:193], v24 offset:32768
    ds_read_b64_tr_b16 v[194:195], v25 offset:32768
    ds_read_b64_tr_b16 v[200:201], v26 offset:32768
    ds_read_b64_tr_b16 v[202:203], v27 offset:32768
    ds_read_b64_tr_b16 v[208:209], v28 offset:32768
    ds_read_b64_tr_b16 v[210:211], v29 offset:32768
    ds_read_b64_tr_b16 v[216:217], v30 offset:32768
    ds_read_b64_tr_b16 v[218:219], v31 offset:32768
    ds_read_b64_tr_b16 v[196:197], v24 offset:49152
    ds_read_b64_tr_b16 v[198:199], v25 offset:49152
    ds_read_b64_tr_b16 v[204:205], v26 offset:49152
    ds_read_b64_tr_b16 v[206:207], v27 offset:49152
    ds_read_b64_tr_b16 v[212:213], v28 offset:49152
    ds_read_b64_tr_b16 v[214:215], v29 offset:49152
    ds_read_b64_tr_b16 v[220:221], v30 offset:49152
    ds_read_b64_tr_b16 v[222:223], v31 offset:49152
    s_waitcnt vmcnt(0)
    s_barrier
    ds_read_b64_tr_b16 v[224:225], v32 offset:32768
    ds_read_b64_tr_b16 v[226:227], v33 offset:32768
    ds_read_b64_tr_b16 v[232:233], v34 offset:32768
    ds_read_b64_tr_b16 v[234:235], v35 offset:32768
    ds_read_b64_tr_b16 v[240:241], v36 offset:32768
    ds_read_b64_tr_b16 v[242:243], v37 offset:32768
    ds_read_b64_tr_b16 v[248:249], v38 offset:32768
    ds_read_b64_tr_b16 v[250:251], v39 offset:32768
    ds_read_b64_tr_b16 v[228:229], v32 offset:49152
    ds_read_b64_tr_b16 v[230:231], v33 offset:49152
    ds_read_b64_tr_b16 v[236:237], v34 offset:49152
    ds_read_b64_tr_b16 v[238:239], v35 offset:49152
    ds_read_b64_tr_b16 v[244:245], v36 offset:49152
    ds_read_b64_tr_b16 v[246:247], v37 offset:49152
    ds_read_b64_tr_b16 v[252:253], v38 offset:49152
    ds_read_b64_tr_b16 v[254:255], v39 offset:49152
    s_add_u32 m0, s69, 0
    s_nop 0
    buffer_load_dwordx4 v48, s[8:11], s16 offen nt lds
    s_add_u32 m0, s69, 0
    s_nop 0
    buffer_load_dwordx4 v49, s[8:11], s16 offen offset:1024 nt lds
    s_add_u32 m0, s69, 0
    s_nop 0
    buffer_load_dwordx4 v50, s[8:11], s16 offen offset:2048 nt lds
    s_add_u32 m0, s69, 0
    s_nop 0
    buffer_load_dwordx4 v51, s[8:11], s16 offen offset:3072 nt lds
    s_add_u32 m0, s69, 4096
    s_nop 0
    buffer_load_dwordx4 v52, s[8:11], s16 offen nt lds
    s_add_u32 m0, s69, 4096
    s_nop 0
    buffer_load_dwordx4 v53, s[8:11], s16 offen offset:1024 nt lds
    s_barrier
    s_add_u32 m0, s69, 4096
    s_nop 0
    buffer_load_dwordx4 v54, s[8:11], s16 offen offset:2048 nt lds
    s_add_u32 m0, s69, 4096
    s_nop 0
    buffer_load_dwordx4 v55, s[8:11], s16 offen offset:3072 nt lds
    s_add_u32 m0, s69, 65536
    s_nop 0
    buffer_load_dwordx4 v48, s[8:11], s17 offen nt lds
    s_add_u32 m0, s69, 65536
    s_nop 0
    buffer_load_dwordx4 v49, s[8:11], s17 offen offset:1024 nt lds
    s_add_u32 m0, s69, 65536
    s_nop 0
    buffer_load_dwordx4 v50, s[8:11], s17 offen offset:2048 nt lds
    s_add_u32 m0, s69, 65536
    s_nop 0
    buffer_load_dwordx4 v51, s[8:11], s17 offen offset:3072 nt lds
    s_add_u32 m0, s69, 69632
    s_nop 0
    buffer_load_dwordx4 v52, s[8:11], s17 offen nt lds
    s_add_u32 m0, s69, 69632
    s_nop 0
    buffer_load_dwordx4 v53, s[8:11], s17 offen offset:1024 nt lds
    s_add_u32 m0, s69, 69632
    s_nop 0
    buffer_load_dwordx4 v54, s[8:11], s17 offen offset:2048 nt lds
    s_add_u32 m0, s69, 69632
    s_nop 0
    buffer_load_dwordx4 v55, s[8:11], s17 offen offset:3072 nt lds
    s_waitcnt lgkmcnt(0)
    s_barrier
    s_add_u32 m0, s69, 32768
    s_nop 0
    buffer_load_dwordx4 v48, s[8:11], s18 offen nt lds
    s_add_u32 m0, s69, 32768
    s_nop 0
    buffer_load_dwordx4 v49, s[8:11], s18 offen offset:1024 nt lds
    s_add_u32 m0, s69, 32768
    s_nop 0
    buffer_load_dwordx4 v50, s[8:11], s18 offen offset:2048 nt lds
    s_add_u32 m0, s69, 32768
    s_nop 0
    buffer_load_dwordx4 v51, s[8:11], s18 offen offset:3072 nt lds
    s_waitcnt vmcnt(4)
    s_barrier
    ds_read_b128 v[8:11], v40 offset:0
    ds_read_b128 v[12:15], v40 offset:1024
    ds_read_b128 v[16:19], v40 offset:2048
    ds_read_b128 v[20:23], v40 offset:3072
    s_waitcnt lgkmcnt(0)
    v_mfma_f32_32x32x16_bf16 v[64:79], v[8:11], v[128:131], v[64:79]
    s_add_u32 m0, s69, 36864
    s_nop 0
    buffer_load_dwordx4 v52, s[8:11], s18 offen nt lds
    v_mfma_f32_32x32x16_bf16 v[80:95], v[8:11], v[136:139], v[80:95]
    s_add_u32 m0, s69, 36864
    s_nop 0
    buffer_load_dwordx4 v53, s[8:11], s18 offen offset:1024 nt lds
    v_mfma_f32_32x32x16_bf16 v[96:111], v[8:11], v[144:147], v[96:111]
    s_add_u32 m0, s69, 36864
    s_nop 0
    buffer_load_dwordx4 v54, s[8:11], s18 offen offset:2048 nt lds
    v_mfma_f32_32x32x16_bf16 v[112:127], v[8:11], v[152:155], v[112:127]
    s_add_u32 m0, s69, 36864
    s_nop 0
    buffer_load_dwordx4 v55, s[8:11], s18 offen offset:3072 nt lds
    v_mfma_f32_32x32x16_bf16 v[64:79], v[12:15], v[132:135], v[64:79]
    s_add_u32 m0, s69, 98304
    s_nop 0
    buffer_load_dwordx4 v48, s[8:11], s19 offen nt lds
    v_mfma_f32_32x32x16_bf16 v[80:95], v[12:15], v[140:143], v[80:95]
    s_add_u32 m0, s69, 98304
    s_nop 0
    buffer_load_dwordx4 v49, s[8:11], s19 offen offset:1024 nt lds
    v_mfma_f32_32x32x16_bf16 v[96:111], v[12:15], v[148:151], v[96:111]
    s_add_u32 m0, s69, 98304
    s_nop 0
    buffer_load_dwordx4 v50, s[8:11], s19 offen offset:2048 nt lds
    v_mfma_f32_32x32x16_bf16 v[112:127], v[12:15], v[156:159], v[112:127]
    s_add_u32 m0, s69, 98304
    s_nop 0
    buffer_load_dwordx4 v51, s[8:11], s19 offen offset:3072 nt lds
    v_mfma_f32_32x32x16_bf16 v[64:79], v[16:19], v[160:163], v[64:79]
    v_mfma_f32_32x32x16_bf16 v[80:95], v[16:19], v[168:171], v[80:95]
    v_mfma_f32_32x32x16_bf16 v[96:111], v[16:19], v[176:179], v[96:111]
    v_mfma_f32_32x32x16_bf16 v[112:127], v[16:19], v[184:187], v[112:127]
    v_mfma_f32_32x32x16_bf16 v[64:79], v[20:23], v[164:167], v[64:79]
    s_waitcnt vmcnt(12)
    s_barrier
    ds_read_b128 v[8:11], v40 offset:4096
    ds_read_b128 v[12:15], v40 offset:5120
    ds_read_b128 v[16:19], v40 offset:6144
    ds_read_b128 v[60:63], v40 offset:7168
    v_mfma_f32_32x32x16_bf16 v[80:95], v[20:23], v[172:175], v[80:95]
    v_mfma_f32_32x32x16_bf16 v[96:111], v[20:23], v[180:183], v[96:111]
    v_mfma_f32_32x32x16_bf16 v[112:127], v[20:23], v[188:191], v[112:127]
    s_waitcnt lgkmcnt(0)
    v_mfma_f32_32x32x16_bf16 v[64:79], v[8:11], v[192:195], v[64:79]
    s_add_u32 m0, s69, 102400
    s_nop 0
    buffer_load_dwordx4 v52, s[8:11], s19 offen nt lds
    s_add_u32 m0, s69, 102400
    s_nop 0
    buffer_load_dwordx4 v53, s[8:11], s19 offen offset:1024 nt lds
    s_add_u32 m0, s69, 102400
    s_nop 0
    buffer_load_dwordx4 v54, s[8:11], s19 offen offset:2048 nt lds
    v_mfma_f32_32x32x16_bf16 v[80:95], v[8:11], v[200:203], v[80:95]
    s_add_u32 m0, s69, 102400
    s_nop 0
    buffer_load_dwordx4 v55, s[8:11], s19 offen offset:3072 nt lds
    ds_read_b64_tr_b16 v[128:129], v24 offset:0
    ds_read_b64_tr_b16 v[130:131], v25 offset:0
    v_mfma_f32_32x32x16_bf16 v[96:111], v[8:11], v[208:211], v[96:111]
    ds_read_b64_tr_b16 v[136:137], v26 offset:0
    ds_read_b64_tr_b16 v[138:139], v27 offset:0
    ds_read_b64_tr_b16 v[144:145], v28 offset:0
    v_mfma_f32_32x32x16_bf16 v[112:127], v[8:11], v[216:219], v[112:127]
    ds_read_b64_tr_b16 v[146:147], v29 offset:0
    ds_read_b64_tr_b16 v[152:153], v30 offset:0
    ds_read_b64_tr_b16 v[154:155], v31 offset:0
    v_mfma_f32_32x32x16_bf16 v[64:79], v[12:15], v[196:199], v[64:79]
    ds_read_b64_tr_b16 v[132:133], v24 offset:16384
    ds_read_b64_tr_b16 v[134:135], v25 offset:16384
    v_mfma_f32_32x32x16_bf16 v[80:95], v[12:15], v[204:207], v[80:95]
    ds_read_b64_tr_b16 v[140:141], v26 offset:16384
    ds_read_b64_tr_b16 v[142:143], v27 offset:16384
    ds_read_b64_tr_b16 v[148:149], v28 offset:16384
    v_mfma_f32_32x32x16_bf16 v[96:111], v[12:15], v[212:215], v[96:111]
    ds_read_b64_tr_b16 v[150:151], v29 offset:16384
    ds_read_b64_tr_b16 v[156:157], v30 offset:16384
    ds_read_b64_tr_b16 v[158:159], v31 offset:16384
    v_mfma_f32_32x32x16_bf16 v[112:127], v[12:15], v[220:223], v[112:127]
    ds_read_b64_tr_b16 v[160:161], v32 offset:0
    ds_read_b64_tr_b16 v[162:163], v33 offset:0
    ds_read_b64_tr_b16 v[168:169], v34 offset:0
    v_mfma_f32_32x32x16_bf16 v[64:79], v[16:19], v[224:227], v[64:79]
    ds_read_b64_tr_b16 v[170:171], v35 offset:0
    ds_read_b64_tr_b16 v[176:177], v36 offset:0
    v_mfma_f32_32x32x16_bf16 v[80:95], v[16:19], v[232:235], v[80:95]
    ds_read_b64_tr_b16 v[178:179], v37 offset:0
    ds_read_b64_tr_b16 v[184:185], v38 offset:0
    ds_read_b64_tr_b16 v[186:187], v39 offset:0
    v_mfma_f32_32x32x16_bf16 v[96:111], v[16:19], v[240:243], v[96:111]
    ds_read_b64_tr_b16 v[164:165], v32 offset:16384
    ds_read_b64_tr_b16 v[166:167], v33 offset:16384
    ds_read_b64_tr_b16 v[172:173], v34 offset:16384
    v_mfma_f32_32x32x16_bf16 v[112:127], v[16:19], v[248:251], v[112:127]
    ds_read_b64_tr_b16 v[174:175], v35 offset:16384
    ds_read_b64_tr_b16 v[180:181], v36 offset:16384
    ds_read_b64_tr_b16 v[182:183], v37 offset:16384
    v_mfma_f32_32x32x16_bf16 v[64:79], v[60:63], v[228:231], v[64:79]
    ds_read_b64_tr_b16 v[188:189], v38 offset:16384
    ds_read_b64_tr_b16 v[190:191], v39 offset:16384
    s_waitcnt vmcnt(8)
    s_waitcnt lgkmcnt(0)
    s_barrier
    ds_read_b128 v[8:11], v40 offset:0
    ds_read_b128 v[12:15], v40 offset:1024
    ds_read_b128 v[16:19], v40 offset:2048
    ds_read_b128 v[20:23], v40 offset:3072
    v_mfma_f32_32x32x16_bf16 v[80:95], v[60:63], v[236:239], v[80:95]
    v_mfma_f32_32x32x16_bf16 v[96:111], v[60:63], v[244:247], v[96:111]
    v_mfma_f32_32x32x16_bf16 v[112:127], v[60:63], v[252:255], v[112:127]
    s_waitcnt lgkmcnt(0)
    v_mfma_f32_32x32x16_bf16 v[64:79], v[8:11], v[128:131], v[64:79]
    ds_read_b64_tr_b16 v[192:193], v24 offset:32768
    ds_read_b64_tr_b16 v[194:195], v25 offset:32768
    v_mfma_f32_32x32x16_bf16 v[80:95], v[8:11], v[136:139], v[80:95]
    ds_read_b64_tr_b16 v[200:201], v26 offset:32768
    ds_read_b64_tr_b16 v[202:203], v27 offset:32768
    v_mfma_f32_32x32x16_bf16 v[96:111], v[8:11], v[144:147], v[96:111]
    ds_read_b64_tr_b16 v[208:209], v28 offset:32768
    v_mfma_f32_32x32x16_bf16 v[112:127], v[8:11], v[152:155], v[112:127]
    ds_read_b64_tr_b16 v[210:211], v29 offset:32768
    ds_read_b64_tr_b16 v[216:217], v30 offset:32768
    v_mfma_f32_32x32x16_bf16 v[64:79], v[12:15], v[132:135], v[64:79]
    ds_read_b64_tr_b16 v[218:219], v31 offset:32768
    v_mfma_f32_32x32x16_bf16 v[80:95], v[12:15], v[140:143], v[80:95]
    ds_read_b64_tr_b16 v[196:197], v24 offset:49152
    ds_read_b64_tr_b16 v[198:199], v25 offset:49152
    v_mfma_f32_32x32x16_bf16 v[96:111], v[12:15], v[148:151], v[96:111]
    ds_read_b64_tr_b16 v[204:205], v26 offset:49152
    ds_read_b64_tr_b16 v[206:207], v27 offset:49152
    v_mfma_f32_32x32x16_bf16 v[112:127], v[12:15], v[156:159], v[112:127]
    ds_read_b64_tr_b16 v[212:213], v28 offset:49152
    v_mfma_f32_32x32x16_bf16 v[64:79], v[16:19], v[160:163], v[64:79]
    ds_read_b64_tr_b16 v[214:215], v29 offset:49152
    ds_read_b64_tr_b16 v[220:221], v30 offset:49152
    v_mfma_f32_32x32x16_bf16 v[80:95], v[16:19], v[168:171], v[80:95]
    ds_read_b64_tr_b16 v[222:223], v31 offset:49152
    s_waitcnt vmcnt(0)
    s_barrier
    ds_read_b128 v[8:11], v40 offset:4096
    ds_read_b128 v[12:15], v40 offset:5120
    v_mfma_f32_32x32x16_bf16 v[96:111], v[16:19], v[176:179], v[96:111]
    v_mfma_f32_32x32x16_bf16 v[112:127], v[16:19], v[184:187], v[112:127]
    v_mfma_f32_32x32x16_bf16 v[64:79], v[20:23], v[164:167], v[64:79]
    v_mfma_f32_32x32x16_bf16 v[80:95], v[20:23], v[172:175], v[80:95]
    v_mfma_f32_32x32x16_bf16 v[96:111], v[20:23], v[180:183], v[96:111]
    v_mfma_f32_32x32x16_bf16 v[112:127], v[20:23], v[188:191], v[112:127]
    s_waitcnt lgkmcnt(0)
    v_mfma_f32_32x32x16_bf16 v[64:79], v[8:11], v[192:195], v[64:79]
    ds_read_b64_tr_b16 v[224:225], v32 offset:32768
    ds_read_b64_tr_b16 v[226:227], v33 offset:32768
    ds_read_b64_tr_b16 v[232:233], v34 offset:32768
    v_mfma_f32_32x32x16_bf16 v[80:95], v[8:11], v[200:203], v[80:95]
    ds_read_b64_tr_b16 v[234:235], v35 offset:32768
    ds_read_b64_tr_b16 v[240:241], v36 offset:32768
    ds_read_b64_tr_b16 v[242:243], v37 offset:32768
    v_mfma_f32_32x32x16_bf16 v[96:111], v[8:11], v[208:211], v[96:111]
    ds_read_b64_tr_b16 v[248:249], v38 offset:32768
    ds_read_b64_tr_b16 v[250:251], v39 offset:32768
    v_mfma_f32_32x32x16_bf16 v[112:127], v[8:11], v[216:219], v[112:127]
    ds_read_b64_tr_b16 v[228:229], v32 offset:49152
    ds_read_b64_tr_b16 v[230:231], v33 offset:49152
    ds_read_b64_tr_b16 v[236:237], v34 offset:49152
    v_mfma_f32_32x32x16_bf16 v[64:79], v[12:15], v[196:199], v[64:79]
    ds_read_b64_tr_b16 v[238:239], v35 offset:49152
    ds_read_b64_tr_b16 v[244:245], v36 offset:49152
    ds_read_b64_tr_b16 v[246:247], v37 offset:49152
    v_mfma_f32_32x32x16_bf16 v[80:95], v[12:15], v[204:207], v[80:95]
    ds_read_b64_tr_b16 v[252:253], v38 offset:49152
    ds_read_b64_tr_b16 v[254:255], v39 offset:49152
    v_lshrrev_b32 v44, 1, v2
    v_and_b32 v45, 1, v2
    v_lshl_add_u32 v44, v44, 2, v45
    v_lshlrev_b32 v44, 17, v44
    v_lshl_add_u32 v44, v1, 4, v44
    s_lshl_b32 s65, s79, 15
    s_lshl_b32 s66, s55, 8
    s_add_u32 s65, s65, s66
    s_add_u32 s65, s65, 4194304
    s_mov_b32 s67, 0x00010001
    s_barrier
    ds_read_b32 v42, v41
    ds_read_b128 v[16:19], v40 offset:6144
    ds_read_b128 v[60:63], v40 offset:7168
    v_mfma_f32_32x32x16_bf16 v[96:111], v[12:15], v[212:215], v[96:111]
    v_mfma_f32_32x32x16_bf16 v[112:127], v[12:15], v[220:223], v[112:127]
    s_waitcnt lgkmcnt(0)
    v_readfirstlane_b32 s64, v42
    s_cmp_lg_u32 s64, 0
    s_cbranch_scc1 L_pv_redo
    v_mfma_f32_32x32x16_bf16 v[64:79], v[16:19], v[224:227], v[64:79]
    v_mfma_f32_32x32x16_bf16 v[80:95], v[16:19], v[232:235], v[80:95]
    v_mfma_f32_32x32x16_bf16 v[96:111], v[16:19], v[240:243], v[96:111]
    v_mfma_f32_32x32x16_bf16 v[112:127], v[16:19], v[248:251], v[112:127]
    v_mfma_f32_32x32x16_bf16 v[64:79], v[60:63], v[228:231], v[64:79]
    v_mfma_f32_32x32x16_bf16 v[80:95], v[60:63], v[236:239], v[80:95]
    v_mfma_f32_32x32x16_bf16 v[96:111], v[60:63], v[244:247], v[96:111]
    v_mfma_f32_32x32x16_bf16 v[112:127], v[60:63], v[252:255], v[112:127]
    s_nop 9
    v_cvt_pk_bf16_f32 v160, v64, v80
    v_cvt_pk_bf16_f32 v161, v65, v81
    v_cvt_pk_bf16_f32 v162, v96, v112
    v_cvt_pk_bf16_f32 v163, v97, v113
    s_barrier
    v_cvt_pk_bf16_f32 v164, v66, v82
    v_cvt_pk_bf16_f32 v165, v67, v83
    v_cvt_pk_bf16_f32 v166, v98, v114
    v_cvt_pk_bf16_f32 v167, v99, v115
    v_permlane16_swap_b32 v160, v161
    v_permlane16_swap_b32 v162, v163
    v_bfi_b32 v160, s67, v4, v160
    v_bfi_b32 v161, s67, v5, v161
    v_bfi_b32 v162, s67, v6, v162
    v_bfi_b32 v163, s67, v7, v163
    s_add_u32 s66, s65, 0
    buffer_store_dwordx4 v[160:163], v44, s[48:51], s66 offen sc1
    v_cvt_pk_bf16_f32 v168, v68, v84
    v_cvt_pk_bf16_f32 v169, v69, v85
    v_cvt_pk_bf16_f32 v170, v100, v116
    v_cvt_pk_bf16_f32 v171, v101, v117
    v_permlane16_swap_b32 v164, v165
    v_permlane16_swap_b32 v166, v167
    v_bfi_b32 v164, s67, v4, v164
    v_bfi_b32 v165, s67, v5, v165
    v_bfi_b32 v166, s67, v6, v166
    v_bfi_b32 v167, s67, v7, v167
    s_add_u32 s66, s65, 262144
    buffer_store_dwordx4 v[164:167], v44, s[48:51], s66 offen sc1
    v_cvt_pk_bf16_f32 v172, v70, v86
    v_cvt_pk_bf16_f32 v173, v71, v87
    v_cvt_pk_bf16_f32 v174, v102, v118
    v_cvt_pk_bf16_f32 v175, v103, v119
    v_permlane16_swap_b32 v168, v169
    v_permlane16_swap_b32 v170, v171
    v_bfi_b32 v168, s67, v4, v168
    v_bfi_b32 v169, s67, v5, v169
    v_bfi_b32 v170, s67, v6, v170
    v_bfi_b32 v171, s67, v7, v171
    s_add_u32 s66, s65, 1048576
    buffer_store_dwordx4 v[168:171], v44, s[48:51], s66 offen sc1
    v_cvt_pk_bf16_f32 v176, v72, v88
    v_cvt_pk_bf16_f32 v177, v73, v89
    v_cvt_pk_bf16_f32 v178, v104, v120
    v_cvt_pk_bf16_f32 v179, v105, v121
    v_permlane16_swap_b32 v172, v173
    v_permlane16_swap_b32 v174, v175
    v_bfi_b32 v172, s67, v4, v172
    v_bfi_b32 v173, s67, v5, v173
    v_bfi_b32 v174, s67, v6, v174
    v_bfi_b32 v175, s67, v7, v175
    s_add_u32 s66, s65, 1310720
    buffer_store_dwordx4 v[172:175], v44, s[48:51], s66 offen sc1
    v_cvt_pk_bf16_f32 v180, v74, v90
    v_cvt_pk_bf16_f32 v181, v75, v91
    v_cvt_pk_bf16_f32 v182, v106, v122
    v_cvt_pk_bf16_f32 v183, v107, v123
    v_permlane16_swap_b32 v176, v177
    v_permlane16_swap_b32 v178, v179
    v_bfi_b32 v176, s67, v4, v176
    v_bfi_b32 v177, s67, v5, v177
    v_bfi_b32 v178, s67, v6, v178
    v_bfi_b32 v179, s67, v7, v179
    s_add_u32 s66, s65, 2097152
    buffer_store_dwordx4 v[176:179], v44, s[48:51], s66 offen sc1
    v_cvt_pk_bf16_f32 v184, v76, v92
    v_cvt_pk_bf16_f32 v185, v77, v93
    v_cvt_pk_bf16_f32 v186, v108, v124
    v_cvt_pk_bf16_f32 v187, v109, v125
    v_permlane16_swap_b32 v180, v181
    v_permlane16_swap_b32 v182, v183
    v_bfi_b32 v180, s67, v4, v180
    v_bfi_b32 v181, s67, v5, v181
    v_bfi_b32 v182, s67, v6, v182
    v_bfi_b32 v183, s67, v7, v183
    s_add_u32 s66, s65, 2359296
    buffer_store_dwordx4 v[180:183], v44, s[48:51], s66 offen sc1
    v_cvt_pk_bf16_f32 v188, v78, v94
    v_cvt_pk_bf16_f32 v189, v79, v95
    v_cvt_pk_bf16_f32 v190, v110, v126
    v_cvt_pk_bf16_f32 v191, v111, v127
    v_permlane16_swap_b32 v184, v185
    v_permlane16_swap_b32 v186, v187
    v_bfi_b32 v184, s67, v4, v184
    v_bfi_b32 v185, s67, v5, v185
    v_bfi_b32 v186, s67, v6, v186
    v_bfi_b32 v187, s67, v7, v187
    s_add_u32 s66, s65, 3145728
    buffer_store_dwordx4 v[184:187], v44, s[48:51], s66 offen sc1
    v_permlane16_swap_b32 v188, v189
    v_permlane16_swap_b32 v190, v191
    v_bfi_b32 v188, s67, v4, v188
    v_bfi_b32 v189, s67, v5, v189
    v_bfi_b32 v190, s67, v6, v190
    v_bfi_b32 v191, s67, v7, v191
    s_add_u32 s66, s65, 3407872
    buffer_store_dwordx4 v[188:191], v44, s[48:51], s66 offen sc1
    s_branch L_att_post
L_pv_redo:
    s_waitcnt vmcnt(0) lgkmcnt(0)
    s_barrier
    s_mov_b32 s72, 1
    s_nop 7
    s_branch L_pv_start
L_qk:
    s_load_dword s57, s[48:49], 0
    s_load_dwordx2 s[28:29], s[0:1], 56
    s_load_dwordx2 s[32:33], s[0:1], 64
    s_load_dwordx2 s[24:25], s[0:1], 40
    s_mov_b32 s30, 1835008
    s_mov_b32 s31, 0x00020000
    s_mov_b32 s34, 1835008
    s_mov_b32 s35, 0x00020000
    s_mov_b32 s26, 4194304
    s_mov_b32 s27, 0x00020000
    v_and_b32 v32, 3, v1
    v_lshlrev_b32 v32, 2, v32
    v_lshrrev_b32 v33, 2, v1
    v_lshlrev_b32 v33, 1, v33
    v_mov_b32 v34, 120
    v_lshrrev_b32 v33, v33, v34
    v_and_b32 v33, 3, v33
    v_or_b32 v32, v32, v33
    v_xor_b32 v32, v32, v2
    v_lshlrev_b32 v33, 10, v1
    s_and_b32 s64, s56, 1
    s_lshl_b32 s64, s64, 14
    s_lshr_b32 s65, s56, 1
    s_lshl_b32 s65, s65, 16
    s_add_u32 s64, s64, s65
    v_add_u32 v33, s64, v33
    v_xor_b32 v48, 0, v32
    v_lshl_add_u32 v48, v48, 4, v33
    v_xor_b32 v49, 4, v32
    v_lshl_add_u32 v49, v49, 4, v33
    v_xor_b32 v50, 8, v32
    v_lshl_add_u32 v50, v50, 4, v33
    v_xor_b32 v51, 12, v32
    v_lshl_add_u32 v51, v51, 4, v33
    v_add_u32 v30, 131072, v16
    v_lshlrev_b32 v53, 4, v0
    v_add_u32 v53, 131072, v53
    v_lshlrev_b32 v55, 4, v1
    v_add_u32 v55, 162816, v55
    v_and_b32 v54, 31, v0
    v_lshlrev_b32 v54, 4, v54
    s_lshl_b32 s64, s56, 2
    s_add_u32 s64, s64, 162816
    v_add_u32 v54, s64, v54
    v_mov_b32 v31, 163328
    v_lshlrev_b32 v52, 6, v1
    v_lshl_add_u32 v52, v2, 4, v52
    s_lshl_b32 s64, s56, 12
    v_add_u32 v57, s64, v53
    s_waitcnt lgkmcnt(0)
    s_mul_i32 s57, s57, 0x9e3779b1
    s_add_u32 s57, s57, 0x7f4a7c15
    s_and_b32 s58, s57, 0xffff
    s_lshr_b32 s59, s57, 16
    s_mov_b32 s72, 0
L_qk_start:
    v_mov_b32 v26, 0
    v_mov_b32 v27, 0
    v_mov_b32 v28, 0
    v_mov_b32 v29, 0
    v_mov_b32 v40, 0
    v_mov_b32 v41, 0
    ds_write_b64 v31, v[40:41]
    s_barrier
    ds_read_b128 v[192:195], v48 offset:0
    ds_read_b128 v[196:199], v49 offset:0
    ds_read_b128 v[200:203], v50 offset:0
    ds_read_b128 v[204:207], v51 offset:0
    ds_read_b128 v[208:211], v48 offset:256
    ds_read_b128 v[212:215], v49 offset:256
    ds_read_b128 v[216:219], v50 offset:256
    ds_read_b128 v[220:223], v51 offset:256
    ds_read_b128 v[224:227], v48 offset:512
    ds_read_b128 v[228:231], v49 offset:512
    ds_read_b128 v[232:235], v50 offset:512
    ds_read_b128 v[236:239], v51 offset:512
    ds_read_b128 v[240:243], v48 offset:768
    ds_read_b128 v[244:247], v49 offset:768
    ds_read_b128 v[248:251], v50 offset:768
    ds_read_b128 v[252:255], v51 offset:768
    s_waitcnt lgkmcnt(0)
    s_barrier
    s_cmp_lg_u32 s72, 0
    s_cbranch_scc1 L_noq
    s_lshl_b32 s64, s55, 7
    s_add_u32 s64, s64, 98304
    s_not_b32 s65, s57
    s_lshl_b32 s68, s52, 18
    s_add_u32 s68, s68, 2097152
    s_add_u32 s78, s68, 31744
    s_lshl_b32 s69, s56, 12
    s_add_u32 s68, s68, s69
    s_add_u32 s69, s68, 16384
    s_mov_b32 s63, 60000
    s_cmp_lg_u32 s56, 0
    s_cbranch_scc1 foll_58
poll_57:
    s_load_dwordx16 s[8:23], s[48:49], s64 glc
    s_waitcnt lgkmcnt(0)
    s_mov_b32 s66, s57
    s_mov_b32 s67, s65
    s_xor_b64 s[8:9], s[8:9], s[66:67]
    s_xor_b64 s[10:11], s[10:11], s[66:67]
    s_xor_b64 s[12:13], s[12:13], s[66:67]
    s_xor_b64 s[14:15], s[14:15], s[66:67]
    s_xor_b64 s[16:17], s[16:17], s[66:67]
    s_xor_b64 s[18:19], s[18:19], s[66:67]
    s_xor_b64 s[20:21], s[20:21], s[66:67]
    s_xor_b64 s[22:23], s[22:23], s[66:67]
    s_or_b64 s[8:9], s[8:9], s[16:17]
    s_or_b64 s[10:11], s[10:11], s[18:19]
    s_or_b64 s[12:13], s[12:13], s[20:21]
    s_or_b64 s[14:15], s[14:15], s[22:23]
    s_or_b64 s[8:9], s[8:9], s[12:13]
    s_or_b64 s[10:11], s[10:11], s[14:15]
    s_or_b64 s[8:9], s[8:9], s[10:11]
    s_cbranch_scc0 seen_59
    s_sub_u32 s63, s63, 1
    s_cbranch_scc0 poll_57
seen_59:
    ds_write_b32 v31, v31 offset:4
foll_58:
    s_barrier
    buffer_load_dwordx4 v[156:159], v52, s[48:51], s68 offen offset:0 sc1
    buffer_load_dwordx4 v[160:163], v52, s[48:51], s68 offen offset:1024 sc1
    buffer_load_dwordx4 v[164:167], v52, s[48:51], s68 offen offset:2048 sc1
    buffer_load_dwordx4 v[168:171], v52, s[48:51], s68 offen offset:3072 sc1
    buffer_load_dwordx4 v[172:175], v52, s[48:51], s69 offen offset:0 sc1
    buffer_load_dwordx4 v[176:179], v52, s[48:51], s69 offen offset:1024 sc1
    buffer_load_dwordx4 v[180:183], v52, s[48:51], s69 offen offset:2048 sc1
    buffer_load_dwordx4 v[184:187], v52, s[48:51], s69 offen offset:3072 sc1
    buffer_load_dwordx4 v[188:191], v52, s[48:51], s78 offen sc1
    s_barrier
    s_waitcnt vmcnt(8)
    ds_write_b128 v57, v[156:159] offset:0
    s_waitcnt vmcnt(7)
    ds_write_b128 v57, v[160:163] offset:1024
    s_waitcnt vmcnt(6)
    ds_write_b128 v57, v[164:167] offset:2048
    s_waitcnt vmcnt(5)
    ds_write_b128 v57, v[168:171] offset:3072
    s_waitcnt vmcnt(4)
    ds_write_b128 v57, v[172:175] offset:16384
    s_waitcnt vmcnt(3)
    ds_write_b128 v57, v[176:179] offset:17408
    s_waitcnt vmcnt(2)
    ds_write_b128 v57, v[180:183] offset:18432
    s_waitcnt vmcnt(1)
    s_cmp_eq_u32 s56, 3
    s_cbranch_scc1 wi_60
    ds_write_b128 v57, v[184:187] offset:19456
wi_60:
    s_mov_b32 s63, 60000
    s_waitcnt vmcnt(0)
poll_62:
    v_max3_u32 v40, v156, v160, v164
    v_max3_u32 v40, v40, v168, v172
    v_max3_u32 v40, v40, v176, v180
    v_max3_u32 v40, v40, v184, v188
    v_cmp_eq_u32 vcc, -1, v40
    s_cbranch_vccz pdone_63
    v_cmp_eq_u32 vcc, -1, v156
    s_cbranch_vccz qn_64
    buffer_load_dwordx4 v[156:159], v52, s[48:51], s68 offen offset:0 sc1
qn_64:
    v_cmp_eq_u32 vcc, -1, v160
    s_cbranch_vccz qn_65
    buffer_load_dwordx4 v[160:163], v52, s[48:51], s68 offen offset:1024 sc1
qn_65:
    v_cmp_eq_u32 vcc, -1, v164
    s_cbranch_vccz qn_66
    buffer_load_dwordx4 v[164:167], v52, s[48:51], s68 offen offset:2048 sc1
qn_66:
    v_cmp_eq_u32 vcc, -1, v168
    s_cbranch_vccz qn_67
    buffer_load_dwordx4 v[168:171], v52, s[48:51], s68 offen offset:3072 sc1
qn_67:
    v_cmp_eq_u32 vcc, -1, v172
    s_cbranch_vccz qn_68
    buffer_load_dwordx4 v[172:175], v52, s[48:51], s69 offen offset:0 sc1
qn_68:
    v_cmp_eq_u32 vcc, -1, v176
    s_cbranch_vccz qn_69
    buffer_load_dwordx4 v[176:179], v52, s[48:51], s69 offen offset:1024 sc1
qn_69:
    v_cmp_eq_u32 vcc, -1, v180
    s_cbranch_vccz qn_70
    buffer_load_dwordx4 v[180:183], v52, s[48:51], s69 offen offset:2048 sc1
qn_70:
    v_cmp_eq_u32 vcc, -1, v184
    s_cbranch_vccz qn_71
    buffer_load_dwordx4 v[184:187], v52, s[48:51], s69 offen offset:3072 sc1
qn_71:
    v_cmp_eq_u32 vcc, -1, v188
    s_cbranch_vccz qn_72
    buffer_load_dwordx4 v[188:191], v52, s[48:51], s78 offen sc1
qn_72:
    s_waitcnt vmcnt(0)
    ds_write_b128 v57, v[156:159] offset:0
    ds_write_b128 v57, v[160:163] offset:1024
    ds_write_b128 v57, v[164:167] offset:2048
    ds_write_b128 v57, v[168:171] offset:3072
    ds_write_b128 v57, v[172:175] offset:16384
    ds_write_b128 v57, v[176:179] offset:17408
    ds_write_b128 v57, v[180:183] offset:18432
    s_cmp_eq_u32 s56, 3
    s_cbranch_scc1 wi_73
    ds_write_b128 v57, v[184:187] offset:19456
wi_73:
    s_sub_u32 s63, s63, 1
    s_cbranch_scc0 poll_62
pdone_63:
    s_branch L_go
L_noq:
    s_barrier
    s_barrier
    ds_write_b128 v53, v[64:67] offset:0
    ds_write_b128 v53, v[68:71] offset:1024
    ds_write_b128 v53, v[72:75] offset:2048
    ds_write_b128 v53, v[76:79] offset:3072
    ds_write_b128 v53, v[80:83] offset:4096
    ds_write_b128 v53, v[84:87] offset:5120
    ds_write_b128 v53, v[88:91] offset:6144
    ds_write_b128 v53, v[92:95] offset:7168
    ds_write_b128 v53, v[96:99] offset:8192
    ds_write_b128 v53, v[100:103] offset:9216
    ds_write_b128 v53, v[104:107] offset:10240
    ds_write_b128 v53, v[108:111] offset:11264
    ds_write_b128 v53, v[112:115] offset:12288
    ds_write_b128 v53, v[116:119] offset:13312
    ds_write_b128 v53, v[120:123] offset:14336
    ds_write_b128 v53, v[124:127] offset:15360
    ds_write_b128 v53, v[128:131] offset:16384
    ds_write_b128 v53, v[132:135] offset:17408
    ds_write_b128 v53, v[136:139] offset:18432
    ds_write_b128 v53, v[140:143] offset:19456
    ds_write_b128 v53, v[144:147] offset:20480
    ds_write_b128 v53, v[148:151] offset:21504
    ds_write_b128 v53, v[152:155] offset:22528
    ds_write_b128 v53, v[156:159] offset:23552
    ds_write_b128 v53, v[160:163] offset:24576
    ds_write_b128 v53, v[164:167] offset:25600
    ds_write_b128 v53, v[168:171] offset:26624
    ds_write_b128 v53, v[172:175] offset:27648
    ds_write_b128 v53, v[176:179] offset:28672
    ds_write_b128 v53, v[180:183] offset:29696
    ds_write_b128 v53, v[184:187] offset:30720
L_go:
    s_mov_b32 s66, 0x3db504f3
    s_mov_b32 s67, 0x3fb8aa3b
    s_mov_b32 s65, 0x42800000
    s_setprio 1
    s_waitcnt lgkmcnt(0)
    s_barrier
    ds_read_b128 v[64:67], v53 offset:0
    ds_read_b128 v[128:131], v53 offset:16384
    ds_read_b128 v[68:71], v53 offset:1024
    ds_read_b128 v[132:135], v53 offset:17408
    ds_read_b128 v[72:75], v53 offset:2048
    ds_read_b128 v[136:139], v53 offset:18432
    ds_read_b128 v[76:79], v53 offset:3072
    ds_read_b128 v[140:143], v53 offset:19456
    s_waitcnt lgkmcnt(7)
    v_mfma_f32_16x16x32_bf16 v[8:11], v[192:195], v[64:67], 0
    ds_read_b128 v[80:83], v53 offset:4096
    s_waitcnt lgkmcnt(7)
    v_mfma_f32_16x16x32_bf16 v[12:15], v[192:195], v[128:131], 0
    ds_read_b128 v[144:147], v53 offset:20480
    s_waitcnt lgkmcnt(7)
    v_mfma_f32_16x16x32_bf16 v[8:11], v[196:199], v[68:71], v[8:11]
    ds_read_b128 v[84:87], v53 offset:5120
    s_waitcnt lgkmcnt(7)
    v_mfma_f32_16x16x32_bf16 v[12:15], v[196:199], v[132:135], v[12:15]
    ds_read_b128 v[148:151], v53 offset:21504
    s_waitcnt lgkmcnt(7)
    v_mfma_f32_16x16x32_bf16 v[8:11], v[200:203], v[72:75], v[8:11]
    ds_read_b128 v[88:91], v53 offset:6144
    s_waitcnt lgkmcnt(7)
    v_mfma_f32_16x16x32_bf16 v[12:15], v[200:203], v[136:139], v[12:15]
    ds_read_b128 v[152:155], v53 offset:22528
    s_waitcnt lgkmcnt(7)
    v_mfma_f32_16x16x32_bf16 v[8:11], v[204:207], v[76:79], v[8:11]
    ds_read_b128 v[92:95], v53 offset:7168
    s_waitcnt lgkmcnt(7)
    v_mfma_f32_16x16x32_bf16 v[12:15], v[204:207], v[140:143], v[12:15]
    ds_read_b128 v[156:159], v53 offset:23552
    s_waitcnt lgkmcnt(7)
    v_mfma_f32_16x16x32_bf16 v[8:11], v[208:211], v[80:83], v[8:11]
    ds_read_b128 v[96:99], v53 offset:8192
    s_waitcnt lgkmcnt(7)
    v_mfma_f32_16x16x32_bf16 v[12:15], v[208:211], v[144:147], v[12:15]
    ds_read_b128 v[160:163], v53 offset:24576
    s_waitcnt lgkmcnt(7)
    v_mfma_f32_16x16x32_bf16 v[8:11], v[212:215], v[84:87], v[8:11]
    ds_read_b128 v[100:103], v53 offset:9216
    s_waitcnt lgkmcnt(7)
    v_mfma_f32_16x16x32_bf16 v[12:15], v[212:215], v[148:151], v[12:15]
    ds_read_b128 v[164:167], v53 offset:25600
    s_waitcnt lgkmcnt(7)
    v_mfma_f32_16x16x32_bf16 v[8:11], v[216:219], v[88:91], v[8:11]
    ds_read_b128 v[104:107], v53 offset:10240
    s_waitcnt lgkmcnt(7)
    v_mfma_f32_16x16x32_bf16 v[12:15], v[216:219], v[152:155], v[12:15]
    ds_read_b128 v[168:171], v53 offset:26624
    s_waitcnt lgkmcnt(7)
    v_mfma_f32_16x16x32_bf16 v[8:11], v[220:223], v[92:95], v[8:11]
    ds_read_b128 v[108:111], v53 offset:11264
    s_waitcnt lgkmcnt(7)
    v_mfma_f32_16x16x32_bf16 v[12:15], v[220:223], v[156:159], v[12:15]
    ds_read_b128 v[172:175], v53 offset:27648
    s_waitcnt lgkmcnt(7)
    v_mfma_f32_16x16x32_bf16 v[8:11], v[224:227], v[96:99], v[8:11]
    ds_read_b128 v[112:115], v53 offset:12288
    s_waitcnt lgkmcnt(7)
    v_mfma_f32_16x16x32_bf16 v[12:15], v[224:227], v[160:163], v[12:15]
    ds_read_b128 v[176:179], v53 offset:28672
    s_waitcnt lgkmcnt(7)
    v_mfma_f32_16x16x32_bf16 v[8:11], v[228:231], v[100:103], v[8:11]
    ds_read_b128 v[116:119], v53 offset:13312
    s_waitcnt lgkmcnt(7)
    v_mfma_f32_16x16x32_bf16 v[12:15], v[228:231], v[164:167], v[12:15]
    ds_read_b128 v[180:183], v53 offset:29696
    s_waitcnt lgkmcnt(7)
    v_mfma_f32_16x16x32_bf16 v[8:11], v[232:235], v[104:107], v[8:11]
    ds_read_b128 v[120:123], v53 offset:14336
    s_waitcnt lgkmcnt(7)
    v_mfma_f32_16x16x32_bf16 v[12:15], v[232:235], v[168:171], v[12:15]
    ds_read_b128 v[184:187], v53 offset:30720
    s_waitcnt lgkmcnt(7)
    v_mfma_f32_16x16x32_bf16 v[8:11], v[236:239], v[108:111], v[8:11]
    ds_read_b128 v[124:127], v53 offset:15360
    s_waitcnt lgkmcnt(7)
    v_mfma_f32_16x16x32_bf16 v[12:15], v[236:239], v[172:175], v[12:15]
    ds_read_b128 v[192:195], v48 offset:32768
    s_waitcnt lgkmcnt(7)
    v_mfma_f32_16x16x32_bf16 v[8:11], v[240:243], v[112:115], v[8:11]
    ds_read_b128 v[196:199], v49 offset:32768
    s_waitcnt lgkmcnt(7)
    v_mfma_f32_16x16x32_bf16 v[12:15], v[240:243], v[176:179], v[12:15]
    ds_read_b128 v[200:203], v50 offset:32768
    s_waitcnt lgkmcnt(7)
    v_mfma_f32_16x16x32_bf16 v[8:11], v[244:247], v[116:119], v[8:11]
    ds_read_b128 v[204:207], v51 offset:32768
    s_waitcnt lgkmcnt(7)
    v_mfma_f32_16x16x32_bf16 v[12:15], v[244:247], v[180:183], v[12:15]
    ds_read_b128 v[208:211], v48 offset:33024
    s_waitcnt lgkmcnt(7)
    v_mfma_f32_16x16x32_bf16 v[8:11], v[248:251], v[120:123], v[8:11]
    ds_read_b128 v[212:215], v49 offset:33024
    s_waitcnt lgkmcnt(7)
    v_mfma_f32_16x16x32_bf16 v[12:15], v[248:251], v[184:187], v[12:15]
    ds_read_b128 v[216:219], v50 offset:33024
    s_waitcnt lgkmcnt(7)
    v_mfma_f32_16x16x32_bf16 v[8:11], v[252:255], v[124:127], v[8:11]
    ds_read_b128 v[220:223], v51 offset:33024
    v_mfma_f32_16x16x32_bf16 v[12:15], v[252:255], v[188:191], v[12:15]
    ds_read_b128 v[224:227], v48 offset:33280
    s_waitcnt lgkmcnt(8)
    v_mfma_f32_16x16x32_bf16 v[4:7], v[192:195], v[64:67], 0
    ds_read_b128 v[228:231], v49 offset:33280
    v_mfma_f32_16x16x32_bf16 v[56:59], v[192:195], v[128:131], 0
    ds_read_b128 v[232:235], v50 offset:33280
    s_waitcnt lgkmcnt(9)
    v_mfma_f32_16x16x32_bf16 v[4:7], v[196:199], v[68:71], v[4:7]
    ds_read_b128 v[236:239], v51 offset:33280
    v_mfma_f32_16x16x32_bf16 v[56:59], v[196:199], v[132:135], v[56:59]
    ds_read_b128 v[240:243], v48 offset:33536
    s_waitcnt lgkmcnt(10)
    v_mfma_f32_16x16x32_bf16 v[4:7], v[200:203], v[72:75], v[4:7]
    ds_read_b128 v[244:247], v49 offset:33536
    v_max3_f32 v44, v8, v9, v10
    v_max3_f32 v45, v12, v13, v14
    v_max_f32 v44, v44, v11
    v_max_f32 v45, v45, v15
    v_mfma_f32_16x16x32_bf16 v[56:59], v[200:203], v[136:139], v[56:59]
    ds_read_b128 v[248:251], v50 offset:33536
    v_cvt_pk_bf16_f32 v32, 0, v8
    v_cvt_pk_bf16_f32 v36, 0, v12
    v_permlane16_swap_b32 v44, v45
    s_waitcnt lgkmcnt(11)
    v_mfma_f32_16x16x32_bf16 v[4:7], v[204:207], v[76:79], v[4:7]
    ds_read_b128 v[252:255], v51 offset:33536
    v_cvt_pk_bf16_f32 v33, 0, v9
    v_cvt_pk_bf16_f32 v37, 0, v13
    v_max_f32 v44, v44, v45
    v_mfma_f32_16x16x32_bf16 v[56:59], v[204:207], v[140:143], v[56:59]
    v_cvt_pk_bf16_f32 v34, 0, v10
    v_cvt_pk_bf16_f32 v38, 0, v14
    v_mov_b32 v46, v44
    s_waitcnt lgkmcnt(11)
    v_mfma_f32_16x16x32_bf16 v[4:7], v[208:211], v[80:83], v[4:7]
    v_cvt_pk_bf16_f32 v35, 0, v11
    v_cvt_pk_bf16_f32 v39, 0, v15
    v_permlane32_swap_b32 v46, v44
    v_mul_f32 v32, s66, v32
    v_mfma_f32_16x16x32_bf16 v[56:59], v[208:211], v[144:147], v[56:59]
    v_mul_f32 v36, s66, v36
    v_max_f32 v44, v44, v46
    ds_write_b32 v54, v44
    s_waitcnt lgkmcnt(11)
    v_mfma_f32_16x16x32_bf16 v[4:7], v[212:215], v[84:87], v[4:7]
    v_mul_f32 v33, s66, v33
    v_mul_f32 v37, s66, v37
    v_mul_f32 v34, s66, v34
    v_mfma_f32_16x16x32_bf16 v[56:59], v[212:215], v[148:151], v[56:59]
    v_mul_f32 v38, s66, v38
    v_mul_f32 v35, s66, v35
    v_mul_f32 v39, s66, v39
    s_waitcnt lgkmcnt(10)
    v_mfma_f32_16x16x32_bf16 v[4:7], v[216:219], v[88:91], v[4:7]
    v_cvt_pk_bf16_f32 v16, 0, v32
    v_cvt_pk_bf16_f32 v20, 0, v36
    s_waitcnt lgkmcnt(0)
    s_barrier
    v_mfma_f32_16x16x32_bf16 v[56:59], v[216:219], v[152:155], v[56:59]
    ds_read_b128 v[40:43], v55
    ds_read_b128 v[44:47], v55 offset:256
    v_cvt_pk_bf16_f32 v17, 0, v33
    v_cvt_pk_bf16_f32 v21, 0, v37
    v_mfma_f32_16x16x32_bf16 v[4:7], v[220:223], v[92:95], v[4:7]
    v_cvt_pk_bf16_f32 v18, 0, v34
    v_cvt_pk_bf16_f32 v22, 0, v38
    v_cvt_pk_bf16_f32 v19, 0, v35
    v_mfma_f32_16x16x32_bf16 v[56:59], v[220:223], v[156:159], v[56:59]
    v_cvt_pk_bf16_f32 v23, 0, v39
    v_mfma_f32_16x16x32_bf16 v[4:7], v[224:227], v[96:99], v[4:7]
    v_mfma_f32_16x16x32_bf16 v[56:59], v[224:227], v[160:163], v[56:59]
    s_waitcnt lgkmcnt(0)
    v_max3_f32 v40, v40, v41, v42
    v_mfma_f32_16x16x32_bf16 v[4:7], v[228:231], v[100:103], v[4:7]
    v_max3_f32 v44, v44, v45, v46
    v_max_f32 v40, v40, v43
    v_max_f32 v44, v44, v47
    v_cvt_pk_bf16_f32 v40, 0, v40
    v_mfma_f32_16x16x32_bf16 v[56:59], v[228:231], v[164:167], v[56:59]
    v_cvt_pk_bf16_f32 v44, 0, v44
    v_mul_f32 v40, s66, v40
    v_mul_f32 v44, s66, v44
    v_mfma_f32_16x16x32_bf16 v[4:7], v[232:235], v[104:107], v[4:7]
    v_cvt_pk_bf16_f32 v40, 0, v40
    v_cvt_pk_bf16_f32 v44, 0, v44
    s_cmp_lg_u32 s72, 0
    s_cbranch_scc1 p2_75
    v_mul_f32 v24, s67, v40
    v_mul_f32 v25, s67, v44
p2_75:
    v_mfma_f32_16x16x32_bf16 v[56:59], v[232:235], v[168:171], v[56:59]
    v_fma_f32 v32, v16, s67, -v24
    v_fma_f32 v36, v20, s67, -v25
    v_fma_f32 v33, v17, s67, -v24
    v_mfma_f32_16x16x32_bf16 v[4:7], v[236:239], v[108:111], v[4:7]
    v_fma_f32 v37, v21, s67, -v25
    v_fma_f32 v34, v18, s67, -v24
    v_fma_f32 v38, v22, s67, -v25
    v_fma_f32 v35, v19, s67, -v24
    v_mfma_f32_16x16x32_bf16 v[56:59], v[236:239], v[172:175], v[56:59]
    v_fma_f32 v39, v23, s67, -v25
    v_max3_f32 v28, v28, v32, v33
    v_max3_f32 v29, v29, v36, v37
    v_mfma_f32_16x16x32_bf16 v[4:7], v[240:243], v[112:115], v[4:7]
    v_max3_f32 v28, v28, v34, v35
    v_max3_f32 v29, v29, v38, v39
    v_exp_f32 v32, v32
    v_mfma_f32_16x16x32_bf16 v[56:59], v[240:243], v[176:179], v[56:59]
    v_exp_f32 v36, v36
    v_exp_f32 v33, v33
    v_exp_f32 v37, v37
    v_mfma_f32_16x16x32_bf16 v[4:7], v[244:247], v[116:119], v[4:7]
    v_exp_f32 v34, v34
    v_exp_f32 v38, v38
    v_exp_f32 v35, v35
    v_mfma_f32_16x16x32_bf16 v[56:59], v[244:247], v[180:183], v[56:59]
    v_exp_f32 v39, v39
    v_cvt_pk_bf16_f32 v60, v32, v33
    v_cvt_pk_bf16_f32 v62, v36, v37
    v_cvt_pk_bf16_f32 v61, v34, v35
    v_mfma_f32_16x16x32_bf16 v[4:7], v[248:251], v[120:123], v[4:7]
    v_cvt_pk_bf16_f32 v63, v38, v39
    v_permlane16_swap_b32 v60, v62
    s_nop 0
    v_permlane16_swap_b32 v61, v63
    v_mfma_f32_16x16x32_bf16 v[56:59], v[248:251], v[184:187], v[56:59]
    ds_write_b128 v30, v[60:63] offset:0
    v_add_f32 v32, v32, v33
    v_add_f32 v36, v36, v37
    v_mfma_f32_16x16x32_bf16 v[4:7], v[252:255], v[124:127], v[4:7]
    v_add_f32 v34, v34, v35
    v_add_f32 v38, v38, v39
    v_add_f32 v26, v26, v32
    v_mfma_f32_16x16x32_bf16 v[56:59], v[252:255], v[188:191], v[56:59]
    v_add_f32 v27, v27, v36
    v_add_f32 v26, v26, v34
    v_add_f32 v27, v27, v38
    s_waitcnt lgkmcnt(0)
    s_barrier
    ds_read_b128 v[192:195], v48 offset:0
    ds_read_b128 v[196:199], v49 offset:0
    ds_read_b128 v[200:203], v50 offset:0
    ds_read_b128 v[204:207], v51 offset:0
    ds_read_b128 v[208:211], v48 offset:256
    ds_read_b128 v[212:215], v49 offset:256
    s_waitcnt lgkmcnt(5)
    v_mfma_f32_16x16x32_bf16 v[8:11], v[192:195], v[64:67], 0
    v_cvt_pk_bf16_f32 v32, 0, v4
    v_cvt_pk_bf16_f32 v36, 0, v56
    v_cvt_pk_bf16_f32 v33, 0, v5
    v_mfma_f32_16x16x32_bf16 v[12:15], v[192:195], v[128:131], 0
    ds_read_b128 v[216:219], v50 offset:256
    v_cvt_pk_bf16_f32 v37, 0, v57
    v_cvt_pk_bf16_f32 v34, 0, v6
    s_waitcnt lgkmcnt(5)
    v_mfma_f32_16x16x32_bf16 v[8:11], v[196:199], v[68:71], v[8:11]
    v_cvt_pk_bf16_f32 v38, 0, v58
    v_cvt_pk_bf16_f32 v35, 0, v7
    v_mfma_f32_16x16x32_bf16 v[12:15], v[196:199], v[132:135], v[12:15]
    ds_read_b128 v[220:223], v51 offset:256
    v_cvt_pk_bf16_f32 v39, 0, v59
    v_mul_f32 v32, s66, v32
    s_waitcnt lgkmcnt(5)
    v_mfma_f32_16x16x32_bf16 v[8:11], v[200:203], v[72:75], v[8:11]
    v_mul_f32 v36, s66, v36
    v_mul_f32 v33, s66, v33
    v_mfma_f32_16x16x32_bf16 v[12:15], v[200:203], v[136:139], v[12:15]
    ds_read_b128 v[224:227], v48 offset:512
    v_mul_f32 v37, s66, v37
    v_mul_f32 v34, s66, v34
    s_waitcnt lgkmcnt(5)
    v_mfma_f32_16x16x32_bf16 v[8:11], v[204:207], v[76:79], v[8:11]
    v_mul_f32 v38, s66, v38
    v_mul_f32 v35, s66, v35
    v_mfma_f32_16x16x32_bf16 v[12:15], v[204:207], v[140:143], v[12:15]
    ds_read_b128 v[228:231], v49 offset:512
    v_mul_f32 v39, s66, v39
    v_cvt_pk_bf16_f32 v16, 0, v32
    s_waitcnt lgkmcnt(5)
    v_mfma_f32_16x16x32_bf16 v[8:11], v[208:211], v[80:83], v[8:11]
    v_cvt_pk_bf16_f32 v20, 0, v36
    v_cvt_pk_bf16_f32 v17, 0, v33
    v_mfma_f32_16x16x32_bf16 v[12:15], v[208:211], v[144:147], v[12:15]
    ds_read_b128 v[232:235], v50 offset:512
    v_cvt_pk_bf16_f32 v21, 0, v37
    v_cvt_pk_bf16_f32 v18, 0, v34
    v_cvt_pk_bf16_f32 v22, 0, v38
    s_waitcnt lgkmcnt(5)
    v_mfma_f32_16x16x32_bf16 v[8:11], v[212:215], v[84:87], v[8:11]
    v_cvt_pk_bf16_f32 v19, 0, v35
    v_cvt_pk_bf16_f32 v23, 0, v39
    v_mfma_f32_16x16x32_bf16 v[12:15], v[212:215], v[148:151], v[12:15]
    ds_read_b128 v[236:239], v51 offset:512
    v_fma_f32 v32, v16, s67, -v24
    v_fma_f32 v36, v20, s67, -v25
    s_waitcnt lgkmcnt(5)
    v_mfma_f32_16x16x32_bf16 v[8:11], v[216:219], v[88:91], v[8:11]
    v_fma_f32 v33, v17, s67, -v24
    v_fma_f32 v37, v21, s67, -v25
    v_mfma_f32_16x16x32_bf16 v[12:15], v[216:219], v[152:155], v[12:15]
    ds_read_b128 v[240:243], v48 offset:768
    v_fma_f32 v34, v18, s67, -v24
    v_fma_f32 v38, v22, s67, -v25
    s_waitcnt lgkmcnt(5)
    v_mfma_f32_16x16x32_bf16 v[8:11], v[220:223], v[92:95], v[8:11]
    v_fma_f32 v35, v19, s67, -v24
    v_fma_f32 v39, v23, s67, -v25
    v_mfma_f32_16x16x32_bf16 v[12:15], v[220:223], v[156:159], v[12:15]
    ds_read_b128 v[244:247], v49 offset:768
    v_max3_f32 v28, v28, v32, v33
    v_max3_f32 v29, v29, v36, v37
    s_waitcnt lgkmcnt(5)
    v_mfma_f32_16x16x32_bf16 v[8:11], v[224:227], v[96:99], v[8:11]
    v_max3_f32 v28, v28, v34, v35
    v_max3_f32 v29, v29, v38, v39
    v_mfma_f32_16x16x32_bf16 v[12:15], v[224:227], v[160:163], v[12:15]
    ds_read_b128 v[248:251], v50 offset:768
    v_exp_f32 v32, v32
    v_exp_f32 v36, v36
    s_waitcnt lgkmcnt(5)
    v_mfma_f32_16x16x32_bf16 v[8:11], v[228:231], v[100:103], v[8:11]
    v_exp_f32 v33, v33
    v_exp_f32 v37, v37
    v_exp_f32 v34, v34
    v_mfma_f32_16x16x32_bf16 v[12:15], v[228:231], v[164:167], v[12:15]
    ds_read_b128 v[252:255], v51 offset:768
    v_exp_f32 v38, v38
    v_exp_f32 v35, v35
    s_waitcnt lgkmcnt(5)
    v_mfma_f32_16x16x32_bf16 v[8:11], v[232:235], v[104:107], v[8:11]
    v_exp_f32 v39, v39
    v_cvt_pk_bf16_f32 v60, v32, v33
    v_mfma_f32_16x16x32_bf16 v[12:15], v[232:235], v[168:171], v[12:15]
    v_cvt_pk_bf16_f32 v62, v36, v37
    v_cvt_pk_bf16_f32 v61, v34, v35
    s_waitcnt lgkmcnt(4)
    v_mfma_f32_16x16x32_bf16 v[8:11], v[236:239], v[108:111], v[8:11]
    v_cvt_pk_bf16_f32 v63, v38, v39
    v_permlane16_swap_b32 v60, v62
    v_mfma_f32_16x16x32_bf16 v[12:15], v[236:239], v[172:175], v[12:15]
    v_permlane16_swap_b32 v61, v63
    ds_write_b128 v30, v[60:63] offset:4096
    s_waitcnt lgkmcnt(4)
    v_mfma_f32_16x16x32_bf16 v[8:11], v[240:243], v[112:115], v[8:11]
    v_add_f32 v32, v32, v33
    v_add_f32 v36, v36, v37
    v_mfma_f32_16x16x32_bf16 v[12:15], v[240:243], v[176:179], v[12:15]
    v_add_f32 v34, v34, v35
    v_add_f32 v38, v38, v39
    s_waitcnt lgkmcnt(3)
    v_mfma_f32_16x16x32_bf16 v[8:11], v[244:247], v[116:119], v[8:11]
    v_add_f32 v26, v26, v32
    v_add_f32 v27, v27, v36
    v_mfma_f32_16x16x32_bf16 v[12:15], v[244:247], v[180:183], v[12:15]
    v_add_f32 v26, v26, v34
    v_add_f32 v27, v27, v38
    s_waitcnt lgkmcnt(2)
    v_mfma_f32_16x16x32_bf16 v[8:11], v[248:251], v[120:123], v[8:11]
    v_mfma_f32_16x16x32_bf16 v[12:15], v[248:251], v[184:187], v[12:15]
    s_waitcnt lgkmcnt(1)
    v_mfma_f32_16x16x32_bf16 v[8:11], v[252:255], v[124:127], v[8:11]
    v_mfma_f32_16x16x32_bf16 v[12:15], v[252:255], v[188:191], v[12:15]
    s_waitcnt lgkmcnt(0)
    s_barrier
    s_getpc_b64 s[68:69]
pc_76:
    s_sub_u32 s68, s68, pc_76-adaLN_cond__compressed_kv_cla__dense_activation_relu__decode_kernel
    s_subb_u32 s69, s69, 0
    s_lshl_b32 s64, s56, 4
    s_add_u32 s64, s64, s54
    s_lshl_b32 s64, s64, 10
    s_cmp_ge_u32 s64, L_code_end-adaLN_cond__compressed_kv_cla__dense_activation_relu__decode_kernel
    s_cbranch_scc1 cpf_77
    s_min_u32 s64, s64, L_code_end-adaLN_cond__compressed_kv_cla__dense_activation_relu__decode_kernel-1024
    v_lshl_add_u32 v40, v0, 4, s64
    global_load_dword v52, v40, s[68:69]
cpf_77:
    v_cvt_pk_bf16_f32 v32, 0, v8
    v_cvt_pk_bf16_f32 v36, 0, v12
    v_cvt_pk_bf16_f32 v33, 0, v9
    v_cvt_pk_bf16_f32 v37, 0, v13
    v_cvt_pk_bf16_f32 v34, 0, v10
    v_cvt_pk_bf16_f32 v38, 0, v14
    v_cvt_pk_bf16_f32 v35, 0, v11
    v_cvt_pk_bf16_f32 v39, 0, v15
    v_mul_f32 v32, s66, v32
    v_mul_f32 v36, s66, v36
    v_mul_f32 v33, s66, v33
    v_mul_f32 v37, s66, v37
    v_mul_f32 v34, s66, v34
    v_mul_f32 v38, s66, v38
    v_mul_f32 v35, s66, v35
    v_mul_f32 v39, s66, v39
    v_cvt_pk_bf16_f32 v16, 0, v32
    v_cvt_pk_bf16_f32 v20, 0, v36
    v_cvt_pk_bf16_f32 v17, 0, v33
    v_cvt_pk_bf16_f32 v21, 0, v37
    v_cvt_pk_bf16_f32 v18, 0, v34
    v_cvt_pk_bf16_f32 v22, 0, v38
    v_cvt_pk_bf16_f32 v19, 0, v35
    v_cvt_pk_bf16_f32 v23, 0, v39
    v_fma_f32 v32, v16, s67, -v24
    v_fma_f32 v36, v20, s67, -v25
    v_fma_f32 v33, v17, s67, -v24
    v_fma_f32 v37, v21, s67, -v25
    v_fma_f32 v34, v18, s67, -v24
    v_fma_f32 v38, v22, s67, -v25
    v_fma_f32 v35, v19, s67, -v24
    v_fma_f32 v39, v23, s67, -v25
    v_max3_f32 v28, v28, v32, v33
    v_max3_f32 v29, v29, v36, v37
    v_max3_f32 v28, v28, v34, v35
    v_max3_f32 v29, v29, v38, v39
    v_exp_f32 v32, v32
    v_exp_f32 v36, v36
    v_exp_f32 v33, v33
    v_exp_f32 v37, v37
    v_exp_f32 v34, v34
    v_exp_f32 v38, v38
    v_exp_f32 v35, v35
    v_exp_f32 v39, v39
    v_cvt_pk_bf16_f32 v60, v32, v33
    v_cvt_pk_bf16_f32 v62, v36, v37
    v_cvt_pk_bf16_f32 v61, v34, v35
    v_cvt_pk_bf16_f32 v63, v38, v39
    v_permlane16_swap_b32 v60, v62
    s_nop 0
    v_permlane16_swap_b32 v61, v63
    ds_write_b128 v30, v[60:63] offset:0
    v_add_f32 v32, v32, v33
    v_add_f32 v36, v36, v37
    v_add_f32 v34, v34, v35
    v_add_f32 v38, v38, v39
    v_add_f32 v26, v26, v32
    v_add_f32 v27, v27, v36
    v_add_f32 v26, v26, v34
    v_add_f32 v27, v27, v38
    v_lshrrev_b32 v44, 1, v2
    v_lshlrev_b32 v44, 9, v44
    v_lshl_add_u32 v44, v1, 4, v44
    v_and_b32 v45, 1, v2
    v_lshl_add_u32 v44, v45, 3, v44
    s_and_b32 s64, s56, 1
    s_lshl_b32 s64, s64, 10
    s_lshr_b32 s68, s56, 1
    s_lshl_b32 s68, s68, 8
    s_add_u32 s64, s64, s68
    s_add_u32 s64, s64, 135168
    v_add_u32 v44, s64, v44
    v_and_b32 v48, 0xffff, v48
    v_and_b32 v49, 0xffff, v49
    v_and_b32 v50, 0xffff, v50
    v_and_b32 v51, 0xffff, v51
    s_waitcnt lgkmcnt(0)
    s_barrier
    v_lshlrev_b32 v40, 7, v3
    s_lshl_b32 s64, s55, 15
    buffer_load_dword v53, v40, s[24:27], s64 offen
    s_cmp_ge_u32 s56, 2
    s_cbranch_scc1 wi_78
    ds_read_b128 v[192:195], v48 offset:32768
    ds_read_b128 v[196:199], v49 offset:32768
    ds_read_b128 v[200:203], v50 offset:32768
    ds_read_b128 v[204:207], v51 offset:32768
    ds_read_b128 v[208:211], v48 offset:33024
    ds_read_b128 v[212:215], v49 offset:33024
    ds_read_b128 v[216:219], v50 offset:33024
    ds_read_b128 v[220:223], v51 offset:33024
    ds_read_b128 v[224:227], v48 offset:33280
    ds_read_b128 v[228:231], v49 offset:33280
    ds_read_b128 v[232:235], v50 offset:33280
    ds_read_b128 v[236:239], v51 offset:33280
    ds_read_b128 v[240:243], v48 offset:33536
    ds_read_b128 v[244:247], v49 offset:33536
    ds_read_b128 v[248:251], v50 offset:33536
    ds_read_b128 v[252:255], v51 offset:33536
    s_waitcnt lgkmcnt(15)
    v_mfma_f32_16x16x32_bf16 v[4:7], v[192:195], v[64:67], 0
    s_waitcnt lgkmcnt(14)
    v_mfma_f32_16x16x32_bf16 v[4:7], v[196:199], v[68:71], v[4:7]
    s_waitcnt lgkmcnt(13)
    v_mfma_f32_16x16x32_bf16 v[4:7], v[200:203], v[72:75], v[4:7]
    s_waitcnt lgkmcnt(12)
    v_mfma_f32_16x16x32_bf16 v[4:7], v[204:207], v[76:79], v[4:7]
    s_waitcnt lgkmcnt(11)
    v_mfma_f32_16x16x32_bf16 v[4:7], v[208:211], v[80:83], v[4:7]
    s_waitcnt lgkmcnt(10)
    v_mfma_f32_16x16x32_bf16 v[4:7], v[212:215], v[84:87], v[4:7]
    s_waitcnt lgkmcnt(9)
    v_mfma_f32_16x16x32_bf16 v[4:7], v[216:219], v[88:91], v[4:7]
    s_waitcnt lgkmcnt(8)
    v_mfma_f32_16x16x32_bf16 v[4:7], v[220:223], v[92:95], v[4:7]
    s_waitcnt lgkmcnt(7)
    v_mfma_f32_16x16x32_bf16 v[4:7], v[224:227], v[96:99], v[4:7]
    s_waitcnt lgkmcnt(6)
    v_mfma_f32_16x16x32_bf16 v[4:7], v[228:231], v[100:103], v[4:7]
    s_waitcnt lgkmcnt(5)
    v_mfma_f32_16x16x32_bf16 v[4:7], v[232:235], v[104:107], v[4:7]
    s_waitcnt lgkmcnt(4)
    v_mfma_f32_16x16x32_bf16 v[4:7], v[236:239], v[108:111], v[4:7]
    s_waitcnt lgkmcnt(3)
    v_mfma_f32_16x16x32_bf16 v[4:7], v[240:243], v[112:115], v[4:7]
    s_waitcnt lgkmcnt(2)
    v_mfma_f32_16x16x32_bf16 v[4:7], v[244:247], v[116:119], v[4:7]
    s_waitcnt lgkmcnt(1)
    v_mfma_f32_16x16x32_bf16 v[4:7], v[248:251], v[120:123], v[4:7]
    s_waitcnt lgkmcnt(0)
    v_mfma_f32_16x16x32_bf16 v[4:7], v[252:255], v[124:127], v[4:7]
    v_or_b32 v48, 0x10000, v48
    v_or_b32 v49, 0x10000, v49
    v_or_b32 v50, 0x10000, v50
    v_or_b32 v51, 0x10000, v51
    s_nop 3
    v_cvt_pk_bf16_f32 v32, 0, v4
    v_cvt_pk_bf16_f32 v33, 0, v5
    v_cvt_pk_bf16_f32 v34, 0, v6
    v_cvt_pk_bf16_f32 v35, 0, v7
    v_mul_f32 v32, s66, v32
    v_mul_f32 v33, s66, v33
    v_mul_f32 v34, s66, v34
    v_mul_f32 v35, s66, v35
    v_cvt_pk_bf16_f32 v16, 0, v32
    v_cvt_pk_bf16_f32 v17, 0, v33
    v_cvt_pk_bf16_f32 v18, 0, v34
    v_cvt_pk_bf16_f32 v19, 0, v35
    v_fma_f32 v32, v16, s67, -v24
    v_fma_f32 v33, v17, s67, -v24
    v_fma_f32 v34, v18, s67, -v24
    v_fma_f32 v35, v19, s67, -v24
    v_max3_f32 v28, v28, v32, v33
    v_max3_f32 v28, v28, v34, v35
    v_exp_f32 v32, v32
    v_exp_f32 v33, v33
    v_exp_f32 v34, v34
    v_exp_f32 v35, v35
    v_cvt_pk_bf16_f32 v60, v32, v33
    v_cvt_pk_bf16_f32 v61, v34, v35
    ds_write_b64 v44, v[60:61] offset:0
    v_add_f32 v32, v32, v33
    v_add_f32 v34, v34, v35
    v_add_f32 v26, v26, v32
    v_add_f32 v26, v26, v34
    s_waitcnt lgkmcnt(0)
    s_barrier
    s_or_b32 s64, s56, s72
    s_cbranch_scc1 noarr_80
    s_lshl_b32 s64, s52, 7
    s_add_u32 s64, s64, 114688
    v_mov_b32 v43, 1
    v_mov_b32 v40, 0
    s_mov_b32 exec_lo, 0x1
    s_mov_b32 exec_hi, 0x0
    buffer_atomic_add v43, v40, s[48:51], s64 offen sc0 sc1
    s_mov_b64 exec, -1
noarr_80:
    ds_read_b128 v[192:195], v48 offset:32768
    ds_read_b128 v[196:199], v49 offset:32768
    ds_read_b128 v[200:203], v50 offset:32768
    ds_read_b128 v[204:207], v51 offset:32768
    ds_read_b128 v[208:211], v48 offset:33024
    ds_read_b128 v[212:215], v49 offset:33024
    ds_read_b128 v[216:219], v50 offset:33024
    ds_read_b128 v[220:223], v51 offset:33024
    ds_read_b128 v[224:227], v48 offset:33280
    ds_read_b128 v[228:231], v49 offset:33280
    ds_read_b128 v[232:235], v50 offset:33280
    ds_read_b128 v[236:239], v51 offset:33280
    ds_read_b128 v[240:243], v48 offset:33536
    ds_read_b128 v[244:247], v49 offset:33536
    ds_read_b128 v[248:251], v50 offset:33536
    ds_read_b128 v[252:255], v51 offset:33536
    s_waitcnt lgkmcnt(15)
    v_mfma_f32_16x16x32_bf16 v[4:7], v[192:195], v[64:67], 0
    s_waitcnt lgkmcnt(14)
    v_mfma_f32_16x16x32_bf16 v[4:7], v[196:199], v[68:71], v[4:7]
    s_waitcnt lgkmcnt(13)
    v_mfma_f32_16x16x32_bf16 v[4:7], v[200:203], v[72:75], v[4:7]
    s_waitcnt lgkmcnt(12)
    v_mfma_f32_16x16x32_bf16 v[4:7], v[204:207], v[76:79], v[4:7]
    s_waitcnt lgkmcnt(11)
    v_mfma_f32_16x16x32_bf16 v[4:7], v[208:211], v[80:83], v[4:7]
    s_waitcnt lgkmcnt(10)
    v_mfma_f32_16x16x32_bf16 v[4:7], v[212:215], v[84:87], v[4:7]
    s_waitcnt lgkmcnt(9)
    v_mfma_f32_16x16x32_bf16 v[4:7], v[216:219], v[88:91], v[4:7]
    s_waitcnt lgkmcnt(8)
    v_mfma_f32_16x16x32_bf16 v[4:7], v[220:223], v[92:95], v[4:7]
    s_waitcnt lgkmcnt(7)
    v_mfma_f32_16x16x32_bf16 v[4:7], v[224:227], v[96:99], v[4:7]
    s_waitcnt lgkmcnt(6)
    v_mfma_f32_16x16x32_bf16 v[4:7], v[228:231], v[100:103], v[4:7]
    s_waitcnt lgkmcnt(5)
    v_mfma_f32_16x16x32_bf16 v[4:7], v[232:235], v[104:107], v[4:7]
    s_waitcnt lgkmcnt(4)
    v_mfma_f32_16x16x32_bf16 v[4:7], v[236:239], v[108:111], v[4:7]
    s_waitcnt lgkmcnt(3)
    v_mfma_f32_16x16x32_bf16 v[4:7], v[240:243], v[112:115], v[4:7]
    s_waitcnt lgkmcnt(2)
    v_mfma_f32_16x16x32_bf16 v[4:7], v[244:247], v[116:119], v[4:7]
    s_waitcnt lgkmcnt(1)
    v_mfma_f32_16x16x32_bf16 v[4:7], v[248:251], v[120:123], v[4:7]
    s_waitcnt lgkmcnt(0)
    v_mfma_f32_16x16x32_bf16 v[4:7], v[252:255], v[124:127], v[4:7]
    v_and_b32 v48, 0xffff, v48
    v_and_b32 v49, 0xffff, v49
    v_and_b32 v50, 0xffff, v50
    v_and_b32 v51, 0xffff, v51
    s_nop 3
    v_cvt_pk_bf16_f32 v32, 0, v4
    v_cvt_pk_bf16_f32 v33, 0, v5
    v_cvt_pk_bf16_f32 v34, 0, v6
    v_cvt_pk_bf16_f32 v35, 0, v7
    v_mul_f32 v32, s66, v32
    v_mul_f32 v33, s66, v33
    v_mul_f32 v34, s66, v34
    v_mul_f32 v35, s66, v35
    v_cvt_pk_bf16_f32 v16, 0, v32
    v_cvt_pk_bf16_f32 v17, 0, v33
    v_cvt_pk_bf16_f32 v18, 0, v34
    v_cvt_pk_bf16_f32 v19, 0, v35
    v_fma_f32 v32, v16, s67, -v24
    v_fma_f32 v33, v17, s67, -v24
    v_fma_f32 v34, v18, s67, -v24
    v_fma_f32 v35, v19, s67, -v24
    v_max3_f32 v28, v28, v32, v33
    v_max3_f32 v28, v28, v34, v35
    v_exp_f32 v32, v32
    v_exp_f32 v33, v33
    v_exp_f32 v34, v34
    v_exp_f32 v35, v35
    v_cvt_pk_bf16_f32 v60, v32, v33
    v_cvt_pk_bf16_f32 v61, v34, v35
    ds_write_b64 v44, v[60:61] offset:2048
    v_add_f32 v32, v32, v33
    v_add_f32 v34, v34, v35
    v_add_f32 v26, v26, v32
    v_add_f32 v26, v26, v34
    s_branch wd_79
wi_78:
    ds_read_b128 v[192:195], v48 offset:32768
    ds_read_b128 v[196:199], v49 offset:32768
    ds_read_b128 v[200:203], v50 offset:32768
    ds_read_b128 v[204:207], v51 offset:32768
    ds_read_b128 v[208:211], v48 offset:33024
    ds_read_b128 v[212:215], v49 offset:33024
    ds_read_b128 v[216:219], v50 offset:33024
    ds_read_b128 v[220:223], v51 offset:33024
    ds_read_b128 v[224:227], v48 offset:33280
    ds_read_b128 v[228:231], v49 offset:33280
    ds_read_b128 v[232:235], v50 offset:33280
    ds_read_b128 v[236:239], v51 offset:33280
    ds_read_b128 v[240:243], v48 offset:33536
    ds_read_b128 v[244:247], v49 offset:33536
    ds_read_b128 v[248:251], v50 offset:33536
    ds_read_b128 v[252:255], v51 offset:33536
    s_waitcnt lgkmcnt(15)
    v_mfma_f32_16x16x32_bf16 v[56:59], v[192:195], v[128:131], 0
    s_waitcnt lgkmcnt(14)
    v_mfma_f32_16x16x32_bf16 v[56:59], v[196:199], v[132:135], v[56:59]
    s_waitcnt lgkmcnt(13)
    v_mfma_f32_16x16x32_bf16 v[56:59], v[200:203], v[136:139], v[56:59]
    s_waitcnt lgkmcnt(12)
    v_mfma_f32_16x16x32_bf16 v[56:59], v[204:207], v[140:143], v[56:59]
    s_waitcnt lgkmcnt(11)
    v_mfma_f32_16x16x32_bf16 v[56:59], v[208:211], v[144:147], v[56:59]
    s_waitcnt lgkmcnt(10)
    v_mfma_f32_16x16x32_bf16 v[56:59], v[212:215], v[148:151], v[56:59]
    s_waitcnt lgkmcnt(9)
    v_mfma_f32_16x16x32_bf16 v[56:59], v[216:219], v[152:155], v[56:59]
    s_waitcnt lgkmcnt(8)
    v_mfma_f32_16x16x32_bf16 v[56:59], v[220:223], v[156:159], v[56:59]
    s_waitcnt lgkmcnt(7)
    v_mfma_f32_16x16x32_bf16 v[56:59], v[224:227], v[160:163], v[56:59]
    s_waitcnt lgkmcnt(6)
    v_mfma_f32_16x16x32_bf16 v[56:59], v[228:231], v[164:167], v[56:59]
    s_waitcnt lgkmcnt(5)
    v_mfma_f32_16x16x32_bf16 v[56:59], v[232:235], v[168:171], v[56:59]
    s_waitcnt lgkmcnt(4)
    v_mfma_f32_16x16x32_bf16 v[56:59], v[236:239], v[172:175], v[56:59]
    s_waitcnt lgkmcnt(3)
    v_mfma_f32_16x16x32_bf16 v[56:59], v[240:243], v[176:179], v[56:59]
    s_waitcnt lgkmcnt(2)
    v_mfma_f32_16x16x32_bf16 v[56:59], v[244:247], v[180:183], v[56:59]
    s_waitcnt lgkmcnt(1)
    v_mfma_f32_16x16x32_bf16 v[56:59], v[248:251], v[184:187], v[56:59]
    s_waitcnt lgkmcnt(0)
    v_mfma_f32_16x16x32_bf16 v[56:59], v[252:255], v[188:191], v[56:59]
    v_or_b32 v48, 0x10000, v48
    v_or_b32 v49, 0x10000, v49
    v_or_b32 v50, 0x10000, v50
    v_or_b32 v51, 0x10000, v51
    s_nop 3
    v_cvt_pk_bf16_f32 v36, 0, v56
    v_cvt_pk_bf16_f32 v37, 0, v57
    v_cvt_pk_bf16_f32 v38, 0, v58
    v_cvt_pk_bf16_f32 v39, 0, v59
    v_mul_f32 v36, s66, v36
    v_mul_f32 v37, s66, v37
    v_mul_f32 v38, s66, v38
    v_mul_f32 v39, s66, v39
    v_cvt_pk_bf16_f32 v20, 0, v36
    v_cvt_pk_bf16_f32 v21, 0, v37
    v_cvt_pk_bf16_f32 v22, 0, v38
    v_cvt_pk_bf16_f32 v23, 0, v39
    v_fma_f32 v36, v20, s67, -v25
    v_fma_f32 v37, v21, s67, -v25
    v_fma_f32 v38, v22, s67, -v25
    v_fma_f32 v39, v23, s67, -v25
    v_max3_f32 v29, v29, v36, v37
    v_max3_f32 v29, v29, v38, v39
    v_exp_f32 v36, v36
    v_exp_f32 v37, v37
    v_exp_f32 v38, v38
    v_exp_f32 v39, v39
    v_cvt_pk_bf16_f32 v62, v36, v37
    v_cvt_pk_bf16_f32 v63, v38, v39
    ds_write_b64 v44, v[62:63] offset:0
    v_add_f32 v36, v36, v37
    v_add_f32 v38, v38, v39
    v_add_f32 v27, v27, v36
    v_add_f32 v27, v27, v38
    s_waitcnt lgkmcnt(0)
    s_barrier
    ds_read_b128 v[192:195], v48 offset:32768
    ds_read_b128 v[196:199], v49 offset:32768
    ds_read_b128 v[200:203], v50 offset:32768
    ds_read_b128 v[204:207], v51 offset:32768
    ds_read_b128 v[208:211], v48 offset:33024
    ds_read_b128 v[212:215], v49 offset:33024
    ds_read_b128 v[216:219], v50 offset:33024
    ds_read_b128 v[220:223], v51 offset:33024
    ds_read_b128 v[224:227], v48 offset:33280
    ds_read_b128 v[228:231], v49 offset:33280
    ds_read_b128 v[232:235], v50 offset:33280
    ds_read_b128 v[236:239], v51 offset:33280
    ds_read_b128 v[240:243], v48 offset:33536
    ds_read_b128 v[244:247], v49 offset:33536
    ds_read_b128 v[248:251], v50 offset:33536
    ds_read_b128 v[252:255], v51 offset:33536
    s_waitcnt lgkmcnt(15)
    v_mfma_f32_16x16x32_bf16 v[56:59], v[192:195], v[128:131], 0
    s_waitcnt lgkmcnt(14)
    v_mfma_f32_16x16x32_bf16 v[56:59], v[196:199], v[132:135], v[56:59]
    s_waitcnt lgkmcnt(13)
    v_mfma_f32_16x16x32_bf16 v[56:59], v[200:203], v[136:139], v[56:59]
    s_waitcnt lgkmcnt(12)
    v_mfma_f32_16x16x32_bf16 v[56:59], v[204:207], v[140:143], v[56:59]
    s_waitcnt lgkmcnt(11)
    v_mfma_f32_16x16x32_bf16 v[56:59], v[208:211], v[144:147], v[56:59]
    s_waitcnt lgkmcnt(10)
    v_mfma_f32_16x16x32_bf16 v[56:59], v[212:215], v[148:151], v[56:59]
    s_waitcnt lgkmcnt(9)
    v_mfma_f32_16x16x32_bf16 v[56:59], v[216:219], v[152:155], v[56:59]
    s_waitcnt lgkmcnt(8)
    v_mfma_f32_16x16x32_bf16 v[56:59], v[220:223], v[156:159], v[56:59]
    s_waitcnt lgkmcnt(7)
    v_mfma_f32_16x16x32_bf16 v[56:59], v[224:227], v[160:163], v[56:59]
    s_waitcnt lgkmcnt(6)
    v_mfma_f32_16x16x32_bf16 v[56:59], v[228:231], v[164:167], v[56:59]
    s_waitcnt lgkmcnt(5)
    v_mfma_f32_16x16x32_bf16 v[56:59], v[232:235], v[168:171], v[56:59]
    s_waitcnt lgkmcnt(4)
    v_mfma_f32_16x16x32_bf16 v[56:59], v[236:239], v[172:175], v[56:59]
    s_waitcnt lgkmcnt(3)
    v_mfma_f32_16x16x32_bf16 v[56:59], v[240:243], v[176:179], v[56:59]
    s_waitcnt lgkmcnt(2)
    v_mfma_f32_16x16x32_bf16 v[56:59], v[244:247], v[180:183], v[56:59]
    s_waitcnt lgkmcnt(1)
    v_mfma_f32_16x16x32_bf16 v[56:59], v[248:251], v[184:187], v[56:59]
    s_waitcnt lgkmcnt(0)
    v_mfma_f32_16x16x32_bf16 v[56:59], v[252:255], v[188:191], v[56:59]
    s_nop 7
    v_cvt_pk_bf16_f32 v36, 0, v56
    v_cvt_pk_bf16_f32 v37, 0, v57
    v_cvt_pk_bf16_f32 v38, 0, v58
    v_cvt_pk_bf16_f32 v39, 0, v59
    v_mul_f32 v36, s66, v36
    v_mul_f32 v37, s66, v37
    v_mul_f32 v38, s66, v38
    v_mul_f32 v39, s66, v39
    v_cvt_pk_bf16_f32 v20, 0, v36
    v_cvt_pk_bf16_f32 v21, 0, v37
    v_cvt_pk_bf16_f32 v22, 0, v38
    v_cvt_pk_bf16_f32 v23, 0, v39
    v_fma_f32 v36, v20, s67, -v25
    v_fma_f32 v37, v21, s67, -v25
    v_fma_f32 v38, v22, s67, -v25
    v_fma_f32 v39, v23, s67, -v25
    v_max3_f32 v29, v29, v36, v37
    v_max3_f32 v29, v29, v38, v39
    v_exp_f32 v36, v36
    v_exp_f32 v37, v37
    v_exp_f32 v38, v38
    v_exp_f32 v39, v39
    v_cvt_pk_bf16_f32 v62, v36, v37
    v_cvt_pk_bf16_f32 v63, v38, v39
    ds_write_b64 v44, v[62:63] offset:2048
    v_add_f32 v36, v36, v37
    v_add_f32 v38, v38, v39
    v_add_f32 v27, v27, v36
    v_add_f32 v27, v27, v38
wd_79:
    v_max_f32 v40, v28, v29
    v_cmp_lt_f32 vcc, s65, v40
    v_permlane16_swap_b32 v26, v27
    v_add_f32 v26, v26, v27
    v_mov_b32 v41, v26
    s_nop 1
    v_permlane32_swap_b32 v41, v26
    v_add_f32 v26, v26, v41
    v_subrev_u32 v42, 23552, v54
    ds_write_b32 v42, v26
    s_cbranch_vccz noflag_81
    s_cmp_lg_u32 s72, 0
    s_cbranch_scc1 noflag_81
    ds_write_b32 v31, v31
noflag_81:
    s_waitcnt lgkmcnt(0)
    s_barrier
    ds_read_b32 v39, v31
    v_and_b32 v42, -16, v42
    ds_read_b128 v[44:47], v42
    s_lshl_b32 s65, s55, 8
    s_add_u32 s65, s65, 65536
    v_lshlrev_b32 v40, 3, v0
    v_and_b32 v41, 1, v2
    v_cmp_eq_u32 vcc, 1, v41
    s_nop 1
    v_cndmask_b32 v32, v24, v25, vcc
    s_setprio 0
    s_waitcnt lgkmcnt(0)
    v_readfirstlane_b32 s64, v39
    v_add_f32 v44, v44, v45
    v_add_f32 v46, v46, v47
    v_add_f32 v33, v44, v46
    s_cmp_lg_u32 s64, 0
    s_cbranch_scc1 L_qk_redo
    s_cmp_lg_u32 s56, 0
    s_cbranch_scc1 wi_82
    s_mov_b32 exec_lo, 0xffffffff
    s_mov_b32 exec_hi, 0x0
    buffer_store_dwordx2 v[32:33], v40, s[48:51], s65 offen sc1
    s_mov_b64 exec, -1
wi_82:
    s_barrier
    s_or_b32 s68, s56, s72
    s_cbranch_scc1 noring_84
    v_lshlrev_b32 v35, 10, v0
    v_mov_b32 v36, s57
    s_lshl_b32 s69, s52, 7
    s_add_u32 s69, s69, 1572864
    s_waitcnt vmcnt(1)
    v_readfirstlane_b32 s68, v43
    s_cmp_lg_u32 s68, 14
    s_cbranch_scc1 noring_84
    s_mov_b32 exec_lo, 0xffffffff
    s_mov_b32 exec_hi, 0x0
    buffer_store_dword v36, v35, s[48:51], s69 offen sc1
    s_mov_b64 exec, -1
noring_84:
    s_branch L_att_post
L_qk_redo:
    s_or_b32 s68, s56, s72
    s_cbranch_scc1 noring_85
    v_lshlrev_b32 v35, 10, v0
    v_mov_b32 v36, s57
    s_lshl_b32 s69, s52, 7
    s_add_u32 s69, s69, 1572864
    s_waitcnt vmcnt(0)
    v_readfirstlane_b32 s68, v43
    s_cmp_lg_u32 s68, 14
    s_cbranch_scc1 noring_85
    s_mov_b32 exec_lo, 0xffffffff
    s_mov_b32 exec_hi, 0x0
    buffer_store_dword v36, v35, s[48:51], s69 offen sc1
    s_mov_b64 exec, -1
noring_85:
    s_waitcnt vmcnt(0)
    v_lshlrev_b32 v53, 4, v0
    v_add_u32 v53, 131072, v53
    v_permlane16_swap_b32 v28, v29
    v_max_f32 v28, v28, v29
    v_mov_b32 v41, v28
    s_nop 1
    v_permlane32_swap_b32 v41, v28
    v_max_f32 v28, v28, v41
    ds_write_b32 v54, v28
    s_waitcnt lgkmcnt(0)
    s_barrier
    ds_read_b128 v[40:43], v55
    ds_read_b128 v[44:47], v55 offset:256
    s_waitcnt lgkmcnt(0)
    v_max3_f32 v40, v40, v41, v42
    v_max_f32 v40, v40, v43
    v_add_f32 v24, v24, v40
    v_max3_f32 v44, v44, v45, v46
    v_max_f32 v44, v44, v47
    v_add_f32 v25, v25, v44
    s_mov_b32 s72, 1
    s_branch L_qk_start
L_att_post:
    s_barrier
    s_cmp_ge_u32 s56, 4
    s_cbranch_scc1 wi_86
    s_cmp_ge_u32 s56, 2
    s_cbranch_scc1 wi_88
    v_and_b32 v40, 31, v3
    v_mul_u32_u24 v40, 3584, v40
    v_lshrrev_b32 v41, 5, v3
    v_lshl_add_u32 v40, v41, 7, v40
    s_mul_i32 s64, s54, 114688
    s_mul_i32 s68, s52, 448
    s_add_u32 s64, s64, s68
    buffer_load_dword v52, v40, s[28:31], s64 offen offset:60
    s_branch wd_89
wi_88:
    v_subrev_u32 v40, 128, v3
    v_min_u32 v40, 111, v40
    v_lshlrev_b32 v40, 7, v40
    s_mul_i32 s64, s55, 14336
    buffer_load_dword v52, v40, s[32:35], s64 offen
wd_89:
wi_86:
    s_cmp_ge_u32 s54, 14
    s_cbranch_scc1 L_fin
    s_lshr_b32 s68, s54, 1
    s_mul_i32 s65, s52, 7
    s_add_u32 s68, s68, s65
    s_and_b32 s69, s54, 1
    v_lshrrev_b32 v44, 2, v0
    v_mul_u32_u24 v44, 3584, v44
    v_and_b32 v45, 3, v0
    v_lshrrev_b32 v32, 5, v0
    v_lshlrev_b32 v32, 1, v32
    v_xor_b32 v45, v45, v32
    v_lshl_add_u32 v44, v45, 4, v44
    v_lshlrev_b32 v32, 4, v0
    s_lshl_b32 s64, s68, 6
    s_mul_i32 s65, s56, 229376
    s_add_u32 s64, s64, s65
    s_lshl_b32 s65, s56, 12
    s_add_u32 s66, s65, 32768
    s_barrier
    s_mov_b32 m0, s66
    s_nop 0
    buffer_load_dwordx4 v44, s[28:31], s64 offen  lds
    s_add_u32 s64, s64, 57344
    s_add_u32 s66, s66, 1024
    s_mov_b32 m0, s66
    s_nop 0
    buffer_load_dwordx4 v44, s[28:31], s64 offen  lds
    s_add_u32 s64, s64, 57344
    s_add_u32 s66, s66, 1024
    s_mov_b32 m0, s66
    s_nop 0
    buffer_load_dwordx4 v44, s[28:31], s64 offen  lds
    s_add_u32 s64, s64, 57344
    s_add_u32 s66, s66, 1024
    s_mov_b32 m0, s66
    s_nop 0
    buffer_load_dwordx4 v44, s[28:31], s64 offen  lds
    s_cmp_lt_u32 s56, 4
    s_cbranch_scc1 wi_90
    s_mov_b32 s78, s69
    s_lshl_b32 s69, s79, 13
    s_min_u32 s64, s54, 13
    s_lshr_b32 s64, s64, 1
    s_mul_i32 s65, s52, 7
    s_add_u32 s64, s64, s65
    s_lshl_b32 s64, s64, 15
    s_add_u32 s64, s64, s69
    s_add_u32 s64, s64, 0
    s_add_u32 m0, s69, 0
    v_lshlrev_b32 v43, 4, v0
    s_and_b32 s65, s56, 1
    s_lshl_b32 s65, s65, 7
    v_xor_b32 v43, s65, v43
    v_xor_b32 v46, 0, v43
    buffer_load_dwordx4 v46, s[32:35], s64 offen offset:0  lds
    v_xor_b32 v46, 32, v43
    buffer_load_dwordx4 v46, s[32:35], s64 offen offset:1024  lds
    v_xor_b32 v46, 64, v43
    buffer_load_dwordx4 v46, s[32:35], s64 offen offset:2048  lds
    v_xor_b32 v46, 96, v43
    buffer_load_dwordx4 v46, s[32:35], s64 offen offset:3072  lds
    s_min_u32 s64, s54, 13
    s_lshr_b32 s64, s64, 1
    s_mul_i32 s65, s52, 7
    s_add_u32 s64, s64, s65
    s_lshl_b32 s64, s64, 15
    s_add_u32 s64, s64, s69
    s_add_u32 s64, s64, 4096
    s_add_u32 m0, s69, 4096
    v_lshlrev_b32 v43, 4, v0
    s_and_b32 s65, s56, 1
    s_lshl_b32 s65, s65, 7
    v_xor_b32 v43, s65, v43
    v_xor_b32 v46, 0, v43
    buffer_load_dwordx4 v46, s[32:35], s64 offen offset:0  lds
    v_xor_b32 v46, 32, v43
    buffer_load_dwordx4 v46, s[32:35], s64 offen offset:1024  lds
    v_xor_b32 v46, 64, v43
    buffer_load_dwordx4 v46, s[32:35], s64 offen offset:2048  lds
    v_xor_b32 v46, 96, v43
    buffer_load_dwordx4 v46, s[32:35], s64 offen offset:3072  lds
    s_mov_b32 s69, s78
wi_90:
    v_and_b32 v38, 3, v1
    s_lshl_b32 s64, s69, 12
    s_lshl_b32 s65, s56, 9
    s_add_u32 s65, s65, s64
    v_and_b32 v33, 31, v0
    v_lshlrev_b32 v33, 4, v33
    v_lshrrev_b32 v34, 5, v0
    v_lshl_add_u32 v33, v34, 3, v33
    buffer_load_dwordx2 v[40:41], v33, s[4:7], s65 offen
    s_add_u32 s65, s65, 32768
    s_add_u32 s66, s65, 8192
    s_add_u32 s67, s65, 16384
    s_mov_b32 s63, 60000
poll_92:
    buffer_load_dwordx2 v[44:45], v33, s[48:51], s65 offen sc1
    buffer_load_dwordx2 v[46:47], v33, s[48:51], s66 offen sc1
    buffer_load_dwordx2 v[48:49], v33, s[48:51], s67 offen sc1
    s_waitcnt vmcnt(0)
    v_max3_u32 v56, v44, v45, v46
    v_max3_u32 v56, v56, v47, v48
    v_max_u32 v56, v56, v49
    v_cmp_eq_u32 vcc, -1, v56
    s_cbranch_vccz pdone_93
    s_sleep 1
    s_sub_u32 s63, s63, 1
    s_cbranch_scc0 poll_92
pdone_93:
    s_lshr_b32 s64, s56, 1
    s_and_b32 s65, s56, 1
    s_mul_i32 s66, s64, 1040
    s_lshl_b32 s67, s65, 9
    s_add_u32 s66, s66, s67
    s_add_u32 s66, s66, 139264
    v_add_u32 v39, s66, v33
    ds_write_b64 v39, v[48:49] offset:4160
    ds_write_b64 v39, v[46:47] offset:8320
    v_lshlrev_b32 v160, 16, v40
    v_and_b32 v161, 0xffff0000, v40
    v_lshlrev_b32 v162, 16, v41
    v_and_b32 v163, 0xffff0000, v41
    v_lshlrev_b32 v164, 16, v44
    v_and_b32 v165, 0xffff0000, v44
    v_lshlrev_b32 v166, 16, v45
    v_and_b32 v167, 0xffff0000, v45
    v_lshlrev_b32 v168, 16, v48
    v_and_b32 v169, 0xffff0000, v48
    v_lshlrev_b32 v170, 16, v49
    v_and_b32 v171, 0xffff0000, v49
    s_waitcnt lgkmcnt(0)
    s_barrier
    v_lshrrev_b32 v34, 2, v1
    v_lshl_add_u32 v34, v2, 3, v34
    v_lshlrev_b32 v35, 6, v34
    v_lshl_add_u32 v35, v38, 3, v35
    v_and_b32 v36, 1, v2
    v_xor_b32 v36, s65, v36
    v_lshl_add_u32 v35, v36, 5, v35
    s_lshl_b32 s66, s64, 13
    v_add_u32 v35, s66, v35
    ds_read_b64_tr_b16 v[128:129], v35 offset:32768
    ds_read_b64_tr_b16 v[130:131], v35 offset:33024
    ds_read_b64_tr_b16 v[132:133], v35 offset:34816
    ds_read_b64_tr_b16 v[134:135], v35 offset:35072
    ds_read_b64_tr_b16 v[136:137], v35 offset:36864
    ds_read_b64_tr_b16 v[138:139], v35 offset:37120
    ds_read_b64_tr_b16 v[140:141], v35 offset:38912
    ds_read_b64_tr_b16 v[142:143], v35 offset:39168
    v_lshlrev_b32 v35, 10, v34
    v_lshl_add_u32 v35, v38, 3, v35
    v_lshrrev_b32 v36, 2, v1
    v_and_b32 v37, 1, v2
    v_lshl_add_u32 v36, v37, 2, v36
    s_and_b32 s66, s56, 3
    s_lshl_b32 s66, s66, 3
    v_xor_b32 v36, s66, v36
    v_lshl_add_u32 v35, v36, 5, v35
    v_xor_b32 v36, 0, v35
    ds_read_b64_tr_b16 v[192:193], v36 offset:0
    ds_read_b64_tr_b16 v[194:195], v36 offset:4096
    v_xor_b32 v36, 32, v35
    ds_read_b64_tr_b16 v[196:197], v36 offset:0
    ds_read_b64_tr_b16 v[198:199], v36 offset:4096
    v_xor_b32 v36, 64, v35
    ds_read_b64_tr_b16 v[200:201], v36 offset:0
    ds_read_b64_tr_b16 v[202:203], v36 offset:4096
    v_xor_b32 v36, 96, v35
    ds_read_b64_tr_b16 v[204:205], v36 offset:0
    ds_read_b64_tr_b16 v[206:207], v36 offset:4096
    v_xor_b32 v36, 128, v35
    ds_read_b64_tr_b16 v[208:209], v36 offset:0
    ds_read_b64_tr_b16 v[210:211], v36 offset:4096
    v_xor_b32 v36, 160, v35
    ds_read_b64_tr_b16 v[212:213], v36 offset:0
    ds_read_b64_tr_b16 v[214:215], v36 offset:4096
    v_xor_b32 v36, 192, v35
    ds_read_b64_tr_b16 v[216:217], v36 offset:0
    ds_read_b64_tr_b16 v[218:219], v36 offset:4096
    v_xor_b32 v36, 224, v35
    ds_read_b64_tr_b16 v[220:221], v36 offset:0
    ds_read_b64_tr_b16 v[222:223], v36 offset:4096
    v_and_b32 v42, 7, v1
    v_mul_u32_u24 v34, 1040, v42
    v_lshl_add_u32 v34, v2, 4, v34
    s_lshl_b32 s66, s64, 8
    s_add_u32 s66, s66, 139264
    v_add_u32 v34, s66, v34
    v_mul_u32_u24 v35, 144, v42
    v_lshl_add_u32 v35, v2, 4, v35
    s_mul_i32 s66, s64, 1216
    s_lshl_b32 s67, s65, 6
    s_add_u32 s66, s66, s67
    s_add_u32 s66, s66, 152576
    v_add_u32 v35, s66, v35
    v_lshrrev_b32 v36, 2, v1
    v_mul_u32_u24 v36, 1216, v36
    v_mul_u32_u24 v43, 144, v38
    v_add_u32 v36, v36, v43
    v_lshl_add_u32 v36, v2, 5, v36
    v_add_u32 v36, 152576, v36
    v_lshrrev_b32 v37, 1, v38
    v_mul_u32_u24 v37, 7168, v37
    v_and_b32 v43, 1, v38
    v_lshl_add_u32 v37, v43, 6, v37
    v_lshl_add_u32 v37, v2, 4, v37
    v_lshrrev_b32 v43, 2, v1
    v_mul_u32_u24 v43, 28672, v43
    v_add_u32 v37, v37, v43
    v_lshlrev_b32 v50, 4, v38
    v_add_u32 v50, 157696, v50
    s_lshl_b32 s66, s56, 3
    s_add_u32 s66, s66, 157696
    v_mov_b32 v51, s66
    ds_read_b128 v[64:67], v34 offset:4160
    ds_read_b128 v[68:71], v34 offset:4224
    ds_read_b128 v[72:75], v34 offset:4288
    ds_read_b128 v[76:79], v34 offset:4352
    s_waitcnt lgkmcnt(0)
    v_mfma_f32_16x16x32_bf16 v[80:83], v[128:131], v[64:67], 0
    v_mfma_f32_16x16x32_bf16 v[80:83], v[132:135], v[68:71], v[80:83]
    v_mfma_f32_16x16x32_bf16 v[80:83], v[136:139], v[72:75], v[80:83]
    v_mfma_f32_16x16x32_bf16 v[80:83], v[140:143], v[76:79], v[80:83]
    s_mov_b32 exec_lo, 0xff00ff
    s_mov_b32 exec_hi, 0xff00ff
    s_nop 5
    ds_write_b128 v35, v[80:83]
    s_mov_b64 exec, -1
    s_waitcnt lgkmcnt(0)
    s_barrier
    ds_read_b128 v[176:179], v36
    ds_read_b128 v[180:183], v36 offset:16
    ds_read_b128 v[184:187], v36 offset:576
    ds_read_b128 v[188:191], v36 offset:592
    s_lshl_b32 s66, s69, 15
    s_lshl_b32 s67, s64, 13
    s_add_u32 s66, s66, s67
    s_lshl_b32 s67, s65, 9
    s_add_u32 s66, s66, s67
    s_add_u32 s66, s66, 116736
    s_add_u32 s67, s66, 4096
    s_lshl_b32 s64, s56, 5
    s_lshl_b32 s65, s69, 1
    s_add_u32 s64, s64, s65
    s_mul_i32 s64, s64, 7168
    s_lshl_b32 s65, s68, 7
    s_add_u32 s64, s64, s65
    s_add_u32 s64, s64, 215040
    s_mov_b32 s65, 0xff
    v_lshrrev_b32 v40, 0, s57
    v_lshrrev_b32 v41, 8, s57
    v_lshrrev_b32 v42, 16, s57
    v_lshrrev_b32 v43, 24, s57
    s_waitcnt lgkmcnt(0)
    v_add_f32_dpp v176, v176, v176 row_ror:8 row_mask:0xf bank_mask:0xf
    v_add_f32_dpp v177, v177, v177 row_ror:8 row_mask:0xf bank_mask:0xf
    v_add_f32_dpp v178, v178, v178 row_ror:8 row_mask:0xf bank_mask:0xf
    v_add_f32_dpp v179, v179, v179 row_ror:8 row_mask:0xf bank_mask:0xf
    v_add_f32_dpp v180, v180, v180 row_ror:8 row_mask:0xf bank_mask:0xf
    v_add_f32_dpp v181, v181, v181 row_ror:8 row_mask:0xf bank_mask:0xf
    v_add_f32_dpp v182, v182, v182 row_ror:8 row_mask:0xf bank_mask:0xf
    v_add_f32_dpp v183, v183, v183 row_ror:8 row_mask:0xf bank_mask:0xf
    v_add_f32_dpp v184, v184, v184 row_ror:8 row_mask:0xf bank_mask:0xf
    v_add_f32_dpp v185, v185, v185 row_ror:8 row_mask:0xf bank_mask:0xf
    v_add_f32_dpp v186, v186, v186 row_ror:8 row_mask:0xf bank_mask:0xf
    v_add_f32_dpp v187, v187, v187 row_ror:8 row_mask:0xf bank_mask:0xf
    v_add_f32_dpp v188, v188, v188 row_ror:8 row_mask:0xf bank_mask:0xf
    v_add_f32_dpp v189, v189, v189 row_ror:8 row_mask:0xf bank_mask:0xf
    v_add_f32_dpp v190, v190, v190 row_ror:8 row_mask:0xf bank_mask:0xf
    v_add_f32_dpp v191, v191, v191 row_ror:8 row_mask:0xf bank_mask:0xf
    v_add_f32_dpp v176, v176, v176 row_ror:4 row_mask:0xf bank_mask:0xf
    v_add_f32_dpp v177, v177, v177 row_ror:4 row_mask:0xf bank_mask:0xf
    v_add_f32_dpp v178, v178, v178 row_ror:4 row_mask:0xf bank_mask:0xf
    v_add_f32_dpp v179, v179, v179 row_ror:4 row_mask:0xf bank_mask:0xf
    v_add_f32_dpp v180, v180, v180 row_ror:4 row_mask:0xf bank_mask:0xf
    v_add_f32_dpp v181, v181, v181 row_ror:4 row_mask:0xf bank_mask:0xf
    v_add_f32_dpp v182, v182, v182 row_ror:4 row_mask:0xf bank_mask:0xf
    v_add_f32_dpp v183, v183, v183 row_ror:4 row_mask:0xf bank_mask:0xf
    v_add_f32_dpp v184, v184, v184 row_ror:4 row_mask:0xf bank_mask:0xf
    v_add_f32_dpp v185, v185, v185 row_ror:4 row_mask:0xf bank_mask:0xf
    v_add_f32_dpp v186, v186, v186 row_ror:4 row_mask:0xf bank_mask:0xf
    v_add_f32_dpp v187, v187, v187 row_ror:4 row_mask:0xf bank_mask:0xf
    v_add_f32_dpp v188, v188, v188 row_ror:4 row_mask:0xf bank_mask:0xf
    v_add_f32_dpp v189, v189, v189 row_ror:4 row_mask:0xf bank_mask:0xf
    v_add_f32_dpp v190, v190, v190 row_ror:4 row_mask:0xf bank_mask:0xf
    v_add_f32_dpp v191, v191, v191 row_ror:4 row_mask:0xf bank_mask:0xf
    v_and_b32 v57, 31, v0
    v_lshlrev_b32 v57, 4, v57
    v_lshrrev_b32 v58, 5, v0
    v_lshl_add_u32 v57, v58, 12, v57
    s_cmp_lg_u32 s56, 0
    s_cbranch_scc1 nohw_94
    s_lshl_b32 s78, s55, 7
    s_add_u32 s78, s78, 182272
    s_mov_b32 s63, 60000
hw_95:
    s_load_dword s79, s[48:49], s78 glc
    s_waitcnt lgkmcnt(0)
    s_cmp_eq_u32 s79, s57
    s_cbranch_scc1 hd_96
    s_sub_u32 s63, s63, 1
    s_cbranch_scc0 hw_95
hd_96:
nohw_94:
    s_barrier
    s_mov_b32 s63, 60000
poll_97:
    buffer_load_dwordx4 v[64:67], v57, s[48:51], s66 offen offset:0 sc1
    buffer_load_dwordx4 v[68:71], v57, s[48:51], s66 offen offset:1024 sc1
    buffer_load_dwordx4 v[72:75], v57, s[48:51], s66 offen offset:2048 sc1
    buffer_load_dwordx4 v[76:79], v57, s[48:51], s66 offen offset:3072 sc1
    s_waitcnt vmcnt(0)
    v_max3_u32 v56, v64, v66, v68
    v_max3_u32 v56, v56, v70, v72
    v_max3_u32 v56, v56, v74, v76
    v_max_u32 v56, v56, v78
    v_cmp_eq_u32 vcc, -1, v56
    s_cbranch_vccz pdone_98
    s_sub_u32 s63, s63, 1
    s_cbranch_scc0 poll_97
pdone_98:
    s_cmp_lg_u32 s56, 6
    s_cbranch_scc1 nohint_99
    s_lshl_b32 s78, s55, 7
    s_add_u32 s78, s78, 198720
    v_mov_b32 v112, s57
    v_mov_b32 v113, 0
    s_mov_b32 exec_lo, 0x1
    s_mov_b32 exec_hi, 0x0
    buffer_store_dword v112, v113, s[48:51], s78 offen sc1
    s_mov_b64 exec, -1
nohint_99:
    v_lshlrev_b32 v80, 16, v64
    v_lshlrev_b32 v81, 16, v65
    v_lshlrev_b32 v82, 16, v66
    v_lshlrev_b32 v83, 16, v67
    v_lshlrev_b32 v84, 16, v68
    v_lshlrev_b32 v85, 16, v69
    v_lshlrev_b32 v86, 16, v70
    v_lshlrev_b32 v87, 16, v71
    v_lshlrev_b32 v88, 16, v72
    v_lshlrev_b32 v89, 16, v73
    v_lshlrev_b32 v90, 16, v74
    v_lshlrev_b32 v91, 16, v75
    v_lshlrev_b32 v92, 16, v76
    v_lshlrev_b32 v93, 16, v77
    v_lshlrev_b32 v94, 16, v78
    v_lshlrev_b32 v95, 16, v79
    v_pk_add_f32 v[64:65], v[64:65], v[72:73]
    v_pk_add_f32 v[66:67], v[66:67], v[74:75]
    v_pk_add_f32 v[68:69], v[68:69], v[76:77]
    v_pk_add_f32 v[70:71], v[70:71], v[78:79]
    v_pk_add_f32 v[80:81], v[80:81], v[88:89]
    v_pk_add_f32 v[82:83], v[82:83], v[90:91]
    v_pk_add_f32 v[84:85], v[84:85], v[92:93]
    v_pk_add_f32 v[86:87], v[86:87], v[94:95]
    v_pk_add_f32 v[64:65], v[64:65], v[68:69]
    v_pk_add_f32 v[66:67], v[66:67], v[70:71]
    v_pk_add_f32 v[80:81], v[80:81], v[84:85]
    v_pk_add_f32 v[82:83], v[82:83], v[86:87]
    s_nop 1
    v_permlane32_swap_b32 v80, v82
    v_permlane32_swap_b32 v81, v83
    v_permlane32_swap_b32 v64, v66
    v_permlane32_swap_b32 v65, v67
    v_pk_add_f32 v[68:69], v[80:81], v[82:83]
    v_pk_add_f32 v[64:65], v[64:65], v[66:67]
    v_fma_f32 v80, v68, v164, v160
    v_fma_f32 v81, v64, v165, v161
    v_fma_f32 v82, v69, v166, v162
    v_fma_f32 v83, v65, v167, v163
    v_mul_f32 v84, v80, v168
    v_mul_f32 v85, v81, v169
    v_mul_f32 v86, v82, v170
    v_mul_f32 v87, v83, v171
    v_cvt_pk_bf16_f32 v88, v84, v85
    v_cvt_pk_bf16_f32 v89, v86, v87
    ds_write_b64 v39, v[88:89]
    v_add_f32 v52, v80, v81
    v_mul_f32 v53, v80, v80
    v_add_f32 v54, v82, v83
    v_fmac_f32 v53, v81, v81
    v_add_f32 v52, v52, v54
    v_fmac_f32 v53, v82, v82
    v_fmac_f32 v53, v83, v83
    s_waitcnt lgkmcnt(0)
    s_barrier
    ds_read_b128 v[64:67], v34 offset:0
    ds_read_b128 v[68:71], v34 offset:64
    ds_read_b128 v[72:75], v34 offset:128
    ds_read_b128 v[76:79], v34 offset:192
    v_add_f32_dpp v52, v52, v52 row_ror:8 row_mask:0xf bank_mask:0xf
    v_add_f32_dpp v53, v53, v53 row_ror:8 row_mask:0xf bank_mask:0xf
    s_nop 0
    v_add_f32_dpp v52, v52, v52 row_ror:4 row_mask:0xf bank_mask:0xf
    v_add_f32_dpp v53, v53, v53 row_ror:4 row_mask:0xf bank_mask:0xf
    s_nop 0
    v_add_f32_dpp v52, v52, v52 row_ror:2 row_mask:0xf bank_mask:0xf
    v_add_f32_dpp v53, v53, v53 row_ror:2 row_mask:0xf bank_mask:0xf
    s_nop 0
    v_add_f32_dpp v52, v52, v52 row_ror:1 row_mask:0xf bank_mask:0xf
    v_add_f32_dpp v53, v53, v53 row_ror:1 row_mask:0xf bank_mask:0xf
    s_waitcnt lgkmcnt(3)
    v_mfma_f32_16x16x32_bf16 v[80:83], v[128:131], v[64:67], 0
    s_waitcnt lgkmcnt(2)
    v_mfma_f32_16x16x32_bf16 v[80:83], v[132:135], v[68:71], v[80:83]
    s_waitcnt lgkmcnt(1)
    v_mfma_f32_16x16x32_bf16 v[80:83], v[136:139], v[72:75], v[80:83]
    s_waitcnt lgkmcnt(0)
    v_mfma_f32_16x16x32_bf16 v[80:83], v[140:143], v[76:79], v[80:83]
    v_add_f32_dpp v52, v52, v52 row_bcast:15 row_mask:0xa bank_mask:0xf
    v_add_f32_dpp v53, v53, v53 row_bcast:15 row_mask:0xa bank_mask:0xf
    s_nop 0
    v_add_f32_dpp v52, v52, v52 row_bcast:31 row_mask:0xc bank_mask:0xf
    v_add_f32_dpp v53, v53, v53 row_bcast:31 row_mask:0xc bank_mask:0xf
    s_mov_b32 exec_lo, 0x0
    s_mov_b32 exec_hi, 0x80000000
    ds_write_b64 v51, v[52:53]
    s_mov_b32 exec_lo, 0xf000f
    s_mov_b32 exec_hi, 0xf000f
    ds_write_b128 v35, v[80:83]
    s_mov_b64 exec, -1
    s_waitcnt lgkmcnt(0)
    s_barrier
    s_cmp_ge_u32 s56, 4
    s_cbranch_scc1 L_fin
    s_add_u32 s66, s64, 114688
    ds_read_b128 v[52:55], v50
    ds_read_b128 v[64:67], v36
    ds_read_b128 v[68:71], v36 offset:16
    s_waitcnt lgkmcnt(2)
    v_add_f32 v52, v52, v54
    v_add_f32 v53, v53, v55
    v_mul_f32 v52, 0x3b000000, v52
    v_mul_f32 v53, 0x3b000000, v53
    v_fma_f32 v53, -v52, v52, v53
    v_max_f32 v53, 0, v53
    v_add_f32 v53, 0x3727c5ac, v53
    v_rsq_f32 v53, v53
    s_waitcnt lgkmcnt(0)
    v_add_f32_dpp v64, v64, v64 row_ror:8 row_mask:0xf bank_mask:0xf
    v_add_f32_dpp v65, v65, v65 row_ror:8 row_mask:0xf bank_mask:0xf
    v_add_f32_dpp v66, v66, v66 row_ror:8 row_mask:0xf bank_mask:0xf
    v_add_f32_dpp v67, v67, v67 row_ror:8 row_mask:0xf bank_mask:0xf
    v_add_f32_dpp v68, v68, v68 row_ror:8 row_mask:0xf bank_mask:0xf
    v_add_f32_dpp v69, v69, v69 row_ror:8 row_mask:0xf bank_mask:0xf
    v_add_f32_dpp v70, v70, v70 row_ror:8 row_mask:0xf bank_mask:0xf
    v_add_f32_dpp v71, v71, v71 row_ror:8 row_mask:0xf bank_mask:0xf
    v_add_f32_dpp v64, v64, v64 row_ror:4 row_mask:0xf bank_mask:0xf
    v_add_f32_dpp v65, v65, v65 row_ror:4 row_mask:0xf bank_mask:0xf
    v_add_f32_dpp v66, v66, v66 row_ror:4 row_mask:0xf bank_mask:0xf
    v_add_f32_dpp v67, v67, v67 row_ror:4 row_mask:0xf bank_mask:0xf
    v_add_f32_dpp v68, v68, v68 row_ror:4 row_mask:0xf bank_mask:0xf
    v_add_f32_dpp v69, v69, v69 row_ror:4 row_mask:0xf bank_mask:0xf
    v_add_f32_dpp v70, v70, v70 row_ror:4 row_mask:0xf bank_mask:0xf
    v_add_f32_dpp v71, v71, v71 row_ror:4 row_mask:0xf bank_mask:0xf
    v_mov_b32 v54, v53
    v_mov_b32 v55, v53
    v_sub_f32 v52, 0, v52
    v_mov_b32 v53, v52
    v_pk_fma_f32 v[64:65], v[52:53], v[176:177], v[64:65]
    v_pk_fma_f32 v[66:67], v[52:53], v[178:179], v[66:67]
    v_pk_fma_f32 v[68:69], v[52:53], v[180:181], v[68:69]
    v_pk_fma_f32 v[70:71], v[52:53], v[182:183], v[70:71]
    v_pk_fma_f32 v[64:65], v[54:55], v[64:65], v[184:185]
    v_pk_fma_f32 v[66:67], v[54:55], v[66:67], v[186:187]
    v_pk_fma_f32 v[68:69], v[54:55], v[68:69], v[188:189]
    v_pk_fma_f32 v[70:71], v[54:55], v[70:71], v[190:191]
    v_cvt_pk_bf16_f32 v72, v64, v65
    v_cvt_pk_bf16_f32 v73, v66, v67
    v_cvt_pk_bf16_f32 v74, v68, v69
    v_cvt_pk_bf16_f32 v75, v70, v71
    v_pk_max_i16 v72, v72, 0
    v_pk_max_i16 v73, v73, 0
    v_pk_max_i16 v74, v74, 0
    v_pk_max_i16 v75, v75, 0
    s_nop 1
    v_mfma_f32_16x16x32_bf16 v[80:83], v[192:195], v[72:75], 0
    v_mfma_f32_16x16x32_bf16 v[84:87], v[196:199], v[72:75], 0
    v_mfma_f32_16x16x32_bf16 v[88:91], v[200:203], v[72:75], 0
    v_mfma_f32_16x16x32_bf16 v[92:95], v[204:207], v[72:75], 0
    v_mfma_f32_16x16x32_bf16 v[96:99], v[208:211], v[72:75], 0
    v_mfma_f32_16x16x32_bf16 v[100:103], v[212:215], v[72:75], 0
    v_mfma_f32_16x16x32_bf16 v[104:107], v[216:219], v[72:75], 0
    v_mfma_f32_16x16x32_bf16 v[108:111], v[220:223], v[72:75], 0
    s_nop 1
    v_mov_b32_dpp v80, v84 quad_perm:[0,1,2,3] row_mask:0xf bank_mask:0x2
    v_mov_b32_dpp v81, v85 quad_perm:[0,1,2,3] row_mask:0xf bank_mask:0x2
    v_mov_b32_dpp v82, v86 quad_perm:[0,1,2,3] row_mask:0xf bank_mask:0x2
    v_mov_b32_dpp v83, v87 quad_perm:[0,1,2,3] row_mask:0xf bank_mask:0x2
    v_mov_b32_dpp v80, v88 quad_perm:[0,1,2,3] row_mask:0xf bank_mask:0x4
    v_mov_b32_dpp v81, v89 quad_perm:[0,1,2,3] row_mask:0xf bank_mask:0x4
    v_mov_b32_dpp v82, v90 quad_perm:[0,1,2,3] row_mask:0xf bank_mask:0x4
    v_mov_b32_dpp v83, v91 quad_perm:[0,1,2,3] row_mask:0xf bank_mask:0x4
    v_mov_b32_dpp v80, v92 quad_perm:[0,1,2,3] row_mask:0xf bank_mask:0x8
    v_mov_b32_dpp v81, v93 quad_perm:[0,1,2,3] row_mask:0xf bank_mask:0x8
    v_mov_b32_dpp v82, v94 quad_perm:[0,1,2,3] row_mask:0xf bank_mask:0x8
    v_mov_b32_dpp v83, v95 quad_perm:[0,1,2,3] row_mask:0xf bank_mask:0x8
    v_bfi_b32 v80, s65, v40, v80
    v_bfi_b32 v81, s65, v41, v81
    v_bfi_b32 v82, s65, v42, v82
    v_bfi_b32 v83, s65, v43, v83
    buffer_store_dwordx4 v[80:83], v37, s[48:51], s64 offen sc1
    v_mov_b32_dpp v96, v100 quad_perm:[0,1,2,3] row_mask:0xf bank_mask:0x2
    v_mov_b32_dpp v97, v101 quad_perm:[0,1,2,3] row_mask:0xf bank_mask:0x2
    v_mov_b32_dpp v98, v102 quad_perm:[0,1,2,3] row_mask:0xf bank_mask:0x2
    v_mov_b32_dpp v99, v103 quad_perm:[0,1,2,3] row_mask:0xf bank_mask:0x2
    v_mov_b32_dpp v96, v104 quad_perm:[0,1,2,3] row_mask:0xf bank_mask:0x4
    v_mov_b32_dpp v97, v105 quad_perm:[0,1,2,3] row_mask:0xf bank_mask:0x4
    v_mov_b32_dpp v98, v106 quad_perm:[0,1,2,3] row_mask:0xf bank_mask:0x4
    v_mov_b32_dpp v99, v107 quad_perm:[0,1,2,3] row_mask:0xf bank_mask:0x4
    v_mov_b32_dpp v96, v108 quad_perm:[0,1,2,3] row_mask:0xf bank_mask:0x8
    v_mov_b32_dpp v97, v109 quad_perm:[0,1,2,3] row_mask:0xf bank_mask:0x8
    v_mov_b32_dpp v98, v110 quad_perm:[0,1,2,3] row_mask:0xf bank_mask:0x8
    v_mov_b32_dpp v99, v111 quad_perm:[0,1,2,3] row_mask:0xf bank_mask:0x8
    v_bfi_b32 v96, s65, v40, v96
    v_bfi_b32 v97, s65, v41, v97
    v_bfi_b32 v98, s65, v42, v98
    v_bfi_b32 v99, s65, v43, v99
    buffer_store_dwordx4 v[96:99], v37, s[48:51], s66 offen sc1
    s_cmp_lg_u32 s56, 0
    s_cbranch_scc1 nohint_100
    s_lshl_b32 s78, s55, 7
    s_add_u32 s78, s78, 198656
    v_mov_b32 v112, s57
    v_mov_b32 v113, 0
    s_mov_b32 exec_lo, 0x1
    s_mov_b32 exec_hi, 0x0
    buffer_store_dword v112, v113, s[48:51], s78 offen sc1
    s_mov_b64 exec, -1
nohint_100:
L_fin:
L_end:
    s_endpgm
L_code_end:
.section .rodata,"a"
.p2align 6
.amdhsa_kernel adaLN_cond__compressed_kv_cla__dense_activation_relu__decode_kernel
  .amdhsa_next_free_vgpr 256
  .amdhsa_next_free_sgpr 102
  .amdhsa_accum_offset 256
  .amdhsa_group_segment_fixed_size 0
  .amdhsa_kernarg_size 112
  .amdhsa_user_sgpr_count 2
  .amdhsa_user_sgpr_kernarg_segment_ptr 1
  .amdhsa_system_sgpr_workgroup_id_x 1
.end_amdhsa_kernel
```

```asm
; @launch grid=(256,1,1) block=(512,1,1) lds=163840
.amdgcn_target "amdgcn-amd-amdhsa--gfx950"
.text
.globl adaLN_cond__compressed_kv_cla__dense_activation_relu__decode_kernel
.p2align 8
.type adaLN_cond__compressed_kv_cla__dense_activation_relu__decode_kernel,@function
adaLN_cond__compressed_kv_cla__dense_activation_relu__decode_kernel:
    s_cmp_ge_u32 s2, 256
    s_cbranch_scc1 L_end
    s_load_dwordx2 s[36:37], s[0:1], 72
    s_load_dwordx2 s[40:41], s[0:1], 80
    s_load_dwordx2 s[48:49], s[0:1], 104
    s_load_dwordx2 s[8:9], s[0:1], 8
    s_load_dwordx2 s[4:5], s[0:1], 0
    s_load_dwordx2 s[12:13], s[0:1], 16
    s_load_dwordx2 s[16:17], s[0:1], 24
    v_mov_b32 v3, v0
    v_lshrrev_b32 v4, 6, v0
    v_and_b32 v0, 63, v0
    v_readfirstlane_b32 s56, v4
    v_and_b32 v1, 15, v0
    v_lshrrev_b32 v2, 4, v0
    s_and_b32 s52, s2, 7
    s_lshr_b32 s53, s2, 3
    s_and_b32 s54, s53, 15
    s_lshl_b32 s55, s52, 4
    s_add_u32 s55, s55, s54
    v_lshlrev_b32 v16, 4, v3
    s_mov_b32 s38, 8192
    s_mov_b32 s39, 0x00020000
    s_mov_b32 s42, 3145728
    s_mov_b32 s43, 0x00020000
    s_mov_b32 s50, 15728640
    s_mov_b32 s51, 0x00020000
    s_mov_b32 s6, 8192
    s_mov_b32 s7, 0x00020000
    v_and_b32 v4, 7, v1
    v_lshlrev_b32 v4, 10, v4
    v_lshrrev_b32 v5, 3, v1
    v_lshl_add_u32 v4, v5, 6, v4
    v_lshl_add_u32 v4, v2, 4, v4
    s_cmp_ge_u32 s53, 16
    s_cbranch_scc1 L_att0
    s_cmp_lg_u32 s56, 0
    s_cbranch_scc1 L_svc0
    s_and_b32 s61, s54, 3
    s_lshl_b32 s64, s61, 8
    v_lshrrev_b32 v5, 2, v0
    v_mul_u32_u24 v5, 6144, v5
    v_and_b32 v18, 3, v0
    v_lshrrev_b32 v17, 5, v0
    v_lshlrev_b32 v17, 1, v17
    v_xor_b32 v18, v18, v17
    v_lshl_add_u32 v5, v18, 4, v5
    s_lshr_b32 s66, s55, 2
    s_lshl_b32 s66, s66, 6
    s_mul_i32 s65, s61, 786432
    s_add_u32 s65, s65, s66
    s_mov_b32 m0, 131072
    v_mov_b32 v20, -1
    v_mov_b32 v21, -1
    v_mov_b32 v22, -1
    v_mov_b32 v23, -1
    s_lshl_b32 s68, s52, 18
    s_lshl_b32 s67, s54, 11
    s_add_u32 s68, s68, s67
    s_add_u32 s35, s68, s67
    s_add_u32 s35, s35, 2293760
    s_add_u32 s67, s68, 2097152
    s_mul_i32 s68, s55, 656
    s_add_u32 s68, s68, 32768
    v_add_u32 v17, s68, v16
    s_add_u32 s68, s35, 368
    v_min_u32 v18, 48, v0
    v_lshl_add_u32 v18, v18, 4, s68
    v_cmp_lt_u32 vcc, 40, v0
    s_nop 1
    v_cndmask_b32 v17, v17, v18, vcc
    s_waitcnt lgkmcnt(0)
    s_load_dword s57, s[48:49], 0
    buffer_load_dwordx4 v[40:43], v4, s[36:39], s64 offen
    buffer_load_dwordx4 v[44:47], v4, s[36:39], s64 offen offset:128
    buffer_load_dwordx4 v5, s[40:43], s65 offen  lds
    s_add_u32 s65, s65, 98304
    s_add_u32 m0, m0, 1024
    s_nop 0
    buffer_load_dwordx4 v5, s[40:43], s65 offen  lds
    s_add_u32 s65, s65, 98304
    s_add_u32 m0, m0, 1024
    s_nop 0
    buffer_load_dwordx4 v5, s[40:43], s65 offen  lds
    s_add_u32 s65, s65, 98304
    s_add_u32 m0, m0, 1024
    s_nop 0
    buffer_load_dwordx4 v5, s[40:43], s65 offen  lds
    s_add_u32 s65, s65, 98304
    s_add_u32 m0, m0, 1024
    s_nop 0
    buffer_load_dwordx4 v5, s[40:43], s65 offen  lds
    s_add_u32 s65, s65, 98304
    s_add_u32 m0, m0, 1024
    s_nop 0
    buffer_load_dwordx4 v5, s[40:43], s65 offen  lds
    s_add_u32 s65, s65, 98304
    s_add_u32 m0, m0, 1024
    s_nop 0
    buffer_load_dwordx4 v5, s[40:43], s65 offen  lds
    s_add_u32 s65, s65, 98304
    s_add_u32 m0, m0, 1024
    s_nop 0
    buffer_load_dwordx4 v5, s[40:43], s65 offen  lds
    buffer_store_dwordx4 v[20:23], v16, s[48:51], s67 offen sc1
    buffer_store_dwordx4 v[20:23], v16, s[48:51], s67 offen offset:1024 sc1
    buffer_store_dwordx4 v[20:23], v17, s[48:51], 0 offen sc1
    s_branch L_p1
L_svc0:
    v_lshlrev_b32 v17, 4, v0
    s_waitcnt lgkmcnt(0)
    s_load_dword s57, s[48:49], 0
    buffer_load_dwordx4 v[8:11], v16, s[4:7], 0 offen
    s_cmp_lg_u32 s56, 3
    s_cbranch_scc1 wi_1
    buffer_load_dwordx4 v[40:43], v17, s[4:7], 0 offen
wi_1:
    s_branch L_svc
L_att0:
    s_cmp_ge_u32 s56, 4
    s_cbranch_scc0 L_atq
    s_barrier
    s_barrier
    s_branch L_pv
L_atq:
    s_getpc_b64 s[64:65]
pc_3:
    s_sub_u32 s64, s64, pc_3-adaLN_cond__compressed_kv_cla__dense_activation_relu__decode_kernel
    s_subb_u32 s65, s65, 0
    s_lshl_b32 s66, s56, 4
    s_add_u32 s66, s66, s54
    s_lshl_b32 s66, s66, 10
    s_cmp_ge_u32 s66, L_code_end-adaLN_cond__compressed_kv_cla__dense_activation_relu__decode_kernel
    s_cbranch_scc1 cpf_4
    s_min_u32 s66, s66, L_code_end-adaLN_cond__compressed_kv_cla__dense_activation_relu__decode_kernel-1024
    v_lshl_add_u32 v32, v0, 4, s66
    global_load_dword v64, v32, s[64:65]
cpf_4:
    s_mov_b32 s18, 4194304
    s_mov_b32 s19, 0x00020000
    v_lshrrev_b32 v33, 3, v3
    v_lshlrev_b32 v33, 13, v33
    v_and_b32 v34, 7, v0
    v_lshl_add_u32 v33, v34, 7, v33
    s_lshl_b32 s67, s54, 18
    s_lshl_b32 s68, s52, 10
    s_add_u32 s67, s67, s68
    s_mov_b32 s14, 4194304
    s_mov_b32 s15, 0x00020000
    s_mov_b32 exec_lo, 0xffffffff
    s_mov_b32 exec_hi, 0xffffffff
    s_waitcnt lgkmcnt(0)
    buffer_load_dword v69, v33, s[12:15], s67 offen
    s_mov_b64 exec, -1
    s_barrier
    s_mov_b32 exec_lo, 0xffffffff
    s_mov_b32 exec_hi, 0xffffffff
    buffer_load_dword v68, v33, s[16:19], s67 offen
    s_mov_b64 exec, -1
    s_lshl_b32 s66, s54, 12
    s_lshl_b32 s65, s52, 18
    s_add_u32 s66, s66, s65
    s_add_u32 s66, s66, 2162688
    buffer_load_dword v70, v16, s[48:51], s66 offen sc1
    s_barrier
    s_branch L_qk
L_p1:
    v_lshrrev_b32 v48, 2, v1
    v_lshl_add_u32 v48, v2, 3, v48
    v_lshlrev_b32 v48, 6, v48
    v_and_b32 v50, 3, v1
    v_lshl_add_u32 v48, v50, 3, v48
    v_and_b32 v50, 1, v2
    v_lshl_add_u32 v48, v50, 5, v48
    v_add_u32 v48, 131072, v48
    v_xor_b32 v49, 32, v48
    v_lshlrev_b32 v50, 6, v1
    v_lshl_add_u32 v50, v2, 4, v50
    s_waitcnt vmcnt(11)
    v_lshlrev_b32 v64, 16, v40
    v_and_b32 v65, 0xffff0000, v40
    v_lshlrev_b32 v66, 16, v41
    v_and_b32 v67, 0xffff0000, v41
    v_lshlrev_b32 v68, 16, v42
    v_and_b32 v69, 0xffff0000, v42
    v_lshlrev_b32 v70, 16, v43
    v_and_b32 v71, 0xffff0000, v43
    v_lshlrev_b32 v72, 16, v44
    v_and_b32 v73, 0xffff0000, v44
    v_lshlrev_b32 v74, 16, v45
    v_and_b32 v75, 0xffff0000, v45
    v_lshlrev_b32 v76, 16, v46
    v_and_b32 v77, 0xffff0000, v46
    v_lshlrev_b32 v78, 16, v47
    v_and_b32 v79, 0xffff0000, v47
    v_mul_f32 v80, 0xbfb8aa3b, v64
    v_mul_f32 v81, 0xbfb8aa3b, v65
    v_mul_f32 v82, 0xbfb8aa3b, v66
    v_mul_f32 v83, 0xbfb8aa3b, v67
    v_mul_f32 v84, 0xbfb8aa3b, v68
    v_mul_f32 v85, 0xbfb8aa3b, v69
    v_mul_f32 v86, 0xbfb8aa3b, v70
    v_mul_f32 v87, 0xbfb8aa3b, v71
    v_mul_f32 v88, 0xbfb8aa3b, v72
    v_mul_f32 v89, 0xbfb8aa3b, v73
    v_mul_f32 v90, 0xbfb8aa3b, v74
    v_mul_f32 v91, 0xbfb8aa3b, v75
    v_mul_f32 v92, 0xbfb8aa3b, v76
    v_mul_f32 v93, 0xbfb8aa3b, v77
    v_mul_f32 v94, 0xbfb8aa3b, v78
    v_mul_f32 v95, 0xbfb8aa3b, v79
    v_exp_f32 v80, v80
    v_exp_f32 v81, v81
    v_exp_f32 v82, v82
    v_exp_f32 v83, v83
    v_exp_f32 v84, v84
    v_exp_f32 v85, v85
    v_exp_f32 v86, v86
    v_exp_f32 v87, v87
    v_exp_f32 v88, v88
    v_exp_f32 v89, v89
    v_exp_f32 v90, v90
    v_exp_f32 v91, v91
    v_exp_f32 v92, v92
    v_exp_f32 v93, v93
    v_exp_f32 v94, v94
    v_exp_f32 v95, v95
    v_add_f32 v80, 1.0, v80
    v_add_f32 v81, 1.0, v81
    v_add_f32 v82, 1.0, v82
    v_add_f32 v83, 1.0, v83
    v_add_f32 v84, 1.0, v84
    v_add_f32 v85, 1.0, v85
    v_add_f32 v86, 1.0, v86
    v_add_f32 v87, 1.0, v87
    v_add_f32 v88, 1.0, v88
    v_add_f32 v89, 1.0, v89
    v_add_f32 v90, 1.0, v90
    v_add_f32 v91, 1.0, v91
    v_add_f32 v92, 1.0, v92
    v_add_f32 v93, 1.0, v93
    v_add_f32 v94, 1.0, v94
    v_add_f32 v95, 1.0, v95
    v_rcp_f32 v80, v80
    v_rcp_f32 v81, v81
    v_rcp_f32 v82, v82
    v_rcp_f32 v83, v83
    v_rcp_f32 v84, v84
    v_rcp_f32 v85, v85
    v_rcp_f32 v86, v86
    v_rcp_f32 v87, v87
    v_rcp_f32 v88, v88
    v_rcp_f32 v89, v89
    v_rcp_f32 v90, v90
    v_rcp_f32 v91, v91
    v_rcp_f32 v92, v92
    v_rcp_f32 v93, v93
    v_rcp_f32 v94, v94
    v_rcp_f32 v95, v95
    v_mul_f32 v64, v64, v80
    v_mul_f32 v65, v65, v81
    v_mul_f32 v66, v66, v82
    v_mul_f32 v67, v67, v83
    v_mul_f32 v68, v68, v84
    v_mul_f32 v69, v69, v85
    v_mul_f32 v70, v70, v86
    v_mul_f32 v71, v71, v87
    v_mul_f32 v72, v72, v88
    v_mul_f32 v73, v73, v89
    v_mul_f32 v74, v74, v90
    v_mul_f32 v75, v75, v91
    v_mul_f32 v76, v76, v92
    v_mul_f32 v77, v77, v93
    v_mul_f32 v78, v78, v94
    v_mul_f32 v79, v79, v95
    v_cvt_pk_bf16_f32 v52, v64, v65
    v_cvt_pk_bf16_f32 v53, v66, v67
    v_cvt_pk_bf16_f32 v54, v68, v69
    v_cvt_pk_bf16_f32 v55, v70, v71
    v_cvt_pk_bf16_f32 v56, v72, v73
    v_cvt_pk_bf16_f32 v57, v74, v75
    v_cvt_pk_bf16_f32 v58, v76, v77
    v_cvt_pk_bf16_f32 v59, v78, v79
    s_waitcnt lgkmcnt(0)
    ds_write_b128 v16, v[52:55] offset:45056
    ds_write_b128 v16, v[56:59] offset:46080
    s_mul_i32 s57, s57, 0x9e3779b1
    s_add_u32 s57, s57, 0x7f4a7c15
    s_getreg_b32 s28, hwreg(HW_REG_XCC_ID)
    s_not_b32 s67, s57
    s_xor_b32 s28, s67, s28
    v_bfe_u32 v12, s57, 0, 8
    v_bfe_u32 v13, s57, 8, 8
    v_bfe_u32 v14, s57, 16, 8
    v_bfe_u32 v15, s57, 24, 8
    s_mov_b32 s67, 0xff
    s_waitcnt lgkmcnt(0)
    s_waitcnt vmcnt(9)
    ds_read_b64_tr_b16 v[64:65], v48 offset:0
    ds_read_b64_tr_b16 v[66:67], v48 offset:256
    ds_read_b64_tr_b16 v[68:69], v49 offset:0
    ds_read_b64_tr_b16 v[70:71], v49 offset:256
    s_waitcnt vmcnt(7)
    ds_read_b64_tr_b16 v[72:73], v48 offset:2048
    ds_read_b64_tr_b16 v[74:75], v48 offset:2304
    ds_read_b64_tr_b16 v[76:77], v49 offset:2048
    ds_read_b64_tr_b16 v[78:79], v49 offset:2304
    s_waitcnt vmcnt(5)
    ds_read_b64_tr_b16 v[80:81], v48 offset:4096
    ds_read_b64_tr_b16 v[82:83], v48 offset:4352
    ds_read_b64_tr_b16 v[84:85], v49 offset:4096
    ds_read_b64_tr_b16 v[86:87], v49 offset:4352
    s_waitcnt vmcnt(3)
    ds_read_b64_tr_b16 v[88:89], v48 offset:6144
    ds_read_b64_tr_b16 v[90:91], v48 offset:6400
    ds_read_b64_tr_b16 v[92:93], v49 offset:6144
    ds_read_b64_tr_b16 v[94:95], v49 offset:6400
    s_waitcnt lgkmcnt(14)
    v_mfma_f32_16x16x32_bf16 v[96:99], v[64:67], v[52:55], 0
    s_waitcnt lgkmcnt(12)
    v_mfma_f32_16x16x32_bf16 v[104:107], v[68:71], v[52:55], 0
    s_waitcnt lgkmcnt(10)
    v_mfma_f32_16x16x32_bf16 v[100:103], v[72:75], v[52:55], 0
    s_waitcnt lgkmcnt(8)
    v_mfma_f32_16x16x32_bf16 v[108:111], v[76:79], v[52:55], 0
    s_waitcnt lgkmcnt(6)
    v_mfma_f32_16x16x32_bf16 v[96:99], v[80:83], v[56:59], v[96:99]
    s_waitcnt lgkmcnt(4)
    v_mfma_f32_16x16x32_bf16 v[104:107], v[84:87], v[56:59], v[104:107]
    s_waitcnt lgkmcnt(2)
    v_mfma_f32_16x16x32_bf16 v[100:103], v[88:91], v[56:59], v[100:103]
    s_waitcnt lgkmcnt(0)
    v_mfma_f32_16x16x32_bf16 v[108:111], v[92:95], v[56:59], v[108:111]
    s_nop 5
    v_add_f32_dpp v112, v100, v96 row_ror:8 row_mask:0xf bank_mask:0x3
    v_add_f32_dpp v113, v101, v97 row_ror:8 row_mask:0xf bank_mask:0x3
    v_add_f32_dpp v114, v102, v98 row_ror:8 row_mask:0xf bank_mask:0x3
    v_add_f32_dpp v115, v103, v99 row_ror:8 row_mask:0xf bank_mask:0x3
    v_add_f32_dpp v112, v104, v108 row_ror:8 row_mask:0xf bank_mask:0xc
    v_add_f32_dpp v113, v105, v109 row_ror:8 row_mask:0xf bank_mask:0xc
    v_add_f32_dpp v114, v106, v110 row_ror:8 row_mask:0xf bank_mask:0xc
    v_add_f32_dpp v115, v107, v111 row_ror:8 row_mask:0xf bank_mask:0xc
    v_bfi_b32 v112, s67, v12, v112
    v_bfi_b32 v113, s67, v13, v113
    v_bfi_b32 v114, s67, v14, v114
    v_bfi_b32 v115, s67, v15, v115
    s_waitcnt vmcnt(0)
    buffer_store_dwordx4 v[112:115], v50, s[48:51], s35 offen sc1
    v_mov_b32 v60, s57
    s_mov_b32 exec_lo, 0x1
    s_mov_b32 exec_hi, 0x0
    buffer_store_dword v60, v16, s[48:51], s35 offen offset:1024 sc1
    s_mov_b64 exec, -1
    s_barrier
L_svc:
    s_load_dwordx2 s[20:21], s[0:1], 32
    s_load_dwordx2 s[24:25], s[0:1], 40
    s_load_dwordx2 s[44:45], s[0:1], 88
    s_mov_b32 s22, 4194304
    s_mov_b32 s23, 0x00020000
    s_mov_b32 s26, 4194304
    s_mov_b32 s27, 0x00020000
    s_mov_b32 s46, 8192
    s_mov_b32 s47, 0x00020000
    s_mov_b32 s18, 4194304
    s_mov_b32 s19, 0x00020000
    s_mov_b32 s10, 33554432
    s_mov_b32 s11, 0x00020000
    s_lshr_b32 s60, s55, 2
    s_and_b32 s61, s54, 3
    v_lshlrev_b32 v29, 13, v2
    s_and_b32 s69, s56, 3
    s_lshl_b32 s67, s61, 20
    s_lshl_b32 s68, s69, 18
    s_add_u32 s67, s67, s68
    s_lshl_b32 s68, s60, 8
    s_add_u32 s67, s67, s68
    s_lshl_b32 s68, s69, 13
    s_mul_i32 s72, s52, 196608
    s_mul_i32 s73, s52, 229376
    s_mov_b32 s76, 0x05040100
    s_mov_b32 s77, 0x07060302
    v_lshrrev_b32 v17, 2, v1
    v_and_b32 v38, 3, v1
    v_lshl_add_u32 v28, v2, 3, v17
    v_lshlrev_b32 v36, 8, v28
    v_lshl_add_u32 v36, v38, 3, v36
    v_lshlrev_b32 v5, 7, v28
    v_lshl_add_u32 v5, v38, 3, v5
    v_bfe_u32 v28, v1, 3, 1
    v_lshl_add_u32 v5, v28, 5, v5
    v_and_b32 v37, 1, v2
    v_lshl_add_u32 v5, v37, 6, v5
    v_and_b32 v19, 7, v1
    v_lshlrev_b32 v95, 1, v37
    v_xor_b32 v95, v95, v19
    v_lshlrev_b32 v95, 4, v95
    v_lshl_add_u32 v37, v37, 2, v17
    v_xor_b32 v37, s56, v37
    v_lshl_add_u32 v36, v37, 5, v36
    s_lshl_b32 s66, s56, 5
    v_bfe_u32 v28, v0, 2, 3
    v_and_b32 v21, 3, v0
    v_lshrrev_b32 v22, 5, v0
    v_lshl_add_u32 v22, v21, 1, v22
    v_mul_u32_u24 v20, 272, v28
    v_lshl_add_u32 v20, v22, 2, v20
    v_add_u32 v20, s66, v20
    v_lshlrev_b32 v24, 10, v28
    v_lshl_add_u32 v24, v22, 2, v24
    s_lshl_b32 s64, s61, 8
    s_add_u32 s64, s64, s66
    v_add_u32 v21, s64, v24
    v_mul_u32_u24 v22, 272, v19
    v_lshrrev_b32 v28, 3, v1
    v_lshl_add_u32 v22, v28, 6, v22
    v_lshl_add_u32 v22, v2, 4, v22
    v_lshlrev_b32 v17, 3, v0
    v_lshlrev_b32 v23, 6, v19
    v_lshl_add_u32 v23, v2, 4, v23
    v_and_b32 v26, 31, v0
    v_lshlrev_b32 v26, 4, v26
    v_lshrrev_b32 v28, 5, v0
    v_lshl_add_u32 v39, v28, 12, v26
    v_lshl_add_u32 v26, v28, 12, v26
    v_add_u32 v27, 8192, v26
    v_lshrrev_b32 v32, 3, v0
    v_mul_u32_u24 v32, 6144, v32
    v_add_u32 v32, v32, v95
    v_xor_b32 v33, 64, v32
    s_lshl_b32 s64, s61, 2
    s_add_u32 s64, s64, s69
    s_mul_i32 s33, s64, 196608
    s_lshl_b32 s64, s60, 7
    s_add_u32 s33, s33, s64
    s_add_u32 s33, s33, 2048
    s_lshl_b32 s34, s69, 12
    s_add_u32 s34, s34, 139264
    s_lshl_b32 s64, s61, 18
    s_lshr_b32 s65, s56, 1
    s_lshl_b32 s65, s65, 14
    s_add_u32 s64, s64, s65
    s_and_b32 s65, s56, 1
    s_lshl_b32 s65, s65, 9
    s_add_u32 s64, s64, s65
    s_add_u32 s30, s64, 2293760
    s_add_u32 s31, s30, 1048576
    v_lshlrev_b32 v34, 7, v2
    s_lshl_b32 s29, s60, 9
    s_add_u32 s29, s29, 4096
    s_cmp_eq_u32 s56, 0
    s_cbranch_scc1 L_svc4
    s_waitcnt vmcnt(0)
    v_mov_b32 v44, v16
    s_cmp_eq_u32 s56, 3
    s_cselect_b32 s68, 1, 0
L_ln:
    v_lshlrev_b32 v96, 16, v8
    v_and_b32 v97, 0xffff0000, v8
    v_lshlrev_b32 v98, 16, v9
    v_and_b32 v99, 0xffff0000, v9
    v_lshlrev_b32 v100, 16, v10
    v_and_b32 v101, 0xffff0000, v10
    v_lshlrev_b32 v102, 16, v11
    v_and_b32 v103, 0xffff0000, v11
    v_readfirstlane_b32 s64, v96
    s_nop 1
    v_subrev_f32 v72, s64, v96
    v_subrev_f32 v73, s64, v97
    v_subrev_f32 v74, s64, v98
    v_subrev_f32 v75, s64, v99
    v_subrev_f32 v76, s64, v100
    v_subrev_f32 v77, s64, v101
    v_subrev_f32 v78, s64, v102
    v_subrev_f32 v79, s64, v103
    v_add_f32 v80, v72, v73
    v_mul_f32 v81, v72, v72
    v_fmac_f32 v81, v73, v73
    v_add_f32 v80, v80, v74
    v_fmac_f32 v81, v74, v74
    v_add_f32 v80, v80, v75
    v_fmac_f32 v81, v75, v75
    v_add_f32 v80, v80, v76
    v_fmac_f32 v81, v76, v76
    v_add_f32 v80, v80, v77
    v_fmac_f32 v81, v77, v77
    v_add_f32 v80, v80, v78
    v_fmac_f32 v81, v78, v78
    v_add_f32 v80, v80, v79
    v_fmac_f32 v81, v79, v79
    s_nop 0
    v_add_f32_dpp v80, v80, v80 row_ror:8 row_mask:0xf bank_mask:0xf
    v_add_f32_dpp v81, v81, v81 row_ror:8 row_mask:0xf bank_mask:0xf
    s_nop 0
    v_add_f32_dpp v80, v80, v80 row_ror:4 row_mask:0xf bank_mask:0xf
    v_add_f32_dpp v81, v81, v81 row_ror:4 row_mask:0xf bank_mask:0xf
    s_nop 0
    v_add_f32_dpp v80, v80, v80 row_ror:2 row_mask:0xf bank_mask:0xf
    v_add_f32_dpp v81, v81, v81 row_ror:2 row_mask:0xf bank_mask:0xf
    s_nop 0
    v_add_f32_dpp v80, v80, v80 row_ror:1 row_mask:0xf bank_mask:0xf
    v_add_f32_dpp v81, v81, v81 row_ror:1 row_mask:0xf bank_mask:0xf
    s_nop 0
    v_add_f32_dpp v80, v80, v80 row_bcast:15 row_mask:0xa bank_mask:0xf
    v_add_f32_dpp v81, v81, v81 row_bcast:15 row_mask:0xa bank_mask:0xf
    s_nop 0
    v_add_f32_dpp v80, v80, v80 row_bcast:31 row_mask:0xc bank_mask:0xf
    v_add_f32_dpp v81, v81, v81 row_bcast:31 row_mask:0xc bank_mask:0xf
    v_readlane_b32 s65, v80, 63
    v_readlane_b32 s66, v81, 63
    v_mov_b32 v72, 0x3b000000
    v_mul_f32 v73, s65, v72
    v_mul_f32 v74, s66, v72
    v_fma_f32 v74, -v73, v73, v74
    v_max_f32 v74, 0, v74
    v_add_f32 v73, s64, v73
    v_cvt_pk_bf16_f32 v73, 0, v73
    v_cvt_pk_bf16_f32 v74, 0, v74
    v_add_f32 v74, 0x3727c5ac, v74
    v_cvt_pk_bf16_f32 v74, 0, v74
    v_sqrt_f32 v74, v74
    v_sub_f32 v96, v96, v73
    v_sub_f32 v97, v97, v73
    v_sub_f32 v98, v98, v73
    v_sub_f32 v99, v99, v73
    v_sub_f32 v100, v100, v73
    v_sub_f32 v101, v101, v73
    v_sub_f32 v102, v102, v73
    v_sub_f32 v103, v103, v73
    v_cvt_pk_bf16_f32 v74, 0, v74
    v_rcp_f32 v74, v74
    v_cvt_pk_bf16_f32 v96, 0, v96
    v_cvt_pk_bf16_f32 v97, 0, v97
    v_cvt_pk_bf16_f32 v98, 0, v98
    v_cvt_pk_bf16_f32 v99, 0, v99
    v_cvt_pk_bf16_f32 v100, 0, v100
    v_cvt_pk_bf16_f32 v101, 0, v101
    v_cvt_pk_bf16_f32 v102, 0, v102
    v_cvt_pk_bf16_f32 v103, 0, v103
    v_mul_f32 v96, v96, v74
    v_mul_f32 v97, v97, v74
    v_mul_f32 v98, v98, v74
    v_mul_f32 v99, v99, v74
    v_mul_f32 v100, v100, v74
    v_mul_f32 v101, v101, v74
    v_mul_f32 v102, v102, v74
    v_mul_f32 v103, v103, v74
    v_cvt_pk_bf16_f32 v84, v96, v97
    v_cvt_pk_bf16_f32 v85, v98, v99
    v_cvt_pk_bf16_f32 v86, v100, v101
    v_cvt_pk_bf16_f32 v87, v102, v103
    ds_write_b128 v44, v[84:87] offset:32768
    v_mov_b32 v8, v40
    v_mov_b32 v9, v41
    v_mov_b32 v10, v42
    v_mov_b32 v11, v43
    v_lshlrev_b32 v44, 4, v0
    s_sub_u32 s68, s68, 1
    s_cbranch_scc0 L_ln
    s_waitcnt lgkmcnt(0)
    s_mul_i32 s57, s57, 0x9e3779b1
    s_add_u32 s57, s57, 0x7f4a7c15
    s_getreg_b32 s28, hwreg(HW_REG_XCC_ID)
    s_not_b32 s67, s57
    s_xor_b32 s28, s67, s28
    v_bfe_u32 v12, s57, 0, 8
    v_bfe_u32 v13, s57, 8, 8
    v_bfe_u32 v14, s57, 16, 8
    v_bfe_u32 v15, s57, 24, 8
    s_cmp_lt_u32 s56, 4
    s_cbranch_scc1 L_svc3
    s_mov_b32 s14, 4194304
    s_mov_b32 s15, 0x00020000
    s_lshr_b32 s60, s55, 2
    s_and_b32 s61, s54, 3
    v_lshlrev_b32 v29, 13, v2
    s_and_b32 s69, s56, 3
    s_lshl_b32 s67, s61, 20
    s_lshl_b32 s68, s69, 18
    s_add_u32 s67, s67, s68
    s_lshl_b32 s68, s60, 8
    s_add_u32 s67, s67, s68
    s_lshl_b32 s68, s69, 13
    v_lshlrev_b32 v30, 1, v2
    v_xor_b32 v30, v30, v1
    v_lshl_add_u32 v30, v30, 4, v29
    v_xor_b32 v31, 128, v30
    s_barrier
    s_add_u32 s64, s67, 0
    s_add_u32 m0, s68, 98304
    s_nop 0
    buffer_load_dwordx4 v30, s[12:15], s64 offen nt lds
    s_add_u32 s64, s67, 32768
    s_add_u32 m0, s68, 99328
    s_nop 0
    buffer_load_dwordx4 v30, s[12:15], s64 offen nt lds
    s_add_u32 s64, s67, 65536
    s_add_u32 m0, s68, 100352
    s_nop 0
    buffer_load_dwordx4 v31, s[12:15], s64 offen nt lds
    s_add_u32 s64, s67, 98304
    s_add_u32 m0, s68, 101376
    s_nop 0
    buffer_load_dwordx4 v31, s[12:15], s64 offen nt lds
    s_add_u32 s64, s67, 131072
    s_add_u32 m0, s68, 102400
    s_nop 0
    buffer_load_dwordx4 v30, s[12:15], s64 offen nt lds
    s_add_u32 s64, s67, 163840
    s_add_u32 m0, s68, 103424
    s_nop 0
    buffer_load_dwordx4 v30, s[12:15], s64 offen nt lds
    s_add_u32 s64, s67, 196608
    s_add_u32 m0, s68, 104448
    s_nop 0
    buffer_load_dwordx4 v31, s[12:15], s64 offen nt lds
    s_add_u32 s64, s67, 229376
    s_add_u32 m0, s68, 105472
    s_nop 0
    buffer_load_dwordx4 v31, s[12:15], s64 offen nt lds
    v_xor_b32 v30, v1, v2
    v_lshl_add_u32 v30, v30, 4, v29
    v_xor_b32 v31, 0, v30
    s_add_u32 s64, s67, 0
    s_add_u32 m0, s68, 0
    s_nop 0
    buffer_load_dwordx4 v31, s[16:19], s64 offen nt lds
    s_add_u32 s64, s67, 32768
    s_add_u32 m0, s68, 1024
    s_nop 0
    buffer_load_dwordx4 v31, s[16:19], s64 offen nt lds
    v_xor_b32 v31, 64, v30
    s_add_u32 s64, s67, 65536
    s_add_u32 m0, s68, 2048
    s_nop 0
    buffer_load_dwordx4 v31, s[16:19], s64 offen nt lds
    s_add_u32 s64, s67, 98304
    s_add_u32 m0, s68, 3072
    s_nop 0
    buffer_load_dwordx4 v31, s[16:19], s64 offen nt lds
    v_xor_b32 v31, 128, v30
    s_add_u32 s64, s67, 131072
    s_add_u32 m0, s68, 4096
    s_nop 0
    buffer_load_dwordx4 v31, s[16:19], s64 offen nt lds
    s_add_u32 s64, s67, 163840
    s_add_u32 m0, s68, 5120
    s_nop 0
    buffer_load_dwordx4 v31, s[16:19], s64 offen nt lds
    v_xor_b32 v31, 192, v30
    s_add_u32 s64, s67, 196608
    s_add_u32 m0, s68, 6144
    s_nop 0
    buffer_load_dwordx4 v31, s[16:19], s64 offen nt lds
    s_add_u32 s64, s67, 229376
    s_add_u32 m0, s68, 7168
    s_nop 0
    buffer_load_dwordx4 v31, s[16:19], s64 offen nt lds
    s_branch L_svc4
L_svc3:
    v_mov_b32 v68, -1
    v_mov_b32 v69, -1
    v_mov_b32 v70, -1
    v_mov_b32 v71, -1
    s_mul_i32 s66, s55, 768
    s_add_u32 s66, s66, 113664
    s_lshl_b32 s67, s55, 11
    s_add_u32 s67, s67, s73
    s_add_u32 s67, s67, 2128896
    s_cmp_eq_u32 s56, 3
    s_cselect_b32 s67, s66, s67
    v_min_u32 v30, 3824, v16
    buffer_store_dwordx4 v[68:71], v30, s[48:51], s67 offen sc1
    s_cmp_lg_u32 s56, 1
    s_cbranch_scc1 wi_5
    v_mov_b32 v66, s57
    v_mov_b32 v67, s28
    s_lshl_b32 s68, s55, 7
    s_add_u32 s68, s68, 4096
    s_mov_b32 exec_lo, 0xffff
    s_mov_b32 exec_hi, 0x0
    buffer_store_dwordx2 v[66:67], v17, s[48:51], s68 offen sc1
    s_mov_b64 exec, -1
wi_5:
    s_and_b32 s66, s56, 1
    s_lshl_b32 s66, s66, 2
    s_add_u32 s66, s66, s61
    s_lshl_b32 s66, s66, 6
    s_and_b32 s67, s60, 15
    s_add_u32 s66, s66, s67
    s_lshl_b32 s66, s66, 12
    s_add_u32 s66, s66, 2294784
    s_barrier
    s_cmp_eq_u32 s56, 3
    s_cbranch_scc1 L_svc4
    s_mov_b32 s63, 60000
hw_7:
    s_load_dword s67, s[48:49], s66 glc
    s_waitcnt lgkmcnt(0)
    s_cmp_eq_u32 s67, s57
    s_cbranch_scc1 hd_8
    s_sub_u32 s63, s63, 1
    s_cbranch_scc0 hw_7
hd_8:
L_svc4:
    s_waitcnt lgkmcnt(0)
    s_barrier
    buffer_load_dwordx4 v[68:71], v26, s[48:51], s31 offen sc1
    buffer_load_dwordx4 v[76:79], v27, s[48:51], s31 offen sc1
    buffer_load_dwordx4 v[64:67], v26, s[48:51], s30 offen sc1
    buffer_load_dwordx4 v[72:75], v27, s[48:51], s30 offen sc1
    buffer_load_dwordx2 v[90:91], v34, s[48:51], s29 offen sc1
    s_cmp_lt_u32 s56, 4
    s_cbranch_scc1 wi_9
    s_waitcnt vmcnt(13)
wi_9:
    s_barrier
    ds_read_b32 v84, v21 offset:32768
    v_add_u32 v30, 98304, v36
    ds_read_b64_tr_b16 v[96:97], v30 offset:0
    ds_read_b64_tr_b16 v[98:99], v30 offset:1024
    ds_read_b64_tr_b16 v[100:101], v30 offset:8192
    ds_read_b64_tr_b16 v[102:103], v30 offset:9216
    ds_read_b64_tr_b16 v[104:105], v30 offset:16384
    ds_read_b64_tr_b16 v[106:107], v30 offset:17408
    ds_read_b64_tr_b16 v[108:109], v30 offset:24576
    ds_read_b64_tr_b16 v[110:111], v30 offset:25600
    s_lshl_b32 s66, s55, 12
    s_lshl_b32 s67, s56, 9
    s_add_u32 s66, s66, s67
    s_add_u32 s66, s66, s72
    s_add_u32 s66, s66, 2162688
    s_mov_b32 s68, 0xff
    s_waitcnt lgkmcnt(8)
    v_lshlrev_b32 v88, 16, v84
    v_and_b32 v89, 0xffff0000, v84
    s_mov_b32 s63, 60000
    s_waitcnt vmcnt(0)
poll_11:
    v_xor_b32 v64, v64, v12
    v_xor_b32 v65, v65, v13
    v_xor_b32 v66, v66, v14
    v_xor_b32 v67, v67, v15
    v_xor_b32 v68, v68, v12
    v_xor_b32 v69, v69, v13
    v_xor_b32 v70, v70, v14
    v_xor_b32 v71, v71, v15
    v_xor_b32 v72, v72, v12
    v_xor_b32 v73, v73, v13
    v_xor_b32 v74, v74, v14
    v_xor_b32 v75, v75, v15
    v_xor_b32 v76, v76, v12
    v_xor_b32 v77, v77, v13
    v_xor_b32 v78, v78, v14
    v_xor_b32 v79, v79, v15
    v_or3_b32 v80, v64, v65, v66
    v_or3_b32 v81, v67, v68, v69
    v_or3_b32 v80, v80, v70, v71
    v_or3_b32 v81, v81, v72, v73
    v_or3_b32 v80, v80, v74, v75
    v_or3_b32 v81, v81, v76, v77
    v_or3_b32 v80, v80, v78, v79
    v_or_b32 v80, v80, v81
    v_and_b32 v80, 0xff, v80
    v_cmp_ne_u32 vcc, 0, v80
    s_cbranch_vccz pdone_12
    s_sleep 1
    buffer_load_dwordx4 v[68:71], v26, s[48:51], s31 offen sc1
    buffer_load_dwordx4 v[76:79], v27, s[48:51], s31 offen sc1
    buffer_load_dwordx4 v[64:67], v26, s[48:51], s30 offen sc1
    buffer_load_dwordx4 v[72:75], v27, s[48:51], s30 offen sc1
    s_sub_u32 s63, s63, 1
    s_waitcnt vmcnt(0)
    s_cbranch_scc0 poll_11
pdone_12:
    v_add_f32 v68, v68, v76
    v_add_f32 v69, v69, v77
    v_add_f32 v70, v70, v78
    v_add_f32 v71, v71, v79
    v_add_f32 v64, v64, v72
    v_add_f32 v65, v65, v73
    v_add_f32 v66, v66, v74
    v_add_f32 v67, v67, v75
    v_permlane32_swap_b32 v68, v70
    v_permlane32_swap_b32 v69, v71
    v_permlane32_swap_b32 v64, v66
    v_permlane32_swap_b32 v65, v67
    v_add_f32 v68, v68, v70
    v_add_f32 v69, v69, v71
    v_add_f32 v64, v64, v66
    v_add_f32 v65, v65, v67
    v_cvt_pk_bf16_f32 v68, 0, v68
    v_cvt_pk_bf16_f32 v69, 0, v69
    v_cvt_pk_bf16_f32 v64, 0, v64
    v_cvt_pk_bf16_f32 v65, 0, v65
    v_add_f32 v68, 1.0, v68
    v_add_f32 v69, 1.0, v69
    v_cvt_pk_bf16_f32 v68, 0, v68
    v_cvt_pk_bf16_f32 v69, 0, v69
    v_mul_f32 v68, v68, v88
    v_mul_f32 v69, v69, v89
    v_cvt_pk_bf16_f32 v68, 0, v68
    v_cvt_pk_bf16_f32 v69, 0, v69
    v_add_f32 v68, v68, v64
    v_add_f32 v69, v69, v65
    v_cvt_pk_bf16_f32 v68, v68, v69
    ds_write_b32 v20, v68 offset:49152
    s_waitcnt lgkmcnt(0)
    s_barrier
    ds_read_b128 v[64:67], v22 offset:49152
    ds_read_b128 v[68:71], v22 offset:49280
    v_xor_b32 v90, s57, v90
    v_xor_b32 v91, s28, v91
    v_or_b32 v90, v90, v91
    v_cmp_ne_u32 vcc, 0, v90
    s_lshl_b32 s64, s60, 14
    s_add_u32 s64, s64, s67
    s_add_u32 s64, s64, s72
    s_add_u32 s64, s64, 2162688
    s_add_u32 s65, s64, 8192
    s_waitcnt lgkmcnt(1)
    v_mfma_f32_16x16x32_bf16 v[112:115], v[96:99], v[64:67], 0
    v_mfma_f32_16x16x32_bf16 v[116:119], v[100:103], v[64:67], 0
    s_waitcnt lgkmcnt(0)
    v_mfma_f32_16x16x32_bf16 v[112:115], v[104:107], v[68:71], v[112:115]
    v_mfma_f32_16x16x32_bf16 v[116:119], v[108:111], v[68:71], v[116:119]
    s_nop 7
    v_add_f32_dpp v112, v116, v112 row_ror:8 row_mask:0xf bank_mask:0xf
    v_add_f32_dpp v113, v117, v113 row_ror:8 row_mask:0xf bank_mask:0xf
    v_add_f32_dpp v114, v118, v114 row_ror:8 row_mask:0xf bank_mask:0xf
    v_add_f32_dpp v115, v119, v115 row_ror:8 row_mask:0xf bank_mask:0xf
    v_bfi_b32 v112, s68, v12, v112
    v_bfi_b32 v113, s68, v13, v113
    v_bfi_b32 v114, s68, v14, v114
    v_bfi_b32 v115, s68, v15, v115
    s_mov_b32 exec_lo, 0xff00ff
    s_mov_b32 exec_hi, 0xff00ff
    s_cbranch_vccnz far_13
    buffer_store_dwordx4 v[112:115], v23, s[48:51], s66 offen
    s_branch dn_14
far_13:
    buffer_store_dwordx4 v[112:115], v23, s[48:51], s66 offen sc1
dn_14:
    s_mov_b64 exec, -1
    s_cmp_ge_u32 s56, 4
    s_cbranch_scc1 wi_15
    v_lshrrev_b32 v40, 2, v1
    v_lshl_add_u32 v40, v40, 3, v38
    v_lshlrev_b32 v40, 8, v40
    s_lshl_b32 s69, s56, 13
    v_add_u32 v40, s69, v40
    v_xor_b32 v41, v1, v2
    v_lshlrev_b32 v30, 18, v19
    v_lshl_add_u32 v30, v2, 4, v30
    s_lshr_b32 s69, s60, 4
    s_lshl_b32 s69, s69, 14
    s_lshl_b32 s66, s61, 12
    s_add_u32 s69, s69, s66
    s_lshl_b32 s66, s56, 10
    s_add_u32 s69, s69, s66
    s_and_b32 s66, s60, 15
    s_lshl_b32 s66, s66, 6
    s_add_u32 s69, s69, s66
    s_add_u32 s69, s69, 2097152
    v_xor_b32 v42, 0, v41
    v_lshl_add_u32 v42, v42, 4, v40
    ds_read_b128 v[128:131], v42 offset:0
    ds_read_b128 v[144:147], v42 offset:1024
    v_xor_b32 v42, 4, v41
    v_lshl_add_u32 v42, v42, 4, v40
    ds_read_b128 v[132:135], v42 offset:0
    ds_read_b128 v[148:151], v42 offset:1024
    v_xor_b32 v42, 8, v41
    v_lshl_add_u32 v42, v42, 4, v40
    ds_read_b128 v[136:139], v42 offset:0
    ds_read_b128 v[152:155], v42 offset:1024
    v_xor_b32 v42, 12, v41
    v_lshl_add_u32 v42, v42, 4, v40
    ds_read_b128 v[140:143], v42 offset:0
    ds_read_b128 v[156:159], v42 offset:1024
    s_branch wd_16
wi_15:
    v_lshlrev_b32 v40, 4, v0
    ds_read_b128 v[128:131], v40 offset:45056
    ds_read_b128 v[132:135], v40 offset:46080
    s_and_b32 s69, s56, 3
    s_lshl_b32 s66, s69, 5
    v_xor_b32 v41, s66, v5
    v_add_u32 v41, 139264, v41
    s_lshl_b32 s69, s69, 9
    s_lshl_b32 s66, s55, 12
    s_add_u32 s69, s69, s66
    s_add_u32 s69, s69, s72
    s_add_u32 s69, s69, 2228224
wd_16:
    s_mov_b32 s63, 60000
    buffer_load_dwordx4 v[64:67], v39, s[48:51], s64 offen sc1
    buffer_load_dwordx4 v[68:71], v39, s[48:51], s65 offen sc1
    s_waitcnt vmcnt(0)
poll_17:
    v_xor_b32 v64, v64, v12
    v_xor_b32 v65, v65, v13
    v_xor_b32 v66, v66, v14
    v_xor_b32 v67, v67, v15
    v_xor_b32 v68, v68, v12
    v_xor_b32 v69, v69, v13
    v_xor_b32 v70, v70, v14
    v_xor_b32 v71, v71, v15
    v_or3_b32 v72, v64, v65, v66
    v_or3_b32 v73, v67, v68, v69
    v_or3_b32 v72, v72, v70, v71
    v_or_b32 v72, v72, v73
    v_and_b32 v72, 0xff, v72
    v_cmp_ne_u32 vcc, 0, v72
    s_cbranch_vccz pdone_18
    buffer_load_dwordx4 v[64:67], v39, s[48:51], s64 offen sc1
    buffer_load_dwordx4 v[68:71], v39, s[48:51], s65 offen sc1
    s_sub_u32 s63, s63, 1
    s_waitcnt vmcnt(0)
    s_cbranch_scc0 poll_17
pdone_18:
    v_add_f32 v64, v64, v68
    v_add_f32 v65, v65, v69
    v_add_f32 v66, v66, v70
    v_add_f32 v67, v67, v71
    s_nop 0
    v_permlane32_swap_b32 v64, v66
    v_permlane32_swap_b32 v65, v67
    v_add_f32 v64, v64, v66
    v_add_f32 v65, v65, v67
    v_cvt_pk_bf16_f32 v64, v64, v65
    ds_write_b32 v20, v64 offset:53248
    s_waitcnt lgkmcnt(0)
    s_barrier
    s_cmp_ge_u32 s56, 4
    s_cbranch_scc1 wi_19
    ds_read_b128 v[64:67], v22 offset:53248
    ds_read_b128 v[68:71], v22 offset:53376
    s_waitcnt lgkmcnt(0)
    v_mfma_f32_16x16x32_bf16 v[96:99], v[128:131], v[64:67], 0
    v_mfma_f32_16x16x32_bf16 v[100:103], v[132:135], v[64:67], 0
    v_mfma_f32_16x16x32_bf16 v[104:107], v[144:147], v[64:67], 0
    v_mfma_f32_16x16x32_bf16 v[108:111], v[148:151], v[64:67], 0
    v_mfma_f32_16x16x32_bf16 v[96:99], v[136:139], v[68:71], v[96:99]
    v_mfma_f32_16x16x32_bf16 v[100:103], v[140:143], v[68:71], v[100:103]
    v_mfma_f32_16x16x32_bf16 v[104:107], v[152:155], v[68:71], v[104:107]
    v_mfma_f32_16x16x32_bf16 v[108:111], v[156:159], v[68:71], v[108:111]
    s_nop 5
    v_add_f32_dpp v96, v100, v96 row_ror:8 row_mask:0xf bank_mask:0xf
    v_add_f32_dpp v97, v101, v97 row_ror:8 row_mask:0xf bank_mask:0xf
    v_add_f32_dpp v98, v102, v98 row_ror:8 row_mask:0xf bank_mask:0xf
    v_add_f32_dpp v99, v103, v99 row_ror:8 row_mask:0xf bank_mask:0xf
    v_add_f32_dpp v104, v108, v104 row_ror:8 row_mask:0xf bank_mask:0xf
    v_add_f32_dpp v105, v109, v105 row_ror:8 row_mask:0xf bank_mask:0xf
    v_add_f32_dpp v106, v110, v106 row_ror:8 row_mask:0xf bank_mask:0xf
    v_add_f32_dpp v107, v111, v107 row_ror:8 row_mask:0xf bank_mask:0xf
    v_cvt_pk_bf16_f32 v72, v96, v97
    v_cvt_pk_bf16_f32 v73, v98, v99
    v_cvt_pk_bf16_f32 v74, v104, v105
    v_cvt_pk_bf16_f32 v75, v106, v107
    s_mov_b32 exec_lo, 0xff00ff
    s_mov_b32 exec_hi, 0xff00ff
    buffer_store_dwordx4 v[72:75], v30, s[48:51], s69 offen sc1
    s_mov_b64 exec, -1
    s_barrier
    s_cmp_lg_u32 s56, 3
    s_cbranch_scc1 noflg_21
    v_mov_b32 v76, s57
    v_not_b32 v77, v76
    s_lshl_b32 s67, s54, 7
    s_lshl_b32 s66, s52, 3
    s_add_u32 s67, s67, s66
    v_lshlrev_b32 v78, 11, v0
    s_mov_b32 exec_lo, 0xff
    s_mov_b32 exec_hi, 0x0
    s_add_u32 s67, s67, 98304
    buffer_store_dwordx2 v[76:77], v78, s[48:51], s67 offen sc1
    s_mov_b64 exec, -1
noflg_21:
    s_branch wd_20
wi_19:
    s_barrier
    s_add_u32 s64, s33, 0
    s_add_u32 m0, s34, 0
    s_nop 0
    buffer_load_dwordx4 v32, s[40:43], s64 offen nt lds
    s_add_u32 s64, s33, 49152
    s_add_u32 m0, s34, 1024
    s_nop 0
    buffer_load_dwordx4 v33, s[40:43], s64 offen nt lds
    s_add_u32 s64, s33, 98304
    s_add_u32 m0, s34, 2048
    s_nop 0
    buffer_load_dwordx4 v32, s[40:43], s64 offen nt lds
    s_add_u32 s64, s33, 147456
    s_add_u32 m0, s34, 3072
    s_nop 0
    buffer_load_dwordx4 v33, s[40:43], s64 offen nt lds
    s_mov_b32 s35, s69
wd_20:
    v_and_b32 v30, 1, v0
    v_lshlrev_b32 v30, 7, v30
    s_lshl_b32 s69, s52, 11
    s_lshl_b32 s66, s56, 8
    s_add_u32 s69, s69, s66
    s_add_u32 s69, s69, 4096
    v_bfe_u32 v37, v1, 2, 1
    v_lshlrev_b32 v37, 12, v37
    v_lshl_add_u32 v37, v38, 5, v37
    v_lshl_add_u32 v37, v2, 3, v37
    s_lshl_b32 s32, s60, 13
    s_lshl_b32 s66, s61, 10
    s_add_u32 s32, s32, s66
    s_lshl_b32 s66, s56, 7
    s_add_u32 s32, s32, s66
    s_add_u32 s32, s32, s73
    s_add_u32 s32, s32, 2129920
    s_lshl_b32 s64, s60, 14
    s_lshl_b32 s65, s61, 9
    s_add_u32 s64, s64, s65
    s_add_u32 s64, s64, s72
    s_add_u32 s64, s64, 2228224
    s_add_u32 s65, s64, 8192
    s_mul_i32 s66, s56, 56
    s_lshl_b32 s67, s52, 22
    s_add_u32 s33, s66, 1152
    v_add_u32 v119, s33, v0
    v_lshrrev_b32 v115, 8, v119
    v_mul_u32_u24 v115, 1, v115
    v_add_u32 v115, s54, v115
    v_and_b32 v115, 15, v115
    v_lshlrev_b32 v115, 18, v115
    v_bfe_u32 v114, v119, 3, 2
    v_lshl_add_u32 v115, v114, 13, v115
    v_bfe_u32 v114, v119, 5, 3
    v_lshl_add_u32 v115, v114, 10, v115
    v_and_b32 v119, 0x707, v119
    v_lshl_add_u32 v118, v119, 7, v115
    s_add_u32 s33, s66, 1600
    v_add_u32 v119, s33, v0
    v_lshrrev_b32 v115, 8, v119
    v_mul_u32_u24 v115, 1, v115
    v_add_u32 v115, s54, v115
    v_and_b32 v115, 15, v115
    v_lshlrev_b32 v115, 18, v115
    v_bfe_u32 v114, v119, 3, 2
    v_lshl_add_u32 v115, v114, 13, v115
    v_bfe_u32 v114, v119, 5, 3
    v_lshl_add_u32 v115, v114, 10, v115
    v_and_b32 v119, 0x707, v119
    v_lshl_add_u32 v117, v119, 7, v115
    buffer_load_dwordx2 v[90:91], v30, s[48:51], s69 offen sc1
    buffer_load_dwordx2 v[92:93], v37, s[48:51], s32 offen sc1
    s_cmp_ge_u32 s56, 4
    s_cbranch_scc1 wi_22
    s_mov_b32 exec_lo, 0xffffffff
    s_mov_b32 exec_hi, 0xffffff
    buffer_load_dword v118, v118, s[8:11], s67 offen
    s_mov_b64 exec, -1
    s_barrier
    s_branch wd_23
wi_22:
    s_waitcnt vmcnt(2)
    s_barrier
    s_mov_b32 s69, s35
    ds_read_b64_tr_b16 v[64:65], v41 offset:0
    ds_read_b64_tr_b16 v[66:67], v41 offset:512
    ds_read_b64_tr_b16 v[68:69], v41 offset:4096
    ds_read_b64_tr_b16 v[70:71], v41 offset:4608
    ds_read_b64_tr_b16 v[72:73], v41 offset:8192
    ds_read_b64_tr_b16 v[74:75], v41 offset:8704
    ds_read_b64_tr_b16 v[76:77], v41 offset:12288
    ds_read_b64_tr_b16 v[78:79], v41 offset:12800
    s_waitcnt lgkmcnt(6)
    v_mfma_f32_16x16x32_bf16 v[96:99], v[64:67], v[128:131], 0
    s_waitcnt lgkmcnt(4)
    v_mfma_f32_16x16x32_bf16 v[100:103], v[68:71], v[128:131], 0
    s_waitcnt lgkmcnt(2)
    v_mfma_f32_16x16x32_bf16 v[96:99], v[72:75], v[132:135], v[96:99]
    s_waitcnt lgkmcnt(0)
    v_mfma_f32_16x16x32_bf16 v[100:103], v[76:79], v[132:135], v[100:103]
    s_nop 7
    v_add_f32_dpp v96, v100, v96 row_ror:8 row_mask:0xf bank_mask:0xf
    v_add_f32_dpp v97, v101, v97 row_ror:8 row_mask:0xf bank_mask:0xf
    v_add_f32_dpp v98, v102, v98 row_ror:8 row_mask:0xf bank_mask:0xf
    v_add_f32_dpp v99, v103, v99 row_ror:8 row_mask:0xf bank_mask:0xf
    v_bfi_b32 v96, s68, v12, v96
    v_bfi_b32 v97, s68, v13, v97
    v_bfi_b32 v98, s68, v14, v98
    v_bfi_b32 v99, s68, v15, v99
    s_mov_b32 exec_lo, 0xff00ff
    s_mov_b32 exec_hi, 0xff00ff
    buffer_store_dwordx4 v[96:99], v23, s[48:51], s69 offen sc1
    s_mov_b64 exec, -1
    s_mov_b32 exec_lo, 0xffffffff
    s_mov_b32 exec_hi, 0xffffff
    buffer_load_dword v118, v118, s[8:11], s67 offen
    s_mov_b64 exec, -1
wd_23:
    s_barrier
    s_mov_b32 exec_lo, 0xffffffff
    s_mov_b32 exec_hi, 0xffffff
    buffer_load_dword v117, v117, s[8:11], s67 offen
    s_mov_b64 exec, -1
    v_mov_b32 v45, v39
    s_mov_b32 s58, s64
    s_mov_b32 s59, s65
    s_cmp_lg_u32 s56, 5
    s_cbranch_scc1 wi_24
    buffer_load_dwordx4 v[64:67], v39, s[48:51], s64 offen sc1
    buffer_load_dwordx4 v[68:71], v39, s[48:51], s65 offen sc1
wi_24:
    s_barrier
    s_cmp_lg_u32 s56, 5
    s_cbranch_scc1 wi_26
    s_waitcnt vmcnt(5)
    s_branch wd_27
wi_26:
    s_waitcnt vmcnt(3)
wd_27:
    v_xor_b32 v90, s57, v90
    v_xor_b32 v91, s28, v91
    v_or_b32 v90, v90, v91
    v_and_b32 v91, 1, v0
    s_lshl_b32 s66, s56, 3
    s_add_u32 s66, s66, 160000
    v_lshl_add_u32 v91, v91, 2, s66
    ds_write_b32 v91, v90
    s_cmp_ge_u32 s56, 4
    s_cbranch_scc1 wi_28
    v_lshrrev_b32 v114, 3, v3
    v_lshlrev_b32 v114, 13, v114
    v_lshl_add_u32 v114, v19, 7, v114
    s_lshl_b32 s67, s54, 18
    s_lshl_b32 s68, s52, 10
    s_add_u32 s67, s67, s68
    buffer_load_dword v114, v114, s[20:23], s67 offen
    s_barrier
    s_branch wd_29
wi_28:
    s_barrier
wd_29:
    s_lshl_b32 s62, s54, 2
    s_add_u32 s62, s62, s56
    s_and_b32 s62, s62, 7
    v_lshrrev_b32 v17, 3, v0
    v_lshlrev_b32 v17, 10, v17
    v_add_u32 v17, v17, v95
    v_xor_b32 v18, 64, v17
    s_lshl_b32 s74, s52, 19
    s_lshl_b32 s66, s62, 16
    s_add_u32 s74, s74, s66
    s_lshr_b32 s66, s54, 1
    s_xor_b32 s66, s66, 4
    s_lshl_b32 s66, s66, 7
    s_add_u32 s74, s74, s66
    s_lshl_b32 s75, s56, 13
    s_add_u32 s75, s75, 32768
    v_add_u32 v5, s75, v5
    v_and_b32 v38, 3, v1
    v_lshlrev_b32 v32, 10, v2
    v_lshl_add_u32 v32, v1, 4, v32
    s_lshl_b32 s64, s55, 15
    s_lshl_b32 s65, s56, 12
    s_add_u32 s64, s64, s65
    s_add_u32 s64, s64, 4194304
    s_lshl_b32 s66, s56, 8
    s_add_u32 s66, s66, 155648
    v_and_b32 v33, 1, v1
    v_lshlrev_b32 v33, 5, v33
    v_lshl_add_u32 v33, v2, 3, v33
    v_add_u32 v33, s66, v33
    v_lshlrev_b32 v44, 5, v2
    v_lshl_add_u32 v44, v1, 1, v44
    v_add_u32 v44, s66, v44
    s_mul_i32 s66, s56, 272
    s_add_u32 s66, s66, 157696
    v_lshlrev_b32 v34, 4, v1
    v_add_u32 v34, s66, v34
    v_mul_u32_u24 v35, 272, v19
    v_lshl_add_u32 v35, v2, 4, v35
    v_add_u32 v35, 157696, v35
    v_lshlrev_b32 v49, 3, v38
    v_lshrrev_b32 v49, v49, s57
    v_bfe_u32 v8, v49, 0, 1
    v_bfe_u32 v48, v49, 1, 1
    v_lshl_or_b32 v8, v48, 16, v8
    v_bfe_u32 v9, v49, 2, 1
    v_bfe_u32 v48, v49, 3, 1
    v_lshl_or_b32 v9, v48, 16, v9
    v_bfe_u32 v10, v49, 4, 1
    v_bfe_u32 v48, v49, 5, 1
    v_lshl_or_b32 v10, v48, 16, v10
    v_bfe_u32 v11, v49, 6, 1
    v_bfe_u32 v48, v49, 7, 1
    v_lshl_or_b32 v11, v48, 16, v11
    v_lshlrev_b32 v39, 8, v1
    s_lshl_b32 s66, s56, 12
    s_lshl_b32 s67, s60, 3
    s_add_u32 s66, s66, s67
    s_add_u32 s66, s66, 65536
    s_mov_b32 s31, s66
    v_lshrrev_b32 v56, 2, v1
    v_lshlrev_b32 v57, 6, v56
    v_lshlrev_b32 v56, 10, v56
    v_lshl_add_u32 v56, v38, 5, v56
    v_lshrrev_b32 v58, 1, v2
    v_lshl_add_u32 v56, v58, 7, v56
    v_and_b32 v58, 1, v2
    v_lshl_add_u32 v56, v58, 4, v56
    s_and_b32 s69, s54, 1
    s_lshl_b32 s33, s52, 15
    s_lshr_b32 s68, s62, 1
    s_lshl_b32 s68, s68, 13
    s_add_u32 s33, s33, s68
    s_lshl_b32 s68, s69, 12
    s_add_u32 s33, s33, s68
    s_and_b32 s68, s62, 1
    s_lshl_b32 s68, s68, 9
    s_add_u32 s33, s33, s68
    s_add_u32 s33, s33, s73
    s_add_u32 s33, s33, 2129920
    v_mul_u32_u24 v58, 272, v38
    v_add_u32 v57, v57, v58
    v_lshl_add_u32 v57, v2, 4, v57
    s_mul_i32 s68, s56, 1088
    s_add_u32 s68, s68, 98304
    v_add_u32 v57, s68, v57
    v_lshlrev_b32 v58, 3, v3
    v_lshrrev_b32 v59, 5, v3
    v_lshl_add_u32 v58, v59, 4, v58
    v_add_u32 v58, 98304, v58
    v_lshrrev_b32 v59, 5, v3
    v_lshlrev_b32 v59, 13, v59
    v_and_b32 v60, 31, v3
    v_lshl_add_u32 v59, v60, 2, v59
    s_lshl_b32 s34, s69, 15
    s_lshl_b32 s68, s52, 10
    s_add_u32 s34, s34, s68
    s_lshr_b32 s68, s54, 1
    s_xor_b32 s68, s68, 4
    s_lshl_b32 s68, s68, 7
    s_add_u32 s34, s34, s68
    s_add_u32 s34, s34, 116736
    v_lshlrev_b32 v110, 2, v1
    v_add_u32 v110, 160000, v110
    s_lshl_b32 s30, s60, 10
    s_lshl_b32 s65, s56, 7
    s_add_u32 s30, s30, s65
    s_add_u32 s30, s30, 1572864
    v_and_b32 v28, 1, v2
    v_lshlrev_b32 v28, 18, v28
    v_lshrrev_b32 v29, 1, v2
    v_lshl_add_u32 v28, v29, 17, v28
    v_lshlrev_b32 v29, 1, v2
    v_xor_b32 v29, v29, v1
    v_lshl_add_u32 v28, v29, 4, v28
    v_xor_b32 v29, 128, v28
    s_lshl_b32 s65, s61, 20
    s_mul_i32 s66, s56, 16384
    s_add_u32 s65, s65, s66
    s_lshl_b32 s66, s60, 8
    s_add_u32 s65, s65, s66
    s_mul_i32 s66, s56, 4096
    s_add_u32 s67, s65, 0
    s_add_u32 s68, s66, 0
    s_mov_b32 m0, s68
    s_nop 0
    buffer_load_dwordx4 v28, s[20:23], s67 offen nt lds
    s_add_u32 s67, s65, 524288
    s_add_u32 s68, s66, 1024
    s_mov_b32 m0, s68
    s_nop 0
    buffer_load_dwordx4 v28, s[20:23], s67 offen nt lds
    s_add_u32 s67, s65, 8192
    s_add_u32 s68, s66, 2048
    s_mov_b32 m0, s68
    s_nop 0
    buffer_load_dwordx4 v29, s[20:23], s67 offen nt lds
    s_add_u32 s67, s65, 532480
    s_add_u32 s68, s66, 3072
    s_mov_b32 m0, s68
    s_nop 0
    buffer_load_dwordx4 v29, s[20:23], s67 offen nt lds
    s_cmp_lg_u32 s56, 5
    s_cbranch_scc1 wi_30
    s_mov_b32 s63, 60000
    s_waitcnt vmcnt(4)
poll_32:
    v_xor_b32 v64, v64, v12
    v_xor_b32 v65, v65, v13
    v_xor_b32 v66, v66, v14
    v_xor_b32 v67, v67, v15
    v_xor_b32 v68, v68, v12
    v_xor_b32 v69, v69, v13
    v_xor_b32 v70, v70, v14
    v_xor_b32 v71, v71, v15
    v_or3_b32 v72, v64, v65, v66
    v_or3_b32 v73, v67, v68, v69
    v_or3_b32 v72, v72, v70, v71
    v_or_b32 v72, v72, v73
    v_and_b32 v72, 0xff, v72
    v_cmp_ne_u32 vcc, 0, v72
    s_cbranch_vccz pdone_33
    s_sleep 2
    buffer_load_dwordx4 v[64:67], v45, s[48:51], s58 offen sc1
    buffer_load_dwordx4 v[68:71], v45, s[48:51], s59 offen sc1
    s_sub_u32 s63, s63, 1
    s_waitcnt vmcnt(0)
    s_cbranch_scc0 poll_32
pdone_33:
    v_add_f32 v64, v64, v68
    v_add_f32 v65, v65, v69
    v_add_f32 v66, v66, v70
    v_add_f32 v67, v67, v71
    s_nop 0
    v_permlane32_swap_b32 v64, v66
    v_permlane32_swap_b32 v65, v67
    v_add_f32 v64, v64, v66
    v_add_f32 v65, v65, v67
    s_lshr_b32 s66, s55, 5
    s_lshl_b32 s65, s66, 13
    s_and_b32 s67, s55, 31
    s_lshl_b32 s67, s67, 5
    s_add_u32 s65, s65, s67
    s_add_u32 s65, s65, 32768
    s_cmp_eq_u32 s66, 2
    s_cselect_b32 s66, 1.0, 0
    v_cvt_pk_bf16_f32 v64, 0, v64
    v_cvt_pk_bf16_f32 v65, 0, v65
    v_add_f32 v64, s66, v64
    v_add_f32 v65, s66, v65
    v_cvt_pk_bf16_f32 v64, v64, v65
    buffer_store_dword v64, v24, s[48:51], s65 offen sc1
wi_30:
    s_load_dword s65, s[48:49], s30 glc
    s_waitcnt lgkmcnt(0)
    s_mov_b32 s78, 1
    s_cmp_eq_u32 s65, s57
    s_cbranch_scc1 gotst_34
    s_mov_b32 s78, 0
    s_add_u32 s65, s74, 0
    s_add_u32 m0, s75, 0
    s_nop 0
    buffer_load_dwordx4 v17, s[24:27], s65 offen  lds
    s_add_u32 s65, s74, 8192
    s_add_u32 m0, s75, 1024
    s_nop 0
    buffer_load_dwordx4 v18, s[24:27], s65 offen  lds
    s_add_u32 s65, s74, 16384
    s_add_u32 m0, s75, 2048
    s_nop 0
    buffer_load_dwordx4 v17, s[24:27], s65 offen  lds
    s_add_u32 s65, s74, 24576
    s_add_u32 m0, s75, 3072
    s_nop 0
    buffer_load_dwordx4 v18, s[24:27], s65 offen  lds
    s_add_u32 s65, s74, 32768
    s_add_u32 m0, s75, 4096
    s_nop 0
    buffer_load_dwordx4 v17, s[24:27], s65 offen  lds
    s_add_u32 s65, s74, 40960
    s_add_u32 m0, s75, 5120
    s_nop 0
    buffer_load_dwordx4 v18, s[24:27], s65 offen  lds
    s_add_u32 s65, s74, 49152
    s_add_u32 m0, s75, 6144
    s_nop 0
    buffer_load_dwordx4 v17, s[24:27], s65 offen  lds
    s_add_u32 s65, s74, 57344
    s_add_u32 m0, s75, 7168
    s_nop 0
    buffer_load_dwordx4 v18, s[24:27], s65 offen  lds
    s_waitcnt vmcnt(8)
    s_barrier
    ds_read_b32 v110, v110
    ds_read_b64_tr_b16 v[112:113], v36 offset:0
    ds_read_b64_tr_b16 v[114:115], v36 offset:1024
    ds_read_b64_tr_b16 v[116:117], v36 offset:8192
    ds_read_b64_tr_b16 v[118:119], v36 offset:9216
    ds_read_b64_tr_b16 v[120:121], v36 offset:16384
    ds_read_b64_tr_b16 v[122:123], v36 offset:17408
    ds_read_b64_tr_b16 v[124:125], v36 offset:24576
    ds_read_b64_tr_b16 v[126:127], v36 offset:25600
    s_mov_b32 s63, 60000
hw_35:
    s_load_dword s65, s[48:49], s30 glc
    s_waitcnt lgkmcnt(0)
    s_cmp_eq_u32 s65, s57
    s_cbranch_scc1 hd_36
    s_sub_u32 s63, s63, 1
    s_cbranch_scc0 hw_35
hd_36:
gotst_34:
    buffer_load_dwordx2 v[40:41], v39, s[48:51], s31 offen sc1
    buffer_load_dwordx4 v[64:67], v32, s[48:51], s64 offen offset:0 sc1
    buffer_load_dwordx4 v[68:71], v32, s[48:51], s64 offen offset:256 sc1
    buffer_load_dwordx4 v[72:75], v32, s[48:51], s64 offen offset:512 sc1
    buffer_load_dwordx4 v[76:79], v32, s[48:51], s64 offen offset:768 sc1
    s_waitcnt vmcnt(4)
    v_max_u32 v47, v40, v41
    v_cmp_eq_u32 vcc, -1, v47
    s_cbranch_vccz okst_37
    s_mov_b32 s63, 60000
poll_38:
    buffer_load_dwordx2 v[40:41], v39, s[48:51], s31 offen sc1
    s_waitcnt vmcnt(0)
    v_max_u32 v47, v40, v41
    v_cmp_eq_u32 vcc, -1, v47
    s_cbranch_vccz pdone_39
    s_sub_u32 s63, s63, 1
    s_cbranch_scc0 poll_38
pdone_39:
okst_37:
    s_cmp_eq_u32 s78, 0
    s_cbranch_scc1 nr_40
    s_add_u32 s65, s74, 0
    s_add_u32 m0, s75, 0
    s_nop 0
    buffer_load_dwordx4 v17, s[24:27], s65 offen  lds
    s_add_u32 s65, s74, 8192
    s_add_u32 m0, s75, 1024
    s_nop 0
    buffer_load_dwordx4 v18, s[24:27], s65 offen  lds
    s_add_u32 s65, s74, 16384
    s_add_u32 m0, s75, 2048
    s_nop 0
    buffer_load_dwordx4 v17, s[24:27], s65 offen  lds
    s_add_u32 s65, s74, 24576
    s_add_u32 m0, s75, 3072
    s_nop 0
    buffer_load_dwordx4 v18, s[24:27], s65 offen  lds
    s_add_u32 s65, s74, 32768
    s_add_u32 m0, s75, 4096
    s_nop 0
    buffer_load_dwordx4 v17, s[24:27], s65 offen  lds
    s_add_u32 s65, s74, 40960
    s_add_u32 m0, s75, 5120
    s_nop 0
    buffer_load_dwordx4 v18, s[24:27], s65 offen  lds
    s_add_u32 s65, s74, 49152
    s_add_u32 m0, s75, 6144
    s_nop 0
    buffer_load_dwordx4 v17, s[24:27], s65 offen  lds
    s_add_u32 s65, s74, 57344
    s_add_u32 m0, s75, 7168
    s_nop 0
    buffer_load_dwordx4 v18, s[24:27], s65 offen  lds
    s_barrier
    ds_read_b32 v110, v110
    ds_read_b64_tr_b16 v[112:113], v36 offset:0
    ds_read_b64_tr_b16 v[114:115], v36 offset:1024
    ds_read_b64_tr_b16 v[116:117], v36 offset:8192
    ds_read_b64_tr_b16 v[118:119], v36 offset:9216
    ds_read_b64_tr_b16 v[120:121], v36 offset:16384
    ds_read_b64_tr_b16 v[122:123], v36 offset:17408
    ds_read_b64_tr_b16 v[124:125], v36 offset:24576
    ds_read_b64_tr_b16 v[126:127], v36 offset:25600
nr_40:
    v_mov_b32 v42, v40
    v_and_b32 v50, 1, v2
    v_cmp_eq_u32 s[70:71], 1, v50
    v_max_f32_dpp v42, v42, v42 row_ror:8 row_mask:0xf bank_mask:0xf
    s_nop 1
    v_max_f32_dpp v42, v42, v42 row_ror:4 row_mask:0xf bank_mask:0xf
    s_nop 1
    v_max_f32_dpp v42, v42, v42 row_ror:2 row_mask:0xf bank_mask:0xf
    s_nop 1
    v_max_f32_dpp v42, v42, v42 row_ror:1 row_mask:0xf bank_mask:0xf
    s_mov_b32 s63, 60000
    s_waitcnt vmcnt(8)
    s_cmp_lg_u32 s78, 0
    s_cbranch_scc1 chk_43
    s_waitcnt vmcnt(0)
chk_43:
    v_sub_f32 v40, v40, v42
    v_xor_b32 v80, v64, v8
    v_xor_b32 v81, v65, v9
    v_exp_f32 v40, v40
    v_xor_b32 v82, v66, v10
    v_xor_b32 v83, v67, v11
    v_mul_f32 v41, v41, v40
    v_xor_b32 v84, v68, v8
    v_xor_b32 v85, v69, v9
    v_add_f32_dpp v41, v41, v41 row_ror:8 row_mask:0xf bank_mask:0xf
    v_xor_b32 v86, v70, v10
    v_xor_b32 v87, v71, v11
    v_add_f32_dpp v41, v41, v41 row_ror:4 row_mask:0xf bank_mask:0xf
    v_xor_b32 v88, v72, v8
    v_xor_b32 v89, v73, v9
    v_add_f32_dpp v41, v41, v41 row_ror:2 row_mask:0xf bank_mask:0xf
    v_xor_b32 v90, v74, v10
    v_xor_b32 v91, v75, v11
    v_add_f32_dpp v41, v41, v41 row_ror:1 row_mask:0xf bank_mask:0xf
    v_xor_b32 v92, v76, v8
    v_xor_b32 v93, v77, v9
    v_rcp_f32 v41, v41
    v_xor_b32 v94, v78, v10
    v_xor_b32 v95, v79, v11
    v_mul_f32 v40, v40, v41
    v_or3_b32 v47, v80, v81, v82
    v_or3_b32 v48, v83, v84, v85
    v_cvt_pk_bf16_f32 v42, v40, v40
    v_or3_b32 v47, v47, v86, v87
    v_or3_b32 v48, v48, v88, v89
    v_and_b32 v43, 0xffff0000, v42
    v_or3_b32 v47, v47, v90, v91
    v_or3_b32 v48, v48, v92, v93
    v_sub_f32 v40, v40, v43
    v_or3_b32 v47, v47, v94, v95
    v_or_b32 v47, v47, v48
    v_cvt_pk_bf16_f32 v43, v40, v40
    v_and_b32 v47, 0x00010001, v47
    v_cmp_ne_u32 vcc, 0, v47
    v_cndmask_b32 v42, v42, v43, s[70:71]
    ds_write_b16 v44, v42
    ds_read_b64 v[52:53], v33
    s_cbranch_vccz pdone_42
poll_41:
    buffer_load_dwordx4 v[64:67], v32, s[48:51], s64 offen offset:0 sc1
    buffer_load_dwordx4 v[68:71], v32, s[48:51], s64 offen offset:256 sc1
    buffer_load_dwordx4 v[72:75], v32, s[48:51], s64 offen offset:512 sc1
    buffer_load_dwordx4 v[76:79], v32, s[48:51], s64 offen offset:768 sc1
    s_waitcnt vmcnt(0)
    v_xor_b32 v80, v64, v8
    v_xor_b32 v81, v65, v9
    v_xor_b32 v82, v66, v10
    v_xor_b32 v83, v67, v11
    v_xor_b32 v84, v68, v8
    v_xor_b32 v85, v69, v9
    v_xor_b32 v86, v70, v10
    v_xor_b32 v87, v71, v11
    v_xor_b32 v88, v72, v8
    v_xor_b32 v89, v73, v9
    v_xor_b32 v90, v74, v10
    v_xor_b32 v91, v75, v11
    v_xor_b32 v92, v76, v8
    v_xor_b32 v93, v77, v9
    v_xor_b32 v94, v78, v10
    v_xor_b32 v95, v79, v11
    v_or3_b32 v47, v80, v81, v82
    v_or3_b32 v48, v83, v84, v85
    v_or3_b32 v47, v47, v86, v87
    v_or3_b32 v48, v48, v88, v89
    v_or3_b32 v47, v47, v90, v91
    v_or3_b32 v48, v48, v92, v93
    v_or3_b32 v47, v47, v94, v95
    v_or_b32 v47, v47, v48
    v_and_b32 v47, 0x00010001, v47
    v_cmp_ne_u32 vcc, 0, v47
    s_cbranch_vccz pdone_42
    s_sub_u32 s63, s63, 1
    s_cbranch_scc0 poll_41
pdone_42:
    v_perm_b32 v64, v84, v80, s76
    v_perm_b32 v65, v92, v88, s76
    v_perm_b32 v66, v84, v80, s77
    v_perm_b32 v67, v92, v88, s77
    v_or_b32 v66, 0x00010001, v66
    v_or_b32 v67, 0x00010001, v67
    v_perm_b32 v68, v85, v81, s76
    v_perm_b32 v69, v93, v89, s76
    v_perm_b32 v70, v85, v81, s77
    v_perm_b32 v71, v93, v89, s77
    v_or_b32 v70, 0x00010001, v70
    v_or_b32 v71, 0x00010001, v71
    s_waitcnt lgkmcnt(0)
    v_mfma_f32_16x16x16_bf16 v[128:131], v[52:53], v[64:65], 0
    v_perm_b32 v72, v86, v82, s76
    v_perm_b32 v73, v94, v90, s76
    v_mfma_f32_16x16x16_bf16 v[132:135], v[52:53], v[66:67], 0
    v_perm_b32 v74, v86, v82, s77
    v_perm_b32 v75, v94, v90, s77
    v_or_b32 v74, 0x00010001, v74
    v_or_b32 v75, 0x00010001, v75
    v_mfma_f32_16x16x16_bf16 v[136:139], v[52:53], v[68:69], 0
    v_perm_b32 v76, v87, v83, s76
    v_perm_b32 v77, v95, v91, s76
    v_mfma_f32_16x16x16_bf16 v[140:143], v[52:53], v[70:71], 0
    v_perm_b32 v78, v87, v83, s77
    v_perm_b32 v79, v95, v91, s77
    v_or_b32 v78, 0x00010001, v78
    v_or_b32 v79, 0x00010001, v79
    v_mfma_f32_16x16x16_bf16 v[144:147], v[52:53], v[72:73], 0
    v_mfma_f32_16x16x16_bf16 v[148:151], v[52:53], v[74:75], 0
    v_mfma_f32_16x16x16_bf16 v[152:155], v[52:53], v[76:77], 0
    v_mfma_f32_16x16x16_bf16 v[156:159], v[52:53], v[78:79], 0
    v_add_f32 v128, v128, v129
    v_add_f32 v132, v132, v133
    v_add_f32 v136, v136, v137
    v_add_f32 v140, v140, v141
    s_nop 0
    v_add_f32 v144, v144, v145
    v_add_f32 v148, v148, v149
    v_add_f32 v152, v152, v153
    v_add_f32 v156, v156, v157
    v_cvt_pk_bf16_f32 v80, v128, v132
    v_cvt_pk_bf16_f32 v81, v136, v140
    v_cvt_pk_bf16_f32 v82, v144, v148
    v_cvt_pk_bf16_f32 v83, v152, v156
    s_mov_b32 exec_lo, 0xffff
    s_mov_b32 exec_hi, 0x0
    ds_write_b128 v34, v[80:83]
    s_mov_b64 exec, -1
    s_waitcnt lgkmcnt(0)
    s_barrier
    ds_read_b128 v[64:67], v35 offset:0
    ds_read_b128 v[68:71], v35 offset:64
    ds_read_b128 v[72:75], v35 offset:128
    ds_read_b128 v[76:79], v35 offset:192
    s_waitcnt lgkmcnt(3)
    v_mfma_f32_16x16x32_bf16 v[84:87], v[112:115], v[64:67], 0
    s_waitcnt lgkmcnt(2)
    v_mfma_f32_16x16x32_bf16 v[84:87], v[116:119], v[68:71], v[84:87]
    s_waitcnt lgkmcnt(1)
    v_mfma_f32_16x16x32_bf16 v[84:87], v[120:123], v[72:75], v[84:87]
    s_waitcnt lgkmcnt(0)
    v_mfma_f32_16x16x32_bf16 v[84:87], v[124:127], v[76:79], v[84:87]
    v_cmp_ne_u32 vcc, 0, v110
    s_or_b32 s29, vcc_lo, vcc_hi
    s_nop 5
    v_cvt_pk_bf16_f32 v88, v84, v85
    v_cvt_pk_bf16_f32 v89, v86, v87
    s_mov_b32 exec_lo, 0xff00ff
    s_mov_b32 exec_hi, 0xff00ff
    s_cmp_lg_u32 s29, 0
    s_cbranch_scc1 far_44
    buffer_store_dwordx2 v[88:89], v37, s[48:51], s32 offen
    s_branch dn_45
far_44:
    buffer_store_dwordx2 v[88:89], v37, s[48:51], s32 offen sc1
dn_45:
    s_mov_b64 exec, -1
    s_waitcnt vmcnt(1)
    v_xor_b32 v47, 0, v5
    ds_read_b64_tr_b16 v[192:193], v47 offset:0
    ds_read_b64_tr_b16 v[194:195], v47 offset:512
    ds_read_b64_tr_b16 v[208:209], v47 offset:4096
    ds_read_b64_tr_b16 v[210:211], v47 offset:4608
    v_xor_b32 v47, 32, v5
    ds_read_b64_tr_b16 v[196:197], v47 offset:0
    ds_read_b64_tr_b16 v[198:199], v47 offset:512
    ds_read_b64_tr_b16 v[212:213], v47 offset:4096
    ds_read_b64_tr_b16 v[214:215], v47 offset:4608
    v_xor_b32 v47, 64, v5
    ds_read_b64_tr_b16 v[200:201], v47 offset:0
    ds_read_b64_tr_b16 v[202:203], v47 offset:512
    ds_read_b64_tr_b16 v[216:217], v47 offset:4096
    ds_read_b64_tr_b16 v[218:219], v47 offset:4608
    v_xor_b32 v47, 96, v5
    ds_read_b64_tr_b16 v[204:205], v47 offset:0
    ds_read_b64_tr_b16 v[206:207], v47 offset:512
    ds_read_b64_tr_b16 v[220:221], v47 offset:4096
    ds_read_b64_tr_b16 v[222:223], v47 offset:4608
    s_mov_b32 s63, 60000
poll_46:
    buffer_load_dwordx4 v[64:67], v56, s[48:51], s33 offen offset:0 sc1
    buffer_load_dwordx4 v[68:71], v56, s[48:51], s33 offen offset:256 sc1
    s_waitcnt vmcnt(0)
    v_max3_u32 v47, v64, v66, v68
    v_max_u32 v47, v47, v70
    v_cmp_eq_u32 vcc, -1, v47
    s_cbranch_vccz pdone_47
    s_sub_u32 s63, s63, 1
    s_cbranch_scc0 poll_46
pdone_47:
    s_waitcnt lgkmcnt(0)
    v_mfma_f32_16x16x32_bf16 v[80:83], v[192:195], v[64:67], 0
    v_mfma_f32_16x16x32_bf16 v[84:87], v[196:199], v[64:67], 0
    v_mfma_f32_16x16x32_bf16 v[88:91], v[200:203], v[64:67], 0
    v_mfma_f32_16x16x32_bf16 v[92:95], v[204:207], v[64:67], 0
    v_mfma_f32_16x16x32_bf16 v[80:83], v[208:211], v[68:71], v[80:83]
    v_mfma_f32_16x16x32_bf16 v[84:87], v[212:215], v[68:71], v[84:87]
    v_mfma_f32_16x16x32_bf16 v[88:91], v[216:219], v[68:71], v[88:91]
    v_mfma_f32_16x16x32_bf16 v[92:95], v[220:223], v[68:71], v[92:95]
    s_nop 4
    v_add_f32_dpp v96, v80, v80 row_ror:8 row_mask:0xf bank_mask:0x3
    v_add_f32_dpp v97, v81, v81 row_ror:8 row_mask:0xf bank_mask:0x3
    v_add_f32_dpp v98, v82, v82 row_ror:8 row_mask:0xf bank_mask:0x3
    v_add_f32_dpp v99, v83, v83 row_ror:8 row_mask:0xf bank_mask:0x3
    v_add_f32_dpp v100, v84, v84 row_ror:8 row_mask:0xf bank_mask:0x3
    v_add_f32_dpp v101, v85, v85 row_ror:8 row_mask:0xf bank_mask:0x3
    v_add_f32_dpp v102, v86, v86 row_ror:8 row_mask:0xf bank_mask:0x3
    v_add_f32_dpp v103, v87, v87 row_ror:8 row_mask:0xf bank_mask:0x3
    v_add_f32_dpp v96, v88, v88 row_ror:8 row_mask:0xf bank_mask:0xc
    v_add_f32_dpp v97, v89, v89 row_ror:8 row_mask:0xf bank_mask:0xc
    v_add_f32_dpp v98, v90, v90 row_ror:8 row_mask:0xf bank_mask:0xc
    v_add_f32_dpp v99, v91, v91 row_ror:8 row_mask:0xf bank_mask:0xc
    v_add_f32_dpp v100, v92, v92 row_ror:8 row_mask:0xf bank_mask:0xc
    v_add_f32_dpp v101, v93, v93 row_ror:8 row_mask:0xf bank_mask:0xc
    v_add_f32_dpp v102, v94, v94 row_ror:8 row_mask:0xf bank_mask:0xc
    v_add_f32_dpp v103, v95, v95 row_ror:8 row_mask:0xf bank_mask:0xc
    v_add_f32_dpp v104, v96, v96 row_shl:4 row_mask:0xf bank_mask:0x5
    v_add_f32_dpp v105, v97, v97 row_shl:4 row_mask:0xf bank_mask:0x5
    v_add_f32_dpp v106, v98, v98 row_shl:4 row_mask:0xf bank_mask:0x5
    v_add_f32_dpp v107, v99, v99 row_shl:4 row_mask:0xf bank_mask:0x5
    v_add_f32_dpp v104, v100, v100 row_shr:4 row_mask:0xf bank_mask:0xa
    v_add_f32_dpp v105, v101, v101 row_shr:4 row_mask:0xf bank_mask:0xa
    v_add_f32_dpp v106, v102, v102 row_shr:4 row_mask:0xf bank_mask:0xa
    v_add_f32_dpp v107, v103, v103 row_shr:4 row_mask:0xf bank_mask:0xa
    ds_write_b128 v57, v[104:107]
    s_waitcnt lgkmcnt(0)
    s_barrier
    s_cmp_lg_u32 s56, 7
    s_cbranch_scc1 nohint_48
    s_lshl_b32 s64, s55, 7
    s_add_u32 s64, s64, 182272
    v_mov_b32 v108, s57
    v_mov_b32 v109, 0
    s_mov_b32 exec_lo, 0x1
    s_mov_b32 exec_hi, 0x0
    buffer_store_dword v108, v109, s[48:51], s64 offen sc1
    s_mov_b64 exec, -1
nohint_48:
    s_cmp_ge_u32 s56, 3
    s_cbranch_scc1 L_fin
    s_cmp_eq_u32 s56, 2
    s_cbranch_scc1 L_final
    ds_read_b64 v[64:65], v58 offset:0
    ds_read_b64 v[66:67], v58 offset:1088
    ds_read_b64 v[68:69], v58 offset:2176
    ds_read_b64 v[70:71], v58 offset:3264
    ds_read_b64 v[72:73], v58 offset:4352
    ds_read_b64 v[74:75], v58 offset:5440
    ds_read_b64 v[76:77], v58 offset:6528
    ds_read_b64 v[78:79], v58 offset:7616
    s_waitcnt lgkmcnt(0)
    v_add_f32 v64, v64, v72
    v_add_f32 v65, v65, v73
    v_add_f32 v66, v66, v74
    v_add_f32 v67, v67, v75
    v_add_f32 v68, v68, v76
    v_add_f32 v69, v69, v77
    v_add_f32 v70, v70, v78
    v_add_f32 v71, v71, v79
    v_add_f32 v64, v64, v68
    v_add_f32 v65, v65, v69
    v_add_f32 v66, v66, v70
    v_add_f32 v67, v67, v71
    v_add_f32 v64, v64, v66
    v_add_f32 v65, v65, v67
    v_cvt_pk_bf16_f32 v64, v64, 0
    v_and_b32 v66, 0x7fffffff, v65
    v_add_u32 v66, 0x8000, v66
    s_mov_b32 s64, 0xffff
    s_brev_b32 s65, 1
    v_sub_u32 v66, v66, v64 clamp
    v_bfi_b32 v64, s64, v64, v66
    v_bfi_b32 v64, s65, v65, v64
    buffer_store_dword v64, v59, s[48:51], s34 offen sc1
    s_cmp_lg_u32 s2, 0
    s_cbranch_scc1 L_fin
    v_mov_b32 v40, s57
    v_mov_b32 v39, 0
    s_mov_b32 exec_lo, 0x1
    s_mov_b32 exec_hi, 0x0
    buffer_store_dword v40, v39, s[48:51], 0 offen offset:0 sc1
    s_mov_b64 exec, -1
    s_branch L_fin
L_final:
    s_lshr_b32 s68, s55, 2
    s_and_b32 s69, s55, 3
    v_bfe_u32 v32, v0, 2, 1
    v_and_b32 v33, 3, v0
    v_lshlrev_b32 v34, 10, v32
    v_lshl_add_u32 v34, v33, 3, v34
    s_lshl_b32 s64, s69, 11
    s_lshl_b32 s65, s68, 5
    s_add_u32 s64, s64, s65
    buffer_load_dwordx2 v[40:41], v34, s[4:7], s64 offen
    s_add_u32 s65, s64, 32768
    s_add_u32 s66, s65, 24576
    s_mov_b32 s63, 60000
poll_49:
    buffer_load_dwordx2 v[42:43], v34, s[48:51], s65 offen sc1
    buffer_load_dwordx2 v[44:45], v34, s[48:51], s66 offen sc1
    s_waitcnt vmcnt(0)
    v_max3_u32 v47, v42, v43, v44
    v_max_u32 v47, v47, v45
    v_cmp_eq_u32 vcc, -1, v47
    s_cbranch_vccz pdone_50
    s_sleep 1
    s_sub_u32 s63, s63, 1
    s_cbranch_scc0 poll_49
pdone_50:
    v_lshlrev_b32 v48, 16, v40
    v_and_b32 v49, 0xffff0000, v40
    v_lshlrev_b32 v50, 16, v41
    v_and_b32 v51, 0xffff0000, v41
    v_lshlrev_b32 v52, 16, v42
    v_and_b32 v53, 0xffff0000, v42
    v_lshlrev_b32 v54, 16, v43
    v_and_b32 v55, 0xffff0000, v43
    v_lshlrev_b32 v56, 16, v44
    v_and_b32 v57, 0xffff0000, v44
    v_lshlrev_b32 v58, 16, v45
    v_and_b32 v59, 0xffff0000, v45
    v_lshlrev_b32 v35, 13, v32
    v_lshl_add_u32 v35, v33, 3, v35
    s_lshl_b32 s65, s69, 14
    s_lshl_b32 s66, s68, 5
    s_add_u32 s65, s65, s66
    s_add_u32 s65, s65, 116736
    s_add_u32 s66, s65, 4096
    s_min_u32 s67, s54, 13
    s_lshl_b32 s33, s52, 4
    s_add_u32 s67, s67, s33
    s_lshl_b32 s67, s67, 7
    s_add_u32 s67, s67, 198720
    s_mov_b32 s63, 60000
hw_51:
    s_load_dword s33, s[48:49], s67 glc
    s_waitcnt lgkmcnt(0)
    s_cmp_eq_u32 s33, s57
    s_cbranch_scc1 hd_52
    s_sub_u32 s63, s63, 1
    s_cbranch_scc0 hw_51
hd_52:
    s_mov_b32 s63, 60000
poll_53:
    buffer_load_dwordx2 v[128:129], v35, s[48:51], s65 offen offset:0 sc1
    buffer_load_dwordx2 v[130:131], v35, s[48:51], s65 offen offset:1024 sc1
    buffer_load_dwordx2 v[132:133], v35, s[48:51], s65 offen offset:2048 sc1
    buffer_load_dwordx2 v[134:135], v35, s[48:51], s65 offen offset:3072 sc1
    buffer_load_dwordx2 v[136:137], v35, s[48:51], s66 offen offset:0 sc1
    buffer_load_dwordx2 v[138:139], v35, s[48:51], s66 offen offset:1024 sc1
    buffer_load_dwordx2 v[140:141], v35, s[48:51], s66 offen offset:2048 sc1
    buffer_load_dwordx2 v[142:143], v35, s[48:51], s66 offen offset:3072 sc1
    s_waitcnt vmcnt(0)
    v_max3_u32 v47, v128, v129, v130
    v_max3_u32 v47, v47, v131, v132
    v_max3_u32 v47, v47, v133, v134
    v_max3_u32 v47, v47, v135, v136
    v_max3_u32 v47, v47, v137, v138
    v_max3_u32 v47, v47, v139, v140
    v_max3_u32 v47, v47, v141, v142
    v_max_u32 v47, v47, v143
    v_cmp_eq_u32 vcc, -1, v47
    s_cbranch_vccz pdone_54
    s_sleep 1
    s_sub_u32 s63, s63, 1
    s_cbranch_scc0 poll_53
pdone_54:
    v_lshlrev_b32 v144, 16, v128
    v_mov_b32 v145, v128
    v_lshlrev_b32 v146, 16, v129
    v_mov_b32 v147, v129
    v_lshlrev_b32 v148, 16, v130
    v_mov_b32 v149, v130
    v_lshlrev_b32 v150, 16, v131
    v_mov_b32 v151, v131
    v_lshlrev_b32 v152, 16, v132
    v_mov_b32 v153, v132
    v_lshlrev_b32 v154, 16, v133
    v_mov_b32 v155, v133
    v_lshlrev_b32 v156, 16, v134
    v_mov_b32 v157, v134
    v_lshlrev_b32 v158, 16, v135
    v_mov_b32 v159, v135
    v_lshlrev_b32 v160, 16, v136
    v_mov_b32 v161, v136
    v_lshlrev_b32 v162, 16, v137
    v_mov_b32 v163, v137
    v_lshlrev_b32 v164, 16, v138
    v_mov_b32 v165, v138
    v_lshlrev_b32 v166, 16, v139
    v_mov_b32 v167, v139
    v_lshlrev_b32 v168, 16, v140
    v_mov_b32 v169, v140
    v_lshlrev_b32 v170, 16, v141
    v_mov_b32 v171, v141
    v_lshlrev_b32 v172, 16, v142
    v_mov_b32 v173, v142
    v_lshlrev_b32 v174, 16, v143
    v_mov_b32 v175, v143
    v_add_f32 v144, v144, v160
    v_add_f32 v145, v145, v161
    v_add_f32 v146, v146, v162
    v_add_f32 v147, v147, v163
    v_add_f32 v148, v148, v164
    v_add_f32 v149, v149, v165
    v_add_f32 v150, v150, v166
    v_add_f32 v151, v151, v167
    v_add_f32 v152, v152, v168
    v_add_f32 v153, v153, v169
    v_add_f32 v154, v154, v170
    v_add_f32 v155, v155, v171
    v_add_f32 v156, v156, v172
    v_add_f32 v157, v157, v173
    v_add_f32 v158, v158, v174
    v_add_f32 v159, v159, v175
    v_add_f32 v144, v144, v152
    v_add_f32 v145, v145, v153
    v_add_f32 v146, v146, v154
    v_add_f32 v147, v147, v155
    v_add_f32 v148, v148, v156
    v_add_f32 v149, v149, v157
    v_add_f32 v150, v150, v158
    v_add_f32 v151, v151, v159
    v_add_f32 v144, v144, v148
    v_add_f32 v145, v145, v149
    v_add_f32 v146, v146, v150
    v_add_f32 v147, v147, v151
    v_mov_b32 v72, v144
    v_mov_b32 v73, v145
    v_mov_b32 v74, v146
    v_mov_b32 v75, v147
    v_cvt_pk_bf16_f32 v72, 0, v72
    v_cvt_pk_bf16_f32 v73, 0, v73
    v_cvt_pk_bf16_f32 v74, 0, v74
    v_cvt_pk_bf16_f32 v75, 0, v75
    v_mul_f32 v72, v72, v52
    v_mul_f32 v73, v73, v53
    v_mul_f32 v74, v74, v54
    v_mul_f32 v75, v75, v55
    v_cvt_pk_bf16_f32 v72, 0, v72
    v_cvt_pk_bf16_f32 v73, 0, v73
    v_cvt_pk_bf16_f32 v74, 0, v74
    v_cvt_pk_bf16_f32 v75, 0, v75
    v_add_f32 v72, v72, v48
    v_add_f32 v73, v73, v49
    v_add_f32 v74, v74, v50
    v_add_f32 v75, v75, v51
    v_cvt_pk_bf16_f32 v72, 0, v72
    v_cvt_pk_bf16_f32 v73, 0, v73
    v_cvt_pk_bf16_f32 v74, 0, v74
    v_cvt_pk_bf16_f32 v75, 0, v75
    v_lshlrev_b32 v35, 4, v0
    s_mul_i32 s65, s55, 7168
    s_add_u32 s65, s65, 215040
    s_add_u32 s66, s65, 4096
    v_bfe_u32 v40, s57, 0, 8
    v_bfe_u32 v41, s57, 8, 8
    v_bfe_u32 v42, s57, 16, 8
    v_bfe_u32 v43, s57, 24, 8
    s_min_u32 s67, s54, 13
    s_lshl_b32 s68, s52, 4
    s_add_u32 s67, s67, s68
    s_lshl_b32 s67, s67, 7
    s_add_u32 s67, s67, 198656
    s_mov_b32 s63, 60000
hw_55:
    s_load_dword s68, s[48:49], s67 glc
    s_waitcnt lgkmcnt(0)
    s_cmp_eq_u32 s68, s57
    s_cbranch_scc1 hd_56
    s_sub_u32 s63, s63, 1
    s_cbranch_scc0 hw_55
hd_56:
    s_mov_b32 s63, 60000
poll_57:
    buffer_load_dwordx4 v[96:99], v35, s[48:51], s65 offen offset:0 sc1
    buffer_load_dwordx4 v[100:103], v35, s[48:51], s65 offen offset:1024 sc1
    buffer_load_dwordx4 v[104:107], v35, s[48:51], s65 offen offset:2048 sc1
    buffer_load_dwordx4 v[108:111], v35, s[48:51], s65 offen offset:3072 sc1
    buffer_load_dwordx4 v[112:115], v35, s[48:51], s66 offen offset:0 sc1
    buffer_load_dwordx4 v[116:119], v35, s[48:51], s66 offen offset:1024 sc1
    buffer_load_dwordx4 v[120:123], v35, s[48:51], s66 offen offset:2048 sc1
    s_waitcnt vmcnt(0)
    v_xor_b32 v96, v96, v40
    v_xor_b32 v97, v97, v41
    v_xor_b32 v98, v98, v42
    v_xor_b32 v99, v99, v43
    v_xor_b32 v100, v100, v40
    v_xor_b32 v101, v101, v41
    v_xor_b32 v102, v102, v42
    v_xor_b32 v103, v103, v43
    v_xor_b32 v104, v104, v40
    v_xor_b32 v105, v105, v41
    v_xor_b32 v106, v106, v42
    v_xor_b32 v107, v107, v43
    v_xor_b32 v108, v108, v40
    v_xor_b32 v109, v109, v41
    v_xor_b32 v110, v110, v42
    v_xor_b32 v111, v111, v43
    v_xor_b32 v112, v112, v40
    v_xor_b32 v113, v113, v41
    v_xor_b32 v114, v114, v42
    v_xor_b32 v115, v115, v43
    v_xor_b32 v116, v116, v40
    v_xor_b32 v117, v117, v41
    v_xor_b32 v118, v118, v42
    v_xor_b32 v119, v119, v43
    v_xor_b32 v120, v120, v40
    v_xor_b32 v121, v121, v41
    v_xor_b32 v122, v122, v42
    v_xor_b32 v123, v123, v43
    v_or3_b32 v47, v96, v97, v98
    v_or3_b32 v46, v99, v100, v101
    v_or3_b32 v47, v47, v102, v103
    v_or3_b32 v46, v46, v104, v105
    v_or3_b32 v47, v47, v106, v107
    v_or3_b32 v46, v46, v108, v109
    v_or3_b32 v47, v47, v110, v111
    v_or3_b32 v46, v46, v112, v113
    v_or3_b32 v47, v47, v114, v115
    v_or3_b32 v46, v46, v116, v117
    v_or3_b32 v47, v47, v118, v119
    v_or3_b32 v46, v46, v120, v121
    v_or3_b32 v47, v47, v122, v123
    v_or_b32 v47, v47, v46
    v_and_b32 v47, 0xff, v47
    v_cmp_ne_u32 vcc, 0, v47
    s_cbranch_vccz pdone_58
    s_sub_u32 s63, s63, 1
    s_cbranch_scc0 poll_57
pdone_58:
    v_add_f32 v96, v96, v100
    v_add_f32 v104, v104, v108
    v_add_f32 v112, v112, v116
    v_add_f32 v97, v97, v101
    v_add_f32 v105, v105, v109
    v_add_f32 v113, v113, v117
    v_add_f32 v98, v98, v102
    v_add_f32 v106, v106, v110
    v_add_f32 v114, v114, v118
    v_add_f32 v99, v99, v103
    v_add_f32 v107, v107, v111
    v_add_f32 v115, v115, v119
    v_add_f32 v96, v96, v104
    v_add_f32 v112, v112, v120
    v_add_f32 v97, v97, v105
    v_add_f32 v113, v113, v121
    v_add_f32 v98, v98, v106
    v_add_f32 v114, v114, v122
    v_add_f32 v99, v99, v107
    v_add_f32 v115, v115, v123
    v_add_f32 v96, v96, v112
    v_add_f32 v97, v97, v113
    v_add_f32 v98, v98, v114
    v_add_f32 v99, v99, v115
    v_add_f32_dpp v96, v96, v96 row_ror:8 row_mask:0xf bank_mask:0xf
    v_add_f32_dpp v97, v97, v97 row_ror:8 row_mask:0xf bank_mask:0xf
    v_add_f32_dpp v98, v98, v98 row_ror:8 row_mask:0xf bank_mask:0xf
    v_add_f32_dpp v99, v99, v99 row_ror:8 row_mask:0xf bank_mask:0xf
    v_mov_b32 v100, v96
    v_mov_b32 v101, v97
    v_mov_b32 v102, v98
    v_mov_b32 v103, v99
    v_permlane16_swap_b32 v100, v96
    v_permlane16_swap_b32 v101, v97
    v_permlane16_swap_b32 v102, v98
    v_permlane16_swap_b32 v103, v99
    v_add_f32 v96, v96, v100
    v_add_f32 v97, v97, v101
    v_add_f32 v98, v98, v102
    v_add_f32 v99, v99, v103
    v_mov_b32 v100, v96
    v_mov_b32 v101, v97
    v_mov_b32 v102, v98
    v_mov_b32 v103, v99
    v_permlane32_swap_b32 v100, v96
    v_permlane32_swap_b32 v101, v97
    v_permlane32_swap_b32 v102, v98
    v_permlane32_swap_b32 v103, v99
    v_add_f32 v96, v96, v100
    v_add_f32 v97, v97, v101
    v_add_f32 v98, v98, v102
    v_add_f32 v99, v99, v103
    v_cvt_pk_bf16_f32 v96, 0, v96
    v_cvt_pk_bf16_f32 v97, 0, v97
    v_cvt_pk_bf16_f32 v98, 0, v98
    v_cvt_pk_bf16_f32 v99, 0, v99
    v_mul_f32 v96, v96, v56
    v_mul_f32 v97, v97, v57
    v_mul_f32 v98, v98, v58
    v_mul_f32 v99, v99, v59
    v_cvt_pk_bf16_f32 v96, 0, v96
    v_cvt_pk_bf16_f32 v97, 0, v97
    v_cvt_pk_bf16_f32 v98, 0, v98
    v_cvt_pk_bf16_f32 v99, 0, v99
    v_add_f32 v96, v96, v72
    v_add_f32 v97, v97, v73
    v_add_f32 v98, v98, v74
    v_add_f32 v99, v99, v75
    v_cvt_pk_bf16_f32 v100, v96, v97
    v_cvt_pk_bf16_f32 v101, v98, v99
    s_mov_b32 exec_lo, 0xff
    s_mov_b32 exec_hi, 0x0
    buffer_store_dwordx2 v[100:101], v34, s[44:47], s64 offen
    s_mov_b64 exec, -1
    s_branch L_fin
L_pv:
    s_mov_b32 s10, 33554432
    s_mov_b32 s11, 0x00020000
    s_lshl_b32 s78, s54, 18
    s_lshl_b32 s64, s52, 22
    s_add_u32 s12, s78, 0
    s_and_b32 s12, s12, 0x3fffff
    s_or_b32 s12, s12, s64
    s_add_u32 s13, s78, 294912
    s_and_b32 s13, s13, 0x3fffff
    s_or_b32 s13, s13, s64
    s_add_u32 s14, s78, 589824
    s_and_b32 s14, s14, 0x3fffff
    s_or_b32 s14, s14, s64
    s_add_u32 s15, s78, 884736
    s_and_b32 s15, s15, 0x3fffff
    s_or_b32 s15, s15, s64
    s_add_u32 s16, s78, 1179648
    s_and_b32 s16, s16, 0x3fffff
    s_or_b32 s16, s16, s64
    s_add_u32 s17, s78, 1474560
    s_and_b32 s17, s17, 0x3fffff
    s_or_b32 s17, s17, s64
    s_add_u32 s18, s78, 1769472
    s_and_b32 s18, s18, 0x3fffff
    s_or_b32 s18, s18, s64
    s_add_u32 s19, s78, 2064384
    s_and_b32 s19, s19, 0x3fffff
    s_or_b32 s19, s19, s64
    s_and_b32 s79, s56, 3
    s_lshl_b32 s69, s79, 13
    s_and_b32 s64, s79, 1
    s_cmp_eq_u32 s64, 1
    s_cselect_b32 s65, 3, 0
    v_xor_b32 v48, s65, v0
    v_lshlrev_b32 v48, 4, v48
    v_add_u32 v48, s69, v48
    s_cselect_b32 s65, 7, 4
    v_xor_b32 v49, s65, v0
    v_lshlrev_b32 v49, 4, v49
    v_add_u32 v49, s69, v49
    s_cselect_b32 s65, 11, 8
    v_xor_b32 v50, s65, v0
    v_lshlrev_b32 v50, 4, v50
    v_add_u32 v50, s69, v50
    s_cselect_b32 s65, 15, 12
    v_xor_b32 v51, s65, v0
    v_lshlrev_b32 v51, 4, v51
    v_add_u32 v51, s69, v51
    s_cselect_b32 s65, 1, 2
    v_xor_b32 v52, s65, v0
    v_lshlrev_b32 v52, 4, v52
    v_add_u32 v52, s69, v52
    v_add_u32 v52, 4096, v52
    s_cselect_b32 s65, 5, 6
    v_xor_b32 v53, s65, v0
    v_lshlrev_b32 v53, 4, v53
    v_add_u32 v53, s69, v53
    v_add_u32 v53, 4096, v53
    s_cselect_b32 s65, 9, 10
    v_xor_b32 v54, s65, v0
    v_lshlrev_b32 v54, 4, v54
    v_add_u32 v54, s69, v54
    v_add_u32 v54, 4096, v54
    s_cselect_b32 s65, 13, 14
    v_xor_b32 v55, s65, v0
    v_lshlrev_b32 v55, 4, v55
    v_add_u32 v55, s69, v55
    v_add_u32 v55, 4096, v55
    s_waitcnt lgkmcnt(0)
    s_load_dword s57, s[48:49], 0
    s_load_dwordx2 s[28:29], s[0:1], 56
    s_load_dwordx2 s[32:33], s[0:1], 64
    s_mov_b32 s30, 1835008
    s_mov_b32 s31, 0x00020000
    s_mov_b32 s34, 1835008
    s_mov_b32 s35, 0x00020000
    s_mov_b32 s72, 0
L_pv_start:
    s_add_u32 m0, s69, 0
    s_nop 0
    buffer_load_dwordx4 v48, s[8:11], s12 offen nt lds
    buffer_load_dwordx4 v49, s[8:11], s12 offen offset:1024 nt lds
    buffer_load_dwordx4 v50, s[8:11], s12 offen offset:2048 nt lds
    buffer_load_dwordx4 v51, s[8:11], s12 offen offset:3072 nt lds
    s_add_u32 m0, s69, 4096
    s_nop 0
    buffer_load_dwordx4 v52, s[8:11], s12 offen nt lds
    buffer_load_dwordx4 v53, s[8:11], s12 offen offset:1024 nt lds
    buffer_load_dwordx4 v54, s[8:11], s12 offen offset:2048 nt lds
    buffer_load_dwordx4 v55, s[8:11], s12 offen offset:3072 nt lds
    v_mov_b32 v64, 0
    v_mov_b32 v65, 0
    v_mov_b32 v66, 0
    v_mov_b32 v67, 0
    v_mov_b32 v68, 0
    v_mov_b32 v69, 0
    v_mov_b32 v70, 0
    v_mov_b32 v71, 0
    v_mov_b32 v72, 0
    v_mov_b32 v73, 0
    v_mov_b32 v74, 0
    v_mov_b32 v75, 0
    v_mov_b32 v76, 0
    v_mov_b32 v77, 0
    v_mov_b32 v78, 0
    v_mov_b32 v79, 0
    v_mov_b32 v80, 0
    v_mov_b32 v81, 0
    v_mov_b32 v82, 0
    v_mov_b32 v83, 0
    v_mov_b32 v84, 0
    v_mov_b32 v85, 0
    v_mov_b32 v86, 0
    v_mov_b32 v87, 0
    v_mov_b32 v88, 0
    v_mov_b32 v89, 0
    v_mov_b32 v90, 0
    v_mov_b32 v91, 0
    v_mov_b32 v92, 0
    v_mov_b32 v93, 0
    v_mov_b32 v94, 0
    v_mov_b32 v95, 0
    v_mov_b32 v96, 0
    v_mov_b32 v97, 0
    v_mov_b32 v98, 0
    v_mov_b32 v99, 0
    v_mov_b32 v100, 0
    v_mov_b32 v101, 0
    v_mov_b32 v102, 0
    v_mov_b32 v103, 0
    v_mov_b32 v104, 0
    v_mov_b32 v105, 0
    v_mov_b32 v106, 0
    v_mov_b32 v107, 0
    v_mov_b32 v108, 0
    v_mov_b32 v109, 0
    v_mov_b32 v110, 0
    v_mov_b32 v111, 0
    v_mov_b32 v112, 0
    v_mov_b32 v113, 0
    v_mov_b32 v114, 0
    v_mov_b32 v115, 0
    v_mov_b32 v116, 0
    v_mov_b32 v117, 0
    v_mov_b32 v118, 0
    v_mov_b32 v119, 0
    v_mov_b32 v120, 0
    v_mov_b32 v121, 0
    v_mov_b32 v122, 0
    v_mov_b32 v123, 0
    v_mov_b32 v124, 0
    v_mov_b32 v125, 0
    v_mov_b32 v126, 0
    v_mov_b32 v127, 0
    s_cmp_lg_u32 s72, 0
    s_cbranch_scc1 L_pv_again
    v_lshrrev_b32 v42, 2, v1
    v_and_b32 v43, 3, v1
    v_and_b32 v44, 1, v2
    v_lshrrev_b32 v45, 1, v2
    v_lshl_add_u32 v46, v45, 3, v42
    v_lshlrev_b32 v46, 10, v46
    v_and_b32 v47, 1, v43
    v_lshl_add_u32 v46, v47, 3, v46
    s_lshl_b32 s64, s79, 8
    v_add_u32 v46, s64, v46
    v_lshrrev_b32 v47, 1, v43
    v_lshl_add_u32 v47, v44, 1, v47
    v_lshl_add_u32 v47, v42, 2, v47
    v_cmp_eq_u32 vcc, 1, v45
    v_mov_b32 v56, 0
    v_mov_b32 v57, 3
    v_cndmask_b32 v56, v56, v57, vcc
    v_xor_b32 v56, v56, v47
    v_xor_b32 v24, 0, v56
    v_lshl_add_u32 v24, v24, 4, v46
    v_add_u32 v32, 0x10000, v24
    v_xor_b32 v26, 4, v56
    v_lshl_add_u32 v26, v26, 4, v46
    v_add_u32 v34, 0x10000, v26
    v_xor_b32 v28, 8, v56
    v_lshl_add_u32 v28, v28, 4, v46
    v_add_u32 v36, 0x10000, v28
    v_xor_b32 v30, 12, v56
    v_lshl_add_u32 v30, v30, 4, v46
    v_add_u32 v38, 0x10000, v30
    v_mov_b32 v56, 2
    v_mov_b32 v57, 1
    v_cndmask_b32 v56, v56, v57, vcc
    v_xor_b32 v56, v56, v47
    v_xor_b32 v25, 0, v56
    v_lshl_add_u32 v25, v25, 4, v46
    v_add_u32 v25, 4096, v25
    v_add_u32 v33, 0x10000, v25
    v_xor_b32 v27, 4, v56
    v_lshl_add_u32 v27, v27, 4, v46
    v_add_u32 v27, 4096, v27
    v_add_u32 v35, 0x10000, v27
    v_xor_b32 v29, 8, v56
    v_lshl_add_u32 v29, v29, 4, v46
    v_add_u32 v29, 4096, v29
    v_add_u32 v37, 0x10000, v29
    v_xor_b32 v31, 12, v56
    v_lshl_add_u32 v31, v31, 4, v46
    v_add_u32 v31, 4096, v31
    v_add_u32 v39, 0x10000, v31
    v_lshlrev_b32 v40, 4, v0
    v_add_u32 v40, 131072, v40
    v_mov_b32 v41, 163328
    s_waitcnt lgkmcnt(0)
    s_mul_i32 s57, s57, 0x9e3779b1
    s_add_u32 s57, s57, 0x7f4a7c15
    v_and_b32 v42, 3, v1
    v_lshlrev_b32 v42, 3, v42
    v_lshrrev_b32 v42, v42, s57
    v_bfe_u32 v4, v42, 0, 1
    v_bfe_u32 v43, v42, 1, 1
    v_lshl_or_b32 v4, v43, 16, v4
    v_bfe_u32 v5, v42, 2, 1
    v_bfe_u32 v43, v42, 3, 1
    v_lshl_or_b32 v5, v43, 16, v5
    v_bfe_u32 v6, v42, 4, 1
    v_bfe_u32 v43, v42, 5, 1
    v_lshl_or_b32 v6, v43, 16, v6
    v_bfe_u32 v7, v42, 6, 1
    v_bfe_u32 v43, v42, 7, 1
    v_lshl_or_b32 v7, v43, 16, v7
L_pv_again:
    s_waitcnt vmcnt(8)
    s_add_u32 m0, s69, 65536
    s_nop 0
    buffer_load_dwordx4 v48, s[8:11], s13 offen nt lds
    buffer_load_dwordx4 v49, s[8:11], s13 offen offset:1024 nt lds
    s_waitcnt vmcnt(8)
    s_add_u32 m0, s69, 65536
    s_nop 0
    buffer_load_dwordx4 v50, s[8:11], s13 offen offset:2048 nt lds
    buffer_load_dwordx4 v51, s[8:11], s13 offen offset:3072 nt lds
    s_waitcnt vmcnt(8)
    s_add_u32 m0, s69, 69632
    s_nop 0
    buffer_load_dwordx4 v52, s[8:11], s13 offen nt lds
    buffer_load_dwordx4 v53, s[8:11], s13 offen offset:1024 nt lds
    s_waitcnt vmcnt(8)
    s_add_u32 m0, s69, 69632
    s_nop 0
    buffer_load_dwordx4 v54, s[8:11], s13 offen offset:2048 nt lds
    buffer_load_dwordx4 v55, s[8:11], s13 offen offset:3072 nt lds
    s_waitcnt vmcnt(8)
    s_add_u32 m0, s69, 32768
    s_nop 0
    buffer_load_dwordx4 v48, s[8:11], s14 offen nt lds
    buffer_load_dwordx4 v49, s[8:11], s14 offen offset:1024 nt lds
    s_waitcnt vmcnt(8)
    s_add_u32 m0, s69, 32768
    s_nop 0
    buffer_load_dwordx4 v50, s[8:11], s14 offen offset:2048 nt lds
    buffer_load_dwordx4 v51, s[8:11], s14 offen offset:3072 nt lds
    s_waitcnt vmcnt(8)
    s_add_u32 m0, s69, 36864
    s_nop 0
    buffer_load_dwordx4 v52, s[8:11], s14 offen nt lds
    buffer_load_dwordx4 v53, s[8:11], s14 offen offset:1024 nt lds
    s_waitcnt vmcnt(8)
    s_add_u32 m0, s69, 36864
    s_nop 0
    buffer_load_dwordx4 v54, s[8:11], s14 offen offset:2048 nt lds
    buffer_load_dwordx4 v55, s[8:11], s14 offen offset:3072 nt lds
    s_waitcnt vmcnt(8)
    s_barrier
    ds_read_b64_tr_b16 v[128:129], v24 offset:0
    ds_read_b64_tr_b16 v[130:131], v25 offset:0
    ds_read_b64_tr_b16 v[136:137], v26 offset:0
    ds_read_b64_tr_b16 v[138:139], v27 offset:0
    ds_read_b64_tr_b16 v[144:145], v28 offset:0
    ds_read_b64_tr_b16 v[146:147], v29 offset:0
    ds_read_b64_tr_b16 v[152:153], v30 offset:0
    ds_read_b64_tr_b16 v[154:155], v31 offset:0
    s_waitcnt vmcnt(8)
    s_add_u32 m0, s69, 98304
    s_nop 0
    buffer_load_dwordx4 v48, s[8:11], s15 offen nt lds
    buffer_load_dwordx4 v49, s[8:11], s15 offen offset:1024 nt lds
    ds_read_b64_tr_b16 v[132:133], v24 offset:16384
    ds_read_b64_tr_b16 v[134:135], v25 offset:16384
    ds_read_b64_tr_b16 v[140:141], v26 offset:16384
    ds_read_b64_tr_b16 v[142:143], v27 offset:16384
    ds_read_b64_tr_b16 v[148:149], v28 offset:16384
    ds_read_b64_tr_b16 v[150:151], v29 offset:16384
    ds_read_b64_tr_b16 v[156:157], v30 offset:16384
    ds_read_b64_tr_b16 v[158:159], v31 offset:16384
    s_waitcnt vmcnt(8)
    s_add_u32 m0, s69, 98304
    s_nop 0
    buffer_load_dwordx4 v50, s[8:11], s15 offen offset:2048 nt lds
    buffer_load_dwordx4 v51, s[8:11], s15 offen offset:3072 nt lds
    ds_read_b64_tr_b16 v[160:161], v32 offset:0
    ds_read_b64_tr_b16 v[162:163], v33 offset:0
    ds_read_b64_tr_b16 v[168:169], v34 offset:0
    ds_read_b64_tr_b16 v[170:171], v35 offset:0
    ds_read_b64_tr_b16 v[176:177], v36 offset:0
    ds_read_b64_tr_b16 v[178:179], v37 offset:0
    ds_read_b64_tr_b16 v[184:185], v38 offset:0
    ds_read_b64_tr_b16 v[186:187], v39 offset:0
    s_waitcnt vmcnt(8)
    s_add_u32 m0, s69, 102400
    s_nop 0
    buffer_load_dwordx4 v52, s[8:11], s15 offen nt lds
    buffer_load_dwordx4 v53, s[8:11], s15 offen offset:1024 nt lds
    ds_read_b64_tr_b16 v[164:165], v32 offset:16384
    ds_read_b64_tr_b16 v[166:167], v33 offset:16384
    ds_read_b64_tr_b16 v[172:173], v34 offset:16384
    ds_read_b64_tr_b16 v[174:175], v35 offset:16384
    ds_read_b64_tr_b16 v[180:181], v36 offset:16384
    ds_read_b64_tr_b16 v[182:183], v37 offset:16384
    ds_read_b64_tr_b16 v[188:189], v38 offset:16384
    ds_read_b64_tr_b16 v[190:191], v39 offset:16384
    s_waitcnt lgkmcnt(0)
    s_barrier
    s_waitcnt vmcnt(8)
    s_add_u32 m0, s69, 102400
    s_nop 0
    buffer_load_dwordx4 v54, s[8:11], s15 offen offset:2048 nt lds
    buffer_load_dwordx4 v55, s[8:11], s15 offen offset:3072 nt lds
    s_waitcnt vmcnt(8)
    s_barrier
    ds_read_b64_tr_b16 v[192:193], v24 offset:32768
    ds_read_b64_tr_b16 v[194:195], v25 offset:32768
    ds_read_b64_tr_b16 v[200:201], v26 offset:32768
    ds_read_b64_tr_b16 v[202:203], v27 offset:32768
    ds_read_b64_tr_b16 v[208:209], v28 offset:32768
    ds_read_b64_tr_b16 v[210:211], v29 offset:32768
    ds_read_b64_tr_b16 v[216:217], v30 offset:32768
    ds_read_b64_tr_b16 v[218:219], v31 offset:32768
    ds_read_b64_tr_b16 v[196:197], v24 offset:49152
    ds_read_b64_tr_b16 v[198:199], v25 offset:49152
    ds_read_b64_tr_b16 v[204:205], v26 offset:49152
    ds_read_b64_tr_b16 v[206:207], v27 offset:49152
    ds_read_b64_tr_b16 v[212:213], v28 offset:49152
    ds_read_b64_tr_b16 v[214:215], v29 offset:49152
    ds_read_b64_tr_b16 v[220:221], v30 offset:49152
    ds_read_b64_tr_b16 v[222:223], v31 offset:49152
    s_waitcnt vmcnt(0)
    s_barrier
    ds_read_b64_tr_b16 v[224:225], v32 offset:32768
    ds_read_b64_tr_b16 v[226:227], v33 offset:32768
    ds_read_b64_tr_b16 v[232:233], v34 offset:32768
    ds_read_b64_tr_b16 v[234:235], v35 offset:32768
    ds_read_b64_tr_b16 v[240:241], v36 offset:32768
    ds_read_b64_tr_b16 v[242:243], v37 offset:32768
    ds_read_b64_tr_b16 v[248:249], v38 offset:32768
    ds_read_b64_tr_b16 v[250:251], v39 offset:32768
    ds_read_b64_tr_b16 v[228:229], v32 offset:49152
    ds_read_b64_tr_b16 v[230:231], v33 offset:49152
    ds_read_b64_tr_b16 v[236:237], v34 offset:49152
    ds_read_b64_tr_b16 v[238:239], v35 offset:49152
    ds_read_b64_tr_b16 v[244:245], v36 offset:49152
    ds_read_b64_tr_b16 v[246:247], v37 offset:49152
    ds_read_b64_tr_b16 v[252:253], v38 offset:49152
    ds_read_b64_tr_b16 v[254:255], v39 offset:49152
    s_add_u32 m0, s69, 0
    s_nop 0
    buffer_load_dwordx4 v48, s[8:11], s16 offen nt lds
    s_add_u32 m0, s69, 0
    s_nop 0
    buffer_load_dwordx4 v49, s[8:11], s16 offen offset:1024 nt lds
    s_add_u32 m0, s69, 0
    s_nop 0
    buffer_load_dwordx4 v50, s[8:11], s16 offen offset:2048 nt lds
    s_add_u32 m0, s69, 0
    s_nop 0
    buffer_load_dwordx4 v51, s[8:11], s16 offen offset:3072 nt lds
    s_add_u32 m0, s69, 4096
    s_nop 0
    buffer_load_dwordx4 v52, s[8:11], s16 offen nt lds
    s_add_u32 m0, s69, 4096
    s_nop 0
    buffer_load_dwordx4 v53, s[8:11], s16 offen offset:1024 nt lds
    s_barrier
    s_add_u32 m0, s69, 4096
    s_nop 0
    buffer_load_dwordx4 v54, s[8:11], s16 offen offset:2048 nt lds
    s_add_u32 m0, s69, 4096
    s_nop 0
    buffer_load_dwordx4 v55, s[8:11], s16 offen offset:3072 nt lds
    s_add_u32 m0, s69, 65536
    s_nop 0
    buffer_load_dwordx4 v48, s[8:11], s17 offen nt lds
    s_add_u32 m0, s69, 65536
    s_nop 0
    buffer_load_dwordx4 v49, s[8:11], s17 offen offset:1024 nt lds
    s_add_u32 m0, s69, 65536
    s_nop 0
    buffer_load_dwordx4 v50, s[8:11], s17 offen offset:2048 nt lds
    s_add_u32 m0, s69, 65536
    s_nop 0
    buffer_load_dwordx4 v51, s[8:11], s17 offen offset:3072 nt lds
    s_add_u32 m0, s69, 69632
    s_nop 0
    buffer_load_dwordx4 v52, s[8:11], s17 offen nt lds
    s_add_u32 m0, s69, 69632
    s_nop 0
    buffer_load_dwordx4 v53, s[8:11], s17 offen offset:1024 nt lds
    s_add_u32 m0, s69, 69632
    s_nop 0
    buffer_load_dwordx4 v54, s[8:11], s17 offen offset:2048 nt lds
    s_add_u32 m0, s69, 69632
    s_nop 0
    buffer_load_dwordx4 v55, s[8:11], s17 offen offset:3072 nt lds
    s_waitcnt lgkmcnt(0)
    s_barrier
    s_add_u32 m0, s69, 32768
    s_nop 0
    buffer_load_dwordx4 v48, s[8:11], s18 offen nt lds
    s_add_u32 m0, s69, 32768
    s_nop 0
    buffer_load_dwordx4 v49, s[8:11], s18 offen offset:1024 nt lds
    s_add_u32 m0, s69, 32768
    s_nop 0
    buffer_load_dwordx4 v50, s[8:11], s18 offen offset:2048 nt lds
    s_add_u32 m0, s69, 32768
    s_nop 0
    buffer_load_dwordx4 v51, s[8:11], s18 offen offset:3072 nt lds
    s_waitcnt vmcnt(4)
    s_barrier
    ds_read_b128 v[8:11], v40 offset:0
    ds_read_b128 v[12:15], v40 offset:1024
    ds_read_b128 v[16:19], v40 offset:2048
    ds_read_b128 v[20:23], v40 offset:3072
    s_waitcnt lgkmcnt(0)
    v_mfma_f32_32x32x16_bf16 v[64:79], v[8:11], v[128:131], v[64:79]
    s_add_u32 m0, s69, 36864
    s_nop 0
    buffer_load_dwordx4 v52, s[8:11], s18 offen nt lds
    v_mfma_f32_32x32x16_bf16 v[80:95], v[8:11], v[136:139], v[80:95]
    s_add_u32 m0, s69, 36864
    s_nop 0
    buffer_load_dwordx4 v53, s[8:11], s18 offen offset:1024 nt lds
    v_mfma_f32_32x32x16_bf16 v[96:111], v[8:11], v[144:147], v[96:111]
    s_add_u32 m0, s69, 36864
    s_nop 0
    buffer_load_dwordx4 v54, s[8:11], s18 offen offset:2048 nt lds
    v_mfma_f32_32x32x16_bf16 v[112:127], v[8:11], v[152:155], v[112:127]
    s_add_u32 m0, s69, 36864
    s_nop 0
    buffer_load_dwordx4 v55, s[8:11], s18 offen offset:3072 nt lds
    v_mfma_f32_32x32x16_bf16 v[64:79], v[12:15], v[132:135], v[64:79]
    s_add_u32 m0, s69, 98304
    s_nop 0
    buffer_load_dwordx4 v48, s[8:11], s19 offen nt lds
    v_mfma_f32_32x32x16_bf16 v[80:95], v[12:15], v[140:143], v[80:95]
    s_add_u32 m0, s69, 98304
    s_nop 0
    buffer_load_dwordx4 v49, s[8:11], s19 offen offset:1024 nt lds
    v_mfma_f32_32x32x16_bf16 v[96:111], v[12:15], v[148:151], v[96:111]
    s_add_u32 m0, s69, 98304
    s_nop 0
    buffer_load_dwordx4 v50, s[8:11], s19 offen offset:2048 nt lds
    v_mfma_f32_32x32x16_bf16 v[112:127], v[12:15], v[156:159], v[112:127]
    s_add_u32 m0, s69, 98304
    s_nop 0
    buffer_load_dwordx4 v51, s[8:11], s19 offen offset:3072 nt lds
    v_mfma_f32_32x32x16_bf16 v[64:79], v[16:19], v[160:163], v[64:79]
    v_mfma_f32_32x32x16_bf16 v[80:95], v[16:19], v[168:171], v[80:95]
    v_mfma_f32_32x32x16_bf16 v[96:111], v[16:19], v[176:179], v[96:111]
    v_mfma_f32_32x32x16_bf16 v[112:127], v[16:19], v[184:187], v[112:127]
    v_mfma_f32_32x32x16_bf16 v[64:79], v[20:23], v[164:167], v[64:79]
    s_waitcnt vmcnt(12)
    s_barrier
    ds_read_b128 v[8:11], v40 offset:4096
    ds_read_b128 v[12:15], v40 offset:5120
    ds_read_b128 v[16:19], v40 offset:6144
    ds_read_b128 v[60:63], v40 offset:7168
    v_mfma_f32_32x32x16_bf16 v[80:95], v[20:23], v[172:175], v[80:95]
    v_mfma_f32_32x32x16_bf16 v[96:111], v[20:23], v[180:183], v[96:111]
    v_mfma_f32_32x32x16_bf16 v[112:127], v[20:23], v[188:191], v[112:127]
    s_waitcnt lgkmcnt(0)
    v_mfma_f32_32x32x16_bf16 v[64:79], v[8:11], v[192:195], v[64:79]
    s_add_u32 m0, s69, 102400
    s_nop 0
    buffer_load_dwordx4 v52, s[8:11], s19 offen nt lds
    s_add_u32 m0, s69, 102400
    s_nop 0
    buffer_load_dwordx4 v53, s[8:11], s19 offen offset:1024 nt lds
    s_add_u32 m0, s69, 102400
    s_nop 0
    buffer_load_dwordx4 v54, s[8:11], s19 offen offset:2048 nt lds
    v_mfma_f32_32x32x16_bf16 v[80:95], v[8:11], v[200:203], v[80:95]
    s_add_u32 m0, s69, 102400
    s_nop 0
    buffer_load_dwordx4 v55, s[8:11], s19 offen offset:3072 nt lds
    ds_read_b64_tr_b16 v[128:129], v24 offset:0
    ds_read_b64_tr_b16 v[130:131], v25 offset:0
    v_mfma_f32_32x32x16_bf16 v[96:111], v[8:11], v[208:211], v[96:111]
    ds_read_b64_tr_b16 v[136:137], v26 offset:0
    ds_read_b64_tr_b16 v[138:139], v27 offset:0
    ds_read_b64_tr_b16 v[144:145], v28 offset:0
    v_mfma_f32_32x32x16_bf16 v[112:127], v[8:11], v[216:219], v[112:127]
    ds_read_b64_tr_b16 v[146:147], v29 offset:0
    ds_read_b64_tr_b16 v[152:153], v30 offset:0
    ds_read_b64_tr_b16 v[154:155], v31 offset:0
    v_mfma_f32_32x32x16_bf16 v[64:79], v[12:15], v[196:199], v[64:79]
    ds_read_b64_tr_b16 v[132:133], v24 offset:16384
    ds_read_b64_tr_b16 v[134:135], v25 offset:16384
    v_mfma_f32_32x32x16_bf16 v[80:95], v[12:15], v[204:207], v[80:95]
    ds_read_b64_tr_b16 v[140:141], v26 offset:16384
    ds_read_b64_tr_b16 v[142:143], v27 offset:16384
    ds_read_b64_tr_b16 v[148:149], v28 offset:16384
    v_mfma_f32_32x32x16_bf16 v[96:111], v[12:15], v[212:215], v[96:111]
    ds_read_b64_tr_b16 v[150:151], v29 offset:16384
    ds_read_b64_tr_b16 v[156:157], v30 offset:16384
    ds_read_b64_tr_b16 v[158:159], v31 offset:16384
    v_mfma_f32_32x32x16_bf16 v[112:127], v[12:15], v[220:223], v[112:127]
    ds_read_b64_tr_b16 v[160:161], v32 offset:0
    ds_read_b64_tr_b16 v[162:163], v33 offset:0
    ds_read_b64_tr_b16 v[168:169], v34 offset:0
    v_mfma_f32_32x32x16_bf16 v[64:79], v[16:19], v[224:227], v[64:79]
    ds_read_b64_tr_b16 v[170:171], v35 offset:0
    ds_read_b64_tr_b16 v[176:177], v36 offset:0
    v_mfma_f32_32x32x16_bf16 v[80:95], v[16:19], v[232:235], v[80:95]
    ds_read_b64_tr_b16 v[178:179], v37 offset:0
    ds_read_b64_tr_b16 v[184:185], v38 offset:0
    ds_read_b64_tr_b16 v[186:187], v39 offset:0
    v_mfma_f32_32x32x16_bf16 v[96:111], v[16:19], v[240:243], v[96:111]
    ds_read_b64_tr_b16 v[164:165], v32 offset:16384
    ds_read_b64_tr_b16 v[166:167], v33 offset:16384
    ds_read_b64_tr_b16 v[172:173], v34 offset:16384
    v_mfma_f32_32x32x16_bf16 v[112:127], v[16:19], v[248:251], v[112:127]
    ds_read_b64_tr_b16 v[174:175], v35 offset:16384
    ds_read_b64_tr_b16 v[180:181], v36 offset:16384
    ds_read_b64_tr_b16 v[182:183], v37 offset:16384
    v_mfma_f32_32x32x16_bf16 v[64:79], v[60:63], v[228:231], v[64:79]
    ds_read_b64_tr_b16 v[188:189], v38 offset:16384
    ds_read_b64_tr_b16 v[190:191], v39 offset:16384
    s_waitcnt vmcnt(8)
    s_waitcnt lgkmcnt(0)
    s_barrier
    ds_read_b128 v[8:11], v40 offset:0
    ds_read_b128 v[12:15], v40 offset:1024
    ds_read_b128 v[16:19], v40 offset:2048
    ds_read_b128 v[20:23], v40 offset:3072
    v_mfma_f32_32x32x16_bf16 v[80:95], v[60:63], v[236:239], v[80:95]
    v_mfma_f32_32x32x16_bf16 v[96:111], v[60:63], v[244:247], v[96:111]
    v_mfma_f32_32x32x16_bf16 v[112:127], v[60:63], v[252:255], v[112:127]
    s_waitcnt lgkmcnt(0)
    v_mfma_f32_32x32x16_bf16 v[64:79], v[8:11], v[128:131], v[64:79]
    ds_read_b64_tr_b16 v[192:193], v24 offset:32768
    ds_read_b64_tr_b16 v[194:195], v25 offset:32768
    v_mfma_f32_32x32x16_bf16 v[80:95], v[8:11], v[136:139], v[80:95]
    ds_read_b64_tr_b16 v[200:201], v26 offset:32768
    ds_read_b64_tr_b16 v[202:203], v27 offset:32768
    v_mfma_f32_32x32x16_bf16 v[96:111], v[8:11], v[144:147], v[96:111]
    ds_read_b64_tr_b16 v[208:209], v28 offset:32768
    v_mfma_f32_32x32x16_bf16 v[112:127], v[8:11], v[152:155], v[112:127]
    ds_read_b64_tr_b16 v[210:211], v29 offset:32768
    ds_read_b64_tr_b16 v[216:217], v30 offset:32768
    v_mfma_f32_32x32x16_bf16 v[64:79], v[12:15], v[132:135], v[64:79]
    ds_read_b64_tr_b16 v[218:219], v31 offset:32768
    v_mfma_f32_32x32x16_bf16 v[80:95], v[12:15], v[140:143], v[80:95]
    ds_read_b64_tr_b16 v[196:197], v24 offset:49152
    ds_read_b64_tr_b16 v[198:199], v25 offset:49152
    v_mfma_f32_32x32x16_bf16 v[96:111], v[12:15], v[148:151], v[96:111]
    ds_read_b64_tr_b16 v[204:205], v26 offset:49152
    ds_read_b64_tr_b16 v[206:207], v27 offset:49152
    v_mfma_f32_32x32x16_bf16 v[112:127], v[12:15], v[156:159], v[112:127]
    ds_read_b64_tr_b16 v[212:213], v28 offset:49152
    v_mfma_f32_32x32x16_bf16 v[64:79], v[16:19], v[160:163], v[64:79]
    ds_read_b64_tr_b16 v[214:215], v29 offset:49152
    ds_read_b64_tr_b16 v[220:221], v30 offset:49152
    v_mfma_f32_32x32x16_bf16 v[80:95], v[16:19], v[168:171], v[80:95]
    ds_read_b64_tr_b16 v[222:223], v31 offset:49152
    s_waitcnt vmcnt(0)
    s_barrier
    ds_read_b128 v[8:11], v40 offset:4096
    ds_read_b128 v[12:15], v40 offset:5120
    v_mfma_f32_32x32x16_bf16 v[96:111], v[16:19], v[176:179], v[96:111]
    v_mfma_f32_32x32x16_bf16 v[112:127], v[16:19], v[184:187], v[112:127]
    v_mfma_f32_32x32x16_bf16 v[64:79], v[20:23], v[164:167], v[64:79]
    v_mfma_f32_32x32x16_bf16 v[80:95], v[20:23], v[172:175], v[80:95]
    v_mfma_f32_32x32x16_bf16 v[96:111], v[20:23], v[180:183], v[96:111]
    v_mfma_f32_32x32x16_bf16 v[112:127], v[20:23], v[188:191], v[112:127]
    s_waitcnt lgkmcnt(0)
    v_mfma_f32_32x32x16_bf16 v[64:79], v[8:11], v[192:195], v[64:79]
    ds_read_b64_tr_b16 v[224:225], v32 offset:32768
    ds_read_b64_tr_b16 v[226:227], v33 offset:32768
    ds_read_b64_tr_b16 v[232:233], v34 offset:32768
    v_mfma_f32_32x32x16_bf16 v[80:95], v[8:11], v[200:203], v[80:95]
    ds_read_b64_tr_b16 v[234:235], v35 offset:32768
    ds_read_b64_tr_b16 v[240:241], v36 offset:32768
    ds_read_b64_tr_b16 v[242:243], v37 offset:32768
    v_mfma_f32_32x32x16_bf16 v[96:111], v[8:11], v[208:211], v[96:111]
    ds_read_b64_tr_b16 v[248:249], v38 offset:32768
    ds_read_b64_tr_b16 v[250:251], v39 offset:32768
    v_mfma_f32_32x32x16_bf16 v[112:127], v[8:11], v[216:219], v[112:127]
    ds_read_b64_tr_b16 v[228:229], v32 offset:49152
    ds_read_b64_tr_b16 v[230:231], v33 offset:49152
    ds_read_b64_tr_b16 v[236:237], v34 offset:49152
    v_mfma_f32_32x32x16_bf16 v[64:79], v[12:15], v[196:199], v[64:79]
    ds_read_b64_tr_b16 v[238:239], v35 offset:49152
    ds_read_b64_tr_b16 v[244:245], v36 offset:49152
    ds_read_b64_tr_b16 v[246:247], v37 offset:49152
    v_mfma_f32_32x32x16_bf16 v[80:95], v[12:15], v[204:207], v[80:95]
    ds_read_b64_tr_b16 v[252:253], v38 offset:49152
    ds_read_b64_tr_b16 v[254:255], v39 offset:49152
    v_lshrrev_b32 v44, 1, v2
    v_and_b32 v45, 1, v2
    v_lshl_add_u32 v44, v44, 2, v45
    v_lshlrev_b32 v44, 17, v44
    v_lshl_add_u32 v44, v1, 4, v44
    s_lshl_b32 s65, s79, 15
    s_lshl_b32 s66, s55, 8
    s_add_u32 s65, s65, s66
    s_add_u32 s65, s65, 4194304
    s_mov_b32 s67, 0x00010001
    s_barrier
    ds_read_b32 v42, v41
    ds_read_b128 v[16:19], v40 offset:6144
    ds_read_b128 v[60:63], v40 offset:7168
    v_mfma_f32_32x32x16_bf16 v[96:111], v[12:15], v[212:215], v[96:111]
    v_mfma_f32_32x32x16_bf16 v[112:127], v[12:15], v[220:223], v[112:127]
    s_waitcnt lgkmcnt(0)
    v_readfirstlane_b32 s64, v42
    s_cmp_lg_u32 s64, 0
    s_cbranch_scc1 L_pv_redo
    v_mfma_f32_32x32x16_bf16 v[64:79], v[16:19], v[224:227], v[64:79]
    v_mfma_f32_32x32x16_bf16 v[80:95], v[16:19], v[232:235], v[80:95]
    v_mfma_f32_32x32x16_bf16 v[96:111], v[16:19], v[240:243], v[96:111]
    v_mfma_f32_32x32x16_bf16 v[112:127], v[16:19], v[248:251], v[112:127]
    v_mfma_f32_32x32x16_bf16 v[64:79], v[60:63], v[228:231], v[64:79]
    v_mfma_f32_32x32x16_bf16 v[80:95], v[60:63], v[236:239], v[80:95]
    v_mfma_f32_32x32x16_bf16 v[96:111], v[60:63], v[244:247], v[96:111]
    v_mfma_f32_32x32x16_bf16 v[112:127], v[60:63], v[252:255], v[112:127]
    s_nop 9
    v_cvt_pk_bf16_f32 v160, v64, v80
    v_cvt_pk_bf16_f32 v161, v65, v81
    v_cvt_pk_bf16_f32 v162, v96, v112
    v_cvt_pk_bf16_f32 v163, v97, v113
    s_barrier
    v_cvt_pk_bf16_f32 v164, v66, v82
    v_cvt_pk_bf16_f32 v165, v67, v83
    v_cvt_pk_bf16_f32 v166, v98, v114
    v_cvt_pk_bf16_f32 v167, v99, v115
    v_permlane16_swap_b32 v160, v161
    v_permlane16_swap_b32 v162, v163
    v_bfi_b32 v160, s67, v4, v160
    v_bfi_b32 v161, s67, v5, v161
    v_bfi_b32 v162, s67, v6, v162
    v_bfi_b32 v163, s67, v7, v163
    s_add_u32 s66, s65, 0
    buffer_store_dwordx4 v[160:163], v44, s[48:51], s66 offen sc1
    v_cvt_pk_bf16_f32 v168, v68, v84
    v_cvt_pk_bf16_f32 v169, v69, v85
    v_cvt_pk_bf16_f32 v170, v100, v116
    v_cvt_pk_bf16_f32 v171, v101, v117
    v_permlane16_swap_b32 v164, v165
    v_permlane16_swap_b32 v166, v167
    v_bfi_b32 v164, s67, v4, v164
    v_bfi_b32 v165, s67, v5, v165
    v_bfi_b32 v166, s67, v6, v166
    v_bfi_b32 v167, s67, v7, v167
    s_add_u32 s66, s65, 262144
    buffer_store_dwordx4 v[164:167], v44, s[48:51], s66 offen sc1
    v_cvt_pk_bf16_f32 v172, v70, v86
    v_cvt_pk_bf16_f32 v173, v71, v87
    v_cvt_pk_bf16_f32 v174, v102, v118
    v_cvt_pk_bf16_f32 v175, v103, v119
    v_permlane16_swap_b32 v168, v169
    v_permlane16_swap_b32 v170, v171
    v_bfi_b32 v168, s67, v4, v168
    v_bfi_b32 v169, s67, v5, v169
    v_bfi_b32 v170, s67, v6, v170
    v_bfi_b32 v171, s67, v7, v171
    s_add_u32 s66, s65, 1048576
    buffer_store_dwordx4 v[168:171], v44, s[48:51], s66 offen sc1
    v_cvt_pk_bf16_f32 v176, v72, v88
    v_cvt_pk_bf16_f32 v177, v73, v89
    v_cvt_pk_bf16_f32 v178, v104, v120
    v_cvt_pk_bf16_f32 v179, v105, v121
    v_permlane16_swap_b32 v172, v173
    v_permlane16_swap_b32 v174, v175
    v_bfi_b32 v172, s67, v4, v172
    v_bfi_b32 v173, s67, v5, v173
    v_bfi_b32 v174, s67, v6, v174
    v_bfi_b32 v175, s67, v7, v175
    s_add_u32 s66, s65, 1310720
    buffer_store_dwordx4 v[172:175], v44, s[48:51], s66 offen sc1
    v_cvt_pk_bf16_f32 v180, v74, v90
    v_cvt_pk_bf16_f32 v181, v75, v91
    v_cvt_pk_bf16_f32 v182, v106, v122
    v_cvt_pk_bf16_f32 v183, v107, v123
    v_permlane16_swap_b32 v176, v177
    v_permlane16_swap_b32 v178, v179
    v_bfi_b32 v176, s67, v4, v176
    v_bfi_b32 v177, s67, v5, v177
    v_bfi_b32 v178, s67, v6, v178
    v_bfi_b32 v179, s67, v7, v179
    s_add_u32 s66, s65, 2097152
    buffer_store_dwordx4 v[176:179], v44, s[48:51], s66 offen sc1
    v_cvt_pk_bf16_f32 v184, v76, v92
    v_cvt_pk_bf16_f32 v185, v77, v93
    v_cvt_pk_bf16_f32 v186, v108, v124
    v_cvt_pk_bf16_f32 v187, v109, v125
    v_permlane16_swap_b32 v180, v181
    v_permlane16_swap_b32 v182, v183
    v_bfi_b32 v180, s67, v4, v180
    v_bfi_b32 v181, s67, v5, v181
    v_bfi_b32 v182, s67, v6, v182
    v_bfi_b32 v183, s67, v7, v183
    s_add_u32 s66, s65, 2359296
    buffer_store_dwordx4 v[180:183], v44, s[48:51], s66 offen sc1
    v_cvt_pk_bf16_f32 v188, v78, v94
    v_cvt_pk_bf16_f32 v189, v79, v95
    v_cvt_pk_bf16_f32 v190, v110, v126
    v_cvt_pk_bf16_f32 v191, v111, v127
    v_permlane16_swap_b32 v184, v185
    v_permlane16_swap_b32 v186, v187
    v_bfi_b32 v184, s67, v4, v184
    v_bfi_b32 v185, s67, v5, v185
    v_bfi_b32 v186, s67, v6, v186
    v_bfi_b32 v187, s67, v7, v187
    s_add_u32 s66, s65, 3145728
    buffer_store_dwordx4 v[184:187], v44, s[48:51], s66 offen sc1
    v_permlane16_swap_b32 v188, v189
    v_permlane16_swap_b32 v190, v191
    v_bfi_b32 v188, s67, v4, v188
    v_bfi_b32 v189, s67, v5, v189
    v_bfi_b32 v190, s67, v6, v190
    v_bfi_b32 v191, s67, v7, v191
    s_add_u32 s66, s65, 3407872
    buffer_store_dwordx4 v[188:191], v44, s[48:51], s66 offen sc1
    s_branch L_att_post
L_pv_redo:
    s_waitcnt vmcnt(0) lgkmcnt(0)
    s_barrier
    s_mov_b32 s72, 1
    s_nop 7
    s_branch L_pv_start
L_qk:
    s_load_dword s57, s[48:49], 0
    s_load_dwordx2 s[28:29], s[0:1], 56
    s_load_dwordx2 s[32:33], s[0:1], 64
    s_load_dwordx2 s[24:25], s[0:1], 40
    s_mov_b32 s30, 1835008
    s_mov_b32 s31, 0x00020000
    s_mov_b32 s34, 1835008
    s_mov_b32 s35, 0x00020000
    s_mov_b32 s26, 4194304
    s_mov_b32 s27, 0x00020000
    v_and_b32 v32, 3, v1
    v_lshlrev_b32 v32, 2, v32
    v_lshrrev_b32 v33, 2, v1
    v_lshlrev_b32 v33, 1, v33
    v_mov_b32 v34, 120
    v_lshrrev_b32 v33, v33, v34
    v_and_b32 v33, 3, v33
    v_or_b32 v32, v32, v33
    v_xor_b32 v32, v32, v2
    v_lshlrev_b32 v33, 10, v1
    s_and_b32 s64, s56, 1
    s_lshl_b32 s64, s64, 14
    s_lshr_b32 s65, s56, 1
    s_lshl_b32 s65, s65, 16
    s_add_u32 s64, s64, s65
    v_add_u32 v33, s64, v33
    v_xor_b32 v48, 0, v32
    v_lshl_add_u32 v48, v48, 4, v33
    v_xor_b32 v49, 4, v32
    v_lshl_add_u32 v49, v49, 4, v33
    v_xor_b32 v50, 8, v32
    v_lshl_add_u32 v50, v50, 4, v33
    v_xor_b32 v51, 12, v32
    v_lshl_add_u32 v51, v51, 4, v33
    v_add_u32 v30, 131072, v16
    v_lshlrev_b32 v53, 4, v0
    v_add_u32 v53, 131072, v53
    v_lshlrev_b32 v55, 4, v1
    v_add_u32 v55, 162816, v55
    v_and_b32 v54, 31, v0
    v_lshlrev_b32 v54, 4, v54
    s_lshl_b32 s64, s56, 2
    s_add_u32 s64, s64, 162816
    v_add_u32 v54, s64, v54
    v_mov_b32 v31, 163328
    v_lshlrev_b32 v52, 6, v1
    v_lshl_add_u32 v52, v2, 4, v52
    s_lshl_b32 s64, s56, 12
    v_add_u32 v57, s64, v53
    s_waitcnt lgkmcnt(0)
    s_mul_i32 s57, s57, 0x9e3779b1
    s_add_u32 s57, s57, 0x7f4a7c15
    s_mov_b32 s72, 0
L_qk_start:
    v_mov_b32 v26, 0
    v_mov_b32 v27, 0
    v_mov_b32 v28, 0
    v_mov_b32 v29, 0
    v_mov_b32 v40, 0
    v_mov_b32 v41, 0
    ds_write_b64 v31, v[40:41]
    s_barrier
    ds_read_b128 v[192:195], v48 offset:0
    ds_read_b128 v[196:199], v49 offset:0
    ds_read_b128 v[200:203], v50 offset:0
    ds_read_b128 v[204:207], v51 offset:0
    ds_read_b128 v[208:211], v48 offset:256
    ds_read_b128 v[212:215], v49 offset:256
    ds_read_b128 v[216:219], v50 offset:256
    ds_read_b128 v[220:223], v51 offset:256
    ds_read_b128 v[224:227], v48 offset:512
    ds_read_b128 v[228:231], v49 offset:512
    ds_read_b128 v[232:235], v50 offset:512
    ds_read_b128 v[236:239], v51 offset:512
    ds_read_b128 v[240:243], v48 offset:768
    ds_read_b128 v[244:247], v49 offset:768
    ds_read_b128 v[248:251], v50 offset:768
    ds_read_b128 v[252:255], v51 offset:768
    s_waitcnt lgkmcnt(0)
    s_barrier
    s_cmp_lg_u32 s72, 0
    s_cbranch_scc1 L_noq
    s_lshl_b32 s64, s55, 7
    s_add_u32 s64, s64, 98304
    s_not_b32 s65, s57
    s_lshl_b32 s68, s52, 18
    s_add_u32 s68, s68, 2097152
    s_add_u32 s78, s68, 31744
    s_lshl_b32 s69, s56, 12
    s_add_u32 s68, s68, s69
    s_add_u32 s69, s68, 16384
    s_mov_b32 s63, 60000
    s_cmp_lg_u32 s56, 0
    s_cbranch_scc1 foll_60
poll_59:
    s_load_dwordx16 s[8:23], s[48:49], s64 glc
    s_waitcnt lgkmcnt(0)
    s_mov_b32 s66, s57
    s_mov_b32 s67, s65
    s_xor_b64 s[8:9], s[8:9], s[66:67]
    s_xor_b64 s[10:11], s[10:11], s[66:67]
    s_xor_b64 s[12:13], s[12:13], s[66:67]
    s_xor_b64 s[14:15], s[14:15], s[66:67]
    s_xor_b64 s[16:17], s[16:17], s[66:67]
    s_xor_b64 s[18:19], s[18:19], s[66:67]
    s_xor_b64 s[20:21], s[20:21], s[66:67]
    s_xor_b64 s[22:23], s[22:23], s[66:67]
    s_or_b64 s[8:9], s[8:9], s[16:17]
    s_or_b64 s[10:11], s[10:11], s[18:19]
    s_or_b64 s[12:13], s[12:13], s[20:21]
    s_or_b64 s[14:15], s[14:15], s[22:23]
    s_or_b64 s[8:9], s[8:9], s[12:13]
    s_or_b64 s[10:11], s[10:11], s[14:15]
    s_or_b64 s[8:9], s[8:9], s[10:11]
    s_cbranch_scc0 seen_61
    s_sub_u32 s63, s63, 1
    s_cbranch_scc0 poll_59
seen_61:
    ds_write_b32 v31, v31 offset:4
foll_60:
    s_barrier
    buffer_load_dwordx4 v[156:159], v52, s[48:51], s68 offen offset:0 sc1
    buffer_load_dwordx4 v[160:163], v52, s[48:51], s68 offen offset:1024 sc1
    buffer_load_dwordx4 v[164:167], v52, s[48:51], s68 offen offset:2048 sc1
    buffer_load_dwordx4 v[168:171], v52, s[48:51], s68 offen offset:3072 sc1
    buffer_load_dwordx4 v[172:175], v52, s[48:51], s69 offen offset:0 sc1
    buffer_load_dwordx4 v[176:179], v52, s[48:51], s69 offen offset:1024 sc1
    buffer_load_dwordx4 v[180:183], v52, s[48:51], s69 offen offset:2048 sc1
    buffer_load_dwordx4 v[184:187], v52, s[48:51], s69 offen offset:3072 sc1
    buffer_load_dwordx4 v[188:191], v52, s[48:51], s78 offen sc1
    s_barrier
    s_waitcnt vmcnt(8)
    ds_write_b128 v57, v[156:159] offset:0
    s_waitcnt vmcnt(7)
    ds_write_b128 v57, v[160:163] offset:1024
    s_waitcnt vmcnt(6)
    ds_write_b128 v57, v[164:167] offset:2048
    s_waitcnt vmcnt(5)
    ds_write_b128 v57, v[168:171] offset:3072
    s_waitcnt vmcnt(4)
    ds_write_b128 v57, v[172:175] offset:16384
    s_waitcnt vmcnt(3)
    ds_write_b128 v57, v[176:179] offset:17408
    s_waitcnt vmcnt(2)
    ds_write_b128 v57, v[180:183] offset:18432
    s_waitcnt vmcnt(1)
    s_cmp_eq_u32 s56, 3
    s_cbranch_scc1 wi_62
    ds_write_b128 v57, v[184:187] offset:19456
wi_62:
    s_mov_b32 s63, 60000
    s_waitcnt vmcnt(0)
poll_64:
    v_max3_u32 v40, v156, v160, v164
    v_max3_u32 v40, v40, v168, v172
    v_max3_u32 v40, v40, v176, v180
    v_max3_u32 v40, v40, v184, v188
    v_cmp_eq_u32 vcc, -1, v40
    s_cbranch_vccz pdone_65
    v_cmp_eq_u32 vcc, -1, v156
    s_cbranch_vccz qn_66
    buffer_load_dwordx4 v[156:159], v52, s[48:51], s68 offen offset:0 sc1
qn_66:
    v_cmp_eq_u32 vcc, -1, v160
    s_cbranch_vccz qn_67
    buffer_load_dwordx4 v[160:163], v52, s[48:51], s68 offen offset:1024 sc1
qn_67:
    v_cmp_eq_u32 vcc, -1, v164
    s_cbranch_vccz qn_68
    buffer_load_dwordx4 v[164:167], v52, s[48:51], s68 offen offset:2048 sc1
qn_68:
    v_cmp_eq_u32 vcc, -1, v168
    s_cbranch_vccz qn_69
    buffer_load_dwordx4 v[168:171], v52, s[48:51], s68 offen offset:3072 sc1
qn_69:
    v_cmp_eq_u32 vcc, -1, v172
    s_cbranch_vccz qn_70
    buffer_load_dwordx4 v[172:175], v52, s[48:51], s69 offen offset:0 sc1
qn_70:
    v_cmp_eq_u32 vcc, -1, v176
    s_cbranch_vccz qn_71
    buffer_load_dwordx4 v[176:179], v52, s[48:51], s69 offen offset:1024 sc1
qn_71:
    v_cmp_eq_u32 vcc, -1, v180
    s_cbranch_vccz qn_72
    buffer_load_dwordx4 v[180:183], v52, s[48:51], s69 offen offset:2048 sc1
qn_72:
    v_cmp_eq_u32 vcc, -1, v184
    s_cbranch_vccz qn_73
    buffer_load_dwordx4 v[184:187], v52, s[48:51], s69 offen offset:3072 sc1
qn_73:
    v_cmp_eq_u32 vcc, -1, v188
    s_cbranch_vccz qn_74
    buffer_load_dwordx4 v[188:191], v52, s[48:51], s78 offen sc1
qn_74:
    s_waitcnt vmcnt(0)
    ds_write_b128 v57, v[156:159] offset:0
    ds_write_b128 v57, v[160:163] offset:1024
    ds_write_b128 v57, v[164:167] offset:2048
    ds_write_b128 v57, v[168:171] offset:3072
    ds_write_b128 v57, v[172:175] offset:16384
    ds_write_b128 v57, v[176:179] offset:17408
    ds_write_b128 v57, v[180:183] offset:18432
    s_cmp_eq_u32 s56, 3
    s_cbranch_scc1 wi_75
    ds_write_b128 v57, v[184:187] offset:19456
wi_75:
    s_sub_u32 s63, s63, 1
    s_cbranch_scc0 poll_64
pdone_65:
    s_branch L_go
L_noq:
    s_barrier
    s_barrier
    ds_write_b128 v53, v[64:67] offset:0
    ds_write_b128 v53, v[68:71] offset:1024
    ds_write_b128 v53, v[72:75] offset:2048
    ds_write_b128 v53, v[76:79] offset:3072
    ds_write_b128 v53, v[80:83] offset:4096
    ds_write_b128 v53, v[84:87] offset:5120
    ds_write_b128 v53, v[88:91] offset:6144
    ds_write_b128 v53, v[92:95] offset:7168
    ds_write_b128 v53, v[96:99] offset:8192
    ds_write_b128 v53, v[100:103] offset:9216
    ds_write_b128 v53, v[104:107] offset:10240
    ds_write_b128 v53, v[108:111] offset:11264
    ds_write_b128 v53, v[112:115] offset:12288
    ds_write_b128 v53, v[116:119] offset:13312
    ds_write_b128 v53, v[120:123] offset:14336
    ds_write_b128 v53, v[124:127] offset:15360
    ds_write_b128 v53, v[128:131] offset:16384
    ds_write_b128 v53, v[132:135] offset:17408
    ds_write_b128 v53, v[136:139] offset:18432
    ds_write_b128 v53, v[140:143] offset:19456
    ds_write_b128 v53, v[144:147] offset:20480
    ds_write_b128 v53, v[148:151] offset:21504
    ds_write_b128 v53, v[152:155] offset:22528
    ds_write_b128 v53, v[156:159] offset:23552
    ds_write_b128 v53, v[160:163] offset:24576
    ds_write_b128 v53, v[164:167] offset:25600
    ds_write_b128 v53, v[168:171] offset:26624
    ds_write_b128 v53, v[172:175] offset:27648
    ds_write_b128 v53, v[176:179] offset:28672
    ds_write_b128 v53, v[180:183] offset:29696
    ds_write_b128 v53, v[184:187] offset:30720
L_go:
    s_mov_b32 s66, 0x3db504f3
    s_mov_b32 s67, 0x3fb8aa3b
    s_mov_b32 s65, 0x42800000
    s_setprio 1
    s_waitcnt lgkmcnt(0)
    s_barrier
    ds_read_b128 v[64:67], v53 offset:0
    ds_read_b128 v[128:131], v53 offset:16384
    ds_read_b128 v[68:71], v53 offset:1024
    ds_read_b128 v[132:135], v53 offset:17408
    ds_read_b128 v[72:75], v53 offset:2048
    ds_read_b128 v[136:139], v53 offset:18432
    ds_read_b128 v[76:79], v53 offset:3072
    ds_read_b128 v[140:143], v53 offset:19456
    s_waitcnt lgkmcnt(7)
    v_mfma_f32_16x16x32_bf16 v[8:11], v[192:195], v[64:67], 0
    ds_read_b128 v[80:83], v53 offset:4096
    s_waitcnt lgkmcnt(7)
    v_mfma_f32_16x16x32_bf16 v[12:15], v[192:195], v[128:131], 0
    ds_read_b128 v[144:147], v53 offset:20480
    s_waitcnt lgkmcnt(7)
    v_mfma_f32_16x16x32_bf16 v[8:11], v[196:199], v[68:71], v[8:11]
    ds_read_b128 v[84:87], v53 offset:5120
    s_waitcnt lgkmcnt(7)
    v_mfma_f32_16x16x32_bf16 v[12:15], v[196:199], v[132:135], v[12:15]
    ds_read_b128 v[148:151], v53 offset:21504
    s_waitcnt lgkmcnt(7)
    v_mfma_f32_16x16x32_bf16 v[8:11], v[200:203], v[72:75], v[8:11]
    ds_read_b128 v[88:91], v53 offset:6144
    s_waitcnt lgkmcnt(7)
    v_mfma_f32_16x16x32_bf16 v[12:15], v[200:203], v[136:139], v[12:15]
    ds_read_b128 v[152:155], v53 offset:22528
    s_waitcnt lgkmcnt(7)
    v_mfma_f32_16x16x32_bf16 v[8:11], v[204:207], v[76:79], v[8:11]
    ds_read_b128 v[92:95], v53 offset:7168
    s_waitcnt lgkmcnt(7)
    v_mfma_f32_16x16x32_bf16 v[12:15], v[204:207], v[140:143], v[12:15]
    ds_read_b128 v[156:159], v53 offset:23552
    s_waitcnt lgkmcnt(7)
    v_mfma_f32_16x16x32_bf16 v[8:11], v[208:211], v[80:83], v[8:11]
    ds_read_b128 v[96:99], v53 offset:8192
    s_waitcnt lgkmcnt(7)
    v_mfma_f32_16x16x32_bf16 v[12:15], v[208:211], v[144:147], v[12:15]
    ds_read_b128 v[160:163], v53 offset:24576
    s_waitcnt lgkmcnt(7)
    v_mfma_f32_16x16x32_bf16 v[8:11], v[212:215], v[84:87], v[8:11]
    ds_read_b128 v[100:103], v53 offset:9216
    s_waitcnt lgkmcnt(7)
    v_mfma_f32_16x16x32_bf16 v[12:15], v[212:215], v[148:151], v[12:15]
    ds_read_b128 v[164:167], v53 offset:25600
    s_waitcnt lgkmcnt(7)
    v_mfma_f32_16x16x32_bf16 v[8:11], v[216:219], v[88:91], v[8:11]
    ds_read_b128 v[104:107], v53 offset:10240
    s_waitcnt lgkmcnt(7)
    v_mfma_f32_16x16x32_bf16 v[12:15], v[216:219], v[152:155], v[12:15]
    ds_read_b128 v[168:171], v53 offset:26624
    s_waitcnt lgkmcnt(7)
    v_mfma_f32_16x16x32_bf16 v[8:11], v[220:223], v[92:95], v[8:11]
    ds_read_b128 v[108:111], v53 offset:11264
    s_waitcnt lgkmcnt(7)
    v_mfma_f32_16x16x32_bf16 v[12:15], v[220:223], v[156:159], v[12:15]
    ds_read_b128 v[172:175], v53 offset:27648
    s_waitcnt lgkmcnt(7)
    v_mfma_f32_16x16x32_bf16 v[8:11], v[224:227], v[96:99], v[8:11]
    ds_read_b128 v[112:115], v53 offset:12288
    s_waitcnt lgkmcnt(7)
    v_mfma_f32_16x16x32_bf16 v[12:15], v[224:227], v[160:163], v[12:15]
    ds_read_b128 v[176:179], v53 offset:28672
    s_waitcnt lgkmcnt(7)
    v_mfma_f32_16x16x32_bf16 v[8:11], v[228:231], v[100:103], v[8:11]
    ds_read_b128 v[116:119], v53 offset:13312
    s_waitcnt lgkmcnt(7)
    v_mfma_f32_16x16x32_bf16 v[12:15], v[228:231], v[164:167], v[12:15]
    ds_read_b128 v[180:183], v53 offset:29696
    s_waitcnt lgkmcnt(7)
    v_mfma_f32_16x16x32_bf16 v[8:11], v[232:235], v[104:107], v[8:11]
    ds_read_b128 v[120:123], v53 offset:14336
    s_waitcnt lgkmcnt(7)
    v_mfma_f32_16x16x32_bf16 v[12:15], v[232:235], v[168:171], v[12:15]
    ds_read_b128 v[184:187], v53 offset:30720
    s_waitcnt lgkmcnt(7)
    v_mfma_f32_16x16x32_bf16 v[8:11], v[236:239], v[108:111], v[8:11]
    ds_read_b128 v[124:127], v53 offset:15360
    s_waitcnt lgkmcnt(7)
    v_mfma_f32_16x16x32_bf16 v[12:15], v[236:239], v[172:175], v[12:15]
    ds_read_b128 v[192:195], v48 offset:32768
    s_waitcnt lgkmcnt(7)
    v_mfma_f32_16x16x32_bf16 v[8:11], v[240:243], v[112:115], v[8:11]
    ds_read_b128 v[196:199], v49 offset:32768
    s_waitcnt lgkmcnt(7)
    v_mfma_f32_16x16x32_bf16 v[12:15], v[240:243], v[176:179], v[12:15]
    ds_read_b128 v[200:203], v50 offset:32768
    s_waitcnt lgkmcnt(7)
    v_mfma_f32_16x16x32_bf16 v[8:11], v[244:247], v[116:119], v[8:11]
    ds_read_b128 v[204:207], v51 offset:32768
    s_waitcnt lgkmcnt(7)
    v_mfma_f32_16x16x32_bf16 v[12:15], v[244:247], v[180:183], v[12:15]
    ds_read_b128 v[208:211], v48 offset:33024
    s_waitcnt lgkmcnt(7)
    v_mfma_f32_16x16x32_bf16 v[8:11], v[248:251], v[120:123], v[8:11]
    ds_read_b128 v[212:215], v49 offset:33024
    s_waitcnt lgkmcnt(7)
    v_mfma_f32_16x16x32_bf16 v[12:15], v[248:251], v[184:187], v[12:15]
    ds_read_b128 v[216:219], v50 offset:33024
    s_waitcnt lgkmcnt(7)
    v_mfma_f32_16x16x32_bf16 v[8:11], v[252:255], v[124:127], v[8:11]
    ds_read_b128 v[220:223], v51 offset:33024
    v_mfma_f32_16x16x32_bf16 v[12:15], v[252:255], v[188:191], v[12:15]
    ds_read_b128 v[224:227], v48 offset:33280
    s_waitcnt lgkmcnt(8)
    v_mfma_f32_16x16x32_bf16 v[4:7], v[192:195], v[64:67], 0
    ds_read_b128 v[228:231], v49 offset:33280
    v_mfma_f32_16x16x32_bf16 v[56:59], v[192:195], v[128:131], 0
    ds_read_b128 v[232:235], v50 offset:33280
    s_waitcnt lgkmcnt(9)
    v_mfma_f32_16x16x32_bf16 v[4:7], v[196:199], v[68:71], v[4:7]
    ds_read_b128 v[236:239], v51 offset:33280
    v_mfma_f32_16x16x32_bf16 v[56:59], v[196:199], v[132:135], v[56:59]
    ds_read_b128 v[240:243], v48 offset:33536
    s_waitcnt lgkmcnt(10)
    v_mfma_f32_16x16x32_bf16 v[4:7], v[200:203], v[72:75], v[4:7]
    ds_read_b128 v[244:247], v49 offset:33536
    v_max3_f32 v44, v8, v9, v10
    v_max3_f32 v45, v12, v13, v14
    v_max_f32 v44, v44, v11
    v_max_f32 v45, v45, v15
    v_mfma_f32_16x16x32_bf16 v[56:59], v[200:203], v[136:139], v[56:59]
    ds_read_b128 v[248:251], v50 offset:33536
    v_cvt_pk_bf16_f32 v32, 0, v8
    v_cvt_pk_bf16_f32 v36, 0, v12
    v_permlane16_swap_b32 v44, v45
    s_waitcnt lgkmcnt(11)
    v_mfma_f32_16x16x32_bf16 v[4:7], v[204:207], v[76:79], v[4:7]
    ds_read_b128 v[252:255], v51 offset:33536
    v_cvt_pk_bf16_f32 v33, 0, v9
    v_cvt_pk_bf16_f32 v37, 0, v13
    v_max_f32 v44, v44, v45
    v_mfma_f32_16x16x32_bf16 v[56:59], v[204:207], v[140:143], v[56:59]
    v_cvt_pk_bf16_f32 v34, 0, v10
    v_cvt_pk_bf16_f32 v38, 0, v14
    v_mov_b32 v46, v44
    s_waitcnt lgkmcnt(11)
    v_mfma_f32_16x16x32_bf16 v[4:7], v[208:211], v[80:83], v[4:7]
    v_cvt_pk_bf16_f32 v35, 0, v11
    v_cvt_pk_bf16_f32 v39, 0, v15
    v_permlane32_swap_b32 v46, v44
    v_mul_f32 v32, s66, v32
    v_mfma_f32_16x16x32_bf16 v[56:59], v[208:211], v[144:147], v[56:59]
    v_mul_f32 v36, s66, v36
    v_max_f32 v44, v44, v46
    ds_write_b32 v54, v44
    s_waitcnt lgkmcnt(11)
    v_mfma_f32_16x16x32_bf16 v[4:7], v[212:215], v[84:87], v[4:7]
    v_mul_f32 v33, s66, v33
    v_mul_f32 v37, s66, v37
    v_mul_f32 v34, s66, v34
    v_mfma_f32_16x16x32_bf16 v[56:59], v[212:215], v[148:151], v[56:59]
    v_mul_f32 v38, s66, v38
    v_mul_f32 v35, s66, v35
    v_mul_f32 v39, s66, v39
    s_waitcnt lgkmcnt(10)
    v_mfma_f32_16x16x32_bf16 v[4:7], v[216:219], v[88:91], v[4:7]
    v_cvt_pk_bf16_f32 v16, 0, v32
    v_cvt_pk_bf16_f32 v20, 0, v36
    s_waitcnt lgkmcnt(0)
    s_barrier
    v_mfma_f32_16x16x32_bf16 v[56:59], v[216:219], v[152:155], v[56:59]
    ds_read_b128 v[40:43], v55
    ds_read_b128 v[44:47], v55 offset:256
    v_cvt_pk_bf16_f32 v17, 0, v33
    v_cvt_pk_bf16_f32 v21, 0, v37
    v_mfma_f32_16x16x32_bf16 v[4:7], v[220:223], v[92:95], v[4:7]
    v_cvt_pk_bf16_f32 v18, 0, v34
    v_cvt_pk_bf16_f32 v22, 0, v38
    v_cvt_pk_bf16_f32 v19, 0, v35
    v_mfma_f32_16x16x32_bf16 v[56:59], v[220:223], v[156:159], v[56:59]
    v_cvt_pk_bf16_f32 v23, 0, v39
    v_mfma_f32_16x16x32_bf16 v[4:7], v[224:227], v[96:99], v[4:7]
    v_mfma_f32_16x16x32_bf16 v[56:59], v[224:227], v[160:163], v[56:59]
    s_waitcnt lgkmcnt(0)
    v_max3_f32 v40, v40, v41, v42
    v_mfma_f32_16x16x32_bf16 v[4:7], v[228:231], v[100:103], v[4:7]
    v_max3_f32 v44, v44, v45, v46
    v_max_f32 v40, v40, v43
    v_max_f32 v44, v44, v47
    v_cvt_pk_bf16_f32 v40, 0, v40
    v_mfma_f32_16x16x32_bf16 v[56:59], v[228:231], v[164:167], v[56:59]
    v_cvt_pk_bf16_f32 v44, 0, v44
    v_mul_f32 v40, s66, v40
    v_mul_f32 v44, s66, v44
    v_mfma_f32_16x16x32_bf16 v[4:7], v[232:235], v[104:107], v[4:7]
    v_cvt_pk_bf16_f32 v40, 0, v40
    v_cvt_pk_bf16_f32 v44, 0, v44
    s_cmp_lg_u32 s72, 0
    s_cbranch_scc1 p2_77
    v_mul_f32 v24, s67, v40
    v_mul_f32 v25, s67, v44
p2_77:
    v_mfma_f32_16x16x32_bf16 v[56:59], v[232:235], v[168:171], v[56:59]
    v_fma_f32 v32, v16, s67, -v24
    v_fma_f32 v36, v20, s67, -v25
    v_fma_f32 v33, v17, s67, -v24
    v_mfma_f32_16x16x32_bf16 v[4:7], v[236:239], v[108:111], v[4:7]
    v_fma_f32 v37, v21, s67, -v25
    v_fma_f32 v34, v18, s67, -v24
    v_fma_f32 v38, v22, s67, -v25
    v_fma_f32 v35, v19, s67, -v24
    v_mfma_f32_16x16x32_bf16 v[56:59], v[236:239], v[172:175], v[56:59]
    v_fma_f32 v39, v23, s67, -v25
    v_max3_f32 v28, v28, v32, v33
    v_max3_f32 v29, v29, v36, v37
    v_mfma_f32_16x16x32_bf16 v[4:7], v[240:243], v[112:115], v[4:7]
    v_max3_f32 v28, v28, v34, v35
    v_max3_f32 v29, v29, v38, v39
    v_exp_f32 v32, v32
    v_mfma_f32_16x16x32_bf16 v[56:59], v[240:243], v[176:179], v[56:59]
    v_exp_f32 v36, v36
    v_exp_f32 v33, v33
    v_exp_f32 v37, v37
    v_mfma_f32_16x16x32_bf16 v[4:7], v[244:247], v[116:119], v[4:7]
    v_exp_f32 v34, v34
    v_exp_f32 v38, v38
    v_exp_f32 v35, v35
    v_mfma_f32_16x16x32_bf16 v[56:59], v[244:247], v[180:183], v[56:59]
    v_exp_f32 v39, v39
    v_cvt_pk_bf16_f32 v60, v32, v33
    v_cvt_pk_bf16_f32 v62, v36, v37
    v_cvt_pk_bf16_f32 v61, v34, v35
    v_mfma_f32_16x16x32_bf16 v[4:7], v[248:251], v[120:123], v[4:7]
    v_cvt_pk_bf16_f32 v63, v38, v39
    v_permlane16_swap_b32 v60, v62
    s_nop 0
    v_permlane16_swap_b32 v61, v63
    v_mfma_f32_16x16x32_bf16 v[56:59], v[248:251], v[184:187], v[56:59]
    ds_write_b128 v30, v[60:63] offset:0
    v_add_f32 v32, v32, v33
    v_add_f32 v36, v36, v37
    v_mfma_f32_16x16x32_bf16 v[4:7], v[252:255], v[124:127], v[4:7]
    v_add_f32 v34, v34, v35
    v_add_f32 v38, v38, v39
    v_add_f32 v26, v26, v32
    v_mfma_f32_16x16x32_bf16 v[56:59], v[252:255], v[188:191], v[56:59]
    v_add_f32 v27, v27, v36
    v_add_f32 v26, v26, v34
    v_add_f32 v27, v27, v38
    s_waitcnt lgkmcnt(0)
    s_barrier
    ds_read_b128 v[192:195], v48 offset:0
    ds_read_b128 v[196:199], v49 offset:0
    ds_read_b128 v[200:203], v50 offset:0
    ds_read_b128 v[204:207], v51 offset:0
    ds_read_b128 v[208:211], v48 offset:256
    ds_read_b128 v[212:215], v49 offset:256
    s_waitcnt lgkmcnt(5)
    v_mfma_f32_16x16x32_bf16 v[8:11], v[192:195], v[64:67], 0
    v_cvt_pk_bf16_f32 v32, 0, v4
    v_cvt_pk_bf16_f32 v36, 0, v56
    v_cvt_pk_bf16_f32 v33, 0, v5
    v_mfma_f32_16x16x32_bf16 v[12:15], v[192:195], v[128:131], 0
    ds_read_b128 v[216:219], v50 offset:256
    v_cvt_pk_bf16_f32 v37, 0, v57
    v_cvt_pk_bf16_f32 v34, 0, v6
    s_waitcnt lgkmcnt(5)
    v_mfma_f32_16x16x32_bf16 v[8:11], v[196:199], v[68:71], v[8:11]
    v_cvt_pk_bf16_f32 v38, 0, v58
    v_cvt_pk_bf16_f32 v35, 0, v7
    v_mfma_f32_16x16x32_bf16 v[12:15], v[196:199], v[132:135], v[12:15]
    ds_read_b128 v[220:223], v51 offset:256
    v_cvt_pk_bf16_f32 v39, 0, v59
    v_mul_f32 v32, s66, v32
    s_waitcnt lgkmcnt(5)
    v_mfma_f32_16x16x32_bf16 v[8:11], v[200:203], v[72:75], v[8:11]
    v_mul_f32 v36, s66, v36
    v_mul_f32 v33, s66, v33
    v_mfma_f32_16x16x32_bf16 v[12:15], v[200:203], v[136:139], v[12:15]
    ds_read_b128 v[224:227], v48 offset:512
    v_mul_f32 v37, s66, v37
    v_mul_f32 v34, s66, v34
    s_waitcnt lgkmcnt(5)
    v_mfma_f32_16x16x32_bf16 v[8:11], v[204:207], v[76:79], v[8:11]
    v_mul_f32 v38, s66, v38
    v_mul_f32 v35, s66, v35
    v_mfma_f32_16x16x32_bf16 v[12:15], v[204:207], v[140:143], v[12:15]
    ds_read_b128 v[228:231], v49 offset:512
    v_mul_f32 v39, s66, v39
    v_cvt_pk_bf16_f32 v16, 0, v32
    s_waitcnt lgkmcnt(5)
    v_mfma_f32_16x16x32_bf16 v[8:11], v[208:211], v[80:83], v[8:11]
    v_cvt_pk_bf16_f32 v20, 0, v36
    v_cvt_pk_bf16_f32 v17, 0, v33
    v_mfma_f32_16x16x32_bf16 v[12:15], v[208:211], v[144:147], v[12:15]
    ds_read_b128 v[232:235], v50 offset:512
    v_cvt_pk_bf16_f32 v21, 0, v37
    v_cvt_pk_bf16_f32 v18, 0, v34
    v_cvt_pk_bf16_f32 v22, 0, v38
    s_waitcnt lgkmcnt(5)
    v_mfma_f32_16x16x32_bf16 v[8:11], v[212:215], v[84:87], v[8:11]
    v_cvt_pk_bf16_f32 v19, 0, v35
    v_cvt_pk_bf16_f32 v23, 0, v39
    v_mfma_f32_16x16x32_bf16 v[12:15], v[212:215], v[148:151], v[12:15]
    ds_read_b128 v[236:239], v51 offset:512
    v_fma_f32 v32, v16, s67, -v24
    v_fma_f32 v36, v20, s67, -v25
    s_waitcnt lgkmcnt(5)
    v_mfma_f32_16x16x32_bf16 v[8:11], v[216:219], v[88:91], v[8:11]
    v_fma_f32 v33, v17, s67, -v24
    v_fma_f32 v37, v21, s67, -v25
    v_mfma_f32_16x16x32_bf16 v[12:15], v[216:219], v[152:155], v[12:15]
    ds_read_b128 v[240:243], v48 offset:768
    v_fma_f32 v34, v18, s67, -v24
    v_fma_f32 v38, v22, s67, -v25
    s_waitcnt lgkmcnt(5)
    v_mfma_f32_16x16x32_bf16 v[8:11], v[220:223], v[92:95], v[8:11]
    v_fma_f32 v35, v19, s67, -v24
    v_fma_f32 v39, v23, s67, -v25
    v_mfma_f32_16x16x32_bf16 v[12:15], v[220:223], v[156:159], v[12:15]
    ds_read_b128 v[244:247], v49 offset:768
    v_max3_f32 v28, v28, v32, v33
    v_max3_f32 v29, v29, v36, v37
    s_waitcnt lgkmcnt(5)
    v_mfma_f32_16x16x32_bf16 v[8:11], v[224:227], v[96:99], v[8:11]
    v_max3_f32 v28, v28, v34, v35
    v_max3_f32 v29, v29, v38, v39
    v_mfma_f32_16x16x32_bf16 v[12:15], v[224:227], v[160:163], v[12:15]
    ds_read_b128 v[248:251], v50 offset:768
    v_exp_f32 v32, v32
    v_exp_f32 v36, v36
    s_waitcnt lgkmcnt(5)
    v_mfma_f32_16x16x32_bf16 v[8:11], v[228:231], v[100:103], v[8:11]
    v_exp_f32 v33, v33
    v_exp_f32 v37, v37
    v_exp_f32 v34, v34
    v_mfma_f32_16x16x32_bf16 v[12:15], v[228:231], v[164:167], v[12:15]
    ds_read_b128 v[252:255], v51 offset:768
    v_exp_f32 v38, v38
    v_exp_f32 v35, v35
    s_waitcnt lgkmcnt(5)
    v_mfma_f32_16x16x32_bf16 v[8:11], v[232:235], v[104:107], v[8:11]
    v_exp_f32 v39, v39
    v_cvt_pk_bf16_f32 v60, v32, v33
    v_mfma_f32_16x16x32_bf16 v[12:15], v[232:235], v[168:171], v[12:15]
    v_cvt_pk_bf16_f32 v62, v36, v37
    v_cvt_pk_bf16_f32 v61, v34, v35
    s_waitcnt lgkmcnt(4)
    v_mfma_f32_16x16x32_bf16 v[8:11], v[236:239], v[108:111], v[8:11]
    v_cvt_pk_bf16_f32 v63, v38, v39
    v_permlane16_swap_b32 v60, v62
    v_mfma_f32_16x16x32_bf16 v[12:15], v[236:239], v[172:175], v[12:15]
    v_permlane16_swap_b32 v61, v63
    ds_write_b128 v30, v[60:63] offset:4096
    s_waitcnt lgkmcnt(4)
    v_mfma_f32_16x16x32_bf16 v[8:11], v[240:243], v[112:115], v[8:11]
    v_add_f32 v32, v32, v33
    v_add_f32 v36, v36, v37
    v_mfma_f32_16x16x32_bf16 v[12:15], v[240:243], v[176:179], v[12:15]
    v_add_f32 v34, v34, v35
    v_add_f32 v38, v38, v39
    s_waitcnt lgkmcnt(3)
    v_mfma_f32_16x16x32_bf16 v[8:11], v[244:247], v[116:119], v[8:11]
    v_add_f32 v26, v26, v32
    v_add_f32 v27, v27, v36
    v_mfma_f32_16x16x32_bf16 v[12:15], v[244:247], v[180:183], v[12:15]
    v_add_f32 v26, v26, v34
    v_add_f32 v27, v27, v38
    s_waitcnt lgkmcnt(2)
    v_mfma_f32_16x16x32_bf16 v[8:11], v[248:251], v[120:123], v[8:11]
    v_mfma_f32_16x16x32_bf16 v[12:15], v[248:251], v[184:187], v[12:15]
    s_waitcnt lgkmcnt(1)
    v_mfma_f32_16x16x32_bf16 v[8:11], v[252:255], v[124:127], v[8:11]
    v_mfma_f32_16x16x32_bf16 v[12:15], v[252:255], v[188:191], v[12:15]
    s_waitcnt lgkmcnt(0)
    s_barrier
    s_getpc_b64 s[68:69]
pc_78:
    s_sub_u32 s68, s68, pc_78-adaLN_cond__compressed_kv_cla__dense_activation_relu__decode_kernel
    s_subb_u32 s69, s69, 0
    s_lshl_b32 s64, s56, 4
    s_add_u32 s64, s64, s54
    s_lshl_b32 s64, s64, 10
    s_cmp_ge_u32 s64, L_code_end-adaLN_cond__compressed_kv_cla__dense_activation_relu__decode_kernel
    s_cbranch_scc1 cpf_79
    s_min_u32 s64, s64, L_code_end-adaLN_cond__compressed_kv_cla__dense_activation_relu__decode_kernel-1024
    v_lshl_add_u32 v40, v0, 4, s64
    global_load_dword v52, v40, s[68:69]
cpf_79:
    v_cvt_pk_bf16_f32 v32, 0, v8
    v_cvt_pk_bf16_f32 v36, 0, v12
    v_cvt_pk_bf16_f32 v33, 0, v9
    v_cvt_pk_bf16_f32 v37, 0, v13
    v_cvt_pk_bf16_f32 v34, 0, v10
    v_cvt_pk_bf16_f32 v38, 0, v14
    v_cvt_pk_bf16_f32 v35, 0, v11
    v_cvt_pk_bf16_f32 v39, 0, v15
    v_mul_f32 v32, s66, v32
    v_mul_f32 v36, s66, v36
    v_mul_f32 v33, s66, v33
    v_mul_f32 v37, s66, v37
    v_mul_f32 v34, s66, v34
    v_mul_f32 v38, s66, v38
    v_mul_f32 v35, s66, v35
    v_mul_f32 v39, s66, v39
    v_cvt_pk_bf16_f32 v16, 0, v32
    v_cvt_pk_bf16_f32 v20, 0, v36
    v_cvt_pk_bf16_f32 v17, 0, v33
    v_cvt_pk_bf16_f32 v21, 0, v37
    v_cvt_pk_bf16_f32 v18, 0, v34
    v_cvt_pk_bf16_f32 v22, 0, v38
    v_cvt_pk_bf16_f32 v19, 0, v35
    v_cvt_pk_bf16_f32 v23, 0, v39
    v_fma_f32 v32, v16, s67, -v24
    v_fma_f32 v36, v20, s67, -v25
    v_fma_f32 v33, v17, s67, -v24
    v_fma_f32 v37, v21, s67, -v25
    v_fma_f32 v34, v18, s67, -v24
    v_fma_f32 v38, v22, s67, -v25
    v_fma_f32 v35, v19, s67, -v24
    v_fma_f32 v39, v23, s67, -v25
    v_max3_f32 v28, v28, v32, v33
    v_max3_f32 v29, v29, v36, v37
    v_max3_f32 v28, v28, v34, v35
    v_max3_f32 v29, v29, v38, v39
    v_exp_f32 v32, v32
    v_exp_f32 v36, v36
    v_exp_f32 v33, v33
    v_exp_f32 v37, v37
    v_exp_f32 v34, v34
    v_exp_f32 v38, v38
    v_exp_f32 v35, v35
    v_exp_f32 v39, v39
    v_cvt_pk_bf16_f32 v60, v32, v33
    v_cvt_pk_bf16_f32 v62, v36, v37
    v_cvt_pk_bf16_f32 v61, v34, v35
    v_cvt_pk_bf16_f32 v63, v38, v39
    v_permlane16_swap_b32 v60, v62
    s_nop 0
    v_permlane16_swap_b32 v61, v63
    ds_write_b128 v30, v[60:63] offset:0
    v_add_f32 v32, v32, v33
    v_add_f32 v36, v36, v37
    v_add_f32 v34, v34, v35
    v_add_f32 v38, v38, v39
    v_add_f32 v26, v26, v32
    v_add_f32 v27, v27, v36
    v_add_f32 v26, v26, v34
    v_add_f32 v27, v27, v38
    v_lshrrev_b32 v44, 1, v2
    v_lshlrev_b32 v44, 9, v44
    v_lshl_add_u32 v44, v1, 4, v44
    v_and_b32 v45, 1, v2
    v_lshl_add_u32 v44, v45, 3, v44
    s_and_b32 s64, s56, 1
    s_lshl_b32 s64, s64, 10
    s_lshr_b32 s68, s56, 1
    s_lshl_b32 s68, s68, 8
    s_add_u32 s64, s64, s68
    s_add_u32 s64, s64, 135168
    v_add_u32 v44, s64, v44
    v_and_b32 v48, 0xffff, v48
    v_and_b32 v49, 0xffff, v49
    v_and_b32 v50, 0xffff, v50
    v_and_b32 v51, 0xffff, v51
    s_waitcnt lgkmcnt(0)
    s_barrier
    v_lshlrev_b32 v40, 7, v3
    s_lshl_b32 s64, s55, 15
    buffer_load_dword v53, v40, s[24:27], s64 offen
    s_cmp_ge_u32 s56, 2
    s_cbranch_scc1 wi_80
    ds_read_b128 v[192:195], v48 offset:32768
    ds_read_b128 v[196:199], v49 offset:32768
    ds_read_b128 v[200:203], v50 offset:32768
    ds_read_b128 v[204:207], v51 offset:32768
    ds_read_b128 v[208:211], v48 offset:33024
    ds_read_b128 v[212:215], v49 offset:33024
    ds_read_b128 v[216:219], v50 offset:33024
    ds_read_b128 v[220:223], v51 offset:33024
    ds_read_b128 v[224:227], v48 offset:33280
    ds_read_b128 v[228:231], v49 offset:33280
    ds_read_b128 v[232:235], v50 offset:33280
    ds_read_b128 v[236:239], v51 offset:33280
    ds_read_b128 v[240:243], v48 offset:33536
    ds_read_b128 v[244:247], v49 offset:33536
    ds_read_b128 v[248:251], v50 offset:33536
    ds_read_b128 v[252:255], v51 offset:33536
    s_waitcnt lgkmcnt(15)
    v_mfma_f32_16x16x32_bf16 v[4:7], v[192:195], v[64:67], 0
    s_waitcnt lgkmcnt(14)
    v_mfma_f32_16x16x32_bf16 v[4:7], v[196:199], v[68:71], v[4:7]
    s_waitcnt lgkmcnt(13)
    v_mfma_f32_16x16x32_bf16 v[4:7], v[200:203], v[72:75], v[4:7]
    s_waitcnt lgkmcnt(12)
    v_mfma_f32_16x16x32_bf16 v[4:7], v[204:207], v[76:79], v[4:7]
    s_waitcnt lgkmcnt(11)
    v_mfma_f32_16x16x32_bf16 v[4:7], v[208:211], v[80:83], v[4:7]
    s_waitcnt lgkmcnt(10)
    v_mfma_f32_16x16x32_bf16 v[4:7], v[212:215], v[84:87], v[4:7]
    s_waitcnt lgkmcnt(9)
    v_mfma_f32_16x16x32_bf16 v[4:7], v[216:219], v[88:91], v[4:7]
    s_waitcnt lgkmcnt(8)
    v_mfma_f32_16x16x32_bf16 v[4:7], v[220:223], v[92:95], v[4:7]
    s_waitcnt lgkmcnt(7)
    v_mfma_f32_16x16x32_bf16 v[4:7], v[224:227], v[96:99], v[4:7]
    s_waitcnt lgkmcnt(6)
    v_mfma_f32_16x16x32_bf16 v[4:7], v[228:231], v[100:103], v[4:7]
    s_waitcnt lgkmcnt(5)
    v_mfma_f32_16x16x32_bf16 v[4:7], v[232:235], v[104:107], v[4:7]
    s_waitcnt lgkmcnt(4)
    v_mfma_f32_16x16x32_bf16 v[4:7], v[236:239], v[108:111], v[4:7]
    s_waitcnt lgkmcnt(3)
    v_mfma_f32_16x16x32_bf16 v[4:7], v[240:243], v[112:115], v[4:7]
    s_waitcnt lgkmcnt(2)
    v_mfma_f32_16x16x32_bf16 v[4:7], v[244:247], v[116:119], v[4:7]
    s_waitcnt lgkmcnt(1)
    v_mfma_f32_16x16x32_bf16 v[4:7], v[248:251], v[120:123], v[4:7]
    s_waitcnt lgkmcnt(0)
    v_mfma_f32_16x16x32_bf16 v[4:7], v[252:255], v[124:127], v[4:7]
    v_or_b32 v48, 0x10000, v48
    v_or_b32 v49, 0x10000, v49
    v_or_b32 v50, 0x10000, v50
    v_or_b32 v51, 0x10000, v51
    s_nop 3
    v_cvt_pk_bf16_f32 v32, 0, v4
    v_cvt_pk_bf16_f32 v33, 0, v5
    v_cvt_pk_bf16_f32 v34, 0, v6
    v_cvt_pk_bf16_f32 v35, 0, v7
    v_mul_f32 v32, s66, v32
    v_mul_f32 v33, s66, v33
    v_mul_f32 v34, s66, v34
    v_mul_f32 v35, s66, v35
    v_cvt_pk_bf16_f32 v16, 0, v32
    v_cvt_pk_bf16_f32 v17, 0, v33
    v_cvt_pk_bf16_f32 v18, 0, v34
    v_cvt_pk_bf16_f32 v19, 0, v35
    v_fma_f32 v32, v16, s67, -v24
    v_fma_f32 v33, v17, s67, -v24
    v_fma_f32 v34, v18, s67, -v24
    v_fma_f32 v35, v19, s67, -v24
    v_max3_f32 v28, v28, v32, v33
    v_max3_f32 v28, v28, v34, v35
    v_exp_f32 v32, v32
    v_exp_f32 v33, v33
    v_exp_f32 v34, v34
    v_exp_f32 v35, v35
    v_cvt_pk_bf16_f32 v60, v32, v33
    v_cvt_pk_bf16_f32 v61, v34, v35
    ds_write_b64 v44, v[60:61] offset:0
    v_add_f32 v32, v32, v33
    v_add_f32 v34, v34, v35
    v_add_f32 v26, v26, v32
    v_add_f32 v26, v26, v34
    s_waitcnt lgkmcnt(0)
    s_barrier
    s_or_b32 s64, s56, s72
    s_cbranch_scc1 noarr_82
    s_lshl_b32 s64, s52, 7
    s_add_u32 s64, s64, 114688
    v_mov_b32 v43, 1
    v_mov_b32 v40, 0
    s_mov_b32 exec_lo, 0x1
    s_mov_b32 exec_hi, 0x0
    buffer_atomic_add v43, v40, s[48:51], s64 offen sc0 sc1
    s_mov_b64 exec, -1
noarr_82:
    ds_read_b128 v[192:195], v48 offset:32768
    ds_read_b128 v[196:199], v49 offset:32768
    ds_read_b128 v[200:203], v50 offset:32768
    ds_read_b128 v[204:207], v51 offset:32768
    ds_read_b128 v[208:211], v48 offset:33024
    ds_read_b128 v[212:215], v49 offset:33024
    ds_read_b128 v[216:219], v50 offset:33024
    ds_read_b128 v[220:223], v51 offset:33024
    ds_read_b128 v[224:227], v48 offset:33280
    ds_read_b128 v[228:231], v49 offset:33280
    ds_read_b128 v[232:235], v50 offset:33280
    ds_read_b128 v[236:239], v51 offset:33280
    ds_read_b128 v[240:243], v48 offset:33536
    ds_read_b128 v[244:247], v49 offset:33536
    ds_read_b128 v[248:251], v50 offset:33536
    ds_read_b128 v[252:255], v51 offset:33536
    s_waitcnt lgkmcnt(15)
    v_mfma_f32_16x16x32_bf16 v[4:7], v[192:195], v[64:67], 0
    s_waitcnt lgkmcnt(14)
    v_mfma_f32_16x16x32_bf16 v[4:7], v[196:199], v[68:71], v[4:7]
    s_waitcnt lgkmcnt(13)
    v_mfma_f32_16x16x32_bf16 v[4:7], v[200:203], v[72:75], v[4:7]
    s_waitcnt lgkmcnt(12)
    v_mfma_f32_16x16x32_bf16 v[4:7], v[204:207], v[76:79], v[4:7]
    s_waitcnt lgkmcnt(11)
    v_mfma_f32_16x16x32_bf16 v[4:7], v[208:211], v[80:83], v[4:7]
    s_waitcnt lgkmcnt(10)
    v_mfma_f32_16x16x32_bf16 v[4:7], v[212:215], v[84:87], v[4:7]
    s_waitcnt lgkmcnt(9)
    v_mfma_f32_16x16x32_bf16 v[4:7], v[216:219], v[88:91], v[4:7]
    s_waitcnt lgkmcnt(8)
    v_mfma_f32_16x16x32_bf16 v[4:7], v[220:223], v[92:95], v[4:7]
    s_waitcnt lgkmcnt(7)
    v_mfma_f32_16x16x32_bf16 v[4:7], v[224:227], v[96:99], v[4:7]
    s_waitcnt lgkmcnt(6)
    v_mfma_f32_16x16x32_bf16 v[4:7], v[228:231], v[100:103], v[4:7]
    s_waitcnt lgkmcnt(5)
    v_mfma_f32_16x16x32_bf16 v[4:7], v[232:235], v[104:107], v[4:7]
    s_waitcnt lgkmcnt(4)
    v_mfma_f32_16x16x32_bf16 v[4:7], v[236:239], v[108:111], v[4:7]
    s_waitcnt lgkmcnt(3)
    v_mfma_f32_16x16x32_bf16 v[4:7], v[240:243], v[112:115], v[4:7]
    s_waitcnt lgkmcnt(2)
    v_mfma_f32_16x16x32_bf16 v[4:7], v[244:247], v[116:119], v[4:7]
    s_waitcnt lgkmcnt(1)
    v_mfma_f32_16x16x32_bf16 v[4:7], v[248:251], v[120:123], v[4:7]
    s_waitcnt lgkmcnt(0)
    v_mfma_f32_16x16x32_bf16 v[4:7], v[252:255], v[124:127], v[4:7]
    v_and_b32 v48, 0xffff, v48
    v_and_b32 v49, 0xffff, v49
    v_and_b32 v50, 0xffff, v50
    v_and_b32 v51, 0xffff, v51
    s_nop 3
    v_cvt_pk_bf16_f32 v32, 0, v4
    v_cvt_pk_bf16_f32 v33, 0, v5
    v_cvt_pk_bf16_f32 v34, 0, v6
    v_cvt_pk_bf16_f32 v35, 0, v7
    v_mul_f32 v32, s66, v32
    v_mul_f32 v33, s66, v33
    v_mul_f32 v34, s66, v34
    v_mul_f32 v35, s66, v35
    v_cvt_pk_bf16_f32 v16, 0, v32
    v_cvt_pk_bf16_f32 v17, 0, v33
    v_cvt_pk_bf16_f32 v18, 0, v34
    v_cvt_pk_bf16_f32 v19, 0, v35
    v_fma_f32 v32, v16, s67, -v24
    v_fma_f32 v33, v17, s67, -v24
    v_fma_f32 v34, v18, s67, -v24
    v_fma_f32 v35, v19, s67, -v24
    v_max3_f32 v28, v28, v32, v33
    v_max3_f32 v28, v28, v34, v35
    v_exp_f32 v32, v32
    v_exp_f32 v33, v33
    v_exp_f32 v34, v34
    v_exp_f32 v35, v35
    v_cvt_pk_bf16_f32 v60, v32, v33
    v_cvt_pk_bf16_f32 v61, v34, v35
    ds_write_b64 v44, v[60:61] offset:2048
    v_add_f32 v32, v32, v33
    v_add_f32 v34, v34, v35
    v_add_f32 v26, v26, v32
    v_add_f32 v26, v26, v34
    s_branch wd_81
wi_80:
    ds_read_b128 v[192:195], v48 offset:32768
    ds_read_b128 v[196:199], v49 offset:32768
    ds_read_b128 v[200:203], v50 offset:32768
    ds_read_b128 v[204:207], v51 offset:32768
    ds_read_b128 v[208:211], v48 offset:33024
    ds_read_b128 v[212:215], v49 offset:33024
    ds_read_b128 v[216:219], v50 offset:33024
    ds_read_b128 v[220:223], v51 offset:33024
    ds_read_b128 v[224:227], v48 offset:33280
    ds_read_b128 v[228:231], v49 offset:33280
    ds_read_b128 v[232:235], v50 offset:33280
    ds_read_b128 v[236:239], v51 offset:33280
    ds_read_b128 v[240:243], v48 offset:33536
    ds_read_b128 v[244:247], v49 offset:33536
    ds_read_b128 v[248:251], v50 offset:33536
    ds_read_b128 v[252:255], v51 offset:33536
    s_waitcnt lgkmcnt(15)
    v_mfma_f32_16x16x32_bf16 v[56:59], v[192:195], v[128:131], 0
    s_waitcnt lgkmcnt(14)
    v_mfma_f32_16x16x32_bf16 v[56:59], v[196:199], v[132:135], v[56:59]
    s_waitcnt lgkmcnt(13)
    v_mfma_f32_16x16x32_bf16 v[56:59], v[200:203], v[136:139], v[56:59]
    s_waitcnt lgkmcnt(12)
    v_mfma_f32_16x16x32_bf16 v[56:59], v[204:207], v[140:143], v[56:59]
    s_waitcnt lgkmcnt(11)
    v_mfma_f32_16x16x32_bf16 v[56:59], v[208:211], v[144:147], v[56:59]
    s_waitcnt lgkmcnt(10)
    v_mfma_f32_16x16x32_bf16 v[56:59], v[212:215], v[148:151], v[56:59]
    s_waitcnt lgkmcnt(9)
    v_mfma_f32_16x16x32_bf16 v[56:59], v[216:219], v[152:155], v[56:59]
    s_waitcnt lgkmcnt(8)
    v_mfma_f32_16x16x32_bf16 v[56:59], v[220:223], v[156:159], v[56:59]
    s_waitcnt lgkmcnt(7)
    v_mfma_f32_16x16x32_bf16 v[56:59], v[224:227], v[160:163], v[56:59]
    s_waitcnt lgkmcnt(6)
    v_mfma_f32_16x16x32_bf16 v[56:59], v[228:231], v[164:167], v[56:59]
    s_waitcnt lgkmcnt(5)
    v_mfma_f32_16x16x32_bf16 v[56:59], v[232:235], v[168:171], v[56:59]
    s_waitcnt lgkmcnt(4)
    v_mfma_f32_16x16x32_bf16 v[56:59], v[236:239], v[172:175], v[56:59]
    s_waitcnt lgkmcnt(3)
    v_mfma_f32_16x16x32_bf16 v[56:59], v[240:243], v[176:179], v[56:59]
    s_waitcnt lgkmcnt(2)
    v_mfma_f32_16x16x32_bf16 v[56:59], v[244:247], v[180:183], v[56:59]
    s_waitcnt lgkmcnt(1)
    v_mfma_f32_16x16x32_bf16 v[56:59], v[248:251], v[184:187], v[56:59]
    s_waitcnt lgkmcnt(0)
    v_mfma_f32_16x16x32_bf16 v[56:59], v[252:255], v[188:191], v[56:59]
    v_or_b32 v48, 0x10000, v48
    v_or_b32 v49, 0x10000, v49
    v_or_b32 v50, 0x10000, v50
    v_or_b32 v51, 0x10000, v51
    s_nop 3
    v_cvt_pk_bf16_f32 v36, 0, v56
    v_cvt_pk_bf16_f32 v37, 0, v57
    v_cvt_pk_bf16_f32 v38, 0, v58
    v_cvt_pk_bf16_f32 v39, 0, v59
    v_mul_f32 v36, s66, v36
    v_mul_f32 v37, s66, v37
    v_mul_f32 v38, s66, v38
    v_mul_f32 v39, s66, v39
    v_cvt_pk_bf16_f32 v20, 0, v36
    v_cvt_pk_bf16_f32 v21, 0, v37
    v_cvt_pk_bf16_f32 v22, 0, v38
    v_cvt_pk_bf16_f32 v23, 0, v39
    v_fma_f32 v36, v20, s67, -v25
    v_fma_f32 v37, v21, s67, -v25
    v_fma_f32 v38, v22, s67, -v25
    v_fma_f32 v39, v23, s67, -v25
    v_max3_f32 v29, v29, v36, v37
    v_max3_f32 v29, v29, v38, v39
    v_exp_f32 v36, v36
    v_exp_f32 v37, v37
    v_exp_f32 v38, v38
    v_exp_f32 v39, v39
    v_cvt_pk_bf16_f32 v62, v36, v37
    v_cvt_pk_bf16_f32 v63, v38, v39
    ds_write_b64 v44, v[62:63] offset:0
    v_add_f32 v36, v36, v37
    v_add_f32 v38, v38, v39
    v_add_f32 v27, v27, v36
    v_add_f32 v27, v27, v38
    s_waitcnt lgkmcnt(0)
    s_barrier
    ds_read_b128 v[192:195], v48 offset:32768
    ds_read_b128 v[196:199], v49 offset:32768
    ds_read_b128 v[200:203], v50 offset:32768
    ds_read_b128 v[204:207], v51 offset:32768
    ds_read_b128 v[208:211], v48 offset:33024
    ds_read_b128 v[212:215], v49 offset:33024
    ds_read_b128 v[216:219], v50 offset:33024
    ds_read_b128 v[220:223], v51 offset:33024
    ds_read_b128 v[224:227], v48 offset:33280
    ds_read_b128 v[228:231], v49 offset:33280
    ds_read_b128 v[232:235], v50 offset:33280
    ds_read_b128 v[236:239], v51 offset:33280
    ds_read_b128 v[240:243], v48 offset:33536
    ds_read_b128 v[244:247], v49 offset:33536
    ds_read_b128 v[248:251], v50 offset:33536
    ds_read_b128 v[252:255], v51 offset:33536
    s_waitcnt lgkmcnt(15)
    v_mfma_f32_16x16x32_bf16 v[56:59], v[192:195], v[128:131], 0
    s_waitcnt lgkmcnt(14)
    v_mfma_f32_16x16x32_bf16 v[56:59], v[196:199], v[132:135], v[56:59]
    s_waitcnt lgkmcnt(13)
    v_mfma_f32_16x16x32_bf16 v[56:59], v[200:203], v[136:139], v[56:59]
    s_waitcnt lgkmcnt(12)
    v_mfma_f32_16x16x32_bf16 v[56:59], v[204:207], v[140:143], v[56:59]
    s_waitcnt lgkmcnt(11)
    v_mfma_f32_16x16x32_bf16 v[56:59], v[208:211], v[144:147], v[56:59]
    s_waitcnt lgkmcnt(10)
    v_mfma_f32_16x16x32_bf16 v[56:59], v[212:215], v[148:151], v[56:59]
    s_waitcnt lgkmcnt(9)
    v_mfma_f32_16x16x32_bf16 v[56:59], v[216:219], v[152:155], v[56:59]
    s_waitcnt lgkmcnt(8)
    v_mfma_f32_16x16x32_bf16 v[56:59], v[220:223], v[156:159], v[56:59]
    s_waitcnt lgkmcnt(7)
    v_mfma_f32_16x16x32_bf16 v[56:59], v[224:227], v[160:163], v[56:59]
    s_waitcnt lgkmcnt(6)
    v_mfma_f32_16x16x32_bf16 v[56:59], v[228:231], v[164:167], v[56:59]
    s_waitcnt lgkmcnt(5)
    v_mfma_f32_16x16x32_bf16 v[56:59], v[232:235], v[168:171], v[56:59]
    s_waitcnt lgkmcnt(4)
    v_mfma_f32_16x16x32_bf16 v[56:59], v[236:239], v[172:175], v[56:59]
    s_waitcnt lgkmcnt(3)
    v_mfma_f32_16x16x32_bf16 v[56:59], v[240:243], v[176:179], v[56:59]
    s_waitcnt lgkmcnt(2)
    v_mfma_f32_16x16x32_bf16 v[56:59], v[244:247], v[180:183], v[56:59]
    s_waitcnt lgkmcnt(1)
    v_mfma_f32_16x16x32_bf16 v[56:59], v[248:251], v[184:187], v[56:59]
    s_waitcnt lgkmcnt(0)
    v_mfma_f32_16x16x32_bf16 v[56:59], v[252:255], v[188:191], v[56:59]
    s_nop 7
    v_cvt_pk_bf16_f32 v36, 0, v56
    v_cvt_pk_bf16_f32 v37, 0, v57
    v_cvt_pk_bf16_f32 v38, 0, v58
    v_cvt_pk_bf16_f32 v39, 0, v59
    v_mul_f32 v36, s66, v36
    v_mul_f32 v37, s66, v37
    v_mul_f32 v38, s66, v38
    v_mul_f32 v39, s66, v39
    v_cvt_pk_bf16_f32 v20, 0, v36
    v_cvt_pk_bf16_f32 v21, 0, v37
    v_cvt_pk_bf16_f32 v22, 0, v38
    v_cvt_pk_bf16_f32 v23, 0, v39
    v_fma_f32 v36, v20, s67, -v25
    v_fma_f32 v37, v21, s67, -v25
    v_fma_f32 v38, v22, s67, -v25
    v_fma_f32 v39, v23, s67, -v25
    v_max3_f32 v29, v29, v36, v37
    v_max3_f32 v29, v29, v38, v39
    v_exp_f32 v36, v36
    v_exp_f32 v37, v37
    v_exp_f32 v38, v38
    v_exp_f32 v39, v39
    v_cvt_pk_bf16_f32 v62, v36, v37
    v_cvt_pk_bf16_f32 v63, v38, v39
    ds_write_b64 v44, v[62:63] offset:2048
    v_add_f32 v36, v36, v37
    v_add_f32 v38, v38, v39
    v_add_f32 v27, v27, v36
    v_add_f32 v27, v27, v38
wd_81:
    v_max_f32 v40, v28, v29
    v_cmp_lt_f32 vcc, s65, v40
    v_permlane16_swap_b32 v26, v27
    v_add_f32 v26, v26, v27
    v_mov_b32 v41, v26
    s_nop 1
    v_permlane32_swap_b32 v41, v26
    v_add_f32 v26, v26, v41
    v_subrev_u32 v42, 23552, v54
    ds_write_b32 v42, v26
    s_cbranch_vccz noflag_83
    s_cmp_lg_u32 s72, 0
    s_cbranch_scc1 noflag_83
    ds_write_b32 v31, v31
noflag_83:
    s_waitcnt lgkmcnt(0)
    s_barrier
    ds_read_b32 v39, v31
    v_and_b32 v42, -16, v42
    ds_read_b128 v[44:47], v42
    s_lshl_b32 s65, s55, 8
    s_add_u32 s65, s65, 65536
    v_lshlrev_b32 v40, 3, v0
    v_and_b32 v41, 1, v2
    v_cmp_eq_u32 vcc, 1, v41
    s_nop 1
    v_cndmask_b32 v32, v24, v25, vcc
    s_setprio 0
    s_waitcnt lgkmcnt(0)
    v_readfirstlane_b32 s64, v39
    v_add_f32 v44, v44, v45
    v_add_f32 v46, v46, v47
    v_add_f32 v33, v44, v46
    s_cmp_lg_u32 s64, 0
    s_cbranch_scc1 L_qk_redo
    s_cmp_lg_u32 s56, 0
    s_cbranch_scc1 wi_84
    s_mov_b32 exec_lo, 0xffffffff
    s_mov_b32 exec_hi, 0x0
    buffer_store_dwordx2 v[32:33], v40, s[48:51], s65 offen sc1
    s_mov_b64 exec, -1
wi_84:
    s_barrier
    s_or_b32 s68, s56, s72
    s_cbranch_scc1 noring_86
    v_lshlrev_b32 v35, 10, v0
    v_mov_b32 v36, s57
    s_lshl_b32 s69, s52, 7
    s_add_u32 s69, s69, 1572864
    s_waitcnt vmcnt(1)
    v_readfirstlane_b32 s68, v43
    s_cmp_lg_u32 s68, 14
    s_cbranch_scc1 noring_86
    s_mov_b32 exec_lo, 0xffffffff
    s_mov_b32 exec_hi, 0x0
    buffer_store_dword v36, v35, s[48:51], s69 offen sc1
    s_mov_b64 exec, -1
noring_86:
    s_branch L_att_post
L_qk_redo:
    s_or_b32 s68, s56, s72
    s_cbranch_scc1 noring_87
    v_lshlrev_b32 v35, 10, v0
    v_mov_b32 v36, s57
    s_lshl_b32 s69, s52, 7
    s_add_u32 s69, s69, 1572864
    s_waitcnt vmcnt(0)
    v_readfirstlane_b32 s68, v43
    s_cmp_lg_u32 s68, 14
    s_cbranch_scc1 noring_87
    s_mov_b32 exec_lo, 0xffffffff
    s_mov_b32 exec_hi, 0x0
    buffer_store_dword v36, v35, s[48:51], s69 offen sc1
    s_mov_b64 exec, -1
noring_87:
    s_waitcnt vmcnt(0)
    v_lshlrev_b32 v53, 4, v0
    v_add_u32 v53, 131072, v53
    v_permlane16_swap_b32 v28, v29
    v_max_f32 v28, v28, v29
    v_mov_b32 v41, v28
    s_nop 1
    v_permlane32_swap_b32 v41, v28
    v_max_f32 v28, v28, v41
    ds_write_b32 v54, v28
    s_waitcnt lgkmcnt(0)
    s_barrier
    ds_read_b128 v[40:43], v55
    ds_read_b128 v[44:47], v55 offset:256
    s_waitcnt lgkmcnt(0)
    v_max3_f32 v40, v40, v41, v42
    v_max_f32 v40, v40, v43
    v_add_f32 v24, v24, v40
    v_max3_f32 v44, v44, v45, v46
    v_max_f32 v44, v44, v47
    v_add_f32 v25, v25, v44
    s_mov_b32 s72, 1
    s_branch L_qk_start
L_att_post:
    s_barrier
    s_cmp_ge_u32 s56, 4
    s_cbranch_scc1 wi_88
    s_cmp_ge_u32 s56, 2
    s_cbranch_scc1 wi_90
    v_and_b32 v40, 31, v3
    v_mul_u32_u24 v40, 3584, v40
    v_lshrrev_b32 v41, 5, v3
    v_lshl_add_u32 v40, v41, 7, v40
    s_mul_i32 s64, s54, 114688
    s_mul_i32 s68, s52, 448
    s_add_u32 s64, s64, s68
    buffer_load_dword v52, v40, s[28:31], s64 offen offset:60
    s_branch wd_91
wi_90:
    v_subrev_u32 v40, 128, v3
    v_min_u32 v40, 111, v40
    v_lshlrev_b32 v40, 7, v40
    s_mul_i32 s64, s55, 14336
    buffer_load_dword v52, v40, s[32:35], s64 offen
wd_91:
wi_88:
    s_cmp_ge_u32 s54, 14
    s_cbranch_scc1 L_fin
    s_lshr_b32 s68, s54, 1
    s_mul_i32 s65, s52, 7
    s_add_u32 s68, s68, s65
    s_and_b32 s69, s54, 1
    v_lshrrev_b32 v44, 2, v0
    v_mul_u32_u24 v44, 3584, v44
    v_and_b32 v45, 3, v0
    v_lshrrev_b32 v32, 5, v0
    v_lshlrev_b32 v32, 1, v32
    v_xor_b32 v45, v45, v32
    v_lshl_add_u32 v44, v45, 4, v44
    v_lshlrev_b32 v32, 4, v0
    s_lshl_b32 s64, s68, 6
    s_mul_i32 s65, s56, 229376
    s_add_u32 s64, s64, s65
    s_lshl_b32 s65, s56, 12
    s_add_u32 s66, s65, 32768
    s_barrier
    s_mov_b32 m0, s66
    s_nop 0
    buffer_load_dwordx4 v44, s[28:31], s64 offen  lds
    s_add_u32 s64, s64, 57344
    s_add_u32 s66, s66, 1024
    s_mov_b32 m0, s66
    s_nop 0
    buffer_load_dwordx4 v44, s[28:31], s64 offen  lds
    s_add_u32 s64, s64, 57344
    s_add_u32 s66, s66, 1024
    s_mov_b32 m0, s66
    s_nop 0
    buffer_load_dwordx4 v44, s[28:31], s64 offen  lds
    s_add_u32 s64, s64, 57344
    s_add_u32 s66, s66, 1024
    s_mov_b32 m0, s66
    s_nop 0
    buffer_load_dwordx4 v44, s[28:31], s64 offen  lds
    s_cmp_lt_u32 s56, 4
    s_cbranch_scc1 wi_92
    s_mov_b32 s78, s69
    s_lshl_b32 s69, s79, 13
    s_min_u32 s64, s54, 13
    s_lshr_b32 s64, s64, 1
    s_mul_i32 s65, s52, 7
    s_add_u32 s64, s64, s65
    s_lshl_b32 s64, s64, 15
    s_add_u32 s64, s64, s69
    s_add_u32 s64, s64, 0
    s_add_u32 m0, s69, 0
    v_lshlrev_b32 v43, 4, v0
    s_and_b32 s65, s56, 1
    s_lshl_b32 s65, s65, 7
    v_xor_b32 v43, s65, v43
    v_xor_b32 v46, 0, v43
    buffer_load_dwordx4 v46, s[32:35], s64 offen offset:0  lds
    v_xor_b32 v46, 32, v43
    buffer_load_dwordx4 v46, s[32:35], s64 offen offset:1024  lds
    v_xor_b32 v46, 64, v43
    buffer_load_dwordx4 v46, s[32:35], s64 offen offset:2048  lds
    v_xor_b32 v46, 96, v43
    buffer_load_dwordx4 v46, s[32:35], s64 offen offset:3072  lds
    s_min_u32 s64, s54, 13
    s_lshr_b32 s64, s64, 1
    s_mul_i32 s65, s52, 7
    s_add_u32 s64, s64, s65
    s_lshl_b32 s64, s64, 15
    s_add_u32 s64, s64, s69
    s_add_u32 s64, s64, 4096
    s_add_u32 m0, s69, 4096
    v_lshlrev_b32 v43, 4, v0
    s_and_b32 s65, s56, 1
    s_lshl_b32 s65, s65, 7
    v_xor_b32 v43, s65, v43
    v_xor_b32 v46, 0, v43
    buffer_load_dwordx4 v46, s[32:35], s64 offen offset:0  lds
    v_xor_b32 v46, 32, v43
    buffer_load_dwordx4 v46, s[32:35], s64 offen offset:1024  lds
    v_xor_b32 v46, 64, v43
    buffer_load_dwordx4 v46, s[32:35], s64 offen offset:2048  lds
    v_xor_b32 v46, 96, v43
    buffer_load_dwordx4 v46, s[32:35], s64 offen offset:3072  lds
    s_mov_b32 s69, s78
wi_92:
    v_and_b32 v38, 3, v1
    s_lshl_b32 s64, s69, 12
    s_lshl_b32 s65, s56, 9
    s_add_u32 s65, s65, s64
    v_and_b32 v33, 31, v0
    v_lshlrev_b32 v33, 4, v33
    v_lshrrev_b32 v34, 5, v0
    v_lshl_add_u32 v33, v34, 3, v33
    buffer_load_dwordx2 v[40:41], v33, s[4:7], s65 offen
    s_add_u32 s65, s65, 32768
    s_add_u32 s66, s65, 8192
    s_add_u32 s67, s65, 16384
    s_mov_b32 s63, 60000
poll_94:
    buffer_load_dwordx2 v[44:45], v33, s[48:51], s65 offen sc1
    buffer_load_dwordx2 v[46:47], v33, s[48:51], s66 offen sc1
    buffer_load_dwordx2 v[48:49], v33, s[48:51], s67 offen sc1
    s_waitcnt vmcnt(0)
    v_max3_u32 v56, v44, v45, v46
    v_max3_u32 v56, v56, v47, v48
    v_max_u32 v56, v56, v49
    v_cmp_eq_u32 vcc, -1, v56
    s_cbranch_vccz pdone_95
    s_sleep 1
    s_sub_u32 s63, s63, 1
    s_cbranch_scc0 poll_94
pdone_95:
    s_lshr_b32 s64, s56, 1
    s_and_b32 s65, s56, 1
    s_mul_i32 s66, s64, 1040
    s_lshl_b32 s67, s65, 9
    s_add_u32 s66, s66, s67
    s_add_u32 s66, s66, 139264
    v_add_u32 v39, s66, v33
    ds_write_b64 v39, v[48:49] offset:4160
    ds_write_b64 v39, v[46:47] offset:8320
    v_lshlrev_b32 v160, 16, v40
    v_and_b32 v161, 0xffff0000, v40
    v_lshlrev_b32 v162, 16, v41
    v_and_b32 v163, 0xffff0000, v41
    v_lshlrev_b32 v164, 16, v44
    v_and_b32 v165, 0xffff0000, v44
    v_lshlrev_b32 v166, 16, v45
    v_and_b32 v167, 0xffff0000, v45
    v_lshlrev_b32 v168, 16, v48
    v_and_b32 v169, 0xffff0000, v48
    v_lshlrev_b32 v170, 16, v49
    v_and_b32 v171, 0xffff0000, v49
    s_waitcnt lgkmcnt(0)
    s_barrier
    v_lshrrev_b32 v34, 2, v1
    v_lshl_add_u32 v34, v2, 3, v34
    v_lshlrev_b32 v35, 6, v34
    v_lshl_add_u32 v35, v38, 3, v35
    v_and_b32 v36, 1, v2
    v_xor_b32 v36, s65, v36
    v_lshl_add_u32 v35, v36, 5, v35
    s_lshl_b32 s66, s64, 13
    v_add_u32 v35, s66, v35
    ds_read_b64_tr_b16 v[128:129], v35 offset:32768
    ds_read_b64_tr_b16 v[130:131], v35 offset:33024
    ds_read_b64_tr_b16 v[132:133], v35 offset:34816
    ds_read_b64_tr_b16 v[134:135], v35 offset:35072
    ds_read_b64_tr_b16 v[136:137], v35 offset:36864
    ds_read_b64_tr_b16 v[138:139], v35 offset:37120
    ds_read_b64_tr_b16 v[140:141], v35 offset:38912
    ds_read_b64_tr_b16 v[142:143], v35 offset:39168
    v_lshlrev_b32 v35, 10, v34
    v_lshl_add_u32 v35, v38, 3, v35
    v_lshrrev_b32 v36, 2, v1
    v_and_b32 v37, 1, v2
    v_lshl_add_u32 v36, v37, 2, v36
    s_and_b32 s66, s56, 3
    s_lshl_b32 s66, s66, 3
    v_xor_b32 v36, s66, v36
    v_lshl_add_u32 v35, v36, 5, v35
    v_xor_b32 v36, 0, v35
    ds_read_b64_tr_b16 v[192:193], v36 offset:0
    ds_read_b64_tr_b16 v[194:195], v36 offset:4096
    v_xor_b32 v36, 32, v35
    ds_read_b64_tr_b16 v[196:197], v36 offset:0
    ds_read_b64_tr_b16 v[198:199], v36 offset:4096
    v_xor_b32 v36, 64, v35
    ds_read_b64_tr_b16 v[200:201], v36 offset:0
    ds_read_b64_tr_b16 v[202:203], v36 offset:4096
    v_xor_b32 v36, 96, v35
    ds_read_b64_tr_b16 v[204:205], v36 offset:0
    ds_read_b64_tr_b16 v[206:207], v36 offset:4096
    v_xor_b32 v36, 128, v35
    ds_read_b64_tr_b16 v[208:209], v36 offset:0
    ds_read_b64_tr_b16 v[210:211], v36 offset:4096
    v_xor_b32 v36, 160, v35
    ds_read_b64_tr_b16 v[212:213], v36 offset:0
    ds_read_b64_tr_b16 v[214:215], v36 offset:4096
    v_xor_b32 v36, 192, v35
    ds_read_b64_tr_b16 v[216:217], v36 offset:0
    ds_read_b64_tr_b16 v[218:219], v36 offset:4096
    v_xor_b32 v36, 224, v35
    ds_read_b64_tr_b16 v[220:221], v36 offset:0
    ds_read_b64_tr_b16 v[222:223], v36 offset:4096
    v_and_b32 v42, 7, v1
    v_mul_u32_u24 v34, 1040, v42
    v_lshl_add_u32 v34, v2, 4, v34
    s_lshl_b32 s66, s64, 8
    s_add_u32 s66, s66, 139264
    v_add_u32 v34, s66, v34
    v_mul_u32_u24 v35, 144, v42
    v_lshl_add_u32 v35, v2, 4, v35
    s_mul_i32 s66, s64, 1216
    s_lshl_b32 s67, s65, 6
    s_add_u32 s66, s66, s67
    s_add_u32 s66, s66, 152576
    v_add_u32 v35, s66, v35
    v_lshrrev_b32 v36, 2, v1
    v_mul_u32_u24 v36, 1216, v36
    v_mul_u32_u24 v43, 144, v38
    v_add_u32 v36, v36, v43
    v_lshl_add_u32 v36, v2, 5, v36
    v_add_u32 v36, 152576, v36
    v_lshrrev_b32 v37, 1, v38
    v_mul_u32_u24 v37, 7168, v37
    v_and_b32 v43, 1, v38
    v_lshl_add_u32 v37, v43, 6, v37
    v_lshl_add_u32 v37, v2, 4, v37
    v_lshrrev_b32 v43, 2, v1
    v_mul_u32_u24 v43, 28672, v43
    v_add_u32 v37, v37, v43
    v_lshlrev_b32 v50, 4, v38
    v_add_u32 v50, 157696, v50
    s_lshl_b32 s66, s56, 3
    s_add_u32 s66, s66, 157696
    v_mov_b32 v51, s66
    ds_read_b128 v[64:67], v34 offset:4160
    ds_read_b128 v[68:71], v34 offset:4224
    ds_read_b128 v[72:75], v34 offset:4288
    ds_read_b128 v[76:79], v34 offset:4352
    s_waitcnt lgkmcnt(0)
    v_mfma_f32_16x16x32_bf16 v[80:83], v[128:131], v[64:67], 0
    v_mfma_f32_16x16x32_bf16 v[80:83], v[132:135], v[68:71], v[80:83]
    v_mfma_f32_16x16x32_bf16 v[80:83], v[136:139], v[72:75], v[80:83]
    v_mfma_f32_16x16x32_bf16 v[80:83], v[140:143], v[76:79], v[80:83]
    s_mov_b32 exec_lo, 0xff00ff
    s_mov_b32 exec_hi, 0xff00ff
    s_nop 5
    ds_write_b128 v35, v[80:83]
    s_mov_b64 exec, -1
    s_waitcnt lgkmcnt(0)
    s_barrier
    ds_read_b128 v[176:179], v36
    ds_read_b128 v[180:183], v36 offset:16
    ds_read_b128 v[184:187], v36 offset:576
    ds_read_b128 v[188:191], v36 offset:592
    s_lshl_b32 s66, s69, 15
    s_lshl_b32 s67, s64, 13
    s_add_u32 s66, s66, s67
    s_lshl_b32 s67, s65, 9
    s_add_u32 s66, s66, s67
    s_add_u32 s66, s66, 116736
    s_add_u32 s67, s66, 4096
    s_lshl_b32 s64, s56, 5
    s_lshl_b32 s65, s69, 1
    s_add_u32 s64, s64, s65
    s_mul_i32 s64, s64, 7168
    s_lshl_b32 s65, s68, 7
    s_add_u32 s64, s64, s65
    s_add_u32 s64, s64, 215040
    s_mov_b32 s65, 0xff
    v_lshrrev_b32 v40, 0, s57
    v_lshrrev_b32 v41, 8, s57
    v_lshrrev_b32 v42, 16, s57
    v_lshrrev_b32 v43, 24, s57
    s_waitcnt lgkmcnt(0)
    v_add_f32_dpp v176, v176, v176 row_ror:8 row_mask:0xf bank_mask:0xf
    v_add_f32_dpp v177, v177, v177 row_ror:8 row_mask:0xf bank_mask:0xf
    v_add_f32_dpp v178, v178, v178 row_ror:8 row_mask:0xf bank_mask:0xf
    v_add_f32_dpp v179, v179, v179 row_ror:8 row_mask:0xf bank_mask:0xf
    v_add_f32_dpp v180, v180, v180 row_ror:8 row_mask:0xf bank_mask:0xf
    v_add_f32_dpp v181, v181, v181 row_ror:8 row_mask:0xf bank_mask:0xf
    v_add_f32_dpp v182, v182, v182 row_ror:8 row_mask:0xf bank_mask:0xf
    v_add_f32_dpp v183, v183, v183 row_ror:8 row_mask:0xf bank_mask:0xf
    v_add_f32_dpp v184, v184, v184 row_ror:8 row_mask:0xf bank_mask:0xf
    v_add_f32_dpp v185, v185, v185 row_ror:8 row_mask:0xf bank_mask:0xf
    v_add_f32_dpp v186, v186, v186 row_ror:8 row_mask:0xf bank_mask:0xf
    v_add_f32_dpp v187, v187, v187 row_ror:8 row_mask:0xf bank_mask:0xf
    v_add_f32_dpp v188, v188, v188 row_ror:8 row_mask:0xf bank_mask:0xf
    v_add_f32_dpp v189, v189, v189 row_ror:8 row_mask:0xf bank_mask:0xf
    v_add_f32_dpp v190, v190, v190 row_ror:8 row_mask:0xf bank_mask:0xf
    v_add_f32_dpp v191, v191, v191 row_ror:8 row_mask:0xf bank_mask:0xf
    v_add_f32_dpp v176, v176, v176 row_ror:4 row_mask:0xf bank_mask:0xf
    v_add_f32_dpp v177, v177, v177 row_ror:4 row_mask:0xf bank_mask:0xf
    v_add_f32_dpp v178, v178, v178 row_ror:4 row_mask:0xf bank_mask:0xf
    v_add_f32_dpp v179, v179, v179 row_ror:4 row_mask:0xf bank_mask:0xf
    v_add_f32_dpp v180, v180, v180 row_ror:4 row_mask:0xf bank_mask:0xf
    v_add_f32_dpp v181, v181, v181 row_ror:4 row_mask:0xf bank_mask:0xf
    v_add_f32_dpp v182, v182, v182 row_ror:4 row_mask:0xf bank_mask:0xf
    v_add_f32_dpp v183, v183, v183 row_ror:4 row_mask:0xf bank_mask:0xf
    v_add_f32_dpp v184, v184, v184 row_ror:4 row_mask:0xf bank_mask:0xf
    v_add_f32_dpp v185, v185, v185 row_ror:4 row_mask:0xf bank_mask:0xf
    v_add_f32_dpp v186, v186, v186 row_ror:4 row_mask:0xf bank_mask:0xf
    v_add_f32_dpp v187, v187, v187 row_ror:4 row_mask:0xf bank_mask:0xf
    v_add_f32_dpp v188, v188, v188 row_ror:4 row_mask:0xf bank_mask:0xf
    v_add_f32_dpp v189, v189, v189 row_ror:4 row_mask:0xf bank_mask:0xf
    v_add_f32_dpp v190, v190, v190 row_ror:4 row_mask:0xf bank_mask:0xf
    v_add_f32_dpp v191, v191, v191 row_ror:4 row_mask:0xf bank_mask:0xf
    v_and_b32 v57, 31, v0
    v_lshlrev_b32 v57, 4, v57
    v_lshrrev_b32 v58, 5, v0
    v_lshl_add_u32 v57, v58, 12, v57
    s_cmp_lg_u32 s56, 0
    s_cbranch_scc1 nohw_96
    s_lshl_b32 s78, s55, 7
    s_add_u32 s78, s78, 182272
    s_mov_b32 s63, 60000
hw_97:
    s_load_dword s79, s[48:49], s78 glc
    s_waitcnt lgkmcnt(0)
    s_cmp_eq_u32 s79, s57
    s_cbranch_scc1 hd_98
    s_sub_u32 s63, s63, 1
    s_cbranch_scc0 hw_97
hd_98:
nohw_96:
    s_barrier
    s_mov_b32 s63, 60000
poll_99:
    buffer_load_dwordx4 v[64:67], v57, s[48:51], s66 offen offset:0 sc1
    buffer_load_dwordx4 v[68:71], v57, s[48:51], s66 offen offset:1024 sc1
    buffer_load_dwordx4 v[72:75], v57, s[48:51], s66 offen offset:2048 sc1
    buffer_load_dwordx4 v[76:79], v57, s[48:51], s66 offen offset:3072 sc1
    s_waitcnt vmcnt(0)
    v_max3_u32 v56, v64, v66, v68
    v_max3_u32 v56, v56, v70, v72
    v_max3_u32 v56, v56, v74, v76
    v_max_u32 v56, v56, v78
    v_cmp_eq_u32 vcc, -1, v56
    s_cbranch_vccz pdone_100
    s_sub_u32 s63, s63, 1
    s_cbranch_scc0 poll_99
pdone_100:
    s_cmp_lg_u32 s56, 6
    s_cbranch_scc1 nohint_101
    s_lshl_b32 s78, s55, 7
    s_add_u32 s78, s78, 198720
    v_mov_b32 v112, s57
    v_mov_b32 v113, 0
    s_mov_b32 exec_lo, 0x1
    s_mov_b32 exec_hi, 0x0
    buffer_store_dword v112, v113, s[48:51], s78 offen sc1
    s_mov_b64 exec, -1
nohint_101:
    v_lshlrev_b32 v80, 16, v64
    v_lshlrev_b32 v81, 16, v65
    v_lshlrev_b32 v82, 16, v66
    v_lshlrev_b32 v83, 16, v67
    v_lshlrev_b32 v84, 16, v68
    v_lshlrev_b32 v85, 16, v69
    v_lshlrev_b32 v86, 16, v70
    v_lshlrev_b32 v87, 16, v71
    v_lshlrev_b32 v88, 16, v72
    v_lshlrev_b32 v89, 16, v73
    v_lshlrev_b32 v90, 16, v74
    v_lshlrev_b32 v91, 16, v75
    v_lshlrev_b32 v92, 16, v76
    v_lshlrev_b32 v93, 16, v77
    v_lshlrev_b32 v94, 16, v78
    v_lshlrev_b32 v95, 16, v79
    v_pk_add_f32 v[64:65], v[64:65], v[72:73]
    v_pk_add_f32 v[66:67], v[66:67], v[74:75]
    v_pk_add_f32 v[68:69], v[68:69], v[76:77]
    v_pk_add_f32 v[70:71], v[70:71], v[78:79]
    v_pk_add_f32 v[80:81], v[80:81], v[88:89]
    v_pk_add_f32 v[82:83], v[82:83], v[90:91]
    v_pk_add_f32 v[84:85], v[84:85], v[92:93]
    v_pk_add_f32 v[86:87], v[86:87], v[94:95]
    v_pk_add_f32 v[64:65], v[64:65], v[68:69]
    v_pk_add_f32 v[66:67], v[66:67], v[70:71]
    v_pk_add_f32 v[80:81], v[80:81], v[84:85]
    v_pk_add_f32 v[82:83], v[82:83], v[86:87]
    s_nop 1
    v_permlane32_swap_b32 v80, v82
    v_permlane32_swap_b32 v81, v83
    v_permlane32_swap_b32 v64, v66
    v_permlane32_swap_b32 v65, v67
    v_pk_add_f32 v[68:69], v[80:81], v[82:83]
    v_pk_add_f32 v[64:65], v[64:65], v[66:67]
    v_fma_f32 v80, v68, v164, v160
    v_fma_f32 v81, v64, v165, v161
    v_fma_f32 v82, v69, v166, v162
    v_fma_f32 v83, v65, v167, v163
    v_mul_f32 v84, v80, v168
    v_mul_f32 v85, v81, v169
    v_mul_f32 v86, v82, v170
    v_mul_f32 v87, v83, v171
    v_cvt_pk_bf16_f32 v88, v84, v85
    v_cvt_pk_bf16_f32 v89, v86, v87
    ds_write_b64 v39, v[88:89]
    v_add_f32 v52, v80, v81
    v_mul_f32 v53, v80, v80
    v_add_f32 v54, v82, v83
    v_fmac_f32 v53, v81, v81
    v_add_f32 v52, v52, v54
    v_fmac_f32 v53, v82, v82
    v_fmac_f32 v53, v83, v83
    s_waitcnt lgkmcnt(0)
    s_barrier
    ds_read_b128 v[64:67], v34 offset:0
    ds_read_b128 v[68:71], v34 offset:64
    ds_read_b128 v[72:75], v34 offset:128
    ds_read_b128 v[76:79], v34 offset:192
    v_add_f32_dpp v52, v52, v52 row_ror:8 row_mask:0xf bank_mask:0xf
    v_add_f32_dpp v53, v53, v53 row_ror:8 row_mask:0xf bank_mask:0xf
    s_nop 0
    v_add_f32_dpp v52, v52, v52 row_ror:4 row_mask:0xf bank_mask:0xf
    v_add_f32_dpp v53, v53, v53 row_ror:4 row_mask:0xf bank_mask:0xf
    s_nop 0
    v_add_f32_dpp v52, v52, v52 row_ror:2 row_mask:0xf bank_mask:0xf
    v_add_f32_dpp v53, v53, v53 row_ror:2 row_mask:0xf bank_mask:0xf
    s_nop 0
    v_add_f32_dpp v52, v52, v52 row_ror:1 row_mask:0xf bank_mask:0xf
    v_add_f32_dpp v53, v53, v53 row_ror:1 row_mask:0xf bank_mask:0xf
    s_waitcnt lgkmcnt(3)
    v_mfma_f32_16x16x32_bf16 v[80:83], v[128:131], v[64:67], 0
    s_waitcnt lgkmcnt(2)
    v_mfma_f32_16x16x32_bf16 v[80:83], v[132:135], v[68:71], v[80:83]
    s_waitcnt lgkmcnt(1)
    v_mfma_f32_16x16x32_bf16 v[80:83], v[136:139], v[72:75], v[80:83]
    s_waitcnt lgkmcnt(0)
    v_mfma_f32_16x16x32_bf16 v[80:83], v[140:143], v[76:79], v[80:83]
    v_add_f32_dpp v52, v52, v52 row_bcast:15 row_mask:0xa bank_mask:0xf
    v_add_f32_dpp v53, v53, v53 row_bcast:15 row_mask:0xa bank_mask:0xf
    s_nop 0
    v_add_f32_dpp v52, v52, v52 row_bcast:31 row_mask:0xc bank_mask:0xf
    v_add_f32_dpp v53, v53, v53 row_bcast:31 row_mask:0xc bank_mask:0xf
    s_mov_b32 exec_lo, 0x0
    s_mov_b32 exec_hi, 0x80000000
    ds_write_b64 v51, v[52:53]
    s_mov_b32 exec_lo, 0xf000f
    s_mov_b32 exec_hi, 0xf000f
    ds_write_b128 v35, v[80:83]
    s_mov_b64 exec, -1
    s_waitcnt lgkmcnt(0)
    s_barrier
    s_cmp_ge_u32 s56, 4
    s_cbranch_scc1 L_fin
    s_add_u32 s66, s64, 114688
    ds_read_b128 v[52:55], v50
    ds_read_b128 v[64:67], v36
    ds_read_b128 v[68:71], v36 offset:16
    s_waitcnt lgkmcnt(2)
    v_add_f32 v52, v52, v54
    v_add_f32 v53, v53, v55
    v_mul_f32 v52, 0x3b000000, v52
    v_mul_f32 v53, 0x3b000000, v53
    v_fma_f32 v53, -v52, v52, v53
    v_max_f32 v53, 0, v53
    v_add_f32 v53, 0x3727c5ac, v53
    v_rsq_f32 v53, v53
    s_waitcnt lgkmcnt(0)
    v_add_f32_dpp v64, v64, v64 row_ror:8 row_mask:0xf bank_mask:0xf
    v_add_f32_dpp v65, v65, v65 row_ror:8 row_mask:0xf bank_mask:0xf
    v_add_f32_dpp v66, v66, v66 row_ror:8 row_mask:0xf bank_mask:0xf
    v_add_f32_dpp v67, v67, v67 row_ror:8 row_mask:0xf bank_mask:0xf
    v_add_f32_dpp v68, v68, v68 row_ror:8 row_mask:0xf bank_mask:0xf
    v_add_f32_dpp v69, v69, v69 row_ror:8 row_mask:0xf bank_mask:0xf
    v_add_f32_dpp v70, v70, v70 row_ror:8 row_mask:0xf bank_mask:0xf
    v_add_f32_dpp v71, v71, v71 row_ror:8 row_mask:0xf bank_mask:0xf
    v_add_f32_dpp v64, v64, v64 row_ror:4 row_mask:0xf bank_mask:0xf
    v_add_f32_dpp v65, v65, v65 row_ror:4 row_mask:0xf bank_mask:0xf
    v_add_f32_dpp v66, v66, v66 row_ror:4 row_mask:0xf bank_mask:0xf
    v_add_f32_dpp v67, v67, v67 row_ror:4 row_mask:0xf bank_mask:0xf
    v_add_f32_dpp v68, v68, v68 row_ror:4 row_mask:0xf bank_mask:0xf
    v_add_f32_dpp v69, v69, v69 row_ror:4 row_mask:0xf bank_mask:0xf
    v_add_f32_dpp v70, v70, v70 row_ror:4 row_mask:0xf bank_mask:0xf
    v_add_f32_dpp v71, v71, v71 row_ror:4 row_mask:0xf bank_mask:0xf
    v_mov_b32 v54, v53
    v_mov_b32 v55, v53
    v_sub_f32 v52, 0, v52
    v_mov_b32 v53, v52
    v_pk_fma_f32 v[64:65], v[52:53], v[176:177], v[64:65]
    v_pk_fma_f32 v[66:67], v[52:53], v[178:179], v[66:67]
    v_pk_fma_f32 v[68:69], v[52:53], v[180:181], v[68:69]
    v_pk_fma_f32 v[70:71], v[52:53], v[182:183], v[70:71]
    v_pk_fma_f32 v[64:65], v[54:55], v[64:65], v[184:185]
    v_pk_fma_f32 v[66:67], v[54:55], v[66:67], v[186:187]
    v_pk_fma_f32 v[68:69], v[54:55], v[68:69], v[188:189]
    v_pk_fma_f32 v[70:71], v[54:55], v[70:71], v[190:191]
    v_cvt_pk_bf16_f32 v72, v64, v65
    v_cvt_pk_bf16_f32 v73, v66, v67
    v_cvt_pk_bf16_f32 v74, v68, v69
    v_cvt_pk_bf16_f32 v75, v70, v71
    v_pk_max_i16 v72, v72, 0
    v_pk_max_i16 v73, v73, 0
    v_pk_max_i16 v74, v74, 0
    v_pk_max_i16 v75, v75, 0
    s_nop 1
    v_mfma_f32_16x16x32_bf16 v[80:83], v[192:195], v[72:75], 0
    v_mfma_f32_16x16x32_bf16 v[84:87], v[196:199], v[72:75], 0
    v_mfma_f32_16x16x32_bf16 v[88:91], v[200:203], v[72:75], 0
    v_mfma_f32_16x16x32_bf16 v[92:95], v[204:207], v[72:75], 0
    v_mfma_f32_16x16x32_bf16 v[96:99], v[208:211], v[72:75], 0
    v_mfma_f32_16x16x32_bf16 v[100:103], v[212:215], v[72:75], 0
    v_mfma_f32_16x16x32_bf16 v[104:107], v[216:219], v[72:75], 0
    v_mfma_f32_16x16x32_bf16 v[108:111], v[220:223], v[72:75], 0
    s_nop 1
    v_mov_b32_dpp v80, v84 quad_perm:[0,1,2,3] row_mask:0xf bank_mask:0x2
    v_mov_b32_dpp v81, v85 quad_perm:[0,1,2,3] row_mask:0xf bank_mask:0x2
    v_mov_b32_dpp v82, v86 quad_perm:[0,1,2,3] row_mask:0xf bank_mask:0x2
    v_mov_b32_dpp v83, v87 quad_perm:[0,1,2,3] row_mask:0xf bank_mask:0x2
    v_mov_b32_dpp v80, v88 quad_perm:[0,1,2,3] row_mask:0xf bank_mask:0x4
    v_mov_b32_dpp v81, v89 quad_perm:[0,1,2,3] row_mask:0xf bank_mask:0x4
    v_mov_b32_dpp v82, v90 quad_perm:[0,1,2,3] row_mask:0xf bank_mask:0x4
    v_mov_b32_dpp v83, v91 quad_perm:[0,1,2,3] row_mask:0xf bank_mask:0x4
    v_mov_b32_dpp v80, v92 quad_perm:[0,1,2,3] row_mask:0xf bank_mask:0x8
    v_mov_b32_dpp v81, v93 quad_perm:[0,1,2,3] row_mask:0xf bank_mask:0x8
    v_mov_b32_dpp v82, v94 quad_perm:[0,1,2,3] row_mask:0xf bank_mask:0x8
    v_mov_b32_dpp v83, v95 quad_perm:[0,1,2,3] row_mask:0xf bank_mask:0x8
    v_bfi_b32 v80, s65, v40, v80
    v_bfi_b32 v81, s65, v41, v81
    v_bfi_b32 v82, s65, v42, v82
    v_bfi_b32 v83, s65, v43, v83
    buffer_store_dwordx4 v[80:83], v37, s[48:51], s64 offen sc1
    v_mov_b32_dpp v96, v100 quad_perm:[0,1,2,3] row_mask:0xf bank_mask:0x2
    v_mov_b32_dpp v97, v101 quad_perm:[0,1,2,3] row_mask:0xf bank_mask:0x2
    v_mov_b32_dpp v98, v102 quad_perm:[0,1,2,3] row_mask:0xf bank_mask:0x2
    v_mov_b32_dpp v99, v103 quad_perm:[0,1,2,3] row_mask:0xf bank_mask:0x2
    v_mov_b32_dpp v96, v104 quad_perm:[0,1,2,3] row_mask:0xf bank_mask:0x4
    v_mov_b32_dpp v97, v105 quad_perm:[0,1,2,3] row_mask:0xf bank_mask:0x4
    v_mov_b32_dpp v98, v106 quad_perm:[0,1,2,3] row_mask:0xf bank_mask:0x4
    v_mov_b32_dpp v99, v107 quad_perm:[0,1,2,3] row_mask:0xf bank_mask:0x4
    v_mov_b32_dpp v96, v108 quad_perm:[0,1,2,3] row_mask:0xf bank_mask:0x8
    v_mov_b32_dpp v97, v109 quad_perm:[0,1,2,3] row_mask:0xf bank_mask:0x8
    v_mov_b32_dpp v98, v110 quad_perm:[0,1,2,3] row_mask:0xf bank_mask:0x8
    v_mov_b32_dpp v99, v111 quad_perm:[0,1,2,3] row_mask:0xf bank_mask:0x8
    v_bfi_b32 v96, s65, v40, v96
    v_bfi_b32 v97, s65, v41, v97
    v_bfi_b32 v98, s65, v42, v98
    v_bfi_b32 v99, s65, v43, v99
    buffer_store_dwordx4 v[96:99], v37, s[48:51], s66 offen sc1
    s_cmp_lg_u32 s56, 0
    s_cbranch_scc1 nohint_102
    s_lshl_b32 s78, s55, 7
    s_add_u32 s78, s78, 198656
    v_mov_b32 v112, s57
    v_mov_b32 v113, 0
    s_mov_b32 exec_lo, 0x1
    s_mov_b32 exec_hi, 0x0
    buffer_store_dword v112, v113, s[48:51], s78 offen sc1
    s_mov_b64 exec, -1
nohint_102:
L_fin:
L_end:
    s_endpgm
L_code_end:
.section .rodata,"a"
.p2align 6
.amdhsa_kernel adaLN_cond__compressed_kv_cla__dense_activation_relu__decode_kernel
  .amdhsa_next_free_vgpr 256
  .amdhsa_next_free_sgpr 102
  .amdhsa_accum_offset 256
  .amdhsa_group_segment_fixed_size 0
  .amdhsa_kernarg_size 112
  .amdhsa_user_sgpr_count 2
  .amdhsa_user_sgpr_kernarg_segment_ptr 1
  .amdhsa_system_sgpr_workgroup_id_x 1
.end_amdhsa_kernel
```

```asm
; @launch grid=(256,1,1) block=(512,1,1) lds=163840
.amdgcn_target "amdgcn-amd-amdhsa--gfx950"
.text
.globl adaLN_cond__compressed_kv_cla__dense_activation_relu__decode_kernel
.p2align 12
.p2align 8
.type adaLN_cond__compressed_kv_cla__dense_activation_relu__decode_kernel,@function
adaLN_cond__compressed_kv_cla__dense_activation_relu__decode_kernel:
    s_cmp_ge_u32 s2, 256
    s_cbranch_scc1 L_end
    s_load_dwordx2 s[36:37], s[0:1], 72
    s_load_dwordx2 s[40:41], s[0:1], 80
    s_load_dwordx2 s[48:49], s[0:1], 104
    s_load_dwordx2 s[8:9], s[0:1], 8
    s_load_dwordx2 s[4:5], s[0:1], 0
    s_load_dwordx2 s[12:13], s[0:1], 16
    s_load_dwordx2 s[16:17], s[0:1], 24
    v_mov_b32 v3, v0
    v_lshrrev_b32 v4, 6, v0
    v_and_b32 v0, 63, v0
    v_readfirstlane_b32 s56, v4
    v_and_b32 v1, 15, v0
    v_lshrrev_b32 v2, 4, v0
    s_and_b32 s52, s2, 7
    s_lshr_b32 s53, s2, 3
    s_and_b32 s54, s53, 15
    s_lshl_b32 s55, s52, 4
    s_add_u32 s55, s55, s54
    v_lshlrev_b32 v16, 4, v3
    s_mov_b32 s38, 8192
    s_mov_b32 s39, 0x00020000
    s_mov_b32 s42, 3145728
    s_mov_b32 s43, 0x00020000
    s_mov_b32 s50, 15728640
    s_mov_b32 s51, 0x00020000
    s_mov_b32 s6, 8192
    s_mov_b32 s7, 0x00020000
    v_and_b32 v4, 7, v1
    v_lshlrev_b32 v4, 10, v4
    v_lshrrev_b32 v5, 3, v1
    v_lshl_add_u32 v4, v5, 6, v4
    v_lshl_add_u32 v4, v2, 4, v4
    s_cmp_ge_u32 s53, 16
    s_cbranch_scc1 L_att0
    s_cmp_lg_u32 s56, 0
    s_cbranch_scc1 L_svc0
    s_and_b32 s61, s54, 3
    s_lshl_b32 s64, s61, 8
    v_lshrrev_b32 v5, 2, v0
    v_mul_u32_u24 v5, 6144, v5
    v_and_b32 v18, 3, v0
    v_lshrrev_b32 v17, 5, v0
    v_lshlrev_b32 v17, 1, v17
    v_xor_b32 v18, v18, v17
    v_lshl_add_u32 v5, v18, 4, v5
    s_lshr_b32 s66, s55, 2
    s_lshl_b32 s66, s66, 6
    s_mul_i32 s65, s61, 786432
    s_add_u32 s65, s65, s66
    s_mov_b32 m0, 131072
    v_mov_b32 v20, -1
    v_mov_b32 v21, -1
    v_mov_b32 v22, -1
    v_mov_b32 v23, -1
    s_lshl_b32 s68, s52, 18
    s_lshl_b32 s67, s54, 11
    s_add_u32 s68, s68, s67
    s_add_u32 s35, s68, s67
    s_add_u32 s35, s35, 2293760
    s_add_u32 s67, s68, 2097152
    s_mul_i32 s68, s55, 656
    s_add_u32 s68, s68, 32768
    v_add_u32 v17, s68, v16
    s_add_u32 s68, s35, 368
    v_min_u32 v18, 48, v0
    v_lshl_add_u32 v18, v18, 4, s68
    v_cmp_lt_u32 vcc, 40, v0
    s_nop 1
    v_cndmask_b32 v17, v17, v18, vcc
    s_waitcnt lgkmcnt(0)
    s_load_dword s57, s[48:49], 0
    buffer_load_dwordx4 v[40:43], v4, s[36:39], s64 offen
    buffer_load_dwordx4 v[44:47], v4, s[36:39], s64 offen offset:128
    buffer_load_dwordx4 v5, s[40:43], s65 offen  lds
    s_add_u32 s65, s65, 98304
    s_add_u32 m0, m0, 1024
    s_nop 0
    buffer_load_dwordx4 v5, s[40:43], s65 offen  lds
    s_add_u32 s65, s65, 98304
    s_add_u32 m0, m0, 1024
    s_nop 0
    buffer_load_dwordx4 v5, s[40:43], s65 offen  lds
    s_add_u32 s65, s65, 98304
    s_add_u32 m0, m0, 1024
    s_nop 0
    buffer_load_dwordx4 v5, s[40:43], s65 offen  lds
    s_add_u32 s65, s65, 98304
    s_add_u32 m0, m0, 1024
    s_nop 0
    buffer_load_dwordx4 v5, s[40:43], s65 offen  lds
    s_add_u32 s65, s65, 98304
    s_add_u32 m0, m0, 1024
    s_nop 0
    buffer_load_dwordx4 v5, s[40:43], s65 offen  lds
    s_add_u32 s65, s65, 98304
    s_add_u32 m0, m0, 1024
    s_nop 0
    buffer_load_dwordx4 v5, s[40:43], s65 offen  lds
    s_add_u32 s65, s65, 98304
    s_add_u32 m0, m0, 1024
    s_nop 0
    buffer_load_dwordx4 v5, s[40:43], s65 offen  lds
    buffer_store_dwordx4 v[20:23], v16, s[48:51], s67 offen sc1
    buffer_store_dwordx4 v[20:23], v16, s[48:51], s67 offen offset:1024 sc1
    buffer_store_dwordx4 v[20:23], v17, s[48:51], 0 offen sc1
    s_branch L_p1
L_svc0:
    v_lshlrev_b32 v17, 4, v0
    s_waitcnt lgkmcnt(0)
    s_load_dword s57, s[48:49], 0
    buffer_load_dwordx4 v[8:11], v16, s[4:7], 0 offen
    s_cmp_lg_u32 s56, 3
    s_cbranch_scc1 wi_1
    buffer_load_dwordx4 v[40:43], v17, s[4:7], 0 offen
wi_1:
    s_branch L_svc
L_att0:
    s_cmp_ge_u32 s56, 4
    s_cbranch_scc0 L_atq
    s_barrier
    s_barrier
    s_branch L_pv
L_atq:
    s_getpc_b64 s[64:65]
pc_3:
    s_sub_u32 s64, s64, pc_3-adaLN_cond__compressed_kv_cla__dense_activation_relu__decode_kernel
    s_subb_u32 s65, s65, 0
    s_lshl_b32 s66, s56, 4
    s_add_u32 s66, s66, s54
    s_lshl_b32 s66, s66, 10
    s_cmp_ge_u32 s66, L_code_end-adaLN_cond__compressed_kv_cla__dense_activation_relu__decode_kernel
    s_cbranch_scc1 cpf_4
    s_min_u32 s66, s66, L_code_end-adaLN_cond__compressed_kv_cla__dense_activation_relu__decode_kernel-1024
    v_lshl_add_u32 v32, v0, 4, s66
    global_load_dword v64, v32, s[64:65]
cpf_4:
    s_waitcnt lgkmcnt(0)
    s_mov_b32 s18, 4194304
    s_mov_b32 s19, 0x00020000
    v_lshrrev_b32 v33, 3, v3
    v_lshlrev_b32 v33, 13, v33
    v_and_b32 v34, 7, v0
    v_lshl_add_u32 v33, v34, 7, v33
    s_lshl_b32 s67, s54, 18
    s_lshl_b32 s68, s52, 10
    s_add_u32 s67, s67, s68
    s_mov_b32 s14, 4194304
    s_mov_b32 s15, 0x00020000
    s_mov_b32 exec_lo, 0xffffffff
    s_mov_b32 exec_hi, 0xffffffff
    s_waitcnt lgkmcnt(0)
    buffer_load_dword v69, v33, s[12:15], s67 offen
    s_mov_b64 exec, -1
    s_barrier
    s_mov_b32 exec_lo, 0xffffffff
    s_mov_b32 exec_hi, 0xffffffff
    buffer_load_dword v68, v33, s[16:19], s67 offen
    s_mov_b64 exec, -1
    s_lshl_b32 s66, s54, 12
    s_lshl_b32 s65, s52, 18
    s_add_u32 s66, s66, s65
    s_add_u32 s66, s66, 2162688
    buffer_load_dword v70, v16, s[48:51], s66 offen sc1
    s_barrier
    s_branch L_qk
L_p1:
    v_lshrrev_b32 v48, 2, v1
    v_lshl_add_u32 v48, v2, 3, v48
    v_lshlrev_b32 v48, 6, v48
    v_and_b32 v50, 3, v1
    v_lshl_add_u32 v48, v50, 3, v48
    v_and_b32 v50, 1, v2
    v_lshl_add_u32 v48, v50, 5, v48
    v_add_u32 v48, 131072, v48
    v_xor_b32 v49, 32, v48
    v_lshlrev_b32 v50, 6, v1
    v_lshl_add_u32 v50, v2, 4, v50
    s_waitcnt vmcnt(11)
    v_lshlrev_b32 v64, 16, v40
    v_and_b32 v65, 0xffff0000, v40
    v_lshlrev_b32 v66, 16, v41
    v_and_b32 v67, 0xffff0000, v41
    v_lshlrev_b32 v68, 16, v42
    v_and_b32 v69, 0xffff0000, v42
    v_lshlrev_b32 v70, 16, v43
    v_and_b32 v71, 0xffff0000, v43
    v_lshlrev_b32 v72, 16, v44
    v_and_b32 v73, 0xffff0000, v44
    v_lshlrev_b32 v74, 16, v45
    v_and_b32 v75, 0xffff0000, v45
    v_lshlrev_b32 v76, 16, v46
    v_and_b32 v77, 0xffff0000, v46
    v_lshlrev_b32 v78, 16, v47
    v_and_b32 v79, 0xffff0000, v47
    v_mul_f32 v80, 0xbfb8aa3b, v64
    v_mul_f32 v81, 0xbfb8aa3b, v65
    v_mul_f32 v82, 0xbfb8aa3b, v66
    v_mul_f32 v83, 0xbfb8aa3b, v67
    v_mul_f32 v84, 0xbfb8aa3b, v68
    v_mul_f32 v85, 0xbfb8aa3b, v69
    v_mul_f32 v86, 0xbfb8aa3b, v70
    v_mul_f32 v87, 0xbfb8aa3b, v71
    v_mul_f32 v88, 0xbfb8aa3b, v72
    v_mul_f32 v89, 0xbfb8aa3b, v73
    v_mul_f32 v90, 0xbfb8aa3b, v74
    v_mul_f32 v91, 0xbfb8aa3b, v75
    v_mul_f32 v92, 0xbfb8aa3b, v76
    v_mul_f32 v93, 0xbfb8aa3b, v77
    v_mul_f32 v94, 0xbfb8aa3b, v78
    v_mul_f32 v95, 0xbfb8aa3b, v79
    v_exp_f32 v80, v80
    v_exp_f32 v81, v81
    v_exp_f32 v82, v82
    v_exp_f32 v83, v83
    v_exp_f32 v84, v84
    v_exp_f32 v85, v85
    v_exp_f32 v86, v86
    v_exp_f32 v87, v87
    v_exp_f32 v88, v88
    v_exp_f32 v89, v89
    v_exp_f32 v90, v90
    v_exp_f32 v91, v91
    v_exp_f32 v92, v92
    v_exp_f32 v93, v93
    v_exp_f32 v94, v94
    v_exp_f32 v95, v95
    v_add_f32 v80, 1.0, v80
    v_add_f32 v81, 1.0, v81
    v_add_f32 v82, 1.0, v82
    v_add_f32 v83, 1.0, v83
    v_add_f32 v84, 1.0, v84
    v_add_f32 v85, 1.0, v85
    v_add_f32 v86, 1.0, v86
    v_add_f32 v87, 1.0, v87
    v_add_f32 v88, 1.0, v88
    v_add_f32 v89, 1.0, v89
    v_add_f32 v90, 1.0, v90
    v_add_f32 v91, 1.0, v91
    v_add_f32 v92, 1.0, v92
    v_add_f32 v93, 1.0, v93
    v_add_f32 v94, 1.0, v94
    v_add_f32 v95, 1.0, v95
    v_rcp_f32 v80, v80
    v_rcp_f32 v81, v81
    v_rcp_f32 v82, v82
    v_rcp_f32 v83, v83
    v_rcp_f32 v84, v84
    v_rcp_f32 v85, v85
    v_rcp_f32 v86, v86
    v_rcp_f32 v87, v87
    v_rcp_f32 v88, v88
    v_rcp_f32 v89, v89
    v_rcp_f32 v90, v90
    v_rcp_f32 v91, v91
    v_rcp_f32 v92, v92
    v_rcp_f32 v93, v93
    v_rcp_f32 v94, v94
    v_rcp_f32 v95, v95
    v_mul_f32 v64, v64, v80
    v_mul_f32 v65, v65, v81
    v_mul_f32 v66, v66, v82
    v_mul_f32 v67, v67, v83
    v_mul_f32 v68, v68, v84
    v_mul_f32 v69, v69, v85
    v_mul_f32 v70, v70, v86
    v_mul_f32 v71, v71, v87
    v_mul_f32 v72, v72, v88
    v_mul_f32 v73, v73, v89
    v_mul_f32 v74, v74, v90
    v_mul_f32 v75, v75, v91
    v_mul_f32 v76, v76, v92
    v_mul_f32 v77, v77, v93
    v_mul_f32 v78, v78, v94
    v_mul_f32 v79, v79, v95
    v_cvt_pk_bf16_f32 v52, v64, v65
    v_cvt_pk_bf16_f32 v53, v66, v67
    v_cvt_pk_bf16_f32 v54, v68, v69
    v_cvt_pk_bf16_f32 v55, v70, v71
    v_cvt_pk_bf16_f32 v56, v72, v73
    v_cvt_pk_bf16_f32 v57, v74, v75
    v_cvt_pk_bf16_f32 v58, v76, v77
    v_cvt_pk_bf16_f32 v59, v78, v79
    s_waitcnt lgkmcnt(0)
    ds_write_b128 v16, v[52:55] offset:45056
    ds_write_b128 v16, v[56:59] offset:46080
    s_mul_i32 s57, s57, 0x9e3779b1
    s_add_u32 s57, s57, 0x7f4a7c15
    s_getreg_b32 s28, hwreg(HW_REG_XCC_ID)
    s_not_b32 s67, s57
    s_xor_b32 s28, s67, s28
    v_bfe_u32 v12, s57, 0, 8
    v_bfe_u32 v13, s57, 8, 8
    v_bfe_u32 v14, s57, 16, 8
    v_bfe_u32 v15, s57, 24, 8
    s_mov_b32 s67, 0xff
    s_waitcnt lgkmcnt(0)
    s_waitcnt vmcnt(9)
    ds_read_b64_tr_b16 v[64:65], v48 offset:0
    ds_read_b64_tr_b16 v[66:67], v48 offset:256
    ds_read_b64_tr_b16 v[68:69], v49 offset:0
    ds_read_b64_tr_b16 v[70:71], v49 offset:256
    s_waitcnt vmcnt(7)
    ds_read_b64_tr_b16 v[72:73], v48 offset:2048
    ds_read_b64_tr_b16 v[74:75], v48 offset:2304
    ds_read_b64_tr_b16 v[76:77], v49 offset:2048
    ds_read_b64_tr_b16 v[78:79], v49 offset:2304
    s_waitcnt vmcnt(5)
    ds_read_b64_tr_b16 v[80:81], v48 offset:4096
    ds_read_b64_tr_b16 v[82:83], v48 offset:4352
    ds_read_b64_tr_b16 v[84:85], v49 offset:4096
    ds_read_b64_tr_b16 v[86:87], v49 offset:4352
    s_waitcnt vmcnt(3)
    ds_read_b64_tr_b16 v[88:89], v48 offset:6144
    ds_read_b64_tr_b16 v[90:91], v48 offset:6400
    ds_read_b64_tr_b16 v[92:93], v49 offset:6144
    ds_read_b64_tr_b16 v[94:95], v49 offset:6400
    s_waitcnt lgkmcnt(14)
    v_mfma_f32_16x16x32_bf16 v[96:99], v[64:67], v[52:55], 0
    s_waitcnt lgkmcnt(12)
    v_mfma_f32_16x16x32_bf16 v[104:107], v[68:71], v[52:55], 0
    s_waitcnt lgkmcnt(10)
    v_mfma_f32_16x16x32_bf16 v[100:103], v[72:75], v[52:55], 0
    s_waitcnt lgkmcnt(8)
    v_mfma_f32_16x16x32_bf16 v[108:111], v[76:79], v[52:55], 0
    s_waitcnt lgkmcnt(6)
    v_mfma_f32_16x16x32_bf16 v[96:99], v[80:83], v[56:59], v[96:99]
    s_waitcnt lgkmcnt(4)
    v_mfma_f32_16x16x32_bf16 v[104:107], v[84:87], v[56:59], v[104:107]
    s_waitcnt lgkmcnt(2)
    v_mfma_f32_16x16x32_bf16 v[100:103], v[88:91], v[56:59], v[100:103]
    s_waitcnt lgkmcnt(0)
    v_mfma_f32_16x16x32_bf16 v[108:111], v[92:95], v[56:59], v[108:111]
    s_nop 5
    v_add_f32_dpp v112, v100, v96 row_ror:8 row_mask:0xf bank_mask:0x3
    v_add_f32_dpp v113, v101, v97 row_ror:8 row_mask:0xf bank_mask:0x3
    v_add_f32_dpp v114, v102, v98 row_ror:8 row_mask:0xf bank_mask:0x3
    v_add_f32_dpp v115, v103, v99 row_ror:8 row_mask:0xf bank_mask:0x3
    v_add_f32_dpp v112, v104, v108 row_ror:8 row_mask:0xf bank_mask:0xc
    v_add_f32_dpp v113, v105, v109 row_ror:8 row_mask:0xf bank_mask:0xc
    v_add_f32_dpp v114, v106, v110 row_ror:8 row_mask:0xf bank_mask:0xc
    v_add_f32_dpp v115, v107, v111 row_ror:8 row_mask:0xf bank_mask:0xc
    v_bfi_b32 v112, s67, v12, v112
    v_bfi_b32 v113, s67, v13, v113
    v_bfi_b32 v114, s67, v14, v114
    v_bfi_b32 v115, s67, v15, v115
    s_waitcnt vmcnt(0)
    buffer_store_dwordx4 v[112:115], v50, s[48:51], s35 offen sc1
    v_mov_b32 v60, s57
    s_mov_b32 exec_lo, 0x1
    s_mov_b32 exec_hi, 0x0
    buffer_store_dword v60, v16, s[48:51], s35 offen offset:1024 sc1
    s_mov_b64 exec, -1
    s_barrier
L_svc:
    s_load_dwordx2 s[20:21], s[0:1], 32
    s_load_dwordx2 s[24:25], s[0:1], 40
    s_load_dwordx2 s[44:45], s[0:1], 88
    s_mov_b32 s22, 4194304
    s_mov_b32 s23, 0x00020000
    s_mov_b32 s26, 4194304
    s_mov_b32 s27, 0x00020000
    s_mov_b32 s46, 8192
    s_mov_b32 s47, 0x00020000
    s_mov_b32 s18, 4194304
    s_mov_b32 s19, 0x00020000
    s_mov_b32 s10, 33554432
    s_mov_b32 s11, 0x00020000
    s_lshr_b32 s60, s55, 2
    s_and_b32 s61, s54, 3
    v_lshlrev_b32 v29, 13, v2
    s_and_b32 s69, s56, 3
    s_lshl_b32 s67, s61, 20
    s_lshl_b32 s68, s69, 18
    s_add_u32 s67, s67, s68
    s_lshl_b32 s68, s60, 8
    s_add_u32 s67, s67, s68
    s_lshl_b32 s68, s69, 13
    s_mul_i32 s72, s52, 196608
    s_mul_i32 s73, s52, 229376
    s_mov_b32 s76, 0x05040100
    s_mov_b32 s77, 0x07060302
    v_lshrrev_b32 v17, 2, v1
    v_and_b32 v38, 3, v1
    v_lshl_add_u32 v28, v2, 3, v17
    v_lshlrev_b32 v36, 8, v28
    v_lshl_add_u32 v36, v38, 3, v36
    v_lshlrev_b32 v5, 7, v28
    v_lshl_add_u32 v5, v38, 3, v5
    v_bfe_u32 v28, v1, 3, 1
    v_lshl_add_u32 v5, v28, 5, v5
    v_and_b32 v37, 1, v2
    v_lshl_add_u32 v5, v37, 6, v5
    v_and_b32 v19, 7, v1
    v_lshlrev_b32 v95, 1, v37
    v_xor_b32 v95, v95, v19
    v_lshlrev_b32 v95, 4, v95
    v_lshl_add_u32 v37, v37, 2, v17
    v_xor_b32 v37, s56, v37
    v_lshl_add_u32 v36, v37, 5, v36
    s_lshl_b32 s66, s56, 5
    v_bfe_u32 v28, v0, 2, 3
    v_and_b32 v21, 3, v0
    v_lshrrev_b32 v22, 5, v0
    v_lshl_add_u32 v22, v21, 1, v22
    v_mul_u32_u24 v20, 272, v28
    v_lshl_add_u32 v20, v22, 2, v20
    v_add_u32 v20, s66, v20
    v_lshlrev_b32 v24, 10, v28
    v_lshl_add_u32 v24, v22, 2, v24
    s_lshl_b32 s64, s61, 8
    s_add_u32 s64, s64, s66
    v_add_u32 v21, s64, v24
    v_mul_u32_u24 v22, 272, v19
    v_lshrrev_b32 v28, 3, v1
    v_lshl_add_u32 v22, v28, 6, v22
    v_lshl_add_u32 v22, v2, 4, v22
    v_lshlrev_b32 v17, 3, v0
    v_lshlrev_b32 v23, 6, v19
    v_lshl_add_u32 v23, v2, 4, v23
    v_and_b32 v26, 31, v0
    v_lshlrev_b32 v26, 4, v26
    v_lshrrev_b32 v28, 5, v0
    v_lshl_add_u32 v39, v28, 12, v26
    v_lshl_add_u32 v26, v28, 12, v26
    v_add_u32 v27, 8192, v26
    v_lshrrev_b32 v32, 3, v0
    v_mul_u32_u24 v32, 6144, v32
    v_add_u32 v32, v32, v95
    v_xor_b32 v33, 64, v32
    s_lshl_b32 s64, s61, 2
    s_add_u32 s64, s64, s69
    s_mul_i32 s33, s64, 196608
    s_lshl_b32 s64, s60, 7
    s_add_u32 s33, s33, s64
    s_add_u32 s33, s33, 2048
    s_lshl_b32 s34, s69, 12
    s_add_u32 s34, s34, 139264
    s_lshl_b32 s64, s61, 18
    s_lshr_b32 s65, s56, 1
    s_lshl_b32 s65, s65, 14
    s_add_u32 s64, s64, s65
    s_and_b32 s65, s56, 1
    s_lshl_b32 s65, s65, 9
    s_add_u32 s64, s64, s65
    s_add_u32 s30, s64, 2293760
    s_add_u32 s31, s30, 1048576
    v_lshlrev_b32 v34, 7, v2
    s_lshl_b32 s29, s60, 9
    s_add_u32 s29, s29, 4096
    s_cmp_eq_u32 s56, 0
    s_cbranch_scc1 L_svc4
    s_waitcnt vmcnt(0)
    v_mov_b32 v44, v16
    s_cmp_eq_u32 s56, 3
    s_cselect_b32 s68, 1, 0
L_ln:
    v_lshlrev_b32 v96, 16, v8
    v_and_b32 v97, 0xffff0000, v8
    v_lshlrev_b32 v98, 16, v9
    v_and_b32 v99, 0xffff0000, v9
    v_lshlrev_b32 v100, 16, v10
    v_and_b32 v101, 0xffff0000, v10
    v_lshlrev_b32 v102, 16, v11
    v_and_b32 v103, 0xffff0000, v11
    v_readfirstlane_b32 s64, v96
    s_nop 1
    v_subrev_f32 v72, s64, v96
    v_subrev_f32 v73, s64, v97
    v_subrev_f32 v74, s64, v98
    v_subrev_f32 v75, s64, v99
    v_subrev_f32 v76, s64, v100
    v_subrev_f32 v77, s64, v101
    v_subrev_f32 v78, s64, v102
    v_subrev_f32 v79, s64, v103
    v_add_f32 v80, v72, v73
    v_mul_f32 v81, v72, v72
    v_fmac_f32 v81, v73, v73
    v_add_f32 v80, v80, v74
    v_fmac_f32 v81, v74, v74
    v_add_f32 v80, v80, v75
    v_fmac_f32 v81, v75, v75
    v_add_f32 v80, v80, v76
    v_fmac_f32 v81, v76, v76
    v_add_f32 v80, v80, v77
    v_fmac_f32 v81, v77, v77
    v_add_f32 v80, v80, v78
    v_fmac_f32 v81, v78, v78
    v_add_f32 v80, v80, v79
    v_fmac_f32 v81, v79, v79
    s_nop 0
    v_add_f32_dpp v80, v80, v80 row_ror:8 row_mask:0xf bank_mask:0xf
    v_add_f32_dpp v81, v81, v81 row_ror:8 row_mask:0xf bank_mask:0xf
    s_nop 0
    v_add_f32_dpp v80, v80, v80 row_ror:4 row_mask:0xf bank_mask:0xf
    v_add_f32_dpp v81, v81, v81 row_ror:4 row_mask:0xf bank_mask:0xf
    s_nop 0
    v_add_f32_dpp v80, v80, v80 row_ror:2 row_mask:0xf bank_mask:0xf
    v_add_f32_dpp v81, v81, v81 row_ror:2 row_mask:0xf bank_mask:0xf
    s_nop 0
    v_add_f32_dpp v80, v80, v80 row_ror:1 row_mask:0xf bank_mask:0xf
    v_add_f32_dpp v81, v81, v81 row_ror:1 row_mask:0xf bank_mask:0xf
    s_nop 0
    v_add_f32_dpp v80, v80, v80 row_bcast:15 row_mask:0xa bank_mask:0xf
    v_add_f32_dpp v81, v81, v81 row_bcast:15 row_mask:0xa bank_mask:0xf
    s_nop 0
    v_add_f32_dpp v80, v80, v80 row_bcast:31 row_mask:0xc bank_mask:0xf
    v_add_f32_dpp v81, v81, v81 row_bcast:31 row_mask:0xc bank_mask:0xf
    v_readlane_b32 s65, v80, 63
    v_readlane_b32 s66, v81, 63
    v_mov_b32 v72, 0x3b000000
    v_mul_f32 v73, s65, v72
    v_mul_f32 v74, s66, v72
    v_fma_f32 v74, -v73, v73, v74
    v_max_f32 v74, 0, v74
    v_add_f32 v73, s64, v73
    v_cvt_pk_bf16_f32 v73, 0, v73
    v_cvt_pk_bf16_f32 v74, 0, v74
    v_add_f32 v74, 0x3727c5ac, v74
    v_cvt_pk_bf16_f32 v74, 0, v74
    v_sqrt_f32 v74, v74
    v_sub_f32 v96, v96, v73
    v_sub_f32 v97, v97, v73
    v_sub_f32 v98, v98, v73
    v_sub_f32 v99, v99, v73
    v_sub_f32 v100, v100, v73
    v_sub_f32 v101, v101, v73
    v_sub_f32 v102, v102, v73
    v_sub_f32 v103, v103, v73
    v_cvt_pk_bf16_f32 v74, 0, v74
    v_rcp_f32 v74, v74
    v_cvt_pk_bf16_f32 v96, 0, v96
    v_cvt_pk_bf16_f32 v97, 0, v97
    v_cvt_pk_bf16_f32 v98, 0, v98
    v_cvt_pk_bf16_f32 v99, 0, v99
    v_cvt_pk_bf16_f32 v100, 0, v100
    v_cvt_pk_bf16_f32 v101, 0, v101
    v_cvt_pk_bf16_f32 v102, 0, v102
    v_cvt_pk_bf16_f32 v103, 0, v103
    v_mul_f32 v96, v96, v74
    v_mul_f32 v97, v97, v74
    v_mul_f32 v98, v98, v74
    v_mul_f32 v99, v99, v74
    v_mul_f32 v100, v100, v74
    v_mul_f32 v101, v101, v74
    v_mul_f32 v102, v102, v74
    v_mul_f32 v103, v103, v74
    v_cvt_pk_bf16_f32 v84, v96, v97
    v_cvt_pk_bf16_f32 v85, v98, v99
    v_cvt_pk_bf16_f32 v86, v100, v101
    v_cvt_pk_bf16_f32 v87, v102, v103
    ds_write_b128 v44, v[84:87] offset:32768
    v_mov_b32 v8, v40
    v_mov_b32 v9, v41
    v_mov_b32 v10, v42
    v_mov_b32 v11, v43
    v_lshlrev_b32 v44, 4, v0
    s_sub_u32 s68, s68, 1
    s_cbranch_scc0 L_ln
    s_waitcnt lgkmcnt(0)
    s_mul_i32 s57, s57, 0x9e3779b1
    s_add_u32 s57, s57, 0x7f4a7c15
    s_getreg_b32 s28, hwreg(HW_REG_XCC_ID)
    s_not_b32 s67, s57
    s_xor_b32 s28, s67, s28
    v_bfe_u32 v12, s57, 0, 8
    v_bfe_u32 v13, s57, 8, 8
    v_bfe_u32 v14, s57, 16, 8
    v_bfe_u32 v15, s57, 24, 8
    s_cmp_lt_u32 s56, 4
    s_cbranch_scc1 L_svc3
    s_mov_b32 s14, 4194304
    s_mov_b32 s15, 0x00020000
    s_lshr_b32 s60, s55, 2
    s_and_b32 s61, s54, 3
    v_lshlrev_b32 v29, 13, v2
    s_and_b32 s69, s56, 3
    s_lshl_b32 s67, s61, 20
    s_lshl_b32 s68, s69, 18
    s_add_u32 s67, s67, s68
    s_lshl_b32 s68, s60, 8
    s_add_u32 s67, s67, s68
    s_lshl_b32 s68, s69, 13
    v_lshlrev_b32 v30, 1, v2
    v_xor_b32 v30, v30, v1
    v_lshl_add_u32 v30, v30, 4, v29
    v_xor_b32 v31, 128, v30
    s_barrier
    s_add_u32 s64, s67, 0
    s_add_u32 m0, s68, 98304
    s_nop 0
    buffer_load_dwordx4 v30, s[12:15], s64 offen nt lds
    s_add_u32 s64, s67, 32768
    s_add_u32 m0, s68, 99328
    s_nop 0
    buffer_load_dwordx4 v30, s[12:15], s64 offen nt lds
    s_add_u32 s64, s67, 65536
    s_add_u32 m0, s68, 100352
    s_nop 0
    buffer_load_dwordx4 v31, s[12:15], s64 offen nt lds
    s_add_u32 s64, s67, 98304
    s_add_u32 m0, s68, 101376
    s_nop 0
    buffer_load_dwordx4 v31, s[12:15], s64 offen nt lds
    s_add_u32 s64, s67, 131072
    s_add_u32 m0, s68, 102400
    s_nop 0
    buffer_load_dwordx4 v30, s[12:15], s64 offen nt lds
    s_add_u32 s64, s67, 163840
    s_add_u32 m0, s68, 103424
    s_nop 0
    buffer_load_dwordx4 v30, s[12:15], s64 offen nt lds
    s_add_u32 s64, s67, 196608
    s_add_u32 m0, s68, 104448
    s_nop 0
    buffer_load_dwordx4 v31, s[12:15], s64 offen nt lds
    s_add_u32 s64, s67, 229376
    s_add_u32 m0, s68, 105472
    s_nop 0
    buffer_load_dwordx4 v31, s[12:15], s64 offen nt lds
    v_xor_b32 v30, v1, v2
    v_lshl_add_u32 v30, v30, 4, v29
    v_xor_b32 v31, 0, v30
    s_add_u32 s64, s67, 0
    s_add_u32 m0, s68, 0
    s_nop 0
    buffer_load_dwordx4 v31, s[16:19], s64 offen nt lds
    s_add_u32 s64, s67, 32768
    s_add_u32 m0, s68, 1024
    s_nop 0
    buffer_load_dwordx4 v31, s[16:19], s64 offen nt lds
    v_xor_b32 v31, 64, v30
    s_add_u32 s64, s67, 65536
    s_add_u32 m0, s68, 2048
    s_nop 0
    buffer_load_dwordx4 v31, s[16:19], s64 offen nt lds
    s_add_u32 s64, s67, 98304
    s_add_u32 m0, s68, 3072
    s_nop 0
    buffer_load_dwordx4 v31, s[16:19], s64 offen nt lds
    v_xor_b32 v31, 128, v30
    s_add_u32 s64, s67, 131072
    s_add_u32 m0, s68, 4096
    s_nop 0
    buffer_load_dwordx4 v31, s[16:19], s64 offen nt lds
    s_add_u32 s64, s67, 163840
    s_add_u32 m0, s68, 5120
    s_nop 0
    buffer_load_dwordx4 v31, s[16:19], s64 offen nt lds
    v_xor_b32 v31, 192, v30
    s_add_u32 s64, s67, 196608
    s_add_u32 m0, s68, 6144
    s_nop 0
    buffer_load_dwordx4 v31, s[16:19], s64 offen nt lds
    s_add_u32 s64, s67, 229376
    s_add_u32 m0, s68, 7168
    s_nop 0
    buffer_load_dwordx4 v31, s[16:19], s64 offen nt lds
    s_branch L_svc4
L_svc3:
    v_mov_b32 v68, -1
    v_mov_b32 v69, -1
    v_mov_b32 v70, -1
    v_mov_b32 v71, -1
    s_mul_i32 s66, s55, 768
    s_add_u32 s66, s66, 113664
    s_lshl_b32 s67, s55, 11
    s_add_u32 s67, s67, s73
    s_add_u32 s67, s67, 2128896
    s_cmp_eq_u32 s56, 3
    s_cselect_b32 s67, s66, s67
    v_min_u32 v30, 3824, v16
    buffer_store_dwordx4 v[68:71], v30, s[48:51], s67 offen sc1
    s_cmp_lg_u32 s56, 1
    s_cbranch_scc1 wi_5
    v_mov_b32 v66, s57
    v_mov_b32 v67, s28
    s_lshl_b32 s68, s55, 7
    s_add_u32 s68, s68, 4096
    s_mov_b32 exec_lo, 0xffff
    s_mov_b32 exec_hi, 0x0
    buffer_store_dwordx2 v[66:67], v17, s[48:51], s68 offen sc1
    s_mov_b64 exec, -1
wi_5:
    s_and_b32 s66, s56, 1
    s_lshl_b32 s66, s66, 2
    s_add_u32 s66, s66, s61
    s_lshl_b32 s66, s66, 6
    s_and_b32 s67, s60, 15
    s_add_u32 s66, s66, s67
    s_lshl_b32 s66, s66, 12
    s_add_u32 s66, s66, 2294784
    s_barrier
    s_cmp_eq_u32 s56, 3
    s_cbranch_scc1 L_svc4
    s_mov_b32 s63, 60000
hw_7:
    s_load_dword s67, s[48:49], s66 glc
    s_waitcnt lgkmcnt(0)
    s_cmp_eq_u32 s67, s57
    s_cbranch_scc1 hd_8
    s_sub_u32 s63, s63, 1
    s_cbranch_scc0 hw_7
hd_8:
L_svc4:
    s_waitcnt lgkmcnt(0)
    s_barrier
    buffer_load_dwordx4 v[68:71], v26, s[48:51], s31 offen sc1
    buffer_load_dwordx4 v[76:79], v27, s[48:51], s31 offen sc1
    buffer_load_dwordx4 v[64:67], v26, s[48:51], s30 offen sc1
    buffer_load_dwordx4 v[72:75], v27, s[48:51], s30 offen sc1
    buffer_load_dwordx2 v[90:91], v34, s[48:51], s29 offen sc1
    s_cmp_lt_u32 s56, 4
    s_cbranch_scc1 wi_9
    s_waitcnt vmcnt(13)
wi_9:
    s_barrier
    ds_read_b32 v84, v21 offset:32768
    v_add_u32 v30, 98304, v36
    ds_read_b64_tr_b16 v[96:97], v30 offset:0
    ds_read_b64_tr_b16 v[98:99], v30 offset:1024
    ds_read_b64_tr_b16 v[100:101], v30 offset:8192
    ds_read_b64_tr_b16 v[102:103], v30 offset:9216
    ds_read_b64_tr_b16 v[104:105], v30 offset:16384
    ds_read_b64_tr_b16 v[106:107], v30 offset:17408
    ds_read_b64_tr_b16 v[108:109], v30 offset:24576
    ds_read_b64_tr_b16 v[110:111], v30 offset:25600
    s_lshl_b32 s66, s55, 12
    s_lshl_b32 s67, s56, 9
    s_add_u32 s66, s66, s67
    s_add_u32 s66, s66, s72
    s_add_u32 s66, s66, 2162688
    s_mov_b32 s68, 0xff
    s_waitcnt lgkmcnt(8)
    v_lshlrev_b32 v88, 16, v84
    v_and_b32 v89, 0xffff0000, v84
    s_mov_b32 s63, 60000
    s_waitcnt vmcnt(0)
poll_11:
    v_xor_b32 v64, v64, v12
    v_xor_b32 v65, v65, v13
    v_xor_b32 v66, v66, v14
    v_xor_b32 v67, v67, v15
    v_xor_b32 v68, v68, v12
    v_xor_b32 v69, v69, v13
    v_xor_b32 v70, v70, v14
    v_xor_b32 v71, v71, v15
    v_xor_b32 v72, v72, v12
    v_xor_b32 v73, v73, v13
    v_xor_b32 v74, v74, v14
    v_xor_b32 v75, v75, v15
    v_xor_b32 v76, v76, v12
    v_xor_b32 v77, v77, v13
    v_xor_b32 v78, v78, v14
    v_xor_b32 v79, v79, v15
    v_or3_b32 v80, v64, v65, v66
    v_or3_b32 v81, v67, v68, v69
    v_or3_b32 v80, v80, v70, v71
    v_or3_b32 v81, v81, v72, v73
    v_or3_b32 v80, v80, v74, v75
    v_or3_b32 v81, v81, v76, v77
    v_or3_b32 v80, v80, v78, v79
    v_or_b32 v80, v80, v81
    v_and_b32 v80, 0xff, v80
    v_cmp_ne_u32 vcc, 0, v80
    s_cbranch_vccz pdone_12
    s_sleep 1
    buffer_load_dwordx4 v[68:71], v26, s[48:51], s31 offen sc1
    buffer_load_dwordx4 v[76:79], v27, s[48:51], s31 offen sc1
    buffer_load_dwordx4 v[64:67], v26, s[48:51], s30 offen sc1
    buffer_load_dwordx4 v[72:75], v27, s[48:51], s30 offen sc1
    s_sub_u32 s63, s63, 1
    s_waitcnt vmcnt(0)
    s_cbranch_scc0 poll_11
pdone_12:
    v_add_f32 v68, v68, v76
    v_add_f32 v69, v69, v77
    v_add_f32 v70, v70, v78
    v_add_f32 v71, v71, v79
    v_add_f32 v64, v64, v72
    v_add_f32 v65, v65, v73
    v_add_f32 v66, v66, v74
    v_add_f32 v67, v67, v75
    v_permlane32_swap_b32 v68, v70
    v_permlane32_swap_b32 v69, v71
    v_permlane32_swap_b32 v64, v66
    v_permlane32_swap_b32 v65, v67
    v_add_f32 v68, v68, v70
    v_add_f32 v69, v69, v71
    v_add_f32 v64, v64, v66
    v_add_f32 v65, v65, v67
    v_cvt_pk_bf16_f32 v68, 0, v68
    v_cvt_pk_bf16_f32 v69, 0, v69
    v_cvt_pk_bf16_f32 v64, 0, v64
    v_cvt_pk_bf16_f32 v65, 0, v65
    v_add_f32 v68, 1.0, v68
    v_add_f32 v69, 1.0, v69
    v_cvt_pk_bf16_f32 v68, 0, v68
    v_cvt_pk_bf16_f32 v69, 0, v69
    v_mul_f32 v68, v68, v88
    v_mul_f32 v69, v69, v89
    v_cvt_pk_bf16_f32 v68, 0, v68
    v_cvt_pk_bf16_f32 v69, 0, v69
    v_add_f32 v68, v68, v64
    v_add_f32 v69, v69, v65
    v_cvt_pk_bf16_f32 v68, v68, v69
    ds_write_b32 v20, v68 offset:49152
    s_waitcnt lgkmcnt(0)
    s_barrier
    ds_read_b128 v[64:67], v22 offset:49152
    ds_read_b128 v[68:71], v22 offset:49280
    v_xor_b32 v90, s57, v90
    v_xor_b32 v91, s28, v91
    v_or_b32 v90, v90, v91
    v_cmp_ne_u32 vcc, 0, v90
    s_lshl_b32 s64, s60, 14
    s_add_u32 s64, s64, s67
    s_add_u32 s64, s64, s72
    s_add_u32 s64, s64, 2162688
    s_add_u32 s65, s64, 8192
    s_waitcnt lgkmcnt(1)
    v_mfma_f32_16x16x32_bf16 v[112:115], v[96:99], v[64:67], 0
    v_mfma_f32_16x16x32_bf16 v[116:119], v[100:103], v[64:67], 0
    s_waitcnt lgkmcnt(0)
    v_mfma_f32_16x16x32_bf16 v[112:115], v[104:107], v[68:71], v[112:115]
    v_mfma_f32_16x16x32_bf16 v[116:119], v[108:111], v[68:71], v[116:119]
    s_nop 7
    v_add_f32_dpp v112, v116, v112 row_ror:8 row_mask:0xf bank_mask:0xf
    v_add_f32_dpp v113, v117, v113 row_ror:8 row_mask:0xf bank_mask:0xf
    v_add_f32_dpp v114, v118, v114 row_ror:8 row_mask:0xf bank_mask:0xf
    v_add_f32_dpp v115, v119, v115 row_ror:8 row_mask:0xf bank_mask:0xf
    v_bfi_b32 v112, s68, v12, v112
    v_bfi_b32 v113, s68, v13, v113
    v_bfi_b32 v114, s68, v14, v114
    v_bfi_b32 v115, s68, v15, v115
    s_mov_b32 exec_lo, 0xff00ff
    s_mov_b32 exec_hi, 0xff00ff
    s_cbranch_vccnz far_13
    buffer_store_dwordx4 v[112:115], v23, s[48:51], s66 offen
    s_branch dn_14
far_13:
    buffer_store_dwordx4 v[112:115], v23, s[48:51], s66 offen sc1
dn_14:
    s_mov_b64 exec, -1
    s_cmp_ge_u32 s56, 4
    s_cbranch_scc1 wi_15
    v_lshrrev_b32 v40, 2, v1
    v_lshl_add_u32 v40, v40, 3, v38
    v_lshlrev_b32 v40, 8, v40
    s_lshl_b32 s69, s56, 13
    v_add_u32 v40, s69, v40
    v_xor_b32 v41, v1, v2
    v_lshlrev_b32 v30, 18, v19
    v_lshl_add_u32 v30, v2, 4, v30
    s_lshr_b32 s69, s60, 4
    s_lshl_b32 s69, s69, 14
    s_lshl_b32 s66, s61, 12
    s_add_u32 s69, s69, s66
    s_lshl_b32 s66, s56, 10
    s_add_u32 s69, s69, s66
    s_and_b32 s66, s60, 15
    s_lshl_b32 s66, s66, 6
    s_add_u32 s69, s69, s66
    s_add_u32 s69, s69, 2097152
    v_xor_b32 v42, 0, v41
    v_lshl_add_u32 v42, v42, 4, v40
    ds_read_b128 v[128:131], v42 offset:0
    ds_read_b128 v[144:147], v42 offset:1024
    v_xor_b32 v42, 4, v41
    v_lshl_add_u32 v42, v42, 4, v40
    ds_read_b128 v[132:135], v42 offset:0
    ds_read_b128 v[148:151], v42 offset:1024
    v_xor_b32 v42, 8, v41
    v_lshl_add_u32 v42, v42, 4, v40
    ds_read_b128 v[136:139], v42 offset:0
    ds_read_b128 v[152:155], v42 offset:1024
    v_xor_b32 v42, 12, v41
    v_lshl_add_u32 v42, v42, 4, v40
    ds_read_b128 v[140:143], v42 offset:0
    ds_read_b128 v[156:159], v42 offset:1024
    s_branch wd_16
wi_15:
    v_lshlrev_b32 v40, 4, v0
    ds_read_b128 v[128:131], v40 offset:45056
    ds_read_b128 v[132:135], v40 offset:46080
    s_and_b32 s69, s56, 3
    s_lshl_b32 s66, s69, 5
    v_xor_b32 v41, s66, v5
    v_add_u32 v41, 139264, v41
    s_lshl_b32 s69, s69, 9
    s_lshl_b32 s66, s55, 12
    s_add_u32 s69, s69, s66
    s_add_u32 s69, s69, s72
    s_add_u32 s69, s69, 2228224
wd_16:
    s_mov_b32 s63, 60000
    buffer_load_dwordx4 v[64:67], v39, s[48:51], s64 offen sc1
    buffer_load_dwordx4 v[68:71], v39, s[48:51], s65 offen sc1
    s_waitcnt vmcnt(0)
poll_17:
    v_xor_b32 v64, v64, v12
    v_xor_b32 v65, v65, v13
    v_xor_b32 v66, v66, v14
    v_xor_b32 v67, v67, v15
    v_xor_b32 v68, v68, v12
    v_xor_b32 v69, v69, v13
    v_xor_b32 v70, v70, v14
    v_xor_b32 v71, v71, v15
    v_or3_b32 v72, v64, v65, v66
    v_or3_b32 v73, v67, v68, v69
    v_or3_b32 v72, v72, v70, v71
    v_or_b32 v72, v72, v73
    v_and_b32 v72, 0xff, v72
    v_cmp_ne_u32 vcc, 0, v72
    s_cbranch_vccz pdone_18
    buffer_load_dwordx4 v[64:67], v39, s[48:51], s64 offen sc1
    buffer_load_dwordx4 v[68:71], v39, s[48:51], s65 offen sc1
    s_sub_u32 s63, s63, 1
    s_waitcnt vmcnt(0)
    s_cbranch_scc0 poll_17
pdone_18:
    v_add_f32 v64, v64, v68
    v_add_f32 v65, v65, v69
    v_add_f32 v66, v66, v70
    v_add_f32 v67, v67, v71
    s_nop 0
    v_permlane32_swap_b32 v64, v66
    v_permlane32_swap_b32 v65, v67
    v_add_f32 v64, v64, v66
    v_add_f32 v65, v65, v67
    v_cvt_pk_bf16_f32 v64, v64, v65
    ds_write_b32 v20, v64 offset:53248
    s_waitcnt lgkmcnt(0)
    s_barrier
    s_cmp_ge_u32 s56, 4
    s_cbranch_scc1 wi_19
    ds_read_b128 v[64:67], v22 offset:53248
    ds_read_b128 v[68:71], v22 offset:53376
    s_waitcnt lgkmcnt(0)
    v_mfma_f32_16x16x32_bf16 v[96:99], v[128:131], v[64:67], 0
    v_mfma_f32_16x16x32_bf16 v[100:103], v[132:135], v[64:67], 0
    v_mfma_f32_16x16x32_bf16 v[104:107], v[144:147], v[64:67], 0
    v_mfma_f32_16x16x32_bf16 v[108:111], v[148:151], v[64:67], 0
    v_mfma_f32_16x16x32_bf16 v[96:99], v[136:139], v[68:71], v[96:99]
    v_mfma_f32_16x16x32_bf16 v[100:103], v[140:143], v[68:71], v[100:103]
    v_mfma_f32_16x16x32_bf16 v[104:107], v[152:155], v[68:71], v[104:107]
    v_mfma_f32_16x16x32_bf16 v[108:111], v[156:159], v[68:71], v[108:111]
    s_nop 5
    v_add_f32_dpp v96, v100, v96 row_ror:8 row_mask:0xf bank_mask:0xf
    v_add_f32_dpp v97, v101, v97 row_ror:8 row_mask:0xf bank_mask:0xf
    v_add_f32_dpp v98, v102, v98 row_ror:8 row_mask:0xf bank_mask:0xf
    v_add_f32_dpp v99, v103, v99 row_ror:8 row_mask:0xf bank_mask:0xf
    v_add_f32_dpp v104, v108, v104 row_ror:8 row_mask:0xf bank_mask:0xf
    v_add_f32_dpp v105, v109, v105 row_ror:8 row_mask:0xf bank_mask:0xf
    v_add_f32_dpp v106, v110, v106 row_ror:8 row_mask:0xf bank_mask:0xf
    v_add_f32_dpp v107, v111, v107 row_ror:8 row_mask:0xf bank_mask:0xf
    v_cvt_pk_bf16_f32 v72, v96, v97
    v_cvt_pk_bf16_f32 v73, v98, v99
    v_cvt_pk_bf16_f32 v74, v104, v105
    v_cvt_pk_bf16_f32 v75, v106, v107
    s_mov_b32 exec_lo, 0xff00ff
    s_mov_b32 exec_hi, 0xff00ff
    buffer_store_dwordx4 v[72:75], v30, s[48:51], s69 offen sc1
    s_mov_b64 exec, -1
    s_barrier
    s_cmp_lg_u32 s56, 3
    s_cbranch_scc1 noflg_21
    v_mov_b32 v76, s57
    v_not_b32 v77, v76
    s_lshl_b32 s67, s54, 7
    s_lshl_b32 s66, s52, 3
    s_add_u32 s67, s67, s66
    v_lshlrev_b32 v78, 11, v0
    s_mov_b32 exec_lo, 0xff
    s_mov_b32 exec_hi, 0x0
    s_add_u32 s67, s67, 98304
    buffer_store_dwordx2 v[76:77], v78, s[48:51], s67 offen sc1
    s_mov_b64 exec, -1
noflg_21:
    s_branch wd_20
wi_19:
    s_barrier
    s_add_u32 s64, s33, 0
    s_add_u32 m0, s34, 0
    s_nop 0
    buffer_load_dwordx4 v32, s[40:43], s64 offen nt lds
    s_add_u32 s64, s33, 49152
    s_add_u32 m0, s34, 1024
    s_nop 0
    buffer_load_dwordx4 v33, s[40:43], s64 offen nt lds
    s_add_u32 s64, s33, 98304
    s_add_u32 m0, s34, 2048
    s_nop 0
    buffer_load_dwordx4 v32, s[40:43], s64 offen nt lds
    s_add_u32 s64, s33, 147456
    s_add_u32 m0, s34, 3072
    s_nop 0
    buffer_load_dwordx4 v33, s[40:43], s64 offen nt lds
    s_mov_b32 s35, s69
wd_20:
    v_and_b32 v30, 1, v0
    v_lshlrev_b32 v30, 7, v30
    s_lshl_b32 s69, s52, 11
    s_lshl_b32 s66, s56, 8
    s_add_u32 s69, s69, s66
    s_add_u32 s69, s69, 4096
    v_bfe_u32 v37, v1, 2, 1
    v_lshlrev_b32 v37, 12, v37
    v_lshl_add_u32 v37, v38, 5, v37
    v_lshl_add_u32 v37, v2, 3, v37
    s_lshl_b32 s32, s60, 13
    s_lshl_b32 s66, s61, 10
    s_add_u32 s32, s32, s66
    s_lshl_b32 s66, s56, 7
    s_add_u32 s32, s32, s66
    s_add_u32 s32, s32, s73
    s_add_u32 s32, s32, 2129920
    s_lshl_b32 s64, s60, 14
    s_lshl_b32 s65, s61, 9
    s_add_u32 s64, s64, s65
    s_add_u32 s64, s64, s72
    s_add_u32 s64, s64, 2228224
    s_add_u32 s65, s64, 8192
    s_mul_i32 s66, s56, 56
    s_lshl_b32 s67, s52, 22
    s_add_u32 s33, s66, 1152
    v_add_u32 v119, s33, v0
    v_lshrrev_b32 v115, 8, v119
    v_mul_u32_u24 v115, 1, v115
    v_add_u32 v115, s54, v115
    v_and_b32 v115, 15, v115
    v_lshlrev_b32 v115, 18, v115
    v_bfe_u32 v114, v119, 3, 2
    v_lshl_add_u32 v115, v114, 13, v115
    v_bfe_u32 v114, v119, 5, 3
    v_lshl_add_u32 v115, v114, 10, v115
    v_and_b32 v119, 0x707, v119
    v_lshl_add_u32 v118, v119, 7, v115
    s_add_u32 s33, s66, 1600
    v_add_u32 v119, s33, v0
    v_lshrrev_b32 v115, 8, v119
    v_mul_u32_u24 v115, 1, v115
    v_add_u32 v115, s54, v115
    v_and_b32 v115, 15, v115
    v_lshlrev_b32 v115, 18, v115
    v_bfe_u32 v114, v119, 3, 2
    v_lshl_add_u32 v115, v114, 13, v115
    v_bfe_u32 v114, v119, 5, 3
    v_lshl_add_u32 v115, v114, 10, v115
    v_and_b32 v119, 0x707, v119
    v_lshl_add_u32 v117, v119, 7, v115
    buffer_load_dwordx2 v[90:91], v30, s[48:51], s69 offen sc1
    buffer_load_dwordx2 v[92:93], v37, s[48:51], s32 offen sc1
    s_cmp_ge_u32 s56, 4
    s_cbranch_scc1 wi_22
    s_mov_b32 exec_lo, 0xffffffff
    s_mov_b32 exec_hi, 0xffffff
    buffer_load_dword v118, v118, s[8:11], s67 offen
    s_mov_b64 exec, -1
    s_barrier
    s_branch wd_23
wi_22:
    s_waitcnt vmcnt(2)
    s_barrier
    s_mov_b32 s69, s35
    ds_read_b64_tr_b16 v[64:65], v41 offset:0
    ds_read_b64_tr_b16 v[66:67], v41 offset:512
    ds_read_b64_tr_b16 v[68:69], v41 offset:4096
    ds_read_b64_tr_b16 v[70:71], v41 offset:4608
    ds_read_b64_tr_b16 v[72:73], v41 offset:8192
    ds_read_b64_tr_b16 v[74:75], v41 offset:8704
    ds_read_b64_tr_b16 v[76:77], v41 offset:12288
    ds_read_b64_tr_b16 v[78:79], v41 offset:12800
    s_waitcnt lgkmcnt(6)
    v_mfma_f32_16x16x32_bf16 v[96:99], v[64:67], v[128:131], 0
    s_waitcnt lgkmcnt(4)
    v_mfma_f32_16x16x32_bf16 v[100:103], v[68:71], v[128:131], 0
    s_waitcnt lgkmcnt(2)
    v_mfma_f32_16x16x32_bf16 v[96:99], v[72:75], v[132:135], v[96:99]
    s_waitcnt lgkmcnt(0)
    v_mfma_f32_16x16x32_bf16 v[100:103], v[76:79], v[132:135], v[100:103]
    s_nop 7
    v_add_f32_dpp v96, v100, v96 row_ror:8 row_mask:0xf bank_mask:0xf
    v_add_f32_dpp v97, v101, v97 row_ror:8 row_mask:0xf bank_mask:0xf
    v_add_f32_dpp v98, v102, v98 row_ror:8 row_mask:0xf bank_mask:0xf
    v_add_f32_dpp v99, v103, v99 row_ror:8 row_mask:0xf bank_mask:0xf
    v_bfi_b32 v96, s68, v12, v96
    v_bfi_b32 v97, s68, v13, v97
    v_bfi_b32 v98, s68, v14, v98
    v_bfi_b32 v99, s68, v15, v99
    s_mov_b32 exec_lo, 0xff00ff
    s_mov_b32 exec_hi, 0xff00ff
    buffer_store_dwordx4 v[96:99], v23, s[48:51], s69 offen sc1
    s_mov_b64 exec, -1
    s_mov_b32 exec_lo, 0xffffffff
    s_mov_b32 exec_hi, 0xffffff
    buffer_load_dword v118, v118, s[8:11], s67 offen
    s_mov_b64 exec, -1
wd_23:
    s_barrier
    s_mov_b32 exec_lo, 0xffffffff
    s_mov_b32 exec_hi, 0xffffff
    buffer_load_dword v117, v117, s[8:11], s67 offen
    s_mov_b64 exec, -1
    v_mov_b32 v45, v39
    s_mov_b32 s58, s64
    s_mov_b32 s59, s65
    s_cmp_lg_u32 s56, 5
    s_cbranch_scc1 wi_24
    buffer_load_dwordx4 v[64:67], v39, s[48:51], s64 offen sc1
    buffer_load_dwordx4 v[68:71], v39, s[48:51], s65 offen sc1
wi_24:
    s_barrier
    s_cmp_lg_u32 s56, 5
    s_cbranch_scc1 wi_26
    s_waitcnt vmcnt(5)
    s_branch wd_27
wi_26:
    s_waitcnt vmcnt(3)
wd_27:
    v_xor_b32 v90, s57, v90
    v_xor_b32 v91, s28, v91
    v_or_b32 v90, v90, v91
    v_and_b32 v91, 1, v0
    s_lshl_b32 s66, s56, 3
    s_add_u32 s66, s66, 160000
    v_lshl_add_u32 v91, v91, 2, s66
    ds_write_b32 v91, v90
    s_cmp_ge_u32 s56, 4
    s_cbranch_scc1 wi_28
    v_lshrrev_b32 v114, 3, v3
    v_lshlrev_b32 v114, 13, v114
    v_lshl_add_u32 v114, v19, 7, v114
    s_lshl_b32 s67, s54, 18
    s_lshl_b32 s68, s52, 10
    s_add_u32 s67, s67, s68
    buffer_load_dword v114, v114, s[20:23], s67 offen
wi_28:
    s_barrier
    s_lshl_b32 s62, s54, 2
    s_add_u32 s62, s62, s56
    s_and_b32 s62, s62, 7
    v_lshrrev_b32 v17, 3, v0
    v_lshlrev_b32 v17, 10, v17
    v_add_u32 v17, v17, v95
    v_xor_b32 v18, 64, v17
    s_lshl_b32 s74, s52, 19
    s_lshl_b32 s66, s62, 16
    s_add_u32 s74, s74, s66
    s_lshr_b32 s66, s54, 1
    s_xor_b32 s66, s66, 4
    s_lshl_b32 s66, s66, 7
    s_add_u32 s74, s74, s66
    s_lshl_b32 s75, s56, 13
    s_add_u32 s75, s75, 32768
    v_add_u32 v5, s75, v5
    v_and_b32 v38, 3, v1
    v_lshlrev_b32 v32, 10, v2
    v_lshl_add_u32 v32, v1, 4, v32
    s_lshl_b32 s64, s55, 15
    s_lshl_b32 s65, s56, 12
    s_add_u32 s64, s64, s65
    s_add_u32 s64, s64, 4194304
    s_lshl_b32 s66, s56, 8
    s_add_u32 s66, s66, 155648
    v_and_b32 v33, 1, v1
    v_lshlrev_b32 v33, 5, v33
    v_lshl_add_u32 v33, v2, 3, v33
    v_add_u32 v33, s66, v33
    v_lshlrev_b32 v44, 5, v2
    v_lshl_add_u32 v44, v1, 1, v44
    v_add_u32 v44, s66, v44
    s_mul_i32 s66, s56, 272
    s_add_u32 s66, s66, 157696
    v_lshlrev_b32 v34, 4, v1
    v_add_u32 v34, s66, v34
    v_mul_u32_u24 v35, 272, v19
    v_lshl_add_u32 v35, v2, 4, v35
    v_add_u32 v35, 157696, v35
    v_lshlrev_b32 v49, 3, v38
    v_lshrrev_b32 v49, v49, s57
    v_bfe_u32 v8, v49, 0, 1
    v_bfe_u32 v48, v49, 1, 1
    v_lshl_or_b32 v8, v48, 16, v8
    v_bfe_u32 v9, v49, 2, 1
    v_bfe_u32 v48, v49, 3, 1
    v_lshl_or_b32 v9, v48, 16, v9
    v_bfe_u32 v10, v49, 4, 1
    v_bfe_u32 v48, v49, 5, 1
    v_lshl_or_b32 v10, v48, 16, v10
    v_bfe_u32 v11, v49, 6, 1
    v_bfe_u32 v48, v49, 7, 1
    v_lshl_or_b32 v11, v48, 16, v11
    v_lshlrev_b32 v39, 8, v1
    s_lshl_b32 s66, s56, 12
    s_lshl_b32 s67, s60, 3
    s_add_u32 s66, s66, s67
    s_add_u32 s66, s66, 65536
    s_mov_b32 s31, s66
    v_lshrrev_b32 v56, 2, v1
    v_lshlrev_b32 v57, 6, v56
    v_lshlrev_b32 v56, 10, v56
    v_lshl_add_u32 v56, v38, 5, v56
    v_lshrrev_b32 v58, 1, v2
    v_lshl_add_u32 v56, v58, 7, v56
    v_and_b32 v58, 1, v2
    v_lshl_add_u32 v56, v58, 4, v56
    s_and_b32 s69, s54, 1
    s_lshl_b32 s33, s52, 15
    s_lshr_b32 s68, s62, 1
    s_lshl_b32 s68, s68, 13
    s_add_u32 s33, s33, s68
    s_lshl_b32 s68, s69, 12
    s_add_u32 s33, s33, s68
    s_and_b32 s68, s62, 1
    s_lshl_b32 s68, s68, 9
    s_add_u32 s33, s33, s68
    s_add_u32 s33, s33, s73
    s_add_u32 s33, s33, 2129920
    v_mul_u32_u24 v58, 272, v38
    v_add_u32 v57, v57, v58
    v_lshl_add_u32 v57, v2, 4, v57
    s_mul_i32 s68, s56, 1088
    s_add_u32 s68, s68, 98304
    v_add_u32 v57, s68, v57
    v_lshlrev_b32 v58, 3, v3
    v_lshrrev_b32 v59, 5, v3
    v_lshl_add_u32 v58, v59, 4, v58
    v_add_u32 v58, 98304, v58
    v_lshrrev_b32 v59, 5, v3
    v_lshlrev_b32 v59, 13, v59
    v_and_b32 v60, 31, v3
    v_lshl_add_u32 v59, v60, 2, v59
    s_lshl_b32 s34, s69, 15
    s_lshl_b32 s68, s52, 10
    s_add_u32 s34, s34, s68
    s_lshr_b32 s68, s54, 1
    s_xor_b32 s68, s68, 4
    s_lshl_b32 s68, s68, 7
    s_add_u32 s34, s34, s68
    s_add_u32 s34, s34, 116736
    v_lshlrev_b32 v110, 2, v1
    v_add_u32 v110, 160000, v110
    s_lshl_b32 s30, s60, 10
    s_lshl_b32 s65, s56, 7
    s_add_u32 s30, s30, s65
    s_add_u32 s30, s30, 1572864
    v_and_b32 v28, 1, v2
    v_lshlrev_b32 v28, 18, v28
    v_lshrrev_b32 v29, 1, v2
    v_lshl_add_u32 v28, v29, 17, v28
    v_lshlrev_b32 v29, 1, v2
    v_xor_b32 v29, v29, v1
    v_lshl_add_u32 v28, v29, 4, v28
    v_xor_b32 v29, 128, v28
    s_lshl_b32 s65, s61, 20
    s_mul_i32 s66, s56, 16384
    s_add_u32 s65, s65, s66
    s_lshl_b32 s66, s60, 8
    s_add_u32 s65, s65, s66
    s_mul_i32 s66, s56, 4096
    s_add_u32 s67, s65, 0
    s_add_u32 s68, s66, 0
    s_mov_b32 m0, s68
    s_nop 0
    buffer_load_dwordx4 v28, s[20:23], s67 offen nt lds
    s_add_u32 s67, s65, 524288
    s_add_u32 s68, s66, 1024
    s_mov_b32 m0, s68
    s_nop 0
    buffer_load_dwordx4 v28, s[20:23], s67 offen nt lds
    s_add_u32 s67, s65, 8192
    s_add_u32 s68, s66, 2048
    s_mov_b32 m0, s68
    s_nop 0
    buffer_load_dwordx4 v29, s[20:23], s67 offen nt lds
    s_add_u32 s67, s65, 532480
    s_add_u32 s68, s66, 3072
    s_mov_b32 m0, s68
    s_nop 0
    buffer_load_dwordx4 v29, s[20:23], s67 offen nt lds
    s_cmp_lg_u32 s56, 5
    s_cbranch_scc1 wi_30
    s_mov_b32 s63, 60000
    s_waitcnt vmcnt(4)
poll_32:
    v_xor_b32 v64, v64, v12
    v_xor_b32 v65, v65, v13
    v_xor_b32 v66, v66, v14
    v_xor_b32 v67, v67, v15
    v_xor_b32 v68, v68, v12
    v_xor_b32 v69, v69, v13
    v_xor_b32 v70, v70, v14
    v_xor_b32 v71, v71, v15
    v_or3_b32 v72, v64, v65, v66
    v_or3_b32 v73, v67, v68, v69
    v_or3_b32 v72, v72, v70, v71
    v_or_b32 v72, v72, v73
    v_and_b32 v72, 0xff, v72
    v_cmp_ne_u32 vcc, 0, v72
    s_cbranch_vccz pdone_33
    s_sleep 2
    buffer_load_dwordx4 v[64:67], v45, s[48:51], s58 offen sc1
    buffer_load_dwordx4 v[68:71], v45, s[48:51], s59 offen sc1
    s_sub_u32 s63, s63, 1
    s_waitcnt vmcnt(0)
    s_cbranch_scc0 poll_32
pdone_33:
    v_add_f32 v64, v64, v68
    v_add_f32 v65, v65, v69
    v_add_f32 v66, v66, v70
    v_add_f32 v67, v67, v71
    s_nop 0
    v_permlane32_swap_b32 v64, v66
    v_permlane32_swap_b32 v65, v67
    v_add_f32 v64, v64, v66
    v_add_f32 v65, v65, v67
    s_lshr_b32 s66, s55, 5
    s_lshl_b32 s65, s66, 13
    s_and_b32 s67, s55, 31
    s_lshl_b32 s67, s67, 5
    s_add_u32 s65, s65, s67
    s_add_u32 s65, s65, 32768
    s_cmp_eq_u32 s66, 2
    s_cselect_b32 s66, 1.0, 0
    v_cvt_pk_bf16_f32 v64, 0, v64
    v_cvt_pk_bf16_f32 v65, 0, v65
    v_add_f32 v64, s66, v64
    v_add_f32 v65, s66, v65
    v_cvt_pk_bf16_f32 v64, v64, v65
    buffer_store_dword v64, v24, s[48:51], s65 offen sc1
wi_30:
    s_load_dword s65, s[48:49], s30 glc
    s_waitcnt lgkmcnt(0)
    s_mov_b32 s78, 1
    s_cmp_eq_u32 s65, s57
    s_cbranch_scc1 gotst_34
    s_mov_b32 s78, 0
    s_add_u32 s65, s74, 0
    s_add_u32 m0, s75, 0
    s_nop 0
    buffer_load_dwordx4 v17, s[24:27], s65 offen  lds
    s_add_u32 s65, s74, 8192
    s_add_u32 m0, s75, 1024
    s_nop 0
    buffer_load_dwordx4 v18, s[24:27], s65 offen  lds
    s_add_u32 s65, s74, 16384
    s_add_u32 m0, s75, 2048
    s_nop 0
    buffer_load_dwordx4 v17, s[24:27], s65 offen  lds
    s_add_u32 s65, s74, 24576
    s_add_u32 m0, s75, 3072
    s_nop 0
    buffer_load_dwordx4 v18, s[24:27], s65 offen  lds
    s_add_u32 s65, s74, 32768
    s_add_u32 m0, s75, 4096
    s_nop 0
    buffer_load_dwordx4 v17, s[24:27], s65 offen  lds
    s_add_u32 s65, s74, 40960
    s_add_u32 m0, s75, 5120
    s_nop 0
    buffer_load_dwordx4 v18, s[24:27], s65 offen  lds
    s_add_u32 s65, s74, 49152
    s_add_u32 m0, s75, 6144
    s_nop 0
    buffer_load_dwordx4 v17, s[24:27], s65 offen  lds
    s_add_u32 s65, s74, 57344
    s_add_u32 m0, s75, 7168
    s_nop 0
    buffer_load_dwordx4 v18, s[24:27], s65 offen  lds
    s_waitcnt vmcnt(8)
    s_barrier
    ds_read_b32 v110, v110
    ds_read_b64_tr_b16 v[112:113], v36 offset:0
    ds_read_b64_tr_b16 v[114:115], v36 offset:1024
    ds_read_b64_tr_b16 v[116:117], v36 offset:8192
    ds_read_b64_tr_b16 v[118:119], v36 offset:9216
    ds_read_b64_tr_b16 v[120:121], v36 offset:16384
    ds_read_b64_tr_b16 v[122:123], v36 offset:17408
    ds_read_b64_tr_b16 v[124:125], v36 offset:24576
    ds_read_b64_tr_b16 v[126:127], v36 offset:25600
    s_mov_b32 s63, 60000
hw_35:
    s_load_dword s65, s[48:49], s30 glc
    s_waitcnt lgkmcnt(0)
    s_cmp_eq_u32 s65, s57
    s_cbranch_scc1 hd_36
    s_sub_u32 s63, s63, 1
    s_cbranch_scc0 hw_35
hd_36:
gotst_34:
    buffer_load_dwordx2 v[40:41], v39, s[48:51], s31 offen sc1
    buffer_load_dwordx4 v[64:67], v32, s[48:51], s64 offen offset:0 sc1
    buffer_load_dwordx4 v[68:71], v32, s[48:51], s64 offen offset:256 sc1
    buffer_load_dwordx4 v[72:75], v32, s[48:51], s64 offen offset:512 sc1
    buffer_load_dwordx4 v[76:79], v32, s[48:51], s64 offen offset:768 sc1
    s_waitcnt vmcnt(4)
    v_max_u32 v47, v40, v41
    v_cmp_eq_u32 vcc, -1, v47
    s_cbranch_vccz okst_37
    s_mov_b32 s63, 60000
poll_38:
    buffer_load_dwordx2 v[40:41], v39, s[48:51], s31 offen sc1
    s_waitcnt vmcnt(0)
    v_max_u32 v47, v40, v41
    v_cmp_eq_u32 vcc, -1, v47
    s_cbranch_vccz pdone_39
    s_sub_u32 s63, s63, 1
    s_cbranch_scc0 poll_38
pdone_39:
okst_37:
    s_cmp_eq_u32 s78, 0
    s_cbranch_scc1 nr_40
    s_add_u32 s65, s74, 0
    s_add_u32 m0, s75, 0
    s_nop 0
    buffer_load_dwordx4 v17, s[24:27], s65 offen  lds
    s_add_u32 s65, s74, 8192
    s_add_u32 m0, s75, 1024
    s_nop 0
    buffer_load_dwordx4 v18, s[24:27], s65 offen  lds
    s_add_u32 s65, s74, 16384
    s_add_u32 m0, s75, 2048
    s_nop 0
    buffer_load_dwordx4 v17, s[24:27], s65 offen  lds
    s_add_u32 s65, s74, 24576
    s_add_u32 m0, s75, 3072
    s_nop 0
    buffer_load_dwordx4 v18, s[24:27], s65 offen  lds
    s_add_u32 s65, s74, 32768
    s_add_u32 m0, s75, 4096
    s_nop 0
    buffer_load_dwordx4 v17, s[24:27], s65 offen  lds
    s_add_u32 s65, s74, 40960
    s_add_u32 m0, s75, 5120
    s_nop 0
    buffer_load_dwordx4 v18, s[24:27], s65 offen  lds
    s_add_u32 s65, s74, 49152
    s_add_u32 m0, s75, 6144
    s_nop 0
    buffer_load_dwordx4 v17, s[24:27], s65 offen  lds
    s_add_u32 s65, s74, 57344
    s_add_u32 m0, s75, 7168
    s_nop 0
    buffer_load_dwordx4 v18, s[24:27], s65 offen  lds
    s_barrier
    ds_read_b32 v110, v110
    ds_read_b64_tr_b16 v[112:113], v36 offset:0
    ds_read_b64_tr_b16 v[114:115], v36 offset:1024
    ds_read_b64_tr_b16 v[116:117], v36 offset:8192
    ds_read_b64_tr_b16 v[118:119], v36 offset:9216
    ds_read_b64_tr_b16 v[120:121], v36 offset:16384
    ds_read_b64_tr_b16 v[122:123], v36 offset:17408
    ds_read_b64_tr_b16 v[124:125], v36 offset:24576
    ds_read_b64_tr_b16 v[126:127], v36 offset:25600
nr_40:
    v_mov_b32 v42, v40
    v_and_b32 v50, 1, v2
    v_cmp_eq_u32 s[70:71], 1, v50
    v_max_f32_dpp v42, v42, v42 row_ror:8 row_mask:0xf bank_mask:0xf
    s_nop 1
    v_max_f32_dpp v42, v42, v42 row_ror:4 row_mask:0xf bank_mask:0xf
    s_nop 1
    v_max_f32_dpp v42, v42, v42 row_ror:2 row_mask:0xf bank_mask:0xf
    s_nop 1
    v_max_f32_dpp v42, v42, v42 row_ror:1 row_mask:0xf bank_mask:0xf
    s_mov_b32 s63, 60000
    s_waitcnt vmcnt(8)
    s_cmp_lg_u32 s78, 0
    s_cbranch_scc1 chk_43
    s_waitcnt vmcnt(0)
chk_43:
    v_sub_f32 v40, v40, v42
    v_xor_b32 v80, v64, v8
    v_xor_b32 v81, v65, v9
    v_exp_f32 v40, v40
    v_xor_b32 v82, v66, v10
    v_xor_b32 v83, v67, v11
    v_mul_f32 v41, v41, v40
    v_xor_b32 v84, v68, v8
    v_xor_b32 v85, v69, v9
    v_add_f32_dpp v41, v41, v41 row_ror:8 row_mask:0xf bank_mask:0xf
    v_xor_b32 v86, v70, v10
    v_xor_b32 v87, v71, v11
    v_add_f32_dpp v41, v41, v41 row_ror:4 row_mask:0xf bank_mask:0xf
    v_xor_b32 v88, v72, v8
    v_xor_b32 v89, v73, v9
    v_add_f32_dpp v41, v41, v41 row_ror:2 row_mask:0xf bank_mask:0xf
    v_xor_b32 v90, v74, v10
    v_xor_b32 v91, v75, v11
    v_add_f32_dpp v41, v41, v41 row_ror:1 row_mask:0xf bank_mask:0xf
    v_xor_b32 v92, v76, v8
    v_xor_b32 v93, v77, v9
    v_rcp_f32 v41, v41
    v_xor_b32 v94, v78, v10
    v_xor_b32 v95, v79, v11
    v_mul_f32 v40, v40, v41
    v_or3_b32 v47, v80, v81, v82
    v_or3_b32 v48, v83, v84, v85
    v_cvt_pk_bf16_f32 v42, v40, v40
    v_or3_b32 v47, v47, v86, v87
    v_or3_b32 v48, v48, v88, v89
    v_and_b32 v43, 0xffff0000, v42
    v_or3_b32 v47, v47, v90, v91
    v_or3_b32 v48, v48, v92, v93
    v_sub_f32 v40, v40, v43
    v_or3_b32 v47, v47, v94, v95
    v_or_b32 v47, v47, v48
    v_cvt_pk_bf16_f32 v43, v40, v40
    v_and_b32 v47, 0x00010001, v47
    v_cmp_ne_u32 vcc, 0, v47
    v_cndmask_b32 v42, v42, v43, s[70:71]
    ds_write_b16 v44, v42
    ds_read_b64 v[52:53], v33
    s_cbranch_vccz pdone_42
poll_41:
    buffer_load_dwordx4 v[64:67], v32, s[48:51], s64 offen offset:0 sc1
    buffer_load_dwordx4 v[68:71], v32, s[48:51], s64 offen offset:256 sc1
    buffer_load_dwordx4 v[72:75], v32, s[48:51], s64 offen offset:512 sc1
    buffer_load_dwordx4 v[76:79], v32, s[48:51], s64 offen offset:768 sc1
    s_waitcnt vmcnt(0)
    v_xor_b32 v80, v64, v8
    v_xor_b32 v81, v65, v9
    v_xor_b32 v82, v66, v10
    v_xor_b32 v83, v67, v11
    v_xor_b32 v84, v68, v8
    v_xor_b32 v85, v69, v9
    v_xor_b32 v86, v70, v10
    v_xor_b32 v87, v71, v11
    v_xor_b32 v88, v72, v8
    v_xor_b32 v89, v73, v9
    v_xor_b32 v90, v74, v10
    v_xor_b32 v91, v75, v11
    v_xor_b32 v92, v76, v8
    v_xor_b32 v93, v77, v9
    v_xor_b32 v94, v78, v10
    v_xor_b32 v95, v79, v11
    v_or3_b32 v47, v80, v81, v82
    v_or3_b32 v48, v83, v84, v85
    v_or3_b32 v47, v47, v86, v87
    v_or3_b32 v48, v48, v88, v89
    v_or3_b32 v47, v47, v90, v91
    v_or3_b32 v48, v48, v92, v93
    v_or3_b32 v47, v47, v94, v95
    v_or_b32 v47, v47, v48
    v_and_b32 v47, 0x00010001, v47
    v_cmp_ne_u32 vcc, 0, v47
    s_cbranch_vccz pdone_42
    s_sub_u32 s63, s63, 1
    s_cbranch_scc0 poll_41
pdone_42:
    v_perm_b32 v64, v84, v80, s76
    v_perm_b32 v65, v92, v88, s76
    v_perm_b32 v66, v84, v80, s77
    v_perm_b32 v67, v92, v88, s77
    v_or_b32 v66, 0x00010001, v66
    v_or_b32 v67, 0x00010001, v67
    v_perm_b32 v68, v85, v81, s76
    v_perm_b32 v69, v93, v89, s76
    v_perm_b32 v70, v85, v81, s77
    v_perm_b32 v71, v93, v89, s77
    v_or_b32 v70, 0x00010001, v70
    v_or_b32 v71, 0x00010001, v71
    s_waitcnt lgkmcnt(0)
    v_mfma_f32_16x16x16_bf16 v[128:131], v[52:53], v[64:65], 0
    v_perm_b32 v72, v86, v82, s76
    v_perm_b32 v73, v94, v90, s76
    v_mfma_f32_16x16x16_bf16 v[132:135], v[52:53], v[66:67], 0
    v_perm_b32 v74, v86, v82, s77
    v_perm_b32 v75, v94, v90, s77
    v_or_b32 v74, 0x00010001, v74
    v_or_b32 v75, 0x00010001, v75
    v_mfma_f32_16x16x16_bf16 v[136:139], v[52:53], v[68:69], 0
    v_perm_b32 v76, v87, v83, s76
    v_perm_b32 v77, v95, v91, s76
    v_mfma_f32_16x16x16_bf16 v[140:143], v[52:53], v[70:71], 0
    v_perm_b32 v78, v87, v83, s77
    v_perm_b32 v79, v95, v91, s77
    v_or_b32 v78, 0x00010001, v78
    v_or_b32 v79, 0x00010001, v79
    v_mfma_f32_16x16x16_bf16 v[144:147], v[52:53], v[72:73], 0
    v_mfma_f32_16x16x16_bf16 v[148:151], v[52:53], v[74:75], 0
    v_mfma_f32_16x16x16_bf16 v[152:155], v[52:53], v[76:77], 0
    v_mfma_f32_16x16x16_bf16 v[156:159], v[52:53], v[78:79], 0
    v_add_f32 v128, v128, v129
    v_add_f32 v132, v132, v133
    v_add_f32 v136, v136, v137
    v_add_f32 v140, v140, v141
    s_nop 0
    v_add_f32 v144, v144, v145
    v_add_f32 v148, v148, v149
    v_add_f32 v152, v152, v153
    v_add_f32 v156, v156, v157
    v_cvt_pk_bf16_f32 v80, v128, v132
    v_cvt_pk_bf16_f32 v81, v136, v140
    v_cvt_pk_bf16_f32 v82, v144, v148
    v_cvt_pk_bf16_f32 v83, v152, v156
    s_mov_b32 exec_lo, 0xffff
    s_mov_b32 exec_hi, 0x0
    ds_write_b128 v34, v[80:83]
    s_mov_b64 exec, -1
    s_waitcnt lgkmcnt(0)
    s_barrier
    ds_read_b128 v[64:67], v35 offset:0
    ds_read_b128 v[68:71], v35 offset:64
    ds_read_b128 v[72:75], v35 offset:128
    ds_read_b128 v[76:79], v35 offset:192
    s_waitcnt lgkmcnt(3)
    v_mfma_f32_16x16x32_bf16 v[84:87], v[112:115], v[64:67], 0
    s_waitcnt lgkmcnt(2)
    v_mfma_f32_16x16x32_bf16 v[84:87], v[116:119], v[68:71], v[84:87]
    s_waitcnt lgkmcnt(1)
    v_mfma_f32_16x16x32_bf16 v[84:87], v[120:123], v[72:75], v[84:87]
    s_waitcnt lgkmcnt(0)
    v_mfma_f32_16x16x32_bf16 v[84:87], v[124:127], v[76:79], v[84:87]
    v_cmp_ne_u32 vcc, 0, v110
    s_or_b32 s29, vcc_lo, vcc_hi
    s_nop 5
    v_cvt_pk_bf16_f32 v88, v84, v85
    v_cvt_pk_bf16_f32 v89, v86, v87
    s_mov_b32 exec_lo, 0xff00ff
    s_mov_b32 exec_hi, 0xff00ff
    s_cmp_lg_u32 s29, 0
    s_cbranch_scc1 far_44
    buffer_store_dwordx2 v[88:89], v37, s[48:51], s32 offen
    s_branch dn_45
far_44:
    buffer_store_dwordx2 v[88:89], v37, s[48:51], s32 offen sc1
dn_45:
    s_mov_b64 exec, -1
    s_waitcnt vmcnt(1)
    v_xor_b32 v47, 0, v5
    ds_read_b64_tr_b16 v[192:193], v47 offset:0
    ds_read_b64_tr_b16 v[194:195], v47 offset:512
    ds_read_b64_tr_b16 v[208:209], v47 offset:4096
    ds_read_b64_tr_b16 v[210:211], v47 offset:4608
    v_xor_b32 v47, 32, v5
    ds_read_b64_tr_b16 v[196:197], v47 offset:0
    ds_read_b64_tr_b16 v[198:199], v47 offset:512
    ds_read_b64_tr_b16 v[212:213], v47 offset:4096
    ds_read_b64_tr_b16 v[214:215], v47 offset:4608
    v_xor_b32 v47, 64, v5
    ds_read_b64_tr_b16 v[200:201], v47 offset:0
    ds_read_b64_tr_b16 v[202:203], v47 offset:512
    ds_read_b64_tr_b16 v[216:217], v47 offset:4096
    ds_read_b64_tr_b16 v[218:219], v47 offset:4608
    v_xor_b32 v47, 96, v5
    ds_read_b64_tr_b16 v[204:205], v47 offset:0
    ds_read_b64_tr_b16 v[206:207], v47 offset:512
    ds_read_b64_tr_b16 v[220:221], v47 offset:4096
    ds_read_b64_tr_b16 v[222:223], v47 offset:4608
    s_mov_b32 s63, 60000
poll_46:
    buffer_load_dwordx4 v[64:67], v56, s[48:51], s33 offen offset:0 sc1
    buffer_load_dwordx4 v[68:71], v56, s[48:51], s33 offen offset:256 sc1
    s_waitcnt vmcnt(0)
    v_max3_u32 v47, v64, v66, v68
    v_max_u32 v47, v47, v70
    v_cmp_eq_u32 vcc, -1, v47
    s_cbranch_vccz pdone_47
    s_sub_u32 s63, s63, 1
    s_cbranch_scc0 poll_46
pdone_47:
    s_waitcnt lgkmcnt(0)
    v_mfma_f32_16x16x32_bf16 v[80:83], v[192:195], v[64:67], 0
    v_mfma_f32_16x16x32_bf16 v[84:87], v[196:199], v[64:67], 0
    v_mfma_f32_16x16x32_bf16 v[88:91], v[200:203], v[64:67], 0
    v_mfma_f32_16x16x32_bf16 v[92:95], v[204:207], v[64:67], 0
    v_mfma_f32_16x16x32_bf16 v[80:83], v[208:211], v[68:71], v[80:83]
    v_mfma_f32_16x16x32_bf16 v[84:87], v[212:215], v[68:71], v[84:87]
    v_mfma_f32_16x16x32_bf16 v[88:91], v[216:219], v[68:71], v[88:91]
    v_mfma_f32_16x16x32_bf16 v[92:95], v[220:223], v[68:71], v[92:95]
    s_nop 4
    v_add_f32_dpp v96, v80, v80 row_ror:8 row_mask:0xf bank_mask:0x3
    v_add_f32_dpp v97, v81, v81 row_ror:8 row_mask:0xf bank_mask:0x3
    v_add_f32_dpp v98, v82, v82 row_ror:8 row_mask:0xf bank_mask:0x3
    v_add_f32_dpp v99, v83, v83 row_ror:8 row_mask:0xf bank_mask:0x3
    v_add_f32_dpp v100, v84, v84 row_ror:8 row_mask:0xf bank_mask:0x3
    v_add_f32_dpp v101, v85, v85 row_ror:8 row_mask:0xf bank_mask:0x3
    v_add_f32_dpp v102, v86, v86 row_ror:8 row_mask:0xf bank_mask:0x3
    v_add_f32_dpp v103, v87, v87 row_ror:8 row_mask:0xf bank_mask:0x3
    v_add_f32_dpp v96, v88, v88 row_ror:8 row_mask:0xf bank_mask:0xc
    v_add_f32_dpp v97, v89, v89 row_ror:8 row_mask:0xf bank_mask:0xc
    v_add_f32_dpp v98, v90, v90 row_ror:8 row_mask:0xf bank_mask:0xc
    v_add_f32_dpp v99, v91, v91 row_ror:8 row_mask:0xf bank_mask:0xc
    v_add_f32_dpp v100, v92, v92 row_ror:8 row_mask:0xf bank_mask:0xc
    v_add_f32_dpp v101, v93, v93 row_ror:8 row_mask:0xf bank_mask:0xc
    v_add_f32_dpp v102, v94, v94 row_ror:8 row_mask:0xf bank_mask:0xc
    v_add_f32_dpp v103, v95, v95 row_ror:8 row_mask:0xf bank_mask:0xc
    v_add_f32_dpp v104, v96, v96 row_shl:4 row_mask:0xf bank_mask:0x5
    v_add_f32_dpp v105, v97, v97 row_shl:4 row_mask:0xf bank_mask:0x5
    v_add_f32_dpp v106, v98, v98 row_shl:4 row_mask:0xf bank_mask:0x5
    v_add_f32_dpp v107, v99, v99 row_shl:4 row_mask:0xf bank_mask:0x5
    v_add_f32_dpp v104, v100, v100 row_shr:4 row_mask:0xf bank_mask:0xa
    v_add_f32_dpp v105, v101, v101 row_shr:4 row_mask:0xf bank_mask:0xa
    v_add_f32_dpp v106, v102, v102 row_shr:4 row_mask:0xf bank_mask:0xa
    v_add_f32_dpp v107, v103, v103 row_shr:4 row_mask:0xf bank_mask:0xa
    ds_write_b128 v57, v[104:107]
    s_waitcnt lgkmcnt(0)
    s_barrier
    s_cmp_lg_u32 s56, 7
    s_cbranch_scc1 nohint_48
    s_lshl_b32 s64, s55, 7
    s_add_u32 s64, s64, 182272
    v_mov_b32 v108, s57
    v_mov_b32 v109, 0
    s_mov_b32 exec_lo, 0x1
    s_mov_b32 exec_hi, 0x0
    buffer_store_dword v108, v109, s[48:51], s64 offen sc1
    s_mov_b64 exec, -1
nohint_48:
    s_cmp_ge_u32 s56, 3
    s_cbranch_scc1 L_fin
    s_cmp_eq_u32 s56, 2
    s_cbranch_scc1 L_final
    ds_read_b64 v[64:65], v58 offset:0
    ds_read_b64 v[66:67], v58 offset:1088
    ds_read_b64 v[68:69], v58 offset:2176
    ds_read_b64 v[70:71], v58 offset:3264
    ds_read_b64 v[72:73], v58 offset:4352
    ds_read_b64 v[74:75], v58 offset:5440
    ds_read_b64 v[76:77], v58 offset:6528
    ds_read_b64 v[78:79], v58 offset:7616
    s_waitcnt lgkmcnt(0)
    v_add_f32 v64, v64, v72
    v_add_f32 v65, v65, v73
    v_add_f32 v66, v66, v74
    v_add_f32 v67, v67, v75
    v_add_f32 v68, v68, v76
    v_add_f32 v69, v69, v77
    v_add_f32 v70, v70, v78
    v_add_f32 v71, v71, v79
    v_add_f32 v64, v64, v68
    v_add_f32 v65, v65, v69
    v_add_f32 v66, v66, v70
    v_add_f32 v67, v67, v71
    v_add_f32 v64, v64, v66
    v_add_f32 v65, v65, v67
    v_cvt_pk_bf16_f32 v64, v64, 0
    v_and_b32 v66, 0x7fffffff, v65
    v_add_u32 v66, 0x8000, v66
    s_mov_b32 s64, 0xffff
    s_brev_b32 s65, 1
    v_sub_u32 v66, v66, v64 clamp
    v_bfi_b32 v64, s64, v64, v66
    v_bfi_b32 v64, s65, v65, v64
    buffer_store_dword v64, v59, s[48:51], s34 offen sc1
    s_cmp_lg_u32 s2, 0
    s_cbranch_scc1 L_fin
    v_mov_b32 v40, s57
    v_mov_b32 v39, 0
    s_mov_b32 exec_lo, 0x1
    s_mov_b32 exec_hi, 0x0
    buffer_store_dword v40, v39, s[48:51], 0 offen offset:0 sc1
    s_mov_b64 exec, -1
    s_branch L_fin
L_final:
    s_lshr_b32 s68, s55, 2
    s_and_b32 s69, s55, 3
    v_bfe_u32 v32, v0, 2, 1
    v_and_b32 v33, 3, v0
    v_lshlrev_b32 v34, 10, v32
    v_lshl_add_u32 v34, v33, 3, v34
    s_lshl_b32 s64, s69, 11
    s_lshl_b32 s65, s68, 5
    s_add_u32 s64, s64, s65
    buffer_load_dwordx2 v[40:41], v34, s[4:7], s64 offen
    s_add_u32 s65, s64, 32768
    s_add_u32 s66, s65, 24576
    s_mov_b32 s63, 60000
poll_49:
    buffer_load_dwordx2 v[42:43], v34, s[48:51], s65 offen sc1
    buffer_load_dwordx2 v[44:45], v34, s[48:51], s66 offen sc1
    s_waitcnt vmcnt(0)
    v_max3_u32 v47, v42, v43, v44
    v_max_u32 v47, v47, v45
    v_cmp_eq_u32 vcc, -1, v47
    s_cbranch_vccz pdone_50
    s_sleep 1
    s_sub_u32 s63, s63, 1
    s_cbranch_scc0 poll_49
pdone_50:
    v_lshlrev_b32 v48, 16, v40
    v_and_b32 v49, 0xffff0000, v40
    v_lshlrev_b32 v50, 16, v41
    v_and_b32 v51, 0xffff0000, v41
    v_lshlrev_b32 v52, 16, v42
    v_and_b32 v53, 0xffff0000, v42
    v_lshlrev_b32 v54, 16, v43
    v_and_b32 v55, 0xffff0000, v43
    v_lshlrev_b32 v56, 16, v44
    v_and_b32 v57, 0xffff0000, v44
    v_lshlrev_b32 v58, 16, v45
    v_and_b32 v59, 0xffff0000, v45
    v_lshlrev_b32 v35, 13, v32
    v_lshl_add_u32 v35, v33, 3, v35
    s_lshl_b32 s65, s69, 14
    s_lshl_b32 s66, s68, 5
    s_add_u32 s65, s65, s66
    s_add_u32 s65, s65, 116736
    s_add_u32 s66, s65, 4096
    s_min_u32 s67, s54, 13
    s_lshl_b32 s33, s52, 4
    s_add_u32 s67, s67, s33
    s_lshl_b32 s67, s67, 7
    s_add_u32 s67, s67, 198720
    s_mov_b32 s63, 60000
hw_51:
    s_load_dword s33, s[48:49], s67 glc
    s_waitcnt lgkmcnt(0)
    s_cmp_eq_u32 s33, s57
    s_cbranch_scc1 hd_52
    s_sub_u32 s63, s63, 1
    s_cbranch_scc0 hw_51
hd_52:
    s_mov_b32 s63, 60000
poll_53:
    buffer_load_dwordx2 v[128:129], v35, s[48:51], s65 offen offset:0 sc1
    buffer_load_dwordx2 v[130:131], v35, s[48:51], s65 offen offset:1024 sc1
    buffer_load_dwordx2 v[132:133], v35, s[48:51], s65 offen offset:2048 sc1
    buffer_load_dwordx2 v[134:135], v35, s[48:51], s65 offen offset:3072 sc1
    buffer_load_dwordx2 v[136:137], v35, s[48:51], s66 offen offset:0 sc1
    buffer_load_dwordx2 v[138:139], v35, s[48:51], s66 offen offset:1024 sc1
    buffer_load_dwordx2 v[140:141], v35, s[48:51], s66 offen offset:2048 sc1
    buffer_load_dwordx2 v[142:143], v35, s[48:51], s66 offen offset:3072 sc1
    s_waitcnt vmcnt(0)
    v_max3_u32 v47, v128, v129, v130
    v_max3_u32 v47, v47, v131, v132
    v_max3_u32 v47, v47, v133, v134
    v_max3_u32 v47, v47, v135, v136
    v_max3_u32 v47, v47, v137, v138
    v_max3_u32 v47, v47, v139, v140
    v_max3_u32 v47, v47, v141, v142
    v_max_u32 v47, v47, v143
    v_cmp_eq_u32 vcc, -1, v47
    s_cbranch_vccz pdone_54
    s_sleep 1
    s_sub_u32 s63, s63, 1
    s_cbranch_scc0 poll_53
pdone_54:
    v_lshlrev_b32 v144, 16, v128
    v_mov_b32 v145, v128
    v_lshlrev_b32 v146, 16, v129
    v_mov_b32 v147, v129
    v_lshlrev_b32 v148, 16, v130
    v_mov_b32 v149, v130
    v_lshlrev_b32 v150, 16, v131
    v_mov_b32 v151, v131
    v_lshlrev_b32 v152, 16, v132
    v_mov_b32 v153, v132
    v_lshlrev_b32 v154, 16, v133
    v_mov_b32 v155, v133
    v_lshlrev_b32 v156, 16, v134
    v_mov_b32 v157, v134
    v_lshlrev_b32 v158, 16, v135
    v_mov_b32 v159, v135
    v_lshlrev_b32 v160, 16, v136
    v_mov_b32 v161, v136
    v_lshlrev_b32 v162, 16, v137
    v_mov_b32 v163, v137
    v_lshlrev_b32 v164, 16, v138
    v_mov_b32 v165, v138
    v_lshlrev_b32 v166, 16, v139
    v_mov_b32 v167, v139
    v_lshlrev_b32 v168, 16, v140
    v_mov_b32 v169, v140
    v_lshlrev_b32 v170, 16, v141
    v_mov_b32 v171, v141
    v_lshlrev_b32 v172, 16, v142
    v_mov_b32 v173, v142
    v_lshlrev_b32 v174, 16, v143
    v_mov_b32 v175, v143
    v_add_f32 v144, v144, v160
    v_add_f32 v145, v145, v161
    v_add_f32 v146, v146, v162
    v_add_f32 v147, v147, v163
    v_add_f32 v148, v148, v164
    v_add_f32 v149, v149, v165
    v_add_f32 v150, v150, v166
    v_add_f32 v151, v151, v167
    v_add_f32 v152, v152, v168
    v_add_f32 v153, v153, v169
    v_add_f32 v154, v154, v170
    v_add_f32 v155, v155, v171
    v_add_f32 v156, v156, v172
    v_add_f32 v157, v157, v173
    v_add_f32 v158, v158, v174
    v_add_f32 v159, v159, v175
    v_add_f32 v144, v144, v152
    v_add_f32 v145, v145, v153
    v_add_f32 v146, v146, v154
    v_add_f32 v147, v147, v155
    v_add_f32 v148, v148, v156
    v_add_f32 v149, v149, v157
    v_add_f32 v150, v150, v158
    v_add_f32 v151, v151, v159
    v_add_f32 v144, v144, v148
    v_add_f32 v145, v145, v149
    v_add_f32 v146, v146, v150
    v_add_f32 v147, v147, v151
    v_mov_b32 v72, v144
    v_mov_b32 v73, v145
    v_mov_b32 v74, v146
    v_mov_b32 v75, v147
    v_cvt_pk_bf16_f32 v72, 0, v72
    v_cvt_pk_bf16_f32 v73, 0, v73
    v_cvt_pk_bf16_f32 v74, 0, v74
    v_cvt_pk_bf16_f32 v75, 0, v75
    v_mul_f32 v72, v72, v52
    v_mul_f32 v73, v73, v53
    v_mul_f32 v74, v74, v54
    v_mul_f32 v75, v75, v55
    v_cvt_pk_bf16_f32 v72, 0, v72
    v_cvt_pk_bf16_f32 v73, 0, v73
    v_cvt_pk_bf16_f32 v74, 0, v74
    v_cvt_pk_bf16_f32 v75, 0, v75
    v_add_f32 v72, v72, v48
    v_add_f32 v73, v73, v49
    v_add_f32 v74, v74, v50
    v_add_f32 v75, v75, v51
    v_cvt_pk_bf16_f32 v72, 0, v72
    v_cvt_pk_bf16_f32 v73, 0, v73
    v_cvt_pk_bf16_f32 v74, 0, v74
    v_cvt_pk_bf16_f32 v75, 0, v75
    v_lshlrev_b32 v35, 4, v0
    s_mul_i32 s65, s55, 7168
    s_add_u32 s65, s65, 215040
    s_add_u32 s66, s65, 4096
    v_bfe_u32 v40, s57, 0, 8
    v_bfe_u32 v41, s57, 8, 8
    v_bfe_u32 v42, s57, 16, 8
    v_bfe_u32 v43, s57, 24, 8
    s_min_u32 s67, s54, 13
    s_lshl_b32 s68, s52, 4
    s_add_u32 s67, s67, s68
    s_lshl_b32 s67, s67, 7
    s_add_u32 s67, s67, 198656
    s_mov_b32 s63, 60000
hw_55:
    s_load_dword s68, s[48:49], s67 glc
    s_waitcnt lgkmcnt(0)
    s_cmp_eq_u32 s68, s57
    s_cbranch_scc1 hd_56
    s_sub_u32 s63, s63, 1
    s_cbranch_scc0 hw_55
hd_56:
    s_mov_b32 s63, 60000
poll_57:
    buffer_load_dwordx4 v[96:99], v35, s[48:51], s65 offen offset:0 sc1
    buffer_load_dwordx4 v[100:103], v35, s[48:51], s65 offen offset:1024 sc1
    buffer_load_dwordx4 v[104:107], v35, s[48:51], s65 offen offset:2048 sc1
    buffer_load_dwordx4 v[108:111], v35, s[48:51], s65 offen offset:3072 sc1
    buffer_load_dwordx4 v[112:115], v35, s[48:51], s66 offen offset:0 sc1
    buffer_load_dwordx4 v[116:119], v35, s[48:51], s66 offen offset:1024 sc1
    buffer_load_dwordx4 v[120:123], v35, s[48:51], s66 offen offset:2048 sc1
    s_waitcnt vmcnt(0)
    v_xor_b32 v96, v96, v40
    v_xor_b32 v97, v97, v41
    v_xor_b32 v98, v98, v42
    v_xor_b32 v99, v99, v43
    v_xor_b32 v100, v100, v40
    v_xor_b32 v101, v101, v41
    v_xor_b32 v102, v102, v42
    v_xor_b32 v103, v103, v43
    v_xor_b32 v104, v104, v40
    v_xor_b32 v105, v105, v41
    v_xor_b32 v106, v106, v42
    v_xor_b32 v107, v107, v43
    v_xor_b32 v108, v108, v40
    v_xor_b32 v109, v109, v41
    v_xor_b32 v110, v110, v42
    v_xor_b32 v111, v111, v43
    v_xor_b32 v112, v112, v40
    v_xor_b32 v113, v113, v41
    v_xor_b32 v114, v114, v42
    v_xor_b32 v115, v115, v43
    v_xor_b32 v116, v116, v40
    v_xor_b32 v117, v117, v41
    v_xor_b32 v118, v118, v42
    v_xor_b32 v119, v119, v43
    v_xor_b32 v120, v120, v40
    v_xor_b32 v121, v121, v41
    v_xor_b32 v122, v122, v42
    v_xor_b32 v123, v123, v43
    v_or3_b32 v47, v96, v97, v98
    v_or3_b32 v46, v99, v100, v101
    v_or3_b32 v47, v47, v102, v103
    v_or3_b32 v46, v46, v104, v105
    v_or3_b32 v47, v47, v106, v107
    v_or3_b32 v46, v46, v108, v109
    v_or3_b32 v47, v47, v110, v111
    v_or3_b32 v46, v46, v112, v113
    v_or3_b32 v47, v47, v114, v115
    v_or3_b32 v46, v46, v116, v117
    v_or3_b32 v47, v47, v118, v119
    v_or3_b32 v46, v46, v120, v121
    v_or3_b32 v47, v47, v122, v123
    v_or_b32 v47, v47, v46
    v_and_b32 v47, 0xff, v47
    v_cmp_ne_u32 vcc, 0, v47
    s_cbranch_vccz pdone_58
    s_sub_u32 s63, s63, 1
    s_cbranch_scc0 poll_57
pdone_58:
    v_add_f32 v96, v96, v100
    v_add_f32 v104, v104, v108
    v_add_f32 v112, v112, v116
    v_add_f32 v97, v97, v101
    v_add_f32 v105, v105, v109
    v_add_f32 v113, v113, v117
    v_add_f32 v98, v98, v102
    v_add_f32 v106, v106, v110
    v_add_f32 v114, v114, v118
    v_add_f32 v99, v99, v103
    v_add_f32 v107, v107, v111
    v_add_f32 v115, v115, v119
    v_add_f32 v96, v96, v104
    v_add_f32 v112, v112, v120
    v_add_f32 v97, v97, v105
    v_add_f32 v113, v113, v121
    v_add_f32 v98, v98, v106
    v_add_f32 v114, v114, v122
    v_add_f32 v99, v99, v107
    v_add_f32 v115, v115, v123
    v_add_f32 v96, v96, v112
    v_add_f32 v97, v97, v113
    v_add_f32 v98, v98, v114
    v_add_f32 v99, v99, v115
    v_add_f32_dpp v96, v96, v96 row_ror:8 row_mask:0xf bank_mask:0xf
    v_add_f32_dpp v97, v97, v97 row_ror:8 row_mask:0xf bank_mask:0xf
    v_add_f32_dpp v98, v98, v98 row_ror:8 row_mask:0xf bank_mask:0xf
    v_add_f32_dpp v99, v99, v99 row_ror:8 row_mask:0xf bank_mask:0xf
    v_mov_b32 v100, v96
    v_mov_b32 v101, v97
    v_mov_b32 v102, v98
    v_mov_b32 v103, v99
    v_permlane16_swap_b32 v100, v96
    v_permlane16_swap_b32 v101, v97
    v_permlane16_swap_b32 v102, v98
    v_permlane16_swap_b32 v103, v99
    v_add_f32 v96, v96, v100
    v_add_f32 v97, v97, v101
    v_add_f32 v98, v98, v102
    v_add_f32 v99, v99, v103
    v_mov_b32 v100, v96
    v_mov_b32 v101, v97
    v_mov_b32 v102, v98
    v_mov_b32 v103, v99
    v_permlane32_swap_b32 v100, v96
    v_permlane32_swap_b32 v101, v97
    v_permlane32_swap_b32 v102, v98
    v_permlane32_swap_b32 v103, v99
    v_add_f32 v96, v96, v100
    v_add_f32 v97, v97, v101
    v_add_f32 v98, v98, v102
    v_add_f32 v99, v99, v103
    v_cvt_pk_bf16_f32 v96, 0, v96
    v_cvt_pk_bf16_f32 v97, 0, v97
    v_cvt_pk_bf16_f32 v98, 0, v98
    v_cvt_pk_bf16_f32 v99, 0, v99
    v_mul_f32 v96, v96, v56
    v_mul_f32 v97, v97, v57
    v_mul_f32 v98, v98, v58
    v_mul_f32 v99, v99, v59
    v_cvt_pk_bf16_f32 v96, 0, v96
    v_cvt_pk_bf16_f32 v97, 0, v97
    v_cvt_pk_bf16_f32 v98, 0, v98
    v_cvt_pk_bf16_f32 v99, 0, v99
    v_add_f32 v96, v96, v72
    v_add_f32 v97, v97, v73
    v_add_f32 v98, v98, v74
    v_add_f32 v99, v99, v75
    v_cvt_pk_bf16_f32 v100, v96, v97
    v_cvt_pk_bf16_f32 v101, v98, v99
    s_mov_b32 exec_lo, 0xff
    s_mov_b32 exec_hi, 0x0
    buffer_store_dwordx2 v[100:101], v34, s[44:47], s64 offen
    s_mov_b64 exec, -1
    s_branch L_fin
L_pv:
    s_mov_b32 s10, 33554432
    s_mov_b32 s11, 0x00020000
    s_lshl_b32 s78, s54, 18
    s_lshl_b32 s64, s52, 22
    s_add_u32 s12, s78, 0
    s_and_b32 s12, s12, 0x3fffff
    s_or_b32 s12, s12, s64
    s_add_u32 s13, s78, 294912
    s_and_b32 s13, s13, 0x3fffff
    s_or_b32 s13, s13, s64
    s_add_u32 s14, s78, 589824
    s_and_b32 s14, s14, 0x3fffff
    s_or_b32 s14, s14, s64
    s_add_u32 s15, s78, 884736
    s_and_b32 s15, s15, 0x3fffff
    s_or_b32 s15, s15, s64
    s_add_u32 s16, s78, 1179648
    s_and_b32 s16, s16, 0x3fffff
    s_or_b32 s16, s16, s64
    s_add_u32 s17, s78, 1474560
    s_and_b32 s17, s17, 0x3fffff
    s_or_b32 s17, s17, s64
    s_add_u32 s18, s78, 1769472
    s_and_b32 s18, s18, 0x3fffff
    s_or_b32 s18, s18, s64
    s_add_u32 s19, s78, 2064384
    s_and_b32 s19, s19, 0x3fffff
    s_or_b32 s19, s19, s64
    s_and_b32 s79, s56, 3
    s_lshl_b32 s69, s79, 13
    s_and_b32 s64, s79, 1
    s_cmp_eq_u32 s64, 1
    s_cselect_b32 s65, 3, 0
    v_xor_b32 v48, s65, v0
    v_lshlrev_b32 v48, 4, v48
    v_add_u32 v48, s69, v48
    s_cselect_b32 s65, 7, 4
    v_xor_b32 v49, s65, v0
    v_lshlrev_b32 v49, 4, v49
    v_add_u32 v49, s69, v49
    s_cselect_b32 s65, 11, 8
    v_xor_b32 v50, s65, v0
    v_lshlrev_b32 v50, 4, v50
    v_add_u32 v50, s69, v50
    s_cselect_b32 s65, 15, 12
    v_xor_b32 v51, s65, v0
    v_lshlrev_b32 v51, 4, v51
    v_add_u32 v51, s69, v51
    s_cselect_b32 s65, 1, 2
    v_xor_b32 v52, s65, v0
    v_lshlrev_b32 v52, 4, v52
    v_add_u32 v52, s69, v52
    v_add_u32 v52, 4096, v52
    s_cselect_b32 s65, 5, 6
    v_xor_b32 v53, s65, v0
    v_lshlrev_b32 v53, 4, v53
    v_add_u32 v53, s69, v53
    v_add_u32 v53, 4096, v53
    s_cselect_b32 s65, 9, 10
    v_xor_b32 v54, s65, v0
    v_lshlrev_b32 v54, 4, v54
    v_add_u32 v54, s69, v54
    v_add_u32 v54, 4096, v54
    s_cselect_b32 s65, 13, 14
    v_xor_b32 v55, s65, v0
    v_lshlrev_b32 v55, 4, v55
    v_add_u32 v55, s69, v55
    v_add_u32 v55, 4096, v55
    s_waitcnt lgkmcnt(0)
    s_load_dword s57, s[48:49], 0
    s_load_dwordx2 s[28:29], s[0:1], 56
    s_load_dwordx2 s[32:33], s[0:1], 64
    s_mov_b32 s30, 1835008
    s_mov_b32 s31, 0x00020000
    s_mov_b32 s34, 1835008
    s_mov_b32 s35, 0x00020000
    s_mov_b32 s72, 0
L_pv_start:
    s_add_u32 m0, s69, 0
    s_nop 0
    buffer_load_dwordx4 v48, s[8:11], s12 offen nt lds
    buffer_load_dwordx4 v49, s[8:11], s12 offen offset:1024 nt lds
    buffer_load_dwordx4 v50, s[8:11], s12 offen offset:2048 nt lds
    buffer_load_dwordx4 v51, s[8:11], s12 offen offset:3072 nt lds
    s_add_u32 m0, s69, 4096
    s_nop 0
    buffer_load_dwordx4 v52, s[8:11], s12 offen nt lds
    buffer_load_dwordx4 v53, s[8:11], s12 offen offset:1024 nt lds
    buffer_load_dwordx4 v54, s[8:11], s12 offen offset:2048 nt lds
    buffer_load_dwordx4 v55, s[8:11], s12 offen offset:3072 nt lds
    v_mov_b32 v64, 0
    v_mov_b32 v65, 0
    v_mov_b32 v66, 0
    v_mov_b32 v67, 0
    v_mov_b32 v68, 0
    v_mov_b32 v69, 0
    v_mov_b32 v70, 0
    v_mov_b32 v71, 0
    v_mov_b32 v72, 0
    v_mov_b32 v73, 0
    v_mov_b32 v74, 0
    v_mov_b32 v75, 0
    v_mov_b32 v76, 0
    v_mov_b32 v77, 0
    v_mov_b32 v78, 0
    v_mov_b32 v79, 0
    v_mov_b32 v80, 0
    v_mov_b32 v81, 0
    v_mov_b32 v82, 0
    v_mov_b32 v83, 0
    v_mov_b32 v84, 0
    v_mov_b32 v85, 0
    v_mov_b32 v86, 0
    v_mov_b32 v87, 0
    v_mov_b32 v88, 0
    v_mov_b32 v89, 0
    v_mov_b32 v90, 0
    v_mov_b32 v91, 0
    v_mov_b32 v92, 0
    v_mov_b32 v93, 0
    v_mov_b32 v94, 0
    v_mov_b32 v95, 0
    v_mov_b32 v96, 0
    v_mov_b32 v97, 0
    v_mov_b32 v98, 0
    v_mov_b32 v99, 0
    v_mov_b32 v100, 0
    v_mov_b32 v101, 0
    v_mov_b32 v102, 0
    v_mov_b32 v103, 0
    v_mov_b32 v104, 0
    v_mov_b32 v105, 0
    v_mov_b32 v106, 0
    v_mov_b32 v107, 0
    v_mov_b32 v108, 0
    v_mov_b32 v109, 0
    v_mov_b32 v110, 0
    v_mov_b32 v111, 0
    v_mov_b32 v112, 0
    v_mov_b32 v113, 0
    v_mov_b32 v114, 0
    v_mov_b32 v115, 0
    v_mov_b32 v116, 0
    v_mov_b32 v117, 0
    v_mov_b32 v118, 0
    v_mov_b32 v119, 0
    v_mov_b32 v120, 0
    v_mov_b32 v121, 0
    v_mov_b32 v122, 0
    v_mov_b32 v123, 0
    v_mov_b32 v124, 0
    v_mov_b32 v125, 0
    v_mov_b32 v126, 0
    v_mov_b32 v127, 0
    s_cmp_lg_u32 s72, 0
    s_cbranch_scc1 L_pv_again
    v_lshrrev_b32 v42, 2, v1
    v_and_b32 v43, 3, v1
    v_and_b32 v44, 1, v2
    v_lshrrev_b32 v45, 1, v2
    v_lshl_add_u32 v46, v45, 3, v42
    v_lshlrev_b32 v46, 10, v46
    v_and_b32 v47, 1, v43
    v_lshl_add_u32 v46, v47, 3, v46
    s_lshl_b32 s64, s79, 8
    v_add_u32 v46, s64, v46
    v_lshrrev_b32 v47, 1, v43
    v_lshl_add_u32 v47, v44, 1, v47
    v_lshl_add_u32 v47, v42, 2, v47
    v_cmp_eq_u32 vcc, 1, v45
    v_mov_b32 v56, 0
    v_mov_b32 v57, 3
    v_cndmask_b32 v56, v56, v57, vcc
    v_xor_b32 v56, v56, v47
    v_xor_b32 v24, 0, v56
    v_lshl_add_u32 v24, v24, 4, v46
    v_add_u32 v32, 0x10000, v24
    v_xor_b32 v26, 4, v56
    v_lshl_add_u32 v26, v26, 4, v46
    v_add_u32 v34, 0x10000, v26
    v_xor_b32 v28, 8, v56
    v_lshl_add_u32 v28, v28, 4, v46
    v_add_u32 v36, 0x10000, v28
    v_xor_b32 v30, 12, v56
    v_lshl_add_u32 v30, v30, 4, v46
    v_add_u32 v38, 0x10000, v30
    v_mov_b32 v56, 2
    v_mov_b32 v57, 1
    v_cndmask_b32 v56, v56, v57, vcc
    v_xor_b32 v56, v56, v47
    v_xor_b32 v25, 0, v56
    v_lshl_add_u32 v25, v25, 4, v46
    v_add_u32 v25, 4096, v25
    v_add_u32 v33, 0x10000, v25
    v_xor_b32 v27, 4, v56
    v_lshl_add_u32 v27, v27, 4, v46
    v_add_u32 v27, 4096, v27
    v_add_u32 v35, 0x10000, v27
    v_xor_b32 v29, 8, v56
    v_lshl_add_u32 v29, v29, 4, v46
    v_add_u32 v29, 4096, v29
    v_add_u32 v37, 0x10000, v29
    v_xor_b32 v31, 12, v56
    v_lshl_add_u32 v31, v31, 4, v46
    v_add_u32 v31, 4096, v31
    v_add_u32 v39, 0x10000, v31
    v_lshlrev_b32 v40, 4, v0
    v_add_u32 v40, 131072, v40
    v_mov_b32 v41, 163328
    s_waitcnt lgkmcnt(0)
    s_mul_i32 s57, s57, 0x9e3779b1
    s_add_u32 s57, s57, 0x7f4a7c15
    v_and_b32 v42, 3, v1
    v_lshlrev_b32 v42, 3, v42
    v_lshrrev_b32 v42, v42, s57
    v_bfe_u32 v4, v42, 0, 1
    v_bfe_u32 v43, v42, 1, 1
    v_lshl_or_b32 v4, v43, 16, v4
    v_bfe_u32 v5, v42, 2, 1
    v_bfe_u32 v43, v42, 3, 1
    v_lshl_or_b32 v5, v43, 16, v5
    v_bfe_u32 v6, v42, 4, 1
    v_bfe_u32 v43, v42, 5, 1
    v_lshl_or_b32 v6, v43, 16, v6
    v_bfe_u32 v7, v42, 6, 1
    v_bfe_u32 v43, v42, 7, 1
    v_lshl_or_b32 v7, v43, 16, v7
L_pv_again:
    s_waitcnt vmcnt(8)
    s_add_u32 m0, s69, 65536
    s_nop 0
    buffer_load_dwordx4 v48, s[8:11], s13 offen nt lds
    buffer_load_dwordx4 v49, s[8:11], s13 offen offset:1024 nt lds
    s_waitcnt vmcnt(8)
    s_add_u32 m0, s69, 65536
    s_nop 0
    buffer_load_dwordx4 v50, s[8:11], s13 offen offset:2048 nt lds
    buffer_load_dwordx4 v51, s[8:11], s13 offen offset:3072 nt lds
    s_waitcnt vmcnt(8)
    s_add_u32 m0, s69, 69632
    s_nop 0
    buffer_load_dwordx4 v52, s[8:11], s13 offen nt lds
    buffer_load_dwordx4 v53, s[8:11], s13 offen offset:1024 nt lds
    s_waitcnt vmcnt(8)
    s_add_u32 m0, s69, 69632
    s_nop 0
    buffer_load_dwordx4 v54, s[8:11], s13 offen offset:2048 nt lds
    buffer_load_dwordx4 v55, s[8:11], s13 offen offset:3072 nt lds
    s_waitcnt vmcnt(8)
    s_add_u32 m0, s69, 32768
    s_nop 0
    buffer_load_dwordx4 v48, s[8:11], s14 offen nt lds
    buffer_load_dwordx4 v49, s[8:11], s14 offen offset:1024 nt lds
    s_waitcnt vmcnt(8)
    s_add_u32 m0, s69, 32768
    s_nop 0
    buffer_load_dwordx4 v50, s[8:11], s14 offen offset:2048 nt lds
    buffer_load_dwordx4 v51, s[8:11], s14 offen offset:3072 nt lds
    s_waitcnt vmcnt(8)
    s_add_u32 m0, s69, 36864
    s_nop 0
    buffer_load_dwordx4 v52, s[8:11], s14 offen nt lds
    buffer_load_dwordx4 v53, s[8:11], s14 offen offset:1024 nt lds
    s_waitcnt vmcnt(8)
    s_add_u32 m0, s69, 36864
    s_nop 0
    buffer_load_dwordx4 v54, s[8:11], s14 offen offset:2048 nt lds
    buffer_load_dwordx4 v55, s[8:11], s14 offen offset:3072 nt lds
    s_waitcnt vmcnt(8)
    s_barrier
    ds_read_b64_tr_b16 v[128:129], v24 offset:0
    ds_read_b64_tr_b16 v[130:131], v25 offset:0
    ds_read_b64_tr_b16 v[136:137], v26 offset:0
    ds_read_b64_tr_b16 v[138:139], v27 offset:0
    ds_read_b64_tr_b16 v[144:145], v28 offset:0
    ds_read_b64_tr_b16 v[146:147], v29 offset:0
    ds_read_b64_tr_b16 v[152:153], v30 offset:0
    ds_read_b64_tr_b16 v[154:155], v31 offset:0
    s_waitcnt vmcnt(8)
    s_add_u32 m0, s69, 98304
    s_nop 0
    buffer_load_dwordx4 v48, s[8:11], s15 offen nt lds
    buffer_load_dwordx4 v49, s[8:11], s15 offen offset:1024 nt lds
    ds_read_b64_tr_b16 v[132:133], v24 offset:16384
    ds_read_b64_tr_b16 v[134:135], v25 offset:16384
    ds_read_b64_tr_b16 v[140:141], v26 offset:16384
    ds_read_b64_tr_b16 v[142:143], v27 offset:16384
    ds_read_b64_tr_b16 v[148:149], v28 offset:16384
    ds_read_b64_tr_b16 v[150:151], v29 offset:16384
    ds_read_b64_tr_b16 v[156:157], v30 offset:16384
    ds_read_b64_tr_b16 v[158:159], v31 offset:16384
    s_waitcnt vmcnt(8)
    s_add_u32 m0, s69, 98304
    s_nop 0
    buffer_load_dwordx4 v50, s[8:11], s15 offen offset:2048 nt lds
    buffer_load_dwordx4 v51, s[8:11], s15 offen offset:3072 nt lds
    ds_read_b64_tr_b16 v[160:161], v32 offset:0
    ds_read_b64_tr_b16 v[162:163], v33 offset:0
    ds_read_b64_tr_b16 v[168:169], v34 offset:0
    ds_read_b64_tr_b16 v[170:171], v35 offset:0
    ds_read_b64_tr_b16 v[176:177], v36 offset:0
    ds_read_b64_tr_b16 v[178:179], v37 offset:0
    ds_read_b64_tr_b16 v[184:185], v38 offset:0
    ds_read_b64_tr_b16 v[186:187], v39 offset:0
    s_waitcnt vmcnt(8)
    s_add_u32 m0, s69, 102400
    s_nop 0
    buffer_load_dwordx4 v52, s[8:11], s15 offen nt lds
    buffer_load_dwordx4 v53, s[8:11], s15 offen offset:1024 nt lds
    ds_read_b64_tr_b16 v[164:165], v32 offset:16384
    ds_read_b64_tr_b16 v[166:167], v33 offset:16384
    ds_read_b64_tr_b16 v[172:173], v34 offset:16384
    ds_read_b64_tr_b16 v[174:175], v35 offset:16384
    ds_read_b64_tr_b16 v[180:181], v36 offset:16384
    ds_read_b64_tr_b16 v[182:183], v37 offset:16384
    ds_read_b64_tr_b16 v[188:189], v38 offset:16384
    ds_read_b64_tr_b16 v[190:191], v39 offset:16384
    s_waitcnt lgkmcnt(0)
    s_barrier
    s_waitcnt vmcnt(8)
    s_add_u32 m0, s69, 102400
    s_nop 0
    buffer_load_dwordx4 v54, s[8:11], s15 offen offset:2048 nt lds
    buffer_load_dwordx4 v55, s[8:11], s15 offen offset:3072 nt lds
    s_waitcnt vmcnt(8)
    s_barrier
    ds_read_b64_tr_b16 v[192:193], v24 offset:32768
    ds_read_b64_tr_b16 v[194:195], v25 offset:32768
    ds_read_b64_tr_b16 v[200:201], v26 offset:32768
    ds_read_b64_tr_b16 v[202:203], v27 offset:32768
    ds_read_b64_tr_b16 v[208:209], v28 offset:32768
    ds_read_b64_tr_b16 v[210:211], v29 offset:32768
    ds_read_b64_tr_b16 v[216:217], v30 offset:32768
    ds_read_b64_tr_b16 v[218:219], v31 offset:32768
    ds_read_b64_tr_b16 v[196:197], v24 offset:49152
    ds_read_b64_tr_b16 v[198:199], v25 offset:49152
    ds_read_b64_tr_b16 v[204:205], v26 offset:49152
    ds_read_b64_tr_b16 v[206:207], v27 offset:49152
    ds_read_b64_tr_b16 v[212:213], v28 offset:49152
    ds_read_b64_tr_b16 v[214:215], v29 offset:49152
    ds_read_b64_tr_b16 v[220:221], v30 offset:49152
    ds_read_b64_tr_b16 v[222:223], v31 offset:49152
    s_waitcnt vmcnt(0)
    s_barrier
    ds_read_b64_tr_b16 v[224:225], v32 offset:32768
    ds_read_b64_tr_b16 v[226:227], v33 offset:32768
    ds_read_b64_tr_b16 v[232:233], v34 offset:32768
    ds_read_b64_tr_b16 v[234:235], v35 offset:32768
    ds_read_b64_tr_b16 v[240:241], v36 offset:32768
    ds_read_b64_tr_b16 v[242:243], v37 offset:32768
    ds_read_b64_tr_b16 v[248:249], v38 offset:32768
    ds_read_b64_tr_b16 v[250:251], v39 offset:32768
    ds_read_b64_tr_b16 v[228:229], v32 offset:49152
    ds_read_b64_tr_b16 v[230:231], v33 offset:49152
    ds_read_b64_tr_b16 v[236:237], v34 offset:49152
    ds_read_b64_tr_b16 v[238:239], v35 offset:49152
    ds_read_b64_tr_b16 v[244:245], v36 offset:49152
    ds_read_b64_tr_b16 v[246:247], v37 offset:49152
    ds_read_b64_tr_b16 v[252:253], v38 offset:49152
    ds_read_b64_tr_b16 v[254:255], v39 offset:49152
    s_add_u32 m0, s69, 0
    s_nop 0
    buffer_load_dwordx4 v48, s[8:11], s16 offen nt lds
    s_add_u32 m0, s69, 0
    s_nop 0
    buffer_load_dwordx4 v49, s[8:11], s16 offen offset:1024 nt lds
    s_add_u32 m0, s69, 0
    s_nop 0
    buffer_load_dwordx4 v50, s[8:11], s16 offen offset:2048 nt lds
    s_add_u32 m0, s69, 0
    s_nop 0
    buffer_load_dwordx4 v51, s[8:11], s16 offen offset:3072 nt lds
    s_add_u32 m0, s69, 4096
    s_nop 0
    buffer_load_dwordx4 v52, s[8:11], s16 offen nt lds
    s_add_u32 m0, s69, 4096
    s_nop 0
    buffer_load_dwordx4 v53, s[8:11], s16 offen offset:1024 nt lds
    s_barrier
    s_add_u32 m0, s69, 4096
    s_nop 0
    buffer_load_dwordx4 v54, s[8:11], s16 offen offset:2048 nt lds
    s_add_u32 m0, s69, 4096
    s_nop 0
    buffer_load_dwordx4 v55, s[8:11], s16 offen offset:3072 nt lds
    s_add_u32 m0, s69, 65536
    s_nop 0
    buffer_load_dwordx4 v48, s[8:11], s17 offen nt lds
    s_add_u32 m0, s69, 65536
    s_nop 0
    buffer_load_dwordx4 v49, s[8:11], s17 offen offset:1024 nt lds
    s_add_u32 m0, s69, 65536
    s_nop 0
    buffer_load_dwordx4 v50, s[8:11], s17 offen offset:2048 nt lds
    s_add_u32 m0, s69, 65536
    s_nop 0
    buffer_load_dwordx4 v51, s[8:11], s17 offen offset:3072 nt lds
    s_add_u32 m0, s69, 69632
    s_nop 0
    buffer_load_dwordx4 v52, s[8:11], s17 offen nt lds
    s_add_u32 m0, s69, 69632
    s_nop 0
    buffer_load_dwordx4 v53, s[8:11], s17 offen offset:1024 nt lds
    s_add_u32 m0, s69, 69632
    s_nop 0
    buffer_load_dwordx4 v54, s[8:11], s17 offen offset:2048 nt lds
    s_add_u32 m0, s69, 69632
    s_nop 0
    buffer_load_dwordx4 v55, s[8:11], s17 offen offset:3072 nt lds
    s_waitcnt lgkmcnt(0)
    s_barrier
    s_add_u32 m0, s69, 32768
    s_nop 0
    buffer_load_dwordx4 v48, s[8:11], s18 offen nt lds
    s_add_u32 m0, s69, 32768
    s_nop 0
    buffer_load_dwordx4 v49, s[8:11], s18 offen offset:1024 nt lds
    s_add_u32 m0, s69, 32768
    s_nop 0
    buffer_load_dwordx4 v50, s[8:11], s18 offen offset:2048 nt lds
    s_add_u32 m0, s69, 32768
    s_nop 0
    buffer_load_dwordx4 v51, s[8:11], s18 offen offset:3072 nt lds
    s_waitcnt vmcnt(4)
    s_barrier
    ds_read_b128 v[8:11], v40 offset:0
    ds_read_b128 v[12:15], v40 offset:1024
    ds_read_b128 v[16:19], v40 offset:2048
    ds_read_b128 v[20:23], v40 offset:3072
    s_waitcnt lgkmcnt(0)
    v_mfma_f32_32x32x16_bf16 v[64:79], v[8:11], v[128:131], v[64:79]
    s_add_u32 m0, s69, 36864
    s_nop 0
    buffer_load_dwordx4 v52, s[8:11], s18 offen nt lds
    v_mfma_f32_32x32x16_bf16 v[80:95], v[8:11], v[136:139], v[80:95]
    s_add_u32 m0, s69, 36864
    s_nop 0
    buffer_load_dwordx4 v53, s[8:11], s18 offen offset:1024 nt lds
    v_mfma_f32_32x32x16_bf16 v[96:111], v[8:11], v[144:147], v[96:111]
    s_add_u32 m0, s69, 36864
    s_nop 0
    buffer_load_dwordx4 v54, s[8:11], s18 offen offset:2048 nt lds
    v_mfma_f32_32x32x16_bf16 v[112:127], v[8:11], v[152:155], v[112:127]
    s_add_u32 m0, s69, 36864
    s_nop 0
    buffer_load_dwordx4 v55, s[8:11], s18 offen offset:3072 nt lds
    v_mfma_f32_32x32x16_bf16 v[64:79], v[12:15], v[132:135], v[64:79]
    s_add_u32 m0, s69, 98304
    s_nop 0
    buffer_load_dwordx4 v48, s[8:11], s19 offen nt lds
    v_mfma_f32_32x32x16_bf16 v[80:95], v[12:15], v[140:143], v[80:95]
    s_add_u32 m0, s69, 98304
    s_nop 0
    buffer_load_dwordx4 v49, s[8:11], s19 offen offset:1024 nt lds
    v_mfma_f32_32x32x16_bf16 v[96:111], v[12:15], v[148:151], v[96:111]
    s_add_u32 m0, s69, 98304
    s_nop 0
    buffer_load_dwordx4 v50, s[8:11], s19 offen offset:2048 nt lds
    v_mfma_f32_32x32x16_bf16 v[112:127], v[12:15], v[156:159], v[112:127]
    s_add_u32 m0, s69, 98304
    s_nop 0
    buffer_load_dwordx4 v51, s[8:11], s19 offen offset:3072 nt lds
    v_mfma_f32_32x32x16_bf16 v[64:79], v[16:19], v[160:163], v[64:79]
    v_mfma_f32_32x32x16_bf16 v[80:95], v[16:19], v[168:171], v[80:95]
    v_mfma_f32_32x32x16_bf16 v[96:111], v[16:19], v[176:179], v[96:111]
    v_mfma_f32_32x32x16_bf16 v[112:127], v[16:19], v[184:187], v[112:127]
    v_mfma_f32_32x32x16_bf16 v[64:79], v[20:23], v[164:167], v[64:79]
    s_waitcnt vmcnt(12)
    s_barrier
    ds_read_b128 v[8:11], v40 offset:4096
    ds_read_b128 v[12:15], v40 offset:5120
    ds_read_b128 v[16:19], v40 offset:6144
    ds_read_b128 v[60:63], v40 offset:7168
    v_mfma_f32_32x32x16_bf16 v[80:95], v[20:23], v[172:175], v[80:95]
    v_mfma_f32_32x32x16_bf16 v[96:111], v[20:23], v[180:183], v[96:111]
    v_mfma_f32_32x32x16_bf16 v[112:127], v[20:23], v[188:191], v[112:127]
    s_waitcnt lgkmcnt(0)
    v_mfma_f32_32x32x16_bf16 v[64:79], v[8:11], v[192:195], v[64:79]
    s_add_u32 m0, s69, 102400
    s_nop 0
    buffer_load_dwordx4 v52, s[8:11], s19 offen nt lds
    s_add_u32 m0, s69, 102400
    s_nop 0
    buffer_load_dwordx4 v53, s[8:11], s19 offen offset:1024 nt lds
    s_add_u32 m0, s69, 102400
    s_nop 0
    buffer_load_dwordx4 v54, s[8:11], s19 offen offset:2048 nt lds
    v_mfma_f32_32x32x16_bf16 v[80:95], v[8:11], v[200:203], v[80:95]
    s_add_u32 m0, s69, 102400
    s_nop 0
    buffer_load_dwordx4 v55, s[8:11], s19 offen offset:3072 nt lds
    ds_read_b64_tr_b16 v[128:129], v24 offset:0
    ds_read_b64_tr_b16 v[130:131], v25 offset:0
    v_mfma_f32_32x32x16_bf16 v[96:111], v[8:11], v[208:211], v[96:111]
    ds_read_b64_tr_b16 v[136:137], v26 offset:0
    ds_read_b64_tr_b16 v[138:139], v27 offset:0
    ds_read_b64_tr_b16 v[144:145], v28 offset:0
    v_mfma_f32_32x32x16_bf16 v[112:127], v[8:11], v[216:219], v[112:127]
    ds_read_b64_tr_b16 v[146:147], v29 offset:0
    ds_read_b64_tr_b16 v[152:153], v30 offset:0
    ds_read_b64_tr_b16 v[154:155], v31 offset:0
    v_mfma_f32_32x32x16_bf16 v[64:79], v[12:15], v[196:199], v[64:79]
    ds_read_b64_tr_b16 v[132:133], v24 offset:16384
    ds_read_b64_tr_b16 v[134:135], v25 offset:16384
    v_mfma_f32_32x32x16_bf16 v[80:95], v[12:15], v[204:207], v[80:95]
    ds_read_b64_tr_b16 v[140:141], v26 offset:16384
    ds_read_b64_tr_b16 v[142:143], v27 offset:16384
    ds_read_b64_tr_b16 v[148:149], v28 offset:16384
    v_mfma_f32_32x32x16_bf16 v[96:111], v[12:15], v[212:215], v[96:111]
    ds_read_b64_tr_b16 v[150:151], v29 offset:16384
    ds_read_b64_tr_b16 v[156:157], v30 offset:16384
    ds_read_b64_tr_b16 v[158:159], v31 offset:16384
    v_mfma_f32_32x32x16_bf16 v[112:127], v[12:15], v[220:223], v[112:127]
    ds_read_b64_tr_b16 v[160:161], v32 offset:0
    ds_read_b64_tr_b16 v[162:163], v33 offset:0
    ds_read_b64_tr_b16 v[168:169], v34 offset:0
    v_mfma_f32_32x32x16_bf16 v[64:79], v[16:19], v[224:227], v[64:79]
    ds_read_b64_tr_b16 v[170:171], v35 offset:0
    ds_read_b64_tr_b16 v[176:177], v36 offset:0
    v_mfma_f32_32x32x16_bf16 v[80:95], v[16:19], v[232:235], v[80:95]
    ds_read_b64_tr_b16 v[178:179], v37 offset:0
    ds_read_b64_tr_b16 v[184:185], v38 offset:0
    ds_read_b64_tr_b16 v[186:187], v39 offset:0
    v_mfma_f32_32x32x16_bf16 v[96:111], v[16:19], v[240:243], v[96:111]
    ds_read_b64_tr_b16 v[164:165], v32 offset:16384
    ds_read_b64_tr_b16 v[166:167], v33 offset:16384
    ds_read_b64_tr_b16 v[172:173], v34 offset:16384
    v_mfma_f32_32x32x16_bf16 v[112:127], v[16:19], v[248:251], v[112:127]
    ds_read_b64_tr_b16 v[174:175], v35 offset:16384
    ds_read_b64_tr_b16 v[180:181], v36 offset:16384
    ds_read_b64_tr_b16 v[182:183], v37 offset:16384
    v_mfma_f32_32x32x16_bf16 v[64:79], v[60:63], v[228:231], v[64:79]
    ds_read_b64_tr_b16 v[188:189], v38 offset:16384
    ds_read_b64_tr_b16 v[190:191], v39 offset:16384
    s_waitcnt vmcnt(8)
    s_waitcnt lgkmcnt(0)
    s_barrier
    ds_read_b128 v[8:11], v40 offset:0
    ds_read_b128 v[12:15], v40 offset:1024
    ds_read_b128 v[16:19], v40 offset:2048
    ds_read_b128 v[20:23], v40 offset:3072
    v_mfma_f32_32x32x16_bf16 v[80:95], v[60:63], v[236:239], v[80:95]
    v_mfma_f32_32x32x16_bf16 v[96:111], v[60:63], v[244:247], v[96:111]
    v_mfma_f32_32x32x16_bf16 v[112:127], v[60:63], v[252:255], v[112:127]
    s_waitcnt lgkmcnt(0)
    v_mfma_f32_32x32x16_bf16 v[64:79], v[8:11], v[128:131], v[64:79]
    ds_read_b64_tr_b16 v[192:193], v24 offset:32768
    ds_read_b64_tr_b16 v[194:195], v25 offset:32768
    v_mfma_f32_32x32x16_bf16 v[80:95], v[8:11], v[136:139], v[80:95]
    ds_read_b64_tr_b16 v[200:201], v26 offset:32768
    ds_read_b64_tr_b16 v[202:203], v27 offset:32768
    v_mfma_f32_32x32x16_bf16 v[96:111], v[8:11], v[144:147], v[96:111]
    ds_read_b64_tr_b16 v[208:209], v28 offset:32768
    v_mfma_f32_32x32x16_bf16 v[112:127], v[8:11], v[152:155], v[112:127]
    ds_read_b64_tr_b16 v[210:211], v29 offset:32768
    ds_read_b64_tr_b16 v[216:217], v30 offset:32768
    v_mfma_f32_32x32x16_bf16 v[64:79], v[12:15], v[132:135], v[64:79]
    ds_read_b64_tr_b16 v[218:219], v31 offset:32768
    v_mfma_f32_32x32x16_bf16 v[80:95], v[12:15], v[140:143], v[80:95]
    ds_read_b64_tr_b16 v[196:197], v24 offset:49152
    ds_read_b64_tr_b16 v[198:199], v25 offset:49152
    v_mfma_f32_32x32x16_bf16 v[96:111], v[12:15], v[148:151], v[96:111]
    ds_read_b64_tr_b16 v[204:205], v26 offset:49152
    ds_read_b64_tr_b16 v[206:207], v27 offset:49152
    v_mfma_f32_32x32x16_bf16 v[112:127], v[12:15], v[156:159], v[112:127]
    ds_read_b64_tr_b16 v[212:213], v28 offset:49152
    v_mfma_f32_32x32x16_bf16 v[64:79], v[16:19], v[160:163], v[64:79]
    ds_read_b64_tr_b16 v[214:215], v29 offset:49152
    ds_read_b64_tr_b16 v[220:221], v30 offset:49152
    v_mfma_f32_32x32x16_bf16 v[80:95], v[16:19], v[168:171], v[80:95]
    ds_read_b64_tr_b16 v[222:223], v31 offset:49152
    s_waitcnt vmcnt(0)
    s_barrier
    ds_read_b128 v[8:11], v40 offset:4096
    ds_read_b128 v[12:15], v40 offset:5120
    v_mfma_f32_32x32x16_bf16 v[96:111], v[16:19], v[176:179], v[96:111]
    v_mfma_f32_32x32x16_bf16 v[112:127], v[16:19], v[184:187], v[112:127]
    v_mfma_f32_32x32x16_bf16 v[64:79], v[20:23], v[164:167], v[64:79]
    v_mfma_f32_32x32x16_bf16 v[80:95], v[20:23], v[172:175], v[80:95]
    v_mfma_f32_32x32x16_bf16 v[96:111], v[20:23], v[180:183], v[96:111]
    v_mfma_f32_32x32x16_bf16 v[112:127], v[20:23], v[188:191], v[112:127]
    s_waitcnt lgkmcnt(0)
    v_mfma_f32_32x32x16_bf16 v[64:79], v[8:11], v[192:195], v[64:79]
    ds_read_b64_tr_b16 v[224:225], v32 offset:32768
    ds_read_b64_tr_b16 v[226:227], v33 offset:32768
    ds_read_b64_tr_b16 v[232:233], v34 offset:32768
    v_mfma_f32_32x32x16_bf16 v[80:95], v[8:11], v[200:203], v[80:95]
    ds_read_b64_tr_b16 v[234:235], v35 offset:32768
    ds_read_b64_tr_b16 v[240:241], v36 offset:32768
    ds_read_b64_tr_b16 v[242:243], v37 offset:32768
    v_mfma_f32_32x32x16_bf16 v[96:111], v[8:11], v[208:211], v[96:111]
    ds_read_b64_tr_b16 v[248:249], v38 offset:32768
    ds_read_b64_tr_b16 v[250:251], v39 offset:32768
    v_mfma_f32_32x32x16_bf16 v[112:127], v[8:11], v[216:219], v[112:127]
    ds_read_b64_tr_b16 v[228:229], v32 offset:49152
    ds_read_b64_tr_b16 v[230:231], v33 offset:49152
    ds_read_b64_tr_b16 v[236:237], v34 offset:49152
    v_mfma_f32_32x32x16_bf16 v[64:79], v[12:15], v[196:199], v[64:79]
    ds_read_b64_tr_b16 v[238:239], v35 offset:49152
    ds_read_b64_tr_b16 v[244:245], v36 offset:49152
    ds_read_b64_tr_b16 v[246:247], v37 offset:49152
    v_mfma_f32_32x32x16_bf16 v[80:95], v[12:15], v[204:207], v[80:95]
    ds_read_b64_tr_b16 v[252:253], v38 offset:49152
    ds_read_b64_tr_b16 v[254:255], v39 offset:49152
    v_lshrrev_b32 v44, 1, v2
    v_and_b32 v45, 1, v2
    v_lshl_add_u32 v44, v44, 2, v45
    v_lshlrev_b32 v44, 17, v44
    v_lshl_add_u32 v44, v1, 4, v44
    s_lshl_b32 s65, s79, 15
    s_lshl_b32 s66, s55, 8
    s_add_u32 s65, s65, s66
    s_add_u32 s65, s65, 4194304
    s_mov_b32 s67, 0x00010001
    s_barrier
    ds_read_b32 v42, v41
    ds_read_b128 v[16:19], v40 offset:6144
    ds_read_b128 v[60:63], v40 offset:7168
    v_mfma_f32_32x32x16_bf16 v[96:111], v[12:15], v[212:215], v[96:111]
    v_mfma_f32_32x32x16_bf16 v[112:127], v[12:15], v[220:223], v[112:127]
    s_waitcnt lgkmcnt(0)
    v_readfirstlane_b32 s64, v42
    s_cmp_lg_u32 s64, 0
    s_cbranch_scc1 L_pv_redo
    v_mfma_f32_32x32x16_bf16 v[64:79], v[16:19], v[224:227], v[64:79]
    v_mfma_f32_32x32x16_bf16 v[80:95], v[16:19], v[232:235], v[80:95]
    v_mfma_f32_32x32x16_bf16 v[96:111], v[16:19], v[240:243], v[96:111]
    v_mfma_f32_32x32x16_bf16 v[112:127], v[16:19], v[248:251], v[112:127]
    v_mfma_f32_32x32x16_bf16 v[64:79], v[60:63], v[228:231], v[64:79]
    v_mfma_f32_32x32x16_bf16 v[80:95], v[60:63], v[236:239], v[80:95]
    v_mfma_f32_32x32x16_bf16 v[96:111], v[60:63], v[244:247], v[96:111]
    v_mfma_f32_32x32x16_bf16 v[112:127], v[60:63], v[252:255], v[112:127]
    s_nop 9
    v_cvt_pk_bf16_f32 v160, v64, v80
    v_cvt_pk_bf16_f32 v161, v65, v81
    v_cvt_pk_bf16_f32 v162, v96, v112
    v_cvt_pk_bf16_f32 v163, v97, v113
    s_barrier
    v_cvt_pk_bf16_f32 v164, v66, v82
    v_cvt_pk_bf16_f32 v165, v67, v83
    v_cvt_pk_bf16_f32 v166, v98, v114
    v_cvt_pk_bf16_f32 v167, v99, v115
    v_permlane16_swap_b32 v160, v161
    v_permlane16_swap_b32 v162, v163
    v_bfi_b32 v160, s67, v4, v160
    v_bfi_b32 v161, s67, v5, v161
    v_bfi_b32 v162, s67, v6, v162
    v_bfi_b32 v163, s67, v7, v163
    s_add_u32 s66, s65, 0
    buffer_store_dwordx4 v[160:163], v44, s[48:51], s66 offen sc1
    v_cvt_pk_bf16_f32 v168, v68, v84
    v_cvt_pk_bf16_f32 v169, v69, v85
    v_cvt_pk_bf16_f32 v170, v100, v116
    v_cvt_pk_bf16_f32 v171, v101, v117
    v_permlane16_swap_b32 v164, v165
    v_permlane16_swap_b32 v166, v167
    v_bfi_b32 v164, s67, v4, v164
    v_bfi_b32 v165, s67, v5, v165
    v_bfi_b32 v166, s67, v6, v166
    v_bfi_b32 v167, s67, v7, v167
    s_add_u32 s66, s65, 262144
    buffer_store_dwordx4 v[164:167], v44, s[48:51], s66 offen sc1
    v_cvt_pk_bf16_f32 v172, v70, v86
    v_cvt_pk_bf16_f32 v173, v71, v87
    v_cvt_pk_bf16_f32 v174, v102, v118
    v_cvt_pk_bf16_f32 v175, v103, v119
    v_permlane16_swap_b32 v168, v169
    v_permlane16_swap_b32 v170, v171
    v_bfi_b32 v168, s67, v4, v168
    v_bfi_b32 v169, s67, v5, v169
    v_bfi_b32 v170, s67, v6, v170
    v_bfi_b32 v171, s67, v7, v171
    s_add_u32 s66, s65, 1048576
    buffer_store_dwordx4 v[168:171], v44, s[48:51], s66 offen sc1
    v_cvt_pk_bf16_f32 v176, v72, v88
    v_cvt_pk_bf16_f32 v177, v73, v89
    v_cvt_pk_bf16_f32 v178, v104, v120
    v_cvt_pk_bf16_f32 v179, v105, v121
    v_permlane16_swap_b32 v172, v173
    v_permlane16_swap_b32 v174, v175
    v_bfi_b32 v172, s67, v4, v172
    v_bfi_b32 v173, s67, v5, v173
    v_bfi_b32 v174, s67, v6, v174
    v_bfi_b32 v175, s67, v7, v175
    s_add_u32 s66, s65, 1310720
    buffer_store_dwordx4 v[172:175], v44, s[48:51], s66 offen sc1
    v_cvt_pk_bf16_f32 v180, v74, v90
    v_cvt_pk_bf16_f32 v181, v75, v91
    v_cvt_pk_bf16_f32 v182, v106, v122
    v_cvt_pk_bf16_f32 v183, v107, v123
    v_permlane16_swap_b32 v176, v177
    v_permlane16_swap_b32 v178, v179
    v_bfi_b32 v176, s67, v4, v176
    v_bfi_b32 v177, s67, v5, v177
    v_bfi_b32 v178, s67, v6, v178
    v_bfi_b32 v179, s67, v7, v179
    s_add_u32 s66, s65, 2097152
    buffer_store_dwordx4 v[176:179], v44, s[48:51], s66 offen sc1
    v_cvt_pk_bf16_f32 v184, v76, v92
    v_cvt_pk_bf16_f32 v185, v77, v93
    v_cvt_pk_bf16_f32 v186, v108, v124
    v_cvt_pk_bf16_f32 v187, v109, v125
    v_permlane16_swap_b32 v180, v181
    v_permlane16_swap_b32 v182, v183
    v_bfi_b32 v180, s67, v4, v180
    v_bfi_b32 v181, s67, v5, v181
    v_bfi_b32 v182, s67, v6, v182
    v_bfi_b32 v183, s67, v7, v183
    s_add_u32 s66, s65, 2359296
    buffer_store_dwordx4 v[180:183], v44, s[48:51], s66 offen sc1
    v_cvt_pk_bf16_f32 v188, v78, v94
    v_cvt_pk_bf16_f32 v189, v79, v95
    v_cvt_pk_bf16_f32 v190, v110, v126
    v_cvt_pk_bf16_f32 v191, v111, v127
    v_permlane16_swap_b32 v184, v185
    v_permlane16_swap_b32 v186, v187
    v_bfi_b32 v184, s67, v4, v184
    v_bfi_b32 v185, s67, v5, v185
    v_bfi_b32 v186, s67, v6, v186
    v_bfi_b32 v187, s67, v7, v187
    s_add_u32 s66, s65, 3145728
    buffer_store_dwordx4 v[184:187], v44, s[48:51], s66 offen sc1
    v_permlane16_swap_b32 v188, v189
    v_permlane16_swap_b32 v190, v191
    v_bfi_b32 v188, s67, v4, v188
    v_bfi_b32 v189, s67, v5, v189
    v_bfi_b32 v190, s67, v6, v190
    v_bfi_b32 v191, s67, v7, v191
    s_add_u32 s66, s65, 3407872
    buffer_store_dwordx4 v[188:191], v44, s[48:51], s66 offen sc1
    s_branch L_att_post
L_pv_redo:
    s_waitcnt vmcnt(0) lgkmcnt(0)
    s_barrier
    s_mov_b32 s72, 1
    s_nop 7
    s_branch L_pv_start
L_qk:
    s_load_dword s57, s[48:49], 0
    s_load_dwordx2 s[28:29], s[0:1], 56
    s_load_dwordx2 s[32:33], s[0:1], 64
    s_load_dwordx2 s[24:25], s[0:1], 40
    s_load_dwordx2 s[20:21], s[0:1], 32
    s_mov_b32 s30, 1835008
    s_mov_b32 s31, 0x00020000
    s_mov_b32 s34, 1835008
    s_mov_b32 s35, 0x00020000
    s_mov_b32 s26, 4194304
    s_mov_b32 s27, 0x00020000
    s_mov_b32 s22, 4194304
    s_mov_b32 s23, 0x00020000
    v_and_b32 v32, 3, v1
    v_lshlrev_b32 v32, 2, v32
    v_lshrrev_b32 v33, 2, v1
    v_lshlrev_b32 v33, 1, v33
    v_mov_b32 v34, 120
    v_lshrrev_b32 v33, v33, v34
    v_and_b32 v33, 3, v33
    v_or_b32 v32, v32, v33
    v_xor_b32 v32, v32, v2
    v_lshlrev_b32 v33, 10, v1
    s_and_b32 s64, s56, 1
    s_lshl_b32 s64, s64, 14
    s_lshr_b32 s65, s56, 1
    s_lshl_b32 s65, s65, 16
    s_add_u32 s64, s64, s65
    v_add_u32 v33, s64, v33
    v_xor_b32 v48, 0, v32
    v_lshl_add_u32 v48, v48, 4, v33
    v_xor_b32 v49, 4, v32
    v_lshl_add_u32 v49, v49, 4, v33
    v_xor_b32 v50, 8, v32
    v_lshl_add_u32 v50, v50, 4, v33
    v_xor_b32 v51, 12, v32
    v_lshl_add_u32 v51, v51, 4, v33
    v_add_u32 v30, 131072, v16
    v_lshlrev_b32 v53, 4, v0
    v_add_u32 v53, 131072, v53
    v_lshlrev_b32 v55, 4, v1
    v_add_u32 v55, 162816, v55
    v_and_b32 v54, 31, v0
    v_lshlrev_b32 v54, 4, v54
    s_lshl_b32 s64, s56, 2
    s_add_u32 s64, s64, 162816
    v_add_u32 v54, s64, v54
    v_mov_b32 v31, 163328
    v_lshlrev_b32 v52, 6, v1
    v_lshl_add_u32 v52, v2, 4, v52
    s_lshl_b32 s64, s56, 12
    v_add_u32 v57, s64, v53
    s_waitcnt lgkmcnt(0)
    s_mul_i32 s57, s57, 0x9e3779b1
    s_add_u32 s57, s57, 0x7f4a7c15
    s_mov_b32 s72, 0
L_qk_start:
    v_mov_b32 v26, 0
    v_mov_b32 v27, 0
    v_mov_b32 v28, 0
    v_mov_b32 v29, 0
    v_mov_b32 v40, 0
    v_mov_b32 v41, 0
    ds_write_b64 v31, v[40:41]
    s_barrier
    ds_read_b128 v[192:195], v48 offset:0
    ds_read_b128 v[196:199], v49 offset:0
    ds_read_b128 v[200:203], v50 offset:0
    ds_read_b128 v[204:207], v51 offset:0
    ds_read_b128 v[208:211], v48 offset:256
    ds_read_b128 v[212:215], v49 offset:256
    ds_read_b128 v[216:219], v50 offset:256
    ds_read_b128 v[220:223], v51 offset:256
    ds_read_b128 v[224:227], v48 offset:512
    ds_read_b128 v[228:231], v49 offset:512
    ds_read_b128 v[232:235], v50 offset:512
    ds_read_b128 v[236:239], v51 offset:512
    ds_read_b128 v[240:243], v48 offset:768
    ds_read_b128 v[244:247], v49 offset:768
    ds_read_b128 v[248:251], v50 offset:768
    ds_read_b128 v[252:255], v51 offset:768
    s_waitcnt lgkmcnt(0)
    s_barrier
    s_cmp_lg_u32 s72, 0
    s_cbranch_scc1 L_noq
    s_lshl_b32 s64, s55, 7
    s_add_u32 s64, s64, 98304
    s_not_b32 s65, s57
    s_lshl_b32 s68, s52, 18
    s_add_u32 s68, s68, 2097152
    s_add_u32 s78, s68, 31744
    s_lshl_b32 s69, s56, 12
    s_add_u32 s68, s68, s69
    s_add_u32 s69, s68, 16384
    s_mov_b32 s63, 60000
    s_cmp_lg_u32 s56, 0
    s_cbranch_scc1 foll_60
poll_59:
    s_load_dwordx16 s[8:23], s[48:49], s64 glc
    s_waitcnt lgkmcnt(0)
    s_mov_b32 s66, s57
    s_mov_b32 s67, s65
    s_xor_b64 s[8:9], s[8:9], s[66:67]
    s_xor_b64 s[10:11], s[10:11], s[66:67]
    s_xor_b64 s[12:13], s[12:13], s[66:67]
    s_xor_b64 s[14:15], s[14:15], s[66:67]
    s_xor_b64 s[16:17], s[16:17], s[66:67]
    s_xor_b64 s[18:19], s[18:19], s[66:67]
    s_xor_b64 s[20:21], s[20:21], s[66:67]
    s_xor_b64 s[22:23], s[22:23], s[66:67]
    s_or_b64 s[8:9], s[8:9], s[16:17]
    s_or_b64 s[10:11], s[10:11], s[18:19]
    s_or_b64 s[12:13], s[12:13], s[20:21]
    s_or_b64 s[14:15], s[14:15], s[22:23]
    s_or_b64 s[8:9], s[8:9], s[12:13]
    s_or_b64 s[10:11], s[10:11], s[14:15]
    s_or_b64 s[8:9], s[8:9], s[10:11]
    s_cbranch_scc0 seen_61
    s_sub_u32 s63, s63, 1
    s_cbranch_scc0 poll_59
seen_61:
    ds_write_b32 v31, v31 offset:4
foll_60:
    s_load_dwordx2 s[20:21], s[0:1], 32
    s_mov_b32 s22, 4194304
    s_mov_b32 s23, 0x00020000
    s_barrier
    buffer_load_dwordx4 v[156:159], v52, s[48:51], s68 offen offset:0 sc1
    buffer_load_dwordx4 v[160:163], v52, s[48:51], s68 offen offset:1024 sc1
    buffer_load_dwordx4 v[164:167], v52, s[48:51], s68 offen offset:2048 sc1
    buffer_load_dwordx4 v[168:171], v52, s[48:51], s68 offen offset:3072 sc1
    buffer_load_dwordx4 v[172:175], v52, s[48:51], s69 offen offset:0 sc1
    buffer_load_dwordx4 v[176:179], v52, s[48:51], s69 offen offset:1024 sc1
    buffer_load_dwordx4 v[180:183], v52, s[48:51], s69 offen offset:2048 sc1
    buffer_load_dwordx4 v[184:187], v52, s[48:51], s69 offen offset:3072 sc1
    buffer_load_dwordx4 v[188:191], v52, s[48:51], s78 offen sc1
    s_barrier
    s_waitcnt vmcnt(8)
    ds_write_b128 v57, v[156:159] offset:0
    s_waitcnt vmcnt(7)
    ds_write_b128 v57, v[160:163] offset:1024
    s_waitcnt vmcnt(6)
    ds_write_b128 v57, v[164:167] offset:2048
    s_waitcnt vmcnt(5)
    ds_write_b128 v57, v[168:171] offset:3072
    s_waitcnt vmcnt(4)
    ds_write_b128 v57, v[172:175] offset:16384
    s_waitcnt vmcnt(3)
    ds_write_b128 v57, v[176:179] offset:17408
    s_waitcnt vmcnt(2)
    ds_write_b128 v57, v[180:183] offset:18432
    s_waitcnt vmcnt(1)
    s_cmp_eq_u32 s56, 3
    s_cbranch_scc1 wi_62
    ds_write_b128 v57, v[184:187] offset:19456
wi_62:
    s_mov_b32 s63, 60000
    s_waitcnt vmcnt(0)
poll_64:
    v_max3_u32 v40, v156, v160, v164
    v_max3_u32 v40, v40, v168, v172
    v_max3_u32 v40, v40, v176, v180
    v_max3_u32 v40, v40, v184, v188
    v_cmp_eq_u32 vcc, -1, v40
    s_cbranch_vccz pdone_65
    v_cmp_eq_u32 vcc, -1, v156
    s_cbranch_vccz qn_66
    buffer_load_dwordx4 v[156:159], v52, s[48:51], s68 offen offset:0 sc1
qn_66:
    v_cmp_eq_u32 vcc, -1, v160
    s_cbranch_vccz qn_67
    buffer_load_dwordx4 v[160:163], v52, s[48:51], s68 offen offset:1024 sc1
qn_67:
    v_cmp_eq_u32 vcc, -1, v164
    s_cbranch_vccz qn_68
    buffer_load_dwordx4 v[164:167], v52, s[48:51], s68 offen offset:2048 sc1
qn_68:
    v_cmp_eq_u32 vcc, -1, v168
    s_cbranch_vccz qn_69
    buffer_load_dwordx4 v[168:171], v52, s[48:51], s68 offen offset:3072 sc1
qn_69:
    v_cmp_eq_u32 vcc, -1, v172
    s_cbranch_vccz qn_70
    buffer_load_dwordx4 v[172:175], v52, s[48:51], s69 offen offset:0 sc1
qn_70:
    v_cmp_eq_u32 vcc, -1, v176
    s_cbranch_vccz qn_71
    buffer_load_dwordx4 v[176:179], v52, s[48:51], s69 offen offset:1024 sc1
qn_71:
    v_cmp_eq_u32 vcc, -1, v180
    s_cbranch_vccz qn_72
    buffer_load_dwordx4 v[180:183], v52, s[48:51], s69 offen offset:2048 sc1
qn_72:
    v_cmp_eq_u32 vcc, -1, v184
    s_cbranch_vccz qn_73
    buffer_load_dwordx4 v[184:187], v52, s[48:51], s69 offen offset:3072 sc1
qn_73:
    v_cmp_eq_u32 vcc, -1, v188
    s_cbranch_vccz qn_74
    buffer_load_dwordx4 v[188:191], v52, s[48:51], s78 offen sc1
qn_74:
    s_waitcnt vmcnt(0)
    ds_write_b128 v57, v[156:159] offset:0
    ds_write_b128 v57, v[160:163] offset:1024
    ds_write_b128 v57, v[164:167] offset:2048
    ds_write_b128 v57, v[168:171] offset:3072
    ds_write_b128 v57, v[172:175] offset:16384
    ds_write_b128 v57, v[176:179] offset:17408
    ds_write_b128 v57, v[180:183] offset:18432
    s_cmp_eq_u32 s56, 3
    s_cbranch_scc1 wi_75
    ds_write_b128 v57, v[184:187] offset:19456
wi_75:
    s_sub_u32 s63, s63, 1
    s_cbranch_scc0 poll_64
pdone_65:
    s_branch L_go
L_noq:
    s_barrier
    s_barrier
    ds_write_b128 v53, v[64:67] offset:0
    ds_write_b128 v53, v[68:71] offset:1024
    ds_write_b128 v53, v[72:75] offset:2048
    ds_write_b128 v53, v[76:79] offset:3072
    ds_write_b128 v53, v[80:83] offset:4096
    ds_write_b128 v53, v[84:87] offset:5120
    ds_write_b128 v53, v[88:91] offset:6144
    ds_write_b128 v53, v[92:95] offset:7168
    ds_write_b128 v53, v[96:99] offset:8192
    ds_write_b128 v53, v[100:103] offset:9216
    ds_write_b128 v53, v[104:107] offset:10240
    ds_write_b128 v53, v[108:111] offset:11264
    ds_write_b128 v53, v[112:115] offset:12288
    ds_write_b128 v53, v[116:119] offset:13312
    ds_write_b128 v53, v[120:123] offset:14336
    ds_write_b128 v53, v[124:127] offset:15360
    ds_write_b128 v53, v[128:131] offset:16384
    ds_write_b128 v53, v[132:135] offset:17408
    ds_write_b128 v53, v[136:139] offset:18432
    ds_write_b128 v53, v[140:143] offset:19456
    ds_write_b128 v53, v[144:147] offset:20480
    ds_write_b128 v53, v[148:151] offset:21504
    ds_write_b128 v53, v[152:155] offset:22528
    ds_write_b128 v53, v[156:159] offset:23552
    ds_write_b128 v53, v[160:163] offset:24576
    ds_write_b128 v53, v[164:167] offset:25600
    ds_write_b128 v53, v[168:171] offset:26624
    ds_write_b128 v53, v[172:175] offset:27648
    ds_write_b128 v53, v[176:179] offset:28672
    ds_write_b128 v53, v[180:183] offset:29696
    ds_write_b128 v53, v[184:187] offset:30720
L_go:
    s_mov_b32 s66, 0x3db504f3
    s_mov_b32 s67, 0x3fb8aa3b
    s_mov_b32 s65, 0x42800000
    s_setprio 1
    s_waitcnt lgkmcnt(0)
    s_barrier
    ds_read_b128 v[64:67], v53 offset:0
    ds_read_b128 v[128:131], v53 offset:16384
    ds_read_b128 v[68:71], v53 offset:1024
    ds_read_b128 v[132:135], v53 offset:17408
    ds_read_b128 v[72:75], v53 offset:2048
    ds_read_b128 v[136:139], v53 offset:18432
    ds_read_b128 v[76:79], v53 offset:3072
    ds_read_b128 v[140:143], v53 offset:19456
    s_waitcnt lgkmcnt(7)
    v_mfma_f32_16x16x32_bf16 v[8:11], v[192:195], v[64:67], 0
    ds_read_b128 v[80:83], v53 offset:4096
    s_waitcnt lgkmcnt(7)
    v_mfma_f32_16x16x32_bf16 v[12:15], v[192:195], v[128:131], 0
    ds_read_b128 v[144:147], v53 offset:20480
    s_waitcnt lgkmcnt(7)
    v_mfma_f32_16x16x32_bf16 v[8:11], v[196:199], v[68:71], v[8:11]
    ds_read_b128 v[84:87], v53 offset:5120
    s_waitcnt lgkmcnt(7)
    v_mfma_f32_16x16x32_bf16 v[12:15], v[196:199], v[132:135], v[12:15]
    ds_read_b128 v[148:151], v53 offset:21504
    s_waitcnt lgkmcnt(7)
    v_mfma_f32_16x16x32_bf16 v[8:11], v[200:203], v[72:75], v[8:11]
    ds_read_b128 v[88:91], v53 offset:6144
    s_waitcnt lgkmcnt(7)
    v_mfma_f32_16x16x32_bf16 v[12:15], v[200:203], v[136:139], v[12:15]
    ds_read_b128 v[152:155], v53 offset:22528
    s_waitcnt lgkmcnt(7)
    v_mfma_f32_16x16x32_bf16 v[8:11], v[204:207], v[76:79], v[8:11]
    ds_read_b128 v[92:95], v53 offset:7168
    s_waitcnt lgkmcnt(7)
    v_mfma_f32_16x16x32_bf16 v[12:15], v[204:207], v[140:143], v[12:15]
    ds_read_b128 v[156:159], v53 offset:23552
    s_waitcnt lgkmcnt(7)
    v_mfma_f32_16x16x32_bf16 v[8:11], v[208:211], v[80:83], v[8:11]
    ds_read_b128 v[96:99], v53 offset:8192
    s_waitcnt lgkmcnt(7)
    v_mfma_f32_16x16x32_bf16 v[12:15], v[208:211], v[144:147], v[12:15]
    ds_read_b128 v[160:163], v53 offset:24576
    s_waitcnt lgkmcnt(7)
    v_mfma_f32_16x16x32_bf16 v[8:11], v[212:215], v[84:87], v[8:11]
    ds_read_b128 v[100:103], v53 offset:9216
    s_waitcnt lgkmcnt(7)
    v_mfma_f32_16x16x32_bf16 v[12:15], v[212:215], v[148:151], v[12:15]
    ds_read_b128 v[164:167], v53 offset:25600
    s_waitcnt lgkmcnt(7)
    v_mfma_f32_16x16x32_bf16 v[8:11], v[216:219], v[88:91], v[8:11]
    ds_read_b128 v[104:107], v53 offset:10240
    s_waitcnt lgkmcnt(7)
    v_mfma_f32_16x16x32_bf16 v[12:15], v[216:219], v[152:155], v[12:15]
    ds_read_b128 v[168:171], v53 offset:26624
    s_waitcnt lgkmcnt(7)
    v_mfma_f32_16x16x32_bf16 v[8:11], v[220:223], v[92:95], v[8:11]
    ds_read_b128 v[108:111], v53 offset:11264
    s_waitcnt lgkmcnt(7)
    v_mfma_f32_16x16x32_bf16 v[12:15], v[220:223], v[156:159], v[12:15]
    ds_read_b128 v[172:175], v53 offset:27648
    s_waitcnt lgkmcnt(7)
    v_mfma_f32_16x16x32_bf16 v[8:11], v[224:227], v[96:99], v[8:11]
    ds_read_b128 v[112:115], v53 offset:12288
    s_waitcnt lgkmcnt(7)
    v_mfma_f32_16x16x32_bf16 v[12:15], v[224:227], v[160:163], v[12:15]
    ds_read_b128 v[176:179], v53 offset:28672
    s_waitcnt lgkmcnt(7)
    v_mfma_f32_16x16x32_bf16 v[8:11], v[228:231], v[100:103], v[8:11]
    ds_read_b128 v[116:119], v53 offset:13312
    s_waitcnt lgkmcnt(7)
    v_mfma_f32_16x16x32_bf16 v[12:15], v[228:231], v[164:167], v[12:15]
    ds_read_b128 v[180:183], v53 offset:29696
    s_waitcnt lgkmcnt(7)
    v_mfma_f32_16x16x32_bf16 v[8:11], v[232:235], v[104:107], v[8:11]
    ds_read_b128 v[120:123], v53 offset:14336
    s_waitcnt lgkmcnt(7)
    v_mfma_f32_16x16x32_bf16 v[12:15], v[232:235], v[168:171], v[12:15]
    ds_read_b128 v[184:187], v53 offset:30720
    s_waitcnt lgkmcnt(7)
    v_mfma_f32_16x16x32_bf16 v[8:11], v[236:239], v[108:111], v[8:11]
    ds_read_b128 v[124:127], v53 offset:15360
    s_waitcnt lgkmcnt(7)
    v_mfma_f32_16x16x32_bf16 v[12:15], v[236:239], v[172:175], v[12:15]
    ds_read_b128 v[192:195], v48 offset:32768
    s_waitcnt lgkmcnt(7)
    v_mfma_f32_16x16x32_bf16 v[8:11], v[240:243], v[112:115], v[8:11]
    ds_read_b128 v[196:199], v49 offset:32768
    s_waitcnt lgkmcnt(7)
    v_mfma_f32_16x16x32_bf16 v[12:15], v[240:243], v[176:179], v[12:15]
    ds_read_b128 v[200:203], v50 offset:32768
    s_waitcnt lgkmcnt(7)
    v_mfma_f32_16x16x32_bf16 v[8:11], v[244:247], v[116:119], v[8:11]
    ds_read_b128 v[204:207], v51 offset:32768
    s_waitcnt lgkmcnt(7)
    v_mfma_f32_16x16x32_bf16 v[12:15], v[244:247], v[180:183], v[12:15]
    ds_read_b128 v[208:211], v48 offset:33024
    s_waitcnt lgkmcnt(7)
    v_mfma_f32_16x16x32_bf16 v[8:11], v[248:251], v[120:123], v[8:11]
    ds_read_b128 v[212:215], v49 offset:33024
    s_waitcnt lgkmcnt(7)
    v_mfma_f32_16x16x32_bf16 v[12:15], v[248:251], v[184:187], v[12:15]
    ds_read_b128 v[216:219], v50 offset:33024
    s_waitcnt lgkmcnt(7)
    v_mfma_f32_16x16x32_bf16 v[8:11], v[252:255], v[124:127], v[8:11]
    ds_read_b128 v[220:223], v51 offset:33024
    v_mfma_f32_16x16x32_bf16 v[12:15], v[252:255], v[188:191], v[12:15]
    ds_read_b128 v[224:227], v48 offset:33280
    s_waitcnt lgkmcnt(8)
    v_mfma_f32_16x16x32_bf16 v[4:7], v[192:195], v[64:67], 0
    ds_read_b128 v[228:231], v49 offset:33280
    v_mfma_f32_16x16x32_bf16 v[56:59], v[192:195], v[128:131], 0
    ds_read_b128 v[232:235], v50 offset:33280
    s_waitcnt lgkmcnt(9)
    v_mfma_f32_16x16x32_bf16 v[4:7], v[196:199], v[68:71], v[4:7]
    ds_read_b128 v[236:239], v51 offset:33280
    v_mfma_f32_16x16x32_bf16 v[56:59], v[196:199], v[132:135], v[56:59]
    ds_read_b128 v[240:243], v48 offset:33536
    s_waitcnt lgkmcnt(10)
    v_mfma_f32_16x16x32_bf16 v[4:7], v[200:203], v[72:75], v[4:7]
    ds_read_b128 v[244:247], v49 offset:33536
    v_max3_f32 v44, v8, v9, v10
    v_max3_f32 v45, v12, v13, v14
    v_max_f32 v44, v44, v11
    v_max_f32 v45, v45, v15
    v_mfma_f32_16x16x32_bf16 v[56:59], v[200:203], v[136:139], v[56:59]
    ds_read_b128 v[248:251], v50 offset:33536
    v_cvt_pk_bf16_f32 v32, 0, v8
    v_cvt_pk_bf16_f32 v36, 0, v12
    v_permlane16_swap_b32 v44, v45
    s_waitcnt lgkmcnt(11)
    v_mfma_f32_16x16x32_bf16 v[4:7], v[204:207], v[76:79], v[4:7]
    ds_read_b128 v[252:255], v51 offset:33536
    v_cvt_pk_bf16_f32 v33, 0, v9
    v_cvt_pk_bf16_f32 v37, 0, v13
    v_max_f32 v44, v44, v45
    v_mfma_f32_16x16x32_bf16 v[56:59], v[204:207], v[140:143], v[56:59]
    v_cvt_pk_bf16_f32 v34, 0, v10
    v_cvt_pk_bf16_f32 v38, 0, v14
    v_mov_b32 v46, v44
    s_waitcnt lgkmcnt(11)
    v_mfma_f32_16x16x32_bf16 v[4:7], v[208:211], v[80:83], v[4:7]
    v_cvt_pk_bf16_f32 v35, 0, v11
    v_cvt_pk_bf16_f32 v39, 0, v15
    v_permlane32_swap_b32 v46, v44
    v_mul_f32 v32, s66, v32
    v_mfma_f32_16x16x32_bf16 v[56:59], v[208:211], v[144:147], v[56:59]
    v_mul_f32 v36, s66, v36
    v_max_f32 v44, v44, v46
    ds_write_b32 v54, v44
    s_waitcnt lgkmcnt(11)
    v_mfma_f32_16x16x32_bf16 v[4:7], v[212:215], v[84:87], v[4:7]
    v_mul_f32 v33, s66, v33
    v_mul_f32 v37, s66, v37
    v_mul_f32 v34, s66, v34
    v_mfma_f32_16x16x32_bf16 v[56:59], v[212:215], v[148:151], v[56:59]
    v_mul_f32 v38, s66, v38
    v_mul_f32 v35, s66, v35
    v_mul_f32 v39, s66, v39
    s_waitcnt lgkmcnt(10)
    v_mfma_f32_16x16x32_bf16 v[4:7], v[216:219], v[88:91], v[4:7]
    v_cvt_pk_bf16_f32 v16, 0, v32
    v_cvt_pk_bf16_f32 v20, 0, v36
    s_waitcnt lgkmcnt(0)
    s_barrier
    v_mfma_f32_16x16x32_bf16 v[56:59], v[216:219], v[152:155], v[56:59]
    ds_read_b128 v[40:43], v55
    ds_read_b128 v[44:47], v55 offset:256
    v_cvt_pk_bf16_f32 v17, 0, v33
    v_cvt_pk_bf16_f32 v21, 0, v37
    v_mfma_f32_16x16x32_bf16 v[4:7], v[220:223], v[92:95], v[4:7]
    v_cvt_pk_bf16_f32 v18, 0, v34
    v_cvt_pk_bf16_f32 v22, 0, v38
    v_cvt_pk_bf16_f32 v19, 0, v35
    v_mfma_f32_16x16x32_bf16 v[56:59], v[220:223], v[156:159], v[56:59]
    v_cvt_pk_bf16_f32 v23, 0, v39
    v_mfma_f32_16x16x32_bf16 v[4:7], v[224:227], v[96:99], v[4:7]
    v_mfma_f32_16x16x32_bf16 v[56:59], v[224:227], v[160:163], v[56:59]
    s_waitcnt lgkmcnt(0)
    v_max3_f32 v40, v40, v41, v42
    v_mfma_f32_16x16x32_bf16 v[4:7], v[228:231], v[100:103], v[4:7]
    v_max3_f32 v44, v44, v45, v46
    v_max_f32 v40, v40, v43
    v_max_f32 v44, v44, v47
    v_cvt_pk_bf16_f32 v40, 0, v40
    v_mfma_f32_16x16x32_bf16 v[56:59], v[228:231], v[164:167], v[56:59]
    v_cvt_pk_bf16_f32 v44, 0, v44
    v_mul_f32 v40, s66, v40
    v_mul_f32 v44, s66, v44
    v_mfma_f32_16x16x32_bf16 v[4:7], v[232:235], v[104:107], v[4:7]
    v_cvt_pk_bf16_f32 v40, 0, v40
    v_cvt_pk_bf16_f32 v44, 0, v44
    s_cmp_lg_u32 s72, 0
    s_cbranch_scc1 p2_77
    v_mul_f32 v24, s67, v40
    v_mul_f32 v25, s67, v44
p2_77:
    v_mfma_f32_16x16x32_bf16 v[56:59], v[232:235], v[168:171], v[56:59]
    v_fma_f32 v32, v16, s67, -v24
    v_fma_f32 v36, v20, s67, -v25
    v_fma_f32 v33, v17, s67, -v24
    v_mfma_f32_16x16x32_bf16 v[4:7], v[236:239], v[108:111], v[4:7]
    v_fma_f32 v37, v21, s67, -v25
    v_fma_f32 v34, v18, s67, -v24
    v_fma_f32 v38, v22, s67, -v25
    v_fma_f32 v35, v19, s67, -v24
    v_mfma_f32_16x16x32_bf16 v[56:59], v[236:239], v[172:175], v[56:59]
    v_fma_f32 v39, v23, s67, -v25
    v_max3_f32 v28, v28, v32, v33
    v_max3_f32 v29, v29, v36, v37
    v_mfma_f32_16x16x32_bf16 v[4:7], v[240:243], v[112:115], v[4:7]
    v_max3_f32 v28, v28, v34, v35
    v_max3_f32 v29, v29, v38, v39
    v_exp_f32 v32, v32
    v_mfma_f32_16x16x32_bf16 v[56:59], v[240:243], v[176:179], v[56:59]
    v_exp_f32 v36, v36
    v_exp_f32 v33, v33
    v_exp_f32 v37, v37
    v_mfma_f32_16x16x32_bf16 v[4:7], v[244:247], v[116:119], v[4:7]
    v_exp_f32 v34, v34
    v_exp_f32 v38, v38
    v_exp_f32 v35, v35
    v_mfma_f32_16x16x32_bf16 v[56:59], v[244:247], v[180:183], v[56:59]
    v_exp_f32 v39, v39
    v_cvt_pk_bf16_f32 v60, v32, v33
    v_cvt_pk_bf16_f32 v62, v36, v37
    v_cvt_pk_bf16_f32 v61, v34, v35
    v_mfma_f32_16x16x32_bf16 v[4:7], v[248:251], v[120:123], v[4:7]
    v_cvt_pk_bf16_f32 v63, v38, v39
    v_permlane16_swap_b32 v60, v62
    s_nop 0
    v_permlane16_swap_b32 v61, v63
    v_mfma_f32_16x16x32_bf16 v[56:59], v[248:251], v[184:187], v[56:59]
    ds_write_b128 v30, v[60:63] offset:0
    v_add_f32 v32, v32, v33
    v_add_f32 v36, v36, v37
    v_mfma_f32_16x16x32_bf16 v[4:7], v[252:255], v[124:127], v[4:7]
    v_add_f32 v34, v34, v35
    v_add_f32 v38, v38, v39
    v_add_f32 v26, v26, v32
    v_mfma_f32_16x16x32_bf16 v[56:59], v[252:255], v[188:191], v[56:59]
    v_add_f32 v27, v27, v36
    v_add_f32 v26, v26, v34
    v_add_f32 v27, v27, v38
    s_waitcnt lgkmcnt(0)
    s_barrier
    ds_read_b128 v[192:195], v48 offset:0
    ds_read_b128 v[196:199], v49 offset:0
    ds_read_b128 v[200:203], v50 offset:0
    ds_read_b128 v[204:207], v51 offset:0
    ds_read_b128 v[208:211], v48 offset:256
    ds_read_b128 v[212:215], v49 offset:256
    s_waitcnt lgkmcnt(5)
    v_mfma_f32_16x16x32_bf16 v[8:11], v[192:195], v[64:67], 0
    v_cvt_pk_bf16_f32 v32, 0, v4
    v_cvt_pk_bf16_f32 v36, 0, v56
    v_cvt_pk_bf16_f32 v33, 0, v5
    v_mfma_f32_16x16x32_bf16 v[12:15], v[192:195], v[128:131], 0
    ds_read_b128 v[216:219], v50 offset:256
    v_cvt_pk_bf16_f32 v37, 0, v57
    v_cvt_pk_bf16_f32 v34, 0, v6
    s_waitcnt lgkmcnt(5)
    v_mfma_f32_16x16x32_bf16 v[8:11], v[196:199], v[68:71], v[8:11]
    v_cvt_pk_bf16_f32 v38, 0, v58
    v_cvt_pk_bf16_f32 v35, 0, v7
    v_mfma_f32_16x16x32_bf16 v[12:15], v[196:199], v[132:135], v[12:15]
    ds_read_b128 v[220:223], v51 offset:256
    v_cvt_pk_bf16_f32 v39, 0, v59
    v_mul_f32 v32, s66, v32
    s_waitcnt lgkmcnt(5)
    v_mfma_f32_16x16x32_bf16 v[8:11], v[200:203], v[72:75], v[8:11]
    v_mul_f32 v36, s66, v36
    v_mul_f32 v33, s66, v33
    v_mfma_f32_16x16x32_bf16 v[12:15], v[200:203], v[136:139], v[12:15]
    ds_read_b128 v[224:227], v48 offset:512
    v_mul_f32 v37, s66, v37
    v_mul_f32 v34, s66, v34
    s_waitcnt lgkmcnt(5)
    v_mfma_f32_16x16x32_bf16 v[8:11], v[204:207], v[76:79], v[8:11]
    v_mul_f32 v38, s66, v38
    v_mul_f32 v35, s66, v35
    v_mfma_f32_16x16x32_bf16 v[12:15], v[204:207], v[140:143], v[12:15]
    ds_read_b128 v[228:231], v49 offset:512
    v_mul_f32 v39, s66, v39
    v_cvt_pk_bf16_f32 v16, 0, v32
    s_waitcnt lgkmcnt(5)
    v_mfma_f32_16x16x32_bf16 v[8:11], v[208:211], v[80:83], v[8:11]
    v_cvt_pk_bf16_f32 v20, 0, v36
    v_cvt_pk_bf16_f32 v17, 0, v33
    v_mfma_f32_16x16x32_bf16 v[12:15], v[208:211], v[144:147], v[12:15]
    ds_read_b128 v[232:235], v50 offset:512
    v_cvt_pk_bf16_f32 v21, 0, v37
    v_cvt_pk_bf16_f32 v18, 0, v34
    v_cvt_pk_bf16_f32 v22, 0, v38
    s_waitcnt lgkmcnt(5)
    v_mfma_f32_16x16x32_bf16 v[8:11], v[212:215], v[84:87], v[8:11]
    v_cvt_pk_bf16_f32 v19, 0, v35
    v_cvt_pk_bf16_f32 v23, 0, v39
    v_mfma_f32_16x16x32_bf16 v[12:15], v[212:215], v[148:151], v[12:15]
    ds_read_b128 v[236:239], v51 offset:512
    v_fma_f32 v32, v16, s67, -v24
    v_fma_f32 v36, v20, s67, -v25
    s_waitcnt lgkmcnt(5)
    v_mfma_f32_16x16x32_bf16 v[8:11], v[216:219], v[88:91], v[8:11]
    v_fma_f32 v33, v17, s67, -v24
    v_fma_f32 v37, v21, s67, -v25
    v_mfma_f32_16x16x32_bf16 v[12:15], v[216:219], v[152:155], v[12:15]
    ds_read_b128 v[240:243], v48 offset:768
    v_fma_f32 v34, v18, s67, -v24
    v_fma_f32 v38, v22, s67, -v25
    s_waitcnt lgkmcnt(5)
    v_mfma_f32_16x16x32_bf16 v[8:11], v[220:223], v[92:95], v[8:11]
    v_fma_f32 v35, v19, s67, -v24
    v_fma_f32 v39, v23, s67, -v25
    v_mfma_f32_16x16x32_bf16 v[12:15], v[220:223], v[156:159], v[12:15]
    ds_read_b128 v[244:247], v49 offset:768
    v_max3_f32 v28, v28, v32, v33
    v_max3_f32 v29, v29, v36, v37
    s_waitcnt lgkmcnt(5)
    v_mfma_f32_16x16x32_bf16 v[8:11], v[224:227], v[96:99], v[8:11]
    v_max3_f32 v28, v28, v34, v35
    v_max3_f32 v29, v29, v38, v39
    v_mfma_f32_16x16x32_bf16 v[12:15], v[224:227], v[160:163], v[12:15]
    ds_read_b128 v[248:251], v50 offset:768
    v_exp_f32 v32, v32
    v_exp_f32 v36, v36
    s_waitcnt lgkmcnt(5)
    v_mfma_f32_16x16x32_bf16 v[8:11], v[228:231], v[100:103], v[8:11]
    v_exp_f32 v33, v33
    v_exp_f32 v37, v37
    v_exp_f32 v34, v34
    v_mfma_f32_16x16x32_bf16 v[12:15], v[228:231], v[164:167], v[12:15]
    ds_read_b128 v[252:255], v51 offset:768
    v_exp_f32 v38, v38
    v_exp_f32 v35, v35
    s_waitcnt lgkmcnt(5)
    v_mfma_f32_16x16x32_bf16 v[8:11], v[232:235], v[104:107], v[8:11]
    v_exp_f32 v39, v39
    v_cvt_pk_bf16_f32 v60, v32, v33
    v_mfma_f32_16x16x32_bf16 v[12:15], v[232:235], v[168:171], v[12:15]
    v_cvt_pk_bf16_f32 v62, v36, v37
    v_cvt_pk_bf16_f32 v61, v34, v35
    s_waitcnt lgkmcnt(4)
    v_mfma_f32_16x16x32_bf16 v[8:11], v[236:239], v[108:111], v[8:11]
    v_cvt_pk_bf16_f32 v63, v38, v39
    v_permlane16_swap_b32 v60, v62
    v_mfma_f32_16x16x32_bf16 v[12:15], v[236:239], v[172:175], v[12:15]
    v_permlane16_swap_b32 v61, v63
    ds_write_b128 v30, v[60:63] offset:4096
    s_waitcnt lgkmcnt(4)
    v_mfma_f32_16x16x32_bf16 v[8:11], v[240:243], v[112:115], v[8:11]
    v_add_f32 v32, v32, v33
    v_add_f32 v36, v36, v37
    v_mfma_f32_16x16x32_bf16 v[12:15], v[240:243], v[176:179], v[12:15]
    v_add_f32 v34, v34, v35
    v_add_f32 v38, v38, v39
    s_waitcnt lgkmcnt(3)
    v_mfma_f32_16x16x32_bf16 v[8:11], v[244:247], v[116:119], v[8:11]
    v_add_f32 v26, v26, v32
    v_add_f32 v27, v27, v36
    v_mfma_f32_16x16x32_bf16 v[12:15], v[244:247], v[180:183], v[12:15]
    v_add_f32 v26, v26, v34
    v_add_f32 v27, v27, v38
    s_waitcnt lgkmcnt(2)
    v_mfma_f32_16x16x32_bf16 v[8:11], v[248:251], v[120:123], v[8:11]
    v_mfma_f32_16x16x32_bf16 v[12:15], v[248:251], v[184:187], v[12:15]
    s_waitcnt lgkmcnt(1)
    v_mfma_f32_16x16x32_bf16 v[8:11], v[252:255], v[124:127], v[8:11]
    v_mfma_f32_16x16x32_bf16 v[12:15], v[252:255], v[188:191], v[12:15]
    s_waitcnt lgkmcnt(0)
    s_barrier
    s_getpc_b64 s[68:69]
pc_78:
    s_sub_u32 s68, s68, pc_78-adaLN_cond__compressed_kv_cla__dense_activation_relu__decode_kernel
    s_subb_u32 s69, s69, 0
    s_lshl_b32 s64, s56, 4
    s_add_u32 s64, s64, s54
    s_lshl_b32 s64, s64, 10
    s_cmp_ge_u32 s64, L_code_end-adaLN_cond__compressed_kv_cla__dense_activation_relu__decode_kernel
    s_cbranch_scc1 cpf_79
    s_min_u32 s64, s64, L_code_end-adaLN_cond__compressed_kv_cla__dense_activation_relu__decode_kernel-1024
    v_lshl_add_u32 v40, v0, 4, s64
    global_load_dword v52, v40, s[68:69]
cpf_79:
    v_cvt_pk_bf16_f32 v32, 0, v8
    v_cvt_pk_bf16_f32 v36, 0, v12
    v_cvt_pk_bf16_f32 v33, 0, v9
    v_cvt_pk_bf16_f32 v37, 0, v13
    v_cvt_pk_bf16_f32 v34, 0, v10
    v_cvt_pk_bf16_f32 v38, 0, v14
    v_cvt_pk_bf16_f32 v35, 0, v11
    v_cvt_pk_bf16_f32 v39, 0, v15
    v_mul_f32 v32, s66, v32
    v_mul_f32 v36, s66, v36
    v_mul_f32 v33, s66, v33
    v_mul_f32 v37, s66, v37
    v_mul_f32 v34, s66, v34
    v_mul_f32 v38, s66, v38
    v_mul_f32 v35, s66, v35
    v_mul_f32 v39, s66, v39
    v_cvt_pk_bf16_f32 v16, 0, v32
    v_cvt_pk_bf16_f32 v20, 0, v36
    v_cvt_pk_bf16_f32 v17, 0, v33
    v_cvt_pk_bf16_f32 v21, 0, v37
    v_cvt_pk_bf16_f32 v18, 0, v34
    v_cvt_pk_bf16_f32 v22, 0, v38
    v_cvt_pk_bf16_f32 v19, 0, v35
    v_cvt_pk_bf16_f32 v23, 0, v39
    v_fma_f32 v32, v16, s67, -v24
    v_fma_f32 v36, v20, s67, -v25
    v_fma_f32 v33, v17, s67, -v24
    v_fma_f32 v37, v21, s67, -v25
    v_fma_f32 v34, v18, s67, -v24
    v_fma_f32 v38, v22, s67, -v25
    v_fma_f32 v35, v19, s67, -v24
    v_fma_f32 v39, v23, s67, -v25
    v_max3_f32 v28, v28, v32, v33
    v_max3_f32 v29, v29, v36, v37
    v_max3_f32 v28, v28, v34, v35
    v_max3_f32 v29, v29, v38, v39
    v_exp_f32 v32, v32
    v_exp_f32 v36, v36
    v_exp_f32 v33, v33
    v_exp_f32 v37, v37
    v_exp_f32 v34, v34
    v_exp_f32 v38, v38
    v_exp_f32 v35, v35
    v_exp_f32 v39, v39
    v_cvt_pk_bf16_f32 v60, v32, v33
    v_cvt_pk_bf16_f32 v62, v36, v37
    v_cvt_pk_bf16_f32 v61, v34, v35
    v_cvt_pk_bf16_f32 v63, v38, v39
    v_permlane16_swap_b32 v60, v62
    s_nop 0
    v_permlane16_swap_b32 v61, v63
    ds_write_b128 v30, v[60:63] offset:0
    v_add_f32 v32, v32, v33
    v_add_f32 v36, v36, v37
    v_add_f32 v34, v34, v35
    v_add_f32 v38, v38, v39
    v_add_f32 v26, v26, v32
    v_add_f32 v27, v27, v36
    v_add_f32 v26, v26, v34
    v_add_f32 v27, v27, v38
    v_lshrrev_b32 v44, 1, v2
    v_lshlrev_b32 v44, 9, v44
    v_lshl_add_u32 v44, v1, 4, v44
    v_and_b32 v45, 1, v2
    v_lshl_add_u32 v44, v45, 3, v44
    s_and_b32 s64, s56, 1
    s_lshl_b32 s64, s64, 10
    s_lshr_b32 s68, s56, 1
    s_lshl_b32 s68, s68, 8
    s_add_u32 s64, s64, s68
    s_add_u32 s64, s64, 135168
    v_add_u32 v44, s64, v44
    v_and_b32 v48, 0xffff, v48
    v_and_b32 v49, 0xffff, v49
    v_and_b32 v50, 0xffff, v50
    v_and_b32 v51, 0xffff, v51
    s_waitcnt lgkmcnt(0)
    s_barrier
    v_lshlrev_b32 v40, 7, v3
    s_lshl_b32 s64, s55, 15
    buffer_load_dword v53, v40, s[24:27], s64 offen
    s_cmp_ge_u32 s56, 2
    s_cbranch_scc1 wi_80
    ds_read_b128 v[192:195], v48 offset:32768
    ds_read_b128 v[196:199], v49 offset:32768
    ds_read_b128 v[200:203], v50 offset:32768
    ds_read_b128 v[204:207], v51 offset:32768
    ds_read_b128 v[208:211], v48 offset:33024
    ds_read_b128 v[212:215], v49 offset:33024
    ds_read_b128 v[216:219], v50 offset:33024
    ds_read_b128 v[220:223], v51 offset:33024
    ds_read_b128 v[224:227], v48 offset:33280
    ds_read_b128 v[228:231], v49 offset:33280
    ds_read_b128 v[232:235], v50 offset:33280
    ds_read_b128 v[236:239], v51 offset:33280
    ds_read_b128 v[240:243], v48 offset:33536
    ds_read_b128 v[244:247], v49 offset:33536
    ds_read_b128 v[248:251], v50 offset:33536
    ds_read_b128 v[252:255], v51 offset:33536
    s_waitcnt lgkmcnt(15)
    v_mfma_f32_16x16x32_bf16 v[4:7], v[192:195], v[64:67], 0
    s_waitcnt lgkmcnt(14)
    v_mfma_f32_16x16x32_bf16 v[4:7], v[196:199], v[68:71], v[4:7]
    s_waitcnt lgkmcnt(13)
    v_mfma_f32_16x16x32_bf16 v[4:7], v[200:203], v[72:75], v[4:7]
    s_waitcnt lgkmcnt(12)
    v_mfma_f32_16x16x32_bf16 v[4:7], v[204:207], v[76:79], v[4:7]
    s_waitcnt lgkmcnt(11)
    v_mfma_f32_16x16x32_bf16 v[4:7], v[208:211], v[80:83], v[4:7]
    s_waitcnt lgkmcnt(10)
    v_mfma_f32_16x16x32_bf16 v[4:7], v[212:215], v[84:87], v[4:7]
    s_waitcnt lgkmcnt(9)
    v_mfma_f32_16x16x32_bf16 v[4:7], v[216:219], v[88:91], v[4:7]
    s_waitcnt lgkmcnt(8)
    v_mfma_f32_16x16x32_bf16 v[4:7], v[220:223], v[92:95], v[4:7]
    s_waitcnt lgkmcnt(7)
    v_mfma_f32_16x16x32_bf16 v[4:7], v[224:227], v[96:99], v[4:7]
    s_waitcnt lgkmcnt(6)
    v_mfma_f32_16x16x32_bf16 v[4:7], v[228:231], v[100:103], v[4:7]
    s_waitcnt lgkmcnt(5)
    v_mfma_f32_16x16x32_bf16 v[4:7], v[232:235], v[104:107], v[4:7]
    s_waitcnt lgkmcnt(4)
    v_mfma_f32_16x16x32_bf16 v[4:7], v[236:239], v[108:111], v[4:7]
    s_waitcnt lgkmcnt(3)
    v_mfma_f32_16x16x32_bf16 v[4:7], v[240:243], v[112:115], v[4:7]
    s_waitcnt lgkmcnt(2)
    v_mfma_f32_16x16x32_bf16 v[4:7], v[244:247], v[116:119], v[4:7]
    s_waitcnt lgkmcnt(1)
    v_mfma_f32_16x16x32_bf16 v[4:7], v[248:251], v[120:123], v[4:7]
    s_waitcnt lgkmcnt(0)
    v_mfma_f32_16x16x32_bf16 v[4:7], v[252:255], v[124:127], v[4:7]
    v_or_b32 v48, 0x10000, v48
    v_or_b32 v49, 0x10000, v49
    v_or_b32 v50, 0x10000, v50
    v_or_b32 v51, 0x10000, v51
    s_nop 3
    v_cvt_pk_bf16_f32 v32, 0, v4
    v_cvt_pk_bf16_f32 v33, 0, v5
    v_cvt_pk_bf16_f32 v34, 0, v6
    v_cvt_pk_bf16_f32 v35, 0, v7
    v_mul_f32 v32, s66, v32
    v_mul_f32 v33, s66, v33
    v_mul_f32 v34, s66, v34
    v_mul_f32 v35, s66, v35
    v_cvt_pk_bf16_f32 v16, 0, v32
    v_cvt_pk_bf16_f32 v17, 0, v33
    v_cvt_pk_bf16_f32 v18, 0, v34
    v_cvt_pk_bf16_f32 v19, 0, v35
    v_fma_f32 v32, v16, s67, -v24
    v_fma_f32 v33, v17, s67, -v24
    v_fma_f32 v34, v18, s67, -v24
    v_fma_f32 v35, v19, s67, -v24
    v_max3_f32 v28, v28, v32, v33
    v_max3_f32 v28, v28, v34, v35
    v_exp_f32 v32, v32
    v_exp_f32 v33, v33
    v_exp_f32 v34, v34
    v_exp_f32 v35, v35
    v_cvt_pk_bf16_f32 v60, v32, v33
    v_cvt_pk_bf16_f32 v61, v34, v35
    ds_write_b64 v44, v[60:61] offset:0
    v_add_f32 v32, v32, v33
    v_add_f32 v34, v34, v35
    v_add_f32 v26, v26, v32
    v_add_f32 v26, v26, v34
    s_waitcnt lgkmcnt(0)
    s_barrier
    s_or_b32 s64, s56, s72
    s_cbranch_scc1 noarr_82
    s_lshl_b32 s64, s52, 7
    s_add_u32 s64, s64, 114688
    v_mov_b32 v43, 1
    v_mov_b32 v40, 0
    s_mov_b32 exec_lo, 0x1
    s_mov_b32 exec_hi, 0x0
    buffer_atomic_add v43, v40, s[48:51], s64 offen sc0 sc1
    s_mov_b64 exec, -1
noarr_82:
    ds_read_b128 v[192:195], v48 offset:32768
    ds_read_b128 v[196:199], v49 offset:32768
    ds_read_b128 v[200:203], v50 offset:32768
    ds_read_b128 v[204:207], v51 offset:32768
    ds_read_b128 v[208:211], v48 offset:33024
    ds_read_b128 v[212:215], v49 offset:33024
    ds_read_b128 v[216:219], v50 offset:33024
    ds_read_b128 v[220:223], v51 offset:33024
    ds_read_b128 v[224:227], v48 offset:33280
    ds_read_b128 v[228:231], v49 offset:33280
    ds_read_b128 v[232:235], v50 offset:33280
    ds_read_b128 v[236:239], v51 offset:33280
    ds_read_b128 v[240:243], v48 offset:33536
    ds_read_b128 v[244:247], v49 offset:33536
    ds_read_b128 v[248:251], v50 offset:33536
    ds_read_b128 v[252:255], v51 offset:33536
    s_waitcnt lgkmcnt(15)
    v_mfma_f32_16x16x32_bf16 v[4:7], v[192:195], v[64:67], 0
    s_waitcnt lgkmcnt(14)
    v_mfma_f32_16x16x32_bf16 v[4:7], v[196:199], v[68:71], v[4:7]
    s_waitcnt lgkmcnt(13)
    v_mfma_f32_16x16x32_bf16 v[4:7], v[200:203], v[72:75], v[4:7]
    s_waitcnt lgkmcnt(12)
    v_mfma_f32_16x16x32_bf16 v[4:7], v[204:207], v[76:79], v[4:7]
    s_waitcnt lgkmcnt(11)
    v_mfma_f32_16x16x32_bf16 v[4:7], v[208:211], v[80:83], v[4:7]
    s_waitcnt lgkmcnt(10)
    v_mfma_f32_16x16x32_bf16 v[4:7], v[212:215], v[84:87], v[4:7]
    s_waitcnt lgkmcnt(9)
    v_mfma_f32_16x16x32_bf16 v[4:7], v[216:219], v[88:91], v[4:7]
    s_waitcnt lgkmcnt(8)
    v_mfma_f32_16x16x32_bf16 v[4:7], v[220:223], v[92:95], v[4:7]
    s_waitcnt lgkmcnt(7)
    v_mfma_f32_16x16x32_bf16 v[4:7], v[224:227], v[96:99], v[4:7]
    s_waitcnt lgkmcnt(6)
    v_mfma_f32_16x16x32_bf16 v[4:7], v[228:231], v[100:103], v[4:7]
    s_waitcnt lgkmcnt(5)
    v_mfma_f32_16x16x32_bf16 v[4:7], v[232:235], v[104:107], v[4:7]
    s_waitcnt lgkmcnt(4)
    v_mfma_f32_16x16x32_bf16 v[4:7], v[236:239], v[108:111], v[4:7]
    s_waitcnt lgkmcnt(3)
    v_mfma_f32_16x16x32_bf16 v[4:7], v[240:243], v[112:115], v[4:7]
    s_waitcnt lgkmcnt(2)
    v_mfma_f32_16x16x32_bf16 v[4:7], v[244:247], v[116:119], v[4:7]
    s_waitcnt lgkmcnt(1)
    v_mfma_f32_16x16x32_bf16 v[4:7], v[248:251], v[120:123], v[4:7]
    s_waitcnt lgkmcnt(0)
    v_mfma_f32_16x16x32_bf16 v[4:7], v[252:255], v[124:127], v[4:7]
    v_and_b32 v48, 0xffff, v48
    v_and_b32 v49, 0xffff, v49
    v_and_b32 v50, 0xffff, v50
    v_and_b32 v51, 0xffff, v51
    s_nop 3
    v_cvt_pk_bf16_f32 v32, 0, v4
    v_cvt_pk_bf16_f32 v33, 0, v5
    v_cvt_pk_bf16_f32 v34, 0, v6
    v_cvt_pk_bf16_f32 v35, 0, v7
    v_mul_f32 v32, s66, v32
    v_mul_f32 v33, s66, v33
    v_mul_f32 v34, s66, v34
    v_mul_f32 v35, s66, v35
    v_cvt_pk_bf16_f32 v16, 0, v32
    v_cvt_pk_bf16_f32 v17, 0, v33
    v_cvt_pk_bf16_f32 v18, 0, v34
    v_cvt_pk_bf16_f32 v19, 0, v35
    v_fma_f32 v32, v16, s67, -v24
    v_fma_f32 v33, v17, s67, -v24
    v_fma_f32 v34, v18, s67, -v24
    v_fma_f32 v35, v19, s67, -v24
    v_max3_f32 v28, v28, v32, v33
    v_max3_f32 v28, v28, v34, v35
    v_exp_f32 v32, v32
    v_exp_f32 v33, v33
    v_exp_f32 v34, v34
    v_exp_f32 v35, v35
    v_cvt_pk_bf16_f32 v60, v32, v33
    v_cvt_pk_bf16_f32 v61, v34, v35
    ds_write_b64 v44, v[60:61] offset:2048
    v_add_f32 v32, v32, v33
    v_add_f32 v34, v34, v35
    v_add_f32 v26, v26, v32
    v_add_f32 v26, v26, v34
    s_branch wd_81
wi_80:
    ds_read_b128 v[192:195], v48 offset:32768
    ds_read_b128 v[196:199], v49 offset:32768
    ds_read_b128 v[200:203], v50 offset:32768
    ds_read_b128 v[204:207], v51 offset:32768
    ds_read_b128 v[208:211], v48 offset:33024
    ds_read_b128 v[212:215], v49 offset:33024
    ds_read_b128 v[216:219], v50 offset:33024
    ds_read_b128 v[220:223], v51 offset:33024
    ds_read_b128 v[224:227], v48 offset:33280
    ds_read_b128 v[228:231], v49 offset:33280
    ds_read_b128 v[232:235], v50 offset:33280
    ds_read_b128 v[236:239], v51 offset:33280
    ds_read_b128 v[240:243], v48 offset:33536
    ds_read_b128 v[244:247], v49 offset:33536
    ds_read_b128 v[248:251], v50 offset:33536
    ds_read_b128 v[252:255], v51 offset:33536
    s_waitcnt lgkmcnt(15)
    v_mfma_f32_16x16x32_bf16 v[56:59], v[192:195], v[128:131], 0
    s_waitcnt lgkmcnt(14)
    v_mfma_f32_16x16x32_bf16 v[56:59], v[196:199], v[132:135], v[56:59]
    s_waitcnt lgkmcnt(13)
    v_mfma_f32_16x16x32_bf16 v[56:59], v[200:203], v[136:139], v[56:59]
    s_waitcnt lgkmcnt(12)
    v_mfma_f32_16x16x32_bf16 v[56:59], v[204:207], v[140:143], v[56:59]
    s_waitcnt lgkmcnt(11)
    v_mfma_f32_16x16x32_bf16 v[56:59], v[208:211], v[144:147], v[56:59]
    s_waitcnt lgkmcnt(10)
    v_mfma_f32_16x16x32_bf16 v[56:59], v[212:215], v[148:151], v[56:59]
    s_waitcnt lgkmcnt(9)
    v_mfma_f32_16x16x32_bf16 v[56:59], v[216:219], v[152:155], v[56:59]
    s_waitcnt lgkmcnt(8)
    v_mfma_f32_16x16x32_bf16 v[56:59], v[220:223], v[156:159], v[56:59]
    s_waitcnt lgkmcnt(7)
    v_mfma_f32_16x16x32_bf16 v[56:59], v[224:227], v[160:163], v[56:59]
    s_waitcnt lgkmcnt(6)
    v_mfma_f32_16x16x32_bf16 v[56:59], v[228:231], v[164:167], v[56:59]
    s_waitcnt lgkmcnt(5)
    v_mfma_f32_16x16x32_bf16 v[56:59], v[232:235], v[168:171], v[56:59]
    s_waitcnt lgkmcnt(4)
    v_mfma_f32_16x16x32_bf16 v[56:59], v[236:239], v[172:175], v[56:59]
    s_waitcnt lgkmcnt(3)
    v_mfma_f32_16x16x32_bf16 v[56:59], v[240:243], v[176:179], v[56:59]
    s_waitcnt lgkmcnt(2)
    v_mfma_f32_16x16x32_bf16 v[56:59], v[244:247], v[180:183], v[56:59]
    s_waitcnt lgkmcnt(1)
    v_mfma_f32_16x16x32_bf16 v[56:59], v[248:251], v[184:187], v[56:59]
    s_waitcnt lgkmcnt(0)
    v_mfma_f32_16x16x32_bf16 v[56:59], v[252:255], v[188:191], v[56:59]
    v_or_b32 v48, 0x10000, v48
    v_or_b32 v49, 0x10000, v49
    v_or_b32 v50, 0x10000, v50
    v_or_b32 v51, 0x10000, v51
    s_nop 3
    v_cvt_pk_bf16_f32 v36, 0, v56
    v_cvt_pk_bf16_f32 v37, 0, v57
    v_cvt_pk_bf16_f32 v38, 0, v58
    v_cvt_pk_bf16_f32 v39, 0, v59
    v_mul_f32 v36, s66, v36
    v_mul_f32 v37, s66, v37
    v_mul_f32 v38, s66, v38
    v_mul_f32 v39, s66, v39
    v_cvt_pk_bf16_f32 v20, 0, v36
    v_cvt_pk_bf16_f32 v21, 0, v37
    v_cvt_pk_bf16_f32 v22, 0, v38
    v_cvt_pk_bf16_f32 v23, 0, v39
    v_fma_f32 v36, v20, s67, -v25
    v_fma_f32 v37, v21, s67, -v25
    v_fma_f32 v38, v22, s67, -v25
    v_fma_f32 v39, v23, s67, -v25
    v_max3_f32 v29, v29, v36, v37
    v_max3_f32 v29, v29, v38, v39
    v_exp_f32 v36, v36
    v_exp_f32 v37, v37
    v_exp_f32 v38, v38
    v_exp_f32 v39, v39
    v_cvt_pk_bf16_f32 v62, v36, v37
    v_cvt_pk_bf16_f32 v63, v38, v39
    ds_write_b64 v44, v[62:63] offset:0
    v_add_f32 v36, v36, v37
    v_add_f32 v38, v38, v39
    v_add_f32 v27, v27, v36
    v_add_f32 v27, v27, v38
    s_waitcnt lgkmcnt(0)
    s_barrier
    ds_read_b128 v[192:195], v48 offset:32768
    ds_read_b128 v[196:199], v49 offset:32768
    ds_read_b128 v[200:203], v50 offset:32768
    ds_read_b128 v[204:207], v51 offset:32768
    ds_read_b128 v[208:211], v48 offset:33024
    ds_read_b128 v[212:215], v49 offset:33024
    ds_read_b128 v[216:219], v50 offset:33024
    ds_read_b128 v[220:223], v51 offset:33024
    ds_read_b128 v[224:227], v48 offset:33280
    ds_read_b128 v[228:231], v49 offset:33280
    ds_read_b128 v[232:235], v50 offset:33280
    ds_read_b128 v[236:239], v51 offset:33280
    ds_read_b128 v[240:243], v48 offset:33536
    ds_read_b128 v[244:247], v49 offset:33536
    ds_read_b128 v[248:251], v50 offset:33536
    ds_read_b128 v[252:255], v51 offset:33536
    s_waitcnt lgkmcnt(15)
    v_mfma_f32_16x16x32_bf16 v[56:59], v[192:195], v[128:131], 0
    s_waitcnt lgkmcnt(14)
    v_mfma_f32_16x16x32_bf16 v[56:59], v[196:199], v[132:135], v[56:59]
    s_waitcnt lgkmcnt(13)
    v_mfma_f32_16x16x32_bf16 v[56:59], v[200:203], v[136:139], v[56:59]
    s_waitcnt lgkmcnt(12)
    v_mfma_f32_16x16x32_bf16 v[56:59], v[204:207], v[140:143], v[56:59]
    s_waitcnt lgkmcnt(11)
    v_mfma_f32_16x16x32_bf16 v[56:59], v[208:211], v[144:147], v[56:59]
    s_waitcnt lgkmcnt(10)
    v_mfma_f32_16x16x32_bf16 v[56:59], v[212:215], v[148:151], v[56:59]
    s_waitcnt lgkmcnt(9)
    v_mfma_f32_16x16x32_bf16 v[56:59], v[216:219], v[152:155], v[56:59]
    s_waitcnt lgkmcnt(8)
    v_mfma_f32_16x16x32_bf16 v[56:59], v[220:223], v[156:159], v[56:59]
    s_waitcnt lgkmcnt(7)
    v_mfma_f32_16x16x32_bf16 v[56:59], v[224:227], v[160:163], v[56:59]
    s_waitcnt lgkmcnt(6)
    v_mfma_f32_16x16x32_bf16 v[56:59], v[228:231], v[164:167], v[56:59]
    s_waitcnt lgkmcnt(5)
    v_mfma_f32_16x16x32_bf16 v[56:59], v[232:235], v[168:171], v[56:59]
    s_waitcnt lgkmcnt(4)
    v_mfma_f32_16x16x32_bf16 v[56:59], v[236:239], v[172:175], v[56:59]
    s_waitcnt lgkmcnt(3)
    v_mfma_f32_16x16x32_bf16 v[56:59], v[240:243], v[176:179], v[56:59]
    s_waitcnt lgkmcnt(2)
    v_mfma_f32_16x16x32_bf16 v[56:59], v[244:247], v[180:183], v[56:59]
    s_waitcnt lgkmcnt(1)
    v_mfma_f32_16x16x32_bf16 v[56:59], v[248:251], v[184:187], v[56:59]
    s_waitcnt lgkmcnt(0)
    v_mfma_f32_16x16x32_bf16 v[56:59], v[252:255], v[188:191], v[56:59]
    s_nop 7
    v_cvt_pk_bf16_f32 v36, 0, v56
    v_cvt_pk_bf16_f32 v37, 0, v57
    v_cvt_pk_bf16_f32 v38, 0, v58
    v_cvt_pk_bf16_f32 v39, 0, v59
    v_mul_f32 v36, s66, v36
    v_mul_f32 v37, s66, v37
    v_mul_f32 v38, s66, v38
    v_mul_f32 v39, s66, v39
    v_cvt_pk_bf16_f32 v20, 0, v36
    v_cvt_pk_bf16_f32 v21, 0, v37
    v_cvt_pk_bf16_f32 v22, 0, v38
    v_cvt_pk_bf16_f32 v23, 0, v39
    v_fma_f32 v36, v20, s67, -v25
    v_fma_f32 v37, v21, s67, -v25
    v_fma_f32 v38, v22, s67, -v25
    v_fma_f32 v39, v23, s67, -v25
    v_max3_f32 v29, v29, v36, v37
    v_max3_f32 v29, v29, v38, v39
    v_exp_f32 v36, v36
    v_exp_f32 v37, v37
    v_exp_f32 v38, v38
    v_exp_f32 v39, v39
    v_cvt_pk_bf16_f32 v62, v36, v37
    v_cvt_pk_bf16_f32 v63, v38, v39
    ds_write_b64 v44, v[62:63] offset:2048
    v_add_f32 v36, v36, v37
    v_add_f32 v38, v38, v39
    v_add_f32 v27, v27, v36
    v_add_f32 v27, v27, v38
wd_81:
    v_max_f32 v40, v28, v29
    v_cmp_lt_f32 vcc, s65, v40
    v_permlane16_swap_b32 v26, v27
    v_add_f32 v26, v26, v27
    v_mov_b32 v41, v26
    s_nop 1
    v_permlane32_swap_b32 v41, v26
    v_add_f32 v26, v26, v41
    v_subrev_u32 v42, 23552, v54
    ds_write_b32 v42, v26
    s_cbranch_vccz noflag_83
    s_cmp_lg_u32 s72, 0
    s_cbranch_scc1 noflag_83
    ds_write_b32 v31, v31
noflag_83:
    s_waitcnt lgkmcnt(0)
    s_barrier
    ds_read_b32 v39, v31
    v_and_b32 v42, -16, v42
    ds_read_b128 v[44:47], v42
    s_lshl_b32 s65, s55, 8
    s_add_u32 s65, s65, 65536
    v_lshlrev_b32 v40, 3, v0
    v_and_b32 v41, 1, v2
    v_cmp_eq_u32 vcc, 1, v41
    s_nop 1
    v_cndmask_b32 v32, v24, v25, vcc
    s_setprio 0
    s_waitcnt lgkmcnt(0)
    v_readfirstlane_b32 s64, v39
    v_add_f32 v44, v44, v45
    v_add_f32 v46, v46, v47
    v_add_f32 v33, v44, v46
    s_cmp_lg_u32 s64, 0
    s_cbranch_scc1 L_qk_redo
    s_cmp_lg_u32 s56, 0
    s_cbranch_scc1 wi_84
    s_mov_b32 exec_lo, 0xffffffff
    s_mov_b32 exec_hi, 0x0
    buffer_store_dwordx2 v[32:33], v40, s[48:51], s65 offen sc1
    s_mov_b64 exec, -1
wi_84:
    s_barrier
    s_or_b32 s68, s56, s72
    s_cbranch_scc1 noring_86
    v_lshlrev_b32 v35, 10, v0
    v_mov_b32 v36, s57
    s_lshl_b32 s69, s52, 7
    s_add_u32 s69, s69, 1572864
    s_waitcnt vmcnt(1)
    v_readfirstlane_b32 s68, v43
    s_cmp_lg_u32 s68, 14
    s_cbranch_scc1 noring_86
    s_mov_b32 exec_lo, 0xffffffff
    s_mov_b32 exec_hi, 0x0
    buffer_store_dword v36, v35, s[48:51], s69 offen sc1
    s_mov_b64 exec, -1
noring_86:
    s_branch L_att_post
L_qk_redo:
    s_or_b32 s68, s56, s72
    s_cbranch_scc1 noring_87
    v_lshlrev_b32 v35, 10, v0
    v_mov_b32 v36, s57
    s_lshl_b32 s69, s52, 7
    s_add_u32 s69, s69, 1572864
    s_waitcnt vmcnt(0)
    v_readfirstlane_b32 s68, v43
    s_cmp_lg_u32 s68, 14
    s_cbranch_scc1 noring_87
    s_mov_b32 exec_lo, 0xffffffff
    s_mov_b32 exec_hi, 0x0
    buffer_store_dword v36, v35, s[48:51], s69 offen sc1
    s_mov_b64 exec, -1
noring_87:
    s_waitcnt vmcnt(0)
    v_lshlrev_b32 v53, 4, v0
    v_add_u32 v53, 131072, v53
    v_permlane16_swap_b32 v28, v29
    v_max_f32 v28, v28, v29
    v_mov_b32 v41, v28
    s_nop 1
    v_permlane32_swap_b32 v41, v28
    v_max_f32 v28, v28, v41
    ds_write_b32 v54, v28
    s_waitcnt lgkmcnt(0)
    s_barrier
    ds_read_b128 v[40:43], v55
    ds_read_b128 v[44:47], v55 offset:256
    s_waitcnt lgkmcnt(0)
    v_max3_f32 v40, v40, v41, v42
    v_max_f32 v40, v40, v43
    v_add_f32 v24, v24, v40
    v_max3_f32 v44, v44, v45, v46
    v_max_f32 v44, v44, v47
    v_add_f32 v25, v25, v44
    s_mov_b32 s72, 1
    s_branch L_qk_start
L_att_post:
    s_barrier
    s_cmp_ge_u32 s56, 4
    s_cbranch_scc1 wi_88
    s_cmp_ge_u32 s56, 2
    s_cbranch_scc1 wi_90
    v_and_b32 v40, 31, v3
    v_mul_u32_u24 v40, 3584, v40
    v_lshrrev_b32 v41, 5, v3
    v_lshl_add_u32 v40, v41, 7, v40
    s_mul_i32 s64, s54, 114688
    s_mul_i32 s68, s52, 448
    s_add_u32 s64, s64, s68
    buffer_load_dword v52, v40, s[28:31], s64 offen offset:60
    s_branch wd_91
wi_90:
    v_subrev_u32 v40, 128, v3
    v_min_u32 v40, 111, v40
    v_lshlrev_b32 v40, 7, v40
    s_mul_i32 s64, s55, 14336
    buffer_load_dword v52, v40, s[32:35], s64 offen
wd_91:
wi_88:
    s_cmp_ge_u32 s54, 14
    s_cbranch_scc1 L_fin
    s_lshr_b32 s68, s54, 1
    s_mul_i32 s65, s52, 7
    s_add_u32 s68, s68, s65
    s_and_b32 s69, s54, 1
    v_lshrrev_b32 v44, 2, v0
    v_mul_u32_u24 v44, 3584, v44
    v_and_b32 v45, 3, v0
    v_lshrrev_b32 v32, 5, v0
    v_lshlrev_b32 v32, 1, v32
    v_xor_b32 v45, v45, v32
    v_lshl_add_u32 v44, v45, 4, v44
    v_lshlrev_b32 v32, 4, v0
    s_lshl_b32 s64, s68, 6
    s_mul_i32 s65, s56, 229376
    s_add_u32 s64, s64, s65
    s_lshl_b32 s65, s56, 12
    s_add_u32 s66, s65, 32768
    s_barrier
    s_mov_b32 m0, s66
    s_nop 0
    buffer_load_dwordx4 v44, s[28:31], s64 offen  lds
    s_add_u32 s64, s64, 57344
    s_add_u32 s66, s66, 1024
    s_mov_b32 m0, s66
    s_nop 0
    buffer_load_dwordx4 v44, s[28:31], s64 offen  lds
    s_add_u32 s64, s64, 57344
    s_add_u32 s66, s66, 1024
    s_mov_b32 m0, s66
    s_nop 0
    buffer_load_dwordx4 v44, s[28:31], s64 offen  lds
    s_add_u32 s64, s64, 57344
    s_add_u32 s66, s66, 1024
    s_mov_b32 m0, s66
    s_nop 0
    buffer_load_dwordx4 v44, s[28:31], s64 offen  lds
    s_cmp_lt_u32 s56, 4
    s_cbranch_scc1 wi_92
    s_mov_b32 s78, s69
    s_lshl_b32 s69, s79, 13
    s_min_u32 s64, s54, 13
    s_lshr_b32 s64, s64, 1
    s_mul_i32 s65, s52, 7
    s_add_u32 s64, s64, s65
    s_lshl_b32 s64, s64, 15
    s_add_u32 s64, s64, s69
    s_add_u32 s64, s64, 0
    s_add_u32 m0, s69, 0
    v_lshlrev_b32 v43, 4, v0
    s_and_b32 s65, s56, 1
    s_lshl_b32 s65, s65, 7
    v_xor_b32 v43, s65, v43
    v_xor_b32 v46, 0, v43
    buffer_load_dwordx4 v46, s[32:35], s64 offen offset:0  lds
    v_xor_b32 v46, 32, v43
    buffer_load_dwordx4 v46, s[32:35], s64 offen offset:1024  lds
    v_xor_b32 v46, 64, v43
    buffer_load_dwordx4 v46, s[32:35], s64 offen offset:2048  lds
    v_xor_b32 v46, 96, v43
    buffer_load_dwordx4 v46, s[32:35], s64 offen offset:3072  lds
    s_min_u32 s64, s54, 13
    s_lshr_b32 s64, s64, 1
    s_mul_i32 s65, s52, 7
    s_add_u32 s64, s64, s65
    s_lshl_b32 s64, s64, 15
    s_add_u32 s64, s64, s69
    s_add_u32 s64, s64, 4096
    s_add_u32 m0, s69, 4096
    v_lshlrev_b32 v43, 4, v0
    s_and_b32 s65, s56, 1
    s_lshl_b32 s65, s65, 7
    v_xor_b32 v43, s65, v43
    v_xor_b32 v46, 0, v43
    buffer_load_dwordx4 v46, s[32:35], s64 offen offset:0  lds
    v_xor_b32 v46, 32, v43
    buffer_load_dwordx4 v46, s[32:35], s64 offen offset:1024  lds
    v_xor_b32 v46, 64, v43
    buffer_load_dwordx4 v46, s[32:35], s64 offen offset:2048  lds
    v_xor_b32 v46, 96, v43
    buffer_load_dwordx4 v46, s[32:35], s64 offen offset:3072  lds
    s_mov_b32 s69, s78
wi_92:
    v_and_b32 v38, 3, v1
    s_lshl_b32 s64, s69, 12
    s_lshl_b32 s65, s56, 9
    s_add_u32 s65, s65, s64
    v_and_b32 v33, 31, v0
    v_lshlrev_b32 v33, 4, v33
    v_lshrrev_b32 v34, 5, v0
    v_lshl_add_u32 v33, v34, 3, v33
    buffer_load_dwordx2 v[40:41], v33, s[4:7], s65 offen
    s_add_u32 s65, s65, 32768
    s_add_u32 s66, s65, 8192
    s_add_u32 s67, s65, 16384
    s_mov_b32 s63, 60000
poll_94:
    buffer_load_dwordx2 v[44:45], v33, s[48:51], s65 offen sc1
    buffer_load_dwordx2 v[46:47], v33, s[48:51], s66 offen sc1
    buffer_load_dwordx2 v[48:49], v33, s[48:51], s67 offen sc1
    s_waitcnt vmcnt(0)
    v_max3_u32 v56, v44, v45, v46
    v_max3_u32 v56, v56, v47, v48
    v_max_u32 v56, v56, v49
    v_cmp_eq_u32 vcc, -1, v56
    s_cbranch_vccz pdone_95
    s_sleep 1
    s_sub_u32 s63, s63, 1
    s_cbranch_scc0 poll_94
pdone_95:
    s_lshr_b32 s64, s56, 1
    s_and_b32 s65, s56, 1
    s_mul_i32 s66, s64, 1040
    s_lshl_b32 s67, s65, 9
    s_add_u32 s66, s66, s67
    s_add_u32 s66, s66, 139264
    v_add_u32 v39, s66, v33
    ds_write_b64 v39, v[48:49] offset:4160
    ds_write_b64 v39, v[46:47] offset:8320
    v_lshlrev_b32 v160, 16, v40
    v_and_b32 v161, 0xffff0000, v40
    v_lshlrev_b32 v162, 16, v41
    v_and_b32 v163, 0xffff0000, v41
    v_lshlrev_b32 v164, 16, v44
    v_and_b32 v165, 0xffff0000, v44
    v_lshlrev_b32 v166, 16, v45
    v_and_b32 v167, 0xffff0000, v45
    v_lshlrev_b32 v168, 16, v48
    v_and_b32 v169, 0xffff0000, v48
    v_lshlrev_b32 v170, 16, v49
    v_and_b32 v171, 0xffff0000, v49
    s_waitcnt lgkmcnt(0)
    s_barrier
    v_lshrrev_b32 v34, 2, v1
    v_lshl_add_u32 v34, v2, 3, v34
    v_lshlrev_b32 v35, 6, v34
    v_lshl_add_u32 v35, v38, 3, v35
    v_and_b32 v36, 1, v2
    v_xor_b32 v36, s65, v36
    v_lshl_add_u32 v35, v36, 5, v35
    s_lshl_b32 s66, s64, 13
    v_add_u32 v35, s66, v35
    ds_read_b64_tr_b16 v[128:129], v35 offset:32768
    ds_read_b64_tr_b16 v[130:131], v35 offset:33024
    ds_read_b64_tr_b16 v[132:133], v35 offset:34816
    ds_read_b64_tr_b16 v[134:135], v35 offset:35072
    ds_read_b64_tr_b16 v[136:137], v35 offset:36864
    ds_read_b64_tr_b16 v[138:139], v35 offset:37120
    ds_read_b64_tr_b16 v[140:141], v35 offset:38912
    ds_read_b64_tr_b16 v[142:143], v35 offset:39168
    v_lshlrev_b32 v35, 10, v34
    v_lshl_add_u32 v35, v38, 3, v35
    v_lshrrev_b32 v36, 2, v1
    v_and_b32 v37, 1, v2
    v_lshl_add_u32 v36, v37, 2, v36
    s_and_b32 s66, s56, 3
    s_lshl_b32 s66, s66, 3
    v_xor_b32 v36, s66, v36
    v_lshl_add_u32 v35, v36, 5, v35
    v_xor_b32 v36, 0, v35
    ds_read_b64_tr_b16 v[192:193], v36 offset:0
    ds_read_b64_tr_b16 v[194:195], v36 offset:4096
    v_xor_b32 v36, 32, v35
    ds_read_b64_tr_b16 v[196:197], v36 offset:0
    ds_read_b64_tr_b16 v[198:199], v36 offset:4096
    v_xor_b32 v36, 64, v35
    ds_read_b64_tr_b16 v[200:201], v36 offset:0
    ds_read_b64_tr_b16 v[202:203], v36 offset:4096
    v_xor_b32 v36, 96, v35
    ds_read_b64_tr_b16 v[204:205], v36 offset:0
    ds_read_b64_tr_b16 v[206:207], v36 offset:4096
    v_xor_b32 v36, 128, v35
    ds_read_b64_tr_b16 v[208:209], v36 offset:0
    ds_read_b64_tr_b16 v[210:211], v36 offset:4096
    v_xor_b32 v36, 160, v35
    ds_read_b64_tr_b16 v[212:213], v36 offset:0
    ds_read_b64_tr_b16 v[214:215], v36 offset:4096
    v_xor_b32 v36, 192, v35
    ds_read_b64_tr_b16 v[216:217], v36 offset:0
    ds_read_b64_tr_b16 v[218:219], v36 offset:4096
    v_xor_b32 v36, 224, v35
    ds_read_b64_tr_b16 v[220:221], v36 offset:0
    ds_read_b64_tr_b16 v[222:223], v36 offset:4096
    v_and_b32 v42, 7, v1
    v_mul_u32_u24 v34, 1040, v42
    v_lshl_add_u32 v34, v2, 4, v34
    s_lshl_b32 s66, s64, 8
    s_add_u32 s66, s66, 139264
    v_add_u32 v34, s66, v34
    v_mul_u32_u24 v35, 144, v42
    v_lshl_add_u32 v35, v2, 4, v35
    s_mul_i32 s66, s64, 1216
    s_lshl_b32 s67, s65, 6
    s_add_u32 s66, s66, s67
    s_add_u32 s66, s66, 152576
    v_add_u32 v35, s66, v35
    v_lshrrev_b32 v36, 2, v1
    v_mul_u32_u24 v36, 1216, v36
    v_mul_u32_u24 v43, 144, v38
    v_add_u32 v36, v36, v43
    v_lshl_add_u32 v36, v2, 5, v36
    v_add_u32 v36, 152576, v36
    v_lshrrev_b32 v37, 1, v38
    v_mul_u32_u24 v37, 7168, v37
    v_and_b32 v43, 1, v38
    v_lshl_add_u32 v37, v43, 6, v37
    v_lshl_add_u32 v37, v2, 4, v37
    v_lshrrev_b32 v43, 2, v1
    v_mul_u32_u24 v43, 28672, v43
    v_add_u32 v37, v37, v43
    v_lshlrev_b32 v50, 4, v38
    v_add_u32 v50, 157696, v50
    s_lshl_b32 s66, s56, 3
    s_add_u32 s66, s66, 157696
    v_mov_b32 v51, s66
    ds_read_b128 v[64:67], v34 offset:4160
    ds_read_b128 v[68:71], v34 offset:4224
    ds_read_b128 v[72:75], v34 offset:4288
    ds_read_b128 v[76:79], v34 offset:4352
    s_waitcnt lgkmcnt(0)
    v_mfma_f32_16x16x32_bf16 v[80:83], v[128:131], v[64:67], 0
    v_mfma_f32_16x16x32_bf16 v[80:83], v[132:135], v[68:71], v[80:83]
    v_mfma_f32_16x16x32_bf16 v[80:83], v[136:139], v[72:75], v[80:83]
    v_mfma_f32_16x16x32_bf16 v[80:83], v[140:143], v[76:79], v[80:83]
    s_mov_b32 exec_lo, 0xff00ff
    s_mov_b32 exec_hi, 0xff00ff
    s_nop 5
    ds_write_b128 v35, v[80:83]
    s_mov_b64 exec, -1
    s_waitcnt lgkmcnt(0)
    s_barrier
    ds_read_b128 v[176:179], v36
    ds_read_b128 v[180:183], v36 offset:16
    ds_read_b128 v[184:187], v36 offset:576
    ds_read_b128 v[188:191], v36 offset:592
    s_lshl_b32 s66, s69, 15
    s_lshl_b32 s67, s64, 13
    s_add_u32 s66, s66, s67
    s_lshl_b32 s67, s65, 9
    s_add_u32 s66, s66, s67
    s_add_u32 s66, s66, 116736
    s_add_u32 s67, s66, 4096
    s_lshl_b32 s64, s56, 5
    s_lshl_b32 s65, s69, 1
    s_add_u32 s64, s64, s65
    s_mul_i32 s64, s64, 7168
    s_lshl_b32 s65, s68, 7
    s_add_u32 s64, s64, s65
    s_add_u32 s64, s64, 215040
    s_mov_b32 s65, 0xff
    v_lshrrev_b32 v40, 0, s57
    v_lshrrev_b32 v41, 8, s57
    v_lshrrev_b32 v42, 16, s57
    v_lshrrev_b32 v43, 24, s57
    s_waitcnt lgkmcnt(0)
    v_add_f32_dpp v176, v176, v176 row_ror:8 row_mask:0xf bank_mask:0xf
    v_add_f32_dpp v177, v177, v177 row_ror:8 row_mask:0xf bank_mask:0xf
    v_add_f32_dpp v178, v178, v178 row_ror:8 row_mask:0xf bank_mask:0xf
    v_add_f32_dpp v179, v179, v179 row_ror:8 row_mask:0xf bank_mask:0xf
    v_add_f32_dpp v180, v180, v180 row_ror:8 row_mask:0xf bank_mask:0xf
    v_add_f32_dpp v181, v181, v181 row_ror:8 row_mask:0xf bank_mask:0xf
    v_add_f32_dpp v182, v182, v182 row_ror:8 row_mask:0xf bank_mask:0xf
    v_add_f32_dpp v183, v183, v183 row_ror:8 row_mask:0xf bank_mask:0xf
    v_add_f32_dpp v184, v184, v184 row_ror:8 row_mask:0xf bank_mask:0xf
    v_add_f32_dpp v185, v185, v185 row_ror:8 row_mask:0xf bank_mask:0xf
    v_add_f32_dpp v186, v186, v186 row_ror:8 row_mask:0xf bank_mask:0xf
    v_add_f32_dpp v187, v187, v187 row_ror:8 row_mask:0xf bank_mask:0xf
    v_add_f32_dpp v188, v188, v188 row_ror:8 row_mask:0xf bank_mask:0xf
    v_add_f32_dpp v189, v189, v189 row_ror:8 row_mask:0xf bank_mask:0xf
    v_add_f32_dpp v190, v190, v190 row_ror:8 row_mask:0xf bank_mask:0xf
    v_add_f32_dpp v191, v191, v191 row_ror:8 row_mask:0xf bank_mask:0xf
    v_add_f32_dpp v176, v176, v176 row_ror:4 row_mask:0xf bank_mask:0xf
    v_add_f32_dpp v177, v177, v177 row_ror:4 row_mask:0xf bank_mask:0xf
    v_add_f32_dpp v178, v178, v178 row_ror:4 row_mask:0xf bank_mask:0xf
    v_add_f32_dpp v179, v179, v179 row_ror:4 row_mask:0xf bank_mask:0xf
    v_add_f32_dpp v180, v180, v180 row_ror:4 row_mask:0xf bank_mask:0xf
    v_add_f32_dpp v181, v181, v181 row_ror:4 row_mask:0xf bank_mask:0xf
    v_add_f32_dpp v182, v182, v182 row_ror:4 row_mask:0xf bank_mask:0xf
    v_add_f32_dpp v183, v183, v183 row_ror:4 row_mask:0xf bank_mask:0xf
    v_add_f32_dpp v184, v184, v184 row_ror:4 row_mask:0xf bank_mask:0xf
    v_add_f32_dpp v185, v185, v185 row_ror:4 row_mask:0xf bank_mask:0xf
    v_add_f32_dpp v186, v186, v186 row_ror:4 row_mask:0xf bank_mask:0xf
    v_add_f32_dpp v187, v187, v187 row_ror:4 row_mask:0xf bank_mask:0xf
    v_add_f32_dpp v188, v188, v188 row_ror:4 row_mask:0xf bank_mask:0xf
    v_add_f32_dpp v189, v189, v189 row_ror:4 row_mask:0xf bank_mask:0xf
    v_add_f32_dpp v190, v190, v190 row_ror:4 row_mask:0xf bank_mask:0xf
    v_add_f32_dpp v191, v191, v191 row_ror:4 row_mask:0xf bank_mask:0xf
    v_and_b32 v57, 31, v0
    v_lshlrev_b32 v57, 4, v57
    v_lshrrev_b32 v58, 5, v0
    v_lshl_add_u32 v57, v58, 12, v57
    s_cmp_lg_u32 s56, 0
    s_cbranch_scc1 nohw_96
    s_lshl_b32 s78, s55, 7
    s_add_u32 s78, s78, 182272
    s_mov_b32 s63, 60000
hw_97:
    s_load_dword s79, s[48:49], s78 glc
    s_waitcnt lgkmcnt(0)
    s_cmp_eq_u32 s79, s57
    s_cbranch_scc1 hd_98
    s_sub_u32 s63, s63, 1
    s_cbranch_scc0 hw_97
hd_98:
nohw_96:
    s_barrier
    s_mov_b32 s63, 60000
poll_99:
    buffer_load_dwordx4 v[64:67], v57, s[48:51], s66 offen offset:0 sc1
    buffer_load_dwordx4 v[68:71], v57, s[48:51], s66 offen offset:1024 sc1
    buffer_load_dwordx4 v[72:75], v57, s[48:51], s66 offen offset:2048 sc1
    buffer_load_dwordx4 v[76:79], v57, s[48:51], s66 offen offset:3072 sc1
    s_waitcnt vmcnt(0)
    v_max3_u32 v56, v64, v66, v68
    v_max3_u32 v56, v56, v70, v72
    v_max3_u32 v56, v56, v74, v76
    v_max_u32 v56, v56, v78
    v_cmp_eq_u32 vcc, -1, v56
    s_cbranch_vccz pdone_100
    s_sub_u32 s63, s63, 1
    s_cbranch_scc0 poll_99
pdone_100:
    s_cmp_lg_u32 s56, 6
    s_cbranch_scc1 nohint_101
    s_lshl_b32 s78, s55, 7
    s_add_u32 s78, s78, 198720
    v_mov_b32 v112, s57
    v_mov_b32 v113, 0
    s_mov_b32 exec_lo, 0x1
    s_mov_b32 exec_hi, 0x0
    buffer_store_dword v112, v113, s[48:51], s78 offen sc1
    s_mov_b64 exec, -1
nohint_101:
    v_lshlrev_b32 v80, 16, v64
    v_lshlrev_b32 v81, 16, v65
    v_lshlrev_b32 v82, 16, v66
    v_lshlrev_b32 v83, 16, v67
    v_lshlrev_b32 v84, 16, v68
    v_lshlrev_b32 v85, 16, v69
    v_lshlrev_b32 v86, 16, v70
    v_lshlrev_b32 v87, 16, v71
    v_lshlrev_b32 v88, 16, v72
    v_lshlrev_b32 v89, 16, v73
    v_lshlrev_b32 v90, 16, v74
    v_lshlrev_b32 v91, 16, v75
    v_lshlrev_b32 v92, 16, v76
    v_lshlrev_b32 v93, 16, v77
    v_lshlrev_b32 v94, 16, v78
    v_lshlrev_b32 v95, 16, v79
    v_pk_add_f32 v[64:65], v[64:65], v[72:73]
    v_pk_add_f32 v[66:67], v[66:67], v[74:75]
    v_pk_add_f32 v[68:69], v[68:69], v[76:77]
    v_pk_add_f32 v[70:71], v[70:71], v[78:79]
    v_pk_add_f32 v[80:81], v[80:81], v[88:89]
    v_pk_add_f32 v[82:83], v[82:83], v[90:91]
    v_pk_add_f32 v[84:85], v[84:85], v[92:93]
    v_pk_add_f32 v[86:87], v[86:87], v[94:95]
    v_pk_add_f32 v[64:65], v[64:65], v[68:69]
    v_pk_add_f32 v[66:67], v[66:67], v[70:71]
    v_pk_add_f32 v[80:81], v[80:81], v[84:85]
    v_pk_add_f32 v[82:83], v[82:83], v[86:87]
    s_nop 1
    v_permlane32_swap_b32 v80, v82
    v_permlane32_swap_b32 v81, v83
    v_permlane32_swap_b32 v64, v66
    v_permlane32_swap_b32 v65, v67
    v_pk_add_f32 v[68:69], v[80:81], v[82:83]
    v_pk_add_f32 v[64:65], v[64:65], v[66:67]
    v_fma_f32 v80, v68, v164, v160
    v_fma_f32 v81, v64, v165, v161
    v_fma_f32 v82, v69, v166, v162
    v_fma_f32 v83, v65, v167, v163
    v_mul_f32 v84, v80, v168
    v_mul_f32 v85, v81, v169
    v_mul_f32 v86, v82, v170
    v_mul_f32 v87, v83, v171
    v_cvt_pk_bf16_f32 v88, v84, v85
    v_cvt_pk_bf16_f32 v89, v86, v87
    ds_write_b64 v39, v[88:89]
    v_add_f32 v52, v80, v81
    v_mul_f32 v53, v80, v80
    v_add_f32 v54, v82, v83
    v_fmac_f32 v53, v81, v81
    v_add_f32 v52, v52, v54
    v_fmac_f32 v53, v82, v82
    v_fmac_f32 v53, v83, v83
    s_waitcnt lgkmcnt(0)
    s_barrier
    ds_read_b128 v[64:67], v34 offset:0
    ds_read_b128 v[68:71], v34 offset:64
    ds_read_b128 v[72:75], v34 offset:128
    ds_read_b128 v[76:79], v34 offset:192
    v_add_f32_dpp v52, v52, v52 row_ror:8 row_mask:0xf bank_mask:0xf
    v_add_f32_dpp v53, v53, v53 row_ror:8 row_mask:0xf bank_mask:0xf
    s_nop 0
    v_add_f32_dpp v52, v52, v52 row_ror:4 row_mask:0xf bank_mask:0xf
    v_add_f32_dpp v53, v53, v53 row_ror:4 row_mask:0xf bank_mask:0xf
    s_nop 0
    v_add_f32_dpp v52, v52, v52 row_ror:2 row_mask:0xf bank_mask:0xf
    v_add_f32_dpp v53, v53, v53 row_ror:2 row_mask:0xf bank_mask:0xf
    s_nop 0
    v_add_f32_dpp v52, v52, v52 row_ror:1 row_mask:0xf bank_mask:0xf
    v_add_f32_dpp v53, v53, v53 row_ror:1 row_mask:0xf bank_mask:0xf
    s_waitcnt lgkmcnt(3)
    v_mfma_f32_16x16x32_bf16 v[80:83], v[128:131], v[64:67], 0
    s_waitcnt lgkmcnt(2)
    v_mfma_f32_16x16x32_bf16 v[80:83], v[132:135], v[68:71], v[80:83]
    s_waitcnt lgkmcnt(1)
    v_mfma_f32_16x16x32_bf16 v[80:83], v[136:139], v[72:75], v[80:83]
    s_waitcnt lgkmcnt(0)
    v_mfma_f32_16x16x32_bf16 v[80:83], v[140:143], v[76:79], v[80:83]
    v_add_f32_dpp v52, v52, v52 row_bcast:15 row_mask:0xa bank_mask:0xf
    v_add_f32_dpp v53, v53, v53 row_bcast:15 row_mask:0xa bank_mask:0xf
    s_nop 0
    v_add_f32_dpp v52, v52, v52 row_bcast:31 row_mask:0xc bank_mask:0xf
    v_add_f32_dpp v53, v53, v53 row_bcast:31 row_mask:0xc bank_mask:0xf
    s_mov_b32 exec_lo, 0x0
    s_mov_b32 exec_hi, 0x80000000
    ds_write_b64 v51, v[52:53]
    s_mov_b32 exec_lo, 0xf000f
    s_mov_b32 exec_hi, 0xf000f
    ds_write_b128 v35, v[80:83]
    s_mov_b64 exec, -1
    s_waitcnt lgkmcnt(0)
    s_barrier
    s_cmp_ge_u32 s56, 4
    s_cbranch_scc1 L_fin
    s_add_u32 s66, s64, 114688
    ds_read_b128 v[52:55], v50
    ds_read_b128 v[64:67], v36
    ds_read_b128 v[68:71], v36 offset:16
    s_waitcnt lgkmcnt(2)
    v_add_f32 v52, v52, v54
    v_add_f32 v53, v53, v55
    v_mul_f32 v52, 0x3b000000, v52
    v_mul_f32 v53, 0x3b000000, v53
    v_fma_f32 v53, -v52, v52, v53
    v_max_f32 v53, 0, v53
    v_add_f32 v53, 0x3727c5ac, v53
    v_rsq_f32 v53, v53
    s_waitcnt lgkmcnt(0)
    v_add_f32_dpp v64, v64, v64 row_ror:8 row_mask:0xf bank_mask:0xf
    v_add_f32_dpp v65, v65, v65 row_ror:8 row_mask:0xf bank_mask:0xf
    v_add_f32_dpp v66, v66, v66 row_ror:8 row_mask:0xf bank_mask:0xf
    v_add_f32_dpp v67, v67, v67 row_ror:8 row_mask:0xf bank_mask:0xf
    v_add_f32_dpp v68, v68, v68 row_ror:8 row_mask:0xf bank_mask:0xf
    v_add_f32_dpp v69, v69, v69 row_ror:8 row_mask:0xf bank_mask:0xf
    v_add_f32_dpp v70, v70, v70 row_ror:8 row_mask:0xf bank_mask:0xf
    v_add_f32_dpp v71, v71, v71 row_ror:8 row_mask:0xf bank_mask:0xf
    v_add_f32_dpp v64, v64, v64 row_ror:4 row_mask:0xf bank_mask:0xf
    v_add_f32_dpp v65, v65, v65 row_ror:4 row_mask:0xf bank_mask:0xf
    v_add_f32_dpp v66, v66, v66 row_ror:4 row_mask:0xf bank_mask:0xf
    v_add_f32_dpp v67, v67, v67 row_ror:4 row_mask:0xf bank_mask:0xf
    v_add_f32_dpp v68, v68, v68 row_ror:4 row_mask:0xf bank_mask:0xf
    v_add_f32_dpp v69, v69, v69 row_ror:4 row_mask:0xf bank_mask:0xf
    v_add_f32_dpp v70, v70, v70 row_ror:4 row_mask:0xf bank_mask:0xf
    v_add_f32_dpp v71, v71, v71 row_ror:4 row_mask:0xf bank_mask:0xf
    v_mov_b32 v54, v53
    v_mov_b32 v55, v53
    v_sub_f32 v52, 0, v52
    v_mov_b32 v53, v52
    v_pk_fma_f32 v[64:65], v[52:53], v[176:177], v[64:65]
    v_pk_fma_f32 v[66:67], v[52:53], v[178:179], v[66:67]
    v_pk_fma_f32 v[68:69], v[52:53], v[180:181], v[68:69]
    v_pk_fma_f32 v[70:71], v[52:53], v[182:183], v[70:71]
    v_pk_fma_f32 v[64:65], v[54:55], v[64:65], v[184:185]
    v_pk_fma_f32 v[66:67], v[54:55], v[66:67], v[186:187]
    v_pk_fma_f32 v[68:69], v[54:55], v[68:69], v[188:189]
    v_pk_fma_f32 v[70:71], v[54:55], v[70:71], v[190:191]
    v_cvt_pk_bf16_f32 v72, v64, v65
    v_cvt_pk_bf16_f32 v73, v66, v67
    v_cvt_pk_bf16_f32 v74, v68, v69
    v_cvt_pk_bf16_f32 v75, v70, v71
    v_pk_max_i16 v72, v72, 0
    v_pk_max_i16 v73, v73, 0
    v_pk_max_i16 v74, v74, 0
    v_pk_max_i16 v75, v75, 0
    s_nop 1
    v_mfma_f32_16x16x32_bf16 v[80:83], v[192:195], v[72:75], 0
    v_mfma_f32_16x16x32_bf16 v[84:87], v[196:199], v[72:75], 0
    v_mfma_f32_16x16x32_bf16 v[88:91], v[200:203], v[72:75], 0
    v_mfma_f32_16x16x32_bf16 v[92:95], v[204:207], v[72:75], 0
    v_mfma_f32_16x16x32_bf16 v[96:99], v[208:211], v[72:75], 0
    v_mfma_f32_16x16x32_bf16 v[100:103], v[212:215], v[72:75], 0
    v_mfma_f32_16x16x32_bf16 v[104:107], v[216:219], v[72:75], 0
    v_mfma_f32_16x16x32_bf16 v[108:111], v[220:223], v[72:75], 0
    s_nop 1
    v_mov_b32_dpp v80, v84 quad_perm:[0,1,2,3] row_mask:0xf bank_mask:0x2
    v_mov_b32_dpp v81, v85 quad_perm:[0,1,2,3] row_mask:0xf bank_mask:0x2
    v_mov_b32_dpp v82, v86 quad_perm:[0,1,2,3] row_mask:0xf bank_mask:0x2
    v_mov_b32_dpp v83, v87 quad_perm:[0,1,2,3] row_mask:0xf bank_mask:0x2
    v_mov_b32_dpp v80, v88 quad_perm:[0,1,2,3] row_mask:0xf bank_mask:0x4
    v_mov_b32_dpp v81, v89 quad_perm:[0,1,2,3] row_mask:0xf bank_mask:0x4
    v_mov_b32_dpp v82, v90 quad_perm:[0,1,2,3] row_mask:0xf bank_mask:0x4
    v_mov_b32_dpp v83, v91 quad_perm:[0,1,2,3] row_mask:0xf bank_mask:0x4
    v_mov_b32_dpp v80, v92 quad_perm:[0,1,2,3] row_mask:0xf bank_mask:0x8
    v_mov_b32_dpp v81, v93 quad_perm:[0,1,2,3] row_mask:0xf bank_mask:0x8
    v_mov_b32_dpp v82, v94 quad_perm:[0,1,2,3] row_mask:0xf bank_mask:0x8
    v_mov_b32_dpp v83, v95 quad_perm:[0,1,2,3] row_mask:0xf bank_mask:0x8
    v_bfi_b32 v80, s65, v40, v80
    v_bfi_b32 v81, s65, v41, v81
    v_bfi_b32 v82, s65, v42, v82
    v_bfi_b32 v83, s65, v43, v83
    buffer_store_dwordx4 v[80:83], v37, s[48:51], s64 offen sc1
    v_mov_b32_dpp v96, v100 quad_perm:[0,1,2,3] row_mask:0xf bank_mask:0x2
    v_mov_b32_dpp v97, v101 quad_perm:[0,1,2,3] row_mask:0xf bank_mask:0x2
    v_mov_b32_dpp v98, v102 quad_perm:[0,1,2,3] row_mask:0xf bank_mask:0x2
    v_mov_b32_dpp v99, v103 quad_perm:[0,1,2,3] row_mask:0xf bank_mask:0x2
    v_mov_b32_dpp v96, v104 quad_perm:[0,1,2,3] row_mask:0xf bank_mask:0x4
    v_mov_b32_dpp v97, v105 quad_perm:[0,1,2,3] row_mask:0xf bank_mask:0x4
    v_mov_b32_dpp v98, v106 quad_perm:[0,1,2,3] row_mask:0xf bank_mask:0x4
    v_mov_b32_dpp v99, v107 quad_perm:[0,1,2,3] row_mask:0xf bank_mask:0x4
    v_mov_b32_dpp v96, v108 quad_perm:[0,1,2,3] row_mask:0xf bank_mask:0x8
    v_mov_b32_dpp v97, v109 quad_perm:[0,1,2,3] row_mask:0xf bank_mask:0x8
    v_mov_b32_dpp v98, v110 quad_perm:[0,1,2,3] row_mask:0xf bank_mask:0x8
    v_mov_b32_dpp v99, v111 quad_perm:[0,1,2,3] row_mask:0xf bank_mask:0x8
    v_bfi_b32 v96, s65, v40, v96
    v_bfi_b32 v97, s65, v41, v97
    v_bfi_b32 v98, s65, v42, v98
    v_bfi_b32 v99, s65, v43, v99
    buffer_store_dwordx4 v[96:99], v37, s[48:51], s66 offen sc1
    s_cmp_lg_u32 s56, 0
    s_cbranch_scc1 nohint_102
    s_lshl_b32 s78, s55, 7
    s_add_u32 s78, s78, 198656
    v_mov_b32 v112, s57
    v_mov_b32 v113, 0
    s_mov_b32 exec_lo, 0x1
    s_mov_b32 exec_hi, 0x0
    buffer_store_dword v112, v113, s[48:51], s78 offen sc1
    s_mov_b64 exec, -1
nohint_102:
L_fin:
L_end:
    s_endpgm
L_code_end:
.section .rodata,"a"
.p2align 6
.amdhsa_kernel adaLN_cond__compressed_kv_cla__dense_activation_relu__decode_kernel
  .amdhsa_next_free_vgpr 256
  .amdhsa_next_free_sgpr 102
  .amdhsa_accum_offset 256
  .amdhsa_group_segment_fixed_size 0
  .amdhsa_kernarg_size 112
  .amdhsa_user_sgpr_count 2
  .amdhsa_user_sgpr_kernarg_segment_ptr 1
  .amdhsa_system_sgpr_workgroup_id_x 1
.end_amdhsa_kernel
```
